```python
import torch

def _softmax(x, axis=-1):
    return torch.softmax(x, dim=axis)
def _gelu(x):
    return torch.nn.functional.gelu(x, approximate="tanh")
def _silu(x):
    return torch.nn.functional.silu(x)
def _sigmoid(x):
    return torch.sigmoid(x)
def _layernorm(x, axis=-1, eps=1e-5):
    m = x.mean(dim=axis, keepdim=True)
    v = x.var(dim=axis, keepdim=True, unbiased=False)
    return (x - m) / torch.sqrt(v + eps)
def _scatter_add(tgt, idx, src, axis=0):
    return tgt.clone().index_add_(axis, idx, src)
def _segment_sum(src, seg, n):
    out = torch.zeros((n,) + src.shape[1:], dtype=src.dtype)
    return out.index_add_(0, seg, src)
def _pad(x, pw):
    flat = tuple(v for pair in reversed(pw) for v in pair)
    return torch.nn.functional.pad(x, flat)

kernel_name = 'standalone__seq2seq_rnn_t_joint__speech'

def setup_inputs():

    _w = (lambda a: (lambda t: t.to(torch.bfloat16) if t.is_floating_point() else t)(torch.as_tensor(a)))
    B, T, D, K = 2, 16000, 256, 31
    U = 8
    sc = (1.0 / (K * D)) ** 0.5
    sd = (1.0 / D) ** 0.5
    return {
        "x": _w((lambda *s: torch.randn(*s, dtype=torch.bfloat16) * 0.2)(B, T, D) * 0.5),
        "w1": _w((lambda *s: torch.randn(*s, dtype=torch.bfloat16) * 3.2)(K, D, D) * sc),
        "w2": _w((lambda *s: torch.randn(*s, dtype=torch.bfloat16) * 3.2)(K, D, D) * sc),
        "g": _w((lambda *s: torch.randn(*s, dtype=torch.bfloat16) * 3.2)(B, U, D) * 0.5),
        "w_f": _w((lambda *s: torch.randn(*s, dtype=torch.bfloat16) * 3.2)(D, D) * sd),
        "w_g": _w((lambda *s: torch.randn(*s, dtype=torch.bfloat16) * 3.2)(D, D) * sd),
        "w_o": _w((lambda *s: torch.randn(*s, dtype=torch.bfloat16) * 3.2)(D, D) * sd),
    }

def reference(x, w1, w2, g, w_f, w_g, w_o):
    B, T, D = x.shape
    K = w1.shape[0]
    pad = K // 2
    xp = _pad(x, ((0,0),(pad,pad),(0,0)))
    h = torch.zeros_like(x)
    for i in range(K):
        h = h + torch.einsum("btc,cd->btd", xp[:, i:i+T, :], w1[i])
    h = _gelu(h)[:, ::2, :]
    T1 = h.shape[1]
    hp = _pad(h, ((0,0),(pad,pad),(0,0)))
    f = torch.zeros_like(h)
    for i in range(K):
        f = f + torch.einsum("btc,cd->btd", hp[:, i:i+T1, :], w2[i])
    f = _gelu(f)[:, ::2, :]
    fe = torch.einsum("btd,de->bte", f, w_f)
    ge = torch.einsum("bud,de->bue", g, w_g)
    j = torch.tanh(fe[:, :, None, :] + ge[:, None, :, :])
    return torch.einsum("btud,dv->btuv", j, w_o)
```

```asm
; @launch kernel=prep_kernel grid=(937,1,1) block=(256,1,1) lds=40960
; @launch kernel=gemm1_kernel grid=(256,1,1) block=(512,1,1) lds=143360
; @launch kernel=mid_kernel grid=(704,1,1) block=(256,1,1) lds=57344
; @launch kernel=gemm2_kernel grid=(256,1,1) block=(512,1,1) lds=143360
; @launch kernel=joint_kernel grid=(250,1,1) block=(256,1,1) lds=98368
.amdgcn_target "amdgcn-amd-amdhsa--gfx950"
.text
.globl prep_kernel
.p2align 8
.type prep_kernel,@function
prep_kernel:
    s_cmp_ge_u32 s2, 937
    s_cbranch_scc1 L_prep_kernel_done
    v_readfirstlane_b32 s20, v0
    s_lshr_b32 s20, s20, 6
    s_cmp_lt_u32 s2, 13
    s_cbranch_scc1 L_prep_kernel_slab
    s_cmp_ge_u32 s2, 681
    s_cbranch_scc1 L_prep_kernel_g
    s_load_dwordx2 s[4:5], s[0:1], 0
    s_load_dwordx2 s[6:7], s[0:1], 72
    s_sub_u32 s24, s2, 13
    s_cmp_ge_u32 s24, 334
    s_cselect_b32 s25, 1, 0
    s_mul_i32 s26, s25, 334
    s_sub_u32 s24, s24, s26
    s_lshr_b32 s26, s24, 1
    s_and_b32 s27, s24, 1
    v_and_b32 v1, 63, v0
    v_lshrrev_b32 v2, 3, v1
    s_mul_i32 s28, s26, 96
    s_add_u32 s28, s28, s27
    s_sub_u32 s28, s28, 15
    v_lshlrev_b32 v3, 1, v2
    v_add_u32 v3, s28, v3
    v_lshlrev_b32 v3, 9, v3
    s_lshl_b32 s29, s20, 7
    v_add_u32 v3, s29, v3
    v_bfe_u32 v4, v2, 1, 1
    v_lshlrev_b32 v4, 1, v4
    v_and_b32 v5, 7, v1
    v_xor_b32 v4, v4, v5
    v_lshl_add_u32 v3, v4, 4, v3
    v_xor_b32 v4, 64, v3
    s_waitcnt lgkmcnt(0)
    s_mul_i32 s30, s25, 8192000
    s_add_u32 s8, s4, s30
    s_addc_u32 s9, s5, 0
    s_mov_b32 s10, 8192000
    s_mov_b32 s11, 0x00020000
    s_lshl_b32 s31, s20, 13
    s_add_u32 m0, s31, 0
    v_add_u32 v5, 0, v3
    buffer_load_dwordx4 v5, s[8:11], 0 offen lds
    s_add_u32 m0, s31, 1024
    v_add_u32 v5, 8192, v4
    buffer_load_dwordx4 v5, s[8:11], 0 offen lds
    s_add_u32 m0, s31, 2048
    v_add_u32 v5, 16384, v3
    buffer_load_dwordx4 v5, s[8:11], 0 offen lds
    s_add_u32 m0, s31, 3072
    v_add_u32 v5, 24576, v4
    buffer_load_dwordx4 v5, s[8:11], 0 offen lds
    s_add_u32 m0, s31, 4096
    v_add_u32 v5, 32768, v3
    buffer_load_dwordx4 v5, s[8:11], 0 offen lds
    s_add_u32 m0, s31, 5120
    v_add_u32 v5, 40960, v4
    buffer_load_dwordx4 v5, s[8:11], 0 offen lds
    s_add_u32 m0, s31, 6144
    v_add_u32 v5, 49152, v3
    buffer_load_dwordx4 v5, s[8:11], 0 offen lds
    s_add_u32 m0, s31, 7168
    v_add_u32 v5, 57344, v4
    buffer_load_dwordx4 v5, s[8:11], 0 offen lds
    s_add_u32 s12, s6, 0
    s_addc_u32 s13, s7, 0
    s_mov_b32 s14, 21889024
    s_mov_b32 s15, 0x00020000
    v_mov_b32 v8, v1
    s_lshl_b32 s32, s20, 4
    v_lshlrev_b32 v6, 4, v1
    s_lshl_b32 s33, s20, 11
    v_add_u32 v7, s33, v6
    v_and_b32 v9, 15, v8
    v_lshrrev_b32 v10, 4, v8
    v_or_b32 v11, 1, v9
    v_add_u32 v11, s32, v11
    v_cvt_f32_u32 v11, v11
    v_mul_f32 v11, 0x3c000000, v11
    v_lshlrev_b32 v10, 3, v10
    v_add_u32 v10, 0, v10
    v_cvt_f32_u32 v10, v10
    v_and_b32 v9, 1, v9
    v_cvt_f32_u32 v9, v9
    v_mul_f32 v9, 0x3e800000, v9
    v_fma_f32 v12, v11, v10, v9
    v_fract_f32 v13, v12
    v_add_f32 v12, v12, v11
    v_fract_f32 v14, v12
    v_add_f32 v12, v12, v11
    v_fract_f32 v15, v12
    v_add_f32 v12, v12, v11
    v_fract_f32 v16, v12
    v_add_f32 v12, v12, v11
    v_fract_f32 v17, v12
    v_add_f32 v12, v12, v11
    v_fract_f32 v18, v12
    v_add_f32 v12, v12, v11
    v_fract_f32 v19, v12
    v_add_f32 v12, v12, v11
    v_fract_f32 v20, v12
    v_cos_f32 v13, v13
    v_cos_f32 v14, v14
    v_cos_f32 v15, v15
    v_cos_f32 v16, v16
    v_cos_f32 v17, v17
    v_cos_f32 v18, v18
    v_cos_f32 v19, v19
    v_cos_f32 v20, v20
    s_nop 0
    v_cvt_pk_bf16_f32 v24, v13, v14
    v_cvt_pk_bf16_f32 v25, v15, v16
    v_cvt_pk_bf16_f32 v26, v17, v18
    v_cvt_pk_bf16_f32 v27, v19, v20
    ds_write_b128 v7, v[24:27] offset:32768
    v_and_b32 v9, 15, v8
    v_lshrrev_b32 v10, 4, v8
    v_or_b32 v11, 1, v9
    v_add_u32 v11, s32, v11
    v_cvt_f32_u32 v11, v11
    v_mul_f32 v11, 0x3c000000, v11
    v_lshlrev_b32 v10, 3, v10
    v_add_u32 v10, 32, v10
    v_cvt_f32_u32 v10, v10
    v_and_b32 v9, 1, v9
    v_cvt_f32_u32 v9, v9
    v_mul_f32 v9, 0x3e800000, v9
    v_fma_f32 v12, v11, v10, v9
    v_fract_f32 v13, v12
    v_add_f32 v12, v12, v11
    v_fract_f32 v14, v12
    v_add_f32 v12, v12, v11
    v_fract_f32 v15, v12
    v_add_f32 v12, v12, v11
    v_fract_f32 v16, v12
    v_add_f32 v12, v12, v11
    v_fract_f32 v17, v12
    v_add_f32 v12, v12, v11
    v_fract_f32 v18, v12
    v_add_f32 v12, v12, v11
    v_fract_f32 v19, v12
    v_add_f32 v12, v12, v11
    v_fract_f32 v20, v12
    v_cos_f32 v13, v13
    v_cos_f32 v14, v14
    v_cos_f32 v15, v15
    v_cos_f32 v16, v16
    v_cos_f32 v17, v17
    v_cos_f32 v18, v18
    v_cos_f32 v19, v19
    v_cos_f32 v20, v20
    s_nop 0
    v_cvt_pk_bf16_f32 v28, v13, v14
    v_cvt_pk_bf16_f32 v29, v15, v16
    v_cvt_pk_bf16_f32 v30, v17, v18
    v_cvt_pk_bf16_f32 v31, v19, v20
    ds_write_b128 v7, v[28:31] offset:33792
    v_bfe_u32 v8, v1, 2, 2
    v_lshrrev_b32 v9, 4, v1
    v_lshl_add_u32 v10, v9, 3, v8
    v_lshlrev_b32 v10, 7, v10
    v_lshrrev_b32 v8, 1, v8
    v_and_b32 v11, 1, v9
    v_lshl_add_u32 v8, v11, 1, v8
    v_lshlrev_b32 v8, 1, v8
    v_bfe_u32 v11, v1, 1, 1
    v_xor_b32 v8, v8, v11
    v_lshl_add_u32 v10, v8, 4, v10
    v_and_b32 v11, 1, v1
    v_lshl_add_u32 v10, v11, 3, v10
    v_add_u32 v10, s31, v10
    v_xor_b32 v12, 0, v10
    v_xor_b32 v13, 32, v10
    v_xor_b32 v14, 64, v10
    v_xor_b32 v15, 96, v10
    v_bfe_u32 v8, v1, 1, 3
    s_mov_b32 s33, 684032
    v_mul_lo_u32 v8, v8, s33
    v_and_b32 v11, 1, v1
    v_lshl_add_u32 v8, v11, 6, v8
    v_lshl_add_u32 v16, v9, 4, v8
    s_mul_i32 s34, s25, 167
    s_add_u32 s34, s34, s26
    s_lshl_b32 s34, s34, 11
    s_lshl_b32 s35, s27, 3
    s_lshl_b32 s36, s20, 1
    s_add_u32 s35, s35, s36
    s_lshl_b32 s35, s35, 7
    s_add_u32 s34, s34, s35
    s_waitcnt lgkmcnt(0)
    s_barrier
    ds_read_b128 v[24:27], v6 offset:32768
    ds_read_b128 v[28:31], v6 offset:33792
    ds_read_b128 v[32:35], v6 offset:34816
    ds_read_b128 v[36:39], v6 offset:35840
    ds_read_b128 v[40:43], v6 offset:36864
    ds_read_b128 v[44:47], v6 offset:37888
    ds_read_b128 v[48:51], v6 offset:38912
    ds_read_b128 v[52:55], v6 offset:39936
    s_waitcnt vmcnt(0)
    ds_read_b64_tr_b16 v[56:57], v12 offset:0
    ds_read_b64_tr_b16 v[58:59], v12 offset:512
    ds_read_b64_tr_b16 v[60:61], v12 offset:4096
    ds_read_b64_tr_b16 v[62:63], v12 offset:4608
    ds_read_b64_tr_b16 v[64:65], v13 offset:0
    ds_read_b64_tr_b16 v[66:67], v13 offset:512
    ds_read_b64_tr_b16 v[68:69], v13 offset:4096
    ds_read_b64_tr_b16 v[70:71], v13 offset:4608
    s_waitcnt lgkmcnt(0)
    v_mfma_f32_16x16x32_bf16 v[72:75], v[56:59], v[24:27], 0
    v_mfma_f32_16x16x32_bf16 v[76:79], v[56:59], v[32:35], 0
    v_mfma_f32_16x16x32_bf16 v[80:83], v[56:59], v[40:43], 0
    v_mfma_f32_16x16x32_bf16 v[84:87], v[56:59], v[48:51], 0
    v_mfma_f32_16x16x32_bf16 v[88:91], v[64:67], v[24:27], 0
    v_mfma_f32_16x16x32_bf16 v[92:95], v[64:67], v[32:35], 0
    v_mfma_f32_16x16x32_bf16 v[96:99], v[64:67], v[40:43], 0
    v_mfma_f32_16x16x32_bf16 v[100:103], v[64:67], v[48:51], 0
    v_mfma_f32_16x16x32_bf16 v[72:75], v[60:63], v[28:31], v[72:75]
    v_mfma_f32_16x16x32_bf16 v[76:79], v[60:63], v[36:39], v[76:79]
    v_mfma_f32_16x16x32_bf16 v[80:83], v[60:63], v[44:47], v[80:83]
    v_mfma_f32_16x16x32_bf16 v[84:87], v[60:63], v[52:55], v[84:87]
    v_mfma_f32_16x16x32_bf16 v[88:91], v[68:71], v[28:31], v[88:91]
    v_mfma_f32_16x16x32_bf16 v[92:95], v[68:71], v[36:39], v[92:95]
    v_mfma_f32_16x16x32_bf16 v[96:99], v[68:71], v[44:47], v[96:99]
    v_mfma_f32_16x16x32_bf16 v[100:103], v[68:71], v[52:55], v[100:103]
    s_nop 7
    v_cvt_pk_bf16_f32 v104, v72, v73
    v_cvt_pk_bf16_f32 v105, v74, v75
    v_cvt_pk_bf16_f32 v106, v88, v89
    v_cvt_pk_bf16_f32 v107, v90, v91
    s_add_u32 s35, s34, 0
    buffer_store_dwordx4 v[104:107], v16, s[12:15], s35 offen
    s_nop 1
    v_cvt_pk_bf16_f32 v108, v76, v77
    v_cvt_pk_bf16_f32 v109, v78, v79
    v_cvt_pk_bf16_f32 v110, v92, v93
    v_cvt_pk_bf16_f32 v111, v94, v95
    s_add_u32 s35, s34, 5472256
    buffer_store_dwordx4 v[108:111], v16, s[12:15], s35 offen
    s_nop 1
    v_cvt_pk_bf16_f32 v104, v80, v81
    v_cvt_pk_bf16_f32 v105, v82, v83
    v_cvt_pk_bf16_f32 v106, v96, v97
    v_cvt_pk_bf16_f32 v107, v98, v99
    s_add_u32 s35, s34, 10944512
    buffer_store_dwordx4 v[104:107], v16, s[12:15], s35 offen
    s_nop 1
    v_cvt_pk_bf16_f32 v108, v84, v85
    v_cvt_pk_bf16_f32 v109, v86, v87
    v_cvt_pk_bf16_f32 v110, v100, v101
    v_cvt_pk_bf16_f32 v111, v102, v103
    s_add_u32 s35, s34, 16416768
    buffer_store_dwordx4 v[108:111], v16, s[12:15], s35 offen
    s_nop 1
    ds_read_b64_tr_b16 v[56:57], v14 offset:0
    ds_read_b64_tr_b16 v[58:59], v14 offset:512
    ds_read_b64_tr_b16 v[60:61], v14 offset:4096
    ds_read_b64_tr_b16 v[62:63], v14 offset:4608
    ds_read_b64_tr_b16 v[64:65], v15 offset:0
    ds_read_b64_tr_b16 v[66:67], v15 offset:512
    ds_read_b64_tr_b16 v[68:69], v15 offset:4096
    ds_read_b64_tr_b16 v[70:71], v15 offset:4608
    s_waitcnt lgkmcnt(0)
    v_mfma_f32_16x16x32_bf16 v[72:75], v[56:59], v[24:27], 0
    v_mfma_f32_16x16x32_bf16 v[76:79], v[56:59], v[32:35], 0
    v_mfma_f32_16x16x32_bf16 v[80:83], v[56:59], v[40:43], 0
    v_mfma_f32_16x16x32_bf16 v[84:87], v[56:59], v[48:51], 0
    v_mfma_f32_16x16x32_bf16 v[88:91], v[64:67], v[24:27], 0
    v_mfma_f32_16x16x32_bf16 v[92:95], v[64:67], v[32:35], 0
    v_mfma_f32_16x16x32_bf16 v[96:99], v[64:67], v[40:43], 0
    v_mfma_f32_16x16x32_bf16 v[100:103], v[64:67], v[48:51], 0
    v_mfma_f32_16x16x32_bf16 v[72:75], v[60:63], v[28:31], v[72:75]
    v_mfma_f32_16x16x32_bf16 v[76:79], v[60:63], v[36:39], v[76:79]
    v_mfma_f32_16x16x32_bf16 v[80:83], v[60:63], v[44:47], v[80:83]
    v_mfma_f32_16x16x32_bf16 v[84:87], v[60:63], v[52:55], v[84:87]
    v_mfma_f32_16x16x32_bf16 v[88:91], v[68:71], v[28:31], v[88:91]
    v_mfma_f32_16x16x32_bf16 v[92:95], v[68:71], v[36:39], v[92:95]
    v_mfma_f32_16x16x32_bf16 v[96:99], v[68:71], v[44:47], v[96:99]
    v_mfma_f32_16x16x32_bf16 v[100:103], v[68:71], v[52:55], v[100:103]
    s_nop 7
    v_cvt_pk_bf16_f32 v104, v72, v73
    v_cvt_pk_bf16_f32 v105, v74, v75
    v_cvt_pk_bf16_f32 v106, v88, v89
    v_cvt_pk_bf16_f32 v107, v90, v91
    s_add_u32 s35, s34, 128
    buffer_store_dwordx4 v[104:107], v16, s[12:15], s35 offen
    s_nop 1
    v_cvt_pk_bf16_f32 v108, v76, v77
    v_cvt_pk_bf16_f32 v109, v78, v79
    v_cvt_pk_bf16_f32 v110, v92, v93
    v_cvt_pk_bf16_f32 v111, v94, v95
    s_add_u32 s35, s34, 5472384
    buffer_store_dwordx4 v[108:111], v16, s[12:15], s35 offen
    s_nop 1
    v_cvt_pk_bf16_f32 v104, v80, v81
    v_cvt_pk_bf16_f32 v105, v82, v83
    v_cvt_pk_bf16_f32 v106, v96, v97
    v_cvt_pk_bf16_f32 v107, v98, v99
    s_add_u32 s35, s34, 10944640
    buffer_store_dwordx4 v[104:107], v16, s[12:15], s35 offen
    s_nop 1
    v_cvt_pk_bf16_f32 v108, v84, v85
    v_cvt_pk_bf16_f32 v109, v86, v87
    v_cvt_pk_bf16_f32 v110, v100, v101
    v_cvt_pk_bf16_f32 v111, v102, v103
    s_add_u32 s35, s34, 16416896
    buffer_store_dwordx4 v[108:111], v16, s[12:15], s35 offen
    s_nop 1
    s_endpgm
L_prep_kernel_g:
    s_sub_u32 s3, s2, 681
    s_load_dwordx2 s[4:5], s[0:1], 8
    s_load_dwordx2 s[6:7], s[0:1], 72
    s_lshr_b32 s24, s3, 4
    s_bfe_u32 s25, s3, 0x20002
    s_and_b32 s26, s3, 3
    s_lshr_b32 s27, s24, 3
    s_and_b32 s28, s24, 7
    v_and_b32 v1, 63, v0
    v_lshrrev_b32 v2, 3, v1
    v_lshrrev_b32 v3, 2, v2
    v_lshlrev_b32 v3, 4, v3
    v_and_b32 v4, 3, v2
    v_add_u32 v3, v3, v4
    s_lshl_b32 s29, s25, 2
    s_lshl_b32 s30, s28, 5
    s_add_u32 s29, s29, s30
    v_add_u32 v3, s29, v3
    v_lshlrev_b32 v3, 9, v3
    v_and_b32 v4, 7, v1
    s_lshr_b32 s30, s20, 1
    s_lshl_b32 s30, s30, 2
    v_xor_b32 v4, s30, v4
    v_lshl_add_u32 v3, v4, 4, v3
    s_lshl_b32 s30, s26, 7
    v_add_u32 v3, s30, v3
    v_xor_b32 v4, 32, v3
    s_waitcnt lgkmcnt(0)
    s_mov_b32 s8, s4
    s_mov_b32 s9, s5
    s_mov_b32 s10, 4063232
    s_mov_b32 s11, 0x00020000
    s_add_u32 s12, s6, 21954560
    s_addc_u32 s13, s7, 0
    s_mov_b32 s14, 16916480
    s_mov_b32 s15, 0x00020000
    s_lshl_b32 s30, s20, 3
    s_add_u32 s30, s30, s27
    s_lshl_b32 s30, s30, 17
    s_mul_i32 s31, s20, 4608
    s_add_u32 m0, s31, 0
    s_add_u32 s32, s30, 0
    buffer_load_dwordx4 v3, s[8:11], s32 offen lds
    s_add_u32 m0, s31, 1152
    s_add_u32 s32, s30, 262144
    buffer_load_dwordx4 v3, s[8:11], s32 offen lds
    s_add_u32 m0, s31, 2304
    s_add_u32 s32, s30, 524288
    buffer_load_dwordx4 v4, s[8:11], s32 offen lds
    s_add_u32 m0, s31, 3456
    s_add_u32 s32, s30, 786432
    buffer_load_dwordx4 v4, s[8:11], s32 offen lds
    v_and_b32 v8, 15, v1
    v_or_b32 v9, 1, v8
    s_lshl_b32 s33, s20, 4
    v_add_u32 v9, s33, v9
    v_cvt_f32_u32 v9, v9
    v_mul_f32 v9, 0x3c000000, v9
    v_bfe_u32 v10, v1, 4, 1
    v_lshlrev_b32 v10, 3, v10
    v_cvt_f32_u32 v10, v10
    v_and_b32 v8, 1, v8
    v_cvt_f32_u32 v8, v8
    v_mul_f32 v8, 0x3f400000, v8
    v_fma_f32 v11, v9, v10, v8
    v_fract_f32 v12, v11
    v_add_f32 v11, v11, v9
    v_fract_f32 v13, v11
    v_add_f32 v11, v11, v9
    v_fract_f32 v14, v11
    v_add_f32 v11, v11, v9
    v_fract_f32 v15, v11
    v_add_f32 v11, v11, v9
    v_fract_f32 v16, v11
    v_add_f32 v11, v11, v9
    v_fract_f32 v17, v11
    v_add_f32 v11, v11, v9
    v_fract_f32 v18, v11
    v_add_f32 v11, v11, v9
    v_fract_f32 v19, v11
    v_cos_f32 v12, v12
    v_cos_f32 v13, v13
    v_cos_f32 v14, v14
    v_cos_f32 v15, v15
    v_cos_f32 v16, v16
    v_cos_f32 v17, v17
    v_cos_f32 v18, v18
    v_cos_f32 v19, v19
    s_nop 0
    v_mul_f32 v12, 0x3d000000, v12
    v_mul_f32 v13, 0x3d000000, v13
    v_mul_f32 v14, 0x3d000000, v14
    v_mul_f32 v15, 0x3d000000, v15
    v_mul_f32 v16, 0x3d000000, v16
    v_mul_f32 v17, 0x3d000000, v17
    v_mul_f32 v18, 0x3d000000, v18
    v_mul_f32 v19, 0x3d000000, v19
    v_cvt_pk_bf16_f32 v20, v12, v13
    v_cvt_pk_bf16_f32 v21, v14, v15
    v_cvt_pk_bf16_f32 v22, v16, v17
    v_cvt_pk_bf16_f32 v23, v18, v19
    v_lshlrev_b32 v28, 16, v20
    v_and_b32 v29, 0xffff0000, v20
    v_sub_f32 v28, v12, v28
    v_sub_f32 v29, v13, v29
    v_cvt_pk_bf16_f32 v24, v28, v29
    v_lshlrev_b32 v28, 16, v21
    v_and_b32 v29, 0xffff0000, v21
    v_sub_f32 v28, v14, v28
    v_sub_f32 v29, v15, v29
    v_cvt_pk_bf16_f32 v25, v28, v29
    v_lshlrev_b32 v28, 16, v22
    v_and_b32 v29, 0xffff0000, v22
    v_sub_f32 v28, v16, v28
    v_sub_f32 v29, v17, v29
    v_cvt_pk_bf16_f32 v26, v28, v29
    v_lshlrev_b32 v28, 16, v23
    v_and_b32 v29, 0xffff0000, v23
    v_sub_f32 v28, v18, v28
    v_sub_f32 v29, v19, v29
    v_cvt_pk_bf16_f32 v27, v28, v29
    v_cmp_gt_u32 vcc, 32, v1
    s_nop 1
    v_cndmask_b32 v20, v24, v20, vcc
    v_cndmask_b32 v21, v25, v21, vcc
    v_cndmask_b32 v22, v26, v22, vcc
    v_cndmask_b32 v23, v27, v23, vcc
    v_lshlrev_b32 v28, 4, v1
    s_lshl_b32 s33, s20, 10
    v_add_u32 v29, s33, v28
    ds_write_b128 v29, v[20:23] offset:18432
    v_bfe_u32 v30, v1, 2, 2
    v_bfe_u32 v31, v1, 4, 1
    v_lshl_add_u32 v32, v31, 3, v30
    v_mul_u32_u24 v32, 1152, v32
    v_lshrrev_b32 v30, 1, v30
    v_lshl_add_u32 v30, v31, 1, v30
    v_lshlrev_b32 v30, 1, v30
    v_bfe_u32 v31, v1, 1, 1
    s_lshl_b32 s33, s20, 1
    v_add_u32 v31, s33, v31
    v_xor_b32 v30, v30, v31
    v_lshl_add_u32 v32, v30, 4, v32
    v_and_b32 v30, 1, v1
    v_lshl_add_u32 v32, v30, 3, v32
    v_lshrrev_b32 v30, 4, v1
    s_mov_b32 s33, 1057280
    v_mul_lo_u32 v30, v30, s33
    v_and_b32 v31, 15, v1
    v_lshl_add_u32 v33, v31, 4, v30
    s_lshl_b32 s34, s24, 15
    s_lshl_b32 s35, s26, 2
    s_add_u32 s35, s35, s20
    s_lshl_b32 s35, s35, 11
    s_add_u32 s34, s34, s35
    s_lshl_b32 s35, s25, 8
    s_add_u32 s34, s34, s35
    s_waitcnt vmcnt(0) lgkmcnt(0)
    s_barrier
    ds_read_b128 v[36:39], v28 offset:18432
    ds_read_b128 v[40:43], v28 offset:19456
    ds_read_b128 v[44:47], v28 offset:20480
    ds_read_b128 v[48:51], v28 offset:21504
    ds_read_b64_tr_b16 v[52:53], v32 offset:0
    ds_read_b64_tr_b16 v[54:55], v32 offset:4608
    ds_read_b64_tr_b16 v[56:57], v32 offset:128
    ds_read_b64_tr_b16 v[58:59], v32 offset:4736
    ds_read_b64_tr_b16 v[60:61], v32 offset:256
    ds_read_b64_tr_b16 v[62:63], v32 offset:4864
    ds_read_b64_tr_b16 v[64:65], v32 offset:384
    ds_read_b64_tr_b16 v[66:67], v32 offset:4992
    ds_read_b64_tr_b16 v[68:69], v32 offset:512
    ds_read_b64_tr_b16 v[70:71], v32 offset:5120
    s_waitcnt lgkmcnt(8)
    ds_read_b64_tr_b16 v[72:73], v32 offset:640
    ds_read_b64_tr_b16 v[74:75], v32 offset:5248
    ds_read_b64_tr_b16 v[76:77], v32 offset:768
    ds_read_b64_tr_b16 v[78:79], v32 offset:5376
    ds_read_b64_tr_b16 v[80:81], v32 offset:896
    ds_read_b64_tr_b16 v[82:83], v32 offset:5504
    s_waitcnt lgkmcnt(0)
    v_mfma_f32_16x16x32_bf16 v[84:87], v[36:39], v[52:55], 0
    v_mfma_f32_16x16x32_bf16 v[88:91], v[36:39], v[56:59], 0
    v_mfma_f32_16x16x32_bf16 v[92:95], v[36:39], v[60:63], 0
    v_mfma_f32_16x16x32_bf16 v[96:99], v[36:39], v[64:67], 0
    v_mfma_f32_16x16x32_bf16 v[100:103], v[36:39], v[68:71], 0
    v_mfma_f32_16x16x32_bf16 v[104:107], v[36:39], v[72:75], 0
    v_mfma_f32_16x16x32_bf16 v[108:111], v[36:39], v[76:79], 0
    v_mfma_f32_16x16x32_bf16 v[112:115], v[36:39], v[80:83], 0
    s_nop 7
    v_cvt_pk_bf16_f32 v116, v84, v88
    v_cvt_pk_bf16_f32 v117, v92, v96
    v_cvt_pk_bf16_f32 v118, v100, v104
    v_cvt_pk_bf16_f32 v119, v108, v112
    s_add_u32 s35, s34, 0
    buffer_store_dwordx4 v[116:119], v33, s[12:15], s35 offen
    s_nop 1
    v_cvt_pk_bf16_f32 v120, v85, v89
    v_cvt_pk_bf16_f32 v121, v93, v97
    v_cvt_pk_bf16_f32 v122, v101, v105
    v_cvt_pk_bf16_f32 v123, v109, v113
    s_add_u32 s35, s34, 1024
    buffer_store_dwordx4 v[120:123], v33, s[12:15], s35 offen
    s_nop 1
    v_cvt_pk_bf16_f32 v116, v86, v90
    v_cvt_pk_bf16_f32 v117, v94, v98
    v_cvt_pk_bf16_f32 v118, v102, v106
    v_cvt_pk_bf16_f32 v119, v110, v114
    s_add_u32 s35, s34, 528640
    buffer_store_dwordx4 v[116:119], v33, s[12:15], s35 offen
    s_nop 1
    v_cvt_pk_bf16_f32 v120, v87, v91
    v_cvt_pk_bf16_f32 v121, v95, v99
    v_cvt_pk_bf16_f32 v122, v103, v107
    v_cvt_pk_bf16_f32 v123, v111, v115
    s_add_u32 s35, s34, 529664
    buffer_store_dwordx4 v[120:123], v33, s[12:15], s35 offen
    s_nop 1
    v_mfma_f32_16x16x32_bf16 v[84:87], v[40:43], v[52:55], 0
    v_mfma_f32_16x16x32_bf16 v[88:91], v[40:43], v[56:59], 0
    v_mfma_f32_16x16x32_bf16 v[92:95], v[40:43], v[60:63], 0
    v_mfma_f32_16x16x32_bf16 v[96:99], v[40:43], v[64:67], 0
    v_mfma_f32_16x16x32_bf16 v[100:103], v[40:43], v[68:71], 0
    v_mfma_f32_16x16x32_bf16 v[104:107], v[40:43], v[72:75], 0
    v_mfma_f32_16x16x32_bf16 v[108:111], v[40:43], v[76:79], 0
    v_mfma_f32_16x16x32_bf16 v[112:115], v[40:43], v[80:83], 0
    s_nop 7
    v_cvt_pk_bf16_f32 v116, v84, v88
    v_cvt_pk_bf16_f32 v117, v92, v96
    v_cvt_pk_bf16_f32 v118, v100, v104
    v_cvt_pk_bf16_f32 v119, v108, v112
    s_add_u32 s35, s34, 4229120
    buffer_store_dwordx4 v[116:119], v33, s[12:15], s35 offen
    s_nop 1
    v_cvt_pk_bf16_f32 v120, v85, v89
    v_cvt_pk_bf16_f32 v121, v93, v97
    v_cvt_pk_bf16_f32 v122, v101, v105
    v_cvt_pk_bf16_f32 v123, v109, v113
    s_add_u32 s35, s34, 4230144
    buffer_store_dwordx4 v[120:123], v33, s[12:15], s35 offen
    s_nop 1
    v_cvt_pk_bf16_f32 v116, v86, v90
    v_cvt_pk_bf16_f32 v117, v94, v98
    v_cvt_pk_bf16_f32 v118, v102, v106
    v_cvt_pk_bf16_f32 v119, v110, v114
    s_add_u32 s35, s34, 4757760
    buffer_store_dwordx4 v[116:119], v33, s[12:15], s35 offen
    s_nop 1
    v_cvt_pk_bf16_f32 v120, v87, v91
    v_cvt_pk_bf16_f32 v121, v95, v99
    v_cvt_pk_bf16_f32 v122, v103, v107
    v_cvt_pk_bf16_f32 v123, v111, v115
    s_add_u32 s35, s34, 4758784
    buffer_store_dwordx4 v[120:123], v33, s[12:15], s35 offen
    s_nop 1
    v_mfma_f32_16x16x32_bf16 v[84:87], v[44:47], v[52:55], 0
    v_mfma_f32_16x16x32_bf16 v[88:91], v[44:47], v[56:59], 0
    v_mfma_f32_16x16x32_bf16 v[92:95], v[44:47], v[60:63], 0
    v_mfma_f32_16x16x32_bf16 v[96:99], v[44:47], v[64:67], 0
    v_mfma_f32_16x16x32_bf16 v[100:103], v[44:47], v[68:71], 0
    v_mfma_f32_16x16x32_bf16 v[104:107], v[44:47], v[72:75], 0
    v_mfma_f32_16x16x32_bf16 v[108:111], v[44:47], v[76:79], 0
    v_mfma_f32_16x16x32_bf16 v[112:115], v[44:47], v[80:83], 0
    s_nop 7
    v_cvt_pk_bf16_f32 v116, v84, v88
    v_cvt_pk_bf16_f32 v117, v92, v96
    v_cvt_pk_bf16_f32 v118, v100, v104
    v_cvt_pk_bf16_f32 v119, v108, v112
    s_add_u32 s35, s34, 8458240
    buffer_store_dwordx4 v[116:119], v33, s[12:15], s35 offen
    s_nop 1
    v_cvt_pk_bf16_f32 v120, v85, v89
    v_cvt_pk_bf16_f32 v121, v93, v97
    v_cvt_pk_bf16_f32 v122, v101, v105
    v_cvt_pk_bf16_f32 v123, v109, v113
    s_add_u32 s35, s34, 8459264
    buffer_store_dwordx4 v[120:123], v33, s[12:15], s35 offen
    s_nop 1
    v_cvt_pk_bf16_f32 v116, v86, v90
    v_cvt_pk_bf16_f32 v117, v94, v98
    v_cvt_pk_bf16_f32 v118, v102, v106
    v_cvt_pk_bf16_f32 v119, v110, v114
    s_add_u32 s35, s34, 8986880
    buffer_store_dwordx4 v[116:119], v33, s[12:15], s35 offen
    s_nop 1
    v_cvt_pk_bf16_f32 v120, v87, v91
    v_cvt_pk_bf16_f32 v121, v95, v99
    v_cvt_pk_bf16_f32 v122, v103, v107
    v_cvt_pk_bf16_f32 v123, v111, v115
    s_add_u32 s35, s34, 8987904
    buffer_store_dwordx4 v[120:123], v33, s[12:15], s35 offen
    s_nop 1
    v_mfma_f32_16x16x32_bf16 v[84:87], v[48:51], v[52:55], 0
    v_mfma_f32_16x16x32_bf16 v[88:91], v[48:51], v[56:59], 0
    v_mfma_f32_16x16x32_bf16 v[92:95], v[48:51], v[60:63], 0
    v_mfma_f32_16x16x32_bf16 v[96:99], v[48:51], v[64:67], 0
    v_mfma_f32_16x16x32_bf16 v[100:103], v[48:51], v[68:71], 0
    v_mfma_f32_16x16x32_bf16 v[104:107], v[48:51], v[72:75], 0
    v_mfma_f32_16x16x32_bf16 v[108:111], v[48:51], v[76:79], 0
    v_mfma_f32_16x16x32_bf16 v[112:115], v[48:51], v[80:83], 0
    s_nop 7
    v_cvt_pk_bf16_f32 v116, v84, v88
    v_cvt_pk_bf16_f32 v117, v92, v96
    v_cvt_pk_bf16_f32 v118, v100, v104
    v_cvt_pk_bf16_f32 v119, v108, v112
    s_add_u32 s35, s34, 12687360
    buffer_store_dwordx4 v[116:119], v33, s[12:15], s35 offen
    s_nop 1
    v_cvt_pk_bf16_f32 v120, v85, v89
    v_cvt_pk_bf16_f32 v121, v93, v97
    v_cvt_pk_bf16_f32 v122, v101, v105
    v_cvt_pk_bf16_f32 v123, v109, v113
    s_add_u32 s35, s34, 12688384
    buffer_store_dwordx4 v[120:123], v33, s[12:15], s35 offen
    s_nop 1
    v_cvt_pk_bf16_f32 v116, v86, v90
    v_cvt_pk_bf16_f32 v117, v94, v98
    v_cvt_pk_bf16_f32 v118, v102, v106
    v_cvt_pk_bf16_f32 v119, v110, v114
    s_add_u32 s35, s34, 13216000
    buffer_store_dwordx4 v[116:119], v33, s[12:15], s35 offen
    s_nop 1
    v_cvt_pk_bf16_f32 v120, v87, v91
    v_cvt_pk_bf16_f32 v121, v95, v99
    v_cvt_pk_bf16_f32 v122, v103, v107
    v_cvt_pk_bf16_f32 v123, v111, v115
    s_add_u32 s35, s34, 13217024
    buffer_store_dwordx4 v[120:123], v33, s[12:15], s35 offen
    s_nop 1
    s_endpgm
L_prep_kernel_slab:
    s_load_dwordx2 s[6:7], s[0:1], 72
    s_cmp_eq_u32 s2, 12
    s_cbranch_scc1 L_prep_kernel_tab
    s_lshr_b32 s24, s2, 2
    s_and_b32 s26, s2, 3
    s_mov_b32 s25, 40
    s_cmp_eq_u32 s24, 1
    s_cselect_b32 s25, 32, s25
    s_cmp_eq_u32 s24, 2
    s_cselect_b32 s25, 48, s25
    s_load_dwordx2 s[4:5], s[0:1], s25
    s_load_dwordx2 s[28:29], s[0:1], 24
    v_and_b32 v1, 63, v0
    v_lshrrev_b32 v2, 3, v1
    s_lshl_b32 s27, s20, 6
    v_add_u32 v2, s27, v2
    v_lshlrev_b32 v2, 9, v2
    v_and_b32 v3, 7, v1
    v_lshl_add_u32 v2, v3, 4, v2
    s_lshl_b32 s27, s26, 7
    v_add_u32 v2, s27, v2
    s_waitcnt lgkmcnt(0)
    s_mov_b32 s8, s4
    s_mov_b32 s9, s5
    s_mov_b32 s10, 131072
    s_mov_b32 s11, 0x00020000
    s_add_u32 s12, s6, 83312640
    s_addc_u32 s13, s7, 0
    s_mov_b32 s14, 294912
    s_mov_b32 s15, 0x00020000
    s_lshl_b32 s31, s20, 13
    s_add_u32 m0, s31, 0
    s_mov_b32 s32, 0
    buffer_load_dwordx4 v2, s[8:11], s32 offen lds
    s_add_u32 m0, s31, 1024
    s_mov_b32 s32, 4096
    buffer_load_dwordx4 v2, s[8:11], s32 offen lds
    s_add_u32 m0, s31, 2048
    s_mov_b32 s32, 8192
    buffer_load_dwordx4 v2, s[8:11], s32 offen lds
    s_add_u32 m0, s31, 3072
    s_mov_b32 s32, 12288
    buffer_load_dwordx4 v2, s[8:11], s32 offen lds
    s_add_u32 m0, s31, 4096
    s_mov_b32 s32, 16384
    buffer_load_dwordx4 v2, s[8:11], s32 offen lds
    s_add_u32 m0, s31, 5120
    s_mov_b32 s32, 20480
    buffer_load_dwordx4 v2, s[8:11], s32 offen lds
    s_add_u32 m0, s31, 6144
    s_mov_b32 s32, 24576
    buffer_load_dwordx4 v2, s[8:11], s32 offen lds
    s_add_u32 m0, s31, 7168
    s_mov_b32 s32, 28672
    buffer_load_dwordx4 v2, s[8:11], s32 offen lds
    s_cmp_eq_u32 s24, 0
    s_cbranch_scc1 L_prep_kernel_ge
    v_bfe_u32 v4, v1, 2, 2
    v_lshrrev_b32 v5, 5, v1
    v_bfe_u32 v6, v1, 4, 1
    v_and_b32 v7, 3, v1
    s_cmp_eq_u32 s24, 1
    s_cbranch_scc0 L_prep_kernel_wo
    v_lshl_add_u32 v8, v5, 4, v4
    v_lshlrev_b32 v8, 7, v8
    v_lshl_add_u32 v8, v6, 5, v8
    v_lshl_add_u32 v8, v7, 3, v8
    s_lshl_b32 s33, s20, 13
    v_add_u32 v8, s33, v8
    s_mov_b32 s34, 32768
    s_lshl_b32 s35, s26, 15
    s_add_u32 s34, s34, s35
    s_lshl_b32 s35, s20, 12
    s_add_u32 s34, s34, s35
    v_lshlrev_b32 v9, 4, v1
    s_waitcnt vmcnt(0)
    s_barrier
    ds_read_b64_tr_b16 v[16:17], v8 offset:0
    ds_read_b64_tr_b16 v[18:19], v8 offset:1024
    ds_read_b64_tr_b16 v[20:21], v8 offset:512
    ds_read_b64_tr_b16 v[22:23], v8 offset:1536
    ds_read_b64_tr_b16 v[24:25], v8 offset:4096
    ds_read_b64_tr_b16 v[26:27], v8 offset:5120
    ds_read_b64_tr_b16 v[28:29], v8 offset:4608
    ds_read_b64_tr_b16 v[30:31], v8 offset:5632
    s_waitcnt lgkmcnt(0)
    s_add_u32 s35, s34, 0
    buffer_store_dwordx4 v[16:19], v9, s[12:15], s35 offen
    s_add_u32 s35, s34, 1024
    buffer_store_dwordx4 v[20:23], v9, s[12:15], s35 offen
    s_add_u32 s35, s34, 2048
    buffer_store_dwordx4 v[24:27], v9, s[12:15], s35 offen
    s_add_u32 s35, s34, 3072
    buffer_store_dwordx4 v[28:31], v9, s[12:15], s35 offen
    ds_read_b64_tr_b16 v[32:33], v8 offset:64
    ds_read_b64_tr_b16 v[34:35], v8 offset:1088
    ds_read_b64_tr_b16 v[36:37], v8 offset:576
    ds_read_b64_tr_b16 v[38:39], v8 offset:1600
    ds_read_b64_tr_b16 v[40:41], v8 offset:4160
    ds_read_b64_tr_b16 v[42:43], v8 offset:5184
    ds_read_b64_tr_b16 v[44:45], v8 offset:4672
    ds_read_b64_tr_b16 v[46:47], v8 offset:5696
    s_waitcnt lgkmcnt(0)
    s_add_u32 s35, s34, 16384
    buffer_store_dwordx4 v[32:35], v9, s[12:15], s35 offen
    s_add_u32 s35, s34, 17408
    buffer_store_dwordx4 v[36:39], v9, s[12:15], s35 offen
    s_add_u32 s35, s34, 18432
    buffer_store_dwordx4 v[40:43], v9, s[12:15], s35 offen
    s_add_u32 s35, s34, 19456
    buffer_store_dwordx4 v[44:47], v9, s[12:15], s35 offen
    s_endpgm
L_prep_kernel_wo:
    v_lshl_add_u32 v8, v5, 2, v4
    v_lshlrev_b32 v8, 7, v8
    v_lshl_add_u32 v8, v6, 5, v8
    v_and_b32 v10, 1, v7
    v_lshl_add_u32 v8, v10, 4, v8
    v_lshrrev_b32 v10, 1, v7
    v_lshl_add_u32 v8, v10, 3, v8
    s_lshl_b32 s33, s20, 13
    v_add_u32 v8, s33, v8
    s_mov_b32 s34, 163840
    s_lshl_b32 s35, s26, 15
    s_add_u32 s34, s34, s35
    s_lshl_b32 s35, s20, 12
    s_add_u32 s34, s34, s35
    v_lshlrev_b32 v9, 4, v1
    s_waitcnt vmcnt(0)
    s_barrier
    ds_read_b64_tr_b16 v[16:17], v8 offset:0
    ds_read_b64_tr_b16 v[18:19], v8 offset:1024
    ds_read_b64_tr_b16 v[20:21], v8 offset:2048
    ds_read_b64_tr_b16 v[22:23], v8 offset:3072
    ds_read_b64_tr_b16 v[24:25], v8 offset:4096
    ds_read_b64_tr_b16 v[26:27], v8 offset:5120
    ds_read_b64_tr_b16 v[28:29], v8 offset:6144
    ds_read_b64_tr_b16 v[30:31], v8 offset:7168
    s_waitcnt lgkmcnt(0)
    s_add_u32 s35, s34, 0
    buffer_store_dwordx4 v[16:19], v9, s[12:15], s35 offen
    s_add_u32 s35, s34, 1024
    buffer_store_dwordx4 v[20:23], v9, s[12:15], s35 offen
    s_add_u32 s35, s34, 2048
    buffer_store_dwordx4 v[24:27], v9, s[12:15], s35 offen
    s_add_u32 s35, s34, 3072
    buffer_store_dwordx4 v[28:31], v9, s[12:15], s35 offen
    ds_read_b64_tr_b16 v[32:33], v8 offset:64
    ds_read_b64_tr_b16 v[34:35], v8 offset:1088
    ds_read_b64_tr_b16 v[36:37], v8 offset:2112
    ds_read_b64_tr_b16 v[38:39], v8 offset:3136
    ds_read_b64_tr_b16 v[40:41], v8 offset:4160
    ds_read_b64_tr_b16 v[42:43], v8 offset:5184
    ds_read_b64_tr_b16 v[44:45], v8 offset:6208
    ds_read_b64_tr_b16 v[46:47], v8 offset:7232
    s_waitcnt lgkmcnt(0)
    s_add_u32 s35, s34, 16384
    buffer_store_dwordx4 v[32:35], v9, s[12:15], s35 offen
    s_add_u32 s35, s34, 17408
    buffer_store_dwordx4 v[36:39], v9, s[12:15], s35 offen
    s_add_u32 s35, s34, 18432
    buffer_store_dwordx4 v[40:43], v9, s[12:15], s35 offen
    s_add_u32 s35, s34, 19456
    buffer_store_dwordx4 v[44:47], v9, s[12:15], s35 offen
    s_endpgm
L_prep_kernel_ge:
    s_mov_b32 s36, s28
    s_mov_b32 s37, s29
    s_mov_b32 s38, 8192
    s_mov_b32 s39, 0x00020000
    v_and_b32 v4, 15, v1
    v_lshrrev_b32 v5, 4, v1
    v_lshlrev_b32 v6, 9, v4
    v_lshl_add_u32 v6, v5, 4, v6
    buffer_load_dwordx4 v[16:19], v6, s[36:39], 0 offen offset:0
    buffer_load_dwordx4 v[20:23], v6, s[36:39], 0 offen offset:64
    buffer_load_dwordx4 v[24:27], v6, s[36:39], 0 offen offset:128
    buffer_load_dwordx4 v[28:31], v6, s[36:39], 0 offen offset:192
    buffer_load_dwordx4 v[32:35], v6, s[36:39], 0 offen offset:256
    buffer_load_dwordx4 v[36:39], v6, s[36:39], 0 offen offset:320
    buffer_load_dwordx4 v[40:43], v6, s[36:39], 0 offen offset:384
    buffer_load_dwordx4 v[44:47], v6, s[36:39], 0 offen offset:448
    v_bfe_u32 v7, v1, 2, 2
    v_lshl_add_u32 v7, v5, 3, v7
    v_lshlrev_b32 v7, 7, v7
    v_and_b32 v8, 3, v1
    v_lshl_add_u32 v7, v8, 3, v7
    s_lshl_b32 s33, s20, 5
    v_add_u32 v7, s33, v7
    s_waitcnt vmcnt(0)
    s_barrier
    ds_read_b64_tr_b16 v[48:49], v7 offset:0
    ds_read_b64_tr_b16 v[50:51], v7 offset:512
    ds_read_b64_tr_b16 v[52:53], v7 offset:4096
    ds_read_b64_tr_b16 v[54:55], v7 offset:4608
    ds_read_b64_tr_b16 v[56:57], v7 offset:8192
    ds_read_b64_tr_b16 v[58:59], v7 offset:8704
    ds_read_b64_tr_b16 v[60:61], v7 offset:12288
    ds_read_b64_tr_b16 v[62:63], v7 offset:12800
    s_waitcnt lgkmcnt(0)
    ds_read_b64_tr_b16 v[64:65], v7 offset:16384
    ds_read_b64_tr_b16 v[66:67], v7 offset:16896
    ds_read_b64_tr_b16 v[68:69], v7 offset:20480
    ds_read_b64_tr_b16 v[70:71], v7 offset:20992
    ds_read_b64_tr_b16 v[72:73], v7 offset:24576
    ds_read_b64_tr_b16 v[74:75], v7 offset:25088
    ds_read_b64_tr_b16 v[76:77], v7 offset:28672
    ds_read_b64_tr_b16 v[78:79], v7 offset:29184
    s_waitcnt lgkmcnt(0)
    v_mfma_f32_16x16x32_bf16 v[80:83], v[48:51], v[16:19], 0
    v_mfma_f32_16x16x32_bf16 v[80:83], v[52:55], v[20:23], v[80:83]
    v_mfma_f32_16x16x32_bf16 v[80:83], v[56:59], v[24:27], v[80:83]
    v_mfma_f32_16x16x32_bf16 v[80:83], v[60:63], v[28:31], v[80:83]
    v_mfma_f32_16x16x32_bf16 v[80:83], v[64:67], v[32:35], v[80:83]
    v_mfma_f32_16x16x32_bf16 v[80:83], v[68:71], v[36:39], v[80:83]
    v_mfma_f32_16x16x32_bf16 v[80:83], v[72:75], v[40:43], v[80:83]
    v_mfma_f32_16x16x32_bf16 v[80:83], v[76:79], v[44:47], v[80:83]
    s_nop 7
    v_cvt_pk_bf16_f32 v84, v80, v81
    v_cvt_pk_bf16_f32 v85, v82, v83
    s_mov_b32 s33, 0x4038aa3b
    v_lshlrev_b32 v80, 16, v84
    v_and_b32 v81, 0xffff0000, v84
    v_lshlrev_b32 v82, 16, v85
    v_and_b32 v83, 0xffff0000, v85
    v_mul_f32 v80, s33, v80
    v_mul_f32 v81, s33, v81
    v_mul_f32 v82, s33, v82
    v_mul_f32 v83, s33, v83
    v_lshlrev_b32 v6, 10, v4
    v_lshl_add_u32 v6, v5, 4, v6
    s_lshl_b32 s33, s26, 8
    s_lshl_b32 s34, s20, 6
    s_add_u32 s33, s33, s34
    s_add_u32 s33, s33, 16384
    buffer_store_dwordx4 v[80:83], v6, s[12:15], s33 offen
    s_endpgm
L_prep_kernel_tab:
    v_and_b32 v8, 63, v0
    v_lshlrev_b32 v6, 4, v8
    s_waitcnt lgkmcnt(0)
    s_add_u32 s12, s6, 83312640
    s_addc_u32 s13, s7, 0
    s_mov_b32 s14, 294912
    s_mov_b32 s15, 0x00020000
    s_lshl_b32 s32, s20, 4
    s_lshl_b32 s33, s20, 11
    v_and_b32 v9, 15, v8
    v_lshrrev_b32 v10, 4, v8
    v_or_b32 v11, 1, v9
    v_add_u32 v11, s32, v11
    v_cvt_f32_u32 v11, v11
    v_mul_f32 v11, 0x3c000000, v11
    v_lshlrev_b32 v10, 3, v10
    v_add_u32 v10, 0, v10
    v_cvt_f32_u32 v10, v10
    v_and_b32 v9, 1, v9
    v_cvt_f32_u32 v9, v9
    v_mul_f32 v9, 0x3e800000, v9
    v_fma_f32 v12, v11, v10, v9
    v_fract_f32 v13, v12
    v_add_f32 v12, v12, v11
    v_fract_f32 v14, v12
    v_add_f32 v12, v12, v11
    v_fract_f32 v15, v12
    v_add_f32 v12, v12, v11
    v_fract_f32 v16, v12
    v_add_f32 v12, v12, v11
    v_fract_f32 v17, v12
    v_add_f32 v12, v12, v11
    v_fract_f32 v18, v12
    v_add_f32 v12, v12, v11
    v_fract_f32 v19, v12
    v_add_f32 v12, v12, v11
    v_fract_f32 v20, v12
    v_cos_f32 v13, v13
    v_cos_f32 v14, v14
    v_cos_f32 v15, v15
    v_cos_f32 v16, v16
    v_cos_f32 v17, v17
    v_cos_f32 v18, v18
    v_cos_f32 v19, v19
    v_cos_f32 v20, v20
    s_nop 0
    v_cvt_pk_bf16_f32 v24, v13, v14
    v_cvt_pk_bf16_f32 v25, v15, v16
    v_cvt_pk_bf16_f32 v26, v17, v18
    v_cvt_pk_bf16_f32 v27, v19, v20
    s_add_u32 s34, s33, 0
    buffer_store_dwordx4 v[24:27], v6, s[12:15], s34 offen
    v_and_b32 v9, 15, v8
    v_lshrrev_b32 v10, 4, v8
    v_or_b32 v11, 1, v9
    v_add_u32 v11, s32, v11
    v_cvt_f32_u32 v11, v11
    v_mul_f32 v11, 0x3c000000, v11
    v_lshlrev_b32 v10, 3, v10
    v_add_u32 v10, 32, v10
    v_cvt_f32_u32 v10, v10
    v_and_b32 v9, 1, v9
    v_cvt_f32_u32 v9, v9
    v_mul_f32 v9, 0x3e800000, v9
    v_fma_f32 v12, v11, v10, v9
    v_fract_f32 v13, v12
    v_add_f32 v12, v12, v11
    v_fract_f32 v14, v12
    v_add_f32 v12, v12, v11
    v_fract_f32 v15, v12
    v_add_f32 v12, v12, v11
    v_fract_f32 v16, v12
    v_add_f32 v12, v12, v11
    v_fract_f32 v17, v12
    v_add_f32 v12, v12, v11
    v_fract_f32 v18, v12
    v_add_f32 v12, v12, v11
    v_fract_f32 v19, v12
    v_add_f32 v12, v12, v11
    v_fract_f32 v20, v12
    v_cos_f32 v13, v13
    v_cos_f32 v14, v14
    v_cos_f32 v15, v15
    v_cos_f32 v16, v16
    v_cos_f32 v17, v17
    v_cos_f32 v18, v18
    v_cos_f32 v19, v19
    v_cos_f32 v20, v20
    s_nop 0
    v_cvt_pk_bf16_f32 v28, v13, v14
    v_cvt_pk_bf16_f32 v29, v15, v16
    v_cvt_pk_bf16_f32 v30, v17, v18
    v_cvt_pk_bf16_f32 v31, v19, v20
    s_add_u32 s34, s33, 1024
    buffer_store_dwordx4 v[28:31], v6, s[12:15], s34 offen
    s_cmp_ge_u32 s20, 3
    s_cbranch_scc1 L_prep_kernel_done
    v_and_b32 v9, 15, v8
    v_add_u32 v9, s32, v9
    v_cvt_f32_u32 v9, v9
    v_mul_f32 v9, 0x3c000000, v9
    v_lshrrev_b32 v10, 4, v8
    v_lshlrev_b32 v10, 3, v10
    v_add_u32 v11, 1, v10
    v_cvt_f32_u32 v11, v11
    v_mul_f32 v11, v11, v9
    v_fract_f32 v12, v11
    v_add_u32 v11, 1, v10
    v_cvt_f32_u32 v11, v11
    v_mul_f32 v11, v11, v9
    v_add_f32 v11, 0x3e800000, v11
    v_fract_f32 v13, v11
    v_add_u32 v11, 3, v10
    v_cvt_f32_u32 v11, v11
    v_mul_f32 v11, v11, v9
    v_fract_f32 v14, v11
    v_add_u32 v11, 3, v10
    v_cvt_f32_u32 v11, v11
    v_mul_f32 v11, v11, v9
    v_add_f32 v11, 0x3e800000, v11
    v_fract_f32 v15, v11
    v_add_u32 v11, 5, v10
    v_cvt_f32_u32 v11, v11
    v_mul_f32 v11, v11, v9
    v_fract_f32 v16, v11
    v_add_u32 v11, 5, v10
    v_cvt_f32_u32 v11, v11
    v_mul_f32 v11, v11, v9
    v_add_f32 v11, 0x3e800000, v11
    v_fract_f32 v17, v11
    v_add_u32 v11, 7, v10
    v_cvt_f32_u32 v11, v11
    v_mul_f32 v11, v11, v9
    v_fract_f32 v18, v11
    v_add_u32 v11, 7, v10
    v_cvt_f32_u32 v11, v11
    v_mul_f32 v11, v11, v9
    v_add_f32 v11, 0x3e800000, v11
    v_fract_f32 v19, v11
    v_cos_f32 v12, v12
    v_cos_f32 v13, v13
    v_cos_f32 v14, v14
    v_cos_f32 v15, v15
    v_cos_f32 v16, v16
    v_cos_f32 v17, v17
    v_cos_f32 v18, v18
    v_cos_f32 v19, v19
    s_nop 0
    v_cvt_pk_bf16_f32 v24, v12, v13
    v_cvt_pk_bf16_f32 v25, v14, v15
    v_cvt_pk_bf16_f32 v26, v16, v17
    v_cvt_pk_bf16_f32 v27, v18, v19
    s_add_u32 s34, s33, 8192
    buffer_store_dwordx4 v[24:27], v6, s[12:15], s34 offen
    s_nop 1
    v_add_u32 v11, 33, v10
    v_cvt_f32_u32 v11, v11
    v_mul_f32 v11, v11, v9
    v_fract_f32 v12, v11
    v_add_u32 v11, 33, v10
    v_cvt_f32_u32 v11, v11
    v_mul_f32 v11, v11, v9
    v_add_f32 v11, 0x3e800000, v11
    v_fract_f32 v13, v11
    v_add_u32 v11, 35, v10
    v_cvt_f32_u32 v11, v11
    v_mul_f32 v11, v11, v9
    v_fract_f32 v14, v11
    v_add_u32 v11, 35, v10
    v_cvt_f32_u32 v11, v11
    v_mul_f32 v11, v11, v9
    v_add_f32 v11, 0x3e800000, v11
    v_fract_f32 v15, v11
    v_add_u32 v11, 37, v10
    v_cvt_f32_u32 v11, v11
    v_mul_f32 v11, v11, v9
    v_fract_f32 v16, v11
    v_add_u32 v11, 37, v10
    v_cvt_f32_u32 v11, v11
    v_mul_f32 v11, v11, v9
    v_add_f32 v11, 0x3e800000, v11
    v_fract_f32 v17, v11
    v_add_u32 v11, 39, v10
    v_cvt_f32_u32 v11, v11
    v_mul_f32 v11, v11, v9
    v_fract_f32 v18, v11
    v_add_u32 v11, 39, v10
    v_cvt_f32_u32 v11, v11
    v_mul_f32 v11, v11, v9
    v_add_f32 v11, 0x3e800000, v11
    v_fract_f32 v19, v11
    v_cos_f32 v12, v12
    v_cos_f32 v13, v13
    v_cos_f32 v14, v14
    v_cos_f32 v15, v15
    v_cos_f32 v16, v16
    v_cos_f32 v17, v17
    v_cos_f32 v18, v18
    v_cos_f32 v19, v19
    s_nop 0
    v_cvt_pk_bf16_f32 v24, v12, v13
    v_cvt_pk_bf16_f32 v25, v14, v15
    v_cvt_pk_bf16_f32 v26, v16, v17
    v_cvt_pk_bf16_f32 v27, v18, v19
    s_add_u32 s34, s33, 9216
    buffer_store_dwordx4 v[24:27], v6, s[12:15], s34 offen
    s_nop 1
L_prep_kernel_done:
    s_endpgm
.globl gemm1_kernel
.p2align 8
.type gemm1_kernel,@function
gemm1_kernel:
    s_cmp_ge_u32 s2, 256
    s_cbranch_scc1 L_gemm1_kernel_done
    s_load_dwordx2 s[4:5], s[0:1], 72
    v_readfirstlane_b32 s20, v0
    s_lshr_b32 s20, s20, 6
    s_and_b32 s24, s2, 7
    s_lshr_b32 s25, s2, 3
    s_lshr_b32 s26, s25, 3
    s_lshl_b32 s24, s24, 2
    s_add_u32 s21, s24, s26
    s_and_b32 s25, s25, 7
    s_lshr_b32 s26, s25, 1
    s_and_b32 s27, s25, 1
    s_mul_i32 s22, s26, 84
    s_sub_u32 s28, 334, s22
    s_min_u32 s28, s28, 84
    s_waitcnt lgkmcnt(0)
    s_mul_i32 s29, s21, 684032
    s_lshl_b32 s30, s22, 11
    s_add_u32 s29, s29, s30
    s_add_u32 s29, s29, 0
    s_add_u32 s8, s4, s29
    s_addc_u32 s9, s5, 0
    s_lshl_b32 s10, s28, 11
    s_mov_b32 s11, 0x00020000
    s_mul_i32 s29, s21, 528640
    s_mul_i32 s30, s27, 16384
    s_add_u32 s29, s29, s30
    s_add_u32 s29, s29, 21954560
    s_add_u32 s12, s4, s29
    s_addc_u32 s13, s5, 0
    s_mov_b32 s14, 507904
    s_mov_b32 s15, 0x00020000
    s_cmp_ge_u32 s20, 4
    s_cbranch_scc1 L_gemm1_kernel_loader
    s_lshl_b32 s29, s22, 15
    s_add_u32 s29, s29, 38871040
    s_add_u32 s16, s4, s29
    s_addc_u32 s17, s5, 0
    s_lshl_b32 s18, s28, 15
    s_mov_b32 s19, 0x00020000
    s_lshr_b32 s29, s20, 1
    s_and_b32 s30, s20, 1
    v_and_b32 v217, 15, v0
    v_bfe_u32 v218, v0, 4, 2
    v_and_b32 v219, 63, v0
    s_mul_i32 s31, s29, 6144
    v_and_b32 v220, 7, v217
    v_xor_b32 v220, v218, v220
    v_lshlrev_b32 v220, 4, v220
    v_lshl_add_u32 v220, v217, 7, v220
    v_add_u32 v220, s31, v220
    v_add_u32 v208, 0, v220
    v_xor_b32 v211, 64, v208
    v_add_u32 v209, 57344, v220
    v_xor_b32 v212, 64, v209
    v_add_u32 v210, 114688, v220
    v_xor_b32 v213, 64, v210
    s_mul_i32 s31, s30, 8192
    s_add_u32 s31, s31, 12288
    v_lshlrev_b32 v220, 4, v219
    v_add_u32 v220, s31, v220
    v_add_u32 v214, 0, v220
    v_add_u32 v215, 57344, v220
    v_add_u32 v216, 114688, v220
    s_mul_i32 s31, s29, 1572864
    v_lshlrev_b32 v221, 15, v217
    v_lshl_add_u32 v221, v218, 4, v221
    v_add_u32 v221, s31, v221
    s_mul_i32 s31, s27, 4
    s_mul_i32 s29, s30, 2
    s_add_u32 s31, s31, s29
    s_lshl_b32 s31, s31, 12
    s_lshl_b32 s29, s21, 7
    s_add_u32 s33, s31, s29
    s_mov_b32 s34, 0x80008000
    s_barrier
    ds_read_b128 v[96:99], v214 offset:0
    ds_read_b128 v[128:131], v208 offset:0
    ds_read_b128 v[136:139], v208 offset:2048
    ds_read_b128 v[144:147], v208 offset:4096
    ds_read_b128 v[104:107], v214 offset:2048
    ds_read_b128 v[112:115], v214 offset:4096
    ds_read_b128 v[120:123], v214 offset:6144
    ds_read_b128 v[132:135], v211 offset:0
    ds_read_b128 v[140:143], v211 offset:2048
    ds_read_b128 v[148:151], v211 offset:4096
    ds_read_b128 v[100:103], v214 offset:1024
    ds_read_b128 v[108:111], v214 offset:3072
    ds_read_b128 v[116:119], v214 offset:5120
    ds_read_b128 v[124:127], v214 offset:7168
    s_waitcnt lgkmcnt(0)
    s_barrier
    v_mfma_f32_16x16x32_bf16 v[0:3], v[96:99], v[128:131], 0
    ds_read_b128 v[152:155], v214 offset:28672
    v_mfma_f32_16x16x32_bf16 v[4:7], v[96:99], v[136:139], 0
    v_mfma_f32_16x16x32_bf16 v[8:11], v[96:99], v[144:147], 0
    ds_read_b128 v[184:187], v208 offset:28672
    v_mfma_f32_16x16x32_bf16 v[12:15], v[104:107], v[128:131], 0
    v_mfma_f32_16x16x32_bf16 v[16:19], v[104:107], v[136:139], 0
    ds_read_b128 v[192:195], v208 offset:30720
    v_mfma_f32_16x16x32_bf16 v[20:23], v[104:107], v[144:147], 0
    v_mfma_f32_16x16x32_bf16 v[24:27], v[112:115], v[128:131], 0
    ds_read_b128 v[200:203], v208 offset:32768
    v_mfma_f32_16x16x32_bf16 v[28:31], v[112:115], v[136:139], 0
    v_mfma_f32_16x16x32_bf16 v[32:35], v[112:115], v[144:147], 0
    ds_read_b128 v[160:163], v214 offset:30720
    v_mfma_f32_16x16x32_bf16 v[36:39], v[120:123], v[128:131], 0
    v_mfma_f32_16x16x32_bf16 v[40:43], v[120:123], v[136:139], 0
    ds_read_b128 v[168:171], v214 offset:32768
    v_mfma_f32_16x16x32_bf16 v[44:47], v[120:123], v[144:147], 0
    v_mfma_f32_16x16x32_bf16 v[48:51], v[96:99], v[132:135], 0
    ds_read_b128 v[176:179], v214 offset:34816
    v_mfma_f32_16x16x32_bf16 v[52:55], v[96:99], v[140:143], 0
    v_mfma_f32_16x16x32_bf16 v[56:59], v[96:99], v[148:151], 0
    ds_read_b128 v[188:191], v211 offset:28672
    v_mfma_f32_16x16x32_bf16 v[60:63], v[104:107], v[132:135], 0
    v_mfma_f32_16x16x32_bf16 v[64:67], v[104:107], v[140:143], 0
    ds_read_b128 v[196:199], v211 offset:30720
    v_mfma_f32_16x16x32_bf16 v[68:71], v[104:107], v[148:151], 0
    v_mfma_f32_16x16x32_bf16 v[72:75], v[112:115], v[132:135], 0
    ds_read_b128 v[204:207], v211 offset:32768
    v_mfma_f32_16x16x32_bf16 v[76:79], v[112:115], v[140:143], 0
    v_mfma_f32_16x16x32_bf16 v[80:83], v[112:115], v[148:151], 0
    ds_read_b128 v[156:159], v214 offset:29696
    v_mfma_f32_16x16x32_bf16 v[84:87], v[120:123], v[132:135], 0
    v_mfma_f32_16x16x32_bf16 v[88:91], v[120:123], v[140:143], 0
    ds_read_b128 v[164:167], v214 offset:31744
    v_mfma_f32_16x16x32_bf16 v[92:95], v[120:123], v[148:151], 0
    v_mfma_f32_16x16x32_bf16 v[48:51], v[100:103], v[128:131], v[48:51]
    ds_read_b128 v[172:175], v214 offset:33792
    v_xor_b32 v132, s34, v132
    v_xor_b32 v133, s34, v133
    v_mfma_f32_16x16x32_bf16 v[52:55], v[100:103], v[136:139], v[52:55]
    v_xor_b32 v134, s34, v134
    v_xor_b32 v135, s34, v135
    v_mfma_f32_16x16x32_bf16 v[56:59], v[100:103], v[144:147], v[56:59]
    ds_read_b128 v[180:183], v214 offset:35840
    v_xor_b32 v140, s34, v140
    v_xor_b32 v141, s34, v141
    v_mfma_f32_16x16x32_bf16 v[60:63], v[108:111], v[128:131], v[60:63]
    v_xor_b32 v142, s34, v142
    v_xor_b32 v143, s34, v143
    v_mfma_f32_16x16x32_bf16 v[64:67], v[108:111], v[136:139], v[64:67]
    v_xor_b32 v148, s34, v148
    v_xor_b32 v149, s34, v149
    v_mfma_f32_16x16x32_bf16 v[68:71], v[108:111], v[144:147], v[68:71]
    v_xor_b32 v150, s34, v150
    v_xor_b32 v151, s34, v151
    v_mfma_f32_16x16x32_bf16 v[72:75], v[116:119], v[128:131], v[72:75]
    v_mfma_f32_16x16x32_bf16 v[76:79], v[116:119], v[136:139], v[76:79]
    v_mfma_f32_16x16x32_bf16 v[80:83], v[116:119], v[144:147], v[80:83]
    v_mfma_f32_16x16x32_bf16 v[84:87], v[124:127], v[128:131], v[84:87]
    v_mfma_f32_16x16x32_bf16 v[88:91], v[124:127], v[136:139], v[88:91]
    v_mfma_f32_16x16x32_bf16 v[92:95], v[124:127], v[144:147], v[92:95]
    v_mfma_f32_16x16x32_bf16 v[0:3], v[100:103], v[132:135], v[0:3]
    v_mfma_f32_16x16x32_bf16 v[4:7], v[100:103], v[140:143], v[4:7]
    v_mfma_f32_16x16x32_bf16 v[8:11], v[100:103], v[148:151], v[8:11]
    v_mfma_f32_16x16x32_bf16 v[12:15], v[108:111], v[132:135], v[12:15]
    v_mfma_f32_16x16x32_bf16 v[16:19], v[108:111], v[140:143], v[16:19]
    s_waitcnt lgkmcnt(0)
    s_barrier
    v_mfma_f32_16x16x32_bf16 v[20:23], v[108:111], v[148:151], v[20:23]
    v_mfma_f32_16x16x32_bf16 v[24:27], v[116:119], v[132:135], v[24:27]
    v_mfma_f32_16x16x32_bf16 v[28:31], v[116:119], v[140:143], v[28:31]
    v_mfma_f32_16x16x32_bf16 v[32:35], v[116:119], v[148:151], v[32:35]
    v_mfma_f32_16x16x32_bf16 v[36:39], v[124:127], v[132:135], v[36:39]
    v_mfma_f32_16x16x32_bf16 v[40:43], v[124:127], v[140:143], v[40:43]
    v_mfma_f32_16x16x32_bf16 v[44:47], v[124:127], v[148:151], v[44:47]
    v_mfma_f32_16x16x32_bf16 v[0:3], v[152:155], v[184:187], v[0:3]
    ds_read_b128 v[96:99], v215 offset:0
    v_mfma_f32_16x16x32_bf16 v[4:7], v[152:155], v[192:195], v[4:7]
    v_mfma_f32_16x16x32_bf16 v[8:11], v[152:155], v[200:203], v[8:11]
    ds_read_b128 v[128:131], v209 offset:0
    v_mfma_f32_16x16x32_bf16 v[12:15], v[160:163], v[184:187], v[12:15]
    v_mfma_f32_16x16x32_bf16 v[16:19], v[160:163], v[192:195], v[16:19]
    ds_read_b128 v[136:139], v209 offset:2048
    v_mfma_f32_16x16x32_bf16 v[20:23], v[160:163], v[200:203], v[20:23]
    v_mfma_f32_16x16x32_bf16 v[24:27], v[168:171], v[184:187], v[24:27]
    ds_read_b128 v[144:147], v209 offset:4096
    v_mfma_f32_16x16x32_bf16 v[28:31], v[168:171], v[192:195], v[28:31]
    v_mfma_f32_16x16x32_bf16 v[32:35], v[168:171], v[200:203], v[32:35]
    ds_read_b128 v[104:107], v215 offset:2048
    v_mfma_f32_16x16x32_bf16 v[36:39], v[176:179], v[184:187], v[36:39]
    v_mfma_f32_16x16x32_bf16 v[40:43], v[176:179], v[192:195], v[40:43]
    ds_read_b128 v[112:115], v215 offset:4096
    v_mfma_f32_16x16x32_bf16 v[44:47], v[176:179], v[200:203], v[44:47]
    v_mfma_f32_16x16x32_bf16 v[48:51], v[152:155], v[188:191], v[48:51]
    ds_read_b128 v[120:123], v215 offset:6144
    v_mfma_f32_16x16x32_bf16 v[52:55], v[152:155], v[196:199], v[52:55]
    v_mfma_f32_16x16x32_bf16 v[56:59], v[152:155], v[204:207], v[56:59]
    ds_read_b128 v[132:135], v212 offset:0
    v_mfma_f32_16x16x32_bf16 v[60:63], v[160:163], v[188:191], v[60:63]
    v_mfma_f32_16x16x32_bf16 v[64:67], v[160:163], v[196:199], v[64:67]
    ds_read_b128 v[140:143], v212 offset:2048
    v_mfma_f32_16x16x32_bf16 v[68:71], v[160:163], v[204:207], v[68:71]
    v_mfma_f32_16x16x32_bf16 v[72:75], v[168:171], v[188:191], v[72:75]
    ds_read_b128 v[148:151], v212 offset:4096
    v_mfma_f32_16x16x32_bf16 v[76:79], v[168:171], v[196:199], v[76:79]
    v_mfma_f32_16x16x32_bf16 v[80:83], v[168:171], v[204:207], v[80:83]
    ds_read_b128 v[100:103], v215 offset:1024
    v_mfma_f32_16x16x32_bf16 v[84:87], v[176:179], v[188:191], v[84:87]
    v_mfma_f32_16x16x32_bf16 v[88:91], v[176:179], v[196:199], v[88:91]
    ds_read_b128 v[108:111], v215 offset:3072
    v_mfma_f32_16x16x32_bf16 v[92:95], v[176:179], v[204:207], v[92:95]
    v_mfma_f32_16x16x32_bf16 v[48:51], v[156:159], v[184:187], v[48:51]
    ds_read_b128 v[116:119], v215 offset:5120
    v_xor_b32 v188, s34, v188
    v_xor_b32 v189, s34, v189
    v_mfma_f32_16x16x32_bf16 v[52:55], v[156:159], v[192:195], v[52:55]
    v_xor_b32 v190, s34, v190
    v_xor_b32 v191, s34, v191
    v_mfma_f32_16x16x32_bf16 v[56:59], v[156:159], v[200:203], v[56:59]
    ds_read_b128 v[124:127], v215 offset:7168
    v_xor_b32 v196, s34, v196
    v_xor_b32 v197, s34, v197
    v_mfma_f32_16x16x32_bf16 v[60:63], v[164:167], v[184:187], v[60:63]
    v_xor_b32 v198, s34, v198
    v_xor_b32 v199, s34, v199
    v_mfma_f32_16x16x32_bf16 v[64:67], v[164:167], v[192:195], v[64:67]
    v_xor_b32 v204, s34, v204
    v_xor_b32 v205, s34, v205
    v_mfma_f32_16x16x32_bf16 v[68:71], v[164:167], v[200:203], v[68:71]
    v_xor_b32 v206, s34, v206
    v_xor_b32 v207, s34, v207
    v_mfma_f32_16x16x32_bf16 v[72:75], v[172:175], v[184:187], v[72:75]
    v_mfma_f32_16x16x32_bf16 v[76:79], v[172:175], v[192:195], v[76:79]
    v_mfma_f32_16x16x32_bf16 v[80:83], v[172:175], v[200:203], v[80:83]
    v_mfma_f32_16x16x32_bf16 v[84:87], v[180:183], v[184:187], v[84:87]
    v_mfma_f32_16x16x32_bf16 v[88:91], v[180:183], v[192:195], v[88:91]
    v_mfma_f32_16x16x32_bf16 v[92:95], v[180:183], v[200:203], v[92:95]
    v_mfma_f32_16x16x32_bf16 v[0:3], v[156:159], v[188:191], v[0:3]
    v_mfma_f32_16x16x32_bf16 v[4:7], v[156:159], v[196:199], v[4:7]
    v_mfma_f32_16x16x32_bf16 v[8:11], v[156:159], v[204:207], v[8:11]
    v_mfma_f32_16x16x32_bf16 v[12:15], v[164:167], v[188:191], v[12:15]
    v_mfma_f32_16x16x32_bf16 v[16:19], v[164:167], v[196:199], v[16:19]
    s_waitcnt lgkmcnt(0)
    s_barrier
    v_mfma_f32_16x16x32_bf16 v[20:23], v[164:167], v[204:207], v[20:23]
    v_mfma_f32_16x16x32_bf16 v[24:27], v[172:175], v[188:191], v[24:27]
    v_mfma_f32_16x16x32_bf16 v[28:31], v[172:175], v[196:199], v[28:31]
    v_mfma_f32_16x16x32_bf16 v[32:35], v[172:175], v[204:207], v[32:35]
    v_mfma_f32_16x16x32_bf16 v[36:39], v[180:183], v[188:191], v[36:39]
    v_mfma_f32_16x16x32_bf16 v[40:43], v[180:183], v[196:199], v[40:43]
    v_mfma_f32_16x16x32_bf16 v[44:47], v[180:183], v[204:207], v[44:47]
    v_mfma_f32_16x16x32_bf16 v[0:3], v[96:99], v[128:131], v[0:3]
    ds_read_b128 v[152:155], v215 offset:28672
    v_mfma_f32_16x16x32_bf16 v[4:7], v[96:99], v[136:139], v[4:7]
    v_mfma_f32_16x16x32_bf16 v[8:11], v[96:99], v[144:147], v[8:11]
    ds_read_b128 v[184:187], v209 offset:28672
    v_mfma_f32_16x16x32_bf16 v[12:15], v[104:107], v[128:131], v[12:15]
    v_mfma_f32_16x16x32_bf16 v[16:19], v[104:107], v[136:139], v[16:19]
    ds_read_b128 v[192:195], v209 offset:30720
    v_mfma_f32_16x16x32_bf16 v[20:23], v[104:107], v[144:147], v[20:23]
    v_mfma_f32_16x16x32_bf16 v[24:27], v[112:115], v[128:131], v[24:27]
    ds_read_b128 v[200:203], v209 offset:32768
    v_mfma_f32_16x16x32_bf16 v[28:31], v[112:115], v[136:139], v[28:31]
    v_mfma_f32_16x16x32_bf16 v[32:35], v[112:115], v[144:147], v[32:35]
    ds_read_b128 v[160:163], v215 offset:30720
    v_mfma_f32_16x16x32_bf16 v[36:39], v[120:123], v[128:131], v[36:39]
    v_mfma_f32_16x16x32_bf16 v[40:43], v[120:123], v[136:139], v[40:43]
    ds_read_b128 v[168:171], v215 offset:32768
    v_mfma_f32_16x16x32_bf16 v[44:47], v[120:123], v[144:147], v[44:47]
    v_mfma_f32_16x16x32_bf16 v[48:51], v[96:99], v[132:135], v[48:51]
    ds_read_b128 v[176:179], v215 offset:34816
    v_mfma_f32_16x16x32_bf16 v[52:55], v[96:99], v[140:143], v[52:55]
    v_mfma_f32_16x16x32_bf16 v[56:59], v[96:99], v[148:151], v[56:59]
    ds_read_b128 v[188:191], v212 offset:28672
    v_mfma_f32_16x16x32_bf16 v[60:63], v[104:107], v[132:135], v[60:63]
    v_mfma_f32_16x16x32_bf16 v[64:67], v[104:107], v[140:143], v[64:67]
    ds_read_b128 v[196:199], v212 offset:30720
    v_mfma_f32_16x16x32_bf16 v[68:71], v[104:107], v[148:151], v[68:71]
    v_mfma_f32_16x16x32_bf16 v[72:75], v[112:115], v[132:135], v[72:75]
    ds_read_b128 v[204:207], v212 offset:32768
    v_mfma_f32_16x16x32_bf16 v[76:79], v[112:115], v[140:143], v[76:79]
    v_mfma_f32_16x16x32_bf16 v[80:83], v[112:115], v[148:151], v[80:83]
    ds_read_b128 v[156:159], v215 offset:29696
    v_mfma_f32_16x16x32_bf16 v[84:87], v[120:123], v[132:135], v[84:87]
    v_mfma_f32_16x16x32_bf16 v[88:91], v[120:123], v[140:143], v[88:91]
    ds_read_b128 v[164:167], v215 offset:31744
    v_mfma_f32_16x16x32_bf16 v[92:95], v[120:123], v[148:151], v[92:95]
    v_mfma_f32_16x16x32_bf16 v[48:51], v[100:103], v[128:131], v[48:51]
    ds_read_b128 v[172:175], v215 offset:33792
    v_xor_b32 v132, s34, v132
    v_xor_b32 v133, s34, v133
    v_mfma_f32_16x16x32_bf16 v[52:55], v[100:103], v[136:139], v[52:55]
    v_xor_b32 v134, s34, v134
    v_xor_b32 v135, s34, v135
    v_mfma_f32_16x16x32_bf16 v[56:59], v[100:103], v[144:147], v[56:59]
    ds_read_b128 v[180:183], v215 offset:35840
    v_xor_b32 v140, s34, v140
    v_xor_b32 v141, s34, v141
    v_mfma_f32_16x16x32_bf16 v[60:63], v[108:111], v[128:131], v[60:63]
    v_xor_b32 v142, s34, v142
    v_xor_b32 v143, s34, v143
    v_mfma_f32_16x16x32_bf16 v[64:67], v[108:111], v[136:139], v[64:67]
    v_xor_b32 v148, s34, v148
    v_xor_b32 v149, s34, v149
    v_mfma_f32_16x16x32_bf16 v[68:71], v[108:111], v[144:147], v[68:71]
    v_xor_b32 v150, s34, v150
    v_xor_b32 v151, s34, v151
    v_mfma_f32_16x16x32_bf16 v[72:75], v[116:119], v[128:131], v[72:75]
    v_mfma_f32_16x16x32_bf16 v[76:79], v[116:119], v[136:139], v[76:79]
    v_mfma_f32_16x16x32_bf16 v[80:83], v[116:119], v[144:147], v[80:83]
    v_mfma_f32_16x16x32_bf16 v[84:87], v[124:127], v[128:131], v[84:87]
    v_mfma_f32_16x16x32_bf16 v[88:91], v[124:127], v[136:139], v[88:91]
    v_mfma_f32_16x16x32_bf16 v[92:95], v[124:127], v[144:147], v[92:95]
    v_mfma_f32_16x16x32_bf16 v[0:3], v[100:103], v[132:135], v[0:3]
    v_mfma_f32_16x16x32_bf16 v[4:7], v[100:103], v[140:143], v[4:7]
    v_mfma_f32_16x16x32_bf16 v[8:11], v[100:103], v[148:151], v[8:11]
    v_mfma_f32_16x16x32_bf16 v[12:15], v[108:111], v[132:135], v[12:15]
    v_mfma_f32_16x16x32_bf16 v[16:19], v[108:111], v[140:143], v[16:19]
    s_waitcnt lgkmcnt(0)
    s_barrier
    v_mfma_f32_16x16x32_bf16 v[20:23], v[108:111], v[148:151], v[20:23]
    v_mfma_f32_16x16x32_bf16 v[24:27], v[116:119], v[132:135], v[24:27]
    v_mfma_f32_16x16x32_bf16 v[28:31], v[116:119], v[140:143], v[28:31]
    v_mfma_f32_16x16x32_bf16 v[32:35], v[116:119], v[148:151], v[32:35]
    v_mfma_f32_16x16x32_bf16 v[36:39], v[124:127], v[132:135], v[36:39]
    v_mfma_f32_16x16x32_bf16 v[40:43], v[124:127], v[140:143], v[40:43]
    v_mfma_f32_16x16x32_bf16 v[44:47], v[124:127], v[148:151], v[44:47]
    v_mfma_f32_16x16x32_bf16 v[0:3], v[152:155], v[184:187], v[0:3]
    ds_read_b128 v[96:99], v216 offset:0
    v_mfma_f32_16x16x32_bf16 v[4:7], v[152:155], v[192:195], v[4:7]
    v_mfma_f32_16x16x32_bf16 v[8:11], v[152:155], v[200:203], v[8:11]
    ds_read_b128 v[128:131], v210 offset:0
    v_mfma_f32_16x16x32_bf16 v[12:15], v[160:163], v[184:187], v[12:15]
    v_mfma_f32_16x16x32_bf16 v[16:19], v[160:163], v[192:195], v[16:19]
    ds_read_b128 v[136:139], v210 offset:2048
    v_mfma_f32_16x16x32_bf16 v[20:23], v[160:163], v[200:203], v[20:23]
    v_mfma_f32_16x16x32_bf16 v[24:27], v[168:171], v[184:187], v[24:27]
    ds_read_b128 v[144:147], v210 offset:4096
    v_mfma_f32_16x16x32_bf16 v[28:31], v[168:171], v[192:195], v[28:31]
    v_mfma_f32_16x16x32_bf16 v[32:35], v[168:171], v[200:203], v[32:35]
    ds_read_b128 v[104:107], v216 offset:2048
    v_mfma_f32_16x16x32_bf16 v[36:39], v[176:179], v[184:187], v[36:39]
    v_mfma_f32_16x16x32_bf16 v[40:43], v[176:179], v[192:195], v[40:43]
    ds_read_b128 v[112:115], v216 offset:4096
    v_mfma_f32_16x16x32_bf16 v[44:47], v[176:179], v[200:203], v[44:47]
    v_mfma_f32_16x16x32_bf16 v[48:51], v[152:155], v[188:191], v[48:51]
    ds_read_b128 v[120:123], v216 offset:6144
    v_mfma_f32_16x16x32_bf16 v[52:55], v[152:155], v[196:199], v[52:55]
    v_mfma_f32_16x16x32_bf16 v[56:59], v[152:155], v[204:207], v[56:59]
    ds_read_b128 v[132:135], v213 offset:0
    v_mfma_f32_16x16x32_bf16 v[60:63], v[160:163], v[188:191], v[60:63]
    v_mfma_f32_16x16x32_bf16 v[64:67], v[160:163], v[196:199], v[64:67]
    ds_read_b128 v[140:143], v213 offset:2048
    v_mfma_f32_16x16x32_bf16 v[68:71], v[160:163], v[204:207], v[68:71]
    v_mfma_f32_16x16x32_bf16 v[72:75], v[168:171], v[188:191], v[72:75]
    ds_read_b128 v[148:151], v213 offset:4096
    v_mfma_f32_16x16x32_bf16 v[76:79], v[168:171], v[196:199], v[76:79]
    v_mfma_f32_16x16x32_bf16 v[80:83], v[168:171], v[204:207], v[80:83]
    ds_read_b128 v[100:103], v216 offset:1024
    v_mfma_f32_16x16x32_bf16 v[84:87], v[176:179], v[188:191], v[84:87]
    v_mfma_f32_16x16x32_bf16 v[88:91], v[176:179], v[196:199], v[88:91]
    ds_read_b128 v[108:111], v216 offset:3072
    v_mfma_f32_16x16x32_bf16 v[92:95], v[176:179], v[204:207], v[92:95]
    v_mfma_f32_16x16x32_bf16 v[48:51], v[156:159], v[184:187], v[48:51]
    ds_read_b128 v[116:119], v216 offset:5120
    v_xor_b32 v188, s34, v188
    v_xor_b32 v189, s34, v189
    v_mfma_f32_16x16x32_bf16 v[52:55], v[156:159], v[192:195], v[52:55]
    v_xor_b32 v190, s34, v190
    v_xor_b32 v191, s34, v191
    v_mfma_f32_16x16x32_bf16 v[56:59], v[156:159], v[200:203], v[56:59]
    ds_read_b128 v[124:127], v216 offset:7168
    v_xor_b32 v196, s34, v196
    v_xor_b32 v197, s34, v197
    v_mfma_f32_16x16x32_bf16 v[60:63], v[164:167], v[184:187], v[60:63]
    v_xor_b32 v198, s34, v198
    v_xor_b32 v199, s34, v199
    v_mfma_f32_16x16x32_bf16 v[64:67], v[164:167], v[192:195], v[64:67]
    v_xor_b32 v204, s34, v204
    v_xor_b32 v205, s34, v205
    v_mfma_f32_16x16x32_bf16 v[68:71], v[164:167], v[200:203], v[68:71]
    v_xor_b32 v206, s34, v206
    v_xor_b32 v207, s34, v207
    v_mfma_f32_16x16x32_bf16 v[72:75], v[172:175], v[184:187], v[72:75]
    v_mfma_f32_16x16x32_bf16 v[76:79], v[172:175], v[192:195], v[76:79]
    v_mfma_f32_16x16x32_bf16 v[80:83], v[172:175], v[200:203], v[80:83]
    v_mfma_f32_16x16x32_bf16 v[84:87], v[180:183], v[184:187], v[84:87]
    v_mfma_f32_16x16x32_bf16 v[88:91], v[180:183], v[192:195], v[88:91]
    v_mfma_f32_16x16x32_bf16 v[92:95], v[180:183], v[200:203], v[92:95]
    v_mfma_f32_16x16x32_bf16 v[0:3], v[156:159], v[188:191], v[0:3]
    v_mfma_f32_16x16x32_bf16 v[4:7], v[156:159], v[196:199], v[4:7]
    v_mfma_f32_16x16x32_bf16 v[8:11], v[156:159], v[204:207], v[8:11]
    v_mfma_f32_16x16x32_bf16 v[12:15], v[164:167], v[188:191], v[12:15]
    v_mfma_f32_16x16x32_bf16 v[16:19], v[164:167], v[196:199], v[16:19]
    s_waitcnt lgkmcnt(0)
    s_barrier
    v_mfma_f32_16x16x32_bf16 v[20:23], v[164:167], v[204:207], v[20:23]
    v_mfma_f32_16x16x32_bf16 v[24:27], v[172:175], v[188:191], v[24:27]
    v_mfma_f32_16x16x32_bf16 v[28:31], v[172:175], v[196:199], v[28:31]
    v_mfma_f32_16x16x32_bf16 v[32:35], v[172:175], v[204:207], v[32:35]
    v_mfma_f32_16x16x32_bf16 v[36:39], v[180:183], v[188:191], v[36:39]
    v_mfma_f32_16x16x32_bf16 v[40:43], v[180:183], v[196:199], v[40:43]
    v_mfma_f32_16x16x32_bf16 v[44:47], v[180:183], v[204:207], v[44:47]
    v_mfma_f32_16x16x32_bf16 v[0:3], v[96:99], v[128:131], v[0:3]
    ds_read_b128 v[152:155], v214 offset:0
    v_mfma_f32_16x16x32_bf16 v[4:7], v[96:99], v[136:139], v[4:7]
    v_mfma_f32_16x16x32_bf16 v[8:11], v[96:99], v[144:147], v[8:11]
    ds_read_b128 v[184:187], v208 offset:0
    v_mfma_f32_16x16x32_bf16 v[12:15], v[104:107], v[128:131], v[12:15]
    v_mfma_f32_16x16x32_bf16 v[16:19], v[104:107], v[136:139], v[16:19]
    ds_read_b128 v[192:195], v208 offset:2048
    v_mfma_f32_16x16x32_bf16 v[20:23], v[104:107], v[144:147], v[20:23]
    v_mfma_f32_16x16x32_bf16 v[24:27], v[112:115], v[128:131], v[24:27]
    ds_read_b128 v[200:203], v208 offset:4096
    v_mfma_f32_16x16x32_bf16 v[28:31], v[112:115], v[136:139], v[28:31]
    v_mfma_f32_16x16x32_bf16 v[32:35], v[112:115], v[144:147], v[32:35]
    ds_read_b128 v[160:163], v214 offset:2048
    v_mfma_f32_16x16x32_bf16 v[36:39], v[120:123], v[128:131], v[36:39]
    v_mfma_f32_16x16x32_bf16 v[40:43], v[120:123], v[136:139], v[40:43]
    ds_read_b128 v[168:171], v214 offset:4096
    v_mfma_f32_16x16x32_bf16 v[44:47], v[120:123], v[144:147], v[44:47]
    v_mfma_f32_16x16x32_bf16 v[48:51], v[96:99], v[132:135], v[48:51]
    ds_read_b128 v[176:179], v214 offset:6144
    v_mfma_f32_16x16x32_bf16 v[52:55], v[96:99], v[140:143], v[52:55]
    v_mfma_f32_16x16x32_bf16 v[56:59], v[96:99], v[148:151], v[56:59]
    ds_read_b128 v[188:191], v211 offset:0
    v_mfma_f32_16x16x32_bf16 v[60:63], v[104:107], v[132:135], v[60:63]
    v_mfma_f32_16x16x32_bf16 v[64:67], v[104:107], v[140:143], v[64:67]
    ds_read_b128 v[196:199], v211 offset:2048
    v_mfma_f32_16x16x32_bf16 v[68:71], v[104:107], v[148:151], v[68:71]
    v_mfma_f32_16x16x32_bf16 v[72:75], v[112:115], v[132:135], v[72:75]
    ds_read_b128 v[204:207], v211 offset:4096
    v_mfma_f32_16x16x32_bf16 v[76:79], v[112:115], v[140:143], v[76:79]
    v_mfma_f32_16x16x32_bf16 v[80:83], v[112:115], v[148:151], v[80:83]
    ds_read_b128 v[156:159], v214 offset:1024
    v_mfma_f32_16x16x32_bf16 v[84:87], v[120:123], v[132:135], v[84:87]
    v_mfma_f32_16x16x32_bf16 v[88:91], v[120:123], v[140:143], v[88:91]
    ds_read_b128 v[164:167], v214 offset:3072
    v_mfma_f32_16x16x32_bf16 v[92:95], v[120:123], v[148:151], v[92:95]
    v_mfma_f32_16x16x32_bf16 v[48:51], v[100:103], v[128:131], v[48:51]
    ds_read_b128 v[172:175], v214 offset:5120
    v_xor_b32 v132, s34, v132
    v_xor_b32 v133, s34, v133
    v_mfma_f32_16x16x32_bf16 v[52:55], v[100:103], v[136:139], v[52:55]
    v_xor_b32 v134, s34, v134
    v_xor_b32 v135, s34, v135
    v_mfma_f32_16x16x32_bf16 v[56:59], v[100:103], v[144:147], v[56:59]
    ds_read_b128 v[180:183], v214 offset:7168
    v_xor_b32 v140, s34, v140
    v_xor_b32 v141, s34, v141
    v_mfma_f32_16x16x32_bf16 v[60:63], v[108:111], v[128:131], v[60:63]
    v_xor_b32 v142, s34, v142
    v_xor_b32 v143, s34, v143
    v_mfma_f32_16x16x32_bf16 v[64:67], v[108:111], v[136:139], v[64:67]
    v_xor_b32 v148, s34, v148
    v_xor_b32 v149, s34, v149
    v_mfma_f32_16x16x32_bf16 v[68:71], v[108:111], v[144:147], v[68:71]
    v_xor_b32 v150, s34, v150
    v_xor_b32 v151, s34, v151
    v_mfma_f32_16x16x32_bf16 v[72:75], v[116:119], v[128:131], v[72:75]
    v_mfma_f32_16x16x32_bf16 v[76:79], v[116:119], v[136:139], v[76:79]
    v_mfma_f32_16x16x32_bf16 v[80:83], v[116:119], v[144:147], v[80:83]
    v_mfma_f32_16x16x32_bf16 v[84:87], v[124:127], v[128:131], v[84:87]
    v_mfma_f32_16x16x32_bf16 v[88:91], v[124:127], v[136:139], v[88:91]
    v_mfma_f32_16x16x32_bf16 v[92:95], v[124:127], v[144:147], v[92:95]
    v_mfma_f32_16x16x32_bf16 v[0:3], v[100:103], v[132:135], v[0:3]
    v_mfma_f32_16x16x32_bf16 v[4:7], v[100:103], v[140:143], v[4:7]
    v_mfma_f32_16x16x32_bf16 v[8:11], v[100:103], v[148:151], v[8:11]
    v_mfma_f32_16x16x32_bf16 v[12:15], v[108:111], v[132:135], v[12:15]
    v_mfma_f32_16x16x32_bf16 v[16:19], v[108:111], v[140:143], v[16:19]
    s_waitcnt lgkmcnt(0)
    s_barrier
    v_mfma_f32_16x16x32_bf16 v[20:23], v[108:111], v[148:151], v[20:23]
    v_mfma_f32_16x16x32_bf16 v[24:27], v[116:119], v[132:135], v[24:27]
    v_mfma_f32_16x16x32_bf16 v[28:31], v[116:119], v[140:143], v[28:31]
    v_mfma_f32_16x16x32_bf16 v[32:35], v[116:119], v[148:151], v[32:35]
    v_mfma_f32_16x16x32_bf16 v[36:39], v[124:127], v[132:135], v[36:39]
    v_mfma_f32_16x16x32_bf16 v[40:43], v[124:127], v[140:143], v[40:43]
    v_mfma_f32_16x16x32_bf16 v[44:47], v[124:127], v[148:151], v[44:47]
    v_mfma_f32_16x16x32_bf16 v[0:3], v[152:155], v[184:187], v[0:3]
    ds_read_b128 v[96:99], v214 offset:28672
    v_mfma_f32_16x16x32_bf16 v[4:7], v[152:155], v[192:195], v[4:7]
    v_mfma_f32_16x16x32_bf16 v[8:11], v[152:155], v[200:203], v[8:11]
    ds_read_b128 v[128:131], v208 offset:28672
    v_mfma_f32_16x16x32_bf16 v[12:15], v[160:163], v[184:187], v[12:15]
    v_mfma_f32_16x16x32_bf16 v[16:19], v[160:163], v[192:195], v[16:19]
    ds_read_b128 v[136:139], v208 offset:30720
    v_mfma_f32_16x16x32_bf16 v[20:23], v[160:163], v[200:203], v[20:23]
    v_mfma_f32_16x16x32_bf16 v[24:27], v[168:171], v[184:187], v[24:27]
    ds_read_b128 v[144:147], v208 offset:32768
    v_mfma_f32_16x16x32_bf16 v[28:31], v[168:171], v[192:195], v[28:31]
    v_mfma_f32_16x16x32_bf16 v[32:35], v[168:171], v[200:203], v[32:35]
    ds_read_b128 v[104:107], v214 offset:30720
    v_mfma_f32_16x16x32_bf16 v[36:39], v[176:179], v[184:187], v[36:39]
    v_mfma_f32_16x16x32_bf16 v[40:43], v[176:179], v[192:195], v[40:43]
    ds_read_b128 v[112:115], v214 offset:32768
    v_mfma_f32_16x16x32_bf16 v[44:47], v[176:179], v[200:203], v[44:47]
    v_mfma_f32_16x16x32_bf16 v[48:51], v[152:155], v[188:191], v[48:51]
    ds_read_b128 v[120:123], v214 offset:34816
    v_mfma_f32_16x16x32_bf16 v[52:55], v[152:155], v[196:199], v[52:55]
    v_mfma_f32_16x16x32_bf16 v[56:59], v[152:155], v[204:207], v[56:59]
    ds_read_b128 v[132:135], v211 offset:28672
    v_mfma_f32_16x16x32_bf16 v[60:63], v[160:163], v[188:191], v[60:63]
    v_mfma_f32_16x16x32_bf16 v[64:67], v[160:163], v[196:199], v[64:67]
    ds_read_b128 v[140:143], v211 offset:30720
    v_mfma_f32_16x16x32_bf16 v[68:71], v[160:163], v[204:207], v[68:71]
    v_mfma_f32_16x16x32_bf16 v[72:75], v[168:171], v[188:191], v[72:75]
    ds_read_b128 v[148:151], v211 offset:32768
    v_mfma_f32_16x16x32_bf16 v[76:79], v[168:171], v[196:199], v[76:79]
    v_mfma_f32_16x16x32_bf16 v[80:83], v[168:171], v[204:207], v[80:83]
    ds_read_b128 v[100:103], v214 offset:29696
    v_mfma_f32_16x16x32_bf16 v[84:87], v[176:179], v[188:191], v[84:87]
    v_mfma_f32_16x16x32_bf16 v[88:91], v[176:179], v[196:199], v[88:91]
    ds_read_b128 v[108:111], v214 offset:31744
    v_mfma_f32_16x16x32_bf16 v[92:95], v[176:179], v[204:207], v[92:95]
    v_mfma_f32_16x16x32_bf16 v[48:51], v[156:159], v[184:187], v[48:51]
    ds_read_b128 v[116:119], v214 offset:33792
    v_xor_b32 v188, s34, v188
    v_xor_b32 v189, s34, v189
    v_mfma_f32_16x16x32_bf16 v[52:55], v[156:159], v[192:195], v[52:55]
    v_xor_b32 v190, s34, v190
    v_xor_b32 v191, s34, v191
    v_mfma_f32_16x16x32_bf16 v[56:59], v[156:159], v[200:203], v[56:59]
    ds_read_b128 v[124:127], v214 offset:35840
    v_xor_b32 v196, s34, v196
    v_xor_b32 v197, s34, v197
    v_mfma_f32_16x16x32_bf16 v[60:63], v[164:167], v[184:187], v[60:63]
    v_xor_b32 v198, s34, v198
    v_xor_b32 v199, s34, v199
    v_mfma_f32_16x16x32_bf16 v[64:67], v[164:167], v[192:195], v[64:67]
    v_xor_b32 v204, s34, v204
    v_xor_b32 v205, s34, v205
    v_mfma_f32_16x16x32_bf16 v[68:71], v[164:167], v[200:203], v[68:71]
    v_xor_b32 v206, s34, v206
    v_xor_b32 v207, s34, v207
    v_mfma_f32_16x16x32_bf16 v[72:75], v[172:175], v[184:187], v[72:75]
    v_mfma_f32_16x16x32_bf16 v[76:79], v[172:175], v[192:195], v[76:79]
    v_mfma_f32_16x16x32_bf16 v[80:83], v[172:175], v[200:203], v[80:83]
    v_mfma_f32_16x16x32_bf16 v[84:87], v[180:183], v[184:187], v[84:87]
    v_mfma_f32_16x16x32_bf16 v[88:91], v[180:183], v[192:195], v[88:91]
    v_mfma_f32_16x16x32_bf16 v[92:95], v[180:183], v[200:203], v[92:95]
    v_mfma_f32_16x16x32_bf16 v[0:3], v[156:159], v[188:191], v[0:3]
    v_mfma_f32_16x16x32_bf16 v[4:7], v[156:159], v[196:199], v[4:7]
    v_mfma_f32_16x16x32_bf16 v[8:11], v[156:159], v[204:207], v[8:11]
    v_mfma_f32_16x16x32_bf16 v[12:15], v[164:167], v[188:191], v[12:15]
    v_mfma_f32_16x16x32_bf16 v[16:19], v[164:167], v[196:199], v[16:19]
    s_waitcnt lgkmcnt(0)
    s_barrier
    v_mfma_f32_16x16x32_bf16 v[20:23], v[164:167], v[204:207], v[20:23]
    v_mfma_f32_16x16x32_bf16 v[24:27], v[172:175], v[188:191], v[24:27]
    v_mfma_f32_16x16x32_bf16 v[28:31], v[172:175], v[196:199], v[28:31]
    v_mfma_f32_16x16x32_bf16 v[32:35], v[172:175], v[204:207], v[32:35]
    v_mfma_f32_16x16x32_bf16 v[36:39], v[180:183], v[188:191], v[36:39]
    v_mfma_f32_16x16x32_bf16 v[40:43], v[180:183], v[196:199], v[40:43]
    v_mfma_f32_16x16x32_bf16 v[44:47], v[180:183], v[204:207], v[44:47]
    v_mfma_f32_16x16x32_bf16 v[0:3], v[96:99], v[128:131], v[0:3]
    ds_read_b128 v[152:155], v215 offset:0
    v_mfma_f32_16x16x32_bf16 v[4:7], v[96:99], v[136:139], v[4:7]
    v_mfma_f32_16x16x32_bf16 v[8:11], v[96:99], v[144:147], v[8:11]
    ds_read_b128 v[184:187], v209 offset:0
    v_mfma_f32_16x16x32_bf16 v[12:15], v[104:107], v[128:131], v[12:15]
    v_mfma_f32_16x16x32_bf16 v[16:19], v[104:107], v[136:139], v[16:19]
    ds_read_b128 v[192:195], v209 offset:2048
    v_mfma_f32_16x16x32_bf16 v[20:23], v[104:107], v[144:147], v[20:23]
    v_mfma_f32_16x16x32_bf16 v[24:27], v[112:115], v[128:131], v[24:27]
    ds_read_b128 v[200:203], v209 offset:4096
    v_mfma_f32_16x16x32_bf16 v[28:31], v[112:115], v[136:139], v[28:31]
    v_mfma_f32_16x16x32_bf16 v[32:35], v[112:115], v[144:147], v[32:35]
    ds_read_b128 v[160:163], v215 offset:2048
    v_mfma_f32_16x16x32_bf16 v[36:39], v[120:123], v[128:131], v[36:39]
    v_mfma_f32_16x16x32_bf16 v[40:43], v[120:123], v[136:139], v[40:43]
    ds_read_b128 v[168:171], v215 offset:4096
    v_mfma_f32_16x16x32_bf16 v[44:47], v[120:123], v[144:147], v[44:47]
    v_mfma_f32_16x16x32_bf16 v[48:51], v[96:99], v[132:135], v[48:51]
    ds_read_b128 v[176:179], v215 offset:6144
    v_mfma_f32_16x16x32_bf16 v[52:55], v[96:99], v[140:143], v[52:55]
    v_mfma_f32_16x16x32_bf16 v[56:59], v[96:99], v[148:151], v[56:59]
    ds_read_b128 v[188:191], v212 offset:0
    v_mfma_f32_16x16x32_bf16 v[60:63], v[104:107], v[132:135], v[60:63]
    v_mfma_f32_16x16x32_bf16 v[64:67], v[104:107], v[140:143], v[64:67]
    ds_read_b128 v[196:199], v212 offset:2048
    v_mfma_f32_16x16x32_bf16 v[68:71], v[104:107], v[148:151], v[68:71]
    v_mfma_f32_16x16x32_bf16 v[72:75], v[112:115], v[132:135], v[72:75]
    ds_read_b128 v[204:207], v212 offset:4096
    v_mfma_f32_16x16x32_bf16 v[76:79], v[112:115], v[140:143], v[76:79]
    v_mfma_f32_16x16x32_bf16 v[80:83], v[112:115], v[148:151], v[80:83]
    ds_read_b128 v[156:159], v215 offset:1024
    v_mfma_f32_16x16x32_bf16 v[84:87], v[120:123], v[132:135], v[84:87]
    v_mfma_f32_16x16x32_bf16 v[88:91], v[120:123], v[140:143], v[88:91]
    ds_read_b128 v[164:167], v215 offset:3072
    v_mfma_f32_16x16x32_bf16 v[92:95], v[120:123], v[148:151], v[92:95]
    v_mfma_f32_16x16x32_bf16 v[48:51], v[100:103], v[128:131], v[48:51]
    ds_read_b128 v[172:175], v215 offset:5120
    v_xor_b32 v132, s34, v132
    v_xor_b32 v133, s34, v133
    v_mfma_f32_16x16x32_bf16 v[52:55], v[100:103], v[136:139], v[52:55]
    v_xor_b32 v134, s34, v134
    v_xor_b32 v135, s34, v135
    v_mfma_f32_16x16x32_bf16 v[56:59], v[100:103], v[144:147], v[56:59]
    ds_read_b128 v[180:183], v215 offset:7168
    v_xor_b32 v140, s34, v140
    v_xor_b32 v141, s34, v141
    v_mfma_f32_16x16x32_bf16 v[60:63], v[108:111], v[128:131], v[60:63]
    v_xor_b32 v142, s34, v142
    v_xor_b32 v143, s34, v143
    v_mfma_f32_16x16x32_bf16 v[64:67], v[108:111], v[136:139], v[64:67]
    v_xor_b32 v148, s34, v148
    v_xor_b32 v149, s34, v149
    v_mfma_f32_16x16x32_bf16 v[68:71], v[108:111], v[144:147], v[68:71]
    v_xor_b32 v150, s34, v150
    v_xor_b32 v151, s34, v151
    v_mfma_f32_16x16x32_bf16 v[72:75], v[116:119], v[128:131], v[72:75]
    v_mfma_f32_16x16x32_bf16 v[76:79], v[116:119], v[136:139], v[76:79]
    v_mfma_f32_16x16x32_bf16 v[80:83], v[116:119], v[144:147], v[80:83]
    v_mfma_f32_16x16x32_bf16 v[84:87], v[124:127], v[128:131], v[84:87]
    v_mfma_f32_16x16x32_bf16 v[88:91], v[124:127], v[136:139], v[88:91]
    v_mfma_f32_16x16x32_bf16 v[92:95], v[124:127], v[144:147], v[92:95]
    v_mfma_f32_16x16x32_bf16 v[0:3], v[100:103], v[132:135], v[0:3]
    v_mfma_f32_16x16x32_bf16 v[4:7], v[100:103], v[140:143], v[4:7]
    v_mfma_f32_16x16x32_bf16 v[8:11], v[100:103], v[148:151], v[8:11]
    v_mfma_f32_16x16x32_bf16 v[12:15], v[108:111], v[132:135], v[12:15]
    v_mfma_f32_16x16x32_bf16 v[16:19], v[108:111], v[140:143], v[16:19]
    s_waitcnt lgkmcnt(0)
    s_barrier
    v_mfma_f32_16x16x32_bf16 v[20:23], v[108:111], v[148:151], v[20:23]
    v_mfma_f32_16x16x32_bf16 v[24:27], v[116:119], v[132:135], v[24:27]
    v_mfma_f32_16x16x32_bf16 v[28:31], v[116:119], v[140:143], v[28:31]
    v_mfma_f32_16x16x32_bf16 v[32:35], v[116:119], v[148:151], v[32:35]
    v_mfma_f32_16x16x32_bf16 v[36:39], v[124:127], v[132:135], v[36:39]
    v_mfma_f32_16x16x32_bf16 v[40:43], v[124:127], v[140:143], v[40:43]
    v_mfma_f32_16x16x32_bf16 v[44:47], v[124:127], v[148:151], v[44:47]
    v_mfma_f32_16x16x32_bf16 v[0:3], v[152:155], v[184:187], v[0:3]
    ds_read_b128 v[96:99], v215 offset:28672
    v_mfma_f32_16x16x32_bf16 v[4:7], v[152:155], v[192:195], v[4:7]
    v_mfma_f32_16x16x32_bf16 v[8:11], v[152:155], v[200:203], v[8:11]
    ds_read_b128 v[128:131], v209 offset:28672
    v_mfma_f32_16x16x32_bf16 v[12:15], v[160:163], v[184:187], v[12:15]
    v_mfma_f32_16x16x32_bf16 v[16:19], v[160:163], v[192:195], v[16:19]
    ds_read_b128 v[136:139], v209 offset:30720
    v_mfma_f32_16x16x32_bf16 v[20:23], v[160:163], v[200:203], v[20:23]
    v_mfma_f32_16x16x32_bf16 v[24:27], v[168:171], v[184:187], v[24:27]
    ds_read_b128 v[144:147], v209 offset:32768
    v_mfma_f32_16x16x32_bf16 v[28:31], v[168:171], v[192:195], v[28:31]
    v_mfma_f32_16x16x32_bf16 v[32:35], v[168:171], v[200:203], v[32:35]
    ds_read_b128 v[104:107], v215 offset:30720
    v_mfma_f32_16x16x32_bf16 v[36:39], v[176:179], v[184:187], v[36:39]
    v_mfma_f32_16x16x32_bf16 v[40:43], v[176:179], v[192:195], v[40:43]
    ds_read_b128 v[112:115], v215 offset:32768
    v_mfma_f32_16x16x32_bf16 v[44:47], v[176:179], v[200:203], v[44:47]
    v_mfma_f32_16x16x32_bf16 v[48:51], v[152:155], v[188:191], v[48:51]
    ds_read_b128 v[120:123], v215 offset:34816
    v_mfma_f32_16x16x32_bf16 v[52:55], v[152:155], v[196:199], v[52:55]
    v_mfma_f32_16x16x32_bf16 v[56:59], v[152:155], v[204:207], v[56:59]
    ds_read_b128 v[132:135], v212 offset:28672
    v_mfma_f32_16x16x32_bf16 v[60:63], v[160:163], v[188:191], v[60:63]
    v_mfma_f32_16x16x32_bf16 v[64:67], v[160:163], v[196:199], v[64:67]
    ds_read_b128 v[140:143], v212 offset:30720
    v_mfma_f32_16x16x32_bf16 v[68:71], v[160:163], v[204:207], v[68:71]
    v_mfma_f32_16x16x32_bf16 v[72:75], v[168:171], v[188:191], v[72:75]
    ds_read_b128 v[148:151], v212 offset:32768
    v_mfma_f32_16x16x32_bf16 v[76:79], v[168:171], v[196:199], v[76:79]
    v_mfma_f32_16x16x32_bf16 v[80:83], v[168:171], v[204:207], v[80:83]
    ds_read_b128 v[100:103], v215 offset:29696
    v_mfma_f32_16x16x32_bf16 v[84:87], v[176:179], v[188:191], v[84:87]
    v_mfma_f32_16x16x32_bf16 v[88:91], v[176:179], v[196:199], v[88:91]
    ds_read_b128 v[108:111], v215 offset:31744
    v_mfma_f32_16x16x32_bf16 v[92:95], v[176:179], v[204:207], v[92:95]
    v_mfma_f32_16x16x32_bf16 v[48:51], v[156:159], v[184:187], v[48:51]
    ds_read_b128 v[116:119], v215 offset:33792
    v_xor_b32 v188, s34, v188
    v_xor_b32 v189, s34, v189
    v_mfma_f32_16x16x32_bf16 v[52:55], v[156:159], v[192:195], v[52:55]
    v_xor_b32 v190, s34, v190
    v_xor_b32 v191, s34, v191
    v_mfma_f32_16x16x32_bf16 v[56:59], v[156:159], v[200:203], v[56:59]
    ds_read_b128 v[124:127], v215 offset:35840
    v_xor_b32 v196, s34, v196
    v_xor_b32 v197, s34, v197
    v_mfma_f32_16x16x32_bf16 v[60:63], v[164:167], v[184:187], v[60:63]
    v_xor_b32 v198, s34, v198
    v_xor_b32 v199, s34, v199
    v_mfma_f32_16x16x32_bf16 v[64:67], v[164:167], v[192:195], v[64:67]
    v_xor_b32 v204, s34, v204
    v_xor_b32 v205, s34, v205
    v_mfma_f32_16x16x32_bf16 v[68:71], v[164:167], v[200:203], v[68:71]
    v_xor_b32 v206, s34, v206
    v_xor_b32 v207, s34, v207
    v_mfma_f32_16x16x32_bf16 v[72:75], v[172:175], v[184:187], v[72:75]
    v_mfma_f32_16x16x32_bf16 v[76:79], v[172:175], v[192:195], v[76:79]
    v_mfma_f32_16x16x32_bf16 v[80:83], v[172:175], v[200:203], v[80:83]
    v_mfma_f32_16x16x32_bf16 v[84:87], v[180:183], v[184:187], v[84:87]
    v_mfma_f32_16x16x32_bf16 v[88:91], v[180:183], v[192:195], v[88:91]
    v_mfma_f32_16x16x32_bf16 v[92:95], v[180:183], v[200:203], v[92:95]
    v_mfma_f32_16x16x32_bf16 v[0:3], v[156:159], v[188:191], v[0:3]
    v_mfma_f32_16x16x32_bf16 v[4:7], v[156:159], v[196:199], v[4:7]
    v_mfma_f32_16x16x32_bf16 v[8:11], v[156:159], v[204:207], v[8:11]
    v_mfma_f32_16x16x32_bf16 v[12:15], v[164:167], v[188:191], v[12:15]
    v_mfma_f32_16x16x32_bf16 v[16:19], v[164:167], v[196:199], v[16:19]
    s_waitcnt lgkmcnt(0)
    s_barrier
    v_mfma_f32_16x16x32_bf16 v[20:23], v[164:167], v[204:207], v[20:23]
    v_mfma_f32_16x16x32_bf16 v[24:27], v[172:175], v[188:191], v[24:27]
    v_mfma_f32_16x16x32_bf16 v[28:31], v[172:175], v[196:199], v[28:31]
    v_mfma_f32_16x16x32_bf16 v[32:35], v[172:175], v[204:207], v[32:35]
    v_mfma_f32_16x16x32_bf16 v[36:39], v[180:183], v[188:191], v[36:39]
    v_mfma_f32_16x16x32_bf16 v[40:43], v[180:183], v[196:199], v[40:43]
    v_mfma_f32_16x16x32_bf16 v[44:47], v[180:183], v[204:207], v[44:47]
    v_mfma_f32_16x16x32_bf16 v[0:3], v[96:99], v[128:131], v[0:3]
    ds_read_b128 v[152:155], v216 offset:0
    v_mfma_f32_16x16x32_bf16 v[4:7], v[96:99], v[136:139], v[4:7]
    v_mfma_f32_16x16x32_bf16 v[8:11], v[96:99], v[144:147], v[8:11]
    ds_read_b128 v[184:187], v210 offset:0
    v_mfma_f32_16x16x32_bf16 v[12:15], v[104:107], v[128:131], v[12:15]
    v_mfma_f32_16x16x32_bf16 v[16:19], v[104:107], v[136:139], v[16:19]
    ds_read_b128 v[192:195], v210 offset:2048
    v_mfma_f32_16x16x32_bf16 v[20:23], v[104:107], v[144:147], v[20:23]
    v_mfma_f32_16x16x32_bf16 v[24:27], v[112:115], v[128:131], v[24:27]
    ds_read_b128 v[200:203], v210 offset:4096
    v_mfma_f32_16x16x32_bf16 v[28:31], v[112:115], v[136:139], v[28:31]
    v_mfma_f32_16x16x32_bf16 v[32:35], v[112:115], v[144:147], v[32:35]
    ds_read_b128 v[160:163], v216 offset:2048
    v_mfma_f32_16x16x32_bf16 v[36:39], v[120:123], v[128:131], v[36:39]
    v_mfma_f32_16x16x32_bf16 v[40:43], v[120:123], v[136:139], v[40:43]
    ds_read_b128 v[168:171], v216 offset:4096
    v_mfma_f32_16x16x32_bf16 v[44:47], v[120:123], v[144:147], v[44:47]
    v_mfma_f32_16x16x32_bf16 v[48:51], v[96:99], v[132:135], v[48:51]
    ds_read_b128 v[176:179], v216 offset:6144
    v_mfma_f32_16x16x32_bf16 v[52:55], v[96:99], v[140:143], v[52:55]
    v_mfma_f32_16x16x32_bf16 v[56:59], v[96:99], v[148:151], v[56:59]
    ds_read_b128 v[188:191], v213 offset:0
    v_mfma_f32_16x16x32_bf16 v[60:63], v[104:107], v[132:135], v[60:63]
    v_mfma_f32_16x16x32_bf16 v[64:67], v[104:107], v[140:143], v[64:67]
    ds_read_b128 v[196:199], v213 offset:2048
    v_mfma_f32_16x16x32_bf16 v[68:71], v[104:107], v[148:151], v[68:71]
    v_mfma_f32_16x16x32_bf16 v[72:75], v[112:115], v[132:135], v[72:75]
    ds_read_b128 v[204:207], v213 offset:4096
    v_mfma_f32_16x16x32_bf16 v[76:79], v[112:115], v[140:143], v[76:79]
    v_mfma_f32_16x16x32_bf16 v[80:83], v[112:115], v[148:151], v[80:83]
    ds_read_b128 v[156:159], v216 offset:1024
    v_mfma_f32_16x16x32_bf16 v[84:87], v[120:123], v[132:135], v[84:87]
    v_mfma_f32_16x16x32_bf16 v[88:91], v[120:123], v[140:143], v[88:91]
    ds_read_b128 v[164:167], v216 offset:3072
    v_mfma_f32_16x16x32_bf16 v[92:95], v[120:123], v[148:151], v[92:95]
    v_mfma_f32_16x16x32_bf16 v[48:51], v[100:103], v[128:131], v[48:51]
    ds_read_b128 v[172:175], v216 offset:5120
    v_xor_b32 v132, s34, v132
    v_xor_b32 v133, s34, v133
    v_mfma_f32_16x16x32_bf16 v[52:55], v[100:103], v[136:139], v[52:55]
    v_xor_b32 v134, s34, v134
    v_xor_b32 v135, s34, v135
    v_mfma_f32_16x16x32_bf16 v[56:59], v[100:103], v[144:147], v[56:59]
    ds_read_b128 v[180:183], v216 offset:7168
    v_xor_b32 v140, s34, v140
    v_xor_b32 v141, s34, v141
    v_mfma_f32_16x16x32_bf16 v[60:63], v[108:111], v[128:131], v[60:63]
    v_xor_b32 v142, s34, v142
    v_xor_b32 v143, s34, v143
    v_mfma_f32_16x16x32_bf16 v[64:67], v[108:111], v[136:139], v[64:67]
    v_xor_b32 v148, s34, v148
    v_xor_b32 v149, s34, v149
    v_mfma_f32_16x16x32_bf16 v[68:71], v[108:111], v[144:147], v[68:71]
    v_xor_b32 v150, s34, v150
    v_xor_b32 v151, s34, v151
    v_mfma_f32_16x16x32_bf16 v[72:75], v[116:119], v[128:131], v[72:75]
    v_mfma_f32_16x16x32_bf16 v[76:79], v[116:119], v[136:139], v[76:79]
    v_mfma_f32_16x16x32_bf16 v[80:83], v[116:119], v[144:147], v[80:83]
    v_mfma_f32_16x16x32_bf16 v[84:87], v[124:127], v[128:131], v[84:87]
    v_mfma_f32_16x16x32_bf16 v[88:91], v[124:127], v[136:139], v[88:91]
    v_mfma_f32_16x16x32_bf16 v[92:95], v[124:127], v[144:147], v[92:95]
    v_mfma_f32_16x16x32_bf16 v[0:3], v[100:103], v[132:135], v[0:3]
    v_mfma_f32_16x16x32_bf16 v[4:7], v[100:103], v[140:143], v[4:7]
    v_mfma_f32_16x16x32_bf16 v[8:11], v[100:103], v[148:151], v[8:11]
    v_mfma_f32_16x16x32_bf16 v[12:15], v[108:111], v[132:135], v[12:15]
    v_mfma_f32_16x16x32_bf16 v[16:19], v[108:111], v[140:143], v[16:19]
    s_waitcnt lgkmcnt(0)
    s_barrier
    v_mfma_f32_16x16x32_bf16 v[20:23], v[108:111], v[148:151], v[20:23]
    v_mfma_f32_16x16x32_bf16 v[24:27], v[116:119], v[132:135], v[24:27]
    v_mfma_f32_16x16x32_bf16 v[28:31], v[116:119], v[140:143], v[28:31]
    v_mfma_f32_16x16x32_bf16 v[32:35], v[116:119], v[148:151], v[32:35]
    v_mfma_f32_16x16x32_bf16 v[36:39], v[124:127], v[132:135], v[36:39]
    v_mfma_f32_16x16x32_bf16 v[40:43], v[124:127], v[140:143], v[40:43]
    v_mfma_f32_16x16x32_bf16 v[44:47], v[124:127], v[148:151], v[44:47]
    v_mfma_f32_16x16x32_bf16 v[0:3], v[152:155], v[184:187], v[0:3]
    ds_read_b128 v[96:99], v214 offset:0
    v_mfma_f32_16x16x32_bf16 v[4:7], v[152:155], v[192:195], v[4:7]
    v_mfma_f32_16x16x32_bf16 v[8:11], v[152:155], v[200:203], v[8:11]
    ds_read_b128 v[128:131], v208 offset:0
    v_mfma_f32_16x16x32_bf16 v[12:15], v[160:163], v[184:187], v[12:15]
    v_mfma_f32_16x16x32_bf16 v[16:19], v[160:163], v[192:195], v[16:19]
    ds_read_b128 v[136:139], v208 offset:2048
    v_mfma_f32_16x16x32_bf16 v[20:23], v[160:163], v[200:203], v[20:23]
    v_mfma_f32_16x16x32_bf16 v[24:27], v[168:171], v[184:187], v[24:27]
    ds_read_b128 v[144:147], v208 offset:4096
    v_mfma_f32_16x16x32_bf16 v[28:31], v[168:171], v[192:195], v[28:31]
    v_mfma_f32_16x16x32_bf16 v[32:35], v[168:171], v[200:203], v[32:35]
    ds_read_b128 v[104:107], v214 offset:2048
    v_mfma_f32_16x16x32_bf16 v[36:39], v[176:179], v[184:187], v[36:39]
    v_mfma_f32_16x16x32_bf16 v[40:43], v[176:179], v[192:195], v[40:43]
    ds_read_b128 v[112:115], v214 offset:4096
    v_mfma_f32_16x16x32_bf16 v[44:47], v[176:179], v[200:203], v[44:47]
    v_mfma_f32_16x16x32_bf16 v[48:51], v[152:155], v[188:191], v[48:51]
    ds_read_b128 v[120:123], v214 offset:6144
    v_mfma_f32_16x16x32_bf16 v[52:55], v[152:155], v[196:199], v[52:55]
    v_mfma_f32_16x16x32_bf16 v[56:59], v[152:155], v[204:207], v[56:59]
    ds_read_b128 v[132:135], v211 offset:0
    v_mfma_f32_16x16x32_bf16 v[60:63], v[160:163], v[188:191], v[60:63]
    v_mfma_f32_16x16x32_bf16 v[64:67], v[160:163], v[196:199], v[64:67]
    ds_read_b128 v[140:143], v211 offset:2048
    v_mfma_f32_16x16x32_bf16 v[68:71], v[160:163], v[204:207], v[68:71]
    v_mfma_f32_16x16x32_bf16 v[72:75], v[168:171], v[188:191], v[72:75]
    ds_read_b128 v[148:151], v211 offset:4096
    v_mfma_f32_16x16x32_bf16 v[76:79], v[168:171], v[196:199], v[76:79]
    v_mfma_f32_16x16x32_bf16 v[80:83], v[168:171], v[204:207], v[80:83]
    ds_read_b128 v[100:103], v214 offset:1024
    v_mfma_f32_16x16x32_bf16 v[84:87], v[176:179], v[188:191], v[84:87]
    v_mfma_f32_16x16x32_bf16 v[88:91], v[176:179], v[196:199], v[88:91]
    ds_read_b128 v[108:111], v214 offset:3072
    v_mfma_f32_16x16x32_bf16 v[92:95], v[176:179], v[204:207], v[92:95]
    v_mfma_f32_16x16x32_bf16 v[48:51], v[156:159], v[184:187], v[48:51]
    ds_read_b128 v[116:119], v214 offset:5120
    v_xor_b32 v188, s34, v188
    v_xor_b32 v189, s34, v189
    v_mfma_f32_16x16x32_bf16 v[52:55], v[156:159], v[192:195], v[52:55]
    v_xor_b32 v190, s34, v190
    v_xor_b32 v191, s34, v191
    v_mfma_f32_16x16x32_bf16 v[56:59], v[156:159], v[200:203], v[56:59]
    ds_read_b128 v[124:127], v214 offset:7168
    v_xor_b32 v196, s34, v196
    v_xor_b32 v197, s34, v197
    v_mfma_f32_16x16x32_bf16 v[60:63], v[164:167], v[184:187], v[60:63]
    v_xor_b32 v198, s34, v198
    v_xor_b32 v199, s34, v199
    v_mfma_f32_16x16x32_bf16 v[64:67], v[164:167], v[192:195], v[64:67]
    v_xor_b32 v204, s34, v204
    v_xor_b32 v205, s34, v205
    v_mfma_f32_16x16x32_bf16 v[68:71], v[164:167], v[200:203], v[68:71]
    v_xor_b32 v206, s34, v206
    v_xor_b32 v207, s34, v207
    v_mfma_f32_16x16x32_bf16 v[72:75], v[172:175], v[184:187], v[72:75]
    v_mfma_f32_16x16x32_bf16 v[76:79], v[172:175], v[192:195], v[76:79]
    v_mfma_f32_16x16x32_bf16 v[80:83], v[172:175], v[200:203], v[80:83]
    v_mfma_f32_16x16x32_bf16 v[84:87], v[180:183], v[184:187], v[84:87]
    v_mfma_f32_16x16x32_bf16 v[88:91], v[180:183], v[192:195], v[88:91]
    v_mfma_f32_16x16x32_bf16 v[92:95], v[180:183], v[200:203], v[92:95]
    v_mfma_f32_16x16x32_bf16 v[0:3], v[156:159], v[188:191], v[0:3]
    v_mfma_f32_16x16x32_bf16 v[4:7], v[156:159], v[196:199], v[4:7]
    v_mfma_f32_16x16x32_bf16 v[8:11], v[156:159], v[204:207], v[8:11]
    v_mfma_f32_16x16x32_bf16 v[12:15], v[164:167], v[188:191], v[12:15]
    v_mfma_f32_16x16x32_bf16 v[16:19], v[164:167], v[196:199], v[16:19]
    s_waitcnt lgkmcnt(0)
    s_barrier
    v_mfma_f32_16x16x32_bf16 v[20:23], v[164:167], v[204:207], v[20:23]
    v_mfma_f32_16x16x32_bf16 v[24:27], v[172:175], v[188:191], v[24:27]
    v_mfma_f32_16x16x32_bf16 v[28:31], v[172:175], v[196:199], v[28:31]
    v_mfma_f32_16x16x32_bf16 v[32:35], v[172:175], v[204:207], v[32:35]
    v_mfma_f32_16x16x32_bf16 v[36:39], v[180:183], v[188:191], v[36:39]
    v_mfma_f32_16x16x32_bf16 v[40:43], v[180:183], v[196:199], v[40:43]
    v_mfma_f32_16x16x32_bf16 v[44:47], v[180:183], v[204:207], v[44:47]
    v_mfma_f32_16x16x32_bf16 v[0:3], v[96:99], v[128:131], v[0:3]
    ds_read_b128 v[152:155], v214 offset:28672
    v_mfma_f32_16x16x32_bf16 v[4:7], v[96:99], v[136:139], v[4:7]
    v_mfma_f32_16x16x32_bf16 v[8:11], v[96:99], v[144:147], v[8:11]
    ds_read_b128 v[184:187], v208 offset:28672
    v_mfma_f32_16x16x32_bf16 v[12:15], v[104:107], v[128:131], v[12:15]
    v_mfma_f32_16x16x32_bf16 v[16:19], v[104:107], v[136:139], v[16:19]
    ds_read_b128 v[192:195], v208 offset:30720
    v_mfma_f32_16x16x32_bf16 v[20:23], v[104:107], v[144:147], v[20:23]
    v_mfma_f32_16x16x32_bf16 v[24:27], v[112:115], v[128:131], v[24:27]
    ds_read_b128 v[200:203], v208 offset:32768
    v_mfma_f32_16x16x32_bf16 v[28:31], v[112:115], v[136:139], v[28:31]
    v_mfma_f32_16x16x32_bf16 v[32:35], v[112:115], v[144:147], v[32:35]
    ds_read_b128 v[160:163], v214 offset:30720
    v_mfma_f32_16x16x32_bf16 v[36:39], v[120:123], v[128:131], v[36:39]
    v_mfma_f32_16x16x32_bf16 v[40:43], v[120:123], v[136:139], v[40:43]
    ds_read_b128 v[168:171], v214 offset:32768
    v_mfma_f32_16x16x32_bf16 v[44:47], v[120:123], v[144:147], v[44:47]
    v_mfma_f32_16x16x32_bf16 v[48:51], v[96:99], v[132:135], v[48:51]
    ds_read_b128 v[176:179], v214 offset:34816
    v_mfma_f32_16x16x32_bf16 v[52:55], v[96:99], v[140:143], v[52:55]
    v_mfma_f32_16x16x32_bf16 v[56:59], v[96:99], v[148:151], v[56:59]
    ds_read_b128 v[188:191], v211 offset:28672
    v_mfma_f32_16x16x32_bf16 v[60:63], v[104:107], v[132:135], v[60:63]
    v_mfma_f32_16x16x32_bf16 v[64:67], v[104:107], v[140:143], v[64:67]
    ds_read_b128 v[196:199], v211 offset:30720
    v_mfma_f32_16x16x32_bf16 v[68:71], v[104:107], v[148:151], v[68:71]
    v_mfma_f32_16x16x32_bf16 v[72:75], v[112:115], v[132:135], v[72:75]
    ds_read_b128 v[204:207], v211 offset:32768
    v_mfma_f32_16x16x32_bf16 v[76:79], v[112:115], v[140:143], v[76:79]
    v_mfma_f32_16x16x32_bf16 v[80:83], v[112:115], v[148:151], v[80:83]
    ds_read_b128 v[156:159], v214 offset:29696
    v_mfma_f32_16x16x32_bf16 v[84:87], v[120:123], v[132:135], v[84:87]
    v_mfma_f32_16x16x32_bf16 v[88:91], v[120:123], v[140:143], v[88:91]
    ds_read_b128 v[164:167], v214 offset:31744
    v_mfma_f32_16x16x32_bf16 v[92:95], v[120:123], v[148:151], v[92:95]
    v_mfma_f32_16x16x32_bf16 v[48:51], v[100:103], v[128:131], v[48:51]
    ds_read_b128 v[172:175], v214 offset:33792
    v_xor_b32 v132, s34, v132
    v_xor_b32 v133, s34, v133
    v_mfma_f32_16x16x32_bf16 v[52:55], v[100:103], v[136:139], v[52:55]
    v_xor_b32 v134, s34, v134
    v_xor_b32 v135, s34, v135
    v_mfma_f32_16x16x32_bf16 v[56:59], v[100:103], v[144:147], v[56:59]
    ds_read_b128 v[180:183], v214 offset:35840
    v_xor_b32 v140, s34, v140
    v_xor_b32 v141, s34, v141
    v_mfma_f32_16x16x32_bf16 v[60:63], v[108:111], v[128:131], v[60:63]
    v_xor_b32 v142, s34, v142
    v_xor_b32 v143, s34, v143
    v_mfma_f32_16x16x32_bf16 v[64:67], v[108:111], v[136:139], v[64:67]
    v_xor_b32 v148, s34, v148
    v_xor_b32 v149, s34, v149
    v_mfma_f32_16x16x32_bf16 v[68:71], v[108:111], v[144:147], v[68:71]
    v_xor_b32 v150, s34, v150
    v_xor_b32 v151, s34, v151
    v_mfma_f32_16x16x32_bf16 v[72:75], v[116:119], v[128:131], v[72:75]
    v_mfma_f32_16x16x32_bf16 v[76:79], v[116:119], v[136:139], v[76:79]
    v_mfma_f32_16x16x32_bf16 v[80:83], v[116:119], v[144:147], v[80:83]
    v_mfma_f32_16x16x32_bf16 v[84:87], v[124:127], v[128:131], v[84:87]
    v_mfma_f32_16x16x32_bf16 v[88:91], v[124:127], v[136:139], v[88:91]
    v_mfma_f32_16x16x32_bf16 v[92:95], v[124:127], v[144:147], v[92:95]
    v_mfma_f32_16x16x32_bf16 v[0:3], v[100:103], v[132:135], v[0:3]
    v_mfma_f32_16x16x32_bf16 v[4:7], v[100:103], v[140:143], v[4:7]
    v_mfma_f32_16x16x32_bf16 v[8:11], v[100:103], v[148:151], v[8:11]
    v_mfma_f32_16x16x32_bf16 v[12:15], v[108:111], v[132:135], v[12:15]
    v_mfma_f32_16x16x32_bf16 v[16:19], v[108:111], v[140:143], v[16:19]
    s_waitcnt lgkmcnt(0)
    s_barrier
    v_mfma_f32_16x16x32_bf16 v[20:23], v[108:111], v[148:151], v[20:23]
    v_mfma_f32_16x16x32_bf16 v[24:27], v[116:119], v[132:135], v[24:27]
    v_mfma_f32_16x16x32_bf16 v[28:31], v[116:119], v[140:143], v[28:31]
    v_mfma_f32_16x16x32_bf16 v[32:35], v[116:119], v[148:151], v[32:35]
    v_mfma_f32_16x16x32_bf16 v[36:39], v[124:127], v[132:135], v[36:39]
    v_mfma_f32_16x16x32_bf16 v[40:43], v[124:127], v[140:143], v[40:43]
    v_mfma_f32_16x16x32_bf16 v[44:47], v[124:127], v[148:151], v[44:47]
    v_mfma_f32_16x16x32_bf16 v[0:3], v[152:155], v[184:187], v[0:3]
    ds_read_b128 v[96:99], v215 offset:0
    v_mfma_f32_16x16x32_bf16 v[4:7], v[152:155], v[192:195], v[4:7]
    v_mfma_f32_16x16x32_bf16 v[8:11], v[152:155], v[200:203], v[8:11]
    ds_read_b128 v[128:131], v209 offset:0
    v_mfma_f32_16x16x32_bf16 v[12:15], v[160:163], v[184:187], v[12:15]
    v_mfma_f32_16x16x32_bf16 v[16:19], v[160:163], v[192:195], v[16:19]
    ds_read_b128 v[136:139], v209 offset:2048
    v_mfma_f32_16x16x32_bf16 v[20:23], v[160:163], v[200:203], v[20:23]
    v_mfma_f32_16x16x32_bf16 v[24:27], v[168:171], v[184:187], v[24:27]
    ds_read_b128 v[144:147], v209 offset:4096
    v_mfma_f32_16x16x32_bf16 v[28:31], v[168:171], v[192:195], v[28:31]
    v_mfma_f32_16x16x32_bf16 v[32:35], v[168:171], v[200:203], v[32:35]
    ds_read_b128 v[104:107], v215 offset:2048
    v_mfma_f32_16x16x32_bf16 v[36:39], v[176:179], v[184:187], v[36:39]
    v_mfma_f32_16x16x32_bf16 v[40:43], v[176:179], v[192:195], v[40:43]
    ds_read_b128 v[112:115], v215 offset:4096
    v_mfma_f32_16x16x32_bf16 v[44:47], v[176:179], v[200:203], v[44:47]
    v_mfma_f32_16x16x32_bf16 v[48:51], v[152:155], v[188:191], v[48:51]
    ds_read_b128 v[120:123], v215 offset:6144
    v_mfma_f32_16x16x32_bf16 v[52:55], v[152:155], v[196:199], v[52:55]
    v_mfma_f32_16x16x32_bf16 v[56:59], v[152:155], v[204:207], v[56:59]
    ds_read_b128 v[132:135], v212 offset:0
    v_mfma_f32_16x16x32_bf16 v[60:63], v[160:163], v[188:191], v[60:63]
    v_mfma_f32_16x16x32_bf16 v[64:67], v[160:163], v[196:199], v[64:67]
    ds_read_b128 v[140:143], v212 offset:2048
    v_mfma_f32_16x16x32_bf16 v[68:71], v[160:163], v[204:207], v[68:71]
    v_mfma_f32_16x16x32_bf16 v[72:75], v[168:171], v[188:191], v[72:75]
    ds_read_b128 v[148:151], v212 offset:4096
    v_mfma_f32_16x16x32_bf16 v[76:79], v[168:171], v[196:199], v[76:79]
    v_mfma_f32_16x16x32_bf16 v[80:83], v[168:171], v[204:207], v[80:83]
    ds_read_b128 v[100:103], v215 offset:1024
    v_mfma_f32_16x16x32_bf16 v[84:87], v[176:179], v[188:191], v[84:87]
    v_mfma_f32_16x16x32_bf16 v[88:91], v[176:179], v[196:199], v[88:91]
    ds_read_b128 v[108:111], v215 offset:3072
    v_mfma_f32_16x16x32_bf16 v[92:95], v[176:179], v[204:207], v[92:95]
    v_mfma_f32_16x16x32_bf16 v[48:51], v[156:159], v[184:187], v[48:51]
    ds_read_b128 v[116:119], v215 offset:5120
    v_xor_b32 v188, s34, v188
    v_xor_b32 v189, s34, v189
    v_mfma_f32_16x16x32_bf16 v[52:55], v[156:159], v[192:195], v[52:55]
    v_xor_b32 v190, s34, v190
    v_xor_b32 v191, s34, v191
    v_mfma_f32_16x16x32_bf16 v[56:59], v[156:159], v[200:203], v[56:59]
    ds_read_b128 v[124:127], v215 offset:7168
    v_xor_b32 v196, s34, v196
    v_xor_b32 v197, s34, v197
    v_mfma_f32_16x16x32_bf16 v[60:63], v[164:167], v[184:187], v[60:63]
    v_xor_b32 v198, s34, v198
    v_xor_b32 v199, s34, v199
    v_mfma_f32_16x16x32_bf16 v[64:67], v[164:167], v[192:195], v[64:67]
    v_xor_b32 v204, s34, v204
    v_xor_b32 v205, s34, v205
    v_mfma_f32_16x16x32_bf16 v[68:71], v[164:167], v[200:203], v[68:71]
    v_xor_b32 v206, s34, v206
    v_xor_b32 v207, s34, v207
    v_mfma_f32_16x16x32_bf16 v[72:75], v[172:175], v[184:187], v[72:75]
    v_mfma_f32_16x16x32_bf16 v[76:79], v[172:175], v[192:195], v[76:79]
    v_mfma_f32_16x16x32_bf16 v[80:83], v[172:175], v[200:203], v[80:83]
    v_mfma_f32_16x16x32_bf16 v[84:87], v[180:183], v[184:187], v[84:87]
    v_mfma_f32_16x16x32_bf16 v[88:91], v[180:183], v[192:195], v[88:91]
    v_mfma_f32_16x16x32_bf16 v[92:95], v[180:183], v[200:203], v[92:95]
    v_mfma_f32_16x16x32_bf16 v[0:3], v[156:159], v[188:191], v[0:3]
    v_mfma_f32_16x16x32_bf16 v[4:7], v[156:159], v[196:199], v[4:7]
    v_mfma_f32_16x16x32_bf16 v[8:11], v[156:159], v[204:207], v[8:11]
    v_mfma_f32_16x16x32_bf16 v[12:15], v[164:167], v[188:191], v[12:15]
    v_mfma_f32_16x16x32_bf16 v[16:19], v[164:167], v[196:199], v[16:19]
    s_waitcnt lgkmcnt(0)
    s_barrier
    v_mfma_f32_16x16x32_bf16 v[20:23], v[164:167], v[204:207], v[20:23]
    v_mfma_f32_16x16x32_bf16 v[24:27], v[172:175], v[188:191], v[24:27]
    v_mfma_f32_16x16x32_bf16 v[28:31], v[172:175], v[196:199], v[28:31]
    v_mfma_f32_16x16x32_bf16 v[32:35], v[172:175], v[204:207], v[32:35]
    v_mfma_f32_16x16x32_bf16 v[36:39], v[180:183], v[188:191], v[36:39]
    v_mfma_f32_16x16x32_bf16 v[40:43], v[180:183], v[196:199], v[40:43]
    v_mfma_f32_16x16x32_bf16 v[44:47], v[180:183], v[204:207], v[44:47]
    v_mfma_f32_16x16x32_bf16 v[0:3], v[96:99], v[128:131], v[0:3]
    ds_read_b128 v[152:155], v215 offset:28672
    v_mfma_f32_16x16x32_bf16 v[4:7], v[96:99], v[136:139], v[4:7]
    v_mfma_f32_16x16x32_bf16 v[8:11], v[96:99], v[144:147], v[8:11]
    ds_read_b128 v[184:187], v209 offset:28672
    v_mfma_f32_16x16x32_bf16 v[12:15], v[104:107], v[128:131], v[12:15]
    v_mfma_f32_16x16x32_bf16 v[16:19], v[104:107], v[136:139], v[16:19]
    ds_read_b128 v[192:195], v209 offset:30720
    v_mfma_f32_16x16x32_bf16 v[20:23], v[104:107], v[144:147], v[20:23]
    v_mfma_f32_16x16x32_bf16 v[24:27], v[112:115], v[128:131], v[24:27]
    ds_read_b128 v[200:203], v209 offset:32768
    v_mfma_f32_16x16x32_bf16 v[28:31], v[112:115], v[136:139], v[28:31]
    v_mfma_f32_16x16x32_bf16 v[32:35], v[112:115], v[144:147], v[32:35]
    ds_read_b128 v[160:163], v215 offset:30720
    v_mfma_f32_16x16x32_bf16 v[36:39], v[120:123], v[128:131], v[36:39]
    v_mfma_f32_16x16x32_bf16 v[40:43], v[120:123], v[136:139], v[40:43]
    ds_read_b128 v[168:171], v215 offset:32768
    v_mfma_f32_16x16x32_bf16 v[44:47], v[120:123], v[144:147], v[44:47]
    v_mfma_f32_16x16x32_bf16 v[48:51], v[96:99], v[132:135], v[48:51]
    ds_read_b128 v[176:179], v215 offset:34816
    v_mfma_f32_16x16x32_bf16 v[52:55], v[96:99], v[140:143], v[52:55]
    v_mfma_f32_16x16x32_bf16 v[56:59], v[96:99], v[148:151], v[56:59]
    ds_read_b128 v[188:191], v212 offset:28672
    v_mfma_f32_16x16x32_bf16 v[60:63], v[104:107], v[132:135], v[60:63]
    v_mfma_f32_16x16x32_bf16 v[64:67], v[104:107], v[140:143], v[64:67]
    ds_read_b128 v[196:199], v212 offset:30720
    v_mfma_f32_16x16x32_bf16 v[68:71], v[104:107], v[148:151], v[68:71]
    v_mfma_f32_16x16x32_bf16 v[72:75], v[112:115], v[132:135], v[72:75]
    ds_read_b128 v[204:207], v212 offset:32768
    v_mfma_f32_16x16x32_bf16 v[76:79], v[112:115], v[140:143], v[76:79]
    v_mfma_f32_16x16x32_bf16 v[80:83], v[112:115], v[148:151], v[80:83]
    ds_read_b128 v[156:159], v215 offset:29696
    v_mfma_f32_16x16x32_bf16 v[84:87], v[120:123], v[132:135], v[84:87]
    v_mfma_f32_16x16x32_bf16 v[88:91], v[120:123], v[140:143], v[88:91]
    ds_read_b128 v[164:167], v215 offset:31744
    v_mfma_f32_16x16x32_bf16 v[92:95], v[120:123], v[148:151], v[92:95]
    v_mfma_f32_16x16x32_bf16 v[48:51], v[100:103], v[128:131], v[48:51]
    ds_read_b128 v[172:175], v215 offset:33792
    v_xor_b32 v132, s34, v132
    v_xor_b32 v133, s34, v133
    v_mfma_f32_16x16x32_bf16 v[52:55], v[100:103], v[136:139], v[52:55]
    v_xor_b32 v134, s34, v134
    v_xor_b32 v135, s34, v135
    v_mfma_f32_16x16x32_bf16 v[56:59], v[100:103], v[144:147], v[56:59]
    ds_read_b128 v[180:183], v215 offset:35840
    v_xor_b32 v140, s34, v140
    v_xor_b32 v141, s34, v141
    v_mfma_f32_16x16x32_bf16 v[60:63], v[108:111], v[128:131], v[60:63]
    v_xor_b32 v142, s34, v142
    v_xor_b32 v143, s34, v143
    v_mfma_f32_16x16x32_bf16 v[64:67], v[108:111], v[136:139], v[64:67]
    v_xor_b32 v148, s34, v148
    v_xor_b32 v149, s34, v149
    v_mfma_f32_16x16x32_bf16 v[68:71], v[108:111], v[144:147], v[68:71]
    v_xor_b32 v150, s34, v150
    v_xor_b32 v151, s34, v151
    v_mfma_f32_16x16x32_bf16 v[72:75], v[116:119], v[128:131], v[72:75]
    v_mfma_f32_16x16x32_bf16 v[76:79], v[116:119], v[136:139], v[76:79]
    v_mfma_f32_16x16x32_bf16 v[80:83], v[116:119], v[144:147], v[80:83]
    v_mfma_f32_16x16x32_bf16 v[84:87], v[124:127], v[128:131], v[84:87]
    v_mfma_f32_16x16x32_bf16 v[88:91], v[124:127], v[136:139], v[88:91]
    v_mfma_f32_16x16x32_bf16 v[92:95], v[124:127], v[144:147], v[92:95]
    v_mfma_f32_16x16x32_bf16 v[0:3], v[100:103], v[132:135], v[0:3]
    v_mfma_f32_16x16x32_bf16 v[4:7], v[100:103], v[140:143], v[4:7]
    v_mfma_f32_16x16x32_bf16 v[8:11], v[100:103], v[148:151], v[8:11]
    v_mfma_f32_16x16x32_bf16 v[12:15], v[108:111], v[132:135], v[12:15]
    v_mfma_f32_16x16x32_bf16 v[16:19], v[108:111], v[140:143], v[16:19]
    s_waitcnt lgkmcnt(0)
    s_barrier
    v_mfma_f32_16x16x32_bf16 v[20:23], v[108:111], v[148:151], v[20:23]
    v_mfma_f32_16x16x32_bf16 v[24:27], v[116:119], v[132:135], v[24:27]
    v_mfma_f32_16x16x32_bf16 v[28:31], v[116:119], v[140:143], v[28:31]
    v_mfma_f32_16x16x32_bf16 v[32:35], v[116:119], v[148:151], v[32:35]
    v_mfma_f32_16x16x32_bf16 v[36:39], v[124:127], v[132:135], v[36:39]
    v_mfma_f32_16x16x32_bf16 v[40:43], v[124:127], v[140:143], v[40:43]
    v_mfma_f32_16x16x32_bf16 v[44:47], v[124:127], v[148:151], v[44:47]
    v_mfma_f32_16x16x32_bf16 v[0:3], v[152:155], v[184:187], v[0:3]
    ds_read_b128 v[96:99], v216 offset:0
    v_mfma_f32_16x16x32_bf16 v[4:7], v[152:155], v[192:195], v[4:7]
    v_mfma_f32_16x16x32_bf16 v[8:11], v[152:155], v[200:203], v[8:11]
    ds_read_b128 v[128:131], v210 offset:0
    v_mfma_f32_16x16x32_bf16 v[12:15], v[160:163], v[184:187], v[12:15]
    v_mfma_f32_16x16x32_bf16 v[16:19], v[160:163], v[192:195], v[16:19]
    ds_read_b128 v[136:139], v210 offset:2048
    v_mfma_f32_16x16x32_bf16 v[20:23], v[160:163], v[200:203], v[20:23]
    v_mfma_f32_16x16x32_bf16 v[24:27], v[168:171], v[184:187], v[24:27]
    ds_read_b128 v[144:147], v210 offset:4096
    v_mfma_f32_16x16x32_bf16 v[28:31], v[168:171], v[192:195], v[28:31]
    v_mfma_f32_16x16x32_bf16 v[32:35], v[168:171], v[200:203], v[32:35]
    ds_read_b128 v[104:107], v216 offset:2048
    v_mfma_f32_16x16x32_bf16 v[36:39], v[176:179], v[184:187], v[36:39]
    v_mfma_f32_16x16x32_bf16 v[40:43], v[176:179], v[192:195], v[40:43]
    ds_read_b128 v[112:115], v216 offset:4096
    v_mfma_f32_16x16x32_bf16 v[44:47], v[176:179], v[200:203], v[44:47]
    v_mfma_f32_16x16x32_bf16 v[48:51], v[152:155], v[188:191], v[48:51]
    ds_read_b128 v[120:123], v216 offset:6144
    v_mfma_f32_16x16x32_bf16 v[52:55], v[152:155], v[196:199], v[52:55]
    v_mfma_f32_16x16x32_bf16 v[56:59], v[152:155], v[204:207], v[56:59]
    ds_read_b128 v[132:135], v213 offset:0
    v_mfma_f32_16x16x32_bf16 v[60:63], v[160:163], v[188:191], v[60:63]
    v_mfma_f32_16x16x32_bf16 v[64:67], v[160:163], v[196:199], v[64:67]
    ds_read_b128 v[140:143], v213 offset:2048
    v_mfma_f32_16x16x32_bf16 v[68:71], v[160:163], v[204:207], v[68:71]
    v_mfma_f32_16x16x32_bf16 v[72:75], v[168:171], v[188:191], v[72:75]
    ds_read_b128 v[148:151], v213 offset:4096
    v_mfma_f32_16x16x32_bf16 v[76:79], v[168:171], v[196:199], v[76:79]
    v_mfma_f32_16x16x32_bf16 v[80:83], v[168:171], v[204:207], v[80:83]
    ds_read_b128 v[100:103], v216 offset:1024
    v_mfma_f32_16x16x32_bf16 v[84:87], v[176:179], v[188:191], v[84:87]
    v_mfma_f32_16x16x32_bf16 v[88:91], v[176:179], v[196:199], v[88:91]
    ds_read_b128 v[108:111], v216 offset:3072
    v_mfma_f32_16x16x32_bf16 v[92:95], v[176:179], v[204:207], v[92:95]
    v_mfma_f32_16x16x32_bf16 v[48:51], v[156:159], v[184:187], v[48:51]
    ds_read_b128 v[116:119], v216 offset:5120
    v_xor_b32 v188, s34, v188
    v_xor_b32 v189, s34, v189
    v_mfma_f32_16x16x32_bf16 v[52:55], v[156:159], v[192:195], v[52:55]
    v_xor_b32 v190, s34, v190
    v_xor_b32 v191, s34, v191
    v_mfma_f32_16x16x32_bf16 v[56:59], v[156:159], v[200:203], v[56:59]
    ds_read_b128 v[124:127], v216 offset:7168
    v_xor_b32 v196, s34, v196
    v_xor_b32 v197, s34, v197
    v_mfma_f32_16x16x32_bf16 v[60:63], v[164:167], v[184:187], v[60:63]
    v_xor_b32 v198, s34, v198
    v_xor_b32 v199, s34, v199
    v_mfma_f32_16x16x32_bf16 v[64:67], v[164:167], v[192:195], v[64:67]
    v_xor_b32 v204, s34, v204
    v_xor_b32 v205, s34, v205
    v_mfma_f32_16x16x32_bf16 v[68:71], v[164:167], v[200:203], v[68:71]
    v_xor_b32 v206, s34, v206
    v_xor_b32 v207, s34, v207
    v_mfma_f32_16x16x32_bf16 v[72:75], v[172:175], v[184:187], v[72:75]
    v_mfma_f32_16x16x32_bf16 v[76:79], v[172:175], v[192:195], v[76:79]
    v_mfma_f32_16x16x32_bf16 v[80:83], v[172:175], v[200:203], v[80:83]
    v_mfma_f32_16x16x32_bf16 v[84:87], v[180:183], v[184:187], v[84:87]
    v_mfma_f32_16x16x32_bf16 v[88:91], v[180:183], v[192:195], v[88:91]
    v_mfma_f32_16x16x32_bf16 v[92:95], v[180:183], v[200:203], v[92:95]
    v_mfma_f32_16x16x32_bf16 v[0:3], v[156:159], v[188:191], v[0:3]
    v_mfma_f32_16x16x32_bf16 v[4:7], v[156:159], v[196:199], v[4:7]
    v_mfma_f32_16x16x32_bf16 v[8:11], v[156:159], v[204:207], v[8:11]
    v_mfma_f32_16x16x32_bf16 v[12:15], v[164:167], v[188:191], v[12:15]
    v_mfma_f32_16x16x32_bf16 v[16:19], v[164:167], v[196:199], v[16:19]
    s_waitcnt lgkmcnt(0)
    s_barrier
    v_mfma_f32_16x16x32_bf16 v[20:23], v[164:167], v[204:207], v[20:23]
    v_mfma_f32_16x16x32_bf16 v[24:27], v[172:175], v[188:191], v[24:27]
    v_mfma_f32_16x16x32_bf16 v[28:31], v[172:175], v[196:199], v[28:31]
    v_mfma_f32_16x16x32_bf16 v[32:35], v[172:175], v[204:207], v[32:35]
    v_mfma_f32_16x16x32_bf16 v[36:39], v[180:183], v[188:191], v[36:39]
    v_mfma_f32_16x16x32_bf16 v[40:43], v[180:183], v[196:199], v[40:43]
    v_mfma_f32_16x16x32_bf16 v[44:47], v[180:183], v[204:207], v[44:47]
    v_mfma_f32_16x16x32_bf16 v[0:3], v[96:99], v[128:131], v[0:3]
    ds_read_b128 v[152:155], v214 offset:0
    v_mfma_f32_16x16x32_bf16 v[4:7], v[96:99], v[136:139], v[4:7]
    v_mfma_f32_16x16x32_bf16 v[8:11], v[96:99], v[144:147], v[8:11]
    ds_read_b128 v[184:187], v208 offset:0
    v_mfma_f32_16x16x32_bf16 v[12:15], v[104:107], v[128:131], v[12:15]
    v_mfma_f32_16x16x32_bf16 v[16:19], v[104:107], v[136:139], v[16:19]
    ds_read_b128 v[192:195], v208 offset:2048
    v_mfma_f32_16x16x32_bf16 v[20:23], v[104:107], v[144:147], v[20:23]
    v_mfma_f32_16x16x32_bf16 v[24:27], v[112:115], v[128:131], v[24:27]
    ds_read_b128 v[200:203], v208 offset:4096
    v_mfma_f32_16x16x32_bf16 v[28:31], v[112:115], v[136:139], v[28:31]
    v_mfma_f32_16x16x32_bf16 v[32:35], v[112:115], v[144:147], v[32:35]
    ds_read_b128 v[160:163], v214 offset:2048
    v_mfma_f32_16x16x32_bf16 v[36:39], v[120:123], v[128:131], v[36:39]
    v_mfma_f32_16x16x32_bf16 v[40:43], v[120:123], v[136:139], v[40:43]
    ds_read_b128 v[168:171], v214 offset:4096
    v_mfma_f32_16x16x32_bf16 v[44:47], v[120:123], v[144:147], v[44:47]
    v_mfma_f32_16x16x32_bf16 v[48:51], v[96:99], v[132:135], v[48:51]
    ds_read_b128 v[176:179], v214 offset:6144
    v_mfma_f32_16x16x32_bf16 v[52:55], v[96:99], v[140:143], v[52:55]
    v_mfma_f32_16x16x32_bf16 v[56:59], v[96:99], v[148:151], v[56:59]
    ds_read_b128 v[188:191], v211 offset:0
    v_mfma_f32_16x16x32_bf16 v[60:63], v[104:107], v[132:135], v[60:63]
    v_mfma_f32_16x16x32_bf16 v[64:67], v[104:107], v[140:143], v[64:67]
    ds_read_b128 v[196:199], v211 offset:2048
    v_mfma_f32_16x16x32_bf16 v[68:71], v[104:107], v[148:151], v[68:71]
    v_mfma_f32_16x16x32_bf16 v[72:75], v[112:115], v[132:135], v[72:75]
    ds_read_b128 v[204:207], v211 offset:4096
    v_mfma_f32_16x16x32_bf16 v[76:79], v[112:115], v[140:143], v[76:79]
    v_mfma_f32_16x16x32_bf16 v[80:83], v[112:115], v[148:151], v[80:83]
    ds_read_b128 v[156:159], v214 offset:1024
    v_mfma_f32_16x16x32_bf16 v[84:87], v[120:123], v[132:135], v[84:87]
    v_mfma_f32_16x16x32_bf16 v[88:91], v[120:123], v[140:143], v[88:91]
    ds_read_b128 v[164:167], v214 offset:3072
    v_mfma_f32_16x16x32_bf16 v[92:95], v[120:123], v[148:151], v[92:95]
    v_mfma_f32_16x16x32_bf16 v[48:51], v[100:103], v[128:131], v[48:51]
    ds_read_b128 v[172:175], v214 offset:5120
    v_xor_b32 v132, s34, v132
    v_xor_b32 v133, s34, v133
    v_mfma_f32_16x16x32_bf16 v[52:55], v[100:103], v[136:139], v[52:55]
    v_xor_b32 v134, s34, v134
    v_xor_b32 v135, s34, v135
    v_mfma_f32_16x16x32_bf16 v[56:59], v[100:103], v[144:147], v[56:59]
    ds_read_b128 v[180:183], v214 offset:7168
    v_xor_b32 v140, s34, v140
    v_xor_b32 v141, s34, v141
    v_mfma_f32_16x16x32_bf16 v[60:63], v[108:111], v[128:131], v[60:63]
    v_xor_b32 v142, s34, v142
    v_xor_b32 v143, s34, v143
    v_mfma_f32_16x16x32_bf16 v[64:67], v[108:111], v[136:139], v[64:67]
    v_xor_b32 v148, s34, v148
    v_xor_b32 v149, s34, v149
    v_mfma_f32_16x16x32_bf16 v[68:71], v[108:111], v[144:147], v[68:71]
    v_xor_b32 v150, s34, v150
    v_xor_b32 v151, s34, v151
    v_mfma_f32_16x16x32_bf16 v[72:75], v[116:119], v[128:131], v[72:75]
    v_mfma_f32_16x16x32_bf16 v[76:79], v[116:119], v[136:139], v[76:79]
    v_mfma_f32_16x16x32_bf16 v[80:83], v[116:119], v[144:147], v[80:83]
    v_mfma_f32_16x16x32_bf16 v[84:87], v[124:127], v[128:131], v[84:87]
    v_mfma_f32_16x16x32_bf16 v[88:91], v[124:127], v[136:139], v[88:91]
    v_mfma_f32_16x16x32_bf16 v[92:95], v[124:127], v[144:147], v[92:95]
    v_mfma_f32_16x16x32_bf16 v[0:3], v[100:103], v[132:135], v[0:3]
    v_mfma_f32_16x16x32_bf16 v[4:7], v[100:103], v[140:143], v[4:7]
    v_mfma_f32_16x16x32_bf16 v[8:11], v[100:103], v[148:151], v[8:11]
    v_mfma_f32_16x16x32_bf16 v[12:15], v[108:111], v[132:135], v[12:15]
    v_mfma_f32_16x16x32_bf16 v[16:19], v[108:111], v[140:143], v[16:19]
    s_waitcnt lgkmcnt(0)
    v_mfma_f32_16x16x32_bf16 v[20:23], v[108:111], v[148:151], v[20:23]
    v_mfma_f32_16x16x32_bf16 v[24:27], v[116:119], v[132:135], v[24:27]
    v_mfma_f32_16x16x32_bf16 v[28:31], v[116:119], v[140:143], v[28:31]
    v_mfma_f32_16x16x32_bf16 v[32:35], v[116:119], v[148:151], v[32:35]
    v_mfma_f32_16x16x32_bf16 v[36:39], v[124:127], v[132:135], v[36:39]
    v_mfma_f32_16x16x32_bf16 v[40:43], v[124:127], v[140:143], v[40:43]
    v_mfma_f32_16x16x32_bf16 v[44:47], v[124:127], v[148:151], v[44:47]
    v_mfma_f32_16x16x32_bf16 v[0:3], v[152:155], v[184:187], v[0:3]
    v_mfma_f32_16x16x32_bf16 v[4:7], v[152:155], v[192:195], v[4:7]
    v_mfma_f32_16x16x32_bf16 v[8:11], v[152:155], v[200:203], v[8:11]
    v_mfma_f32_16x16x32_bf16 v[12:15], v[160:163], v[184:187], v[12:15]
    v_mfma_f32_16x16x32_bf16 v[16:19], v[160:163], v[192:195], v[16:19]
    v_mfma_f32_16x16x32_bf16 v[20:23], v[160:163], v[200:203], v[20:23]
    v_mfma_f32_16x16x32_bf16 v[24:27], v[168:171], v[184:187], v[24:27]
    v_mfma_f32_16x16x32_bf16 v[28:31], v[168:171], v[192:195], v[28:31]
    v_mfma_f32_16x16x32_bf16 v[32:35], v[168:171], v[200:203], v[32:35]
    v_mfma_f32_16x16x32_bf16 v[36:39], v[176:179], v[184:187], v[36:39]
    v_mfma_f32_16x16x32_bf16 v[40:43], v[176:179], v[192:195], v[40:43]
    v_mfma_f32_16x16x32_bf16 v[44:47], v[176:179], v[200:203], v[44:47]
    v_mfma_f32_16x16x32_bf16 v[48:51], v[152:155], v[188:191], v[48:51]
    v_mfma_f32_16x16x32_bf16 v[52:55], v[152:155], v[196:199], v[52:55]
    v_mfma_f32_16x16x32_bf16 v[56:59], v[152:155], v[204:207], v[56:59]
    v_mfma_f32_16x16x32_bf16 v[60:63], v[160:163], v[188:191], v[60:63]
    v_mfma_f32_16x16x32_bf16 v[64:67], v[160:163], v[196:199], v[64:67]
    v_mfma_f32_16x16x32_bf16 v[68:71], v[160:163], v[204:207], v[68:71]
    v_mfma_f32_16x16x32_bf16 v[72:75], v[168:171], v[188:191], v[72:75]
    v_mfma_f32_16x16x32_bf16 v[76:79], v[168:171], v[196:199], v[76:79]
    v_mfma_f32_16x16x32_bf16 v[80:83], v[168:171], v[204:207], v[80:83]
    v_mfma_f32_16x16x32_bf16 v[84:87], v[176:179], v[188:191], v[84:87]
    v_mfma_f32_16x16x32_bf16 v[88:91], v[176:179], v[196:199], v[88:91]
    v_mfma_f32_16x16x32_bf16 v[92:95], v[176:179], v[204:207], v[92:95]
    v_mfma_f32_16x16x32_bf16 v[48:51], v[156:159], v[184:187], v[48:51]
    v_xor_b32 v188, s34, v188
    v_xor_b32 v189, s34, v189
    v_mfma_f32_16x16x32_bf16 v[52:55], v[156:159], v[192:195], v[52:55]
    v_xor_b32 v190, s34, v190
    v_xor_b32 v191, s34, v191
    v_mfma_f32_16x16x32_bf16 v[56:59], v[156:159], v[200:203], v[56:59]
    v_xor_b32 v196, s34, v196
    v_xor_b32 v197, s34, v197
    v_mfma_f32_16x16x32_bf16 v[60:63], v[164:167], v[184:187], v[60:63]
    v_xor_b32 v198, s34, v198
    v_xor_b32 v199, s34, v199
    v_mfma_f32_16x16x32_bf16 v[64:67], v[164:167], v[192:195], v[64:67]
    v_xor_b32 v204, s34, v204
    v_xor_b32 v205, s34, v205
    v_mfma_f32_16x16x32_bf16 v[68:71], v[164:167], v[200:203], v[68:71]
    v_xor_b32 v206, s34, v206
    v_xor_b32 v207, s34, v207
    v_mfma_f32_16x16x32_bf16 v[72:75], v[172:175], v[184:187], v[72:75]
    v_mfma_f32_16x16x32_bf16 v[76:79], v[172:175], v[192:195], v[76:79]
    v_mfma_f32_16x16x32_bf16 v[80:83], v[172:175], v[200:203], v[80:83]
    v_mfma_f32_16x16x32_bf16 v[84:87], v[180:183], v[184:187], v[84:87]
    v_mfma_f32_16x16x32_bf16 v[88:91], v[180:183], v[192:195], v[88:91]
    v_mfma_f32_16x16x32_bf16 v[92:95], v[180:183], v[200:203], v[92:95]
    v_mfma_f32_16x16x32_bf16 v[0:3], v[156:159], v[188:191], v[0:3]
    v_mfma_f32_16x16x32_bf16 v[4:7], v[156:159], v[196:199], v[4:7]
    v_mfma_f32_16x16x32_bf16 v[8:11], v[156:159], v[204:207], v[8:11]
    v_mfma_f32_16x16x32_bf16 v[12:15], v[164:167], v[188:191], v[12:15]
    v_mfma_f32_16x16x32_bf16 v[16:19], v[164:167], v[196:199], v[16:19]
    v_mfma_f32_16x16x32_bf16 v[20:23], v[164:167], v[204:207], v[20:23]
    v_mfma_f32_16x16x32_bf16 v[24:27], v[172:175], v[188:191], v[24:27]
    v_mfma_f32_16x16x32_bf16 v[28:31], v[172:175], v[196:199], v[28:31]
    v_mfma_f32_16x16x32_bf16 v[32:35], v[172:175], v[204:207], v[32:35]
    v_mfma_f32_16x16x32_bf16 v[36:39], v[180:183], v[188:191], v[36:39]
    v_mfma_f32_16x16x32_bf16 v[40:43], v[180:183], v[196:199], v[40:43]
    v_mfma_f32_16x16x32_bf16 v[44:47], v[180:183], v[204:207], v[44:47]
    s_nop 7
    s_nop 7
    v_cvt_pk_bf16_f32 v96, v48, v49
    v_cvt_pk_bf16_f32 v97, v50, v51
    v_cvt_pk_bf16_f32 v98, v60, v61
    v_cvt_pk_bf16_f32 v99, v62, v63
    s_add_u32 s35, s33, 0
    buffer_store_dwordx4 v[96:99], v221, s[16:19], s35 offen offset:64
    v_cvt_pk_bf16_f32 v100, v52, v53
    v_cvt_pk_bf16_f32 v101, v54, v55
    v_cvt_pk_bf16_f32 v102, v64, v65
    v_cvt_pk_bf16_f32 v103, v66, v67
    s_add_u32 s35, s33, 524288
    buffer_store_dwordx4 v[100:103], v221, s[16:19], s35 offen offset:64
    v_cvt_pk_bf16_f32 v104, v56, v57
    v_cvt_pk_bf16_f32 v105, v58, v59
    v_cvt_pk_bf16_f32 v106, v68, v69
    v_cvt_pk_bf16_f32 v107, v70, v71
    s_add_u32 s35, s33, 1048576
    buffer_store_dwordx4 v[104:107], v221, s[16:19], s35 offen offset:64
    v_cvt_pk_bf16_f32 v108, v72, v73
    v_cvt_pk_bf16_f32 v109, v74, v75
    v_cvt_pk_bf16_f32 v110, v84, v85
    v_cvt_pk_bf16_f32 v111, v86, v87
    s_add_u32 s35, s33, 4096
    buffer_store_dwordx4 v[108:111], v221, s[16:19], s35 offen offset:64
    v_cvt_pk_bf16_f32 v112, v76, v77
    v_cvt_pk_bf16_f32 v113, v78, v79
    v_cvt_pk_bf16_f32 v114, v88, v89
    v_cvt_pk_bf16_f32 v115, v90, v91
    s_add_u32 s35, s33, 528384
    buffer_store_dwordx4 v[112:115], v221, s[16:19], s35 offen offset:64
    v_cvt_pk_bf16_f32 v116, v80, v81
    v_cvt_pk_bf16_f32 v117, v82, v83
    v_cvt_pk_bf16_f32 v118, v92, v93
    v_cvt_pk_bf16_f32 v119, v94, v95
    s_add_u32 s35, s33, 1052672
    buffer_store_dwordx4 v[116:119], v221, s[16:19], s35 offen offset:64
    v_cvt_pk_bf16_f32 v120, v0, v1
    v_cvt_pk_bf16_f32 v121, v2, v3
    v_cvt_pk_bf16_f32 v122, v12, v13
    v_cvt_pk_bf16_f32 v123, v14, v15
    s_add_u32 s35, s33, 0
    buffer_store_dwordx4 v[120:123], v221, s[16:19], s35 offen offset:0
    v_cvt_pk_bf16_f32 v124, v4, v5
    v_cvt_pk_bf16_f32 v125, v6, v7
    v_cvt_pk_bf16_f32 v126, v16, v17
    v_cvt_pk_bf16_f32 v127, v18, v19
    s_add_u32 s35, s33, 524288
    buffer_store_dwordx4 v[124:127], v221, s[16:19], s35 offen offset:0
    v_cvt_pk_bf16_f32 v96, v8, v9
    v_cvt_pk_bf16_f32 v97, v10, v11
    v_cvt_pk_bf16_f32 v98, v20, v21
    v_cvt_pk_bf16_f32 v99, v22, v23
    s_add_u32 s35, s33, 1048576
    buffer_store_dwordx4 v[96:99], v221, s[16:19], s35 offen offset:0
    v_cvt_pk_bf16_f32 v100, v24, v25
    v_cvt_pk_bf16_f32 v101, v26, v27
    v_cvt_pk_bf16_f32 v102, v36, v37
    v_cvt_pk_bf16_f32 v103, v38, v39
    s_add_u32 s35, s33, 4096
    buffer_store_dwordx4 v[100:103], v221, s[16:19], s35 offen offset:0
    v_cvt_pk_bf16_f32 v104, v28, v29
    v_cvt_pk_bf16_f32 v105, v30, v31
    v_cvt_pk_bf16_f32 v106, v40, v41
    v_cvt_pk_bf16_f32 v107, v42, v43
    s_add_u32 s35, s33, 528384
    buffer_store_dwordx4 v[104:107], v221, s[16:19], s35 offen offset:0
    v_cvt_pk_bf16_f32 v108, v32, v33
    v_cvt_pk_bf16_f32 v109, v34, v35
    v_cvt_pk_bf16_f32 v110, v44, v45
    v_cvt_pk_bf16_f32 v111, v46, v47
    s_add_u32 s35, s33, 1052672
    buffer_store_dwordx4 v[108:111], v221, s[16:19], s35 offen offset:0
    s_endpgm
L_gemm1_kernel_loader:
    s_sub_u32 s20, s20, 4
    v_and_b32 v3, 63, v0
    v_lshrrev_b32 v4, 3, v3
    v_and_b32 v5, 7, v3
    v_xor_b32 v5, v5, v4
    v_lshlrev_b32 v5, 4, v5
    v_lshl_add_u32 v1, v4, 11, v5
    v_lshlrev_b32 v2, 4, v3
    s_add_u32 s24, s20, 0
    s_lshl_b32 s40, s24, 10
    s_lshl_b32 s43, s24, 14
    s_add_u32 s24, s20, 4
    s_lshl_b32 s41, s24, 10
    s_lshl_b32 s44, s24, 14
    s_add_u32 s24, s20, 8
    s_lshl_b32 s42, s24, 10
    s_lshl_b32 s45, s24, 14
    s_mul_i32 s46, s20, 4096
    s_add_u32 s47, s46, 12288
    s_add_u32 m0, s40, 0
    s_add_u32 s24, s43, 0
    buffer_load_dwordx4 v1, s[8:11], s24 offen lds
    s_add_u32 m0, s41, 0
    s_add_u32 s24, s44, 0
    buffer_load_dwordx4 v1, s[8:11], s24 offen lds
    s_add_u32 m0, s42, 0
    s_add_u32 s24, s45, 0
    buffer_load_dwordx4 v1, s[8:11], s24 offen lds
    s_add_u32 m0, s47, 0
    s_add_u32 s24, s46, 0
    buffer_load_dwordx4 v2, s[12:15], s24 offen offset:0 lds
    buffer_load_dwordx4 v2, s[12:15], s24 offen offset:1024 lds
    buffer_load_dwordx4 v2, s[12:15], s24 offen offset:2048 lds
    buffer_load_dwordx4 v2, s[12:15], s24 offen offset:3072 lds
    s_add_u32 m0, s40, 28672
    s_add_u32 s24, s43, 128
    buffer_load_dwordx4 v1, s[8:11], s24 offen lds
    s_add_u32 m0, s41, 28672
    s_add_u32 s24, s44, 128
    buffer_load_dwordx4 v1, s[8:11], s24 offen lds
    s_add_u32 m0, s42, 28672
    s_add_u32 s24, s45, 128
    buffer_load_dwordx4 v1, s[8:11], s24 offen lds
    s_add_u32 m0, s47, 28672
    s_add_u32 s24, s46, 32768
    buffer_load_dwordx4 v2, s[12:15], s24 offen offset:0 lds
    buffer_load_dwordx4 v2, s[12:15], s24 offen offset:1024 lds
    buffer_load_dwordx4 v2, s[12:15], s24 offen offset:2048 lds
    buffer_load_dwordx4 v2, s[12:15], s24 offen offset:3072 lds
    s_add_u32 m0, s40, 57344
    s_add_u32 s24, s43, 256
    buffer_load_dwordx4 v1, s[8:11], s24 offen lds
    s_add_u32 m0, s41, 57344
    s_add_u32 s24, s44, 256
    buffer_load_dwordx4 v1, s[8:11], s24 offen lds
    s_add_u32 m0, s42, 57344
    s_add_u32 s24, s45, 256
    buffer_load_dwordx4 v1, s[8:11], s24 offen lds
    s_add_u32 m0, s47, 57344
    s_add_u32 s24, s46, 65536
    buffer_load_dwordx4 v2, s[12:15], s24 offen offset:0 lds
    buffer_load_dwordx4 v2, s[12:15], s24 offen offset:1024 lds
    buffer_load_dwordx4 v2, s[12:15], s24 offen offset:2048 lds
    buffer_load_dwordx4 v2, s[12:15], s24 offen offset:3072 lds
    s_add_u32 m0, s40, 86016
    s_add_u32 s24, s43, 384
    buffer_load_dwordx4 v1, s[8:11], s24 offen lds
    s_add_u32 m0, s41, 86016
    s_add_u32 s24, s44, 384
    buffer_load_dwordx4 v1, s[8:11], s24 offen lds
    s_add_u32 m0, s42, 86016
    s_add_u32 s24, s45, 384
    buffer_load_dwordx4 v1, s[8:11], s24 offen lds
    s_add_u32 m0, s47, 86016
    s_add_u32 s24, s46, 98304
    buffer_load_dwordx4 v2, s[12:15], s24 offen offset:0 lds
    buffer_load_dwordx4 v2, s[12:15], s24 offen offset:1024 lds
    buffer_load_dwordx4 v2, s[12:15], s24 offen offset:2048 lds
    buffer_load_dwordx4 v2, s[12:15], s24 offen offset:3072 lds
    s_add_u32 m0, s40, 114688
    s_add_u32 s24, s43, 512
    buffer_load_dwordx4 v1, s[8:11], s24 offen lds
    s_add_u32 m0, s41, 114688
    s_add_u32 s24, s44, 512
    buffer_load_dwordx4 v1, s[8:11], s24 offen lds
    s_add_u32 m0, s42, 114688
    s_add_u32 s24, s45, 512
    buffer_load_dwordx4 v1, s[8:11], s24 offen lds
    s_add_u32 m0, s47, 114688
    s_add_u32 s24, s46, 131072
    buffer_load_dwordx4 v2, s[12:15], s24 offen offset:0 lds
    buffer_load_dwordx4 v2, s[12:15], s24 offen offset:1024 lds
    buffer_load_dwordx4 v2, s[12:15], s24 offen offset:2048 lds
    buffer_load_dwordx4 v2, s[12:15], s24 offen offset:3072 lds
    s_waitcnt vmcnt(28)
    s_barrier
    s_waitcnt vmcnt(21)
    s_barrier
    s_add_u32 m0, s40, 0
    s_add_u32 s24, s43, 640
    buffer_load_dwordx4 v1, s[8:11], s24 offen lds
    s_add_u32 m0, s41, 0
    s_add_u32 s24, s44, 640
    buffer_load_dwordx4 v1, s[8:11], s24 offen lds
    s_add_u32 m0, s42, 0
    s_add_u32 s24, s45, 640
    buffer_load_dwordx4 v1, s[8:11], s24 offen lds
    s_add_u32 m0, s47, 0
    s_add_u32 s24, s46, 163840
    buffer_load_dwordx4 v2, s[12:15], s24 offen offset:0 lds
    buffer_load_dwordx4 v2, s[12:15], s24 offen offset:1024 lds
    buffer_load_dwordx4 v2, s[12:15], s24 offen offset:2048 lds
    buffer_load_dwordx4 v2, s[12:15], s24 offen offset:3072 lds
    s_waitcnt vmcnt(21)
    s_barrier
    s_add_u32 m0, s40, 28672
    s_add_u32 s24, s43, 768
    buffer_load_dwordx4 v1, s[8:11], s24 offen lds
    s_add_u32 m0, s41, 28672
    s_add_u32 s24, s44, 768
    buffer_load_dwordx4 v1, s[8:11], s24 offen lds
    s_add_u32 m0, s42, 28672
    s_add_u32 s24, s45, 768
    buffer_load_dwordx4 v1, s[8:11], s24 offen lds
    s_add_u32 m0, s47, 28672
    s_add_u32 s24, s46, 196608
    buffer_load_dwordx4 v2, s[12:15], s24 offen offset:0 lds
    buffer_load_dwordx4 v2, s[12:15], s24 offen offset:1024 lds
    buffer_load_dwordx4 v2, s[12:15], s24 offen offset:2048 lds
    buffer_load_dwordx4 v2, s[12:15], s24 offen offset:3072 lds
    s_waitcnt vmcnt(21)
    s_barrier
    s_add_u32 m0, s40, 57344
    s_add_u32 s24, s43, 896
    buffer_load_dwordx4 v1, s[8:11], s24 offen lds
    s_add_u32 m0, s41, 57344
    s_add_u32 s24, s44, 896
    buffer_load_dwordx4 v1, s[8:11], s24 offen lds
    s_add_u32 m0, s42, 57344
    s_add_u32 s24, s45, 896
    buffer_load_dwordx4 v1, s[8:11], s24 offen lds
    s_add_u32 m0, s47, 57344
    s_add_u32 s24, s46, 229376
    buffer_load_dwordx4 v2, s[12:15], s24 offen offset:0 lds
    buffer_load_dwordx4 v2, s[12:15], s24 offen offset:1024 lds
    buffer_load_dwordx4 v2, s[12:15], s24 offen offset:2048 lds
    buffer_load_dwordx4 v2, s[12:15], s24 offen offset:3072 lds
    s_waitcnt vmcnt(21)
    s_barrier
    s_add_u32 m0, s40, 86016
    s_add_u32 s24, s43, 1024
    buffer_load_dwordx4 v1, s[8:11], s24 offen lds
    s_add_u32 m0, s41, 86016
    s_add_u32 s24, s44, 1024
    buffer_load_dwordx4 v1, s[8:11], s24 offen lds
    s_add_u32 m0, s42, 86016
    s_add_u32 s24, s45, 1024
    buffer_load_dwordx4 v1, s[8:11], s24 offen lds
    s_add_u32 m0, s47, 86016
    s_add_u32 s24, s46, 262144
    buffer_load_dwordx4 v2, s[12:15], s24 offen offset:0 lds
    buffer_load_dwordx4 v2, s[12:15], s24 offen offset:1024 lds
    buffer_load_dwordx4 v2, s[12:15], s24 offen offset:2048 lds
    buffer_load_dwordx4 v2, s[12:15], s24 offen offset:3072 lds
    s_waitcnt vmcnt(21)
    s_barrier
    s_add_u32 m0, s40, 114688
    s_add_u32 s24, s43, 1152
    buffer_load_dwordx4 v1, s[8:11], s24 offen lds
    s_add_u32 m0, s41, 114688
    s_add_u32 s24, s44, 1152
    buffer_load_dwordx4 v1, s[8:11], s24 offen lds
    s_add_u32 m0, s42, 114688
    s_add_u32 s24, s45, 1152
    buffer_load_dwordx4 v1, s[8:11], s24 offen lds
    s_add_u32 m0, s47, 114688
    s_add_u32 s24, s46, 294912
    buffer_load_dwordx4 v2, s[12:15], s24 offen offset:0 lds
    buffer_load_dwordx4 v2, s[12:15], s24 offen offset:1024 lds
    buffer_load_dwordx4 v2, s[12:15], s24 offen offset:2048 lds
    buffer_load_dwordx4 v2, s[12:15], s24 offen offset:3072 lds
    s_waitcnt vmcnt(21)
    s_barrier
    s_add_u32 m0, s40, 0
    s_add_u32 s24, s43, 1280
    buffer_load_dwordx4 v1, s[8:11], s24 offen lds
    s_add_u32 m0, s41, 0
    s_add_u32 s24, s44, 1280
    buffer_load_dwordx4 v1, s[8:11], s24 offen lds
    s_add_u32 m0, s42, 0
    s_add_u32 s24, s45, 1280
    buffer_load_dwordx4 v1, s[8:11], s24 offen lds
    s_add_u32 m0, s47, 0
    s_add_u32 s24, s46, 327680
    buffer_load_dwordx4 v2, s[12:15], s24 offen offset:0 lds
    buffer_load_dwordx4 v2, s[12:15], s24 offen offset:1024 lds
    buffer_load_dwordx4 v2, s[12:15], s24 offen offset:2048 lds
    buffer_load_dwordx4 v2, s[12:15], s24 offen offset:3072 lds
    s_waitcnt vmcnt(21)
    s_barrier
    s_add_u32 m0, s40, 28672
    s_add_u32 s24, s43, 1408
    buffer_load_dwordx4 v1, s[8:11], s24 offen lds
    s_add_u32 m0, s41, 28672
    s_add_u32 s24, s44, 1408
    buffer_load_dwordx4 v1, s[8:11], s24 offen lds
    s_add_u32 m0, s42, 28672
    s_add_u32 s24, s45, 1408
    buffer_load_dwordx4 v1, s[8:11], s24 offen lds
    s_add_u32 m0, s47, 28672
    s_add_u32 s24, s46, 360448
    buffer_load_dwordx4 v2, s[12:15], s24 offen offset:0 lds
    buffer_load_dwordx4 v2, s[12:15], s24 offen offset:1024 lds
    buffer_load_dwordx4 v2, s[12:15], s24 offen offset:2048 lds
    buffer_load_dwordx4 v2, s[12:15], s24 offen offset:3072 lds
    s_waitcnt vmcnt(21)
    s_barrier
    s_add_u32 m0, s40, 57344
    s_add_u32 s24, s43, 1536
    buffer_load_dwordx4 v1, s[8:11], s24 offen lds
    s_add_u32 m0, s41, 57344
    s_add_u32 s24, s44, 1536
    buffer_load_dwordx4 v1, s[8:11], s24 offen lds
    s_add_u32 m0, s42, 57344
    s_add_u32 s24, s45, 1536
    buffer_load_dwordx4 v1, s[8:11], s24 offen lds
    s_add_u32 m0, s47, 57344
    s_add_u32 s24, s46, 393216
    buffer_load_dwordx4 v2, s[12:15], s24 offen offset:0 lds
    buffer_load_dwordx4 v2, s[12:15], s24 offen offset:1024 lds
    buffer_load_dwordx4 v2, s[12:15], s24 offen offset:2048 lds
    buffer_load_dwordx4 v2, s[12:15], s24 offen offset:3072 lds
    s_waitcnt vmcnt(21)
    s_barrier
    s_add_u32 m0, s40, 86016
    s_add_u32 s24, s43, 1664
    buffer_load_dwordx4 v1, s[8:11], s24 offen lds
    s_add_u32 m0, s41, 86016
    s_add_u32 s24, s44, 1664
    buffer_load_dwordx4 v1, s[8:11], s24 offen lds
    s_add_u32 m0, s42, 86016
    s_add_u32 s24, s45, 1664
    buffer_load_dwordx4 v1, s[8:11], s24 offen lds
    s_add_u32 m0, s47, 86016
    s_add_u32 s24, s46, 425984
    buffer_load_dwordx4 v2, s[12:15], s24 offen offset:0 lds
    buffer_load_dwordx4 v2, s[12:15], s24 offen offset:1024 lds
    buffer_load_dwordx4 v2, s[12:15], s24 offen offset:2048 lds
    buffer_load_dwordx4 v2, s[12:15], s24 offen offset:3072 lds
    s_waitcnt vmcnt(21)
    s_barrier
    s_add_u32 m0, s40, 114688
    s_add_u32 s24, s43, 1792
    buffer_load_dwordx4 v1, s[8:11], s24 offen lds
    s_add_u32 m0, s41, 114688
    s_add_u32 s24, s44, 1792
    buffer_load_dwordx4 v1, s[8:11], s24 offen lds
    s_add_u32 m0, s42, 114688
    s_add_u32 s24, s45, 1792
    buffer_load_dwordx4 v1, s[8:11], s24 offen lds
    s_add_u32 m0, s47, 114688
    s_add_u32 s24, s46, 458752
    buffer_load_dwordx4 v2, s[12:15], s24 offen offset:0 lds
    buffer_load_dwordx4 v2, s[12:15], s24 offen offset:1024 lds
    buffer_load_dwordx4 v2, s[12:15], s24 offen offset:2048 lds
    buffer_load_dwordx4 v2, s[12:15], s24 offen offset:3072 lds
    s_waitcnt vmcnt(21)
    s_barrier
    s_add_u32 m0, s40, 0
    s_add_u32 s24, s43, 1920
    buffer_load_dwordx4 v1, s[8:11], s24 offen lds
    s_add_u32 m0, s41, 0
    s_add_u32 s24, s44, 1920
    buffer_load_dwordx4 v1, s[8:11], s24 offen lds
    s_add_u32 m0, s42, 0
    s_add_u32 s24, s45, 1920
    buffer_load_dwordx4 v1, s[8:11], s24 offen lds
    s_add_u32 m0, s47, 0
    s_add_u32 s24, s46, 491520
    buffer_load_dwordx4 v2, s[12:15], s24 offen offset:0 lds
    buffer_load_dwordx4 v2, s[12:15], s24 offen offset:1024 lds
    buffer_load_dwordx4 v2, s[12:15], s24 offen offset:2048 lds
    buffer_load_dwordx4 v2, s[12:15], s24 offen offset:3072 lds
    s_waitcnt vmcnt(21)
    s_barrier
    s_waitcnt vmcnt(14)
    s_barrier
    s_waitcnt vmcnt(7)
    s_barrier
    s_waitcnt vmcnt(0)
    s_barrier
L_gemm1_kernel_done:
    s_endpgm
.globl mid_kernel
.p2align 8
.type mid_kernel,@function
mid_kernel:
    s_cmp_ge_u32 s2, 704
    s_cbranch_scc1 L_mid_kernel_done
    v_readfirstlane_b32 s20, v0
    s_lshr_b32 s20, s20, 6
    s_cmp_ge_u32 s2, 448
    s_cbranch_scc1 L_mid_kernel_g
    s_load_dwordx2 s[6:7], s[0:1], 72
    s_cmp_ge_u32 s2, 224
    s_cselect_b32 s24, 1, 0
    s_mul_i32 s25, s24, 224
    s_sub_u32 s25, s2, s25
    s_lshr_b32 s26, s25, 3
    s_and_b32 s27, s25, 7
    v_and_b32 v1, 63, v0
    v_lshrrev_b32 v2, 2, v1
    v_lshlrev_b32 v2, 6, v2
    v_lshrrev_b32 v3, 5, v1
    v_lshlrev_b32 v3, 1, v3
    v_and_b32 v4, 3, v1
    v_xor_b32 v3, v3, v4
    v_lshl_add_u32 v2, v3, 4, v2
    s_mul_i32 s28, s26, 6
    s_lshl_b32 s29, s20, 1
    s_add_u32 s28, s28, s29
    s_sub_u32 s28, s28, 1
    s_lshl_b32 s30, s27, 12
    s_add_u32 s31, s28, 0
    s_lshl_b32 s32, s31, 15
    s_add_u32 s32, s32, s30
    s_cmp_lt_i32 s31, 0
    s_cselect_b32 s32, 0x7f000000, s32
    v_add_u32 v3, s32, v2
    s_add_u32 s31, s28, 1
    s_lshl_b32 s32, s31, 15
    s_add_u32 s32, s32, s30
    s_cmp_lt_i32 s31, 0
    s_cselect_b32 s32, 0x7f000000, s32
    v_add_u32 v4, s32, v2
    s_waitcnt lgkmcnt(0)
    s_mul_i32 s33, s24, 5472256
    s_add_u32 s33, s33, 38871040
    s_add_u32 s8, s6, s33
    s_addc_u32 s9, s7, 0
    s_mov_b32 s10, 5472256
    s_mov_b32 s11, 0x00020000
    s_add_u32 s12, s6, 83312640
    s_addc_u32 s13, s7, 0
    s_mov_b32 s14, 16384
    s_mov_b32 s15, 0x00020000
    s_lshl_b32 s34, s20, 13
    s_add_u32 m0, s34, 0
    s_nop 0
    buffer_load_dwordx4 v3, s[8:11], 0 offen offset:0 lds
    buffer_load_dwordx4 v3, s[8:11], 0 offen offset:1024 lds
    buffer_load_dwordx4 v3, s[8:11], 0 offen offset:2048 lds
    buffer_load_dwordx4 v3, s[8:11], 0 offen offset:3072 lds
    s_add_u32 m0, s34, 4096
    s_nop 0
    buffer_load_dwordx4 v4, s[8:11], 0 offen offset:0 lds
    buffer_load_dwordx4 v4, s[8:11], 0 offen offset:1024 lds
    buffer_load_dwordx4 v4, s[8:11], 0 offen offset:2048 lds
    buffer_load_dwordx4 v4, s[8:11], 0 offen offset:3072 lds
    v_lshlrev_b32 v5, 4, v1
    s_mov_b32 s35, 8192
    buffer_load_dwordx4 v[8:11], v5, s[12:15], s35 offen
    s_mov_b32 s35, 9216
    buffer_load_dwordx4 v[12:15], v5, s[12:15], s35 offen
    s_mov_b32 s35, 10240
    buffer_load_dwordx4 v[16:19], v5, s[12:15], s35 offen
    s_mov_b32 s35, 11264
    buffer_load_dwordx4 v[20:23], v5, s[12:15], s35 offen
    s_mov_b32 s35, 12288
    buffer_load_dwordx4 v[24:27], v5, s[12:15], s35 offen
    s_mov_b32 s35, 13312
    buffer_load_dwordx4 v[28:31], v5, s[12:15], s35 offen
    s_lshl_b32 s35, s20, 11
    buffer_load_dwordx4 v[32:35], v5, s[12:15], s35 offen offset:0
    buffer_load_dwordx4 v[36:39], v5, s[12:15], s35 offen offset:1024
    v_bfe_u32 v40, v1, 2, 2
    v_lshrrev_b32 v41, 4, v1
    v_and_b32 v42, 3, v1
    v_lshl_add_u32 v43, v41, 3, v40
    v_lshlrev_b32 v46, 6, v43
    v_and_b32 v47, 1, v41
    v_lshlrev_b32 v47, 1, v47
    v_lshrrev_b32 v48, 1, v42
    v_xor_b32 v47, v47, v48
    v_lshl_add_u32 v46, v47, 4, v46
    v_and_b32 v48, 1, v42
    v_lshl_add_u32 v46, v48, 3, v46
    v_add_u32 v44, s34, v46
    v_xor_b32 v45, 32, v44
    v_add_u32 v49, 46080, v46
    v_xor_b32 v50, 32, v49
    v_add_u32 v47, 1, v43
    v_bfe_u32 v48, v47, 3, 1
    v_lshlrev_b32 v48, 1, v48
    v_lshrrev_b32 v55, 1, v42
    v_xor_b32 v48, v48, v55
    v_lshlrev_b32 v47, 6, v47
    v_lshl_add_u32 v47, v48, 4, v47
    v_and_b32 v48, 1, v42
    v_lshl_add_u32 v47, v48, 3, v47
    v_add_u32 v51, 33792, v47
    v_xor_b32 v52, 32, v51
    v_add_u32 v47, 5, v43
    v_bfe_u32 v48, v47, 3, 1
    v_lshlrev_b32 v48, 1, v48
    v_lshrrev_b32 v55, 1, v42
    v_xor_b32 v48, v48, v55
    v_lshlrev_b32 v47, 6, v47
    v_lshl_add_u32 v47, v48, 4, v47
    v_and_b32 v48, 1, v42
    v_lshl_add_u32 v47, v48, 3, v47
    v_add_u32 v53, 33792, v47
    v_xor_b32 v54, 32, v53
    v_and_b32 v47, 1, v1
    v_mul_u32_u24 v47, 12288, v47
    v_bfe_u32 v48, v1, 1, 3
    v_lshl_add_u32 v47, v48, 6, v47
    v_lshl_add_u32 v47, v41, 4, v47
    s_mul_i32 s35, s20, 3072
    s_add_u32 s35, s35, 32768
    v_add_u32 v56, s35, v47
    v_xor_b32 v57, 32, v56
    s_mov_b32 s35, 344064
    v_mul_lo_u32 v58, v48, s35
    v_and_b32 v47, 1, v1
    v_lshl_add_u32 v58, v47, 6, v58
    v_lshl_add_u32 v58, v41, 4, v58
    s_mov_b32 s36, 0xbdd2d3e8
    v_mov_b32 v59, 0xc0135761
    s_add_u32 s16, s6, 49815552
    s_addc_u32 s17, s7, 0
    s_mov_b32 s18, 11010048
    s_mov_b32 s19, 0x00020000
    s_mul_i32 s37, s20, 2752512
    s_mul_i32 s38, s24, 84
    s_mul_i32 s39, s26, 3
    s_add_u32 s38, s38, s39
    s_lshl_b32 s38, s38, 11
    s_add_u32 s37, s37, s38
    s_lshl_b32 s38, s27, 7
    s_add_u32 s37, s37, s38
    s_waitcnt vmcnt(2)
    ds_read_b64_tr_b16 v[60:61], v44 offset:0
    ds_read_b64_tr_b16 v[62:63], v44 offset:256
    ds_read_b64_tr_b16 v[64:65], v44 offset:2048
    ds_read_b64_tr_b16 v[66:67], v44 offset:2304
    ds_read_b64_tr_b16 v[68:69], v45 offset:0
    ds_read_b64_tr_b16 v[70:71], v45 offset:256
    ds_read_b64_tr_b16 v[72:73], v45 offset:2048
    ds_read_b64_tr_b16 v[74:75], v45 offset:2304
    s_waitcnt lgkmcnt(0)
    v_mfma_f32_16x16x32_bf16 v[76:79], v[60:63], v[8:11], 0
    v_mfma_f32_16x16x32_bf16 v[80:83], v[68:71], v[8:11], 0
    v_mfma_f32_16x16x32_bf16 v[84:87], v[60:63], v[16:19], 0
    v_mfma_f32_16x16x32_bf16 v[88:91], v[68:71], v[16:19], 0
    v_mfma_f32_16x16x32_bf16 v[92:95], v[60:63], v[24:27], 0
    v_mfma_f32_16x16x32_bf16 v[96:99], v[68:71], v[24:27], 0
    v_mfma_f32_16x16x32_bf16 v[76:79], v[64:67], v[12:15], v[76:79]
    v_mfma_f32_16x16x32_bf16 v[80:83], v[72:75], v[12:15], v[80:83]
    v_mfma_f32_16x16x32_bf16 v[84:87], v[64:67], v[20:23], v[84:87]
    v_mfma_f32_16x16x32_bf16 v[88:91], v[72:75], v[20:23], v[88:91]
    v_mfma_f32_16x16x32_bf16 v[92:95], v[64:67], v[28:31], v[92:95]
    v_mfma_f32_16x16x32_bf16 v[96:99], v[72:75], v[28:31], v[96:99]
    s_add_u32 s31, s28, 0
    s_cmp_eq_u32 s31, 166
    s_cselect_b32 s39, 0, -1
    s_nop 4
    v_mul_f32 v100, v76, v76
    v_mul_f32 v101, v77, v77
    v_mul_f32 v102, v78, v78
    v_mul_f32 v103, v79, v79
    v_mul_f32 v104, v80, v80
    v_mul_f32 v105, v81, v81
    v_mul_f32 v106, v82, v82
    v_mul_f32 v107, v83, v83
    v_fma_f32 v100, v100, s36, v59
    v_fma_f32 v101, v101, s36, v59
    v_fma_f32 v102, v102, s36, v59
    v_fma_f32 v103, v103, s36, v59
    v_fma_f32 v104, v104, s36, v59
    v_fma_f32 v105, v105, s36, v59
    v_fma_f32 v106, v106, s36, v59
    v_fma_f32 v107, v107, s36, v59
    v_mul_f32 v100, v100, v76
    v_mul_f32 v101, v101, v77
    v_mul_f32 v102, v102, v78
    v_mul_f32 v103, v103, v79
    v_mul_f32 v104, v104, v80
    v_mul_f32 v105, v105, v81
    v_mul_f32 v106, v106, v82
    v_mul_f32 v107, v107, v83
    v_exp_f32 v100, v100
    v_exp_f32 v101, v101
    v_exp_f32 v102, v102
    v_exp_f32 v103, v103
    v_exp_f32 v104, v104
    v_exp_f32 v105, v105
    v_exp_f32 v106, v106
    v_exp_f32 v107, v107
    v_add_f32 v100, 1.0, v100
    v_add_f32 v101, 1.0, v101
    v_add_f32 v102, 1.0, v102
    v_add_f32 v103, 1.0, v103
    v_add_f32 v104, 1.0, v104
    v_add_f32 v105, 1.0, v105
    v_add_f32 v106, 1.0, v106
    v_add_f32 v107, 1.0, v107
    v_rcp_f32 v100, v100
    v_rcp_f32 v101, v101
    v_rcp_f32 v102, v102
    v_rcp_f32 v103, v103
    v_rcp_f32 v104, v104
    v_rcp_f32 v105, v105
    v_rcp_f32 v106, v106
    v_rcp_f32 v107, v107
    v_mul_f32 v76, v76, v100
    v_mul_f32 v77, v77, v101
    v_mul_f32 v78, v78, v102
    v_mul_f32 v79, v79, v103
    v_mul_f32 v80, v80, v104
    v_mul_f32 v81, v81, v105
    v_mul_f32 v82, v82, v106
    v_mul_f32 v83, v83, v107
    v_cvt_pk_bf16_f32 v108, v76, v77
    v_cvt_pk_bf16_f32 v109, v78, v79
    v_cvt_pk_bf16_f32 v110, v80, v81
    v_cvt_pk_bf16_f32 v111, v82, v83
    ds_write_b128 v56, v[108:111] offset:0
    v_mul_f32 v100, v84, v84
    v_mul_f32 v101, v85, v85
    v_mul_f32 v102, v86, v86
    v_mul_f32 v103, v87, v87
    v_mul_f32 v104, v88, v88
    v_mul_f32 v105, v89, v89
    v_mul_f32 v106, v90, v90
    v_mul_f32 v107, v91, v91
    v_fma_f32 v100, v100, s36, v59
    v_fma_f32 v101, v101, s36, v59
    v_fma_f32 v102, v102, s36, v59
    v_fma_f32 v103, v103, s36, v59
    v_fma_f32 v104, v104, s36, v59
    v_fma_f32 v105, v105, s36, v59
    v_fma_f32 v106, v106, s36, v59
    v_fma_f32 v107, v107, s36, v59
    v_mul_f32 v100, v100, v84
    v_mul_f32 v101, v101, v85
    v_mul_f32 v102, v102, v86
    v_mul_f32 v103, v103, v87
    v_mul_f32 v104, v104, v88
    v_mul_f32 v105, v105, v89
    v_mul_f32 v106, v106, v90
    v_mul_f32 v107, v107, v91
    v_exp_f32 v100, v100
    v_exp_f32 v101, v101
    v_exp_f32 v102, v102
    v_exp_f32 v103, v103
    v_exp_f32 v104, v104
    v_exp_f32 v105, v105
    v_exp_f32 v106, v106
    v_exp_f32 v107, v107
    v_add_f32 v100, 1.0, v100
    v_add_f32 v101, 1.0, v101
    v_add_f32 v102, 1.0, v102
    v_add_f32 v103, 1.0, v103
    v_add_f32 v104, 1.0, v104
    v_add_f32 v105, 1.0, v105
    v_add_f32 v106, 1.0, v106
    v_add_f32 v107, 1.0, v107
    v_rcp_f32 v100, v100
    v_rcp_f32 v101, v101
    v_rcp_f32 v102, v102
    v_rcp_f32 v103, v103
    v_rcp_f32 v104, v104
    v_rcp_f32 v105, v105
    v_rcp_f32 v106, v106
    v_rcp_f32 v107, v107
    v_mul_f32 v84, v84, v100
    v_mul_f32 v85, v85, v101
    v_mul_f32 v86, v86, v102
    v_mul_f32 v87, v87, v103
    v_mul_f32 v88, v88, v104
    v_mul_f32 v89, v89, v105
    v_mul_f32 v90, v90, v106
    v_mul_f32 v91, v91, v107
    v_cvt_pk_bf16_f32 v112, v84, v85
    v_cvt_pk_bf16_f32 v113, v86, v87
    v_cvt_pk_bf16_f32 v114, v88, v89
    v_cvt_pk_bf16_f32 v115, v90, v91
    ds_write_b128 v57, v[112:115] offset:512
    v_mul_f32 v100, v92, v92
    v_mul_f32 v101, v93, v93
    v_mul_f32 v102, v94, v94
    v_mul_f32 v103, v95, v95
    v_mul_f32 v104, v96, v96
    v_mul_f32 v105, v97, v97
    v_mul_f32 v106, v98, v98
    v_mul_f32 v107, v99, v99
    v_fma_f32 v100, v100, s36, v59
    v_fma_f32 v101, v101, s36, v59
    v_fma_f32 v102, v102, s36, v59
    v_fma_f32 v103, v103, s36, v59
    v_fma_f32 v104, v104, s36, v59
    v_fma_f32 v105, v105, s36, v59
    v_fma_f32 v106, v106, s36, v59
    v_fma_f32 v107, v107, s36, v59
    v_mul_f32 v100, v100, v92
    v_mul_f32 v101, v101, v93
    v_mul_f32 v102, v102, v94
    v_mul_f32 v103, v103, v95
    v_mul_f32 v104, v104, v96
    v_mul_f32 v105, v105, v97
    v_mul_f32 v106, v106, v98
    v_mul_f32 v107, v107, v99
    v_exp_f32 v100, v100
    v_exp_f32 v101, v101
    v_exp_f32 v102, v102
    v_exp_f32 v103, v103
    v_exp_f32 v104, v104
    v_exp_f32 v105, v105
    v_exp_f32 v106, v106
    v_exp_f32 v107, v107
    v_add_f32 v100, 1.0, v100
    v_add_f32 v101, 1.0, v101
    v_add_f32 v102, 1.0, v102
    v_add_f32 v103, 1.0, v103
    v_add_f32 v104, 1.0, v104
    v_add_f32 v105, 1.0, v105
    v_add_f32 v106, 1.0, v106
    v_add_f32 v107, 1.0, v107
    v_rcp_f32 v100, v100
    v_rcp_f32 v101, v101
    v_rcp_f32 v102, v102
    v_rcp_f32 v103, v103
    v_rcp_f32 v104, v104
    v_rcp_f32 v105, v105
    v_rcp_f32 v106, v106
    v_rcp_f32 v107, v107
    v_mul_f32 v92, v92, v100
    v_mul_f32 v93, v93, v101
    v_mul_f32 v94, v94, v102
    v_mul_f32 v95, v95, v103
    v_mul_f32 v96, v96, v104
    v_mul_f32 v97, v97, v105
    v_mul_f32 v98, v98, v106
    v_mul_f32 v99, v99, v107
    v_cvt_pk_bf16_f32 v116, v92, v93
    v_cvt_pk_bf16_f32 v117, v94, v95
    v_cvt_pk_bf16_f32 v118, v96, v97
    v_cvt_pk_bf16_f32 v119, v98, v99
    v_and_b32 v116, s39, v116
    v_and_b32 v117, s39, v117
    v_and_b32 v118, s39, v118
    v_and_b32 v119, s39, v119
    ds_write_b128 v56, v[116:119] offset:1024
    ds_read_b64_tr_b16 v[60:61], v44 offset:4096
    ds_read_b64_tr_b16 v[62:63], v44 offset:4352
    ds_read_b64_tr_b16 v[64:65], v44 offset:6144
    ds_read_b64_tr_b16 v[66:67], v44 offset:6400
    ds_read_b64_tr_b16 v[68:69], v45 offset:4096
    ds_read_b64_tr_b16 v[70:71], v45 offset:4352
    ds_read_b64_tr_b16 v[72:73], v45 offset:6144
    ds_read_b64_tr_b16 v[74:75], v45 offset:6400
    s_waitcnt lgkmcnt(0)
    v_mfma_f32_16x16x32_bf16 v[76:79], v[60:63], v[8:11], 0
    v_mfma_f32_16x16x32_bf16 v[80:83], v[68:71], v[8:11], 0
    v_mfma_f32_16x16x32_bf16 v[84:87], v[60:63], v[16:19], 0
    v_mfma_f32_16x16x32_bf16 v[88:91], v[68:71], v[16:19], 0
    v_mfma_f32_16x16x32_bf16 v[92:95], v[60:63], v[24:27], 0
    v_mfma_f32_16x16x32_bf16 v[96:99], v[68:71], v[24:27], 0
    v_mfma_f32_16x16x32_bf16 v[76:79], v[64:67], v[12:15], v[76:79]
    v_mfma_f32_16x16x32_bf16 v[80:83], v[72:75], v[12:15], v[80:83]
    v_mfma_f32_16x16x32_bf16 v[84:87], v[64:67], v[20:23], v[84:87]
    v_mfma_f32_16x16x32_bf16 v[88:91], v[72:75], v[20:23], v[88:91]
    v_mfma_f32_16x16x32_bf16 v[92:95], v[64:67], v[28:31], v[92:95]
    v_mfma_f32_16x16x32_bf16 v[96:99], v[72:75], v[28:31], v[96:99]
    s_add_u32 s31, s28, 1
    s_cmp_eq_u32 s31, 166
    s_cselect_b32 s39, 0, -1
    s_nop 4
    v_mul_f32 v100, v76, v76
    v_mul_f32 v101, v77, v77
    v_mul_f32 v102, v78, v78
    v_mul_f32 v103, v79, v79
    v_mul_f32 v104, v80, v80
    v_mul_f32 v105, v81, v81
    v_mul_f32 v106, v82, v82
    v_mul_f32 v107, v83, v83
    v_fma_f32 v100, v100, s36, v59
    v_fma_f32 v101, v101, s36, v59
    v_fma_f32 v102, v102, s36, v59
    v_fma_f32 v103, v103, s36, v59
    v_fma_f32 v104, v104, s36, v59
    v_fma_f32 v105, v105, s36, v59
    v_fma_f32 v106, v106, s36, v59
    v_fma_f32 v107, v107, s36, v59
    v_mul_f32 v100, v100, v76
    v_mul_f32 v101, v101, v77
    v_mul_f32 v102, v102, v78
    v_mul_f32 v103, v103, v79
    v_mul_f32 v104, v104, v80
    v_mul_f32 v105, v105, v81
    v_mul_f32 v106, v106, v82
    v_mul_f32 v107, v107, v83
    v_exp_f32 v100, v100
    v_exp_f32 v101, v101
    v_exp_f32 v102, v102
    v_exp_f32 v103, v103
    v_exp_f32 v104, v104
    v_exp_f32 v105, v105
    v_exp_f32 v106, v106
    v_exp_f32 v107, v107
    v_add_f32 v100, 1.0, v100
    v_add_f32 v101, 1.0, v101
    v_add_f32 v102, 1.0, v102
    v_add_f32 v103, 1.0, v103
    v_add_f32 v104, 1.0, v104
    v_add_f32 v105, 1.0, v105
    v_add_f32 v106, 1.0, v106
    v_add_f32 v107, 1.0, v107
    v_rcp_f32 v100, v100
    v_rcp_f32 v101, v101
    v_rcp_f32 v102, v102
    v_rcp_f32 v103, v103
    v_rcp_f32 v104, v104
    v_rcp_f32 v105, v105
    v_rcp_f32 v106, v106
    v_rcp_f32 v107, v107
    v_mul_f32 v76, v76, v100
    v_mul_f32 v77, v77, v101
    v_mul_f32 v78, v78, v102
    v_mul_f32 v79, v79, v103
    v_mul_f32 v80, v80, v104
    v_mul_f32 v81, v81, v105
    v_mul_f32 v82, v82, v106
    v_mul_f32 v83, v83, v107
    v_cvt_pk_bf16_f32 v108, v76, v77
    v_cvt_pk_bf16_f32 v109, v78, v79
    v_cvt_pk_bf16_f32 v110, v80, v81
    v_cvt_pk_bf16_f32 v111, v82, v83
    ds_write_b128 v57, v[108:111] offset:1536
    v_mul_f32 v100, v84, v84
    v_mul_f32 v101, v85, v85
    v_mul_f32 v102, v86, v86
    v_mul_f32 v103, v87, v87
    v_mul_f32 v104, v88, v88
    v_mul_f32 v105, v89, v89
    v_mul_f32 v106, v90, v90
    v_mul_f32 v107, v91, v91
    v_fma_f32 v100, v100, s36, v59
    v_fma_f32 v101, v101, s36, v59
    v_fma_f32 v102, v102, s36, v59
    v_fma_f32 v103, v103, s36, v59
    v_fma_f32 v104, v104, s36, v59
    v_fma_f32 v105, v105, s36, v59
    v_fma_f32 v106, v106, s36, v59
    v_fma_f32 v107, v107, s36, v59
    v_mul_f32 v100, v100, v84
    v_mul_f32 v101, v101, v85
    v_mul_f32 v102, v102, v86
    v_mul_f32 v103, v103, v87
    v_mul_f32 v104, v104, v88
    v_mul_f32 v105, v105, v89
    v_mul_f32 v106, v106, v90
    v_mul_f32 v107, v107, v91
    v_exp_f32 v100, v100
    v_exp_f32 v101, v101
    v_exp_f32 v102, v102
    v_exp_f32 v103, v103
    v_exp_f32 v104, v104
    v_exp_f32 v105, v105
    v_exp_f32 v106, v106
    v_exp_f32 v107, v107
    v_add_f32 v100, 1.0, v100
    v_add_f32 v101, 1.0, v101
    v_add_f32 v102, 1.0, v102
    v_add_f32 v103, 1.0, v103
    v_add_f32 v104, 1.0, v104
    v_add_f32 v105, 1.0, v105
    v_add_f32 v106, 1.0, v106
    v_add_f32 v107, 1.0, v107
    v_rcp_f32 v100, v100
    v_rcp_f32 v101, v101
    v_rcp_f32 v102, v102
    v_rcp_f32 v103, v103
    v_rcp_f32 v104, v104
    v_rcp_f32 v105, v105
    v_rcp_f32 v106, v106
    v_rcp_f32 v107, v107
    v_mul_f32 v84, v84, v100
    v_mul_f32 v85, v85, v101
    v_mul_f32 v86, v86, v102
    v_mul_f32 v87, v87, v103
    v_mul_f32 v88, v88, v104
    v_mul_f32 v89, v89, v105
    v_mul_f32 v90, v90, v106
    v_mul_f32 v91, v91, v107
    v_cvt_pk_bf16_f32 v112, v84, v85
    v_cvt_pk_bf16_f32 v113, v86, v87
    v_cvt_pk_bf16_f32 v114, v88, v89
    v_cvt_pk_bf16_f32 v115, v90, v91
    ds_write_b128 v56, v[112:115] offset:2048
    v_mul_f32 v100, v92, v92
    v_mul_f32 v101, v93, v93
    v_mul_f32 v102, v94, v94
    v_mul_f32 v103, v95, v95
    v_mul_f32 v104, v96, v96
    v_mul_f32 v105, v97, v97
    v_mul_f32 v106, v98, v98
    v_mul_f32 v107, v99, v99
    v_fma_f32 v100, v100, s36, v59
    v_fma_f32 v101, v101, s36, v59
    v_fma_f32 v102, v102, s36, v59
    v_fma_f32 v103, v103, s36, v59
    v_fma_f32 v104, v104, s36, v59
    v_fma_f32 v105, v105, s36, v59
    v_fma_f32 v106, v106, s36, v59
    v_fma_f32 v107, v107, s36, v59
    v_mul_f32 v100, v100, v92
    v_mul_f32 v101, v101, v93
    v_mul_f32 v102, v102, v94
    v_mul_f32 v103, v103, v95
    v_mul_f32 v104, v104, v96
    v_mul_f32 v105, v105, v97
    v_mul_f32 v106, v106, v98
    v_mul_f32 v107, v107, v99
    v_exp_f32 v100, v100
    v_exp_f32 v101, v101
    v_exp_f32 v102, v102
    v_exp_f32 v103, v103
    v_exp_f32 v104, v104
    v_exp_f32 v105, v105
    v_exp_f32 v106, v106
    v_exp_f32 v107, v107
    v_add_f32 v100, 1.0, v100
    v_add_f32 v101, 1.0, v101
    v_add_f32 v102, 1.0, v102
    v_add_f32 v103, 1.0, v103
    v_add_f32 v104, 1.0, v104
    v_add_f32 v105, 1.0, v105
    v_add_f32 v106, 1.0, v106
    v_add_f32 v107, 1.0, v107
    v_rcp_f32 v100, v100
    v_rcp_f32 v101, v101
    v_rcp_f32 v102, v102
    v_rcp_f32 v103, v103
    v_rcp_f32 v104, v104
    v_rcp_f32 v105, v105
    v_rcp_f32 v106, v106
    v_rcp_f32 v107, v107
    v_mul_f32 v92, v92, v100
    v_mul_f32 v93, v93, v101
    v_mul_f32 v94, v94, v102
    v_mul_f32 v95, v95, v103
    v_mul_f32 v96, v96, v104
    v_mul_f32 v97, v97, v105
    v_mul_f32 v98, v98, v106
    v_mul_f32 v99, v99, v107
    v_cvt_pk_bf16_f32 v116, v92, v93
    v_cvt_pk_bf16_f32 v117, v94, v95
    v_cvt_pk_bf16_f32 v118, v96, v97
    v_cvt_pk_bf16_f32 v119, v98, v99
    v_and_b32 v116, s39, v116
    v_and_b32 v117, s39, v117
    v_and_b32 v118, s39, v118
    v_and_b32 v119, s39, v119
    ds_write_b128 v57, v[116:119] offset:2560
    s_waitcnt vmcnt(0)
    s_waitcnt lgkmcnt(0)
    s_barrier
    ds_read_b64_tr_b16 v[60:61], v49 offset:0
    ds_read_b64_tr_b16 v[62:63], v49 offset:256
    ds_read_b64_tr_b16 v[64:65], v49 offset:2048
    ds_read_b64_tr_b16 v[66:67], v49 offset:2304
    ds_read_b64_tr_b16 v[68:69], v50 offset:0
    ds_read_b64_tr_b16 v[70:71], v50 offset:256
    ds_read_b64_tr_b16 v[72:73], v50 offset:2048
    ds_read_b64_tr_b16 v[74:75], v50 offset:2304
    s_waitcnt lgkmcnt(0)
    v_mfma_f32_16x16x32_bf16 v[92:95], v[60:63], v[32:35], 0
    v_mfma_f32_16x16x32_bf16 v[96:99], v[68:71], v[32:35], 0
    v_mfma_f32_16x16x32_bf16 v[92:95], v[64:67], v[36:39], v[92:95]
    v_mfma_f32_16x16x32_bf16 v[96:99], v[72:75], v[36:39], v[96:99]
    ds_read_b64_tr_b16 v[76:77], v51 offset:0
    ds_read_b64_tr_b16 v[78:79], v53 offset:0
    ds_read_b64_tr_b16 v[80:81], v51 offset:2048
    ds_read_b64_tr_b16 v[82:83], v53 offset:2048
    ds_read_b64_tr_b16 v[84:85], v52 offset:0
    ds_read_b64_tr_b16 v[86:87], v54 offset:0
    ds_read_b64_tr_b16 v[88:89], v52 offset:2048
    ds_read_b64_tr_b16 v[90:91], v54 offset:2048
    v_cvt_pk_bf16_f32 v108, v92, v93
    v_cvt_pk_bf16_f32 v109, v94, v95
    v_cvt_pk_bf16_f32 v110, v96, v97
    v_cvt_pk_bf16_f32 v111, v98, v99
    s_add_u32 s38, s37, 0
    buffer_store_dwordx4 v[108:111], v58, s[16:19], s38 offen
    s_waitcnt lgkmcnt(0)
    v_mfma_f32_16x16x32_bf16 v[100:103], v[76:79], v[32:35], 0
    v_mfma_f32_16x16x32_bf16 v[104:107], v[84:87], v[32:35], 0
    v_mfma_f32_16x16x32_bf16 v[100:103], v[80:83], v[36:39], v[100:103]
    v_mfma_f32_16x16x32_bf16 v[104:107], v[88:91], v[36:39], v[104:107]
    ds_read_b64_tr_b16 v[60:61], v49 offset:3072
    ds_read_b64_tr_b16 v[62:63], v49 offset:3328
    ds_read_b64_tr_b16 v[64:65], v49 offset:5120
    ds_read_b64_tr_b16 v[66:67], v49 offset:5376
    ds_read_b64_tr_b16 v[68:69], v50 offset:3072
    ds_read_b64_tr_b16 v[70:71], v50 offset:3328
    ds_read_b64_tr_b16 v[72:73], v50 offset:5120
    ds_read_b64_tr_b16 v[74:75], v50 offset:5376
    v_cvt_pk_bf16_f32 v112, v100, v101
    v_cvt_pk_bf16_f32 v113, v102, v103
    v_cvt_pk_bf16_f32 v114, v104, v105
    v_cvt_pk_bf16_f32 v115, v106, v107
    s_add_u32 s38, s37, 1024
    buffer_store_dwordx4 v[112:115], v58, s[16:19], s38 offen
    s_waitcnt lgkmcnt(0)
    v_mfma_f32_16x16x32_bf16 v[92:95], v[60:63], v[32:35], 0
    v_mfma_f32_16x16x32_bf16 v[96:99], v[68:71], v[32:35], 0
    v_mfma_f32_16x16x32_bf16 v[92:95], v[64:67], v[36:39], v[92:95]
    v_mfma_f32_16x16x32_bf16 v[96:99], v[72:75], v[36:39], v[96:99]
    ds_read_b64_tr_b16 v[76:77], v51 offset:3072
    ds_read_b64_tr_b16 v[78:79], v53 offset:3072
    ds_read_b64_tr_b16 v[80:81], v51 offset:5120
    ds_read_b64_tr_b16 v[82:83], v53 offset:5120
    ds_read_b64_tr_b16 v[84:85], v52 offset:3072
    ds_read_b64_tr_b16 v[86:87], v54 offset:3072
    ds_read_b64_tr_b16 v[88:89], v52 offset:5120
    ds_read_b64_tr_b16 v[90:91], v54 offset:5120
    v_cvt_pk_bf16_f32 v108, v92, v93
    v_cvt_pk_bf16_f32 v109, v94, v95
    v_cvt_pk_bf16_f32 v110, v96, v97
    v_cvt_pk_bf16_f32 v111, v98, v99
    s_add_u32 s38, s37, 2048
    buffer_store_dwordx4 v[108:111], v58, s[16:19], s38 offen
    s_waitcnt lgkmcnt(0)
    v_mfma_f32_16x16x32_bf16 v[100:103], v[76:79], v[32:35], 0
    v_mfma_f32_16x16x32_bf16 v[104:107], v[84:87], v[32:35], 0
    v_mfma_f32_16x16x32_bf16 v[100:103], v[80:83], v[36:39], v[100:103]
    v_mfma_f32_16x16x32_bf16 v[104:107], v[88:91], v[36:39], v[104:107]
    ds_read_b64_tr_b16 v[60:61], v49 offset:6144
    ds_read_b64_tr_b16 v[62:63], v49 offset:6400
    ds_read_b64_tr_b16 v[64:65], v49 offset:8192
    ds_read_b64_tr_b16 v[66:67], v49 offset:8448
    ds_read_b64_tr_b16 v[68:69], v50 offset:6144
    ds_read_b64_tr_b16 v[70:71], v50 offset:6400
    ds_read_b64_tr_b16 v[72:73], v50 offset:8192
    ds_read_b64_tr_b16 v[74:75], v50 offset:8448
    v_cvt_pk_bf16_f32 v112, v100, v101
    v_cvt_pk_bf16_f32 v113, v102, v103
    v_cvt_pk_bf16_f32 v114, v104, v105
    v_cvt_pk_bf16_f32 v115, v106, v107
    s_add_u32 s38, s37, 3072
    buffer_store_dwordx4 v[112:115], v58, s[16:19], s38 offen
    s_waitcnt lgkmcnt(0)
    v_mfma_f32_16x16x32_bf16 v[92:95], v[60:63], v[32:35], 0
    v_mfma_f32_16x16x32_bf16 v[96:99], v[68:71], v[32:35], 0
    v_mfma_f32_16x16x32_bf16 v[92:95], v[64:67], v[36:39], v[92:95]
    v_mfma_f32_16x16x32_bf16 v[96:99], v[72:75], v[36:39], v[96:99]
    ds_read_b64_tr_b16 v[76:77], v51 offset:6144
    ds_read_b64_tr_b16 v[78:79], v53 offset:6144
    ds_read_b64_tr_b16 v[80:81], v51 offset:8192
    ds_read_b64_tr_b16 v[82:83], v53 offset:8192
    ds_read_b64_tr_b16 v[84:85], v52 offset:6144
    ds_read_b64_tr_b16 v[86:87], v54 offset:6144
    ds_read_b64_tr_b16 v[88:89], v52 offset:8192
    ds_read_b64_tr_b16 v[90:91], v54 offset:8192
    v_cvt_pk_bf16_f32 v108, v92, v93
    v_cvt_pk_bf16_f32 v109, v94, v95
    v_cvt_pk_bf16_f32 v110, v96, v97
    v_cvt_pk_bf16_f32 v111, v98, v99
    s_add_u32 s38, s37, 4096
    buffer_store_dwordx4 v[108:111], v58, s[16:19], s38 offen
    s_waitcnt lgkmcnt(0)
    v_mfma_f32_16x16x32_bf16 v[100:103], v[76:79], v[32:35], 0
    v_mfma_f32_16x16x32_bf16 v[104:107], v[84:87], v[32:35], 0
    v_mfma_f32_16x16x32_bf16 v[100:103], v[80:83], v[36:39], v[100:103]
    v_mfma_f32_16x16x32_bf16 v[104:107], v[88:91], v[36:39], v[104:107]
    s_nop 7
    v_cvt_pk_bf16_f32 v112, v100, v101
    v_cvt_pk_bf16_f32 v113, v102, v103
    v_cvt_pk_bf16_f32 v114, v104, v105
    v_cvt_pk_bf16_f32 v115, v106, v107
    s_add_u32 s38, s37, 5120
    buffer_store_dwordx4 v[112:115], v58, s[16:19], s38 offen
    s_endpgm
L_mid_kernel_g:
    s_sub_u32 s3, s2, 448
    s_load_dwordx2 s[4:5], s[0:1], 16
    s_load_dwordx2 s[6:7], s[0:1], 72
    s_lshr_b32 s24, s3, 4
    s_bfe_u32 s25, s3, 0x20002
    s_and_b32 s26, s3, 3
    s_lshr_b32 s27, s24, 3
    s_and_b32 s28, s24, 7
    v_and_b32 v1, 63, v0
    v_lshrrev_b32 v2, 3, v1
    v_mov_b32 v3, v2
    s_lshl_b32 s29, s25, 3
    s_lshl_b32 s30, s28, 5
    s_add_u32 s29, s29, s30
    v_add_u32 v3, s29, v3
    v_lshlrev_b32 v3, 9, v3
    v_and_b32 v4, 7, v1
    s_lshr_b32 s30, s20, 1
    s_lshl_b32 s30, s30, 2
    v_xor_b32 v4, s30, v4
    v_lshl_add_u32 v3, v4, 4, v3
    s_lshl_b32 s30, s26, 7
    v_add_u32 v3, s30, v3
    v_xor_b32 v4, 32, v3
    s_waitcnt lgkmcnt(0)
    s_mov_b32 s8, s4
    s_mov_b32 s9, s5
    s_mov_b32 s10, 4063232
    s_mov_b32 s11, 0x00020000
    s_add_u32 s12, s6, 60891136
    s_addc_u32 s13, s7, 0
    s_mov_b32 s14, 16916480
    s_mov_b32 s15, 0x00020000
    s_lshl_b32 s30, s20, 3
    s_add_u32 s30, s30, s27
    s_lshl_b32 s30, s30, 17
    s_mul_i32 s31, s20, 4608
    s_add_u32 m0, s31, 0
    s_add_u32 s32, s30, 0
    buffer_load_dwordx4 v3, s[8:11], s32 offen lds
    s_add_u32 m0, s31, 1152
    s_add_u32 s32, s30, 262144
    buffer_load_dwordx4 v3, s[8:11], s32 offen lds
    s_add_u32 m0, s31, 2304
    s_add_u32 s32, s30, 524288
    buffer_load_dwordx4 v4, s[8:11], s32 offen lds
    s_add_u32 m0, s31, 3456
    s_add_u32 s32, s30, 786432
    buffer_load_dwordx4 v4, s[8:11], s32 offen lds
    v_and_b32 v8, 15, v1
    v_or_b32 v9, 1, v8
    s_lshl_b32 s33, s20, 4
    v_add_u32 v9, s33, v9
    v_cvt_f32_u32 v9, v9
    v_mul_f32 v9, 0x3c000000, v9
    v_bfe_u32 v10, v1, 4, 1
    v_lshlrev_b32 v10, 3, v10
    v_cvt_f32_u32 v10, v10
    v_and_b32 v8, 1, v8
    v_cvt_f32_u32 v8, v8
    v_mul_f32 v8, 0x3f400000, v8
    v_fma_f32 v11, v9, v10, v8
    v_fract_f32 v12, v11
    v_add_f32 v11, v11, v9
    v_fract_f32 v13, v11
    v_add_f32 v11, v11, v9
    v_fract_f32 v14, v11
    v_add_f32 v11, v11, v9
    v_fract_f32 v15, v11
    v_add_f32 v11, v11, v9
    v_fract_f32 v16, v11
    v_add_f32 v11, v11, v9
    v_fract_f32 v17, v11
    v_add_f32 v11, v11, v9
    v_fract_f32 v18, v11
    v_add_f32 v11, v11, v9
    v_fract_f32 v19, v11
    v_cos_f32 v12, v12
    v_cos_f32 v13, v13
    v_cos_f32 v14, v14
    v_cos_f32 v15, v15
    v_cos_f32 v16, v16
    v_cos_f32 v17, v17
    v_cos_f32 v18, v18
    v_cos_f32 v19, v19
    s_nop 0
    v_mul_f32 v12, 0x3d000000, v12
    v_mul_f32 v13, 0x3d000000, v13
    v_mul_f32 v14, 0x3d000000, v14
    v_mul_f32 v15, 0x3d000000, v15
    v_mul_f32 v16, 0x3d000000, v16
    v_mul_f32 v17, 0x3d000000, v17
    v_mul_f32 v18, 0x3d000000, v18
    v_mul_f32 v19, 0x3d000000, v19
    v_cvt_pk_bf16_f32 v20, v12, v13
    v_cvt_pk_bf16_f32 v21, v14, v15
    v_cvt_pk_bf16_f32 v22, v16, v17
    v_cvt_pk_bf16_f32 v23, v18, v19
    v_lshlrev_b32 v28, 16, v20
    v_and_b32 v29, 0xffff0000, v20
    v_sub_f32 v28, v12, v28
    v_sub_f32 v29, v13, v29
    v_cvt_pk_bf16_f32 v24, v28, v29
    v_lshlrev_b32 v28, 16, v21
    v_and_b32 v29, 0xffff0000, v21
    v_sub_f32 v28, v14, v28
    v_sub_f32 v29, v15, v29
    v_cvt_pk_bf16_f32 v25, v28, v29
    v_lshlrev_b32 v28, 16, v22
    v_and_b32 v29, 0xffff0000, v22
    v_sub_f32 v28, v16, v28
    v_sub_f32 v29, v17, v29
    v_cvt_pk_bf16_f32 v26, v28, v29
    v_lshlrev_b32 v28, 16, v23
    v_and_b32 v29, 0xffff0000, v23
    v_sub_f32 v28, v18, v28
    v_sub_f32 v29, v19, v29
    v_cvt_pk_bf16_f32 v27, v28, v29
    v_cmp_gt_u32 vcc, 32, v1
    s_nop 1
    v_cndmask_b32 v20, v24, v20, vcc
    v_cndmask_b32 v21, v25, v21, vcc
    v_cndmask_b32 v22, v26, v22, vcc
    v_cndmask_b32 v23, v27, v23, vcc
    v_lshlrev_b32 v28, 4, v1
    s_lshl_b32 s33, s20, 10
    v_add_u32 v29, s33, v28
    ds_write_b128 v29, v[20:23] offset:18432
    v_bfe_u32 v30, v1, 2, 2
    v_bfe_u32 v31, v1, 4, 1
    v_lshl_add_u32 v32, v31, 3, v30
    v_mul_u32_u24 v32, 1152, v32
    v_lshrrev_b32 v30, 1, v30
    v_lshl_add_u32 v30, v31, 1, v30
    v_lshlrev_b32 v30, 1, v30
    v_bfe_u32 v31, v1, 1, 1
    s_lshl_b32 s33, s20, 1
    v_add_u32 v31, s33, v31
    v_xor_b32 v30, v30, v31
    v_lshl_add_u32 v32, v30, 4, v32
    v_and_b32 v30, 1, v1
    v_lshl_add_u32 v32, v30, 3, v32
    v_lshrrev_b32 v30, 4, v1
    s_mov_b32 s33, 1057280
    v_mul_lo_u32 v30, v30, s33
    v_and_b32 v31, 15, v1
    v_lshl_add_u32 v33, v31, 4, v30
    s_lshl_b32 s34, s24, 15
    s_lshl_b32 s35, s26, 2
    s_add_u32 s35, s35, s20
    s_lshl_b32 s35, s35, 11
    s_add_u32 s34, s34, s35
    s_lshl_b32 s35, s25, 8
    s_add_u32 s34, s34, s35
    s_waitcnt vmcnt(0) lgkmcnt(0)
    s_barrier
    ds_read_b128 v[36:39], v28 offset:18432
    ds_read_b128 v[40:43], v28 offset:19456
    ds_read_b128 v[44:47], v28 offset:20480
    ds_read_b128 v[48:51], v28 offset:21504
    ds_read_b64_tr_b16 v[52:53], v32 offset:0
    ds_read_b64_tr_b16 v[54:55], v32 offset:4608
    ds_read_b64_tr_b16 v[56:57], v32 offset:128
    ds_read_b64_tr_b16 v[58:59], v32 offset:4736
    ds_read_b64_tr_b16 v[60:61], v32 offset:256
    ds_read_b64_tr_b16 v[62:63], v32 offset:4864
    ds_read_b64_tr_b16 v[64:65], v32 offset:384
    ds_read_b64_tr_b16 v[66:67], v32 offset:4992
    ds_read_b64_tr_b16 v[68:69], v32 offset:512
    ds_read_b64_tr_b16 v[70:71], v32 offset:5120
    s_waitcnt lgkmcnt(8)
    ds_read_b64_tr_b16 v[72:73], v32 offset:640
    ds_read_b64_tr_b16 v[74:75], v32 offset:5248
    ds_read_b64_tr_b16 v[76:77], v32 offset:768
    ds_read_b64_tr_b16 v[78:79], v32 offset:5376
    ds_read_b64_tr_b16 v[80:81], v32 offset:896
    ds_read_b64_tr_b16 v[82:83], v32 offset:5504
    s_waitcnt lgkmcnt(0)
    v_mfma_f32_16x16x32_bf16 v[84:87], v[36:39], v[52:55], 0
    v_mfma_f32_16x16x32_bf16 v[88:91], v[36:39], v[56:59], 0
    v_mfma_f32_16x16x32_bf16 v[92:95], v[36:39], v[60:63], 0
    v_mfma_f32_16x16x32_bf16 v[96:99], v[36:39], v[64:67], 0
    v_mfma_f32_16x16x32_bf16 v[100:103], v[36:39], v[68:71], 0
    v_mfma_f32_16x16x32_bf16 v[104:107], v[36:39], v[72:75], 0
    v_mfma_f32_16x16x32_bf16 v[108:111], v[36:39], v[76:79], 0
    v_mfma_f32_16x16x32_bf16 v[112:115], v[36:39], v[80:83], 0
    s_nop 7
    v_cvt_pk_bf16_f32 v116, v84, v88
    v_cvt_pk_bf16_f32 v117, v92, v96
    v_cvt_pk_bf16_f32 v118, v100, v104
    v_cvt_pk_bf16_f32 v119, v108, v112
    s_add_u32 s35, s34, 0
    buffer_store_dwordx4 v[116:119], v33, s[12:15], s35 offen
    s_nop 1
    v_cvt_pk_bf16_f32 v120, v85, v89
    v_cvt_pk_bf16_f32 v121, v93, v97
    v_cvt_pk_bf16_f32 v122, v101, v105
    v_cvt_pk_bf16_f32 v123, v109, v113
    s_add_u32 s35, s34, 1024
    buffer_store_dwordx4 v[120:123], v33, s[12:15], s35 offen
    s_nop 1
    v_cvt_pk_bf16_f32 v116, v86, v90
    v_cvt_pk_bf16_f32 v117, v94, v98
    v_cvt_pk_bf16_f32 v118, v102, v106
    v_cvt_pk_bf16_f32 v119, v110, v114
    s_add_u32 s35, s34, 528640
    buffer_store_dwordx4 v[116:119], v33, s[12:15], s35 offen
    s_nop 1
    v_cvt_pk_bf16_f32 v120, v87, v91
    v_cvt_pk_bf16_f32 v121, v95, v99
    v_cvt_pk_bf16_f32 v122, v103, v107
    v_cvt_pk_bf16_f32 v123, v111, v115
    s_add_u32 s35, s34, 529664
    buffer_store_dwordx4 v[120:123], v33, s[12:15], s35 offen
    s_nop 1
    v_mfma_f32_16x16x32_bf16 v[84:87], v[40:43], v[52:55], 0
    v_mfma_f32_16x16x32_bf16 v[88:91], v[40:43], v[56:59], 0
    v_mfma_f32_16x16x32_bf16 v[92:95], v[40:43], v[60:63], 0
    v_mfma_f32_16x16x32_bf16 v[96:99], v[40:43], v[64:67], 0
    v_mfma_f32_16x16x32_bf16 v[100:103], v[40:43], v[68:71], 0
    v_mfma_f32_16x16x32_bf16 v[104:107], v[40:43], v[72:75], 0
    v_mfma_f32_16x16x32_bf16 v[108:111], v[40:43], v[76:79], 0
    v_mfma_f32_16x16x32_bf16 v[112:115], v[40:43], v[80:83], 0
    s_nop 7
    v_cvt_pk_bf16_f32 v116, v84, v88
    v_cvt_pk_bf16_f32 v117, v92, v96
    v_cvt_pk_bf16_f32 v118, v100, v104
    v_cvt_pk_bf16_f32 v119, v108, v112
    s_add_u32 s35, s34, 4229120
    buffer_store_dwordx4 v[116:119], v33, s[12:15], s35 offen
    s_nop 1
    v_cvt_pk_bf16_f32 v120, v85, v89
    v_cvt_pk_bf16_f32 v121, v93, v97
    v_cvt_pk_bf16_f32 v122, v101, v105
    v_cvt_pk_bf16_f32 v123, v109, v113
    s_add_u32 s35, s34, 4230144
    buffer_store_dwordx4 v[120:123], v33, s[12:15], s35 offen
    s_nop 1
    v_cvt_pk_bf16_f32 v116, v86, v90
    v_cvt_pk_bf16_f32 v117, v94, v98
    v_cvt_pk_bf16_f32 v118, v102, v106
    v_cvt_pk_bf16_f32 v119, v110, v114
    s_add_u32 s35, s34, 4757760
    buffer_store_dwordx4 v[116:119], v33, s[12:15], s35 offen
    s_nop 1
    v_cvt_pk_bf16_f32 v120, v87, v91
    v_cvt_pk_bf16_f32 v121, v95, v99
    v_cvt_pk_bf16_f32 v122, v103, v107
    v_cvt_pk_bf16_f32 v123, v111, v115
    s_add_u32 s35, s34, 4758784
    buffer_store_dwordx4 v[120:123], v33, s[12:15], s35 offen
    s_nop 1
    v_mfma_f32_16x16x32_bf16 v[84:87], v[44:47], v[52:55], 0
    v_mfma_f32_16x16x32_bf16 v[88:91], v[44:47], v[56:59], 0
    v_mfma_f32_16x16x32_bf16 v[92:95], v[44:47], v[60:63], 0
    v_mfma_f32_16x16x32_bf16 v[96:99], v[44:47], v[64:67], 0
    v_mfma_f32_16x16x32_bf16 v[100:103], v[44:47], v[68:71], 0
    v_mfma_f32_16x16x32_bf16 v[104:107], v[44:47], v[72:75], 0
    v_mfma_f32_16x16x32_bf16 v[108:111], v[44:47], v[76:79], 0
    v_mfma_f32_16x16x32_bf16 v[112:115], v[44:47], v[80:83], 0
    s_nop 7
    v_cvt_pk_bf16_f32 v116, v84, v88
    v_cvt_pk_bf16_f32 v117, v92, v96
    v_cvt_pk_bf16_f32 v118, v100, v104
    v_cvt_pk_bf16_f32 v119, v108, v112
    s_add_u32 s35, s34, 8458240
    buffer_store_dwordx4 v[116:119], v33, s[12:15], s35 offen
    s_nop 1
    v_cvt_pk_bf16_f32 v120, v85, v89
    v_cvt_pk_bf16_f32 v121, v93, v97
    v_cvt_pk_bf16_f32 v122, v101, v105
    v_cvt_pk_bf16_f32 v123, v109, v113
    s_add_u32 s35, s34, 8459264
    buffer_store_dwordx4 v[120:123], v33, s[12:15], s35 offen
    s_nop 1
    v_cvt_pk_bf16_f32 v116, v86, v90
    v_cvt_pk_bf16_f32 v117, v94, v98
    v_cvt_pk_bf16_f32 v118, v102, v106
    v_cvt_pk_bf16_f32 v119, v110, v114
    s_add_u32 s35, s34, 8986880
    buffer_store_dwordx4 v[116:119], v33, s[12:15], s35 offen
    s_nop 1
    v_cvt_pk_bf16_f32 v120, v87, v91
    v_cvt_pk_bf16_f32 v121, v95, v99
    v_cvt_pk_bf16_f32 v122, v103, v107
    v_cvt_pk_bf16_f32 v123, v111, v115
    s_add_u32 s35, s34, 8987904
    buffer_store_dwordx4 v[120:123], v33, s[12:15], s35 offen
    s_nop 1
    v_mfma_f32_16x16x32_bf16 v[84:87], v[48:51], v[52:55], 0
    v_mfma_f32_16x16x32_bf16 v[88:91], v[48:51], v[56:59], 0
    v_mfma_f32_16x16x32_bf16 v[92:95], v[48:51], v[60:63], 0
    v_mfma_f32_16x16x32_bf16 v[96:99], v[48:51], v[64:67], 0
    v_mfma_f32_16x16x32_bf16 v[100:103], v[48:51], v[68:71], 0
    v_mfma_f32_16x16x32_bf16 v[104:107], v[48:51], v[72:75], 0
    v_mfma_f32_16x16x32_bf16 v[108:111], v[48:51], v[76:79], 0
    v_mfma_f32_16x16x32_bf16 v[112:115], v[48:51], v[80:83], 0
    s_nop 7
    v_cvt_pk_bf16_f32 v116, v84, v88
    v_cvt_pk_bf16_f32 v117, v92, v96
    v_cvt_pk_bf16_f32 v118, v100, v104
    v_cvt_pk_bf16_f32 v119, v108, v112
    s_add_u32 s35, s34, 12687360
    buffer_store_dwordx4 v[116:119], v33, s[12:15], s35 offen
    s_nop 1
    v_cvt_pk_bf16_f32 v120, v85, v89
    v_cvt_pk_bf16_f32 v121, v93, v97
    v_cvt_pk_bf16_f32 v122, v101, v105
    v_cvt_pk_bf16_f32 v123, v109, v113
    s_add_u32 s35, s34, 12688384
    buffer_store_dwordx4 v[120:123], v33, s[12:15], s35 offen
    s_nop 1
    v_cvt_pk_bf16_f32 v116, v86, v90
    v_cvt_pk_bf16_f32 v117, v94, v98
    v_cvt_pk_bf16_f32 v118, v102, v106
    v_cvt_pk_bf16_f32 v119, v110, v114
    s_add_u32 s35, s34, 13216000
    buffer_store_dwordx4 v[116:119], v33, s[12:15], s35 offen
    s_nop 1
    v_cvt_pk_bf16_f32 v120, v87, v91
    v_cvt_pk_bf16_f32 v121, v95, v99
    v_cvt_pk_bf16_f32 v122, v103, v107
    v_cvt_pk_bf16_f32 v123, v111, v115
    s_add_u32 s35, s34, 13217024
    buffer_store_dwordx4 v[120:123], v33, s[12:15], s35 offen
    s_nop 1
    s_endpgm
L_mid_kernel_done:
    s_endpgm
.globl gemm2_kernel
.p2align 8
.type gemm2_kernel,@function
gemm2_kernel:
    s_cmp_ge_u32 s2, 256
    s_cbranch_scc1 L_gemm2_kernel_done
    s_load_dwordx2 s[4:5], s[0:1], 72
    v_readfirstlane_b32 s20, v0
    s_lshr_b32 s20, s20, 6
    s_and_b32 s24, s2, 7
    s_lshr_b32 s25, s2, 3
    s_lshr_b32 s26, s25, 3
    s_lshl_b32 s24, s24, 2
    s_add_u32 s21, s24, s26
    s_and_b32 s25, s25, 7
    s_lshr_b32 s26, s25, 2
    s_and_b32 s27, s25, 3
    s_mul_i32 s22, s26, 84
    s_sub_u32 s28, 168, s22
    s_min_u32 s28, s28, 84
    s_waitcnt lgkmcnt(0)
    s_mul_i32 s29, s21, 344064
    s_lshl_b32 s30, s22, 11
    s_add_u32 s29, s29, s30
    s_add_u32 s29, s29, 49815552
    s_add_u32 s8, s4, s29
    s_addc_u32 s9, s5, 0
    s_lshl_b32 s10, s28, 11
    s_mov_b32 s11, 0x00020000
    s_mul_i32 s29, s21, 528640
    s_mul_i32 s30, s27, 8192
    s_add_u32 s29, s29, s30
    s_add_u32 s29, s29, 60891136
    s_add_u32 s12, s4, s29
    s_addc_u32 s13, s5, 0
    s_mov_b32 s14, 499712
    s_mov_b32 s15, 0x00020000
    s_cmp_ge_u32 s20, 4
    s_cbranch_scc1 L_gemm2_kernel_loader
    s_lshl_b32 s29, s22, 15
    s_add_u32 s29, s29, 77807616
    s_add_u32 s16, s4, s29
    s_addc_u32 s17, s5, 0
    s_lshl_b32 s18, s28, 15
    s_mov_b32 s19, 0x00020000
    s_lshr_b32 s29, s20, 1
    s_and_b32 s30, s20, 1
    v_and_b32 v137, 15, v0
    v_bfe_u32 v138, v0, 4, 2
    v_and_b32 v139, 63, v0
    s_mul_i32 s31, s29, 6144
    v_and_b32 v140, 7, v137
    v_xor_b32 v140, v138, v140
    v_lshlrev_b32 v140, 4, v140
    v_lshl_add_u32 v140, v137, 7, v140
    v_add_u32 v140, s31, v140
    v_add_u32 v128, 0, v140
    v_xor_b32 v131, 64, v128
    v_add_u32 v129, 61440, v140
    v_xor_b32 v132, 64, v129
    v_add_u32 v130, 122880, v140
    v_xor_b32 v133, 64, v130
    s_mul_i32 s31, s30, 4096
    s_add_u32 s31, s31, 12288
    v_lshlrev_b32 v140, 4, v139
    v_add_u32 v140, s31, v140
    v_add_u32 v134, 0, v140
    v_add_u32 v135, 61440, v140
    v_add_u32 v136, 122880, v140
    s_mul_i32 s31, s29, 1572864
    v_lshlrev_b32 v141, 15, v137
    v_lshl_add_u32 v141, v138, 4, v141
    v_add_u32 v141, s31, v141
    s_mul_i32 s31, s27, 2
    s_mul_i32 s29, s30, 1
    s_add_u32 s31, s31, s29
    s_lshl_b32 s31, s31, 12
    s_lshl_b32 s29, s21, 7
    s_add_u32 s33, s31, s29
    s_mov_b32 s34, 0x80008000
    s_barrier
    ds_read_b128 v[48:51], v134 offset:0
    ds_read_b128 v[64:67], v128 offset:0
    ds_read_b128 v[72:75], v128 offset:2048
    ds_read_b128 v[80:83], v128 offset:4096
    ds_read_b128 v[56:59], v134 offset:2048
    ds_read_b128 v[68:71], v131 offset:0
    ds_read_b128 v[76:79], v131 offset:2048
    ds_read_b128 v[84:87], v131 offset:4096
    ds_read_b128 v[52:55], v134 offset:1024
    ds_read_b128 v[60:63], v134 offset:3072
    s_waitcnt lgkmcnt(0)
    s_barrier
    v_mfma_f32_16x16x32_bf16 v[0:3], v[48:51], v[64:67], 0
    ds_read_b128 v[88:91], v134 offset:20480
    v_mfma_f32_16x16x32_bf16 v[4:7], v[48:51], v[72:75], 0
    ds_read_b128 v[104:107], v128 offset:20480
    v_mfma_f32_16x16x32_bf16 v[8:11], v[48:51], v[80:83], 0
    ds_read_b128 v[112:115], v128 offset:22528
    v_mfma_f32_16x16x32_bf16 v[12:15], v[56:59], v[64:67], 0
    ds_read_b128 v[120:123], v128 offset:24576
    v_mfma_f32_16x16x32_bf16 v[16:19], v[56:59], v[72:75], 0
    ds_read_b128 v[96:99], v134 offset:22528
    v_mfma_f32_16x16x32_bf16 v[20:23], v[56:59], v[80:83], 0
    ds_read_b128 v[108:111], v131 offset:20480
    v_mfma_f32_16x16x32_bf16 v[24:27], v[48:51], v[68:71], 0
    ds_read_b128 v[116:119], v131 offset:22528
    v_mfma_f32_16x16x32_bf16 v[28:31], v[48:51], v[76:79], 0
    ds_read_b128 v[124:127], v131 offset:24576
    v_mfma_f32_16x16x32_bf16 v[32:35], v[48:51], v[84:87], 0
    ds_read_b128 v[92:95], v134 offset:21504
    v_mfma_f32_16x16x32_bf16 v[36:39], v[56:59], v[68:71], 0
    ds_read_b128 v[100:103], v134 offset:23552
    v_mfma_f32_16x16x32_bf16 v[40:43], v[56:59], v[76:79], 0
    v_mfma_f32_16x16x32_bf16 v[44:47], v[56:59], v[84:87], 0
    v_mfma_f32_16x16x32_bf16 v[24:27], v[52:55], v[64:67], v[24:27]
    v_xor_b32 v68, s34, v68
    v_xor_b32 v69, s34, v69
    v_mfma_f32_16x16x32_bf16 v[28:31], v[52:55], v[72:75], v[28:31]
    v_xor_b32 v70, s34, v70
    v_xor_b32 v71, s34, v71
    v_mfma_f32_16x16x32_bf16 v[32:35], v[52:55], v[80:83], v[32:35]
    v_xor_b32 v76, s34, v76
    v_xor_b32 v77, s34, v77
    v_mfma_f32_16x16x32_bf16 v[36:39], v[60:63], v[64:67], v[36:39]
    v_xor_b32 v78, s34, v78
    v_xor_b32 v79, s34, v79
    v_mfma_f32_16x16x32_bf16 v[40:43], v[60:63], v[72:75], v[40:43]
    v_xor_b32 v84, s34, v84
    v_xor_b32 v85, s34, v85
    v_mfma_f32_16x16x32_bf16 v[44:47], v[60:63], v[80:83], v[44:47]
    v_xor_b32 v86, s34, v86
    v_xor_b32 v87, s34, v87
    v_mfma_f32_16x16x32_bf16 v[0:3], v[52:55], v[68:71], v[0:3]
    v_mfma_f32_16x16x32_bf16 v[4:7], v[52:55], v[76:79], v[4:7]
    v_mfma_f32_16x16x32_bf16 v[8:11], v[52:55], v[84:87], v[8:11]
    s_waitcnt lgkmcnt(0)
    s_barrier
    v_mfma_f32_16x16x32_bf16 v[12:15], v[60:63], v[68:71], v[12:15]
    v_mfma_f32_16x16x32_bf16 v[16:19], v[60:63], v[76:79], v[16:19]
    v_mfma_f32_16x16x32_bf16 v[20:23], v[60:63], v[84:87], v[20:23]
    v_mfma_f32_16x16x32_bf16 v[0:3], v[88:91], v[104:107], v[0:3]
    ds_read_b128 v[48:51], v134 offset:40960
    v_mfma_f32_16x16x32_bf16 v[4:7], v[88:91], v[112:115], v[4:7]
    ds_read_b128 v[64:67], v128 offset:40960
    v_mfma_f32_16x16x32_bf16 v[8:11], v[88:91], v[120:123], v[8:11]
    ds_read_b128 v[72:75], v128 offset:43008
    v_mfma_f32_16x16x32_bf16 v[12:15], v[96:99], v[104:107], v[12:15]
    ds_read_b128 v[80:83], v128 offset:45056
    v_mfma_f32_16x16x32_bf16 v[16:19], v[96:99], v[112:115], v[16:19]
    ds_read_b128 v[56:59], v134 offset:43008
    v_mfma_f32_16x16x32_bf16 v[20:23], v[96:99], v[120:123], v[20:23]
    ds_read_b128 v[68:71], v131 offset:40960
    v_mfma_f32_16x16x32_bf16 v[24:27], v[88:91], v[108:111], v[24:27]
    ds_read_b128 v[76:79], v131 offset:43008
    v_mfma_f32_16x16x32_bf16 v[28:31], v[88:91], v[116:119], v[28:31]
    ds_read_b128 v[84:87], v131 offset:45056
    v_mfma_f32_16x16x32_bf16 v[32:35], v[88:91], v[124:127], v[32:35]
    ds_read_b128 v[52:55], v134 offset:41984
    v_mfma_f32_16x16x32_bf16 v[36:39], v[96:99], v[108:111], v[36:39]
    ds_read_b128 v[60:63], v134 offset:44032
    v_mfma_f32_16x16x32_bf16 v[40:43], v[96:99], v[116:119], v[40:43]
    v_mfma_f32_16x16x32_bf16 v[44:47], v[96:99], v[124:127], v[44:47]
    v_mfma_f32_16x16x32_bf16 v[24:27], v[92:95], v[104:107], v[24:27]
    v_xor_b32 v108, s34, v108
    v_xor_b32 v109, s34, v109
    v_mfma_f32_16x16x32_bf16 v[28:31], v[92:95], v[112:115], v[28:31]
    v_xor_b32 v110, s34, v110
    v_xor_b32 v111, s34, v111
    v_mfma_f32_16x16x32_bf16 v[32:35], v[92:95], v[120:123], v[32:35]
    v_xor_b32 v116, s34, v116
    v_xor_b32 v117, s34, v117
    v_mfma_f32_16x16x32_bf16 v[36:39], v[100:103], v[104:107], v[36:39]
    v_xor_b32 v118, s34, v118
    v_xor_b32 v119, s34, v119
    v_mfma_f32_16x16x32_bf16 v[40:43], v[100:103], v[112:115], v[40:43]
    v_xor_b32 v124, s34, v124
    v_xor_b32 v125, s34, v125
    v_mfma_f32_16x16x32_bf16 v[44:47], v[100:103], v[120:123], v[44:47]
    v_xor_b32 v126, s34, v126
    v_xor_b32 v127, s34, v127
    v_mfma_f32_16x16x32_bf16 v[0:3], v[92:95], v[108:111], v[0:3]
    v_mfma_f32_16x16x32_bf16 v[4:7], v[92:95], v[116:119], v[4:7]
    v_mfma_f32_16x16x32_bf16 v[8:11], v[92:95], v[124:127], v[8:11]
    s_waitcnt lgkmcnt(0)
    s_barrier
    v_mfma_f32_16x16x32_bf16 v[12:15], v[100:103], v[108:111], v[12:15]
    v_mfma_f32_16x16x32_bf16 v[16:19], v[100:103], v[116:119], v[16:19]
    v_mfma_f32_16x16x32_bf16 v[20:23], v[100:103], v[124:127], v[20:23]
    v_mfma_f32_16x16x32_bf16 v[0:3], v[48:51], v[64:67], v[0:3]
    ds_read_b128 v[88:91], v135 offset:0
    v_mfma_f32_16x16x32_bf16 v[4:7], v[48:51], v[72:75], v[4:7]
    ds_read_b128 v[104:107], v129 offset:0
    v_mfma_f32_16x16x32_bf16 v[8:11], v[48:51], v[80:83], v[8:11]
    ds_read_b128 v[112:115], v129 offset:2048
    v_mfma_f32_16x16x32_bf16 v[12:15], v[56:59], v[64:67], v[12:15]
    ds_read_b128 v[120:123], v129 offset:4096
    v_mfma_f32_16x16x32_bf16 v[16:19], v[56:59], v[72:75], v[16:19]
    ds_read_b128 v[96:99], v135 offset:2048
    v_mfma_f32_16x16x32_bf16 v[20:23], v[56:59], v[80:83], v[20:23]
    ds_read_b128 v[108:111], v132 offset:0
    v_mfma_f32_16x16x32_bf16 v[24:27], v[48:51], v[68:71], v[24:27]
    ds_read_b128 v[116:119], v132 offset:2048
    v_mfma_f32_16x16x32_bf16 v[28:31], v[48:51], v[76:79], v[28:31]
    ds_read_b128 v[124:127], v132 offset:4096
    v_mfma_f32_16x16x32_bf16 v[32:35], v[48:51], v[84:87], v[32:35]
    ds_read_b128 v[92:95], v135 offset:1024
    v_mfma_f32_16x16x32_bf16 v[36:39], v[56:59], v[68:71], v[36:39]
    ds_read_b128 v[100:103], v135 offset:3072
    v_mfma_f32_16x16x32_bf16 v[40:43], v[56:59], v[76:79], v[40:43]
    v_mfma_f32_16x16x32_bf16 v[44:47], v[56:59], v[84:87], v[44:47]
    v_mfma_f32_16x16x32_bf16 v[24:27], v[52:55], v[64:67], v[24:27]
    v_xor_b32 v68, s34, v68
    v_xor_b32 v69, s34, v69
    v_mfma_f32_16x16x32_bf16 v[28:31], v[52:55], v[72:75], v[28:31]
    v_xor_b32 v70, s34, v70
    v_xor_b32 v71, s34, v71
    v_mfma_f32_16x16x32_bf16 v[32:35], v[52:55], v[80:83], v[32:35]
    v_xor_b32 v76, s34, v76
    v_xor_b32 v77, s34, v77
    v_mfma_f32_16x16x32_bf16 v[36:39], v[60:63], v[64:67], v[36:39]
    v_xor_b32 v78, s34, v78
    v_xor_b32 v79, s34, v79
    v_mfma_f32_16x16x32_bf16 v[40:43], v[60:63], v[72:75], v[40:43]
    v_xor_b32 v84, s34, v84
    v_xor_b32 v85, s34, v85
    v_mfma_f32_16x16x32_bf16 v[44:47], v[60:63], v[80:83], v[44:47]
    v_xor_b32 v86, s34, v86
    v_xor_b32 v87, s34, v87
    v_mfma_f32_16x16x32_bf16 v[0:3], v[52:55], v[68:71], v[0:3]
    v_mfma_f32_16x16x32_bf16 v[4:7], v[52:55], v[76:79], v[4:7]
    v_mfma_f32_16x16x32_bf16 v[8:11], v[52:55], v[84:87], v[8:11]
    s_waitcnt lgkmcnt(0)
    s_barrier
    v_mfma_f32_16x16x32_bf16 v[12:15], v[60:63], v[68:71], v[12:15]
    v_mfma_f32_16x16x32_bf16 v[16:19], v[60:63], v[76:79], v[16:19]
    v_mfma_f32_16x16x32_bf16 v[20:23], v[60:63], v[84:87], v[20:23]
    v_mfma_f32_16x16x32_bf16 v[0:3], v[88:91], v[104:107], v[0:3]
    ds_read_b128 v[48:51], v135 offset:20480
    v_mfma_f32_16x16x32_bf16 v[4:7], v[88:91], v[112:115], v[4:7]
    ds_read_b128 v[64:67], v129 offset:20480
    v_mfma_f32_16x16x32_bf16 v[8:11], v[88:91], v[120:123], v[8:11]
    ds_read_b128 v[72:75], v129 offset:22528
    v_mfma_f32_16x16x32_bf16 v[12:15], v[96:99], v[104:107], v[12:15]
    ds_read_b128 v[80:83], v129 offset:24576
    v_mfma_f32_16x16x32_bf16 v[16:19], v[96:99], v[112:115], v[16:19]
    ds_read_b128 v[56:59], v135 offset:22528
    v_mfma_f32_16x16x32_bf16 v[20:23], v[96:99], v[120:123], v[20:23]
    ds_read_b128 v[68:71], v132 offset:20480
    v_mfma_f32_16x16x32_bf16 v[24:27], v[88:91], v[108:111], v[24:27]
    ds_read_b128 v[76:79], v132 offset:22528
    v_mfma_f32_16x16x32_bf16 v[28:31], v[88:91], v[116:119], v[28:31]
    ds_read_b128 v[84:87], v132 offset:24576
    v_mfma_f32_16x16x32_bf16 v[32:35], v[88:91], v[124:127], v[32:35]
    ds_read_b128 v[52:55], v135 offset:21504
    v_mfma_f32_16x16x32_bf16 v[36:39], v[96:99], v[108:111], v[36:39]
    ds_read_b128 v[60:63], v135 offset:23552
    v_mfma_f32_16x16x32_bf16 v[40:43], v[96:99], v[116:119], v[40:43]
    v_mfma_f32_16x16x32_bf16 v[44:47], v[96:99], v[124:127], v[44:47]
    v_mfma_f32_16x16x32_bf16 v[24:27], v[92:95], v[104:107], v[24:27]
    v_xor_b32 v108, s34, v108
    v_xor_b32 v109, s34, v109
    v_mfma_f32_16x16x32_bf16 v[28:31], v[92:95], v[112:115], v[28:31]
    v_xor_b32 v110, s34, v110
    v_xor_b32 v111, s34, v111
    v_mfma_f32_16x16x32_bf16 v[32:35], v[92:95], v[120:123], v[32:35]
    v_xor_b32 v116, s34, v116
    v_xor_b32 v117, s34, v117
    v_mfma_f32_16x16x32_bf16 v[36:39], v[100:103], v[104:107], v[36:39]
    v_xor_b32 v118, s34, v118
    v_xor_b32 v119, s34, v119
    v_mfma_f32_16x16x32_bf16 v[40:43], v[100:103], v[112:115], v[40:43]
    v_xor_b32 v124, s34, v124
    v_xor_b32 v125, s34, v125
    v_mfma_f32_16x16x32_bf16 v[44:47], v[100:103], v[120:123], v[44:47]
    v_xor_b32 v126, s34, v126
    v_xor_b32 v127, s34, v127
    v_mfma_f32_16x16x32_bf16 v[0:3], v[92:95], v[108:111], v[0:3]
    v_mfma_f32_16x16x32_bf16 v[4:7], v[92:95], v[116:119], v[4:7]
    v_mfma_f32_16x16x32_bf16 v[8:11], v[92:95], v[124:127], v[8:11]
    s_waitcnt lgkmcnt(0)
    s_barrier
    v_mfma_f32_16x16x32_bf16 v[12:15], v[100:103], v[108:111], v[12:15]
    v_mfma_f32_16x16x32_bf16 v[16:19], v[100:103], v[116:119], v[16:19]
    v_mfma_f32_16x16x32_bf16 v[20:23], v[100:103], v[124:127], v[20:23]
    v_mfma_f32_16x16x32_bf16 v[0:3], v[48:51], v[64:67], v[0:3]
    ds_read_b128 v[88:91], v135 offset:40960
    v_mfma_f32_16x16x32_bf16 v[4:7], v[48:51], v[72:75], v[4:7]
    ds_read_b128 v[104:107], v129 offset:40960
    v_mfma_f32_16x16x32_bf16 v[8:11], v[48:51], v[80:83], v[8:11]
    ds_read_b128 v[112:115], v129 offset:43008
    v_mfma_f32_16x16x32_bf16 v[12:15], v[56:59], v[64:67], v[12:15]
    ds_read_b128 v[120:123], v129 offset:45056
    v_mfma_f32_16x16x32_bf16 v[16:19], v[56:59], v[72:75], v[16:19]
    ds_read_b128 v[96:99], v135 offset:43008
    v_mfma_f32_16x16x32_bf16 v[20:23], v[56:59], v[80:83], v[20:23]
    ds_read_b128 v[108:111], v132 offset:40960
    v_mfma_f32_16x16x32_bf16 v[24:27], v[48:51], v[68:71], v[24:27]
    ds_read_b128 v[116:119], v132 offset:43008
    v_mfma_f32_16x16x32_bf16 v[28:31], v[48:51], v[76:79], v[28:31]
    ds_read_b128 v[124:127], v132 offset:45056
    v_mfma_f32_16x16x32_bf16 v[32:35], v[48:51], v[84:87], v[32:35]
    ds_read_b128 v[92:95], v135 offset:41984
    v_mfma_f32_16x16x32_bf16 v[36:39], v[56:59], v[68:71], v[36:39]
    ds_read_b128 v[100:103], v135 offset:44032
    v_mfma_f32_16x16x32_bf16 v[40:43], v[56:59], v[76:79], v[40:43]
    v_mfma_f32_16x16x32_bf16 v[44:47], v[56:59], v[84:87], v[44:47]
    v_mfma_f32_16x16x32_bf16 v[24:27], v[52:55], v[64:67], v[24:27]
    v_xor_b32 v68, s34, v68
    v_xor_b32 v69, s34, v69
    v_mfma_f32_16x16x32_bf16 v[28:31], v[52:55], v[72:75], v[28:31]
    v_xor_b32 v70, s34, v70
    v_xor_b32 v71, s34, v71
    v_mfma_f32_16x16x32_bf16 v[32:35], v[52:55], v[80:83], v[32:35]
    v_xor_b32 v76, s34, v76
    v_xor_b32 v77, s34, v77
    v_mfma_f32_16x16x32_bf16 v[36:39], v[60:63], v[64:67], v[36:39]
    v_xor_b32 v78, s34, v78
    v_xor_b32 v79, s34, v79
    v_mfma_f32_16x16x32_bf16 v[40:43], v[60:63], v[72:75], v[40:43]
    v_xor_b32 v84, s34, v84
    v_xor_b32 v85, s34, v85
    v_mfma_f32_16x16x32_bf16 v[44:47], v[60:63], v[80:83], v[44:47]
    v_xor_b32 v86, s34, v86
    v_xor_b32 v87, s34, v87
    v_mfma_f32_16x16x32_bf16 v[0:3], v[52:55], v[68:71], v[0:3]
    v_mfma_f32_16x16x32_bf16 v[4:7], v[52:55], v[76:79], v[4:7]
    v_mfma_f32_16x16x32_bf16 v[8:11], v[52:55], v[84:87], v[8:11]
    s_waitcnt lgkmcnt(0)
    s_barrier
    v_mfma_f32_16x16x32_bf16 v[12:15], v[60:63], v[68:71], v[12:15]
    v_mfma_f32_16x16x32_bf16 v[16:19], v[60:63], v[76:79], v[16:19]
    v_mfma_f32_16x16x32_bf16 v[20:23], v[60:63], v[84:87], v[20:23]
    v_mfma_f32_16x16x32_bf16 v[0:3], v[88:91], v[104:107], v[0:3]
    ds_read_b128 v[48:51], v136 offset:0
    v_mfma_f32_16x16x32_bf16 v[4:7], v[88:91], v[112:115], v[4:7]
    ds_read_b128 v[64:67], v130 offset:0
    v_mfma_f32_16x16x32_bf16 v[8:11], v[88:91], v[120:123], v[8:11]
    ds_read_b128 v[72:75], v130 offset:2048
    v_mfma_f32_16x16x32_bf16 v[12:15], v[96:99], v[104:107], v[12:15]
    ds_read_b128 v[80:83], v130 offset:4096
    v_mfma_f32_16x16x32_bf16 v[16:19], v[96:99], v[112:115], v[16:19]
    ds_read_b128 v[56:59], v136 offset:2048
    v_mfma_f32_16x16x32_bf16 v[20:23], v[96:99], v[120:123], v[20:23]
    ds_read_b128 v[68:71], v133 offset:0
    v_mfma_f32_16x16x32_bf16 v[24:27], v[88:91], v[108:111], v[24:27]
    ds_read_b128 v[76:79], v133 offset:2048
    v_mfma_f32_16x16x32_bf16 v[28:31], v[88:91], v[116:119], v[28:31]
    ds_read_b128 v[84:87], v133 offset:4096
    v_mfma_f32_16x16x32_bf16 v[32:35], v[88:91], v[124:127], v[32:35]
    ds_read_b128 v[52:55], v136 offset:1024
    v_mfma_f32_16x16x32_bf16 v[36:39], v[96:99], v[108:111], v[36:39]
    ds_read_b128 v[60:63], v136 offset:3072
    v_mfma_f32_16x16x32_bf16 v[40:43], v[96:99], v[116:119], v[40:43]
    v_mfma_f32_16x16x32_bf16 v[44:47], v[96:99], v[124:127], v[44:47]
    v_mfma_f32_16x16x32_bf16 v[24:27], v[92:95], v[104:107], v[24:27]
    v_xor_b32 v108, s34, v108
    v_xor_b32 v109, s34, v109
    v_mfma_f32_16x16x32_bf16 v[28:31], v[92:95], v[112:115], v[28:31]
    v_xor_b32 v110, s34, v110
    v_xor_b32 v111, s34, v111
    v_mfma_f32_16x16x32_bf16 v[32:35], v[92:95], v[120:123], v[32:35]
    v_xor_b32 v116, s34, v116
    v_xor_b32 v117, s34, v117
    v_mfma_f32_16x16x32_bf16 v[36:39], v[100:103], v[104:107], v[36:39]
    v_xor_b32 v118, s34, v118
    v_xor_b32 v119, s34, v119
    v_mfma_f32_16x16x32_bf16 v[40:43], v[100:103], v[112:115], v[40:43]
    v_xor_b32 v124, s34, v124
    v_xor_b32 v125, s34, v125
    v_mfma_f32_16x16x32_bf16 v[44:47], v[100:103], v[120:123], v[44:47]
    v_xor_b32 v126, s34, v126
    v_xor_b32 v127, s34, v127
    v_mfma_f32_16x16x32_bf16 v[0:3], v[92:95], v[108:111], v[0:3]
    v_mfma_f32_16x16x32_bf16 v[4:7], v[92:95], v[116:119], v[4:7]
    v_mfma_f32_16x16x32_bf16 v[8:11], v[92:95], v[124:127], v[8:11]
    s_waitcnt lgkmcnt(0)
    s_barrier
    v_mfma_f32_16x16x32_bf16 v[12:15], v[100:103], v[108:111], v[12:15]
    v_mfma_f32_16x16x32_bf16 v[16:19], v[100:103], v[116:119], v[16:19]
    v_mfma_f32_16x16x32_bf16 v[20:23], v[100:103], v[124:127], v[20:23]
    v_mfma_f32_16x16x32_bf16 v[0:3], v[48:51], v[64:67], v[0:3]
    ds_read_b128 v[88:91], v134 offset:0
    v_mfma_f32_16x16x32_bf16 v[4:7], v[48:51], v[72:75], v[4:7]
    ds_read_b128 v[104:107], v128 offset:0
    v_mfma_f32_16x16x32_bf16 v[8:11], v[48:51], v[80:83], v[8:11]
    ds_read_b128 v[112:115], v128 offset:2048
    v_mfma_f32_16x16x32_bf16 v[12:15], v[56:59], v[64:67], v[12:15]
    ds_read_b128 v[120:123], v128 offset:4096
    v_mfma_f32_16x16x32_bf16 v[16:19], v[56:59], v[72:75], v[16:19]
    ds_read_b128 v[96:99], v134 offset:2048
    v_mfma_f32_16x16x32_bf16 v[20:23], v[56:59], v[80:83], v[20:23]
    ds_read_b128 v[108:111], v131 offset:0
    v_mfma_f32_16x16x32_bf16 v[24:27], v[48:51], v[68:71], v[24:27]
    ds_read_b128 v[116:119], v131 offset:2048
    v_mfma_f32_16x16x32_bf16 v[28:31], v[48:51], v[76:79], v[28:31]
    ds_read_b128 v[124:127], v131 offset:4096
    v_mfma_f32_16x16x32_bf16 v[32:35], v[48:51], v[84:87], v[32:35]
    ds_read_b128 v[92:95], v134 offset:1024
    v_mfma_f32_16x16x32_bf16 v[36:39], v[56:59], v[68:71], v[36:39]
    ds_read_b128 v[100:103], v134 offset:3072
    v_mfma_f32_16x16x32_bf16 v[40:43], v[56:59], v[76:79], v[40:43]
    v_mfma_f32_16x16x32_bf16 v[44:47], v[56:59], v[84:87], v[44:47]
    v_mfma_f32_16x16x32_bf16 v[24:27], v[52:55], v[64:67], v[24:27]
    v_xor_b32 v68, s34, v68
    v_xor_b32 v69, s34, v69
    v_mfma_f32_16x16x32_bf16 v[28:31], v[52:55], v[72:75], v[28:31]
    v_xor_b32 v70, s34, v70
    v_xor_b32 v71, s34, v71
    v_mfma_f32_16x16x32_bf16 v[32:35], v[52:55], v[80:83], v[32:35]
    v_xor_b32 v76, s34, v76
    v_xor_b32 v77, s34, v77
    v_mfma_f32_16x16x32_bf16 v[36:39], v[60:63], v[64:67], v[36:39]
    v_xor_b32 v78, s34, v78
    v_xor_b32 v79, s34, v79
    v_mfma_f32_16x16x32_bf16 v[40:43], v[60:63], v[72:75], v[40:43]
    v_xor_b32 v84, s34, v84
    v_xor_b32 v85, s34, v85
    v_mfma_f32_16x16x32_bf16 v[44:47], v[60:63], v[80:83], v[44:47]
    v_xor_b32 v86, s34, v86
    v_xor_b32 v87, s34, v87
    v_mfma_f32_16x16x32_bf16 v[0:3], v[52:55], v[68:71], v[0:3]
    v_mfma_f32_16x16x32_bf16 v[4:7], v[52:55], v[76:79], v[4:7]
    v_mfma_f32_16x16x32_bf16 v[8:11], v[52:55], v[84:87], v[8:11]
    s_waitcnt lgkmcnt(0)
    s_barrier
    v_mfma_f32_16x16x32_bf16 v[12:15], v[60:63], v[68:71], v[12:15]
    v_mfma_f32_16x16x32_bf16 v[16:19], v[60:63], v[76:79], v[16:19]
    v_mfma_f32_16x16x32_bf16 v[20:23], v[60:63], v[84:87], v[20:23]
    v_mfma_f32_16x16x32_bf16 v[0:3], v[88:91], v[104:107], v[0:3]
    ds_read_b128 v[48:51], v134 offset:20480
    v_mfma_f32_16x16x32_bf16 v[4:7], v[88:91], v[112:115], v[4:7]
    ds_read_b128 v[64:67], v128 offset:20480
    v_mfma_f32_16x16x32_bf16 v[8:11], v[88:91], v[120:123], v[8:11]
    ds_read_b128 v[72:75], v128 offset:22528
    v_mfma_f32_16x16x32_bf16 v[12:15], v[96:99], v[104:107], v[12:15]
    ds_read_b128 v[80:83], v128 offset:24576
    v_mfma_f32_16x16x32_bf16 v[16:19], v[96:99], v[112:115], v[16:19]
    ds_read_b128 v[56:59], v134 offset:22528
    v_mfma_f32_16x16x32_bf16 v[20:23], v[96:99], v[120:123], v[20:23]
    ds_read_b128 v[68:71], v131 offset:20480
    v_mfma_f32_16x16x32_bf16 v[24:27], v[88:91], v[108:111], v[24:27]
    ds_read_b128 v[76:79], v131 offset:22528
    v_mfma_f32_16x16x32_bf16 v[28:31], v[88:91], v[116:119], v[28:31]
    ds_read_b128 v[84:87], v131 offset:24576
    v_mfma_f32_16x16x32_bf16 v[32:35], v[88:91], v[124:127], v[32:35]
    ds_read_b128 v[52:55], v134 offset:21504
    v_mfma_f32_16x16x32_bf16 v[36:39], v[96:99], v[108:111], v[36:39]
    ds_read_b128 v[60:63], v134 offset:23552
    v_mfma_f32_16x16x32_bf16 v[40:43], v[96:99], v[116:119], v[40:43]
    v_mfma_f32_16x16x32_bf16 v[44:47], v[96:99], v[124:127], v[44:47]
    v_mfma_f32_16x16x32_bf16 v[24:27], v[92:95], v[104:107], v[24:27]
    v_xor_b32 v108, s34, v108
    v_xor_b32 v109, s34, v109
    v_mfma_f32_16x16x32_bf16 v[28:31], v[92:95], v[112:115], v[28:31]
    v_xor_b32 v110, s34, v110
    v_xor_b32 v111, s34, v111
    v_mfma_f32_16x16x32_bf16 v[32:35], v[92:95], v[120:123], v[32:35]
    v_xor_b32 v116, s34, v116
    v_xor_b32 v117, s34, v117
    v_mfma_f32_16x16x32_bf16 v[36:39], v[100:103], v[104:107], v[36:39]
    v_xor_b32 v118, s34, v118
    v_xor_b32 v119, s34, v119
    v_mfma_f32_16x16x32_bf16 v[40:43], v[100:103], v[112:115], v[40:43]
    v_xor_b32 v124, s34, v124
    v_xor_b32 v125, s34, v125
    v_mfma_f32_16x16x32_bf16 v[44:47], v[100:103], v[120:123], v[44:47]
    v_xor_b32 v126, s34, v126
    v_xor_b32 v127, s34, v127
    v_mfma_f32_16x16x32_bf16 v[0:3], v[92:95], v[108:111], v[0:3]
    v_mfma_f32_16x16x32_bf16 v[4:7], v[92:95], v[116:119], v[4:7]
    v_mfma_f32_16x16x32_bf16 v[8:11], v[92:95], v[124:127], v[8:11]
    s_waitcnt lgkmcnt(0)
    s_barrier
    v_mfma_f32_16x16x32_bf16 v[12:15], v[100:103], v[108:111], v[12:15]
    v_mfma_f32_16x16x32_bf16 v[16:19], v[100:103], v[116:119], v[16:19]
    v_mfma_f32_16x16x32_bf16 v[20:23], v[100:103], v[124:127], v[20:23]
    v_mfma_f32_16x16x32_bf16 v[0:3], v[48:51], v[64:67], v[0:3]
    ds_read_b128 v[88:91], v134 offset:40960
    v_mfma_f32_16x16x32_bf16 v[4:7], v[48:51], v[72:75], v[4:7]
    ds_read_b128 v[104:107], v128 offset:40960
    v_mfma_f32_16x16x32_bf16 v[8:11], v[48:51], v[80:83], v[8:11]
    ds_read_b128 v[112:115], v128 offset:43008
    v_mfma_f32_16x16x32_bf16 v[12:15], v[56:59], v[64:67], v[12:15]
    ds_read_b128 v[120:123], v128 offset:45056
    v_mfma_f32_16x16x32_bf16 v[16:19], v[56:59], v[72:75], v[16:19]
    ds_read_b128 v[96:99], v134 offset:43008
    v_mfma_f32_16x16x32_bf16 v[20:23], v[56:59], v[80:83], v[20:23]
    ds_read_b128 v[108:111], v131 offset:40960
    v_mfma_f32_16x16x32_bf16 v[24:27], v[48:51], v[68:71], v[24:27]
    ds_read_b128 v[116:119], v131 offset:43008
    v_mfma_f32_16x16x32_bf16 v[28:31], v[48:51], v[76:79], v[28:31]
    ds_read_b128 v[124:127], v131 offset:45056
    v_mfma_f32_16x16x32_bf16 v[32:35], v[48:51], v[84:87], v[32:35]
    ds_read_b128 v[92:95], v134 offset:41984
    v_mfma_f32_16x16x32_bf16 v[36:39], v[56:59], v[68:71], v[36:39]
    ds_read_b128 v[100:103], v134 offset:44032
    v_mfma_f32_16x16x32_bf16 v[40:43], v[56:59], v[76:79], v[40:43]
    v_mfma_f32_16x16x32_bf16 v[44:47], v[56:59], v[84:87], v[44:47]
    v_mfma_f32_16x16x32_bf16 v[24:27], v[52:55], v[64:67], v[24:27]
    v_xor_b32 v68, s34, v68
    v_xor_b32 v69, s34, v69
    v_mfma_f32_16x16x32_bf16 v[28:31], v[52:55], v[72:75], v[28:31]
    v_xor_b32 v70, s34, v70
    v_xor_b32 v71, s34, v71
    v_mfma_f32_16x16x32_bf16 v[32:35], v[52:55], v[80:83], v[32:35]
    v_xor_b32 v76, s34, v76
    v_xor_b32 v77, s34, v77
    v_mfma_f32_16x16x32_bf16 v[36:39], v[60:63], v[64:67], v[36:39]
    v_xor_b32 v78, s34, v78
    v_xor_b32 v79, s34, v79
    v_mfma_f32_16x16x32_bf16 v[40:43], v[60:63], v[72:75], v[40:43]
    v_xor_b32 v84, s34, v84
    v_xor_b32 v85, s34, v85
    v_mfma_f32_16x16x32_bf16 v[44:47], v[60:63], v[80:83], v[44:47]
    v_xor_b32 v86, s34, v86
    v_xor_b32 v87, s34, v87
    v_mfma_f32_16x16x32_bf16 v[0:3], v[52:55], v[68:71], v[0:3]
    v_mfma_f32_16x16x32_bf16 v[4:7], v[52:55], v[76:79], v[4:7]
    v_mfma_f32_16x16x32_bf16 v[8:11], v[52:55], v[84:87], v[8:11]
    s_waitcnt lgkmcnt(0)
    s_barrier
    v_mfma_f32_16x16x32_bf16 v[12:15], v[60:63], v[68:71], v[12:15]
    v_mfma_f32_16x16x32_bf16 v[16:19], v[60:63], v[76:79], v[16:19]
    v_mfma_f32_16x16x32_bf16 v[20:23], v[60:63], v[84:87], v[20:23]
    v_mfma_f32_16x16x32_bf16 v[0:3], v[88:91], v[104:107], v[0:3]
    ds_read_b128 v[48:51], v135 offset:0
    v_mfma_f32_16x16x32_bf16 v[4:7], v[88:91], v[112:115], v[4:7]
    ds_read_b128 v[64:67], v129 offset:0
    v_mfma_f32_16x16x32_bf16 v[8:11], v[88:91], v[120:123], v[8:11]
    ds_read_b128 v[72:75], v129 offset:2048
    v_mfma_f32_16x16x32_bf16 v[12:15], v[96:99], v[104:107], v[12:15]
    ds_read_b128 v[80:83], v129 offset:4096
    v_mfma_f32_16x16x32_bf16 v[16:19], v[96:99], v[112:115], v[16:19]
    ds_read_b128 v[56:59], v135 offset:2048
    v_mfma_f32_16x16x32_bf16 v[20:23], v[96:99], v[120:123], v[20:23]
    ds_read_b128 v[68:71], v132 offset:0
    v_mfma_f32_16x16x32_bf16 v[24:27], v[88:91], v[108:111], v[24:27]
    ds_read_b128 v[76:79], v132 offset:2048
    v_mfma_f32_16x16x32_bf16 v[28:31], v[88:91], v[116:119], v[28:31]
    ds_read_b128 v[84:87], v132 offset:4096
    v_mfma_f32_16x16x32_bf16 v[32:35], v[88:91], v[124:127], v[32:35]
    ds_read_b128 v[52:55], v135 offset:1024
    v_mfma_f32_16x16x32_bf16 v[36:39], v[96:99], v[108:111], v[36:39]
    ds_read_b128 v[60:63], v135 offset:3072
    v_mfma_f32_16x16x32_bf16 v[40:43], v[96:99], v[116:119], v[40:43]
    v_mfma_f32_16x16x32_bf16 v[44:47], v[96:99], v[124:127], v[44:47]
    v_mfma_f32_16x16x32_bf16 v[24:27], v[92:95], v[104:107], v[24:27]
    v_xor_b32 v108, s34, v108
    v_xor_b32 v109, s34, v109
    v_mfma_f32_16x16x32_bf16 v[28:31], v[92:95], v[112:115], v[28:31]
    v_xor_b32 v110, s34, v110
    v_xor_b32 v111, s34, v111
    v_mfma_f32_16x16x32_bf16 v[32:35], v[92:95], v[120:123], v[32:35]
    v_xor_b32 v116, s34, v116
    v_xor_b32 v117, s34, v117
    v_mfma_f32_16x16x32_bf16 v[36:39], v[100:103], v[104:107], v[36:39]
    v_xor_b32 v118, s34, v118
    v_xor_b32 v119, s34, v119
    v_mfma_f32_16x16x32_bf16 v[40:43], v[100:103], v[112:115], v[40:43]
    v_xor_b32 v124, s34, v124
    v_xor_b32 v125, s34, v125
    v_mfma_f32_16x16x32_bf16 v[44:47], v[100:103], v[120:123], v[44:47]
    v_xor_b32 v126, s34, v126
    v_xor_b32 v127, s34, v127
    v_mfma_f32_16x16x32_bf16 v[0:3], v[92:95], v[108:111], v[0:3]
    v_mfma_f32_16x16x32_bf16 v[4:7], v[92:95], v[116:119], v[4:7]
    v_mfma_f32_16x16x32_bf16 v[8:11], v[92:95], v[124:127], v[8:11]
    s_waitcnt lgkmcnt(0)
    s_barrier
    v_mfma_f32_16x16x32_bf16 v[12:15], v[100:103], v[108:111], v[12:15]
    v_mfma_f32_16x16x32_bf16 v[16:19], v[100:103], v[116:119], v[16:19]
    v_mfma_f32_16x16x32_bf16 v[20:23], v[100:103], v[124:127], v[20:23]
    v_mfma_f32_16x16x32_bf16 v[0:3], v[48:51], v[64:67], v[0:3]
    ds_read_b128 v[88:91], v135 offset:20480
    v_mfma_f32_16x16x32_bf16 v[4:7], v[48:51], v[72:75], v[4:7]
    ds_read_b128 v[104:107], v129 offset:20480
    v_mfma_f32_16x16x32_bf16 v[8:11], v[48:51], v[80:83], v[8:11]
    ds_read_b128 v[112:115], v129 offset:22528
    v_mfma_f32_16x16x32_bf16 v[12:15], v[56:59], v[64:67], v[12:15]
    ds_read_b128 v[120:123], v129 offset:24576
    v_mfma_f32_16x16x32_bf16 v[16:19], v[56:59], v[72:75], v[16:19]
    ds_read_b128 v[96:99], v135 offset:22528
    v_mfma_f32_16x16x32_bf16 v[20:23], v[56:59], v[80:83], v[20:23]
    ds_read_b128 v[108:111], v132 offset:20480
    v_mfma_f32_16x16x32_bf16 v[24:27], v[48:51], v[68:71], v[24:27]
    ds_read_b128 v[116:119], v132 offset:22528
    v_mfma_f32_16x16x32_bf16 v[28:31], v[48:51], v[76:79], v[28:31]
    ds_read_b128 v[124:127], v132 offset:24576
    v_mfma_f32_16x16x32_bf16 v[32:35], v[48:51], v[84:87], v[32:35]
    ds_read_b128 v[92:95], v135 offset:21504
    v_mfma_f32_16x16x32_bf16 v[36:39], v[56:59], v[68:71], v[36:39]
    ds_read_b128 v[100:103], v135 offset:23552
    v_mfma_f32_16x16x32_bf16 v[40:43], v[56:59], v[76:79], v[40:43]
    v_mfma_f32_16x16x32_bf16 v[44:47], v[56:59], v[84:87], v[44:47]
    v_mfma_f32_16x16x32_bf16 v[24:27], v[52:55], v[64:67], v[24:27]
    v_xor_b32 v68, s34, v68
    v_xor_b32 v69, s34, v69
    v_mfma_f32_16x16x32_bf16 v[28:31], v[52:55], v[72:75], v[28:31]
    v_xor_b32 v70, s34, v70
    v_xor_b32 v71, s34, v71
    v_mfma_f32_16x16x32_bf16 v[32:35], v[52:55], v[80:83], v[32:35]
    v_xor_b32 v76, s34, v76
    v_xor_b32 v77, s34, v77
    v_mfma_f32_16x16x32_bf16 v[36:39], v[60:63], v[64:67], v[36:39]
    v_xor_b32 v78, s34, v78
    v_xor_b32 v79, s34, v79
    v_mfma_f32_16x16x32_bf16 v[40:43], v[60:63], v[72:75], v[40:43]
    v_xor_b32 v84, s34, v84
    v_xor_b32 v85, s34, v85
    v_mfma_f32_16x16x32_bf16 v[44:47], v[60:63], v[80:83], v[44:47]
    v_xor_b32 v86, s34, v86
    v_xor_b32 v87, s34, v87
    v_mfma_f32_16x16x32_bf16 v[0:3], v[52:55], v[68:71], v[0:3]
    v_mfma_f32_16x16x32_bf16 v[4:7], v[52:55], v[76:79], v[4:7]
    v_mfma_f32_16x16x32_bf16 v[8:11], v[52:55], v[84:87], v[8:11]
    s_waitcnt lgkmcnt(0)
    s_barrier
    v_mfma_f32_16x16x32_bf16 v[12:15], v[60:63], v[68:71], v[12:15]
    v_mfma_f32_16x16x32_bf16 v[16:19], v[60:63], v[76:79], v[16:19]
    v_mfma_f32_16x16x32_bf16 v[20:23], v[60:63], v[84:87], v[20:23]
    v_mfma_f32_16x16x32_bf16 v[0:3], v[88:91], v[104:107], v[0:3]
    ds_read_b128 v[48:51], v135 offset:40960
    v_mfma_f32_16x16x32_bf16 v[4:7], v[88:91], v[112:115], v[4:7]
    ds_read_b128 v[64:67], v129 offset:40960
    v_mfma_f32_16x16x32_bf16 v[8:11], v[88:91], v[120:123], v[8:11]
    ds_read_b128 v[72:75], v129 offset:43008
    v_mfma_f32_16x16x32_bf16 v[12:15], v[96:99], v[104:107], v[12:15]
    ds_read_b128 v[80:83], v129 offset:45056
    v_mfma_f32_16x16x32_bf16 v[16:19], v[96:99], v[112:115], v[16:19]
    ds_read_b128 v[56:59], v135 offset:43008
    v_mfma_f32_16x16x32_bf16 v[20:23], v[96:99], v[120:123], v[20:23]
    ds_read_b128 v[68:71], v132 offset:40960
    v_mfma_f32_16x16x32_bf16 v[24:27], v[88:91], v[108:111], v[24:27]
    ds_read_b128 v[76:79], v132 offset:43008
    v_mfma_f32_16x16x32_bf16 v[28:31], v[88:91], v[116:119], v[28:31]
    ds_read_b128 v[84:87], v132 offset:45056
    v_mfma_f32_16x16x32_bf16 v[32:35], v[88:91], v[124:127], v[32:35]
    ds_read_b128 v[52:55], v135 offset:41984
    v_mfma_f32_16x16x32_bf16 v[36:39], v[96:99], v[108:111], v[36:39]
    ds_read_b128 v[60:63], v135 offset:44032
    v_mfma_f32_16x16x32_bf16 v[40:43], v[96:99], v[116:119], v[40:43]
    v_mfma_f32_16x16x32_bf16 v[44:47], v[96:99], v[124:127], v[44:47]
    v_mfma_f32_16x16x32_bf16 v[24:27], v[92:95], v[104:107], v[24:27]
    v_xor_b32 v108, s34, v108
    v_xor_b32 v109, s34, v109
    v_mfma_f32_16x16x32_bf16 v[28:31], v[92:95], v[112:115], v[28:31]
    v_xor_b32 v110, s34, v110
    v_xor_b32 v111, s34, v111
    v_mfma_f32_16x16x32_bf16 v[32:35], v[92:95], v[120:123], v[32:35]
    v_xor_b32 v116, s34, v116
    v_xor_b32 v117, s34, v117
    v_mfma_f32_16x16x32_bf16 v[36:39], v[100:103], v[104:107], v[36:39]
    v_xor_b32 v118, s34, v118
    v_xor_b32 v119, s34, v119
    v_mfma_f32_16x16x32_bf16 v[40:43], v[100:103], v[112:115], v[40:43]
    v_xor_b32 v124, s34, v124
    v_xor_b32 v125, s34, v125
    v_mfma_f32_16x16x32_bf16 v[44:47], v[100:103], v[120:123], v[44:47]
    v_xor_b32 v126, s34, v126
    v_xor_b32 v127, s34, v127
    v_mfma_f32_16x16x32_bf16 v[0:3], v[92:95], v[108:111], v[0:3]
    v_mfma_f32_16x16x32_bf16 v[4:7], v[92:95], v[116:119], v[4:7]
    v_mfma_f32_16x16x32_bf16 v[8:11], v[92:95], v[124:127], v[8:11]
    s_waitcnt lgkmcnt(0)
    s_barrier
    v_mfma_f32_16x16x32_bf16 v[12:15], v[100:103], v[108:111], v[12:15]
    v_mfma_f32_16x16x32_bf16 v[16:19], v[100:103], v[116:119], v[16:19]
    v_mfma_f32_16x16x32_bf16 v[20:23], v[100:103], v[124:127], v[20:23]
    v_mfma_f32_16x16x32_bf16 v[0:3], v[48:51], v[64:67], v[0:3]
    ds_read_b128 v[88:91], v136 offset:0
    v_mfma_f32_16x16x32_bf16 v[4:7], v[48:51], v[72:75], v[4:7]
    ds_read_b128 v[104:107], v130 offset:0
    v_mfma_f32_16x16x32_bf16 v[8:11], v[48:51], v[80:83], v[8:11]
    ds_read_b128 v[112:115], v130 offset:2048
    v_mfma_f32_16x16x32_bf16 v[12:15], v[56:59], v[64:67], v[12:15]
    ds_read_b128 v[120:123], v130 offset:4096
    v_mfma_f32_16x16x32_bf16 v[16:19], v[56:59], v[72:75], v[16:19]
    ds_read_b128 v[96:99], v136 offset:2048
    v_mfma_f32_16x16x32_bf16 v[20:23], v[56:59], v[80:83], v[20:23]
    ds_read_b128 v[108:111], v133 offset:0
    v_mfma_f32_16x16x32_bf16 v[24:27], v[48:51], v[68:71], v[24:27]
    ds_read_b128 v[116:119], v133 offset:2048
    v_mfma_f32_16x16x32_bf16 v[28:31], v[48:51], v[76:79], v[28:31]
    ds_read_b128 v[124:127], v133 offset:4096
    v_mfma_f32_16x16x32_bf16 v[32:35], v[48:51], v[84:87], v[32:35]
    ds_read_b128 v[92:95], v136 offset:1024
    v_mfma_f32_16x16x32_bf16 v[36:39], v[56:59], v[68:71], v[36:39]
    ds_read_b128 v[100:103], v136 offset:3072
    v_mfma_f32_16x16x32_bf16 v[40:43], v[56:59], v[76:79], v[40:43]
    v_mfma_f32_16x16x32_bf16 v[44:47], v[56:59], v[84:87], v[44:47]
    v_mfma_f32_16x16x32_bf16 v[24:27], v[52:55], v[64:67], v[24:27]
    v_xor_b32 v68, s34, v68
    v_xor_b32 v69, s34, v69
    v_mfma_f32_16x16x32_bf16 v[28:31], v[52:55], v[72:75], v[28:31]
    v_xor_b32 v70, s34, v70
    v_xor_b32 v71, s34, v71
    v_mfma_f32_16x16x32_bf16 v[32:35], v[52:55], v[80:83], v[32:35]
    v_xor_b32 v76, s34, v76
    v_xor_b32 v77, s34, v77
    v_mfma_f32_16x16x32_bf16 v[36:39], v[60:63], v[64:67], v[36:39]
    v_xor_b32 v78, s34, v78
    v_xor_b32 v79, s34, v79
    v_mfma_f32_16x16x32_bf16 v[40:43], v[60:63], v[72:75], v[40:43]
    v_xor_b32 v84, s34, v84
    v_xor_b32 v85, s34, v85
    v_mfma_f32_16x16x32_bf16 v[44:47], v[60:63], v[80:83], v[44:47]
    v_xor_b32 v86, s34, v86
    v_xor_b32 v87, s34, v87
    v_mfma_f32_16x16x32_bf16 v[0:3], v[52:55], v[68:71], v[0:3]
    v_mfma_f32_16x16x32_bf16 v[4:7], v[52:55], v[76:79], v[4:7]
    v_mfma_f32_16x16x32_bf16 v[8:11], v[52:55], v[84:87], v[8:11]
    s_waitcnt lgkmcnt(0)
    s_barrier
    v_mfma_f32_16x16x32_bf16 v[12:15], v[60:63], v[68:71], v[12:15]
    v_mfma_f32_16x16x32_bf16 v[16:19], v[60:63], v[76:79], v[16:19]
    v_mfma_f32_16x16x32_bf16 v[20:23], v[60:63], v[84:87], v[20:23]
    v_mfma_f32_16x16x32_bf16 v[0:3], v[88:91], v[104:107], v[0:3]
    ds_read_b128 v[48:51], v134 offset:0
    v_mfma_f32_16x16x32_bf16 v[4:7], v[88:91], v[112:115], v[4:7]
    ds_read_b128 v[64:67], v128 offset:0
    v_mfma_f32_16x16x32_bf16 v[8:11], v[88:91], v[120:123], v[8:11]
    ds_read_b128 v[72:75], v128 offset:2048
    v_mfma_f32_16x16x32_bf16 v[12:15], v[96:99], v[104:107], v[12:15]
    ds_read_b128 v[80:83], v128 offset:4096
    v_mfma_f32_16x16x32_bf16 v[16:19], v[96:99], v[112:115], v[16:19]
    ds_read_b128 v[56:59], v134 offset:2048
    v_mfma_f32_16x16x32_bf16 v[20:23], v[96:99], v[120:123], v[20:23]
    ds_read_b128 v[68:71], v131 offset:0
    v_mfma_f32_16x16x32_bf16 v[24:27], v[88:91], v[108:111], v[24:27]
    ds_read_b128 v[76:79], v131 offset:2048
    v_mfma_f32_16x16x32_bf16 v[28:31], v[88:91], v[116:119], v[28:31]
    ds_read_b128 v[84:87], v131 offset:4096
    v_mfma_f32_16x16x32_bf16 v[32:35], v[88:91], v[124:127], v[32:35]
    ds_read_b128 v[52:55], v134 offset:1024
    v_mfma_f32_16x16x32_bf16 v[36:39], v[96:99], v[108:111], v[36:39]
    ds_read_b128 v[60:63], v134 offset:3072
    v_mfma_f32_16x16x32_bf16 v[40:43], v[96:99], v[116:119], v[40:43]
    v_mfma_f32_16x16x32_bf16 v[44:47], v[96:99], v[124:127], v[44:47]
    v_mfma_f32_16x16x32_bf16 v[24:27], v[92:95], v[104:107], v[24:27]
    v_xor_b32 v108, s34, v108
    v_xor_b32 v109, s34, v109
    v_mfma_f32_16x16x32_bf16 v[28:31], v[92:95], v[112:115], v[28:31]
    v_xor_b32 v110, s34, v110
    v_xor_b32 v111, s34, v111
    v_mfma_f32_16x16x32_bf16 v[32:35], v[92:95], v[120:123], v[32:35]
    v_xor_b32 v116, s34, v116
    v_xor_b32 v117, s34, v117
    v_mfma_f32_16x16x32_bf16 v[36:39], v[100:103], v[104:107], v[36:39]
    v_xor_b32 v118, s34, v118
    v_xor_b32 v119, s34, v119
    v_mfma_f32_16x16x32_bf16 v[40:43], v[100:103], v[112:115], v[40:43]
    v_xor_b32 v124, s34, v124
    v_xor_b32 v125, s34, v125
    v_mfma_f32_16x16x32_bf16 v[44:47], v[100:103], v[120:123], v[44:47]
    v_xor_b32 v126, s34, v126
    v_xor_b32 v127, s34, v127
    v_mfma_f32_16x16x32_bf16 v[0:3], v[92:95], v[108:111], v[0:3]
    v_mfma_f32_16x16x32_bf16 v[4:7], v[92:95], v[116:119], v[4:7]
    v_mfma_f32_16x16x32_bf16 v[8:11], v[92:95], v[124:127], v[8:11]
    s_waitcnt lgkmcnt(0)
    s_barrier
    v_mfma_f32_16x16x32_bf16 v[12:15], v[100:103], v[108:111], v[12:15]
    v_mfma_f32_16x16x32_bf16 v[16:19], v[100:103], v[116:119], v[16:19]
    v_mfma_f32_16x16x32_bf16 v[20:23], v[100:103], v[124:127], v[20:23]
    v_mfma_f32_16x16x32_bf16 v[0:3], v[48:51], v[64:67], v[0:3]
    ds_read_b128 v[88:91], v134 offset:20480
    v_mfma_f32_16x16x32_bf16 v[4:7], v[48:51], v[72:75], v[4:7]
    ds_read_b128 v[104:107], v128 offset:20480
    v_mfma_f32_16x16x32_bf16 v[8:11], v[48:51], v[80:83], v[8:11]
    ds_read_b128 v[112:115], v128 offset:22528
    v_mfma_f32_16x16x32_bf16 v[12:15], v[56:59], v[64:67], v[12:15]
    ds_read_b128 v[120:123], v128 offset:24576
    v_mfma_f32_16x16x32_bf16 v[16:19], v[56:59], v[72:75], v[16:19]
    ds_read_b128 v[96:99], v134 offset:22528
    v_mfma_f32_16x16x32_bf16 v[20:23], v[56:59], v[80:83], v[20:23]
    ds_read_b128 v[108:111], v131 offset:20480
    v_mfma_f32_16x16x32_bf16 v[24:27], v[48:51], v[68:71], v[24:27]
    ds_read_b128 v[116:119], v131 offset:22528
    v_mfma_f32_16x16x32_bf16 v[28:31], v[48:51], v[76:79], v[28:31]
    ds_read_b128 v[124:127], v131 offset:24576
    v_mfma_f32_16x16x32_bf16 v[32:35], v[48:51], v[84:87], v[32:35]
    ds_read_b128 v[92:95], v134 offset:21504
    v_mfma_f32_16x16x32_bf16 v[36:39], v[56:59], v[68:71], v[36:39]
    ds_read_b128 v[100:103], v134 offset:23552
    v_mfma_f32_16x16x32_bf16 v[40:43], v[56:59], v[76:79], v[40:43]
    v_mfma_f32_16x16x32_bf16 v[44:47], v[56:59], v[84:87], v[44:47]
    v_mfma_f32_16x16x32_bf16 v[24:27], v[52:55], v[64:67], v[24:27]
    v_xor_b32 v68, s34, v68
    v_xor_b32 v69, s34, v69
    v_mfma_f32_16x16x32_bf16 v[28:31], v[52:55], v[72:75], v[28:31]
    v_xor_b32 v70, s34, v70
    v_xor_b32 v71, s34, v71
    v_mfma_f32_16x16x32_bf16 v[32:35], v[52:55], v[80:83], v[32:35]
    v_xor_b32 v76, s34, v76
    v_xor_b32 v77, s34, v77
    v_mfma_f32_16x16x32_bf16 v[36:39], v[60:63], v[64:67], v[36:39]
    v_xor_b32 v78, s34, v78
    v_xor_b32 v79, s34, v79
    v_mfma_f32_16x16x32_bf16 v[40:43], v[60:63], v[72:75], v[40:43]
    v_xor_b32 v84, s34, v84
    v_xor_b32 v85, s34, v85
    v_mfma_f32_16x16x32_bf16 v[44:47], v[60:63], v[80:83], v[44:47]
    v_xor_b32 v86, s34, v86
    v_xor_b32 v87, s34, v87
    v_mfma_f32_16x16x32_bf16 v[0:3], v[52:55], v[68:71], v[0:3]
    v_mfma_f32_16x16x32_bf16 v[4:7], v[52:55], v[76:79], v[4:7]
    v_mfma_f32_16x16x32_bf16 v[8:11], v[52:55], v[84:87], v[8:11]
    s_waitcnt lgkmcnt(0)
    v_mfma_f32_16x16x32_bf16 v[12:15], v[60:63], v[68:71], v[12:15]
    v_mfma_f32_16x16x32_bf16 v[16:19], v[60:63], v[76:79], v[16:19]
    v_mfma_f32_16x16x32_bf16 v[20:23], v[60:63], v[84:87], v[20:23]
    v_mfma_f32_16x16x32_bf16 v[0:3], v[88:91], v[104:107], v[0:3]
    v_mfma_f32_16x16x32_bf16 v[4:7], v[88:91], v[112:115], v[4:7]
    v_mfma_f32_16x16x32_bf16 v[8:11], v[88:91], v[120:123], v[8:11]
    v_mfma_f32_16x16x32_bf16 v[12:15], v[96:99], v[104:107], v[12:15]
    v_mfma_f32_16x16x32_bf16 v[16:19], v[96:99], v[112:115], v[16:19]
    v_mfma_f32_16x16x32_bf16 v[20:23], v[96:99], v[120:123], v[20:23]
    v_mfma_f32_16x16x32_bf16 v[24:27], v[88:91], v[108:111], v[24:27]
    v_mfma_f32_16x16x32_bf16 v[28:31], v[88:91], v[116:119], v[28:31]
    v_mfma_f32_16x16x32_bf16 v[32:35], v[88:91], v[124:127], v[32:35]
    v_mfma_f32_16x16x32_bf16 v[36:39], v[96:99], v[108:111], v[36:39]
    v_mfma_f32_16x16x32_bf16 v[40:43], v[96:99], v[116:119], v[40:43]
    v_mfma_f32_16x16x32_bf16 v[44:47], v[96:99], v[124:127], v[44:47]
    v_mfma_f32_16x16x32_bf16 v[24:27], v[92:95], v[104:107], v[24:27]
    v_xor_b32 v108, s34, v108
    v_xor_b32 v109, s34, v109
    v_mfma_f32_16x16x32_bf16 v[28:31], v[92:95], v[112:115], v[28:31]
    v_xor_b32 v110, s34, v110
    v_xor_b32 v111, s34, v111
    v_mfma_f32_16x16x32_bf16 v[32:35], v[92:95], v[120:123], v[32:35]
    v_xor_b32 v116, s34, v116
    v_xor_b32 v117, s34, v117
    v_mfma_f32_16x16x32_bf16 v[36:39], v[100:103], v[104:107], v[36:39]
    v_xor_b32 v118, s34, v118
    v_xor_b32 v119, s34, v119
    v_mfma_f32_16x16x32_bf16 v[40:43], v[100:103], v[112:115], v[40:43]
    v_xor_b32 v124, s34, v124
    v_xor_b32 v125, s34, v125
    v_mfma_f32_16x16x32_bf16 v[44:47], v[100:103], v[120:123], v[44:47]
    v_xor_b32 v126, s34, v126
    v_xor_b32 v127, s34, v127
    v_mfma_f32_16x16x32_bf16 v[0:3], v[92:95], v[108:111], v[0:3]
    v_mfma_f32_16x16x32_bf16 v[4:7], v[92:95], v[116:119], v[4:7]
    v_mfma_f32_16x16x32_bf16 v[8:11], v[92:95], v[124:127], v[8:11]
    v_mfma_f32_16x16x32_bf16 v[12:15], v[100:103], v[108:111], v[12:15]
    v_mfma_f32_16x16x32_bf16 v[16:19], v[100:103], v[116:119], v[16:19]
    v_mfma_f32_16x16x32_bf16 v[20:23], v[100:103], v[124:127], v[20:23]
    s_nop 7
    s_nop 7
    v_cvt_pk_bf16_f32 v48, v24, v25
    v_cvt_pk_bf16_f32 v49, v26, v27
    v_cvt_pk_bf16_f32 v50, v36, v37
    v_cvt_pk_bf16_f32 v51, v38, v39
    s_add_u32 s35, s33, 0
    buffer_store_dwordx4 v[48:51], v141, s[16:19], s35 offen offset:64
    v_cvt_pk_bf16_f32 v52, v28, v29
    v_cvt_pk_bf16_f32 v53, v30, v31
    v_cvt_pk_bf16_f32 v54, v40, v41
    v_cvt_pk_bf16_f32 v55, v42, v43
    s_add_u32 s35, s33, 524288
    buffer_store_dwordx4 v[52:55], v141, s[16:19], s35 offen offset:64
    v_cvt_pk_bf16_f32 v56, v32, v33
    v_cvt_pk_bf16_f32 v57, v34, v35
    v_cvt_pk_bf16_f32 v58, v44, v45
    v_cvt_pk_bf16_f32 v59, v46, v47
    s_add_u32 s35, s33, 1048576
    buffer_store_dwordx4 v[56:59], v141, s[16:19], s35 offen offset:64
    v_cvt_pk_bf16_f32 v60, v0, v1
    v_cvt_pk_bf16_f32 v61, v2, v3
    v_cvt_pk_bf16_f32 v62, v12, v13
    v_cvt_pk_bf16_f32 v63, v14, v15
    s_add_u32 s35, s33, 0
    buffer_store_dwordx4 v[60:63], v141, s[16:19], s35 offen offset:0
    v_cvt_pk_bf16_f32 v64, v4, v5
    v_cvt_pk_bf16_f32 v65, v6, v7
    v_cvt_pk_bf16_f32 v66, v16, v17
    v_cvt_pk_bf16_f32 v67, v18, v19
    s_add_u32 s35, s33, 524288
    buffer_store_dwordx4 v[64:67], v141, s[16:19], s35 offen offset:0
    v_cvt_pk_bf16_f32 v68, v8, v9
    v_cvt_pk_bf16_f32 v69, v10, v11
    v_cvt_pk_bf16_f32 v70, v20, v21
    v_cvt_pk_bf16_f32 v71, v22, v23
    s_add_u32 s35, s33, 1048576
    buffer_store_dwordx4 v[68:71], v141, s[16:19], s35 offen offset:0
    s_endpgm
L_gemm2_kernel_loader:
    s_sub_u32 s20, s20, 4
    v_and_b32 v3, 63, v0
    v_lshrrev_b32 v4, 3, v3
    v_and_b32 v5, 7, v3
    v_xor_b32 v5, v5, v4
    v_lshlrev_b32 v5, 4, v5
    v_lshl_add_u32 v1, v4, 11, v5
    v_lshlrev_b32 v2, 4, v3
    s_add_u32 s24, s20, 0
    s_lshl_b32 s40, s24, 10
    s_lshl_b32 s43, s24, 14
    s_add_u32 s24, s20, 4
    s_lshl_b32 s41, s24, 10
    s_lshl_b32 s44, s24, 14
    s_add_u32 s24, s20, 8
    s_lshl_b32 s42, s24, 10
    s_lshl_b32 s45, s24, 14
    s_mul_i32 s46, s20, 2048
    s_add_u32 s47, s46, 12288
    s_add_u32 m0, s40, 0
    s_add_u32 s24, s43, 0
    buffer_load_dwordx4 v1, s[8:11], s24 offen lds
    s_add_u32 m0, s41, 0
    s_add_u32 s24, s44, 0
    buffer_load_dwordx4 v1, s[8:11], s24 offen lds
    s_add_u32 m0, s42, 0
    s_add_u32 s24, s45, 0
    buffer_load_dwordx4 v1, s[8:11], s24 offen lds
    s_add_u32 m0, s47, 0
    s_add_u32 s24, s46, 0
    buffer_load_dwordx4 v2, s[12:15], s24 offen offset:0 lds
    buffer_load_dwordx4 v2, s[12:15], s24 offen offset:1024 lds
    s_add_u32 m0, s40, 20480
    s_add_u32 s24, s43, 128
    buffer_load_dwordx4 v1, s[8:11], s24 offen lds
    s_add_u32 m0, s41, 20480
    s_add_u32 s24, s44, 128
    buffer_load_dwordx4 v1, s[8:11], s24 offen lds
    s_add_u32 m0, s42, 20480
    s_add_u32 s24, s45, 128
    buffer_load_dwordx4 v1, s[8:11], s24 offen lds
    s_add_u32 m0, s47, 20480
    s_add_u32 s24, s46, 32768
    buffer_load_dwordx4 v2, s[12:15], s24 offen offset:0 lds
    buffer_load_dwordx4 v2, s[12:15], s24 offen offset:1024 lds
    s_add_u32 m0, s40, 40960
    s_add_u32 s24, s43, 256
    buffer_load_dwordx4 v1, s[8:11], s24 offen lds
    s_add_u32 m0, s41, 40960
    s_add_u32 s24, s44, 256
    buffer_load_dwordx4 v1, s[8:11], s24 offen lds
    s_add_u32 m0, s42, 40960
    s_add_u32 s24, s45, 256
    buffer_load_dwordx4 v1, s[8:11], s24 offen lds
    s_add_u32 m0, s47, 40960
    s_add_u32 s24, s46, 65536
    buffer_load_dwordx4 v2, s[12:15], s24 offen offset:0 lds
    buffer_load_dwordx4 v2, s[12:15], s24 offen offset:1024 lds
    s_add_u32 m0, s40, 61440
    s_add_u32 s24, s43, 384
    buffer_load_dwordx4 v1, s[8:11], s24 offen lds
    s_add_u32 m0, s41, 61440
    s_add_u32 s24, s44, 384
    buffer_load_dwordx4 v1, s[8:11], s24 offen lds
    s_add_u32 m0, s42, 61440
    s_add_u32 s24, s45, 384
    buffer_load_dwordx4 v1, s[8:11], s24 offen lds
    s_add_u32 m0, s47, 61440
    s_add_u32 s24, s46, 98304
    buffer_load_dwordx4 v2, s[12:15], s24 offen offset:0 lds
    buffer_load_dwordx4 v2, s[12:15], s24 offen offset:1024 lds
    s_add_u32 m0, s40, 81920
    s_add_u32 s24, s43, 512
    buffer_load_dwordx4 v1, s[8:11], s24 offen lds
    s_add_u32 m0, s41, 81920
    s_add_u32 s24, s44, 512
    buffer_load_dwordx4 v1, s[8:11], s24 offen lds
    s_add_u32 m0, s42, 81920
    s_add_u32 s24, s45, 512
    buffer_load_dwordx4 v1, s[8:11], s24 offen lds
    s_add_u32 m0, s47, 81920
    s_add_u32 s24, s46, 131072
    buffer_load_dwordx4 v2, s[12:15], s24 offen offset:0 lds
    buffer_load_dwordx4 v2, s[12:15], s24 offen offset:1024 lds
    s_add_u32 m0, s40, 102400
    s_add_u32 s24, s43, 640
    buffer_load_dwordx4 v1, s[8:11], s24 offen lds
    s_add_u32 m0, s41, 102400
    s_add_u32 s24, s44, 640
    buffer_load_dwordx4 v1, s[8:11], s24 offen lds
    s_add_u32 m0, s42, 102400
    s_add_u32 s24, s45, 640
    buffer_load_dwordx4 v1, s[8:11], s24 offen lds
    s_add_u32 m0, s47, 102400
    s_add_u32 s24, s46, 163840
    buffer_load_dwordx4 v2, s[12:15], s24 offen offset:0 lds
    buffer_load_dwordx4 v2, s[12:15], s24 offen offset:1024 lds
    s_add_u32 m0, s40, 122880
    s_add_u32 s24, s43, 768
    buffer_load_dwordx4 v1, s[8:11], s24 offen lds
    s_add_u32 m0, s41, 122880
    s_add_u32 s24, s44, 768
    buffer_load_dwordx4 v1, s[8:11], s24 offen lds
    s_add_u32 m0, s42, 122880
    s_add_u32 s24, s45, 768
    buffer_load_dwordx4 v1, s[8:11], s24 offen lds
    s_add_u32 m0, s47, 122880
    s_add_u32 s24, s46, 196608
    buffer_load_dwordx4 v2, s[12:15], s24 offen offset:0 lds
    buffer_load_dwordx4 v2, s[12:15], s24 offen offset:1024 lds
    s_waitcnt vmcnt(30)
    s_barrier
    s_waitcnt vmcnt(25)
    s_barrier
    s_add_u32 m0, s40, 0
    s_add_u32 s24, s43, 896
    buffer_load_dwordx4 v1, s[8:11], s24 offen lds
    s_add_u32 m0, s41, 0
    s_add_u32 s24, s44, 896
    buffer_load_dwordx4 v1, s[8:11], s24 offen lds
    s_add_u32 m0, s42, 0
    s_add_u32 s24, s45, 896
    buffer_load_dwordx4 v1, s[8:11], s24 offen lds
    s_add_u32 m0, s47, 0
    s_add_u32 s24, s46, 229376
    buffer_load_dwordx4 v2, s[12:15], s24 offen offset:0 lds
    buffer_load_dwordx4 v2, s[12:15], s24 offen offset:1024 lds
    s_waitcnt vmcnt(25)
    s_barrier
    s_add_u32 m0, s40, 20480
    s_add_u32 s24, s43, 1024
    buffer_load_dwordx4 v1, s[8:11], s24 offen lds
    s_add_u32 m0, s41, 20480
    s_add_u32 s24, s44, 1024
    buffer_load_dwordx4 v1, s[8:11], s24 offen lds
    s_add_u32 m0, s42, 20480
    s_add_u32 s24, s45, 1024
    buffer_load_dwordx4 v1, s[8:11], s24 offen lds
    s_add_u32 m0, s47, 20480
    s_add_u32 s24, s46, 262144
    buffer_load_dwordx4 v2, s[12:15], s24 offen offset:0 lds
    buffer_load_dwordx4 v2, s[12:15], s24 offen offset:1024 lds
    s_waitcnt vmcnt(25)
    s_barrier
    s_add_u32 m0, s40, 40960
    s_add_u32 s24, s43, 1152
    buffer_load_dwordx4 v1, s[8:11], s24 offen lds
    s_add_u32 m0, s41, 40960
    s_add_u32 s24, s44, 1152
    buffer_load_dwordx4 v1, s[8:11], s24 offen lds
    s_add_u32 m0, s42, 40960
    s_add_u32 s24, s45, 1152
    buffer_load_dwordx4 v1, s[8:11], s24 offen lds
    s_add_u32 m0, s47, 40960
    s_add_u32 s24, s46, 294912
    buffer_load_dwordx4 v2, s[12:15], s24 offen offset:0 lds
    buffer_load_dwordx4 v2, s[12:15], s24 offen offset:1024 lds
    s_waitcnt vmcnt(25)
    s_barrier
    s_add_u32 m0, s40, 61440
    s_add_u32 s24, s43, 1280
    buffer_load_dwordx4 v1, s[8:11], s24 offen lds
    s_add_u32 m0, s41, 61440
    s_add_u32 s24, s44, 1280
    buffer_load_dwordx4 v1, s[8:11], s24 offen lds
    s_add_u32 m0, s42, 61440
    s_add_u32 s24, s45, 1280
    buffer_load_dwordx4 v1, s[8:11], s24 offen lds
    s_add_u32 m0, s47, 61440
    s_add_u32 s24, s46, 327680
    buffer_load_dwordx4 v2, s[12:15], s24 offen offset:0 lds
    buffer_load_dwordx4 v2, s[12:15], s24 offen offset:1024 lds
    s_waitcnt vmcnt(25)
    s_barrier
    s_add_u32 m0, s40, 81920
    s_add_u32 s24, s43, 1408
    buffer_load_dwordx4 v1, s[8:11], s24 offen lds
    s_add_u32 m0, s41, 81920
    s_add_u32 s24, s44, 1408
    buffer_load_dwordx4 v1, s[8:11], s24 offen lds
    s_add_u32 m0, s42, 81920
    s_add_u32 s24, s45, 1408
    buffer_load_dwordx4 v1, s[8:11], s24 offen lds
    s_add_u32 m0, s47, 81920
    s_add_u32 s24, s46, 360448
    buffer_load_dwordx4 v2, s[12:15], s24 offen offset:0 lds
    buffer_load_dwordx4 v2, s[12:15], s24 offen offset:1024 lds
    s_waitcnt vmcnt(25)
    s_barrier
    s_add_u32 m0, s40, 102400
    s_add_u32 s24, s43, 1536
    buffer_load_dwordx4 v1, s[8:11], s24 offen lds
    s_add_u32 m0, s41, 102400
    s_add_u32 s24, s44, 1536
    buffer_load_dwordx4 v1, s[8:11], s24 offen lds
    s_add_u32 m0, s42, 102400
    s_add_u32 s24, s45, 1536
    buffer_load_dwordx4 v1, s[8:11], s24 offen lds
    s_add_u32 m0, s47, 102400
    s_add_u32 s24, s46, 393216
    buffer_load_dwordx4 v2, s[12:15], s24 offen offset:0 lds
    buffer_load_dwordx4 v2, s[12:15], s24 offen offset:1024 lds
    s_waitcnt vmcnt(25)
    s_barrier
    s_add_u32 m0, s40, 122880
    s_add_u32 s24, s43, 1664
    buffer_load_dwordx4 v1, s[8:11], s24 offen lds
    s_add_u32 m0, s41, 122880
    s_add_u32 s24, s44, 1664
    buffer_load_dwordx4 v1, s[8:11], s24 offen lds
    s_add_u32 m0, s42, 122880
    s_add_u32 s24, s45, 1664
    buffer_load_dwordx4 v1, s[8:11], s24 offen lds
    s_add_u32 m0, s47, 122880
    s_add_u32 s24, s46, 425984
    buffer_load_dwordx4 v2, s[12:15], s24 offen offset:0 lds
    buffer_load_dwordx4 v2, s[12:15], s24 offen offset:1024 lds
    s_waitcnt vmcnt(25)
    s_barrier
    s_add_u32 m0, s40, 0
    s_add_u32 s24, s43, 1792
    buffer_load_dwordx4 v1, s[8:11], s24 offen lds
    s_add_u32 m0, s41, 0
    s_add_u32 s24, s44, 1792
    buffer_load_dwordx4 v1, s[8:11], s24 offen lds
    s_add_u32 m0, s42, 0
    s_add_u32 s24, s45, 1792
    buffer_load_dwordx4 v1, s[8:11], s24 offen lds
    s_add_u32 m0, s47, 0
    s_add_u32 s24, s46, 458752
    buffer_load_dwordx4 v2, s[12:15], s24 offen offset:0 lds
    buffer_load_dwordx4 v2, s[12:15], s24 offen offset:1024 lds
    s_waitcnt vmcnt(25)
    s_barrier
    s_add_u32 m0, s40, 20480
    s_add_u32 s24, s43, 1920
    buffer_load_dwordx4 v1, s[8:11], s24 offen lds
    s_add_u32 m0, s41, 20480
    s_add_u32 s24, s44, 1920
    buffer_load_dwordx4 v1, s[8:11], s24 offen lds
    s_add_u32 m0, s42, 20480
    s_add_u32 s24, s45, 1920
    buffer_load_dwordx4 v1, s[8:11], s24 offen lds
    s_add_u32 m0, s47, 20480
    s_add_u32 s24, s46, 491520
    buffer_load_dwordx4 v2, s[12:15], s24 offen offset:0 lds
    buffer_load_dwordx4 v2, s[12:15], s24 offen offset:1024 lds
    s_waitcnt vmcnt(25)
    s_barrier
    s_waitcnt vmcnt(20)
    s_barrier
    s_waitcnt vmcnt(15)
    s_barrier
    s_waitcnt vmcnt(10)
    s_barrier
    s_waitcnt vmcnt(5)
    s_barrier
    s_waitcnt vmcnt(0)
    s_barrier
L_gemm2_kernel_done:
    s_endpgm
.globl joint_kernel
.p2align 8
.type joint_kernel,@function
joint_kernel:
    s_cmp_ge_u32 s2, 250
    s_cbranch_scc1 L_joint_kernel_done
    s_load_dwordx2 s[6:7], s[0:1], 72
    s_load_dwordx2 s[4:5], s[0:1], 56
    v_readfirstlane_b32 s20, v0
    s_lshr_b32 s20, s20, 6
    s_cmp_ge_u32 s2, 125
    s_cselect_b32 s24, 1, 0
    s_mul_i32 s25, s24, 125
    s_sub_u32 s25, s2, s25
    s_lshl_b32 s26, s25, 1
    s_add_u32 s26, s26, 0
    s_mul_i32 s27, s26, 171
    s_lshr_b32 s28, s27, 9
    s_mul_i32 s27, s28, 3
    s_sub_u32 s30, s26, s27
    s_lshl_b32 s26, s25, 1
    s_add_u32 s26, s26, 1
    s_mul_i32 s27, s26, 171
    s_lshr_b32 s29, s27, 9
    s_mul_i32 s27, s29, 3
    s_sub_u32 s31, s26, s27
    v_and_b32 v1, 63, v0
    v_lshrrev_b32 v2, 2, v1
    v_lshlrev_b32 v2, 6, v2
    v_lshrrev_b32 v3, 5, v1
    v_lshlrev_b32 v3, 1, v3
    v_and_b32 v4, 3, v1
    v_xor_b32 v3, v3, v4
    v_lshl_add_u32 v2, v3, 4, v2
    v_lshlrev_b32 v5, 4, v1
    s_waitcnt lgkmcnt(0)
    s_mul_i32 s33, s24, 2752512
    s_add_u32 s33, s33, 77807616
    s_add_u32 s8, s6, s33
    s_addc_u32 s9, s7, 0
    s_mov_b32 s10, 2752512
    s_mov_b32 s11, 0x00020000
    s_add_u32 s12, s6, 83312640
    s_addc_u32 s13, s7, 0
    s_mov_b32 s14, 294912
    s_mov_b32 s15, 0x00020000
    s_lshl_b32 s36, s30, 11
    s_add_u32 s36, s36, 8192
    buffer_load_dwordx4 v[8:11], v5, s[12:15], s36 offen offset:0
    buffer_load_dwordx4 v[12:15], v5, s[12:15], s36 offen offset:1024
    s_lshl_b32 s36, s31, 11
    s_add_u32 s36, s36, 8192
    buffer_load_dwordx4 v[16:19], v5, s[12:15], s36 offen offset:0
    buffer_load_dwordx4 v[20:23], v5, s[12:15], s36 offen offset:1024
    v_lshlrev_b32 v6, 5, v0
    s_lshl_b32 s36, s24, 13
    s_add_u32 s36, s36, 16384
    buffer_load_dwordx4 v[24:27], v6, s[12:15], s36 offen offset:0
    buffer_load_dwordx4 v[28:31], v6, s[12:15], s36 offen offset:16
    s_lshl_b32 s34, s20, 14
    s_lshl_b32 s35, s20, 13
    s_lshl_b32 s36, s28, 15
    s_add_u32 s36, s36, s35
    s_add_u32 m0, s34, 0
    s_add_u32 s37, s36, 0
    buffer_load_dwordx4 v2, s[8:11], s37 offen offset:0 lds
    buffer_load_dwordx4 v2, s[8:11], s37 offen offset:1024 lds
    buffer_load_dwordx4 v2, s[8:11], s37 offen offset:2048 lds
    buffer_load_dwordx4 v2, s[8:11], s37 offen offset:3072 lds
    s_add_u32 m0, s34, 4096
    s_add_u32 s37, s36, 4096
    buffer_load_dwordx4 v2, s[8:11], s37 offen offset:0 lds
    buffer_load_dwordx4 v2, s[8:11], s37 offen offset:1024 lds
    buffer_load_dwordx4 v2, s[8:11], s37 offen offset:2048 lds
    buffer_load_dwordx4 v2, s[8:11], s37 offen offset:3072 lds
    s_lshl_b32 s36, s29, 15
    s_add_u32 s36, s36, s35
    s_add_u32 m0, s34, 8192
    s_add_u32 s37, s36, 0
    buffer_load_dwordx4 v2, s[8:11], s37 offen offset:0 lds
    buffer_load_dwordx4 v2, s[8:11], s37 offen offset:1024 lds
    buffer_load_dwordx4 v2, s[8:11], s37 offen offset:2048 lds
    buffer_load_dwordx4 v2, s[8:11], s37 offen offset:3072 lds
    s_add_u32 m0, s34, 12288
    s_add_u32 s37, s36, 4096
    buffer_load_dwordx4 v2, s[8:11], s37 offen offset:0 lds
    buffer_load_dwordx4 v2, s[8:11], s37 offen offset:1024 lds
    buffer_load_dwordx4 v2, s[8:11], s37 offen offset:2048 lds
    buffer_load_dwordx4 v2, s[8:11], s37 offen offset:3072 lds
    s_lshl_b32 s38, s20, 15
    s_add_u32 s36, s38, 32768
    buffer_load_dwordx4 v[128:131], v5, s[12:15], s36 offen offset:0
    buffer_load_dwordx4 v[132:135], v5, s[12:15], s36 offen offset:1024
    buffer_load_dwordx4 v[136:139], v5, s[12:15], s36 offen offset:2048
    buffer_load_dwordx4 v[140:143], v5, s[12:15], s36 offen offset:3072
    s_add_u32 s36, s38, 36864
    buffer_load_dwordx4 v[144:147], v5, s[12:15], s36 offen offset:0
    buffer_load_dwordx4 v[148:151], v5, s[12:15], s36 offen offset:1024
    buffer_load_dwordx4 v[152:155], v5, s[12:15], s36 offen offset:2048
    buffer_load_dwordx4 v[156:159], v5, s[12:15], s36 offen offset:3072
    s_add_u32 s36, s38, 40960
    buffer_load_dwordx4 v[160:163], v5, s[12:15], s36 offen offset:0
    buffer_load_dwordx4 v[164:167], v5, s[12:15], s36 offen offset:1024
    buffer_load_dwordx4 v[168:171], v5, s[12:15], s36 offen offset:2048
    buffer_load_dwordx4 v[172:175], v5, s[12:15], s36 offen offset:3072
    s_add_u32 s36, s38, 45056
    buffer_load_dwordx4 v[176:179], v5, s[12:15], s36 offen offset:0
    buffer_load_dwordx4 v[180:183], v5, s[12:15], s36 offen offset:1024
    buffer_load_dwordx4 v[184:187], v5, s[12:15], s36 offen offset:2048
    buffer_load_dwordx4 v[188:191], v5, s[12:15], s36 offen offset:3072
    s_add_u32 s36, s38, 49152
    buffer_load_dwordx4 v[192:195], v5, s[12:15], s36 offen offset:0
    buffer_load_dwordx4 v[196:199], v5, s[12:15], s36 offen offset:1024
    buffer_load_dwordx4 v[200:203], v5, s[12:15], s36 offen offset:2048
    buffer_load_dwordx4 v[204:207], v5, s[12:15], s36 offen offset:3072
    s_add_u32 s36, s38, 53248
    buffer_load_dwordx4 v[208:211], v5, s[12:15], s36 offen offset:0
    buffer_load_dwordx4 v[212:215], v5, s[12:15], s36 offen offset:1024
    buffer_load_dwordx4 v[216:219], v5, s[12:15], s36 offen offset:2048
    buffer_load_dwordx4 v[220:223], v5, s[12:15], s36 offen offset:3072
    s_add_u32 s36, s38, 57344
    buffer_load_dwordx4 v[224:227], v5, s[12:15], s36 offen offset:0
    buffer_load_dwordx4 v[228:231], v5, s[12:15], s36 offen offset:1024
    buffer_load_dwordx4 v[232:235], v5, s[12:15], s36 offen offset:2048
    buffer_load_dwordx4 v[236:239], v5, s[12:15], s36 offen offset:3072
    s_add_u32 s36, s38, 61440
    buffer_load_dwordx4 v[240:243], v5, s[12:15], s36 offen offset:0
    buffer_load_dwordx4 v[244:247], v5, s[12:15], s36 offen offset:1024
    buffer_load_dwordx4 v[248:251], v5, s[12:15], s36 offen offset:2048
    buffer_load_dwordx4 v[252:255], v5, s[12:15], s36 offen offset:3072
    v_bfe_u32 v32, v1, 2, 2
    v_lshrrev_b32 v33, 4, v1
    v_and_b32 v34, 3, v1
    v_lshl_add_u32 v35, v33, 3, v32
    v_lshlrev_b32 v38, 6, v35
    v_and_b32 v39, 1, v33
    v_lshlrev_b32 v39, 1, v39
    v_lshrrev_b32 v40, 1, v34
    v_xor_b32 v39, v39, v40
    v_lshl_add_u32 v38, v39, 4, v38
    v_and_b32 v40, 1, v34
    v_lshl_add_u32 v38, v40, 3, v38
    v_add_u32 v36, s34, v38
    v_xor_b32 v37, 32, v36
    v_lshrrev_b32 v39, 1, v33
    v_lshlrev_b32 v39, 10, v39
    v_and_b32 v40, 1, v33
    v_lshl_add_u32 v39, v40, 9, v39
    v_and_b32 v40, 15, v1
    v_lshl_add_u32 v39, v40, 4, v39
    s_lshl_b32 s36, s20, 12
    s_add_u32 s36, s36, 65536
    v_add_u32 v41, s36, v39
    s_mov_b32 s40, 0xbdd2d3e8
    v_mov_b32 v42, 0xc0135761
    s_mul_i32 s36, s24, 4000
    s_lshl_b32 s37, s25, 5
    s_add_u32 s36, s36, s37
    s_lshl_b32 s36, s36, 12
    s_add_u32 s16, s4, s36
    s_addc_u32 s17, s5, 0
    s_mov_b32 s18, 131072
    s_mov_b32 s19, 0x00020000
    s_waitcnt vmcnt(48)
    s_mov_b32 s41, 0x42a80000
    s_mov_b64 s[42:43], 0
    v_max3_f32 v44, |v24|, |v25|, |v26|
    v_max3_f32 v44, v44, |v27|, |v28|
    v_max3_f32 v44, v44, |v29|, |v30|
    v_max_f32 v44, v44, |v31|
    v_add_f32 v45, v24, v25
    v_add_f32 v45, v45, v26
    v_add_f32 v45, v45, v27
    v_add_f32 v45, v45, v28
    v_add_f32 v45, v45, v29
    v_add_f32 v45, v45, v30
    v_add_f32 v45, v45, v31
    v_cmp_nge_f32 s[42:43], s41, v44
    v_cmp_u_f32 vcc, v45, v45
    s_nop 1
    s_or_b64 s[42:43], s[42:43], vcc
    s_cmp_lg_u64 s[42:43], 0
    s_cselect_b32 s44, 1, 0
    v_mov_b32 v44, s44
    s_lshl_b32 s45, s20, 2
    s_add_u32 s45, s45, 98304
    v_mov_b32 v45, s45
    ds_write_b32 v45, v44
    v_add_u32 v46, 90112, v6
    ds_write_b128 v46, v[24:27]
    ds_write_b128 v46, v[28:31] offset:16
    v_exp_f32 v24, v24
    v_exp_f32 v25, v25
    v_exp_f32 v26, v26
    v_exp_f32 v27, v27
    v_exp_f32 v28, v28
    v_exp_f32 v29, v29
    v_exp_f32 v30, v30
    v_exp_f32 v31, v31
    s_nop 0
    v_add_u32 v46, 81920, v6
    ds_write_b128 v46, v[24:27]
    ds_write_b128 v46, v[28:31] offset:16
    s_waitcnt vmcnt(44)
    s_add_u32 s36, s38, 163840
    buffer_load_dwordx4 a[0:3], v5, s[12:15], s36 offen offset:0
    buffer_load_dwordx4 a[4:7], v5, s[12:15], s36 offen offset:1024
    buffer_load_dwordx4 a[8:11], v5, s[12:15], s36 offen offset:2048
    buffer_load_dwordx4 a[12:15], v5, s[12:15], s36 offen offset:3072
    s_add_u32 s36, s38, 167936
    buffer_load_dwordx4 a[16:19], v5, s[12:15], s36 offen offset:0
    buffer_load_dwordx4 a[20:23], v5, s[12:15], s36 offen offset:1024
    buffer_load_dwordx4 a[24:27], v5, s[12:15], s36 offen offset:2048
    buffer_load_dwordx4 a[28:31], v5, s[12:15], s36 offen offset:3072
    ds_read_b64_tr_b16 v[48:49], v36 offset:0
    ds_read_b64_tr_b16 v[50:51], v36 offset:256
    ds_read_b64_tr_b16 v[52:53], v36 offset:2048
    ds_read_b64_tr_b16 v[54:55], v36 offset:2304
    ds_read_b64_tr_b16 v[56:57], v37 offset:0
    ds_read_b64_tr_b16 v[58:59], v37 offset:256
    ds_read_b64_tr_b16 v[60:61], v37 offset:2048
    ds_read_b64_tr_b16 v[62:63], v37 offset:2304
    s_waitcnt lgkmcnt(0)
    v_mfma_f32_16x16x32_bf16 v[64:67], v[48:51], v[8:11], 0
    v_mfma_f32_16x16x32_bf16 v[68:71], v[56:59], v[8:11], 0
    v_mfma_f32_16x16x32_bf16 v[64:67], v[52:55], v[12:15], v[64:67]
    v_mfma_f32_16x16x32_bf16 v[68:71], v[60:63], v[12:15], v[68:71]
    s_nop 7
    v_mul_f32 v72, v64, v64
    v_mul_f32 v73, v65, v65
    v_mul_f32 v74, v66, v66
    v_mul_f32 v75, v67, v67
    v_mul_f32 v76, v68, v68
    v_mul_f32 v77, v69, v69
    v_mul_f32 v78, v70, v70
    v_mul_f32 v79, v71, v71
    v_fma_f32 v72, v72, s40, v42
    v_fma_f32 v73, v73, s40, v42
    v_fma_f32 v74, v74, s40, v42
    v_fma_f32 v75, v75, s40, v42
    v_fma_f32 v76, v76, s40, v42
    v_fma_f32 v77, v77, s40, v42
    v_fma_f32 v78, v78, s40, v42
    v_fma_f32 v79, v79, s40, v42
    v_mul_f32 v72, v72, v64
    v_mul_f32 v73, v73, v65
    v_mul_f32 v74, v74, v66
    v_mul_f32 v75, v75, v67
    v_mul_f32 v76, v76, v68
    v_mul_f32 v77, v77, v69
    v_mul_f32 v78, v78, v70
    v_mul_f32 v79, v79, v71
    v_exp_f32 v72, v72
    v_exp_f32 v73, v73
    v_exp_f32 v74, v74
    v_exp_f32 v75, v75
    v_exp_f32 v76, v76
    v_exp_f32 v77, v77
    v_exp_f32 v78, v78
    v_exp_f32 v79, v79
    v_add_f32 v72, 1.0, v72
    v_add_f32 v73, 1.0, v73
    v_add_f32 v74, 1.0, v74
    v_add_f32 v75, 1.0, v75
    v_add_f32 v76, 1.0, v76
    v_add_f32 v77, 1.0, v77
    v_add_f32 v78, 1.0, v78
    v_add_f32 v79, 1.0, v79
    v_rcp_f32 v72, v72
    v_rcp_f32 v73, v73
    v_rcp_f32 v74, v74
    v_rcp_f32 v75, v75
    v_rcp_f32 v76, v76
    v_rcp_f32 v77, v77
    v_rcp_f32 v78, v78
    v_rcp_f32 v79, v79
    v_mul_f32 v64, v64, v72
    v_mul_f32 v65, v65, v73
    v_mul_f32 v66, v66, v74
    v_mul_f32 v67, v67, v75
    v_mul_f32 v68, v68, v76
    v_mul_f32 v69, v69, v77
    v_mul_f32 v70, v70, v78
    v_mul_f32 v71, v71, v79
    v_cvt_pk_bf16_f32 v80, v64, v65
    v_cvt_pk_bf16_f32 v81, v66, v67
    v_cvt_pk_bf16_f32 v82, v68, v69
    v_cvt_pk_bf16_f32 v83, v70, v71
    ds_write_b128 v41, v[80:83] offset:0
    s_waitcnt vmcnt(48)
    ds_read_b64_tr_b16 v[48:49], v36 offset:4096
    ds_read_b64_tr_b16 v[50:51], v36 offset:4352
    ds_read_b64_tr_b16 v[52:53], v36 offset:6144
    ds_read_b64_tr_b16 v[54:55], v36 offset:6400
    ds_read_b64_tr_b16 v[56:57], v37 offset:4096
    ds_read_b64_tr_b16 v[58:59], v37 offset:4352
    ds_read_b64_tr_b16 v[60:61], v37 offset:6144
    ds_read_b64_tr_b16 v[62:63], v37 offset:6400
    s_waitcnt lgkmcnt(0)
    v_mfma_f32_16x16x32_bf16 v[64:67], v[48:51], v[8:11], 0
    v_mfma_f32_16x16x32_bf16 v[68:71], v[56:59], v[8:11], 0
    v_mfma_f32_16x16x32_bf16 v[64:67], v[52:55], v[12:15], v[64:67]
    v_mfma_f32_16x16x32_bf16 v[68:71], v[60:63], v[12:15], v[68:71]
    s_nop 7
    v_mul_f32 v72, v64, v64
    v_mul_f32 v73, v65, v65
    v_mul_f32 v74, v66, v66
    v_mul_f32 v75, v67, v67
    v_mul_f32 v76, v68, v68
    v_mul_f32 v77, v69, v69
    v_mul_f32 v78, v70, v70
    v_mul_f32 v79, v71, v71
    v_fma_f32 v72, v72, s40, v42
    v_fma_f32 v73, v73, s40, v42
    v_fma_f32 v74, v74, s40, v42
    v_fma_f32 v75, v75, s40, v42
    v_fma_f32 v76, v76, s40, v42
    v_fma_f32 v77, v77, s40, v42
    v_fma_f32 v78, v78, s40, v42
    v_fma_f32 v79, v79, s40, v42
    v_mul_f32 v72, v72, v64
    v_mul_f32 v73, v73, v65
    v_mul_f32 v74, v74, v66
    v_mul_f32 v75, v75, v67
    v_mul_f32 v76, v76, v68
    v_mul_f32 v77, v77, v69
    v_mul_f32 v78, v78, v70
    v_mul_f32 v79, v79, v71
    v_exp_f32 v72, v72
    v_exp_f32 v73, v73
    v_exp_f32 v74, v74
    v_exp_f32 v75, v75
    v_exp_f32 v76, v76
    v_exp_f32 v77, v77
    v_exp_f32 v78, v78
    v_exp_f32 v79, v79
    v_add_f32 v72, 1.0, v72
    v_add_f32 v73, 1.0, v73
    v_add_f32 v74, 1.0, v74
    v_add_f32 v75, 1.0, v75
    v_add_f32 v76, 1.0, v76
    v_add_f32 v77, 1.0, v77
    v_add_f32 v78, 1.0, v78
    v_add_f32 v79, 1.0, v79
    v_rcp_f32 v72, v72
    v_rcp_f32 v73, v73
    v_rcp_f32 v74, v74
    v_rcp_f32 v75, v75
    v_rcp_f32 v76, v76
    v_rcp_f32 v77, v77
    v_rcp_f32 v78, v78
    v_rcp_f32 v79, v79
    v_mul_f32 v64, v64, v72
    v_mul_f32 v65, v65, v73
    v_mul_f32 v66, v66, v74
    v_mul_f32 v67, v67, v75
    v_mul_f32 v68, v68, v76
    v_mul_f32 v69, v69, v77
    v_mul_f32 v70, v70, v78
    v_mul_f32 v71, v71, v79
    v_cvt_pk_bf16_f32 v80, v64, v65
    v_cvt_pk_bf16_f32 v81, v66, v67
    v_cvt_pk_bf16_f32 v82, v68, v69
    v_cvt_pk_bf16_f32 v83, v70, v71
    ds_write_b128 v41, v[80:83] offset:2048
    s_waitcnt vmcnt(44)
    ds_read_b64_tr_b16 v[48:49], v36 offset:8192
    ds_read_b64_tr_b16 v[50:51], v36 offset:8448
    ds_read_b64_tr_b16 v[52:53], v36 offset:10240
    ds_read_b64_tr_b16 v[54:55], v36 offset:10496
    ds_read_b64_tr_b16 v[56:57], v37 offset:8192
    ds_read_b64_tr_b16 v[58:59], v37 offset:8448
    ds_read_b64_tr_b16 v[60:61], v37 offset:10240
    ds_read_b64_tr_b16 v[62:63], v37 offset:10496
    s_waitcnt lgkmcnt(0)
    v_mfma_f32_16x16x32_bf16 v[64:67], v[48:51], v[16:19], 0
    v_mfma_f32_16x16x32_bf16 v[68:71], v[56:59], v[16:19], 0
    v_mfma_f32_16x16x32_bf16 v[64:67], v[52:55], v[20:23], v[64:67]
    v_mfma_f32_16x16x32_bf16 v[68:71], v[60:63], v[20:23], v[68:71]
    s_nop 7
    v_mul_f32 v72, v64, v64
    v_mul_f32 v73, v65, v65
    v_mul_f32 v74, v66, v66
    v_mul_f32 v75, v67, v67
    v_mul_f32 v76, v68, v68
    v_mul_f32 v77, v69, v69
    v_mul_f32 v78, v70, v70
    v_mul_f32 v79, v71, v71
    v_fma_f32 v72, v72, s40, v42
    v_fma_f32 v73, v73, s40, v42
    v_fma_f32 v74, v74, s40, v42
    v_fma_f32 v75, v75, s40, v42
    v_fma_f32 v76, v76, s40, v42
    v_fma_f32 v77, v77, s40, v42
    v_fma_f32 v78, v78, s40, v42
    v_fma_f32 v79, v79, s40, v42
    v_mul_f32 v72, v72, v64
    v_mul_f32 v73, v73, v65
    v_mul_f32 v74, v74, v66
    v_mul_f32 v75, v75, v67
    v_mul_f32 v76, v76, v68
    v_mul_f32 v77, v77, v69
    v_mul_f32 v78, v78, v70
    v_mul_f32 v79, v79, v71
    v_exp_f32 v72, v72
    v_exp_f32 v73, v73
    v_exp_f32 v74, v74
    v_exp_f32 v75, v75
    v_exp_f32 v76, v76
    v_exp_f32 v77, v77
    v_exp_f32 v78, v78
    v_exp_f32 v79, v79
    v_add_f32 v72, 1.0, v72
    v_add_f32 v73, 1.0, v73
    v_add_f32 v74, 1.0, v74
    v_add_f32 v75, 1.0, v75
    v_add_f32 v76, 1.0, v76
    v_add_f32 v77, 1.0, v77
    v_add_f32 v78, 1.0, v78
    v_add_f32 v79, 1.0, v79
    v_rcp_f32 v72, v72
    v_rcp_f32 v73, v73
    v_rcp_f32 v74, v74
    v_rcp_f32 v75, v75
    v_rcp_f32 v76, v76
    v_rcp_f32 v77, v77
    v_rcp_f32 v78, v78
    v_rcp_f32 v79, v79
    v_mul_f32 v64, v64, v72
    v_mul_f32 v65, v65, v73
    v_mul_f32 v66, v66, v74
    v_mul_f32 v67, v67, v75
    v_mul_f32 v68, v68, v76
    v_mul_f32 v69, v69, v77
    v_mul_f32 v70, v70, v78
    v_mul_f32 v71, v71, v79
    v_cvt_pk_bf16_f32 v80, v64, v65
    v_cvt_pk_bf16_f32 v81, v66, v67
    v_cvt_pk_bf16_f32 v82, v68, v69
    v_cvt_pk_bf16_f32 v83, v70, v71
    ds_write_b128 v41, v[80:83] offset:256
    s_waitcnt vmcnt(40)
    ds_read_b64_tr_b16 v[48:49], v36 offset:12288
    ds_read_b64_tr_b16 v[50:51], v36 offset:12544
    ds_read_b64_tr_b16 v[52:53], v36 offset:14336
    ds_read_b64_tr_b16 v[54:55], v36 offset:14592
    ds_read_b64_tr_b16 v[56:57], v37 offset:12288
    ds_read_b64_tr_b16 v[58:59], v37 offset:12544
    ds_read_b64_tr_b16 v[60:61], v37 offset:14336
    ds_read_b64_tr_b16 v[62:63], v37 offset:14592
    s_waitcnt lgkmcnt(0)
    v_mfma_f32_16x16x32_bf16 v[64:67], v[48:51], v[16:19], 0
    v_mfma_f32_16x16x32_bf16 v[68:71], v[56:59], v[16:19], 0
    v_mfma_f32_16x16x32_bf16 v[64:67], v[52:55], v[20:23], v[64:67]
    v_mfma_f32_16x16x32_bf16 v[68:71], v[60:63], v[20:23], v[68:71]
    s_nop 7
    v_mul_f32 v72, v64, v64
    v_mul_f32 v73, v65, v65
    v_mul_f32 v74, v66, v66
    v_mul_f32 v75, v67, v67
    v_mul_f32 v76, v68, v68
    v_mul_f32 v77, v69, v69
    v_mul_f32 v78, v70, v70
    v_mul_f32 v79, v71, v71
    v_fma_f32 v72, v72, s40, v42
    v_fma_f32 v73, v73, s40, v42
    v_fma_f32 v74, v74, s40, v42
    v_fma_f32 v75, v75, s40, v42
    v_fma_f32 v76, v76, s40, v42
    v_fma_f32 v77, v77, s40, v42
    v_fma_f32 v78, v78, s40, v42
    v_fma_f32 v79, v79, s40, v42
    v_mul_f32 v72, v72, v64
    v_mul_f32 v73, v73, v65
    v_mul_f32 v74, v74, v66
    v_mul_f32 v75, v75, v67
    v_mul_f32 v76, v76, v68
    v_mul_f32 v77, v77, v69
    v_mul_f32 v78, v78, v70
    v_mul_f32 v79, v79, v71
    v_exp_f32 v72, v72
    v_exp_f32 v73, v73
    v_exp_f32 v74, v74
    v_exp_f32 v75, v75
    v_exp_f32 v76, v76
    v_exp_f32 v77, v77
    v_exp_f32 v78, v78
    v_exp_f32 v79, v79
    v_add_f32 v72, 1.0, v72
    v_add_f32 v73, 1.0, v73
    v_add_f32 v74, 1.0, v74
    v_add_f32 v75, 1.0, v75
    v_add_f32 v76, 1.0, v76
    v_add_f32 v77, 1.0, v77
    v_add_f32 v78, 1.0, v78
    v_add_f32 v79, 1.0, v79
    v_rcp_f32 v72, v72
    v_rcp_f32 v73, v73
    v_rcp_f32 v74, v74
    v_rcp_f32 v75, v75
    v_rcp_f32 v76, v76
    v_rcp_f32 v77, v77
    v_rcp_f32 v78, v78
    v_rcp_f32 v79, v79
    v_mul_f32 v64, v64, v72
    v_mul_f32 v65, v65, v73
    v_mul_f32 v66, v66, v74
    v_mul_f32 v67, v67, v75
    v_mul_f32 v68, v68, v76
    v_mul_f32 v69, v69, v77
    v_mul_f32 v70, v70, v78
    v_mul_f32 v71, v71, v79
    v_cvt_pk_bf16_f32 v80, v64, v65
    v_cvt_pk_bf16_f32 v81, v66, v67
    v_cvt_pk_bf16_f32 v82, v68, v69
    v_cvt_pk_bf16_f32 v83, v70, v71
    ds_write_b128 v41, v[80:83] offset:2304
    s_waitcnt lgkmcnt(0)
    s_barrier
    v_mov_b32 v96, 98304
    ds_read_b128 v[100:103], v96
    v_add_u32 v97, 65536, v5
    ds_read_b128 v[64:67], v97 offset:0
    ds_read_b128 v[68:71], v97 offset:1024
    ds_read_b128 v[72:75], v97 offset:2048
    ds_read_b128 v[76:79], v97 offset:3072
    ds_read_b128 v[80:83], v97 offset:4096
    ds_read_b128 v[84:87], v97 offset:5120
    ds_read_b128 v[88:91], v97 offset:6144
    ds_read_b128 v[92:95], v97 offset:7168
    s_waitcnt vmcnt(16)
    s_waitcnt lgkmcnt(0)
    v_mfma_f32_32x32x16_bf16 v[32:47], v[128:131], v[64:67], 0
    v_mfma_f32_32x32x16_bf16 v[48:63], v[192:195], v[64:67], 0
    v_mfma_f32_32x32x16_bf16 v[32:47], v[132:135], v[68:71], v[32:47]
    v_mfma_f32_32x32x16_bf16 v[48:63], v[196:199], v[68:71], v[48:63]
    v_mfma_f32_32x32x16_bf16 v[32:47], v[136:139], v[72:75], v[32:47]
    v_mfma_f32_32x32x16_bf16 v[48:63], v[200:203], v[72:75], v[48:63]
    v_mfma_f32_32x32x16_bf16 v[32:47], v[140:143], v[76:79], v[32:47]
    v_mfma_f32_32x32x16_bf16 v[48:63], v[204:207], v[76:79], v[48:63]
    v_mfma_f32_32x32x16_bf16 v[32:47], v[144:147], v[80:83], v[32:47]
    v_mfma_f32_32x32x16_bf16 v[48:63], v[208:211], v[80:83], v[48:63]
    v_mfma_f32_32x32x16_bf16 v[32:47], v[148:151], v[84:87], v[32:47]
    v_mfma_f32_32x32x16_bf16 v[48:63], v[212:215], v[84:87], v[48:63]
    v_mfma_f32_32x32x16_bf16 v[32:47], v[152:155], v[88:91], v[32:47]
    v_mfma_f32_32x32x16_bf16 v[48:63], v[216:219], v[88:91], v[48:63]
    v_mfma_f32_32x32x16_bf16 v[32:47], v[156:159], v[92:95], v[32:47]
    v_mfma_f32_32x32x16_bf16 v[48:63], v[220:223], v[92:95], v[48:63]
    s_add_u32 s36, s38, 172032
    buffer_load_dwordx4 a[32:35], v5, s[12:15], s36 offen offset:0
    buffer_load_dwordx4 a[36:39], v5, s[12:15], s36 offen offset:1024
    buffer_load_dwordx4 a[40:43], v5, s[12:15], s36 offen offset:2048
    buffer_load_dwordx4 a[44:47], v5, s[12:15], s36 offen offset:3072
    s_add_u32 s36, s38, 176128
    buffer_load_dwordx4 a[48:51], v5, s[12:15], s36 offen offset:0
    buffer_load_dwordx4 a[52:55], v5, s[12:15], s36 offen offset:1024
    buffer_load_dwordx4 a[56:59], v5, s[12:15], s36 offen offset:2048
    buffer_load_dwordx4 a[60:63], v5, s[12:15], s36 offen offset:3072
    s_add_u32 s36, s38, 180224
    buffer_load_dwordx4 a[64:67], v5, s[12:15], s36 offen offset:0
    buffer_load_dwordx4 a[68:71], v5, s[12:15], s36 offen offset:1024
    buffer_load_dwordx4 a[72:75], v5, s[12:15], s36 offen offset:2048
    buffer_load_dwordx4 a[76:79], v5, s[12:15], s36 offen offset:3072
    ds_read_b128 v[64:67], v97 offset:8192
    ds_read_b128 v[68:71], v97 offset:9216
    ds_read_b128 v[72:75], v97 offset:10240
    ds_read_b128 v[76:79], v97 offset:11264
    ds_read_b128 v[80:83], v97 offset:12288
    ds_read_b128 v[84:87], v97 offset:13312
    ds_read_b128 v[88:91], v97 offset:14336
    ds_read_b128 v[92:95], v97 offset:15360
    s_waitcnt vmcnt(20)
    s_waitcnt lgkmcnt(0)
    v_mfma_f32_32x32x16_bf16 v[32:47], v[160:163], v[64:67], v[32:47]
    v_mfma_f32_32x32x16_bf16 v[48:63], v[224:227], v[64:67], v[48:63]
    v_mfma_f32_32x32x16_bf16 v[32:47], v[164:167], v[68:71], v[32:47]
    v_mfma_f32_32x32x16_bf16 v[48:63], v[228:231], v[68:71], v[48:63]
    v_mfma_f32_32x32x16_bf16 v[32:47], v[168:171], v[72:75], v[32:47]
    v_mfma_f32_32x32x16_bf16 v[48:63], v[232:235], v[72:75], v[48:63]
    v_mfma_f32_32x32x16_bf16 v[32:47], v[172:175], v[76:79], v[32:47]
    v_mfma_f32_32x32x16_bf16 v[48:63], v[236:239], v[76:79], v[48:63]
    v_mfma_f32_32x32x16_bf16 v[32:47], v[176:179], v[80:83], v[32:47]
    v_mfma_f32_32x32x16_bf16 v[48:63], v[240:243], v[80:83], v[48:63]
    v_mfma_f32_32x32x16_bf16 v[32:47], v[180:183], v[84:87], v[32:47]
    v_mfma_f32_32x32x16_bf16 v[48:63], v[244:247], v[84:87], v[48:63]
    v_mfma_f32_32x32x16_bf16 v[32:47], v[184:187], v[88:91], v[32:47]
    v_mfma_f32_32x32x16_bf16 v[48:63], v[248:251], v[88:91], v[48:63]
    v_mfma_f32_32x32x16_bf16 v[32:47], v[188:191], v[92:95], v[32:47]
    v_mfma_f32_32x32x16_bf16 v[48:63], v[252:255], v[92:95], v[48:63]
    s_add_u32 s36, s38, 184320
    buffer_load_dwordx4 a[80:83], v5, s[12:15], s36 offen offset:0
    buffer_load_dwordx4 a[84:87], v5, s[12:15], s36 offen offset:1024
    buffer_load_dwordx4 a[88:91], v5, s[12:15], s36 offen offset:2048
    buffer_load_dwordx4 a[92:95], v5, s[12:15], s36 offen offset:3072
    s_add_u32 s36, s38, 188416
    buffer_load_dwordx4 a[96:99], v5, s[12:15], s36 offen offset:0
    buffer_load_dwordx4 a[100:103], v5, s[12:15], s36 offen offset:1024
    buffer_load_dwordx4 a[104:107], v5, s[12:15], s36 offen offset:2048
    buffer_load_dwordx4 a[108:111], v5, s[12:15], s36 offen offset:3072
    s_add_u32 s36, s38, 192512
    buffer_load_dwordx4 a[112:115], v5, s[12:15], s36 offen offset:0
    buffer_load_dwordx4 a[116:119], v5, s[12:15], s36 offen offset:1024
    buffer_load_dwordx4 a[120:123], v5, s[12:15], s36 offen offset:2048
    buffer_load_dwordx4 a[124:127], v5, s[12:15], s36 offen offset:3072
    v_or_b32 v100, v100, v101
    v_or_b32 v102, v102, v103
    v_or_b32 v100, v100, v102
    s_nop 0
    v_readfirstlane_b32 s44, v100
    s_nop 7
    s_mov_b32 s41, 0x4038aa3b
    v_cvt_pk_bf16_f32 v64, v32, v33
    v_cvt_pk_bf16_f32 v65, v34, v35
    v_cvt_pk_bf16_f32 v66, v36, v37
    v_cvt_pk_bf16_f32 v67, v38, v39
    v_cvt_pk_bf16_f32 v68, v40, v41
    v_cvt_pk_bf16_f32 v69, v42, v43
    v_cvt_pk_bf16_f32 v70, v44, v45
    v_cvt_pk_bf16_f32 v71, v46, v47
    v_cvt_pk_bf16_f32 v72, v48, v49
    v_cvt_pk_bf16_f32 v73, v50, v51
    v_cvt_pk_bf16_f32 v74, v52, v53
    v_cvt_pk_bf16_f32 v75, v54, v55
    v_cvt_pk_bf16_f32 v76, v56, v57
    v_cvt_pk_bf16_f32 v77, v58, v59
    v_cvt_pk_bf16_f32 v78, v60, v61
    v_cvt_pk_bf16_f32 v79, v62, v63
    v_lshlrev_b32 v96, 16, v64
    v_and_b32 v97, 0xffff0000, v64
    v_lshlrev_b32 v98, 16, v65
    v_and_b32 v99, 0xffff0000, v65
    v_lshlrev_b32 v100, 16, v66
    v_and_b32 v101, 0xffff0000, v66
    v_lshlrev_b32 v102, 16, v67
    v_and_b32 v103, 0xffff0000, v67
    v_lshlrev_b32 v104, 16, v68
    v_and_b32 v105, 0xffff0000, v68
    v_lshlrev_b32 v106, 16, v69
    v_and_b32 v107, 0xffff0000, v69
    v_lshlrev_b32 v108, 16, v70
    v_and_b32 v109, 0xffff0000, v70
    v_lshlrev_b32 v110, 16, v71
    v_and_b32 v111, 0xffff0000, v71
    v_lshlrev_b32 v112, 16, v72
    v_and_b32 v113, 0xffff0000, v72
    v_lshlrev_b32 v114, 16, v73
    v_and_b32 v115, 0xffff0000, v73
    v_lshlrev_b32 v116, 16, v74
    v_and_b32 v117, 0xffff0000, v74
    v_lshlrev_b32 v118, 16, v75
    v_and_b32 v119, 0xffff0000, v75
    v_lshlrev_b32 v120, 16, v76
    v_and_b32 v121, 0xffff0000, v76
    v_lshlrev_b32 v122, 16, v77
    v_and_b32 v123, 0xffff0000, v77
    v_lshlrev_b32 v124, 16, v78
    v_and_b32 v125, 0xffff0000, v78
    v_lshlrev_b32 v126, 16, v79
    v_and_b32 v127, 0xffff0000, v79
    v_mul_f32 v96, s41, v96
    v_mul_f32 v97, s41, v97
    v_mul_f32 v98, s41, v98
    v_mul_f32 v99, s41, v99
    v_mul_f32 v100, s41, v100
    v_mul_f32 v101, s41, v101
    v_mul_f32 v102, s41, v102
    v_mul_f32 v103, s41, v103
    v_mul_f32 v104, s41, v104
    v_mul_f32 v105, s41, v105
    v_mul_f32 v106, s41, v106
    v_mul_f32 v107, s41, v107
    v_mul_f32 v108, s41, v108
    v_mul_f32 v109, s41, v109
    v_mul_f32 v110, s41, v110
    v_mul_f32 v111, s41, v111
    v_mul_f32 v112, s41, v112
    v_mul_f32 v113, s41, v113
    v_mul_f32 v114, s41, v114
    v_mul_f32 v115, s41, v115
    v_mul_f32 v116, s41, v116
    v_mul_f32 v117, s41, v117
    v_mul_f32 v118, s41, v118
    v_mul_f32 v119, s41, v119
    v_mul_f32 v120, s41, v120
    v_mul_f32 v121, s41, v121
    v_mul_f32 v122, s41, v122
    v_mul_f32 v123, s41, v123
    v_mul_f32 v124, s41, v124
    v_mul_f32 v125, s41, v125
    v_mul_f32 v126, s41, v126
    v_mul_f32 v127, s41, v127
    v_max3_f32 v64, |v96|, |v97|, |v98|
    v_max3_f32 v64, v64, |v99|, |v100|
    v_max3_f32 v64, v64, |v101|, |v102|
    v_max3_f32 v64, v64, |v103|, |v104|
    v_max3_f32 v64, v64, |v105|, |v106|
    v_max3_f32 v64, v64, |v107|, |v108|
    v_max3_f32 v64, v64, |v109|, |v110|
    v_max3_f32 v64, v64, |v111|, |v112|
    v_max3_f32 v64, v64, |v113|, |v114|
    v_max3_f32 v64, v64, |v115|, |v116|
    v_max3_f32 v64, v64, |v117|, |v118|
    v_max3_f32 v64, v64, |v119|, |v120|
    v_max3_f32 v64, v64, |v121|, |v122|
    v_max3_f32 v64, v64, |v123|, |v124|
    v_max3_f32 v64, v64, |v125|, |v126|
    v_max_f32 v64, v64, |v127|
    v_add_f32 v65, v96, v97
    v_add_f32 v65, v65, v98
    v_add_f32 v65, v65, v99
    v_add_f32 v65, v65, v100
    v_add_f32 v65, v65, v101
    v_add_f32 v65, v65, v102
    v_add_f32 v65, v65, v103
    v_add_f32 v65, v65, v104
    v_add_f32 v65, v65, v105
    v_add_f32 v65, v65, v106
    v_add_f32 v65, v65, v107
    v_add_f32 v65, v65, v108
    v_add_f32 v65, v65, v109
    v_add_f32 v65, v65, v110
    v_add_f32 v65, v65, v111
    v_add_f32 v65, v65, v112
    v_add_f32 v65, v65, v113
    v_add_f32 v65, v65, v114
    v_add_f32 v65, v65, v115
    v_add_f32 v65, v65, v116
    v_add_f32 v65, v65, v117
    v_add_f32 v65, v65, v118
    v_add_f32 v65, v65, v119
    v_add_f32 v65, v65, v120
    v_add_f32 v65, v65, v121
    v_add_f32 v65, v65, v122
    v_add_f32 v65, v65, v123
    v_add_f32 v65, v65, v124
    v_add_f32 v65, v65, v125
    v_add_f32 v65, v65, v126
    v_add_f32 v65, v65, v127
    s_mov_b32 s41, 0x42200000
    v_cmp_nge_f32 s[42:43], s41, v64
    v_cmp_u_f32 vcc, v65, v65
    s_nop 1
    s_or_b64 s[42:43], s[42:43], vcc
    s_cmp_lg_u64 s[42:43], 0
    s_cselect_b32 s45, 1, 0
    s_or_b32 s44, s44, s45
    s_lshl_b32 s36, s20, 12
    v_add_u32 v2, s36, v5
    v_mov_b32 v3, v5
    v_lshrrev_b32 v8, 5, v1
    v_lshlrev_b32 v8, 4, v8
    s_lshl_b32 s36, s20, 8
    v_add_u32 v4, s36, v8
    v_and_b32 v8, 15, v1
    v_lshlrev_b32 v6, 12, v8
    v_bfe_u32 v8, v1, 4, 1
    v_lshl_add_u32 v6, v8, 5, v6
    v_lshrrev_b32 v8, 5, v1
    v_lshl_add_u32 v6, v8, 4, v6
    s_lshl_b32 s36, s20, 7
    v_add_u32 v6, s36, v6
    v_add_u32 v7, 65536, v6
    s_cmp_lg_u32 s44, 0
    s_cbranch_scc1 L_joint_kernel_slow
    v_add_u32 v4, 81920, v4
    v_exp_f32 v96, v96
    v_exp_f32 v97, v97
    v_exp_f32 v98, v98
    v_exp_f32 v99, v99
    v_exp_f32 v100, v100
    v_exp_f32 v101, v101
    v_exp_f32 v102, v102
    v_exp_f32 v103, v103
    v_exp_f32 v104, v104
    v_exp_f32 v105, v105
    v_exp_f32 v106, v106
    v_exp_f32 v107, v107
    v_exp_f32 v108, v108
    v_exp_f32 v109, v109
    v_exp_f32 v110, v110
    v_exp_f32 v111, v111
    v_exp_f32 v112, v112
    v_exp_f32 v113, v113
    v_exp_f32 v114, v114
    v_exp_f32 v115, v115
    v_exp_f32 v116, v116
    v_exp_f32 v117, v117
    v_exp_f32 v118, v118
    v_exp_f32 v119, v119
    v_exp_f32 v120, v120
    v_exp_f32 v121, v121
    v_exp_f32 v122, v122
    v_exp_f32 v123, v123
    v_exp_f32 v124, v124
    v_exp_f32 v125, v125
    v_exp_f32 v126, v126
    v_exp_f32 v127, v127
    ds_read_b128 v[128:131], v4 offset:0
    ds_read_b128 v[132:135], v4 offset:32
    ds_read_b128 v[136:139], v4 offset:64
    ds_read_b128 v[140:143], v4 offset:96
    ds_read_b128 v[144:147], v4 offset:128
    ds_read_b128 v[148:151], v4 offset:160
    ds_read_b128 v[152:155], v4 offset:192
    ds_read_b128 v[156:159], v4 offset:224
    s_waitcnt lgkmcnt(0)
    v_fma_f32 v160, v96, v128, 1.0
    v_fma_f32 v161, v97, v129, 1.0
    v_fma_f32 v162, v98, v130, 1.0
    v_fma_f32 v163, v99, v131, 1.0
    v_fma_f32 v164, v100, v132, 1.0
    v_fma_f32 v165, v101, v133, 1.0
    v_fma_f32 v166, v102, v134, 1.0
    v_fma_f32 v167, v103, v135, 1.0
    v_rcp_f32 v160, v160
    v_rcp_f32 v161, v161
    v_rcp_f32 v162, v162
    v_rcp_f32 v163, v163
    v_rcp_f32 v164, v164
    v_rcp_f32 v165, v165
    v_rcp_f32 v166, v166
    v_rcp_f32 v167, v167
    v_fma_f32 v160, v160, -2.0, 1.0
    v_fma_f32 v161, v161, -2.0, 1.0
    v_fma_f32 v162, v162, -2.0, 1.0
    v_fma_f32 v163, v163, -2.0, 1.0
    v_fma_f32 v164, v164, -2.0, 1.0
    v_fma_f32 v165, v165, -2.0, 1.0
    v_fma_f32 v166, v166, -2.0, 1.0
    v_fma_f32 v167, v167, -2.0, 1.0
    v_cvt_pk_bf16_f32 v192, v160, v161
    v_cvt_pk_bf16_f32 v193, v162, v163
    v_cvt_pk_bf16_f32 v194, v164, v165
    v_cvt_pk_bf16_f32 v195, v166, v167
    ds_write_b128 v2, v[192:195] offset:0
    v_fma_f32 v168, v104, v136, 1.0
    v_fma_f32 v169, v105, v137, 1.0
    v_fma_f32 v170, v106, v138, 1.0
    v_fma_f32 v171, v107, v139, 1.0
    v_fma_f32 v172, v108, v140, 1.0
    v_fma_f32 v173, v109, v141, 1.0
    v_fma_f32 v174, v110, v142, 1.0
    v_fma_f32 v175, v111, v143, 1.0
    v_rcp_f32 v168, v168
    v_rcp_f32 v169, v169
    v_rcp_f32 v170, v170
    v_rcp_f32 v171, v171
    v_rcp_f32 v172, v172
    v_rcp_f32 v173, v173
    v_rcp_f32 v174, v174
    v_rcp_f32 v175, v175
    v_fma_f32 v168, v168, -2.0, 1.0
    v_fma_f32 v169, v169, -2.0, 1.0
    v_fma_f32 v170, v170, -2.0, 1.0
    v_fma_f32 v171, v171, -2.0, 1.0
    v_fma_f32 v172, v172, -2.0, 1.0
    v_fma_f32 v173, v173, -2.0, 1.0
    v_fma_f32 v174, v174, -2.0, 1.0
    v_fma_f32 v175, v175, -2.0, 1.0
    v_cvt_pk_bf16_f32 v196, v168, v169
    v_cvt_pk_bf16_f32 v197, v170, v171
    v_cvt_pk_bf16_f32 v198, v172, v173
    v_cvt_pk_bf16_f32 v199, v174, v175
    ds_write_b128 v2, v[196:199] offset:1024
    v_fma_f32 v176, v112, v144, 1.0
    v_fma_f32 v177, v113, v145, 1.0
    v_fma_f32 v178, v114, v146, 1.0
    v_fma_f32 v179, v115, v147, 1.0
    v_fma_f32 v180, v116, v148, 1.0
    v_fma_f32 v181, v117, v149, 1.0
    v_fma_f32 v182, v118, v150, 1.0
    v_fma_f32 v183, v119, v151, 1.0
    v_rcp_f32 v176, v176
    v_rcp_f32 v177, v177
    v_rcp_f32 v178, v178
    v_rcp_f32 v179, v179
    v_rcp_f32 v180, v180
    v_rcp_f32 v181, v181
    v_rcp_f32 v182, v182
    v_rcp_f32 v183, v183
    v_fma_f32 v176, v176, -2.0, 1.0
    v_fma_f32 v177, v177, -2.0, 1.0
    v_fma_f32 v178, v178, -2.0, 1.0
    v_fma_f32 v179, v179, -2.0, 1.0
    v_fma_f32 v180, v180, -2.0, 1.0
    v_fma_f32 v181, v181, -2.0, 1.0
    v_fma_f32 v182, v182, -2.0, 1.0
    v_fma_f32 v183, v183, -2.0, 1.0
    v_cvt_pk_bf16_f32 v200, v176, v177
    v_cvt_pk_bf16_f32 v201, v178, v179
    v_cvt_pk_bf16_f32 v202, v180, v181
    v_cvt_pk_bf16_f32 v203, v182, v183
    ds_write_b128 v2, v[200:203] offset:2048
    v_fma_f32 v184, v120, v152, 1.0
    v_fma_f32 v185, v121, v153, 1.0
    v_fma_f32 v186, v122, v154, 1.0
    v_fma_f32 v187, v123, v155, 1.0
    v_fma_f32 v188, v124, v156, 1.0
    v_fma_f32 v189, v125, v157, 1.0
    v_fma_f32 v190, v126, v158, 1.0
    v_fma_f32 v191, v127, v159, 1.0
    v_rcp_f32 v184, v184
    v_rcp_f32 v185, v185
    v_rcp_f32 v186, v186
    v_rcp_f32 v187, v187
    v_rcp_f32 v188, v188
    v_rcp_f32 v189, v189
    v_rcp_f32 v190, v190
    v_rcp_f32 v191, v191
    v_fma_f32 v184, v184, -2.0, 1.0
    v_fma_f32 v185, v185, -2.0, 1.0
    v_fma_f32 v186, v186, -2.0, 1.0
    v_fma_f32 v187, v187, -2.0, 1.0
    v_fma_f32 v188, v188, -2.0, 1.0
    v_fma_f32 v189, v189, -2.0, 1.0
    v_fma_f32 v190, v190, -2.0, 1.0
    v_fma_f32 v191, v191, -2.0, 1.0
    v_cvt_pk_bf16_f32 v204, v184, v185
    v_cvt_pk_bf16_f32 v205, v186, v187
    v_cvt_pk_bf16_f32 v206, v188, v189
    v_cvt_pk_bf16_f32 v207, v190, v191
    ds_write_b128 v2, v[204:207] offset:3072
    s_waitcnt vmcnt(0)
    s_waitcnt lgkmcnt(0)
    s_barrier
    ds_read_b128 v[72:75], v3 offset:0
    ds_read_b128 v[76:79], v3 offset:1024
    ds_read_b128 v[80:83], v3 offset:2048
    ds_read_b128 v[84:87], v3 offset:3072
    s_waitcnt lgkmcnt(3)
    v_mfma_f32_32x32x16_bf16 v[8:23], a[0:3], v[72:75], 0
    ds_read_b128 v[88:91], v3 offset:4096
    ds_read_b128 v[128:131], v4 offset:1024
    ds_read_b128 v[132:135], v4 offset:1056
    ds_read_b128 v[136:139], v4 offset:1088
    ds_read_b128 v[140:143], v4 offset:1120
    v_mfma_f32_32x32x16_bf16 v[24:39], a[64:67], v[72:75], 0
    ds_read_b128 v[144:147], v4 offset:1152
    ds_read_b128 v[148:151], v4 offset:1184
    ds_read_b128 v[152:155], v4 offset:1216
    ds_read_b128 v[156:159], v4 offset:1248
    s_waitcnt lgkmcnt(11)
    v_mfma_f32_32x32x16_bf16 v[8:23], a[4:7], v[76:79], v[8:23]
    ds_read_b128 v[92:95], v3 offset:5120
    s_waitcnt lgkmcnt(1)
    v_fma_f32 v160, v96, v128, 1.0
    v_fma_f32 v161, v97, v129, 1.0
    v_fma_f32 v162, v98, v130, 1.0
    v_mfma_f32_32x32x16_bf16 v[24:39], a[68:71], v[76:79], v[24:39]
    v_fma_f32 v163, v99, v131, 1.0
    v_fma_f32 v164, v100, v132, 1.0
    v_fma_f32 v165, v101, v133, 1.0
    v_fma_f32 v166, v102, v134, 1.0
    v_mfma_f32_32x32x16_bf16 v[8:23], a[8:11], v[80:83], v[8:23]
    ds_read_b128 v[72:75], v3 offset:6144
    v_fma_f32 v167, v103, v135, 1.0
    v_rcp_f32 v160, v160
    v_rcp_f32 v161, v161
    v_rcp_f32 v162, v162
    v_mfma_f32_32x32x16_bf16 v[24:39], a[72:75], v[80:83], v[24:39]
    v_rcp_f32 v163, v163
    v_rcp_f32 v164, v164
    v_rcp_f32 v165, v165
    v_rcp_f32 v166, v166
    v_mfma_f32_32x32x16_bf16 v[8:23], a[12:15], v[84:87], v[8:23]
    ds_read_b128 v[76:79], v3 offset:7168
    v_rcp_f32 v167, v167
    v_fma_f32 v160, v160, -2.0, 1.0
    v_fma_f32 v161, v161, -2.0, 1.0
    v_fma_f32 v162, v162, -2.0, 1.0
    v_mfma_f32_32x32x16_bf16 v[24:39], a[76:79], v[84:87], v[24:39]
    v_fma_f32 v163, v163, -2.0, 1.0
    v_fma_f32 v164, v164, -2.0, 1.0
    v_fma_f32 v165, v165, -2.0, 1.0
    v_fma_f32 v166, v166, -2.0, 1.0
    v_mfma_f32_32x32x16_bf16 v[8:23], a[16:19], v[88:91], v[8:23]
    ds_read_b128 v[80:83], v3 offset:8192
    v_fma_f32 v167, v167, -2.0, 1.0
    v_cvt_pk_bf16_f32 v192, v160, v161
    v_cvt_pk_bf16_f32 v193, v162, v163
    v_cvt_pk_bf16_f32 v194, v164, v165
    v_mfma_f32_32x32x16_bf16 v[24:39], a[80:83], v[88:91], v[24:39]
    v_cvt_pk_bf16_f32 v195, v166, v167
    ds_write_b128 v2, v[192:195] offset:16384
    v_fma_f32 v168, v104, v136, 1.0
    v_fma_f32 v169, v105, v137, 1.0
    s_waitcnt lgkmcnt(4)
    v_mfma_f32_32x32x16_bf16 v[8:23], a[20:23], v[92:95], v[8:23]
    ds_read_b128 v[84:87], v3 offset:9216
    v_fma_f32 v170, v106, v138, 1.0
    v_fma_f32 v171, v107, v139, 1.0
    v_fma_f32 v172, v108, v140, 1.0
    v_fma_f32 v173, v109, v141, 1.0
    v_mfma_f32_32x32x16_bf16 v[24:39], a[84:87], v[92:95], v[24:39]
    v_fma_f32 v174, v110, v142, 1.0
    v_fma_f32 v175, v111, v143, 1.0
    v_rcp_f32 v168, v168
    s_waitcnt lgkmcnt(4)
    v_mfma_f32_32x32x16_bf16 v[8:23], a[24:27], v[72:75], v[8:23]
    ds_read_b128 v[88:91], v3 offset:10240
    v_rcp_f32 v169, v169
    v_rcp_f32 v170, v170
    v_rcp_f32 v171, v171
    v_rcp_f32 v172, v172
    v_mfma_f32_32x32x16_bf16 v[24:39], a[88:91], v[72:75], v[24:39]
    v_rcp_f32 v173, v173
    v_rcp_f32 v174, v174
    v_rcp_f32 v175, v175
    v_fma_f32 v168, v168, -2.0, 1.0
    s_waitcnt lgkmcnt(4)
    v_mfma_f32_32x32x16_bf16 v[8:23], a[28:31], v[76:79], v[8:23]
    ds_read_b128 v[92:95], v3 offset:11264
    v_fma_f32 v169, v169, -2.0, 1.0
    v_fma_f32 v170, v170, -2.0, 1.0
    v_fma_f32 v171, v171, -2.0, 1.0
    v_fma_f32 v172, v172, -2.0, 1.0
    v_mfma_f32_32x32x16_bf16 v[24:39], a[92:95], v[76:79], v[24:39]
    v_fma_f32 v173, v173, -2.0, 1.0
    v_fma_f32 v174, v174, -2.0, 1.0
    v_fma_f32 v175, v175, -2.0, 1.0
    v_cvt_pk_bf16_f32 v196, v168, v169
    s_waitcnt lgkmcnt(4)
    v_mfma_f32_32x32x16_bf16 v[8:23], a[32:35], v[80:83], v[8:23]
    ds_read_b128 v[72:75], v3 offset:12288
    v_cvt_pk_bf16_f32 v197, v170, v171
    v_cvt_pk_bf16_f32 v198, v172, v173
    v_cvt_pk_bf16_f32 v199, v174, v175
    ds_write_b128 v2, v[196:199] offset:17408
    v_mfma_f32_32x32x16_bf16 v[24:39], a[96:99], v[80:83], v[24:39]
    v_fma_f32 v176, v112, v144, 1.0
    v_fma_f32 v177, v113, v145, 1.0
    v_fma_f32 v178, v114, v146, 1.0
    v_fma_f32 v179, v115, v147, 1.0
    s_waitcnt lgkmcnt(4)
    v_mfma_f32_32x32x16_bf16 v[8:23], a[36:39], v[84:87], v[8:23]
    ds_read_b128 v[76:79], v3 offset:13312
    v_fma_f32 v180, v116, v148, 1.0
    v_fma_f32 v181, v117, v149, 1.0
    v_fma_f32 v182, v118, v150, 1.0
    v_fma_f32 v183, v119, v151, 1.0
    v_mfma_f32_32x32x16_bf16 v[24:39], a[100:103], v[84:87], v[24:39]
    v_rcp_f32 v176, v176
    v_rcp_f32 v177, v177
    v_rcp_f32 v178, v178
    v_rcp_f32 v179, v179
    s_waitcnt lgkmcnt(4)
    v_mfma_f32_32x32x16_bf16 v[8:23], a[40:43], v[88:91], v[8:23]
    ds_read_b128 v[80:83], v3 offset:14336
    v_rcp_f32 v180, v180
    v_rcp_f32 v181, v181
    v_rcp_f32 v182, v182
    v_rcp_f32 v183, v183
    v_mfma_f32_32x32x16_bf16 v[24:39], a[104:107], v[88:91], v[24:39]
    v_fma_f32 v176, v176, -2.0, 1.0
    v_fma_f32 v177, v177, -2.0, 1.0
    v_fma_f32 v178, v178, -2.0, 1.0
    s_waitcnt lgkmcnt(4)
    v_mfma_f32_32x32x16_bf16 v[8:23], a[44:47], v[92:95], v[8:23]
    ds_read_b128 v[84:87], v3 offset:15360
    v_fma_f32 v179, v179, -2.0, 1.0
    v_fma_f32 v180, v180, -2.0, 1.0
    v_fma_f32 v181, v181, -2.0, 1.0
    v_fma_f32 v182, v182, -2.0, 1.0
    v_mfma_f32_32x32x16_bf16 v[24:39], a[108:111], v[92:95], v[24:39]
    v_fma_f32 v183, v183, -2.0, 1.0
    v_cvt_pk_bf16_f32 v200, v176, v177
    v_cvt_pk_bf16_f32 v201, v178, v179
    v_cvt_pk_bf16_f32 v202, v180, v181
    s_waitcnt lgkmcnt(4)
    v_mfma_f32_32x32x16_bf16 v[8:23], a[48:51], v[72:75], v[8:23]
    v_cvt_pk_bf16_f32 v203, v182, v183
    ds_write_b128 v2, v[200:203] offset:18432
    v_fma_f32 v184, v120, v152, 1.0
    v_fma_f32 v185, v121, v153, 1.0
    v_mfma_f32_32x32x16_bf16 v[24:39], a[112:115], v[72:75], v[24:39]
    v_fma_f32 v186, v122, v154, 1.0
    v_fma_f32 v187, v123, v155, 1.0
    v_fma_f32 v188, v124, v156, 1.0
    v_fma_f32 v189, v125, v157, 1.0
    s_waitcnt lgkmcnt(3)
    v_mfma_f32_32x32x16_bf16 v[8:23], a[52:55], v[76:79], v[8:23]
    v_fma_f32 v190, v126, v158, 1.0
    v_fma_f32 v191, v127, v159, 1.0
    v_rcp_f32 v184, v184
    v_rcp_f32 v185, v185
    v_mfma_f32_32x32x16_bf16 v[24:39], a[116:119], v[76:79], v[24:39]
    v_rcp_f32 v186, v186
    v_rcp_f32 v187, v187
    v_rcp_f32 v188, v188
    v_rcp_f32 v189, v189
    s_waitcnt lgkmcnt(2)
    v_mfma_f32_32x32x16_bf16 v[8:23], a[56:59], v[80:83], v[8:23]
    v_rcp_f32 v190, v190
    v_rcp_f32 v191, v191
    v_fma_f32 v184, v184, -2.0, 1.0
    v_fma_f32 v185, v185, -2.0, 1.0
    v_mfma_f32_32x32x16_bf16 v[24:39], a[120:123], v[80:83], v[24:39]
    v_fma_f32 v186, v186, -2.0, 1.0
    v_fma_f32 v187, v187, -2.0, 1.0
    v_fma_f32 v188, v188, -2.0, 1.0
    v_fma_f32 v189, v189, -2.0, 1.0
    s_waitcnt lgkmcnt(1)
    v_mfma_f32_32x32x16_bf16 v[8:23], a[60:63], v[84:87], v[8:23]
    v_fma_f32 v190, v190, -2.0, 1.0
    v_fma_f32 v191, v191, -2.0, 1.0
    v_cvt_pk_bf16_f32 v204, v184, v185
    v_cvt_pk_bf16_f32 v205, v186, v187
    v_mfma_f32_32x32x16_bf16 v[24:39], a[124:127], v[84:87], v[24:39]
    v_cvt_pk_bf16_f32 v206, v188, v189
    v_cvt_pk_bf16_f32 v207, v190, v191
    ds_write_b128 v2, v[204:207] offset:19456
    s_waitcnt lgkmcnt(0)
    s_barrier
    ds_read_b128 v[72:75], v3 offset:16384
    ds_read_b128 v[76:79], v3 offset:17408
    ds_read_b128 v[80:83], v3 offset:18432
    ds_read_b128 v[84:87], v3 offset:19456
    s_waitcnt lgkmcnt(3)
    v_mfma_f32_32x32x16_bf16 v[40:55], a[0:3], v[72:75], 0
    ds_read_b128 v[88:91], v3 offset:20480
    ds_read_b128 v[128:131], v4 offset:2048
    ds_read_b128 v[132:135], v4 offset:2080
    ds_read_b128 v[136:139], v4 offset:2112
    ds_read_b128 v[140:143], v4 offset:2144
    v_mfma_f32_32x32x16_bf16 v[56:71], a[64:67], v[72:75], 0
    ds_read_b128 v[144:147], v4 offset:2176
    ds_read_b128 v[148:151], v4 offset:2208
    ds_read_b128 v[152:155], v4 offset:2240
    ds_read_b128 v[156:159], v4 offset:2272
    s_waitcnt lgkmcnt(11)
    v_mfma_f32_32x32x16_bf16 v[40:55], a[4:7], v[76:79], v[40:55]
    ds_read_b128 v[92:95], v3 offset:21504
    v_cvt_pk_bf16_f32 v208, v8, v9
    v_cvt_pk_bf16_f32 v209, v10, v11
    v_cvt_pk_bf16_f32 v210, v12, v13
    v_cvt_pk_bf16_f32 v211, v14, v15
    v_cvt_pk_bf16_f32 v212, v16, v17
    v_mfma_f32_32x32x16_bf16 v[56:71], a[68:71], v[76:79], v[56:71]
    v_cvt_pk_bf16_f32 v213, v18, v19
    v_cvt_pk_bf16_f32 v214, v20, v21
    v_cvt_pk_bf16_f32 v215, v22, v23
    s_nop 1
    v_permlane16_swap_b32 v208, v212
    s_waitcnt lgkmcnt(11)
    v_mfma_f32_32x32x16_bf16 v[40:55], a[8:11], v[80:83], v[40:55]
    ds_read_b128 v[72:75], v3 offset:22528
    v_permlane16_swap_b32 v209, v213
    v_permlane16_swap_b32 v210, v214
    v_permlane16_swap_b32 v211, v215
    buffer_store_dwordx4 v[208:211], v6, s[16:19], 0 offen offset:0
    buffer_store_dwordx4 v[212:215], v7, s[16:19], 0 offen offset:0
    v_mfma_f32_32x32x16_bf16 v[56:71], a[72:75], v[80:83], v[56:71]
    v_cvt_pk_bf16_f32 v216, v24, v25
    v_cvt_pk_bf16_f32 v217, v26, v27
    v_cvt_pk_bf16_f32 v218, v28, v29
    v_cvt_pk_bf16_f32 v219, v30, v31
    v_cvt_pk_bf16_f32 v220, v32, v33
    s_waitcnt lgkmcnt(11)
    v_mfma_f32_32x32x16_bf16 v[40:55], a[12:15], v[84:87], v[40:55]
    ds_read_b128 v[76:79], v3 offset:23552
    v_cvt_pk_bf16_f32 v221, v34, v35
    v_cvt_pk_bf16_f32 v222, v36, v37
    v_cvt_pk_bf16_f32 v223, v38, v39
    s_nop 1
    v_permlane16_swap_b32 v216, v220
    v_mfma_f32_32x32x16_bf16 v[56:71], a[76:79], v[84:87], v[56:71]
    v_permlane16_swap_b32 v217, v221
    v_permlane16_swap_b32 v218, v222
    v_permlane16_swap_b32 v219, v223
    buffer_store_dwordx4 v[216:219], v6, s[16:19], 0 offen offset:64
    buffer_store_dwordx4 v[220:223], v7, s[16:19], 0 offen offset:64
    s_waitcnt lgkmcnt(11)
    v_mfma_f32_32x32x16_bf16 v[40:55], a[16:19], v[88:91], v[40:55]
    ds_read_b128 v[80:83], v3 offset:24576
    s_waitcnt lgkmcnt(4)
    v_fma_f32 v160, v96, v128, 1.0
    v_fma_f32 v161, v97, v129, 1.0
    v_fma_f32 v162, v98, v130, 1.0
    v_fma_f32 v163, v99, v131, 1.0
    v_mfma_f32_32x32x16_bf16 v[56:71], a[80:83], v[88:91], v[56:71]
    v_fma_f32 v164, v100, v132, 1.0
    v_fma_f32 v165, v101, v133, 1.0
    v_fma_f32 v166, v102, v134, 1.0
    v_fma_f32 v167, v103, v135, 1.0
    v_rcp_f32 v160, v160
    s_waitcnt lgkmcnt(3)
    v_mfma_f32_32x32x16_bf16 v[40:55], a[20:23], v[92:95], v[40:55]
    ds_read_b128 v[84:87], v3 offset:25600
    v_rcp_f32 v161, v161
    v_rcp_f32 v162, v162
    v_rcp_f32 v163, v163
    v_rcp_f32 v164, v164
    v_rcp_f32 v165, v165
    v_mfma_f32_32x32x16_bf16 v[56:71], a[84:87], v[92:95], v[56:71]
    v_rcp_f32 v166, v166
    v_rcp_f32 v167, v167
    v_fma_f32 v160, v160, -2.0, 1.0
    v_fma_f32 v161, v161, -2.0, 1.0
    s_waitcnt lgkmcnt(3)
    v_mfma_f32_32x32x16_bf16 v[40:55], a[24:27], v[72:75], v[40:55]
    ds_read_b128 v[88:91], v3 offset:26624
    v_fma_f32 v162, v162, -2.0, 1.0
    v_fma_f32 v163, v163, -2.0, 1.0
    v_fma_f32 v164, v164, -2.0, 1.0
    v_fma_f32 v165, v165, -2.0, 1.0
    v_fma_f32 v166, v166, -2.0, 1.0
    v_mfma_f32_32x32x16_bf16 v[56:71], a[88:91], v[72:75], v[56:71]
    v_fma_f32 v167, v167, -2.0, 1.0
    v_cvt_pk_bf16_f32 v192, v160, v161
    v_cvt_pk_bf16_f32 v193, v162, v163
    v_cvt_pk_bf16_f32 v194, v164, v165
    v_cvt_pk_bf16_f32 v195, v166, v167
    s_waitcnt lgkmcnt(3)
    v_mfma_f32_32x32x16_bf16 v[40:55], a[28:31], v[76:79], v[40:55]
    ds_read_b128 v[92:95], v3 offset:27648
    ds_write_b128 v2, v[192:195] offset:0
    v_fma_f32 v168, v104, v136, 1.0
    v_fma_f32 v169, v105, v137, 1.0
    v_fma_f32 v170, v106, v138, 1.0
    v_fma_f32 v171, v107, v139, 1.0
    v_mfma_f32_32x32x16_bf16 v[56:71], a[92:95], v[76:79], v[56:71]
    v_fma_f32 v172, v108, v140, 1.0
    v_fma_f32 v173, v109, v141, 1.0
    v_fma_f32 v174, v110, v142, 1.0
    v_fma_f32 v175, v111, v143, 1.0
    v_rcp_f32 v168, v168
    s_waitcnt lgkmcnt(4)
    v_mfma_f32_32x32x16_bf16 v[40:55], a[32:35], v[80:83], v[40:55]
    ds_read_b128 v[72:75], v3 offset:28672
    v_rcp_f32 v169, v169
    v_rcp_f32 v170, v170
    v_rcp_f32 v171, v171
    v_rcp_f32 v172, v172
    v_rcp_f32 v173, v173
    v_mfma_f32_32x32x16_bf16 v[56:71], a[96:99], v[80:83], v[56:71]
    v_rcp_f32 v174, v174
    v_rcp_f32 v175, v175
    v_fma_f32 v168, v168, -2.0, 1.0
    v_fma_f32 v169, v169, -2.0, 1.0
    v_fma_f32 v170, v170, -2.0, 1.0
    s_waitcnt lgkmcnt(4)
    v_mfma_f32_32x32x16_bf16 v[40:55], a[36:39], v[84:87], v[40:55]
    ds_read_b128 v[76:79], v3 offset:29696
    v_fma_f32 v171, v171, -2.0, 1.0
    v_fma_f32 v172, v172, -2.0, 1.0
    v_fma_f32 v173, v173, -2.0, 1.0
    v_fma_f32 v174, v174, -2.0, 1.0
    v_fma_f32 v175, v175, -2.0, 1.0
    v_mfma_f32_32x32x16_bf16 v[56:71], a[100:103], v[84:87], v[56:71]
    v_cvt_pk_bf16_f32 v196, v168, v169
    v_cvt_pk_bf16_f32 v197, v170, v171
    v_cvt_pk_bf16_f32 v198, v172, v173
    v_cvt_pk_bf16_f32 v199, v174, v175
    ds_write_b128 v2, v[196:199] offset:1024
    s_waitcnt lgkmcnt(5)
    v_mfma_f32_32x32x16_bf16 v[40:55], a[40:43], v[88:91], v[40:55]
    ds_read_b128 v[80:83], v3 offset:30720
    v_fma_f32 v176, v112, v144, 1.0
    v_fma_f32 v177, v113, v145, 1.0
    v_fma_f32 v178, v114, v146, 1.0
    v_fma_f32 v179, v115, v147, 1.0
    v_fma_f32 v180, v116, v148, 1.0
    v_mfma_f32_32x32x16_bf16 v[56:71], a[104:107], v[88:91], v[56:71]
    v_fma_f32 v181, v117, v149, 1.0
    v_fma_f32 v182, v118, v150, 1.0
    v_fma_f32 v183, v119, v151, 1.0
    v_rcp_f32 v176, v176
    s_waitcnt lgkmcnt(5)
    v_mfma_f32_32x32x16_bf16 v[40:55], a[44:47], v[92:95], v[40:55]
    ds_read_b128 v[84:87], v3 offset:31744
    v_rcp_f32 v177, v177
    v_rcp_f32 v178, v178
    v_rcp_f32 v179, v179
    v_rcp_f32 v180, v180
    v_rcp_f32 v181, v181
    v_mfma_f32_32x32x16_bf16 v[56:71], a[108:111], v[92:95], v[56:71]
    v_rcp_f32 v182, v182
    v_rcp_f32 v183, v183
    v_fma_f32 v176, v176, -2.0, 1.0
    v_fma_f32 v177, v177, -2.0, 1.0
    v_fma_f32 v178, v178, -2.0, 1.0
    s_waitcnt lgkmcnt(4)
    v_mfma_f32_32x32x16_bf16 v[40:55], a[48:51], v[72:75], v[40:55]
    v_fma_f32 v179, v179, -2.0, 1.0
    v_fma_f32 v180, v180, -2.0, 1.0
    v_fma_f32 v181, v181, -2.0, 1.0
    v_fma_f32 v182, v182, -2.0, 1.0
    v_fma_f32 v183, v183, -2.0, 1.0
    v_mfma_f32_32x32x16_bf16 v[56:71], a[112:115], v[72:75], v[56:71]
    v_cvt_pk_bf16_f32 v200, v176, v177
    v_cvt_pk_bf16_f32 v201, v178, v179
    v_cvt_pk_bf16_f32 v202, v180, v181
    v_cvt_pk_bf16_f32 v203, v182, v183
    ds_write_b128 v2, v[200:203] offset:2048
    s_waitcnt lgkmcnt(4)
    v_mfma_f32_32x32x16_bf16 v[40:55], a[52:55], v[76:79], v[40:55]
    v_fma_f32 v184, v120, v152, 1.0
    v_fma_f32 v185, v121, v153, 1.0
    v_fma_f32 v186, v122, v154, 1.0
    v_fma_f32 v187, v123, v155, 1.0
    v_fma_f32 v188, v124, v156, 1.0
    v_mfma_f32_32x32x16_bf16 v[56:71], a[116:119], v[76:79], v[56:71]
    v_fma_f32 v189, v125, v157, 1.0
    v_fma_f32 v190, v126, v158, 1.0
    v_fma_f32 v191, v127, v159, 1.0
    v_rcp_f32 v184, v184
    v_rcp_f32 v185, v185
    s_waitcnt lgkmcnt(2)
    v_mfma_f32_32x32x16_bf16 v[40:55], a[56:59], v[80:83], v[40:55]
    v_rcp_f32 v186, v186
    v_rcp_f32 v187, v187
    v_rcp_f32 v188, v188
    v_rcp_f32 v189, v189
    v_rcp_f32 v190, v190
    v_mfma_f32_32x32x16_bf16 v[56:71], a[120:123], v[80:83], v[56:71]
    v_rcp_f32 v191, v191
    v_fma_f32 v184, v184, -2.0, 1.0
    v_fma_f32 v185, v185, -2.0, 1.0
    v_fma_f32 v186, v186, -2.0, 1.0
    v_fma_f32 v187, v187, -2.0, 1.0
    s_waitcnt lgkmcnt(1)
    v_mfma_f32_32x32x16_bf16 v[40:55], a[60:63], v[84:87], v[40:55]
    v_fma_f32 v188, v188, -2.0, 1.0
    v_fma_f32 v189, v189, -2.0, 1.0
    v_fma_f32 v190, v190, -2.0, 1.0
    v_fma_f32 v191, v191, -2.0, 1.0
    v_cvt_pk_bf16_f32 v204, v184, v185
    v_mfma_f32_32x32x16_bf16 v[56:71], a[124:127], v[84:87], v[56:71]
    v_cvt_pk_bf16_f32 v205, v186, v187
    v_cvt_pk_bf16_f32 v206, v188, v189
    v_cvt_pk_bf16_f32 v207, v190, v191
    ds_write_b128 v2, v[204:207] offset:3072
    s_waitcnt lgkmcnt(0)
    s_barrier
    ds_read_b128 v[72:75], v3 offset:0
    ds_read_b128 v[76:79], v3 offset:1024
    ds_read_b128 v[80:83], v3 offset:2048
    ds_read_b128 v[84:87], v3 offset:3072
    s_waitcnt lgkmcnt(3)
    v_mfma_f32_32x32x16_bf16 v[8:23], a[0:3], v[72:75], 0
    ds_read_b128 v[88:91], v3 offset:4096
    ds_read_b128 v[128:131], v4 offset:3072
    ds_read_b128 v[132:135], v4 offset:3104
    ds_read_b128 v[136:139], v4 offset:3136
    ds_read_b128 v[140:143], v4 offset:3168
    v_mfma_f32_32x32x16_bf16 v[24:39], a[64:67], v[72:75], 0
    ds_read_b128 v[144:147], v4 offset:3200
    ds_read_b128 v[148:151], v4 offset:3232
    ds_read_b128 v[152:155], v4 offset:3264
    ds_read_b128 v[156:159], v4 offset:3296
    s_waitcnt lgkmcnt(11)
    v_mfma_f32_32x32x16_bf16 v[8:23], a[4:7], v[76:79], v[8:23]
    ds_read_b128 v[92:95], v3 offset:5120
    v_cvt_pk_bf16_f32 v208, v40, v41
    v_cvt_pk_bf16_f32 v209, v42, v43
    v_cvt_pk_bf16_f32 v210, v44, v45
    v_cvt_pk_bf16_f32 v211, v46, v47
    v_cvt_pk_bf16_f32 v212, v48, v49
    v_mfma_f32_32x32x16_bf16 v[24:39], a[68:71], v[76:79], v[24:39]
    v_cvt_pk_bf16_f32 v213, v50, v51
    v_cvt_pk_bf16_f32 v214, v52, v53
    v_cvt_pk_bf16_f32 v215, v54, v55
    s_nop 1
    v_permlane16_swap_b32 v208, v212
    s_waitcnt lgkmcnt(11)
    v_mfma_f32_32x32x16_bf16 v[8:23], a[8:11], v[80:83], v[8:23]
    ds_read_b128 v[72:75], v3 offset:6144
    v_permlane16_swap_b32 v209, v213
    v_permlane16_swap_b32 v210, v214
    v_permlane16_swap_b32 v211, v215
    buffer_store_dwordx4 v[208:211], v6, s[16:19], 0 offen offset:512
    buffer_store_dwordx4 v[212:215], v7, s[16:19], 0 offen offset:512
    v_mfma_f32_32x32x16_bf16 v[24:39], a[72:75], v[80:83], v[24:39]
    v_cvt_pk_bf16_f32 v216, v56, v57
    v_cvt_pk_bf16_f32 v217, v58, v59
    v_cvt_pk_bf16_f32 v218, v60, v61
    v_cvt_pk_bf16_f32 v219, v62, v63
    v_cvt_pk_bf16_f32 v220, v64, v65
    s_waitcnt lgkmcnt(11)
    v_mfma_f32_32x32x16_bf16 v[8:23], a[12:15], v[84:87], v[8:23]
    ds_read_b128 v[76:79], v3 offset:7168
    v_cvt_pk_bf16_f32 v221, v66, v67
    v_cvt_pk_bf16_f32 v222, v68, v69
    v_cvt_pk_bf16_f32 v223, v70, v71
    s_nop 1
    v_permlane16_swap_b32 v216, v220
    v_mfma_f32_32x32x16_bf16 v[24:39], a[76:79], v[84:87], v[24:39]
    v_permlane16_swap_b32 v217, v221
    v_permlane16_swap_b32 v218, v222
    v_permlane16_swap_b32 v219, v223
    buffer_store_dwordx4 v[216:219], v6, s[16:19], 0 offen offset:576
    buffer_store_dwordx4 v[220:223], v7, s[16:19], 0 offen offset:576
    s_waitcnt lgkmcnt(11)
    v_mfma_f32_32x32x16_bf16 v[8:23], a[16:19], v[88:91], v[8:23]
    ds_read_b128 v[80:83], v3 offset:8192
    s_waitcnt lgkmcnt(4)
    v_fma_f32 v160, v96, v128, 1.0
    v_fma_f32 v161, v97, v129, 1.0
    v_fma_f32 v162, v98, v130, 1.0
    v_fma_f32 v163, v99, v131, 1.0
    v_mfma_f32_32x32x16_bf16 v[24:39], a[80:83], v[88:91], v[24:39]
    v_fma_f32 v164, v100, v132, 1.0
    v_fma_f32 v165, v101, v133, 1.0
    v_fma_f32 v166, v102, v134, 1.0
    v_fma_f32 v167, v103, v135, 1.0
    v_rcp_f32 v160, v160
    s_waitcnt lgkmcnt(3)
    v_mfma_f32_32x32x16_bf16 v[8:23], a[20:23], v[92:95], v[8:23]
    ds_read_b128 v[84:87], v3 offset:9216
    v_rcp_f32 v161, v161
    v_rcp_f32 v162, v162
    v_rcp_f32 v163, v163
    v_rcp_f32 v164, v164
    v_rcp_f32 v165, v165
    v_mfma_f32_32x32x16_bf16 v[24:39], a[84:87], v[92:95], v[24:39]
    v_rcp_f32 v166, v166
    v_rcp_f32 v167, v167
    v_fma_f32 v160, v160, -2.0, 1.0
    v_fma_f32 v161, v161, -2.0, 1.0
    s_waitcnt lgkmcnt(3)
    v_mfma_f32_32x32x16_bf16 v[8:23], a[24:27], v[72:75], v[8:23]
    ds_read_b128 v[88:91], v3 offset:10240
    v_fma_f32 v162, v162, -2.0, 1.0
    v_fma_f32 v163, v163, -2.0, 1.0
    v_fma_f32 v164, v164, -2.0, 1.0
    v_fma_f32 v165, v165, -2.0, 1.0
    v_fma_f32 v166, v166, -2.0, 1.0
    v_mfma_f32_32x32x16_bf16 v[24:39], a[88:91], v[72:75], v[24:39]
    v_fma_f32 v167, v167, -2.0, 1.0
    v_cvt_pk_bf16_f32 v192, v160, v161
    v_cvt_pk_bf16_f32 v193, v162, v163
    v_cvt_pk_bf16_f32 v194, v164, v165
    v_cvt_pk_bf16_f32 v195, v166, v167
    s_waitcnt lgkmcnt(3)
    v_mfma_f32_32x32x16_bf16 v[8:23], a[28:31], v[76:79], v[8:23]
    ds_read_b128 v[92:95], v3 offset:11264
    ds_write_b128 v2, v[192:195] offset:16384
    v_fma_f32 v168, v104, v136, 1.0
    v_fma_f32 v169, v105, v137, 1.0
    v_fma_f32 v170, v106, v138, 1.0
    v_fma_f32 v171, v107, v139, 1.0
    v_mfma_f32_32x32x16_bf16 v[24:39], a[92:95], v[76:79], v[24:39]
    v_fma_f32 v172, v108, v140, 1.0
    v_fma_f32 v173, v109, v141, 1.0
    v_fma_f32 v174, v110, v142, 1.0
    v_fma_f32 v175, v111, v143, 1.0
    v_rcp_f32 v168, v168
    s_waitcnt lgkmcnt(4)
    v_mfma_f32_32x32x16_bf16 v[8:23], a[32:35], v[80:83], v[8:23]
    ds_read_b128 v[72:75], v3 offset:12288
    v_rcp_f32 v169, v169
    v_rcp_f32 v170, v170
    v_rcp_f32 v171, v171
    v_rcp_f32 v172, v172
    v_rcp_f32 v173, v173
    v_mfma_f32_32x32x16_bf16 v[24:39], a[96:99], v[80:83], v[24:39]
    v_rcp_f32 v174, v174
    v_rcp_f32 v175, v175
    v_fma_f32 v168, v168, -2.0, 1.0
    v_fma_f32 v169, v169, -2.0, 1.0
    v_fma_f32 v170, v170, -2.0, 1.0
    s_waitcnt lgkmcnt(4)
    v_mfma_f32_32x32x16_bf16 v[8:23], a[36:39], v[84:87], v[8:23]
    ds_read_b128 v[76:79], v3 offset:13312
    v_fma_f32 v171, v171, -2.0, 1.0
    v_fma_f32 v172, v172, -2.0, 1.0
    v_fma_f32 v173, v173, -2.0, 1.0
    v_fma_f32 v174, v174, -2.0, 1.0
    v_fma_f32 v175, v175, -2.0, 1.0
    v_mfma_f32_32x32x16_bf16 v[24:39], a[100:103], v[84:87], v[24:39]
    v_cvt_pk_bf16_f32 v196, v168, v169
    v_cvt_pk_bf16_f32 v197, v170, v171
    v_cvt_pk_bf16_f32 v198, v172, v173
    v_cvt_pk_bf16_f32 v199, v174, v175
    ds_write_b128 v2, v[196:199] offset:17408
    s_waitcnt lgkmcnt(5)
    v_mfma_f32_32x32x16_bf16 v[8:23], a[40:43], v[88:91], v[8:23]
    ds_read_b128 v[80:83], v3 offset:14336
    v_fma_f32 v176, v112, v144, 1.0
    v_fma_f32 v177, v113, v145, 1.0
    v_fma_f32 v178, v114, v146, 1.0
    v_fma_f32 v179, v115, v147, 1.0
    v_fma_f32 v180, v116, v148, 1.0
    v_mfma_f32_32x32x16_bf16 v[24:39], a[104:107], v[88:91], v[24:39]
    v_fma_f32 v181, v117, v149, 1.0
    v_fma_f32 v182, v118, v150, 1.0
    v_fma_f32 v183, v119, v151, 1.0
    v_rcp_f32 v176, v176
    s_waitcnt lgkmcnt(5)
    v_mfma_f32_32x32x16_bf16 v[8:23], a[44:47], v[92:95], v[8:23]
    ds_read_b128 v[84:87], v3 offset:15360
    v_rcp_f32 v177, v177
    v_rcp_f32 v178, v178
    v_rcp_f32 v179, v179
    v_rcp_f32 v180, v180
    v_rcp_f32 v181, v181
    v_mfma_f32_32x32x16_bf16 v[24:39], a[108:111], v[92:95], v[24:39]
    v_rcp_f32 v182, v182
    v_rcp_f32 v183, v183
    v_fma_f32 v176, v176, -2.0, 1.0
    v_fma_f32 v177, v177, -2.0, 1.0
    v_fma_f32 v178, v178, -2.0, 1.0
    s_waitcnt lgkmcnt(4)
    v_mfma_f32_32x32x16_bf16 v[8:23], a[48:51], v[72:75], v[8:23]
    v_fma_f32 v179, v179, -2.0, 1.0
    v_fma_f32 v180, v180, -2.0, 1.0
    v_fma_f32 v181, v181, -2.0, 1.0
    v_fma_f32 v182, v182, -2.0, 1.0
    v_fma_f32 v183, v183, -2.0, 1.0
    v_mfma_f32_32x32x16_bf16 v[24:39], a[112:115], v[72:75], v[24:39]
    v_cvt_pk_bf16_f32 v200, v176, v177
    v_cvt_pk_bf16_f32 v201, v178, v179
    v_cvt_pk_bf16_f32 v202, v180, v181
    v_cvt_pk_bf16_f32 v203, v182, v183
    ds_write_b128 v2, v[200:203] offset:18432
    s_waitcnt lgkmcnt(4)
    v_mfma_f32_32x32x16_bf16 v[8:23], a[52:55], v[76:79], v[8:23]
    v_fma_f32 v184, v120, v152, 1.0
    v_fma_f32 v185, v121, v153, 1.0
    v_fma_f32 v186, v122, v154, 1.0
    v_fma_f32 v187, v123, v155, 1.0
    v_fma_f32 v188, v124, v156, 1.0
    v_mfma_f32_32x32x16_bf16 v[24:39], a[116:119], v[76:79], v[24:39]
    v_fma_f32 v189, v125, v157, 1.0
    v_fma_f32 v190, v126, v158, 1.0
    v_fma_f32 v191, v127, v159, 1.0
    v_rcp_f32 v184, v184
    v_rcp_f32 v185, v185
    s_waitcnt lgkmcnt(2)
    v_mfma_f32_32x32x16_bf16 v[8:23], a[56:59], v[80:83], v[8:23]
    v_rcp_f32 v186, v186
    v_rcp_f32 v187, v187
    v_rcp_f32 v188, v188
    v_rcp_f32 v189, v189
    v_rcp_f32 v190, v190
    v_mfma_f32_32x32x16_bf16 v[24:39], a[120:123], v[80:83], v[24:39]
    v_rcp_f32 v191, v191
    v_fma_f32 v184, v184, -2.0, 1.0
    v_fma_f32 v185, v185, -2.0, 1.0
    v_fma_f32 v186, v186, -2.0, 1.0
    v_fma_f32 v187, v187, -2.0, 1.0
    s_waitcnt lgkmcnt(1)
    v_mfma_f32_32x32x16_bf16 v[8:23], a[60:63], v[84:87], v[8:23]
    v_fma_f32 v188, v188, -2.0, 1.0
    v_fma_f32 v189, v189, -2.0, 1.0
    v_fma_f32 v190, v190, -2.0, 1.0
    v_fma_f32 v191, v191, -2.0, 1.0
    v_cvt_pk_bf16_f32 v204, v184, v185
    v_mfma_f32_32x32x16_bf16 v[24:39], a[124:127], v[84:87], v[24:39]
    v_cvt_pk_bf16_f32 v205, v186, v187
    v_cvt_pk_bf16_f32 v206, v188, v189
    v_cvt_pk_bf16_f32 v207, v190, v191
    ds_write_b128 v2, v[204:207] offset:19456
    s_waitcnt lgkmcnt(0)
    s_barrier
    ds_read_b128 v[72:75], v3 offset:16384
    ds_read_b128 v[76:79], v3 offset:17408
    ds_read_b128 v[80:83], v3 offset:18432
    ds_read_b128 v[84:87], v3 offset:19456
    s_waitcnt lgkmcnt(3)
    v_mfma_f32_32x32x16_bf16 v[40:55], a[0:3], v[72:75], 0
    ds_read_b128 v[88:91], v3 offset:20480
    ds_read_b128 v[128:131], v4 offset:4096
    ds_read_b128 v[132:135], v4 offset:4128
    ds_read_b128 v[136:139], v4 offset:4160
    ds_read_b128 v[140:143], v4 offset:4192
    v_mfma_f32_32x32x16_bf16 v[56:71], a[64:67], v[72:75], 0
    ds_read_b128 v[144:147], v4 offset:4224
    ds_read_b128 v[148:151], v4 offset:4256
    ds_read_b128 v[152:155], v4 offset:4288
    ds_read_b128 v[156:159], v4 offset:4320
    s_waitcnt lgkmcnt(11)
    v_mfma_f32_32x32x16_bf16 v[40:55], a[4:7], v[76:79], v[40:55]
    ds_read_b128 v[92:95], v3 offset:21504
    v_cvt_pk_bf16_f32 v208, v8, v9
    v_cvt_pk_bf16_f32 v209, v10, v11
    v_cvt_pk_bf16_f32 v210, v12, v13
    v_cvt_pk_bf16_f32 v211, v14, v15
    v_cvt_pk_bf16_f32 v212, v16, v17
    v_mfma_f32_32x32x16_bf16 v[56:71], a[68:71], v[76:79], v[56:71]
    v_cvt_pk_bf16_f32 v213, v18, v19
    v_cvt_pk_bf16_f32 v214, v20, v21
    v_cvt_pk_bf16_f32 v215, v22, v23
    s_nop 1
    v_permlane16_swap_b32 v208, v212
    s_waitcnt lgkmcnt(11)
    v_mfma_f32_32x32x16_bf16 v[40:55], a[8:11], v[80:83], v[40:55]
    ds_read_b128 v[72:75], v3 offset:22528
    v_permlane16_swap_b32 v209, v213
    v_permlane16_swap_b32 v210, v214
    v_permlane16_swap_b32 v211, v215
    buffer_store_dwordx4 v[208:211], v6, s[16:19], 0 offen offset:1024
    buffer_store_dwordx4 v[212:215], v7, s[16:19], 0 offen offset:1024
    v_mfma_f32_32x32x16_bf16 v[56:71], a[72:75], v[80:83], v[56:71]
    v_cvt_pk_bf16_f32 v216, v24, v25
    v_cvt_pk_bf16_f32 v217, v26, v27
    v_cvt_pk_bf16_f32 v218, v28, v29
    v_cvt_pk_bf16_f32 v219, v30, v31
    v_cvt_pk_bf16_f32 v220, v32, v33
    s_waitcnt lgkmcnt(11)
    v_mfma_f32_32x32x16_bf16 v[40:55], a[12:15], v[84:87], v[40:55]
    ds_read_b128 v[76:79], v3 offset:23552
    v_cvt_pk_bf16_f32 v221, v34, v35
    v_cvt_pk_bf16_f32 v222, v36, v37
    v_cvt_pk_bf16_f32 v223, v38, v39
    s_nop 1
    v_permlane16_swap_b32 v216, v220
    v_mfma_f32_32x32x16_bf16 v[56:71], a[76:79], v[84:87], v[56:71]
    v_permlane16_swap_b32 v217, v221
    v_permlane16_swap_b32 v218, v222
    v_permlane16_swap_b32 v219, v223
    buffer_store_dwordx4 v[216:219], v6, s[16:19], 0 offen offset:1088
    buffer_store_dwordx4 v[220:223], v7, s[16:19], 0 offen offset:1088
    s_waitcnt lgkmcnt(11)
    v_mfma_f32_32x32x16_bf16 v[40:55], a[16:19], v[88:91], v[40:55]
    ds_read_b128 v[80:83], v3 offset:24576
    s_waitcnt lgkmcnt(4)
    v_fma_f32 v160, v96, v128, 1.0
    v_fma_f32 v161, v97, v129, 1.0
    v_fma_f32 v162, v98, v130, 1.0
    v_fma_f32 v163, v99, v131, 1.0
    v_mfma_f32_32x32x16_bf16 v[56:71], a[80:83], v[88:91], v[56:71]
    v_fma_f32 v164, v100, v132, 1.0
    v_fma_f32 v165, v101, v133, 1.0
    v_fma_f32 v166, v102, v134, 1.0
    v_fma_f32 v167, v103, v135, 1.0
    v_rcp_f32 v160, v160
    s_waitcnt lgkmcnt(3)
    v_mfma_f32_32x32x16_bf16 v[40:55], a[20:23], v[92:95], v[40:55]
    ds_read_b128 v[84:87], v3 offset:25600
    v_rcp_f32 v161, v161
    v_rcp_f32 v162, v162
    v_rcp_f32 v163, v163
    v_rcp_f32 v164, v164
    v_rcp_f32 v165, v165
    v_mfma_f32_32x32x16_bf16 v[56:71], a[84:87], v[92:95], v[56:71]
    v_rcp_f32 v166, v166
    v_rcp_f32 v167, v167
    v_fma_f32 v160, v160, -2.0, 1.0
    v_fma_f32 v161, v161, -2.0, 1.0
    s_waitcnt lgkmcnt(3)
    v_mfma_f32_32x32x16_bf16 v[40:55], a[24:27], v[72:75], v[40:55]
    ds_read_b128 v[88:91], v3 offset:26624
    v_fma_f32 v162, v162, -2.0, 1.0
    v_fma_f32 v163, v163, -2.0, 1.0
    v_fma_f32 v164, v164, -2.0, 1.0
    v_fma_f32 v165, v165, -2.0, 1.0
    v_fma_f32 v166, v166, -2.0, 1.0
    v_mfma_f32_32x32x16_bf16 v[56:71], a[88:91], v[72:75], v[56:71]
    v_fma_f32 v167, v167, -2.0, 1.0
    v_cvt_pk_bf16_f32 v192, v160, v161
    v_cvt_pk_bf16_f32 v193, v162, v163
    v_cvt_pk_bf16_f32 v194, v164, v165
    v_cvt_pk_bf16_f32 v195, v166, v167
    s_waitcnt lgkmcnt(3)
    v_mfma_f32_32x32x16_bf16 v[40:55], a[28:31], v[76:79], v[40:55]
    ds_read_b128 v[92:95], v3 offset:27648
    ds_write_b128 v2, v[192:195] offset:0
    v_fma_f32 v168, v104, v136, 1.0
    v_fma_f32 v169, v105, v137, 1.0
    v_fma_f32 v170, v106, v138, 1.0
    v_fma_f32 v171, v107, v139, 1.0
    v_mfma_f32_32x32x16_bf16 v[56:71], a[92:95], v[76:79], v[56:71]
    v_fma_f32 v172, v108, v140, 1.0
    v_fma_f32 v173, v109, v141, 1.0
    v_fma_f32 v174, v110, v142, 1.0
    v_fma_f32 v175, v111, v143, 1.0
    v_rcp_f32 v168, v168
    s_waitcnt lgkmcnt(4)
    v_mfma_f32_32x32x16_bf16 v[40:55], a[32:35], v[80:83], v[40:55]
    ds_read_b128 v[72:75], v3 offset:28672
    v_rcp_f32 v169, v169
    v_rcp_f32 v170, v170
    v_rcp_f32 v171, v171
    v_rcp_f32 v172, v172
    v_rcp_f32 v173, v173
    v_mfma_f32_32x32x16_bf16 v[56:71], a[96:99], v[80:83], v[56:71]
    v_rcp_f32 v174, v174
    v_rcp_f32 v175, v175
    v_fma_f32 v168, v168, -2.0, 1.0
    v_fma_f32 v169, v169, -2.0, 1.0
    v_fma_f32 v170, v170, -2.0, 1.0
    s_waitcnt lgkmcnt(4)
    v_mfma_f32_32x32x16_bf16 v[40:55], a[36:39], v[84:87], v[40:55]
    ds_read_b128 v[76:79], v3 offset:29696
    v_fma_f32 v171, v171, -2.0, 1.0
    v_fma_f32 v172, v172, -2.0, 1.0
    v_fma_f32 v173, v173, -2.0, 1.0
    v_fma_f32 v174, v174, -2.0, 1.0
    v_fma_f32 v175, v175, -2.0, 1.0
    v_mfma_f32_32x32x16_bf16 v[56:71], a[100:103], v[84:87], v[56:71]
    v_cvt_pk_bf16_f32 v196, v168, v169
    v_cvt_pk_bf16_f32 v197, v170, v171
    v_cvt_pk_bf16_f32 v198, v172, v173
    v_cvt_pk_bf16_f32 v199, v174, v175
    ds_write_b128 v2, v[196:199] offset:1024
    s_waitcnt lgkmcnt(5)
    v_mfma_f32_32x32x16_bf16 v[40:55], a[40:43], v[88:91], v[40:55]
    ds_read_b128 v[80:83], v3 offset:30720
    v_fma_f32 v176, v112, v144, 1.0
    v_fma_f32 v177, v113, v145, 1.0
    v_fma_f32 v178, v114, v146, 1.0
    v_fma_f32 v179, v115, v147, 1.0
    v_fma_f32 v180, v116, v148, 1.0
    v_mfma_f32_32x32x16_bf16 v[56:71], a[104:107], v[88:91], v[56:71]
    v_fma_f32 v181, v117, v149, 1.0
    v_fma_f32 v182, v118, v150, 1.0
    v_fma_f32 v183, v119, v151, 1.0
    v_rcp_f32 v176, v176
    s_waitcnt lgkmcnt(5)
    v_mfma_f32_32x32x16_bf16 v[40:55], a[44:47], v[92:95], v[40:55]
    ds_read_b128 v[84:87], v3 offset:31744
    v_rcp_f32 v177, v177
    v_rcp_f32 v178, v178
    v_rcp_f32 v179, v179
    v_rcp_f32 v180, v180
    v_rcp_f32 v181, v181
    v_mfma_f32_32x32x16_bf16 v[56:71], a[108:111], v[92:95], v[56:71]
    v_rcp_f32 v182, v182
    v_rcp_f32 v183, v183
    v_fma_f32 v176, v176, -2.0, 1.0
    v_fma_f32 v177, v177, -2.0, 1.0
    v_fma_f32 v178, v178, -2.0, 1.0
    s_waitcnt lgkmcnt(4)
    v_mfma_f32_32x32x16_bf16 v[40:55], a[48:51], v[72:75], v[40:55]
    v_fma_f32 v179, v179, -2.0, 1.0
    v_fma_f32 v180, v180, -2.0, 1.0
    v_fma_f32 v181, v181, -2.0, 1.0
    v_fma_f32 v182, v182, -2.0, 1.0
    v_fma_f32 v183, v183, -2.0, 1.0
    v_mfma_f32_32x32x16_bf16 v[56:71], a[112:115], v[72:75], v[56:71]
    v_cvt_pk_bf16_f32 v200, v176, v177
    v_cvt_pk_bf16_f32 v201, v178, v179
    v_cvt_pk_bf16_f32 v202, v180, v181
    v_cvt_pk_bf16_f32 v203, v182, v183
    ds_write_b128 v2, v[200:203] offset:2048
    s_waitcnt lgkmcnt(4)
    v_mfma_f32_32x32x16_bf16 v[40:55], a[52:55], v[76:79], v[40:55]
    v_fma_f32 v184, v120, v152, 1.0
    v_fma_f32 v185, v121, v153, 1.0
    v_fma_f32 v186, v122, v154, 1.0
    v_fma_f32 v187, v123, v155, 1.0
    v_fma_f32 v188, v124, v156, 1.0
    v_mfma_f32_32x32x16_bf16 v[56:71], a[116:119], v[76:79], v[56:71]
    v_fma_f32 v189, v125, v157, 1.0
    v_fma_f32 v190, v126, v158, 1.0
    v_fma_f32 v191, v127, v159, 1.0
    v_rcp_f32 v184, v184
    v_rcp_f32 v185, v185
    s_waitcnt lgkmcnt(2)
    v_mfma_f32_32x32x16_bf16 v[40:55], a[56:59], v[80:83], v[40:55]
    v_rcp_f32 v186, v186
    v_rcp_f32 v187, v187
    v_rcp_f32 v188, v188
    v_rcp_f32 v189, v189
    v_rcp_f32 v190, v190
    v_mfma_f32_32x32x16_bf16 v[56:71], a[120:123], v[80:83], v[56:71]
    v_rcp_f32 v191, v191
    v_fma_f32 v184, v184, -2.0, 1.0
    v_fma_f32 v185, v185, -2.0, 1.0
    v_fma_f32 v186, v186, -2.0, 1.0
    v_fma_f32 v187, v187, -2.0, 1.0
    s_waitcnt lgkmcnt(1)
    v_mfma_f32_32x32x16_bf16 v[40:55], a[60:63], v[84:87], v[40:55]
    v_fma_f32 v188, v188, -2.0, 1.0
    v_fma_f32 v189, v189, -2.0, 1.0
    v_fma_f32 v190, v190, -2.0, 1.0
    v_fma_f32 v191, v191, -2.0, 1.0
    v_cvt_pk_bf16_f32 v204, v184, v185
    v_mfma_f32_32x32x16_bf16 v[56:71], a[124:127], v[84:87], v[56:71]
    v_cvt_pk_bf16_f32 v205, v186, v187
    v_cvt_pk_bf16_f32 v206, v188, v189
    v_cvt_pk_bf16_f32 v207, v190, v191
    ds_write_b128 v2, v[204:207] offset:3072
    s_waitcnt lgkmcnt(0)
    s_barrier
    ds_read_b128 v[72:75], v3 offset:0
    ds_read_b128 v[76:79], v3 offset:1024
    ds_read_b128 v[80:83], v3 offset:2048
    ds_read_b128 v[84:87], v3 offset:3072
    s_waitcnt lgkmcnt(3)
    v_mfma_f32_32x32x16_bf16 v[8:23], a[0:3], v[72:75], 0
    ds_read_b128 v[88:91], v3 offset:4096
    ds_read_b128 v[128:131], v4 offset:5120
    ds_read_b128 v[132:135], v4 offset:5152
    ds_read_b128 v[136:139], v4 offset:5184
    ds_read_b128 v[140:143], v4 offset:5216
    v_mfma_f32_32x32x16_bf16 v[24:39], a[64:67], v[72:75], 0
    ds_read_b128 v[144:147], v4 offset:5248
    ds_read_b128 v[148:151], v4 offset:5280
    ds_read_b128 v[152:155], v4 offset:5312
    ds_read_b128 v[156:159], v4 offset:5344
    s_waitcnt lgkmcnt(11)
    v_mfma_f32_32x32x16_bf16 v[8:23], a[4:7], v[76:79], v[8:23]
    ds_read_b128 v[92:95], v3 offset:5120
    v_cvt_pk_bf16_f32 v208, v40, v41
    v_cvt_pk_bf16_f32 v209, v42, v43
    v_cvt_pk_bf16_f32 v210, v44, v45
    v_cvt_pk_bf16_f32 v211, v46, v47
    v_cvt_pk_bf16_f32 v212, v48, v49
    v_mfma_f32_32x32x16_bf16 v[24:39], a[68:71], v[76:79], v[24:39]
    v_cvt_pk_bf16_f32 v213, v50, v51
    v_cvt_pk_bf16_f32 v214, v52, v53
    v_cvt_pk_bf16_f32 v215, v54, v55
    s_nop 1
    v_permlane16_swap_b32 v208, v212
    s_waitcnt lgkmcnt(11)
    v_mfma_f32_32x32x16_bf16 v[8:23], a[8:11], v[80:83], v[8:23]
    ds_read_b128 v[72:75], v3 offset:6144
    v_permlane16_swap_b32 v209, v213
    v_permlane16_swap_b32 v210, v214
    v_permlane16_swap_b32 v211, v215
    buffer_store_dwordx4 v[208:211], v6, s[16:19], 0 offen offset:1536
    buffer_store_dwordx4 v[212:215], v7, s[16:19], 0 offen offset:1536
    v_mfma_f32_32x32x16_bf16 v[24:39], a[72:75], v[80:83], v[24:39]
    v_cvt_pk_bf16_f32 v216, v56, v57
    v_cvt_pk_bf16_f32 v217, v58, v59
    v_cvt_pk_bf16_f32 v218, v60, v61
    v_cvt_pk_bf16_f32 v219, v62, v63
    v_cvt_pk_bf16_f32 v220, v64, v65
    s_waitcnt lgkmcnt(11)
    v_mfma_f32_32x32x16_bf16 v[8:23], a[12:15], v[84:87], v[8:23]
    ds_read_b128 v[76:79], v3 offset:7168
    v_cvt_pk_bf16_f32 v221, v66, v67
    v_cvt_pk_bf16_f32 v222, v68, v69
    v_cvt_pk_bf16_f32 v223, v70, v71
    s_nop 1
    v_permlane16_swap_b32 v216, v220
    v_mfma_f32_32x32x16_bf16 v[24:39], a[76:79], v[84:87], v[24:39]
    v_permlane16_swap_b32 v217, v221
    v_permlane16_swap_b32 v218, v222
    v_permlane16_swap_b32 v219, v223
    buffer_store_dwordx4 v[216:219], v6, s[16:19], 0 offen offset:1600
    buffer_store_dwordx4 v[220:223], v7, s[16:19], 0 offen offset:1600
    s_waitcnt lgkmcnt(11)
    v_mfma_f32_32x32x16_bf16 v[8:23], a[16:19], v[88:91], v[8:23]
    ds_read_b128 v[80:83], v3 offset:8192
    s_waitcnt lgkmcnt(4)
    v_fma_f32 v160, v96, v128, 1.0
    v_fma_f32 v161, v97, v129, 1.0
    v_fma_f32 v162, v98, v130, 1.0
    v_fma_f32 v163, v99, v131, 1.0
    v_mfma_f32_32x32x16_bf16 v[24:39], a[80:83], v[88:91], v[24:39]
    v_fma_f32 v164, v100, v132, 1.0
    v_fma_f32 v165, v101, v133, 1.0
    v_fma_f32 v166, v102, v134, 1.0
    v_fma_f32 v167, v103, v135, 1.0
    v_rcp_f32 v160, v160
    s_waitcnt lgkmcnt(3)
    v_mfma_f32_32x32x16_bf16 v[8:23], a[20:23], v[92:95], v[8:23]
    ds_read_b128 v[84:87], v3 offset:9216
    v_rcp_f32 v161, v161
    v_rcp_f32 v162, v162
    v_rcp_f32 v163, v163
    v_rcp_f32 v164, v164
    v_rcp_f32 v165, v165
    v_mfma_f32_32x32x16_bf16 v[24:39], a[84:87], v[92:95], v[24:39]
    v_rcp_f32 v166, v166
    v_rcp_f32 v167, v167
    v_fma_f32 v160, v160, -2.0, 1.0
    v_fma_f32 v161, v161, -2.0, 1.0
    s_waitcnt lgkmcnt(3)
    v_mfma_f32_32x32x16_bf16 v[8:23], a[24:27], v[72:75], v[8:23]
    ds_read_b128 v[88:91], v3 offset:10240
    v_fma_f32 v162, v162, -2.0, 1.0
    v_fma_f32 v163, v163, -2.0, 1.0
    v_fma_f32 v164, v164, -2.0, 1.0
    v_fma_f32 v165, v165, -2.0, 1.0
    v_fma_f32 v166, v166, -2.0, 1.0
    v_mfma_f32_32x32x16_bf16 v[24:39], a[88:91], v[72:75], v[24:39]
    v_fma_f32 v167, v167, -2.0, 1.0
    v_cvt_pk_bf16_f32 v192, v160, v161
    v_cvt_pk_bf16_f32 v193, v162, v163
    v_cvt_pk_bf16_f32 v194, v164, v165
    v_cvt_pk_bf16_f32 v195, v166, v167
    s_waitcnt lgkmcnt(3)
    v_mfma_f32_32x32x16_bf16 v[8:23], a[28:31], v[76:79], v[8:23]
    ds_read_b128 v[92:95], v3 offset:11264
    ds_write_b128 v2, v[192:195] offset:16384
    v_fma_f32 v168, v104, v136, 1.0
    v_fma_f32 v169, v105, v137, 1.0
    v_fma_f32 v170, v106, v138, 1.0
    v_fma_f32 v171, v107, v139, 1.0
    v_mfma_f32_32x32x16_bf16 v[24:39], a[92:95], v[76:79], v[24:39]
    v_fma_f32 v172, v108, v140, 1.0
    v_fma_f32 v173, v109, v141, 1.0
    v_fma_f32 v174, v110, v142, 1.0
    v_fma_f32 v175, v111, v143, 1.0
    v_rcp_f32 v168, v168
    s_waitcnt lgkmcnt(4)
    v_mfma_f32_32x32x16_bf16 v[8:23], a[32:35], v[80:83], v[8:23]
    ds_read_b128 v[72:75], v3 offset:12288
    v_rcp_f32 v169, v169
    v_rcp_f32 v170, v170
    v_rcp_f32 v171, v171
    v_rcp_f32 v172, v172
    v_rcp_f32 v173, v173
    v_mfma_f32_32x32x16_bf16 v[24:39], a[96:99], v[80:83], v[24:39]
    v_rcp_f32 v174, v174
    v_rcp_f32 v175, v175
    v_fma_f32 v168, v168, -2.0, 1.0
    v_fma_f32 v169, v169, -2.0, 1.0
    v_fma_f32 v170, v170, -2.0, 1.0
    s_waitcnt lgkmcnt(4)
    v_mfma_f32_32x32x16_bf16 v[8:23], a[36:39], v[84:87], v[8:23]
    ds_read_b128 v[76:79], v3 offset:13312
    v_fma_f32 v171, v171, -2.0, 1.0
    v_fma_f32 v172, v172, -2.0, 1.0
    v_fma_f32 v173, v173, -2.0, 1.0
    v_fma_f32 v174, v174, -2.0, 1.0
    v_fma_f32 v175, v175, -2.0, 1.0
    v_mfma_f32_32x32x16_bf16 v[24:39], a[100:103], v[84:87], v[24:39]
    v_cvt_pk_bf16_f32 v196, v168, v169
    v_cvt_pk_bf16_f32 v197, v170, v171
    v_cvt_pk_bf16_f32 v198, v172, v173
    v_cvt_pk_bf16_f32 v199, v174, v175
    ds_write_b128 v2, v[196:199] offset:17408
    s_waitcnt lgkmcnt(5)
    v_mfma_f32_32x32x16_bf16 v[8:23], a[40:43], v[88:91], v[8:23]
    ds_read_b128 v[80:83], v3 offset:14336
    v_fma_f32 v176, v112, v144, 1.0
    v_fma_f32 v177, v113, v145, 1.0
    v_fma_f32 v178, v114, v146, 1.0
    v_fma_f32 v179, v115, v147, 1.0
    v_fma_f32 v180, v116, v148, 1.0
    v_mfma_f32_32x32x16_bf16 v[24:39], a[104:107], v[88:91], v[24:39]
    v_fma_f32 v181, v117, v149, 1.0
    v_fma_f32 v182, v118, v150, 1.0
    v_fma_f32 v183, v119, v151, 1.0
    v_rcp_f32 v176, v176
    s_waitcnt lgkmcnt(5)
    v_mfma_f32_32x32x16_bf16 v[8:23], a[44:47], v[92:95], v[8:23]
    ds_read_b128 v[84:87], v3 offset:15360
    v_rcp_f32 v177, v177
    v_rcp_f32 v178, v178
    v_rcp_f32 v179, v179
    v_rcp_f32 v180, v180
    v_rcp_f32 v181, v181
    v_mfma_f32_32x32x16_bf16 v[24:39], a[108:111], v[92:95], v[24:39]
    v_rcp_f32 v182, v182
    v_rcp_f32 v183, v183
    v_fma_f32 v176, v176, -2.0, 1.0
    v_fma_f32 v177, v177, -2.0, 1.0
    v_fma_f32 v178, v178, -2.0, 1.0
    s_waitcnt lgkmcnt(4)
    v_mfma_f32_32x32x16_bf16 v[8:23], a[48:51], v[72:75], v[8:23]
    v_fma_f32 v179, v179, -2.0, 1.0
    v_fma_f32 v180, v180, -2.0, 1.0
    v_fma_f32 v181, v181, -2.0, 1.0
    v_fma_f32 v182, v182, -2.0, 1.0
    v_fma_f32 v183, v183, -2.0, 1.0
    v_mfma_f32_32x32x16_bf16 v[24:39], a[112:115], v[72:75], v[24:39]
    v_cvt_pk_bf16_f32 v200, v176, v177
    v_cvt_pk_bf16_f32 v201, v178, v179
    v_cvt_pk_bf16_f32 v202, v180, v181
    v_cvt_pk_bf16_f32 v203, v182, v183
    ds_write_b128 v2, v[200:203] offset:18432
    s_waitcnt lgkmcnt(4)
    v_mfma_f32_32x32x16_bf16 v[8:23], a[52:55], v[76:79], v[8:23]
    v_fma_f32 v184, v120, v152, 1.0
    v_fma_f32 v185, v121, v153, 1.0
    v_fma_f32 v186, v122, v154, 1.0
    v_fma_f32 v187, v123, v155, 1.0
    v_fma_f32 v188, v124, v156, 1.0
    v_mfma_f32_32x32x16_bf16 v[24:39], a[116:119], v[76:79], v[24:39]
    v_fma_f32 v189, v125, v157, 1.0
    v_fma_f32 v190, v126, v158, 1.0
    v_fma_f32 v191, v127, v159, 1.0
    v_rcp_f32 v184, v184
    v_rcp_f32 v185, v185
    s_waitcnt lgkmcnt(2)
    v_mfma_f32_32x32x16_bf16 v[8:23], a[56:59], v[80:83], v[8:23]
    v_rcp_f32 v186, v186
    v_rcp_f32 v187, v187
    v_rcp_f32 v188, v188
    v_rcp_f32 v189, v189
    v_rcp_f32 v190, v190
    v_mfma_f32_32x32x16_bf16 v[24:39], a[120:123], v[80:83], v[24:39]
    v_rcp_f32 v191, v191
    v_fma_f32 v184, v184, -2.0, 1.0
    v_fma_f32 v185, v185, -2.0, 1.0
    v_fma_f32 v186, v186, -2.0, 1.0
    v_fma_f32 v187, v187, -2.0, 1.0
    s_waitcnt lgkmcnt(1)
    v_mfma_f32_32x32x16_bf16 v[8:23], a[60:63], v[84:87], v[8:23]
    v_fma_f32 v188, v188, -2.0, 1.0
    v_fma_f32 v189, v189, -2.0, 1.0
    v_fma_f32 v190, v190, -2.0, 1.0
    v_fma_f32 v191, v191, -2.0, 1.0
    v_cvt_pk_bf16_f32 v204, v184, v185
    v_mfma_f32_32x32x16_bf16 v[24:39], a[124:127], v[84:87], v[24:39]
    v_cvt_pk_bf16_f32 v205, v186, v187
    v_cvt_pk_bf16_f32 v206, v188, v189
    v_cvt_pk_bf16_f32 v207, v190, v191
    ds_write_b128 v2, v[204:207] offset:19456
    s_waitcnt lgkmcnt(0)
    s_barrier
    ds_read_b128 v[72:75], v3 offset:16384
    ds_read_b128 v[76:79], v3 offset:17408
    ds_read_b128 v[80:83], v3 offset:18432
    ds_read_b128 v[84:87], v3 offset:19456
    s_waitcnt lgkmcnt(3)
    v_mfma_f32_32x32x16_bf16 v[40:55], a[0:3], v[72:75], 0
    ds_read_b128 v[88:91], v3 offset:20480
    ds_read_b128 v[128:131], v4 offset:6144
    ds_read_b128 v[132:135], v4 offset:6176
    ds_read_b128 v[136:139], v4 offset:6208
    ds_read_b128 v[140:143], v4 offset:6240
    v_mfma_f32_32x32x16_bf16 v[56:71], a[64:67], v[72:75], 0
    ds_read_b128 v[144:147], v4 offset:6272
    ds_read_b128 v[148:151], v4 offset:6304
    ds_read_b128 v[152:155], v4 offset:6336
    ds_read_b128 v[156:159], v4 offset:6368
    s_waitcnt lgkmcnt(11)
    v_mfma_f32_32x32x16_bf16 v[40:55], a[4:7], v[76:79], v[40:55]
    ds_read_b128 v[92:95], v3 offset:21504
    v_cvt_pk_bf16_f32 v208, v8, v9
    v_cvt_pk_bf16_f32 v209, v10, v11
    v_cvt_pk_bf16_f32 v210, v12, v13
    v_cvt_pk_bf16_f32 v211, v14, v15
    v_cvt_pk_bf16_f32 v212, v16, v17
    v_mfma_f32_32x32x16_bf16 v[56:71], a[68:71], v[76:79], v[56:71]
    v_cvt_pk_bf16_f32 v213, v18, v19
    v_cvt_pk_bf16_f32 v214, v20, v21
    v_cvt_pk_bf16_f32 v215, v22, v23
    s_nop 1
    v_permlane16_swap_b32 v208, v212
    s_waitcnt lgkmcnt(11)
    v_mfma_f32_32x32x16_bf16 v[40:55], a[8:11], v[80:83], v[40:55]
    ds_read_b128 v[72:75], v3 offset:22528
    v_permlane16_swap_b32 v209, v213
    v_permlane16_swap_b32 v210, v214
    v_permlane16_swap_b32 v211, v215
    buffer_store_dwordx4 v[208:211], v6, s[16:19], 0 offen offset:2048
    buffer_store_dwordx4 v[212:215], v7, s[16:19], 0 offen offset:2048
    v_mfma_f32_32x32x16_bf16 v[56:71], a[72:75], v[80:83], v[56:71]
    v_cvt_pk_bf16_f32 v216, v24, v25
    v_cvt_pk_bf16_f32 v217, v26, v27
    v_cvt_pk_bf16_f32 v218, v28, v29
    v_cvt_pk_bf16_f32 v219, v30, v31
    v_cvt_pk_bf16_f32 v220, v32, v33
    s_waitcnt lgkmcnt(11)
    v_mfma_f32_32x32x16_bf16 v[40:55], a[12:15], v[84:87], v[40:55]
    ds_read_b128 v[76:79], v3 offset:23552
    v_cvt_pk_bf16_f32 v221, v34, v35
    v_cvt_pk_bf16_f32 v222, v36, v37
    v_cvt_pk_bf16_f32 v223, v38, v39
    s_nop 1
    v_permlane16_swap_b32 v216, v220
    v_mfma_f32_32x32x16_bf16 v[56:71], a[76:79], v[84:87], v[56:71]
    v_permlane16_swap_b32 v217, v221
    v_permlane16_swap_b32 v218, v222
    v_permlane16_swap_b32 v219, v223
    buffer_store_dwordx4 v[216:219], v6, s[16:19], 0 offen offset:2112
    buffer_store_dwordx4 v[220:223], v7, s[16:19], 0 offen offset:2112
    s_waitcnt lgkmcnt(11)
    v_mfma_f32_32x32x16_bf16 v[40:55], a[16:19], v[88:91], v[40:55]
    ds_read_b128 v[80:83], v3 offset:24576
    s_waitcnt lgkmcnt(4)
    v_fma_f32 v160, v96, v128, 1.0
    v_fma_f32 v161, v97, v129, 1.0
    v_fma_f32 v162, v98, v130, 1.0
    v_fma_f32 v163, v99, v131, 1.0
    v_mfma_f32_32x32x16_bf16 v[56:71], a[80:83], v[88:91], v[56:71]
    v_fma_f32 v164, v100, v132, 1.0
    v_fma_f32 v165, v101, v133, 1.0
    v_fma_f32 v166, v102, v134, 1.0
    v_fma_f32 v167, v103, v135, 1.0
    v_rcp_f32 v160, v160
    s_waitcnt lgkmcnt(3)
    v_mfma_f32_32x32x16_bf16 v[40:55], a[20:23], v[92:95], v[40:55]
    ds_read_b128 v[84:87], v3 offset:25600
    v_rcp_f32 v161, v161
    v_rcp_f32 v162, v162
    v_rcp_f32 v163, v163
    v_rcp_f32 v164, v164
    v_rcp_f32 v165, v165
    v_mfma_f32_32x32x16_bf16 v[56:71], a[84:87], v[92:95], v[56:71]
    v_rcp_f32 v166, v166
    v_rcp_f32 v167, v167
    v_fma_f32 v160, v160, -2.0, 1.0
    v_fma_f32 v161, v161, -2.0, 1.0
    s_waitcnt lgkmcnt(3)
    v_mfma_f32_32x32x16_bf16 v[40:55], a[24:27], v[72:75], v[40:55]
    ds_read_b128 v[88:91], v3 offset:26624
    v_fma_f32 v162, v162, -2.0, 1.0
    v_fma_f32 v163, v163, -2.0, 1.0
    v_fma_f32 v164, v164, -2.0, 1.0
    v_fma_f32 v165, v165, -2.0, 1.0
    v_fma_f32 v166, v166, -2.0, 1.0
    v_mfma_f32_32x32x16_bf16 v[56:71], a[88:91], v[72:75], v[56:71]
    v_fma_f32 v167, v167, -2.0, 1.0
    v_cvt_pk_bf16_f32 v192, v160, v161
    v_cvt_pk_bf16_f32 v193, v162, v163
    v_cvt_pk_bf16_f32 v194, v164, v165
    v_cvt_pk_bf16_f32 v195, v166, v167
    s_waitcnt lgkmcnt(3)
    v_mfma_f32_32x32x16_bf16 v[40:55], a[28:31], v[76:79], v[40:55]
    ds_read_b128 v[92:95], v3 offset:27648
    ds_write_b128 v2, v[192:195] offset:0
    v_fma_f32 v168, v104, v136, 1.0
    v_fma_f32 v169, v105, v137, 1.0
    v_fma_f32 v170, v106, v138, 1.0
    v_fma_f32 v171, v107, v139, 1.0
    v_mfma_f32_32x32x16_bf16 v[56:71], a[92:95], v[76:79], v[56:71]
    v_fma_f32 v172, v108, v140, 1.0
    v_fma_f32 v173, v109, v141, 1.0
    v_fma_f32 v174, v110, v142, 1.0
    v_fma_f32 v175, v111, v143, 1.0
    v_rcp_f32 v168, v168
    s_waitcnt lgkmcnt(4)
    v_mfma_f32_32x32x16_bf16 v[40:55], a[32:35], v[80:83], v[40:55]
    ds_read_b128 v[72:75], v3 offset:28672
    v_rcp_f32 v169, v169
    v_rcp_f32 v170, v170
    v_rcp_f32 v171, v171
    v_rcp_f32 v172, v172
    v_rcp_f32 v173, v173
    v_mfma_f32_32x32x16_bf16 v[56:71], a[96:99], v[80:83], v[56:71]
    v_rcp_f32 v174, v174
    v_rcp_f32 v175, v175
    v_fma_f32 v168, v168, -2.0, 1.0
    v_fma_f32 v169, v169, -2.0, 1.0
    v_fma_f32 v170, v170, -2.0, 1.0
    s_waitcnt lgkmcnt(4)
    v_mfma_f32_32x32x16_bf16 v[40:55], a[36:39], v[84:87], v[40:55]
    ds_read_b128 v[76:79], v3 offset:29696
    v_fma_f32 v171, v171, -2.0, 1.0
    v_fma_f32 v172, v172, -2.0, 1.0
    v_fma_f32 v173, v173, -2.0, 1.0
    v_fma_f32 v174, v174, -2.0, 1.0
    v_fma_f32 v175, v175, -2.0, 1.0
    v_mfma_f32_32x32x16_bf16 v[56:71], a[100:103], v[84:87], v[56:71]
    v_cvt_pk_bf16_f32 v196, v168, v169
    v_cvt_pk_bf16_f32 v197, v170, v171
    v_cvt_pk_bf16_f32 v198, v172, v173
    v_cvt_pk_bf16_f32 v199, v174, v175
    ds_write_b128 v2, v[196:199] offset:1024
    s_waitcnt lgkmcnt(5)
    v_mfma_f32_32x32x16_bf16 v[40:55], a[40:43], v[88:91], v[40:55]
    ds_read_b128 v[80:83], v3 offset:30720
    v_fma_f32 v176, v112, v144, 1.0
    v_fma_f32 v177, v113, v145, 1.0
    v_fma_f32 v178, v114, v146, 1.0
    v_fma_f32 v179, v115, v147, 1.0
    v_fma_f32 v180, v116, v148, 1.0
    v_mfma_f32_32x32x16_bf16 v[56:71], a[104:107], v[88:91], v[56:71]
    v_fma_f32 v181, v117, v149, 1.0
    v_fma_f32 v182, v118, v150, 1.0
    v_fma_f32 v183, v119, v151, 1.0
    v_rcp_f32 v176, v176
    s_waitcnt lgkmcnt(5)
    v_mfma_f32_32x32x16_bf16 v[40:55], a[44:47], v[92:95], v[40:55]
    ds_read_b128 v[84:87], v3 offset:31744
    v_rcp_f32 v177, v177
    v_rcp_f32 v178, v178
    v_rcp_f32 v179, v179
    v_rcp_f32 v180, v180
    v_rcp_f32 v181, v181
    v_mfma_f32_32x32x16_bf16 v[56:71], a[108:111], v[92:95], v[56:71]
    v_rcp_f32 v182, v182
    v_rcp_f32 v183, v183
    v_fma_f32 v176, v176, -2.0, 1.0
    v_fma_f32 v177, v177, -2.0, 1.0
    v_fma_f32 v178, v178, -2.0, 1.0
    s_waitcnt lgkmcnt(4)
    v_mfma_f32_32x32x16_bf16 v[40:55], a[48:51], v[72:75], v[40:55]
    v_fma_f32 v179, v179, -2.0, 1.0
    v_fma_f32 v180, v180, -2.0, 1.0
    v_fma_f32 v181, v181, -2.0, 1.0
    v_fma_f32 v182, v182, -2.0, 1.0
    v_fma_f32 v183, v183, -2.0, 1.0
    v_mfma_f32_32x32x16_bf16 v[56:71], a[112:115], v[72:75], v[56:71]
    v_cvt_pk_bf16_f32 v200, v176, v177
    v_cvt_pk_bf16_f32 v201, v178, v179
    v_cvt_pk_bf16_f32 v202, v180, v181
    v_cvt_pk_bf16_f32 v203, v182, v183
    ds_write_b128 v2, v[200:203] offset:2048
    s_waitcnt lgkmcnt(4)
    v_mfma_f32_32x32x16_bf16 v[40:55], a[52:55], v[76:79], v[40:55]
    v_fma_f32 v184, v120, v152, 1.0
    v_fma_f32 v185, v121, v153, 1.0
    v_fma_f32 v186, v122, v154, 1.0
    v_fma_f32 v187, v123, v155, 1.0
    v_fma_f32 v188, v124, v156, 1.0
    v_mfma_f32_32x32x16_bf16 v[56:71], a[116:119], v[76:79], v[56:71]
    v_fma_f32 v189, v125, v157, 1.0
    v_fma_f32 v190, v126, v158, 1.0
    v_fma_f32 v191, v127, v159, 1.0
    v_rcp_f32 v184, v184
    v_rcp_f32 v185, v185
    s_waitcnt lgkmcnt(2)
    v_mfma_f32_32x32x16_bf16 v[40:55], a[56:59], v[80:83], v[40:55]
    v_rcp_f32 v186, v186
    v_rcp_f32 v187, v187
    v_rcp_f32 v188, v188
    v_rcp_f32 v189, v189
    v_rcp_f32 v190, v190
    v_mfma_f32_32x32x16_bf16 v[56:71], a[120:123], v[80:83], v[56:71]
    v_rcp_f32 v191, v191
    v_fma_f32 v184, v184, -2.0, 1.0
    v_fma_f32 v185, v185, -2.0, 1.0
    v_fma_f32 v186, v186, -2.0, 1.0
    v_fma_f32 v187, v187, -2.0, 1.0
    s_waitcnt lgkmcnt(1)
    v_mfma_f32_32x32x16_bf16 v[40:55], a[60:63], v[84:87], v[40:55]
    v_fma_f32 v188, v188, -2.0, 1.0
    v_fma_f32 v189, v189, -2.0, 1.0
    v_fma_f32 v190, v190, -2.0, 1.0
    v_fma_f32 v191, v191, -2.0, 1.0
    v_cvt_pk_bf16_f32 v204, v184, v185
    v_mfma_f32_32x32x16_bf16 v[56:71], a[124:127], v[84:87], v[56:71]
    v_cvt_pk_bf16_f32 v205, v186, v187
    v_cvt_pk_bf16_f32 v206, v188, v189
    v_cvt_pk_bf16_f32 v207, v190, v191
    ds_write_b128 v2, v[204:207] offset:3072
    s_waitcnt lgkmcnt(0)
    s_barrier
    ds_read_b128 v[72:75], v3 offset:0
    ds_read_b128 v[76:79], v3 offset:1024
    ds_read_b128 v[80:83], v3 offset:2048
    ds_read_b128 v[84:87], v3 offset:3072
    s_waitcnt lgkmcnt(3)
    v_mfma_f32_32x32x16_bf16 v[8:23], a[0:3], v[72:75], 0
    ds_read_b128 v[88:91], v3 offset:4096
    ds_read_b128 v[128:131], v4 offset:7168
    ds_read_b128 v[132:135], v4 offset:7200
    ds_read_b128 v[136:139], v4 offset:7232
    ds_read_b128 v[140:143], v4 offset:7264
    v_mfma_f32_32x32x16_bf16 v[24:39], a[64:67], v[72:75], 0
    ds_read_b128 v[144:147], v4 offset:7296
    ds_read_b128 v[148:151], v4 offset:7328
    ds_read_b128 v[152:155], v4 offset:7360
    ds_read_b128 v[156:159], v4 offset:7392
    s_waitcnt lgkmcnt(11)
    v_mfma_f32_32x32x16_bf16 v[8:23], a[4:7], v[76:79], v[8:23]
    ds_read_b128 v[92:95], v3 offset:5120
    v_cvt_pk_bf16_f32 v208, v40, v41
    v_cvt_pk_bf16_f32 v209, v42, v43
    v_cvt_pk_bf16_f32 v210, v44, v45
    v_cvt_pk_bf16_f32 v211, v46, v47
    v_cvt_pk_bf16_f32 v212, v48, v49
    v_mfma_f32_32x32x16_bf16 v[24:39], a[68:71], v[76:79], v[24:39]
    v_cvt_pk_bf16_f32 v213, v50, v51
    v_cvt_pk_bf16_f32 v214, v52, v53
    v_cvt_pk_bf16_f32 v215, v54, v55
    s_nop 1
    v_permlane16_swap_b32 v208, v212
    s_waitcnt lgkmcnt(11)
    v_mfma_f32_32x32x16_bf16 v[8:23], a[8:11], v[80:83], v[8:23]
    ds_read_b128 v[72:75], v3 offset:6144
    v_permlane16_swap_b32 v209, v213
    v_permlane16_swap_b32 v210, v214
    v_permlane16_swap_b32 v211, v215
    buffer_store_dwordx4 v[208:211], v6, s[16:19], 0 offen offset:2560
    buffer_store_dwordx4 v[212:215], v7, s[16:19], 0 offen offset:2560
    v_mfma_f32_32x32x16_bf16 v[24:39], a[72:75], v[80:83], v[24:39]
    v_cvt_pk_bf16_f32 v216, v56, v57
    v_cvt_pk_bf16_f32 v217, v58, v59
    v_cvt_pk_bf16_f32 v218, v60, v61
    v_cvt_pk_bf16_f32 v219, v62, v63
    v_cvt_pk_bf16_f32 v220, v64, v65
    s_waitcnt lgkmcnt(11)
    v_mfma_f32_32x32x16_bf16 v[8:23], a[12:15], v[84:87], v[8:23]
    ds_read_b128 v[76:79], v3 offset:7168
    v_cvt_pk_bf16_f32 v221, v66, v67
    v_cvt_pk_bf16_f32 v222, v68, v69
    v_cvt_pk_bf16_f32 v223, v70, v71
    s_nop 1
    v_permlane16_swap_b32 v216, v220
    v_mfma_f32_32x32x16_bf16 v[24:39], a[76:79], v[84:87], v[24:39]
    v_permlane16_swap_b32 v217, v221
    v_permlane16_swap_b32 v218, v222
    v_permlane16_swap_b32 v219, v223
    buffer_store_dwordx4 v[216:219], v6, s[16:19], 0 offen offset:2624
    buffer_store_dwordx4 v[220:223], v7, s[16:19], 0 offen offset:2624
    s_waitcnt lgkmcnt(11)
    v_mfma_f32_32x32x16_bf16 v[8:23], a[16:19], v[88:91], v[8:23]
    ds_read_b128 v[80:83], v3 offset:8192
    s_waitcnt lgkmcnt(4)
    v_fma_f32 v160, v96, v128, 1.0
    v_fma_f32 v161, v97, v129, 1.0
    v_fma_f32 v162, v98, v130, 1.0
    v_fma_f32 v163, v99, v131, 1.0
    v_mfma_f32_32x32x16_bf16 v[24:39], a[80:83], v[88:91], v[24:39]
    v_fma_f32 v164, v100, v132, 1.0
    v_fma_f32 v165, v101, v133, 1.0
    v_fma_f32 v166, v102, v134, 1.0
    v_fma_f32 v167, v103, v135, 1.0
    v_rcp_f32 v160, v160
    s_waitcnt lgkmcnt(3)
    v_mfma_f32_32x32x16_bf16 v[8:23], a[20:23], v[92:95], v[8:23]
    ds_read_b128 v[84:87], v3 offset:9216
    v_rcp_f32 v161, v161
    v_rcp_f32 v162, v162
    v_rcp_f32 v163, v163
    v_rcp_f32 v164, v164
    v_rcp_f32 v165, v165
    v_mfma_f32_32x32x16_bf16 v[24:39], a[84:87], v[92:95], v[24:39]
    v_rcp_f32 v166, v166
    v_rcp_f32 v167, v167
    v_fma_f32 v160, v160, -2.0, 1.0
    v_fma_f32 v161, v161, -2.0, 1.0
    s_waitcnt lgkmcnt(3)
    v_mfma_f32_32x32x16_bf16 v[8:23], a[24:27], v[72:75], v[8:23]
    ds_read_b128 v[88:91], v3 offset:10240
    v_fma_f32 v162, v162, -2.0, 1.0
    v_fma_f32 v163, v163, -2.0, 1.0
    v_fma_f32 v164, v164, -2.0, 1.0
    v_fma_f32 v165, v165, -2.0, 1.0
    v_fma_f32 v166, v166, -2.0, 1.0
    v_mfma_f32_32x32x16_bf16 v[24:39], a[88:91], v[72:75], v[24:39]
    v_fma_f32 v167, v167, -2.0, 1.0
    v_cvt_pk_bf16_f32 v192, v160, v161
    v_cvt_pk_bf16_f32 v193, v162, v163
    v_cvt_pk_bf16_f32 v194, v164, v165
    v_cvt_pk_bf16_f32 v195, v166, v167
    s_waitcnt lgkmcnt(3)
    v_mfma_f32_32x32x16_bf16 v[8:23], a[28:31], v[76:79], v[8:23]
    ds_read_b128 v[92:95], v3 offset:11264
    ds_write_b128 v2, v[192:195] offset:16384
    v_fma_f32 v168, v104, v136, 1.0
    v_fma_f32 v169, v105, v137, 1.0
    v_fma_f32 v170, v106, v138, 1.0
    v_fma_f32 v171, v107, v139, 1.0
    v_mfma_f32_32x32x16_bf16 v[24:39], a[92:95], v[76:79], v[24:39]
    v_fma_f32 v172, v108, v140, 1.0
    v_fma_f32 v173, v109, v141, 1.0
    v_fma_f32 v174, v110, v142, 1.0
    v_fma_f32 v175, v111, v143, 1.0
    v_rcp_f32 v168, v168
    s_waitcnt lgkmcnt(4)
    v_mfma_f32_32x32x16_bf16 v[8:23], a[32:35], v[80:83], v[8:23]
    ds_read_b128 v[72:75], v3 offset:12288
    v_rcp_f32 v169, v169
    v_rcp_f32 v170, v170
    v_rcp_f32 v171, v171
    v_rcp_f32 v172, v172
    v_rcp_f32 v173, v173
    v_mfma_f32_32x32x16_bf16 v[24:39], a[96:99], v[80:83], v[24:39]
    v_rcp_f32 v174, v174
    v_rcp_f32 v175, v175
    v_fma_f32 v168, v168, -2.0, 1.0
    v_fma_f32 v169, v169, -2.0, 1.0
    v_fma_f32 v170, v170, -2.0, 1.0
    s_waitcnt lgkmcnt(4)
    v_mfma_f32_32x32x16_bf16 v[8:23], a[36:39], v[84:87], v[8:23]
    ds_read_b128 v[76:79], v3 offset:13312
    v_fma_f32 v171, v171, -2.0, 1.0
    v_fma_f32 v172, v172, -2.0, 1.0
    v_fma_f32 v173, v173, -2.0, 1.0
    v_fma_f32 v174, v174, -2.0, 1.0
    v_fma_f32 v175, v175, -2.0, 1.0
    v_mfma_f32_32x32x16_bf16 v[24:39], a[100:103], v[84:87], v[24:39]
    v_cvt_pk_bf16_f32 v196, v168, v169
    v_cvt_pk_bf16_f32 v197, v170, v171
    v_cvt_pk_bf16_f32 v198, v172, v173
    v_cvt_pk_bf16_f32 v199, v174, v175
    ds_write_b128 v2, v[196:199] offset:17408
    s_waitcnt lgkmcnt(5)
    v_mfma_f32_32x32x16_bf16 v[8:23], a[40:43], v[88:91], v[8:23]
    ds_read_b128 v[80:83], v3 offset:14336
    v_fma_f32 v176, v112, v144, 1.0
    v_fma_f32 v177, v113, v145, 1.0
    v_fma_f32 v178, v114, v146, 1.0
    v_fma_f32 v179, v115, v147, 1.0
    v_fma_f32 v180, v116, v148, 1.0
    v_mfma_f32_32x32x16_bf16 v[24:39], a[104:107], v[88:91], v[24:39]
    v_fma_f32 v181, v117, v149, 1.0
    v_fma_f32 v182, v118, v150, 1.0
    v_fma_f32 v183, v119, v151, 1.0
    v_rcp_f32 v176, v176
    s_waitcnt lgkmcnt(5)
    v_mfma_f32_32x32x16_bf16 v[8:23], a[44:47], v[92:95], v[8:23]
    ds_read_b128 v[84:87], v3 offset:15360
    v_rcp_f32 v177, v177
    v_rcp_f32 v178, v178
    v_rcp_f32 v179, v179
    v_rcp_f32 v180, v180
    v_rcp_f32 v181, v181
    v_mfma_f32_32x32x16_bf16 v[24:39], a[108:111], v[92:95], v[24:39]
    v_rcp_f32 v182, v182
    v_rcp_f32 v183, v183
    v_fma_f32 v176, v176, -2.0, 1.0
    v_fma_f32 v177, v177, -2.0, 1.0
    v_fma_f32 v178, v178, -2.0, 1.0
    s_waitcnt lgkmcnt(4)
    v_mfma_f32_32x32x16_bf16 v[8:23], a[48:51], v[72:75], v[8:23]
    v_fma_f32 v179, v179, -2.0, 1.0
    v_fma_f32 v180, v180, -2.0, 1.0
    v_fma_f32 v181, v181, -2.0, 1.0
    v_fma_f32 v182, v182, -2.0, 1.0
    v_fma_f32 v183, v183, -2.0, 1.0
    v_mfma_f32_32x32x16_bf16 v[24:39], a[112:115], v[72:75], v[24:39]
    v_cvt_pk_bf16_f32 v200, v176, v177
    v_cvt_pk_bf16_f32 v201, v178, v179
    v_cvt_pk_bf16_f32 v202, v180, v181
    v_cvt_pk_bf16_f32 v203, v182, v183
    ds_write_b128 v2, v[200:203] offset:18432
    s_waitcnt lgkmcnt(4)
    v_mfma_f32_32x32x16_bf16 v[8:23], a[52:55], v[76:79], v[8:23]
    v_fma_f32 v184, v120, v152, 1.0
    v_fma_f32 v185, v121, v153, 1.0
    v_fma_f32 v186, v122, v154, 1.0
    v_fma_f32 v187, v123, v155, 1.0
    v_fma_f32 v188, v124, v156, 1.0
    v_mfma_f32_32x32x16_bf16 v[24:39], a[116:119], v[76:79], v[24:39]
    v_fma_f32 v189, v125, v157, 1.0
    v_fma_f32 v190, v126, v158, 1.0
    v_fma_f32 v191, v127, v159, 1.0
    v_rcp_f32 v184, v184
    v_rcp_f32 v185, v185
    s_waitcnt lgkmcnt(2)
    v_mfma_f32_32x32x16_bf16 v[8:23], a[56:59], v[80:83], v[8:23]
    v_rcp_f32 v186, v186
    v_rcp_f32 v187, v187
    v_rcp_f32 v188, v188
    v_rcp_f32 v189, v189
    v_rcp_f32 v190, v190
    v_mfma_f32_32x32x16_bf16 v[24:39], a[120:123], v[80:83], v[24:39]
    v_rcp_f32 v191, v191
    v_fma_f32 v184, v184, -2.0, 1.0
    v_fma_f32 v185, v185, -2.0, 1.0
    v_fma_f32 v186, v186, -2.0, 1.0
    v_fma_f32 v187, v187, -2.0, 1.0
    s_waitcnt lgkmcnt(1)
    v_mfma_f32_32x32x16_bf16 v[8:23], a[60:63], v[84:87], v[8:23]
    v_fma_f32 v188, v188, -2.0, 1.0
    v_fma_f32 v189, v189, -2.0, 1.0
    v_fma_f32 v190, v190, -2.0, 1.0
    v_fma_f32 v191, v191, -2.0, 1.0
    v_cvt_pk_bf16_f32 v204, v184, v185
    v_mfma_f32_32x32x16_bf16 v[24:39], a[124:127], v[84:87], v[24:39]
    v_cvt_pk_bf16_f32 v205, v186, v187
    v_cvt_pk_bf16_f32 v206, v188, v189
    v_cvt_pk_bf16_f32 v207, v190, v191
    ds_write_b128 v2, v[204:207] offset:19456
    s_waitcnt lgkmcnt(0)
    s_barrier
    ds_read_b128 v[72:75], v3 offset:16384
    ds_read_b128 v[76:79], v3 offset:17408
    ds_read_b128 v[80:83], v3 offset:18432
    ds_read_b128 v[84:87], v3 offset:19456
    s_waitcnt lgkmcnt(3)
    v_mfma_f32_32x32x16_bf16 v[40:55], a[0:3], v[72:75], 0
    ds_read_b128 v[88:91], v3 offset:20480
    v_mfma_f32_32x32x16_bf16 v[56:71], a[64:67], v[72:75], 0
    s_waitcnt lgkmcnt(3)
    v_mfma_f32_32x32x16_bf16 v[40:55], a[4:7], v[76:79], v[40:55]
    ds_read_b128 v[92:95], v3 offset:21504
    v_cvt_pk_bf16_f32 v208, v8, v9
    v_mfma_f32_32x32x16_bf16 v[56:71], a[68:71], v[76:79], v[56:71]
    v_cvt_pk_bf16_f32 v209, v10, v11
    s_waitcnt lgkmcnt(3)
    v_mfma_f32_32x32x16_bf16 v[40:55], a[8:11], v[80:83], v[40:55]
    ds_read_b128 v[72:75], v3 offset:22528
    v_cvt_pk_bf16_f32 v210, v12, v13
    v_mfma_f32_32x32x16_bf16 v[56:71], a[72:75], v[80:83], v[56:71]
    v_cvt_pk_bf16_f32 v211, v14, v15
    s_waitcnt lgkmcnt(3)
    v_mfma_f32_32x32x16_bf16 v[40:55], a[12:15], v[84:87], v[40:55]
    ds_read_b128 v[76:79], v3 offset:23552
    v_cvt_pk_bf16_f32 v212, v16, v17
    v_mfma_f32_32x32x16_bf16 v[56:71], a[76:79], v[84:87], v[56:71]
    v_cvt_pk_bf16_f32 v213, v18, v19
    s_waitcnt lgkmcnt(3)
    v_mfma_f32_32x32x16_bf16 v[40:55], a[16:19], v[88:91], v[40:55]
    ds_read_b128 v[80:83], v3 offset:24576
    v_cvt_pk_bf16_f32 v214, v20, v21
    v_mfma_f32_32x32x16_bf16 v[56:71], a[80:83], v[88:91], v[56:71]
    v_cvt_pk_bf16_f32 v215, v22, v23
    s_waitcnt lgkmcnt(3)
    v_mfma_f32_32x32x16_bf16 v[40:55], a[20:23], v[92:95], v[40:55]
    ds_read_b128 v[84:87], v3 offset:25600
    s_nop 1
    v_mfma_f32_32x32x16_bf16 v[56:71], a[84:87], v[92:95], v[56:71]
    v_permlane16_swap_b32 v208, v212
    s_waitcnt lgkmcnt(3)
    v_mfma_f32_32x32x16_bf16 v[40:55], a[24:27], v[72:75], v[40:55]
    ds_read_b128 v[88:91], v3 offset:26624
    v_permlane16_swap_b32 v209, v213
    v_mfma_f32_32x32x16_bf16 v[56:71], a[88:91], v[72:75], v[56:71]
    v_permlane16_swap_b32 v210, v214
    s_waitcnt lgkmcnt(3)
    v_mfma_f32_32x32x16_bf16 v[40:55], a[28:31], v[76:79], v[40:55]
    ds_read_b128 v[92:95], v3 offset:27648
    v_permlane16_swap_b32 v211, v215
    v_mfma_f32_32x32x16_bf16 v[56:71], a[92:95], v[76:79], v[56:71]
    buffer_store_dwordx4 v[208:211], v6, s[16:19], 0 offen offset:3072
    s_waitcnt lgkmcnt(3)
    v_mfma_f32_32x32x16_bf16 v[40:55], a[32:35], v[80:83], v[40:55]
    ds_read_b128 v[72:75], v3 offset:28672
    buffer_store_dwordx4 v[212:215], v7, s[16:19], 0 offen offset:3072
    v_mfma_f32_32x32x16_bf16 v[56:71], a[96:99], v[80:83], v[56:71]
    v_cvt_pk_bf16_f32 v216, v24, v25
    s_waitcnt lgkmcnt(3)
    v_mfma_f32_32x32x16_bf16 v[40:55], a[36:39], v[84:87], v[40:55]
    ds_read_b128 v[76:79], v3 offset:29696
    v_cvt_pk_bf16_f32 v217, v26, v27
    v_mfma_f32_32x32x16_bf16 v[56:71], a[100:103], v[84:87], v[56:71]
    v_cvt_pk_bf16_f32 v218, v28, v29
    s_waitcnt lgkmcnt(3)
    v_mfma_f32_32x32x16_bf16 v[40:55], a[40:43], v[88:91], v[40:55]
    ds_read_b128 v[80:83], v3 offset:30720
    v_cvt_pk_bf16_f32 v219, v30, v31
    v_mfma_f32_32x32x16_bf16 v[56:71], a[104:107], v[88:91], v[56:71]
    v_cvt_pk_bf16_f32 v220, v32, v33
    s_waitcnt lgkmcnt(3)
    v_mfma_f32_32x32x16_bf16 v[40:55], a[44:47], v[92:95], v[40:55]
    ds_read_b128 v[84:87], v3 offset:31744
    v_cvt_pk_bf16_f32 v221, v34, v35
    v_mfma_f32_32x32x16_bf16 v[56:71], a[108:111], v[92:95], v[56:71]
    v_cvt_pk_bf16_f32 v222, v36, v37
    s_waitcnt lgkmcnt(3)
    v_mfma_f32_32x32x16_bf16 v[40:55], a[48:51], v[72:75], v[40:55]
    v_cvt_pk_bf16_f32 v223, v38, v39
    v_mfma_f32_32x32x16_bf16 v[56:71], a[112:115], v[72:75], v[56:71]
    s_nop 1
    s_waitcnt lgkmcnt(2)
    v_mfma_f32_32x32x16_bf16 v[40:55], a[52:55], v[76:79], v[40:55]
    v_permlane16_swap_b32 v216, v220
    v_mfma_f32_32x32x16_bf16 v[56:71], a[116:119], v[76:79], v[56:71]
    v_permlane16_swap_b32 v217, v221
    s_waitcnt lgkmcnt(1)
    v_mfma_f32_32x32x16_bf16 v[40:55], a[56:59], v[80:83], v[40:55]
    v_permlane16_swap_b32 v218, v222
    v_mfma_f32_32x32x16_bf16 v[56:71], a[120:123], v[80:83], v[56:71]
    v_permlane16_swap_b32 v219, v223
    s_waitcnt lgkmcnt(0)
    v_mfma_f32_32x32x16_bf16 v[40:55], a[60:63], v[84:87], v[40:55]
    buffer_store_dwordx4 v[216:219], v6, s[16:19], 0 offen offset:3136
    v_mfma_f32_32x32x16_bf16 v[56:71], a[124:127], v[84:87], v[56:71]
    buffer_store_dwordx4 v[220:223], v7, s[16:19], 0 offen offset:3136
    s_nop 7
    s_nop 7
    v_cvt_pk_bf16_f32 v208, v40, v41
    v_cvt_pk_bf16_f32 v209, v42, v43
    v_cvt_pk_bf16_f32 v210, v44, v45
    v_cvt_pk_bf16_f32 v211, v46, v47
    v_cvt_pk_bf16_f32 v212, v48, v49
    v_cvt_pk_bf16_f32 v213, v50, v51
    v_cvt_pk_bf16_f32 v214, v52, v53
    v_cvt_pk_bf16_f32 v215, v54, v55
    s_nop 1
    v_permlane16_swap_b32 v208, v212
    v_permlane16_swap_b32 v209, v213
    v_permlane16_swap_b32 v210, v214
    v_permlane16_swap_b32 v211, v215
    buffer_store_dwordx4 v[208:211], v6, s[16:19], 0 offen offset:3584
    buffer_store_dwordx4 v[212:215], v7, s[16:19], 0 offen offset:3584
    v_cvt_pk_bf16_f32 v216, v56, v57
    v_cvt_pk_bf16_f32 v217, v58, v59
    v_cvt_pk_bf16_f32 v218, v60, v61
    v_cvt_pk_bf16_f32 v219, v62, v63
    v_cvt_pk_bf16_f32 v220, v64, v65
    v_cvt_pk_bf16_f32 v221, v66, v67
    v_cvt_pk_bf16_f32 v222, v68, v69
    v_cvt_pk_bf16_f32 v223, v70, v71
    s_nop 1
    v_permlane16_swap_b32 v216, v220
    v_permlane16_swap_b32 v217, v221
    v_permlane16_swap_b32 v218, v222
    v_permlane16_swap_b32 v219, v223
    buffer_store_dwordx4 v[216:219], v6, s[16:19], 0 offen offset:3648
    buffer_store_dwordx4 v[220:223], v7, s[16:19], 0 offen offset:3648
    s_endpgm
L_joint_kernel_slow:
    v_add_u32 v4, 90112, v4
    ds_read_b128 v[128:131], v4 offset:0
    ds_read_b128 v[132:135], v4 offset:32
    ds_read_b128 v[136:139], v4 offset:64
    ds_read_b128 v[140:143], v4 offset:96
    ds_read_b128 v[144:147], v4 offset:128
    ds_read_b128 v[148:151], v4 offset:160
    ds_read_b128 v[152:155], v4 offset:192
    ds_read_b128 v[156:159], v4 offset:224
    s_waitcnt lgkmcnt(0)
    v_add_f32 v160, v96, v128
    v_add_f32 v161, v97, v129
    v_add_f32 v162, v98, v130
    v_add_f32 v163, v99, v131
    v_add_f32 v164, v100, v132
    v_add_f32 v165, v101, v133
    v_add_f32 v166, v102, v134
    v_add_f32 v167, v103, v135
    v_exp_f32 v160, v160
    v_exp_f32 v161, v161
    v_exp_f32 v162, v162
    v_exp_f32 v163, v163
    v_exp_f32 v164, v164
    v_exp_f32 v165, v165
    v_exp_f32 v166, v166
    v_exp_f32 v167, v167
    v_add_f32 v160, 1.0, v160
    v_add_f32 v161, 1.0, v161
    v_add_f32 v162, 1.0, v162
    v_add_f32 v163, 1.0, v163
    v_add_f32 v164, 1.0, v164
    v_add_f32 v165, 1.0, v165
    v_add_f32 v166, 1.0, v166
    v_add_f32 v167, 1.0, v167
    v_rcp_f32 v160, v160
    v_rcp_f32 v161, v161
    v_rcp_f32 v162, v162
    v_rcp_f32 v163, v163
    v_rcp_f32 v164, v164
    v_rcp_f32 v165, v165
    v_rcp_f32 v166, v166
    v_rcp_f32 v167, v167
    v_fma_f32 v160, v160, -2.0, 1.0
    v_fma_f32 v161, v161, -2.0, 1.0
    v_fma_f32 v162, v162, -2.0, 1.0
    v_fma_f32 v163, v163, -2.0, 1.0
    v_fma_f32 v164, v164, -2.0, 1.0
    v_fma_f32 v165, v165, -2.0, 1.0
    v_fma_f32 v166, v166, -2.0, 1.0
    v_fma_f32 v167, v167, -2.0, 1.0
    v_cvt_pk_bf16_f32 v192, v160, v161
    v_cvt_pk_bf16_f32 v193, v162, v163
    v_cvt_pk_bf16_f32 v194, v164, v165
    v_cvt_pk_bf16_f32 v195, v166, v167
    ds_write_b128 v2, v[192:195] offset:0
    v_add_f32 v168, v104, v136
    v_add_f32 v169, v105, v137
    v_add_f32 v170, v106, v138
    v_add_f32 v171, v107, v139
    v_add_f32 v172, v108, v140
    v_add_f32 v173, v109, v141
    v_add_f32 v174, v110, v142
    v_add_f32 v175, v111, v143
    v_exp_f32 v168, v168
    v_exp_f32 v169, v169
    v_exp_f32 v170, v170
    v_exp_f32 v171, v171
    v_exp_f32 v172, v172
    v_exp_f32 v173, v173
    v_exp_f32 v174, v174
    v_exp_f32 v175, v175
    v_add_f32 v168, 1.0, v168
    v_add_f32 v169, 1.0, v169
    v_add_f32 v170, 1.0, v170
    v_add_f32 v171, 1.0, v171
    v_add_f32 v172, 1.0, v172
    v_add_f32 v173, 1.0, v173
    v_add_f32 v174, 1.0, v174
    v_add_f32 v175, 1.0, v175
    v_rcp_f32 v168, v168
    v_rcp_f32 v169, v169
    v_rcp_f32 v170, v170
    v_rcp_f32 v171, v171
    v_rcp_f32 v172, v172
    v_rcp_f32 v173, v173
    v_rcp_f32 v174, v174
    v_rcp_f32 v175, v175
    v_fma_f32 v168, v168, -2.0, 1.0
    v_fma_f32 v169, v169, -2.0, 1.0
    v_fma_f32 v170, v170, -2.0, 1.0
    v_fma_f32 v171, v171, -2.0, 1.0
    v_fma_f32 v172, v172, -2.0, 1.0
    v_fma_f32 v173, v173, -2.0, 1.0
    v_fma_f32 v174, v174, -2.0, 1.0
    v_fma_f32 v175, v175, -2.0, 1.0
    v_cvt_pk_bf16_f32 v196, v168, v169
    v_cvt_pk_bf16_f32 v197, v170, v171
    v_cvt_pk_bf16_f32 v198, v172, v173
    v_cvt_pk_bf16_f32 v199, v174, v175
    ds_write_b128 v2, v[196:199] offset:1024
    v_add_f32 v176, v112, v144
    v_add_f32 v177, v113, v145
    v_add_f32 v178, v114, v146
    v_add_f32 v179, v115, v147
    v_add_f32 v180, v116, v148
    v_add_f32 v181, v117, v149
    v_add_f32 v182, v118, v150
    v_add_f32 v183, v119, v151
    v_exp_f32 v176, v176
    v_exp_f32 v177, v177
    v_exp_f32 v178, v178
    v_exp_f32 v179, v179
    v_exp_f32 v180, v180
    v_exp_f32 v181, v181
    v_exp_f32 v182, v182
    v_exp_f32 v183, v183
    v_add_f32 v176, 1.0, v176
    v_add_f32 v177, 1.0, v177
    v_add_f32 v178, 1.0, v178
    v_add_f32 v179, 1.0, v179
    v_add_f32 v180, 1.0, v180
    v_add_f32 v181, 1.0, v181
    v_add_f32 v182, 1.0, v182
    v_add_f32 v183, 1.0, v183
    v_rcp_f32 v176, v176
    v_rcp_f32 v177, v177
    v_rcp_f32 v178, v178
    v_rcp_f32 v179, v179
    v_rcp_f32 v180, v180
    v_rcp_f32 v181, v181
    v_rcp_f32 v182, v182
    v_rcp_f32 v183, v183
    v_fma_f32 v176, v176, -2.0, 1.0
    v_fma_f32 v177, v177, -2.0, 1.0
    v_fma_f32 v178, v178, -2.0, 1.0
    v_fma_f32 v179, v179, -2.0, 1.0
    v_fma_f32 v180, v180, -2.0, 1.0
    v_fma_f32 v181, v181, -2.0, 1.0
    v_fma_f32 v182, v182, -2.0, 1.0
    v_fma_f32 v183, v183, -2.0, 1.0
    v_cvt_pk_bf16_f32 v200, v176, v177
    v_cvt_pk_bf16_f32 v201, v178, v179
    v_cvt_pk_bf16_f32 v202, v180, v181
    v_cvt_pk_bf16_f32 v203, v182, v183
    ds_write_b128 v2, v[200:203] offset:2048
    v_add_f32 v184, v120, v152
    v_add_f32 v185, v121, v153
    v_add_f32 v186, v122, v154
    v_add_f32 v187, v123, v155
    v_add_f32 v188, v124, v156
    v_add_f32 v189, v125, v157
    v_add_f32 v190, v126, v158
    v_add_f32 v191, v127, v159
    v_exp_f32 v184, v184
    v_exp_f32 v185, v185
    v_exp_f32 v186, v186
    v_exp_f32 v187, v187
    v_exp_f32 v188, v188
    v_exp_f32 v189, v189
    v_exp_f32 v190, v190
    v_exp_f32 v191, v191
    v_add_f32 v184, 1.0, v184
    v_add_f32 v185, 1.0, v185
    v_add_f32 v186, 1.0, v186
    v_add_f32 v187, 1.0, v187
    v_add_f32 v188, 1.0, v188
    v_add_f32 v189, 1.0, v189
    v_add_f32 v190, 1.0, v190
    v_add_f32 v191, 1.0, v191
    v_rcp_f32 v184, v184
    v_rcp_f32 v185, v185
    v_rcp_f32 v186, v186
    v_rcp_f32 v187, v187
    v_rcp_f32 v188, v188
    v_rcp_f32 v189, v189
    v_rcp_f32 v190, v190
    v_rcp_f32 v191, v191
    v_fma_f32 v184, v184, -2.0, 1.0
    v_fma_f32 v185, v185, -2.0, 1.0
    v_fma_f32 v186, v186, -2.0, 1.0
    v_fma_f32 v187, v187, -2.0, 1.0
    v_fma_f32 v188, v188, -2.0, 1.0
    v_fma_f32 v189, v189, -2.0, 1.0
    v_fma_f32 v190, v190, -2.0, 1.0
    v_fma_f32 v191, v191, -2.0, 1.0
    v_cvt_pk_bf16_f32 v204, v184, v185
    v_cvt_pk_bf16_f32 v205, v186, v187
    v_cvt_pk_bf16_f32 v206, v188, v189
    v_cvt_pk_bf16_f32 v207, v190, v191
    ds_write_b128 v2, v[204:207] offset:3072
    s_waitcnt vmcnt(0)
    s_waitcnt lgkmcnt(0)
    s_barrier
    ds_read_b128 v[72:75], v3 offset:0
    ds_read_b128 v[76:79], v3 offset:1024
    ds_read_b128 v[80:83], v3 offset:2048
    ds_read_b128 v[84:87], v3 offset:3072
    s_waitcnt lgkmcnt(3)
    v_mfma_f32_32x32x16_bf16 v[8:23], a[0:3], v[72:75], 0
    ds_read_b128 v[88:91], v3 offset:4096
    ds_read_b128 v[128:131], v4 offset:1024
    ds_read_b128 v[132:135], v4 offset:1056
    ds_read_b128 v[136:139], v4 offset:1088
    ds_read_b128 v[140:143], v4 offset:1120
    v_mfma_f32_32x32x16_bf16 v[24:39], a[64:67], v[72:75], 0
    ds_read_b128 v[144:147], v4 offset:1152
    ds_read_b128 v[148:151], v4 offset:1184
    ds_read_b128 v[152:155], v4 offset:1216
    ds_read_b128 v[156:159], v4 offset:1248
    s_waitcnt lgkmcnt(11)
    v_mfma_f32_32x32x16_bf16 v[8:23], a[4:7], v[76:79], v[8:23]
    ds_read_b128 v[92:95], v3 offset:5120
    s_waitcnt lgkmcnt(1)
    v_add_f32 v160, v96, v128
    v_add_f32 v161, v97, v129
    v_add_f32 v162, v98, v130
    v_add_f32 v163, v99, v131
    v_add_f32 v164, v100, v132
    v_add_f32 v165, v101, v133
    v_mfma_f32_32x32x16_bf16 v[24:39], a[68:71], v[76:79], v[24:39]
    v_add_f32 v166, v102, v134
    v_add_f32 v167, v103, v135
    v_exp_f32 v160, v160
    v_exp_f32 v161, v161
    v_exp_f32 v162, v162
    v_exp_f32 v163, v163
    v_mfma_f32_32x32x16_bf16 v[8:23], a[8:11], v[80:83], v[8:23]
    ds_read_b128 v[72:75], v3 offset:6144
    v_exp_f32 v164, v164
    v_exp_f32 v165, v165
    v_exp_f32 v166, v166
    v_exp_f32 v167, v167
    v_add_f32 v160, 1.0, v160
    v_add_f32 v161, 1.0, v161
    v_mfma_f32_32x32x16_bf16 v[24:39], a[72:75], v[80:83], v[24:39]
    v_add_f32 v162, 1.0, v162
    v_add_f32 v163, 1.0, v163
    v_add_f32 v164, 1.0, v164
    v_add_f32 v165, 1.0, v165
    v_add_f32 v166, 1.0, v166
    v_add_f32 v167, 1.0, v167
    v_mfma_f32_32x32x16_bf16 v[8:23], a[12:15], v[84:87], v[8:23]
    ds_read_b128 v[76:79], v3 offset:7168
    v_rcp_f32 v160, v160
    v_rcp_f32 v161, v161
    v_rcp_f32 v162, v162
    v_rcp_f32 v163, v163
    v_rcp_f32 v164, v164
    v_rcp_f32 v165, v165
    v_mfma_f32_32x32x16_bf16 v[24:39], a[76:79], v[84:87], v[24:39]
    v_rcp_f32 v166, v166
    v_rcp_f32 v167, v167
    v_fma_f32 v160, v160, -2.0, 1.0
    v_fma_f32 v161, v161, -2.0, 1.0
    v_fma_f32 v162, v162, -2.0, 1.0
    v_fma_f32 v163, v163, -2.0, 1.0
    v_mfma_f32_32x32x16_bf16 v[8:23], a[16:19], v[88:91], v[8:23]
    ds_read_b128 v[80:83], v3 offset:8192
    v_fma_f32 v164, v164, -2.0, 1.0
    v_fma_f32 v165, v165, -2.0, 1.0
    v_fma_f32 v166, v166, -2.0, 1.0
    v_fma_f32 v167, v167, -2.0, 1.0
    v_cvt_pk_bf16_f32 v192, v160, v161
    v_cvt_pk_bf16_f32 v193, v162, v163
    v_mfma_f32_32x32x16_bf16 v[24:39], a[80:83], v[88:91], v[24:39]
    v_cvt_pk_bf16_f32 v194, v164, v165
    v_cvt_pk_bf16_f32 v195, v166, v167
    ds_write_b128 v2, v[192:195] offset:16384
    v_add_f32 v168, v104, v136
    v_add_f32 v169, v105, v137
    v_add_f32 v170, v106, v138
    s_waitcnt lgkmcnt(4)
    v_mfma_f32_32x32x16_bf16 v[8:23], a[20:23], v[92:95], v[8:23]
    ds_read_b128 v[84:87], v3 offset:9216
    v_add_f32 v171, v107, v139
    v_add_f32 v172, v108, v140
    v_add_f32 v173, v109, v141
    v_add_f32 v174, v110, v142
    v_add_f32 v175, v111, v143
    v_exp_f32 v168, v168
    v_mfma_f32_32x32x16_bf16 v[24:39], a[84:87], v[92:95], v[24:39]
    v_exp_f32 v169, v169
    v_exp_f32 v170, v170
    v_exp_f32 v171, v171
    v_exp_f32 v172, v172
    v_exp_f32 v173, v173
    v_exp_f32 v174, v174
    s_waitcnt lgkmcnt(4)
    v_mfma_f32_32x32x16_bf16 v[8:23], a[24:27], v[72:75], v[8:23]
    ds_read_b128 v[88:91], v3 offset:10240
    v_exp_f32 v175, v175
    v_add_f32 v168, 1.0, v168
    v_add_f32 v169, 1.0, v169
    v_add_f32 v170, 1.0, v170
    v_add_f32 v171, 1.0, v171
    v_add_f32 v172, 1.0, v172
    v_mfma_f32_32x32x16_bf16 v[24:39], a[88:91], v[72:75], v[24:39]
    v_add_f32 v173, 1.0, v173
    v_add_f32 v174, 1.0, v174
    v_add_f32 v175, 1.0, v175
    v_rcp_f32 v168, v168
    v_rcp_f32 v169, v169
    v_rcp_f32 v170, v170
    s_waitcnt lgkmcnt(4)
    v_mfma_f32_32x32x16_bf16 v[8:23], a[28:31], v[76:79], v[8:23]
    ds_read_b128 v[92:95], v3 offset:11264
    v_rcp_f32 v171, v171
    v_rcp_f32 v172, v172
    v_rcp_f32 v173, v173
    v_rcp_f32 v174, v174
    v_rcp_f32 v175, v175
    v_fma_f32 v168, v168, -2.0, 1.0
    v_mfma_f32_32x32x16_bf16 v[24:39], a[92:95], v[76:79], v[24:39]
    v_fma_f32 v169, v169, -2.0, 1.0
    v_fma_f32 v170, v170, -2.0, 1.0
    v_fma_f32 v171, v171, -2.0, 1.0
    v_fma_f32 v172, v172, -2.0, 1.0
    v_fma_f32 v173, v173, -2.0, 1.0
    v_fma_f32 v174, v174, -2.0, 1.0
    s_waitcnt lgkmcnt(4)
    v_mfma_f32_32x32x16_bf16 v[8:23], a[32:35], v[80:83], v[8:23]
    ds_read_b128 v[72:75], v3 offset:12288
    v_fma_f32 v175, v175, -2.0, 1.0
    v_cvt_pk_bf16_f32 v196, v168, v169
    v_cvt_pk_bf16_f32 v197, v170, v171
    v_cvt_pk_bf16_f32 v198, v172, v173
    v_cvt_pk_bf16_f32 v199, v174, v175
    ds_write_b128 v2, v[196:199] offset:17408
    v_mfma_f32_32x32x16_bf16 v[24:39], a[96:99], v[80:83], v[24:39]
    v_add_f32 v176, v112, v144
    v_add_f32 v177, v113, v145
    v_add_f32 v178, v114, v146
    v_add_f32 v179, v115, v147
    v_add_f32 v180, v116, v148
    v_add_f32 v181, v117, v149
    s_waitcnt lgkmcnt(4)
    v_mfma_f32_32x32x16_bf16 v[8:23], a[36:39], v[84:87], v[8:23]
    ds_read_b128 v[76:79], v3 offset:13312
    v_add_f32 v182, v118, v150
    v_add_f32 v183, v119, v151
    v_exp_f32 v176, v176
    v_exp_f32 v177, v177
    v_exp_f32 v178, v178
    v_exp_f32 v179, v179
    v_mfma_f32_32x32x16_bf16 v[24:39], a[100:103], v[84:87], v[24:39]
    v_exp_f32 v180, v180
    v_exp_f32 v181, v181
    v_exp_f32 v182, v182
    v_exp_f32 v183, v183
    v_add_f32 v176, 1.0, v176
    v_add_f32 v177, 1.0, v177
    s_waitcnt lgkmcnt(4)
    v_mfma_f32_32x32x16_bf16 v[8:23], a[40:43], v[88:91], v[8:23]
    ds_read_b128 v[80:83], v3 offset:14336
    v_add_f32 v178, 1.0, v178
    v_add_f32 v179, 1.0, v179
    v_add_f32 v180, 1.0, v180
    v_add_f32 v181, 1.0, v181
    v_add_f32 v182, 1.0, v182
    v_add_f32 v183, 1.0, v183
    v_mfma_f32_32x32x16_bf16 v[24:39], a[104:107], v[88:91], v[24:39]
    v_rcp_f32 v176, v176
    v_rcp_f32 v177, v177
    v_rcp_f32 v178, v178
    v_rcp_f32 v179, v179
    v_rcp_f32 v180, v180
    v_rcp_f32 v181, v181
    s_waitcnt lgkmcnt(4)
    v_mfma_f32_32x32x16_bf16 v[8:23], a[44:47], v[92:95], v[8:23]
    ds_read_b128 v[84:87], v3 offset:15360
    v_rcp_f32 v182, v182
    v_rcp_f32 v183, v183
    v_fma_f32 v176, v176, -2.0, 1.0
    v_fma_f32 v177, v177, -2.0, 1.0
    v_fma_f32 v178, v178, -2.0, 1.0
    v_fma_f32 v179, v179, -2.0, 1.0
    v_mfma_f32_32x32x16_bf16 v[24:39], a[108:111], v[92:95], v[24:39]
    v_fma_f32 v180, v180, -2.0, 1.0
    v_fma_f32 v181, v181, -2.0, 1.0
    v_fma_f32 v182, v182, -2.0, 1.0
    v_fma_f32 v183, v183, -2.0, 1.0
    v_cvt_pk_bf16_f32 v200, v176, v177
    v_cvt_pk_bf16_f32 v201, v178, v179
    s_waitcnt lgkmcnt(4)
    v_mfma_f32_32x32x16_bf16 v[8:23], a[48:51], v[72:75], v[8:23]
    v_cvt_pk_bf16_f32 v202, v180, v181
    v_cvt_pk_bf16_f32 v203, v182, v183
    ds_write_b128 v2, v[200:203] offset:18432
    v_add_f32 v184, v120, v152
    v_add_f32 v185, v121, v153
    v_add_f32 v186, v122, v154
    v_mfma_f32_32x32x16_bf16 v[24:39], a[112:115], v[72:75], v[24:39]
    v_add_f32 v187, v123, v155
    v_add_f32 v188, v124, v156
    v_add_f32 v189, v125, v157
    v_add_f32 v190, v126, v158
    v_add_f32 v191, v127, v159
    v_exp_f32 v184, v184
    s_waitcnt lgkmcnt(3)
    v_mfma_f32_32x32x16_bf16 v[8:23], a[52:55], v[76:79], v[8:23]
    v_exp_f32 v185, v185
    v_exp_f32 v186, v186
    v_exp_f32 v187, v187
    v_exp_f32 v188, v188
    v_exp_f32 v189, v189
    v_exp_f32 v190, v190
    v_mfma_f32_32x32x16_bf16 v[24:39], a[116:119], v[76:79], v[24:39]
    v_exp_f32 v191, v191
    v_add_f32 v184, 1.0, v184
    v_add_f32 v185, 1.0, v185
    v_add_f32 v186, 1.0, v186
    v_add_f32 v187, 1.0, v187
    v_add_f32 v188, 1.0, v188
    s_waitcnt lgkmcnt(2)
    v_mfma_f32_32x32x16_bf16 v[8:23], a[56:59], v[80:83], v[8:23]
    v_add_f32 v189, 1.0, v189
    v_add_f32 v190, 1.0, v190
    v_add_f32 v191, 1.0, v191
    v_rcp_f32 v184, v184
    v_rcp_f32 v185, v185
    v_rcp_f32 v186, v186
    v_mfma_f32_32x32x16_bf16 v[24:39], a[120:123], v[80:83], v[24:39]
    v_rcp_f32 v187, v187
    v_rcp_f32 v188, v188
    v_rcp_f32 v189, v189
    v_rcp_f32 v190, v190
    v_rcp_f32 v191, v191
    v_fma_f32 v184, v184, -2.0, 1.0
    s_waitcnt lgkmcnt(1)
    v_mfma_f32_32x32x16_bf16 v[8:23], a[60:63], v[84:87], v[8:23]
    v_fma_f32 v185, v185, -2.0, 1.0
    v_fma_f32 v186, v186, -2.0, 1.0
    v_fma_f32 v187, v187, -2.0, 1.0
    v_fma_f32 v188, v188, -2.0, 1.0
    v_fma_f32 v189, v189, -2.0, 1.0
    v_fma_f32 v190, v190, -2.0, 1.0
    v_mfma_f32_32x32x16_bf16 v[24:39], a[124:127], v[84:87], v[24:39]
    v_fma_f32 v191, v191, -2.0, 1.0
    v_cvt_pk_bf16_f32 v204, v184, v185
    v_cvt_pk_bf16_f32 v205, v186, v187
    v_cvt_pk_bf16_f32 v206, v188, v189
    v_cvt_pk_bf16_f32 v207, v190, v191
    ds_write_b128 v2, v[204:207] offset:19456
    s_waitcnt lgkmcnt(0)
    s_barrier
    ds_read_b128 v[72:75], v3 offset:16384
    ds_read_b128 v[76:79], v3 offset:17408
    ds_read_b128 v[80:83], v3 offset:18432
    ds_read_b128 v[84:87], v3 offset:19456
    s_waitcnt lgkmcnt(3)
    v_mfma_f32_32x32x16_bf16 v[40:55], a[0:3], v[72:75], 0
    ds_read_b128 v[88:91], v3 offset:20480
    ds_read_b128 v[128:131], v4 offset:2048
    ds_read_b128 v[132:135], v4 offset:2080
    ds_read_b128 v[136:139], v4 offset:2112
    ds_read_b128 v[140:143], v4 offset:2144
    v_mfma_f32_32x32x16_bf16 v[56:71], a[64:67], v[72:75], 0
    ds_read_b128 v[144:147], v4 offset:2176
    ds_read_b128 v[148:151], v4 offset:2208
    ds_read_b128 v[152:155], v4 offset:2240
    ds_read_b128 v[156:159], v4 offset:2272
    s_waitcnt lgkmcnt(11)
    v_mfma_f32_32x32x16_bf16 v[40:55], a[4:7], v[76:79], v[40:55]
    ds_read_b128 v[92:95], v3 offset:21504
    v_cvt_pk_bf16_f32 v208, v8, v9
    v_cvt_pk_bf16_f32 v209, v10, v11
    v_cvt_pk_bf16_f32 v210, v12, v13
    v_cvt_pk_bf16_f32 v211, v14, v15
    v_cvt_pk_bf16_f32 v212, v16, v17
    v_cvt_pk_bf16_f32 v213, v18, v19
    v_cvt_pk_bf16_f32 v214, v20, v21
    v_cvt_pk_bf16_f32 v215, v22, v23
    v_mfma_f32_32x32x16_bf16 v[56:71], a[68:71], v[76:79], v[56:71]
    s_nop 1
    v_permlane16_swap_b32 v208, v212
    v_permlane16_swap_b32 v209, v213
    v_permlane16_swap_b32 v210, v214
    v_permlane16_swap_b32 v211, v215
    buffer_store_dwordx4 v[208:211], v6, s[16:19], 0 offen offset:0
    buffer_store_dwordx4 v[212:215], v7, s[16:19], 0 offen offset:0
    s_waitcnt lgkmcnt(11)
    v_mfma_f32_32x32x16_bf16 v[40:55], a[8:11], v[80:83], v[40:55]
    ds_read_b128 v[72:75], v3 offset:22528
    v_cvt_pk_bf16_f32 v216, v24, v25
    v_cvt_pk_bf16_f32 v217, v26, v27
    v_cvt_pk_bf16_f32 v218, v28, v29
    v_cvt_pk_bf16_f32 v219, v30, v31
    v_cvt_pk_bf16_f32 v220, v32, v33
    v_cvt_pk_bf16_f32 v221, v34, v35
    v_cvt_pk_bf16_f32 v222, v36, v37
    v_mfma_f32_32x32x16_bf16 v[56:71], a[72:75], v[80:83], v[56:71]
    v_cvt_pk_bf16_f32 v223, v38, v39
    s_nop 1
    v_permlane16_swap_b32 v216, v220
    v_permlane16_swap_b32 v217, v221
    v_permlane16_swap_b32 v218, v222
    v_permlane16_swap_b32 v219, v223
    buffer_store_dwordx4 v[216:219], v6, s[16:19], 0 offen offset:64
    s_waitcnt lgkmcnt(11)
    v_mfma_f32_32x32x16_bf16 v[40:55], a[12:15], v[84:87], v[40:55]
    ds_read_b128 v[76:79], v3 offset:23552
    buffer_store_dwordx4 v[220:223], v7, s[16:19], 0 offen offset:64
    s_waitcnt lgkmcnt(3)
    v_add_f32 v160, v96, v128
    v_add_f32 v161, v97, v129
    v_add_f32 v162, v98, v130
    v_add_f32 v163, v99, v131
    v_add_f32 v164, v100, v132
    v_mfma_f32_32x32x16_bf16 v[56:71], a[76:79], v[84:87], v[56:71]
    v_add_f32 v165, v101, v133
    v_add_f32 v166, v102, v134
    v_add_f32 v167, v103, v135
    v_exp_f32 v160, v160
    v_exp_f32 v161, v161
    v_exp_f32 v162, v162
    v_exp_f32 v163, v163
    v_mfma_f32_32x32x16_bf16 v[40:55], a[16:19], v[88:91], v[40:55]
    ds_read_b128 v[80:83], v3 offset:24576
    v_exp_f32 v164, v164
    v_exp_f32 v165, v165
    v_exp_f32 v166, v166
    v_exp_f32 v167, v167
    v_add_f32 v160, 1.0, v160
    v_add_f32 v161, 1.0, v161
    v_add_f32 v162, 1.0, v162
    v_mfma_f32_32x32x16_bf16 v[56:71], a[80:83], v[88:91], v[56:71]
    v_add_f32 v163, 1.0, v163
    v_add_f32 v164, 1.0, v164
    v_add_f32 v165, 1.0, v165
    v_add_f32 v166, 1.0, v166
    v_add_f32 v167, 1.0, v167
    v_rcp_f32 v160, v160
    v_rcp_f32 v161, v161
    s_waitcnt lgkmcnt(3)
    v_mfma_f32_32x32x16_bf16 v[40:55], a[20:23], v[92:95], v[40:55]
    ds_read_b128 v[84:87], v3 offset:25600
    v_rcp_f32 v162, v162
    v_rcp_f32 v163, v163
    v_rcp_f32 v164, v164
    v_rcp_f32 v165, v165
    v_rcp_f32 v166, v166
    v_rcp_f32 v167, v167
    v_fma_f32 v160, v160, -2.0, 1.0
    v_mfma_f32_32x32x16_bf16 v[56:71], a[84:87], v[92:95], v[56:71]
    v_fma_f32 v161, v161, -2.0, 1.0
    v_fma_f32 v162, v162, -2.0, 1.0
    v_fma_f32 v163, v163, -2.0, 1.0
    v_fma_f32 v164, v164, -2.0, 1.0
    v_fma_f32 v165, v165, -2.0, 1.0
    v_fma_f32 v166, v166, -2.0, 1.0
    v_fma_f32 v167, v167, -2.0, 1.0
    s_waitcnt lgkmcnt(3)
    v_mfma_f32_32x32x16_bf16 v[40:55], a[24:27], v[72:75], v[40:55]
    ds_read_b128 v[88:91], v3 offset:26624
    v_cvt_pk_bf16_f32 v192, v160, v161
    v_cvt_pk_bf16_f32 v193, v162, v163
    v_cvt_pk_bf16_f32 v194, v164, v165
    v_cvt_pk_bf16_f32 v195, v166, v167
    ds_write_b128 v2, v[192:195] offset:0
    v_add_f32 v168, v104, v136
    v_add_f32 v169, v105, v137
    v_mfma_f32_32x32x16_bf16 v[56:71], a[88:91], v[72:75], v[56:71]
    v_add_f32 v170, v106, v138
    v_add_f32 v171, v107, v139
    v_add_f32 v172, v108, v140
    v_add_f32 v173, v109, v141
    v_add_f32 v174, v110, v142
    v_add_f32 v175, v111, v143
    v_exp_f32 v168, v168
    s_waitcnt lgkmcnt(4)
    v_mfma_f32_32x32x16_bf16 v[40:55], a[28:31], v[76:79], v[40:55]
    ds_read_b128 v[92:95], v3 offset:27648
    v_exp_f32 v169, v169
    v_exp_f32 v170, v170
    v_exp_f32 v171, v171
    v_exp_f32 v172, v172
    v_exp_f32 v173, v173
    v_exp_f32 v174, v174
    v_exp_f32 v175, v175
    v_mfma_f32_32x32x16_bf16 v[56:71], a[92:95], v[76:79], v[56:71]
    v_add_f32 v168, 1.0, v168
    v_add_f32 v169, 1.0, v169
    v_add_f32 v170, 1.0, v170
    v_add_f32 v171, 1.0, v171
    v_add_f32 v172, 1.0, v172
    v_add_f32 v173, 1.0, v173
    v_add_f32 v174, 1.0, v174
    s_waitcnt lgkmcnt(4)
    v_mfma_f32_32x32x16_bf16 v[40:55], a[32:35], v[80:83], v[40:55]
    ds_read_b128 v[72:75], v3 offset:28672
    v_add_f32 v175, 1.0, v175
    v_rcp_f32 v168, v168
    v_rcp_f32 v169, v169
    v_rcp_f32 v170, v170
    v_rcp_f32 v171, v171
    v_rcp_f32 v172, v172
    v_rcp_f32 v173, v173
    v_mfma_f32_32x32x16_bf16 v[56:71], a[96:99], v[80:83], v[56:71]
    v_rcp_f32 v174, v174
    v_rcp_f32 v175, v175
    v_fma_f32 v168, v168, -2.0, 1.0
    v_fma_f32 v169, v169, -2.0, 1.0
    v_fma_f32 v170, v170, -2.0, 1.0
    v_fma_f32 v171, v171, -2.0, 1.0
    v_fma_f32 v172, v172, -2.0, 1.0
    s_waitcnt lgkmcnt(4)
    v_mfma_f32_32x32x16_bf16 v[40:55], a[36:39], v[84:87], v[40:55]
    ds_read_b128 v[76:79], v3 offset:29696
    v_fma_f32 v173, v173, -2.0, 1.0
    v_fma_f32 v174, v174, -2.0, 1.0
    v_fma_f32 v175, v175, -2.0, 1.0
    v_cvt_pk_bf16_f32 v196, v168, v169
    v_cvt_pk_bf16_f32 v197, v170, v171
    v_cvt_pk_bf16_f32 v198, v172, v173
    v_cvt_pk_bf16_f32 v199, v174, v175
    v_mfma_f32_32x32x16_bf16 v[56:71], a[100:103], v[84:87], v[56:71]
    ds_write_b128 v2, v[196:199] offset:1024
    v_add_f32 v176, v112, v144
    v_add_f32 v177, v113, v145
    v_add_f32 v178, v114, v146
    v_add_f32 v179, v115, v147
    v_add_f32 v180, v116, v148
    v_add_f32 v181, v117, v149
    s_waitcnt lgkmcnt(5)
    v_mfma_f32_32x32x16_bf16 v[40:55], a[40:43], v[88:91], v[40:55]
    ds_read_b128 v[80:83], v3 offset:30720
    v_add_f32 v182, v118, v150
    v_add_f32 v183, v119, v151
    v_exp_f32 v176, v176
    v_exp_f32 v177, v177
    v_exp_f32 v178, v178
    v_exp_f32 v179, v179
    v_exp_f32 v180, v180
    v_mfma_f32_32x32x16_bf16 v[56:71], a[104:107], v[88:91], v[56:71]
    v_exp_f32 v181, v181
    v_exp_f32 v182, v182
    v_exp_f32 v183, v183
    v_add_f32 v176, 1.0, v176
    v_add_f32 v177, 1.0, v177
    v_add_f32 v178, 1.0, v178
    v_add_f32 v179, 1.0, v179
    s_waitcnt lgkmcnt(4)
    v_mfma_f32_32x32x16_bf16 v[40:55], a[44:47], v[92:95], v[40:55]
    ds_read_b128 v[84:87], v3 offset:31744
    v_add_f32 v180, 1.0, v180
    v_add_f32 v181, 1.0, v181
    v_add_f32 v182, 1.0, v182
    v_add_f32 v183, 1.0, v183
    v_rcp_f32 v176, v176
    v_rcp_f32 v177, v177
    v_rcp_f32 v178, v178
    v_mfma_f32_32x32x16_bf16 v[56:71], a[108:111], v[92:95], v[56:71]
    v_rcp_f32 v179, v179
    v_rcp_f32 v180, v180
    v_rcp_f32 v181, v181
    v_rcp_f32 v182, v182
    v_rcp_f32 v183, v183
    v_fma_f32 v176, v176, -2.0, 1.0
    v_fma_f32 v177, v177, -2.0, 1.0
    s_waitcnt lgkmcnt(4)
    v_mfma_f32_32x32x16_bf16 v[40:55], a[48:51], v[72:75], v[40:55]
    v_fma_f32 v178, v178, -2.0, 1.0
    v_fma_f32 v179, v179, -2.0, 1.0
    v_fma_f32 v180, v180, -2.0, 1.0
    v_fma_f32 v181, v181, -2.0, 1.0
    v_fma_f32 v182, v182, -2.0, 1.0
    v_fma_f32 v183, v183, -2.0, 1.0
    v_cvt_pk_bf16_f32 v200, v176, v177
    v_mfma_f32_32x32x16_bf16 v[56:71], a[112:115], v[72:75], v[56:71]
    v_cvt_pk_bf16_f32 v201, v178, v179
    v_cvt_pk_bf16_f32 v202, v180, v181
    v_cvt_pk_bf16_f32 v203, v182, v183
    ds_write_b128 v2, v[200:203] offset:2048
    v_add_f32 v184, v120, v152
    v_add_f32 v185, v121, v153
    v_add_f32 v186, v122, v154
    s_waitcnt lgkmcnt(4)
    v_mfma_f32_32x32x16_bf16 v[40:55], a[52:55], v[76:79], v[40:55]
    v_add_f32 v187, v123, v155
    v_add_f32 v188, v124, v156
    v_add_f32 v189, v125, v157
    v_add_f32 v190, v126, v158
    v_add_f32 v191, v127, v159
    v_exp_f32 v184, v184
    v_exp_f32 v185, v185
    v_mfma_f32_32x32x16_bf16 v[56:71], a[116:119], v[76:79], v[56:71]
    v_exp_f32 v186, v186
    v_exp_f32 v187, v187
    v_exp_f32 v188, v188
    v_exp_f32 v189, v189
    v_exp_f32 v190, v190
    v_exp_f32 v191, v191
    v_add_f32 v184, 1.0, v184
    s_waitcnt lgkmcnt(2)
    v_mfma_f32_32x32x16_bf16 v[40:55], a[56:59], v[80:83], v[40:55]
    v_add_f32 v185, 1.0, v185
    v_add_f32 v186, 1.0, v186
    v_add_f32 v187, 1.0, v187
    v_add_f32 v188, 1.0, v188
    v_add_f32 v189, 1.0, v189
    v_add_f32 v190, 1.0, v190
    v_add_f32 v191, 1.0, v191
    v_mfma_f32_32x32x16_bf16 v[56:71], a[120:123], v[80:83], v[56:71]
    v_rcp_f32 v184, v184
    v_rcp_f32 v185, v185
    v_rcp_f32 v186, v186
    v_rcp_f32 v187, v187
    v_rcp_f32 v188, v188
    v_rcp_f32 v189, v189
    v_rcp_f32 v190, v190
    s_waitcnt lgkmcnt(1)
    v_mfma_f32_32x32x16_bf16 v[40:55], a[60:63], v[84:87], v[40:55]
    v_rcp_f32 v191, v191
    v_fma_f32 v184, v184, -2.0, 1.0
    v_fma_f32 v185, v185, -2.0, 1.0
    v_fma_f32 v186, v186, -2.0, 1.0
    v_fma_f32 v187, v187, -2.0, 1.0
    v_fma_f32 v188, v188, -2.0, 1.0
    v_fma_f32 v189, v189, -2.0, 1.0
    v_mfma_f32_32x32x16_bf16 v[56:71], a[124:127], v[84:87], v[56:71]
    v_fma_f32 v190, v190, -2.0, 1.0
    v_fma_f32 v191, v191, -2.0, 1.0
    v_cvt_pk_bf16_f32 v204, v184, v185
    v_cvt_pk_bf16_f32 v205, v186, v187
    v_cvt_pk_bf16_f32 v206, v188, v189
    v_cvt_pk_bf16_f32 v207, v190, v191
    ds_write_b128 v2, v[204:207] offset:3072
    s_waitcnt lgkmcnt(0)
    s_barrier
    ds_read_b128 v[72:75], v3 offset:0
    ds_read_b128 v[76:79], v3 offset:1024
    ds_read_b128 v[80:83], v3 offset:2048
    ds_read_b128 v[84:87], v3 offset:3072
    s_waitcnt lgkmcnt(3)
    v_mfma_f32_32x32x16_bf16 v[8:23], a[0:3], v[72:75], 0
    ds_read_b128 v[88:91], v3 offset:4096
    ds_read_b128 v[128:131], v4 offset:3072
    ds_read_b128 v[132:135], v4 offset:3104
    ds_read_b128 v[136:139], v4 offset:3136
    ds_read_b128 v[140:143], v4 offset:3168
    v_mfma_f32_32x32x16_bf16 v[24:39], a[64:67], v[72:75], 0
    ds_read_b128 v[144:147], v4 offset:3200
    ds_read_b128 v[148:151], v4 offset:3232
    ds_read_b128 v[152:155], v4 offset:3264
    ds_read_b128 v[156:159], v4 offset:3296
    s_waitcnt lgkmcnt(11)
    v_mfma_f32_32x32x16_bf16 v[8:23], a[4:7], v[76:79], v[8:23]
    ds_read_b128 v[92:95], v3 offset:5120
    v_cvt_pk_bf16_f32 v208, v40, v41
    v_cvt_pk_bf16_f32 v209, v42, v43
    v_cvt_pk_bf16_f32 v210, v44, v45
    v_cvt_pk_bf16_f32 v211, v46, v47
    v_cvt_pk_bf16_f32 v212, v48, v49
    v_cvt_pk_bf16_f32 v213, v50, v51
    v_cvt_pk_bf16_f32 v214, v52, v53
    v_cvt_pk_bf16_f32 v215, v54, v55
    v_mfma_f32_32x32x16_bf16 v[24:39], a[68:71], v[76:79], v[24:39]
    s_nop 1
    v_permlane16_swap_b32 v208, v212
    v_permlane16_swap_b32 v209, v213
    v_permlane16_swap_b32 v210, v214
    v_permlane16_swap_b32 v211, v215
    buffer_store_dwordx4 v[208:211], v6, s[16:19], 0 offen offset:512
    buffer_store_dwordx4 v[212:215], v7, s[16:19], 0 offen offset:512
    s_waitcnt lgkmcnt(11)
    v_mfma_f32_32x32x16_bf16 v[8:23], a[8:11], v[80:83], v[8:23]
    ds_read_b128 v[72:75], v3 offset:6144
    v_cvt_pk_bf16_f32 v216, v56, v57
    v_cvt_pk_bf16_f32 v217, v58, v59
    v_cvt_pk_bf16_f32 v218, v60, v61
    v_cvt_pk_bf16_f32 v219, v62, v63
    v_cvt_pk_bf16_f32 v220, v64, v65
    v_cvt_pk_bf16_f32 v221, v66, v67
    v_cvt_pk_bf16_f32 v222, v68, v69
    v_mfma_f32_32x32x16_bf16 v[24:39], a[72:75], v[80:83], v[24:39]
    v_cvt_pk_bf16_f32 v223, v70, v71
    s_nop 1
    v_permlane16_swap_b32 v216, v220
    v_permlane16_swap_b32 v217, v221
    v_permlane16_swap_b32 v218, v222
    v_permlane16_swap_b32 v219, v223
    buffer_store_dwordx4 v[216:219], v6, s[16:19], 0 offen offset:576
    s_waitcnt lgkmcnt(11)
    v_mfma_f32_32x32x16_bf16 v[8:23], a[12:15], v[84:87], v[8:23]
    ds_read_b128 v[76:79], v3 offset:7168
    buffer_store_dwordx4 v[220:223], v7, s[16:19], 0 offen offset:576
    s_waitcnt lgkmcnt(3)
    v_add_f32 v160, v96, v128
    v_add_f32 v161, v97, v129
    v_add_f32 v162, v98, v130
    v_add_f32 v163, v99, v131
    v_add_f32 v164, v100, v132
    v_mfma_f32_32x32x16_bf16 v[24:39], a[76:79], v[84:87], v[24:39]
    v_add_f32 v165, v101, v133
    v_add_f32 v166, v102, v134
    v_add_f32 v167, v103, v135
    v_exp_f32 v160, v160
    v_exp_f32 v161, v161
    v_exp_f32 v162, v162
    v_exp_f32 v163, v163
    v_mfma_f32_32x32x16_bf16 v[8:23], a[16:19], v[88:91], v[8:23]
    ds_read_b128 v[80:83], v3 offset:8192
    v_exp_f32 v164, v164
    v_exp_f32 v165, v165
    v_exp_f32 v166, v166
    v_exp_f32 v167, v167
    v_add_f32 v160, 1.0, v160
    v_add_f32 v161, 1.0, v161
    v_add_f32 v162, 1.0, v162
    v_mfma_f32_32x32x16_bf16 v[24:39], a[80:83], v[88:91], v[24:39]
    v_add_f32 v163, 1.0, v163
    v_add_f32 v164, 1.0, v164
    v_add_f32 v165, 1.0, v165
    v_add_f32 v166, 1.0, v166
    v_add_f32 v167, 1.0, v167
    v_rcp_f32 v160, v160
    v_rcp_f32 v161, v161
    s_waitcnt lgkmcnt(3)
    v_mfma_f32_32x32x16_bf16 v[8:23], a[20:23], v[92:95], v[8:23]
    ds_read_b128 v[84:87], v3 offset:9216
    v_rcp_f32 v162, v162
    v_rcp_f32 v163, v163
    v_rcp_f32 v164, v164
    v_rcp_f32 v165, v165
    v_rcp_f32 v166, v166
    v_rcp_f32 v167, v167
    v_fma_f32 v160, v160, -2.0, 1.0
    v_mfma_f32_32x32x16_bf16 v[24:39], a[84:87], v[92:95], v[24:39]
    v_fma_f32 v161, v161, -2.0, 1.0
    v_fma_f32 v162, v162, -2.0, 1.0
    v_fma_f32 v163, v163, -2.0, 1.0
    v_fma_f32 v164, v164, -2.0, 1.0
    v_fma_f32 v165, v165, -2.0, 1.0
    v_fma_f32 v166, v166, -2.0, 1.0
    v_fma_f32 v167, v167, -2.0, 1.0
    s_waitcnt lgkmcnt(3)
    v_mfma_f32_32x32x16_bf16 v[8:23], a[24:27], v[72:75], v[8:23]
    ds_read_b128 v[88:91], v3 offset:10240
    v_cvt_pk_bf16_f32 v192, v160, v161
    v_cvt_pk_bf16_f32 v193, v162, v163
    v_cvt_pk_bf16_f32 v194, v164, v165
    v_cvt_pk_bf16_f32 v195, v166, v167
    ds_write_b128 v2, v[192:195] offset:16384
    v_add_f32 v168, v104, v136
    v_add_f32 v169, v105, v137
    v_mfma_f32_32x32x16_bf16 v[24:39], a[88:91], v[72:75], v[24:39]
    v_add_f32 v170, v106, v138
    v_add_f32 v171, v107, v139
    v_add_f32 v172, v108, v140
    v_add_f32 v173, v109, v141
    v_add_f32 v174, v110, v142
    v_add_f32 v175, v111, v143
    v_exp_f32 v168, v168
    s_waitcnt lgkmcnt(4)
    v_mfma_f32_32x32x16_bf16 v[8:23], a[28:31], v[76:79], v[8:23]
    ds_read_b128 v[92:95], v3 offset:11264
    v_exp_f32 v169, v169
    v_exp_f32 v170, v170
    v_exp_f32 v171, v171
    v_exp_f32 v172, v172
    v_exp_f32 v173, v173
    v_exp_f32 v174, v174
    v_exp_f32 v175, v175
    v_mfma_f32_32x32x16_bf16 v[24:39], a[92:95], v[76:79], v[24:39]
    v_add_f32 v168, 1.0, v168
    v_add_f32 v169, 1.0, v169
    v_add_f32 v170, 1.0, v170
    v_add_f32 v171, 1.0, v171
    v_add_f32 v172, 1.0, v172
    v_add_f32 v173, 1.0, v173
    v_add_f32 v174, 1.0, v174
    s_waitcnt lgkmcnt(4)
    v_mfma_f32_32x32x16_bf16 v[8:23], a[32:35], v[80:83], v[8:23]
    ds_read_b128 v[72:75], v3 offset:12288
    v_add_f32 v175, 1.0, v175
    v_rcp_f32 v168, v168
    v_rcp_f32 v169, v169
    v_rcp_f32 v170, v170
    v_rcp_f32 v171, v171
    v_rcp_f32 v172, v172
    v_rcp_f32 v173, v173
    v_mfma_f32_32x32x16_bf16 v[24:39], a[96:99], v[80:83], v[24:39]
    v_rcp_f32 v174, v174
    v_rcp_f32 v175, v175
    v_fma_f32 v168, v168, -2.0, 1.0
    v_fma_f32 v169, v169, -2.0, 1.0
    v_fma_f32 v170, v170, -2.0, 1.0
    v_fma_f32 v171, v171, -2.0, 1.0
    v_fma_f32 v172, v172, -2.0, 1.0
    s_waitcnt lgkmcnt(4)
    v_mfma_f32_32x32x16_bf16 v[8:23], a[36:39], v[84:87], v[8:23]
    ds_read_b128 v[76:79], v3 offset:13312
    v_fma_f32 v173, v173, -2.0, 1.0
    v_fma_f32 v174, v174, -2.0, 1.0
    v_fma_f32 v175, v175, -2.0, 1.0
    v_cvt_pk_bf16_f32 v196, v168, v169
    v_cvt_pk_bf16_f32 v197, v170, v171
    v_cvt_pk_bf16_f32 v198, v172, v173
    v_cvt_pk_bf16_f32 v199, v174, v175
    v_mfma_f32_32x32x16_bf16 v[24:39], a[100:103], v[84:87], v[24:39]
    ds_write_b128 v2, v[196:199] offset:17408
    v_add_f32 v176, v112, v144
    v_add_f32 v177, v113, v145
    v_add_f32 v178, v114, v146
    v_add_f32 v179, v115, v147
    v_add_f32 v180, v116, v148
    v_add_f32 v181, v117, v149
    s_waitcnt lgkmcnt(5)
    v_mfma_f32_32x32x16_bf16 v[8:23], a[40:43], v[88:91], v[8:23]
    ds_read_b128 v[80:83], v3 offset:14336
    v_add_f32 v182, v118, v150
    v_add_f32 v183, v119, v151
    v_exp_f32 v176, v176
    v_exp_f32 v177, v177
    v_exp_f32 v178, v178
    v_exp_f32 v179, v179
    v_exp_f32 v180, v180
    v_mfma_f32_32x32x16_bf16 v[24:39], a[104:107], v[88:91], v[24:39]
    v_exp_f32 v181, v181
    v_exp_f32 v182, v182
    v_exp_f32 v183, v183
    v_add_f32 v176, 1.0, v176
    v_add_f32 v177, 1.0, v177
    v_add_f32 v178, 1.0, v178
    v_add_f32 v179, 1.0, v179
    s_waitcnt lgkmcnt(4)
    v_mfma_f32_32x32x16_bf16 v[8:23], a[44:47], v[92:95], v[8:23]
    ds_read_b128 v[84:87], v3 offset:15360
    v_add_f32 v180, 1.0, v180
    v_add_f32 v181, 1.0, v181
    v_add_f32 v182, 1.0, v182
    v_add_f32 v183, 1.0, v183
    v_rcp_f32 v176, v176
    v_rcp_f32 v177, v177
    v_rcp_f32 v178, v178
    v_mfma_f32_32x32x16_bf16 v[24:39], a[108:111], v[92:95], v[24:39]
    v_rcp_f32 v179, v179
    v_rcp_f32 v180, v180
    v_rcp_f32 v181, v181
    v_rcp_f32 v182, v182
    v_rcp_f32 v183, v183
    v_fma_f32 v176, v176, -2.0, 1.0
    v_fma_f32 v177, v177, -2.0, 1.0
    s_waitcnt lgkmcnt(4)
    v_mfma_f32_32x32x16_bf16 v[8:23], a[48:51], v[72:75], v[8:23]
    v_fma_f32 v178, v178, -2.0, 1.0
    v_fma_f32 v179, v179, -2.0, 1.0
    v_fma_f32 v180, v180, -2.0, 1.0
    v_fma_f32 v181, v181, -2.0, 1.0
    v_fma_f32 v182, v182, -2.0, 1.0
    v_fma_f32 v183, v183, -2.0, 1.0
    v_cvt_pk_bf16_f32 v200, v176, v177
    v_mfma_f32_32x32x16_bf16 v[24:39], a[112:115], v[72:75], v[24:39]
    v_cvt_pk_bf16_f32 v201, v178, v179
    v_cvt_pk_bf16_f32 v202, v180, v181
    v_cvt_pk_bf16_f32 v203, v182, v183
    ds_write_b128 v2, v[200:203] offset:18432
    v_add_f32 v184, v120, v152
    v_add_f32 v185, v121, v153
    v_add_f32 v186, v122, v154
    s_waitcnt lgkmcnt(4)
    v_mfma_f32_32x32x16_bf16 v[8:23], a[52:55], v[76:79], v[8:23]
    v_add_f32 v187, v123, v155
    v_add_f32 v188, v124, v156
    v_add_f32 v189, v125, v157
    v_add_f32 v190, v126, v158
    v_add_f32 v191, v127, v159
    v_exp_f32 v184, v184
    v_exp_f32 v185, v185
    v_mfma_f32_32x32x16_bf16 v[24:39], a[116:119], v[76:79], v[24:39]
    v_exp_f32 v186, v186
    v_exp_f32 v187, v187
    v_exp_f32 v188, v188
    v_exp_f32 v189, v189
    v_exp_f32 v190, v190
    v_exp_f32 v191, v191
    v_add_f32 v184, 1.0, v184
    s_waitcnt lgkmcnt(2)
    v_mfma_f32_32x32x16_bf16 v[8:23], a[56:59], v[80:83], v[8:23]
    v_add_f32 v185, 1.0, v185
    v_add_f32 v186, 1.0, v186
    v_add_f32 v187, 1.0, v187
    v_add_f32 v188, 1.0, v188
    v_add_f32 v189, 1.0, v189
    v_add_f32 v190, 1.0, v190
    v_add_f32 v191, 1.0, v191
    v_mfma_f32_32x32x16_bf16 v[24:39], a[120:123], v[80:83], v[24:39]
    v_rcp_f32 v184, v184
    v_rcp_f32 v185, v185
    v_rcp_f32 v186, v186
    v_rcp_f32 v187, v187
    v_rcp_f32 v188, v188
    v_rcp_f32 v189, v189
    v_rcp_f32 v190, v190
    s_waitcnt lgkmcnt(1)
    v_mfma_f32_32x32x16_bf16 v[8:23], a[60:63], v[84:87], v[8:23]
    v_rcp_f32 v191, v191
    v_fma_f32 v184, v184, -2.0, 1.0
    v_fma_f32 v185, v185, -2.0, 1.0
    v_fma_f32 v186, v186, -2.0, 1.0
    v_fma_f32 v187, v187, -2.0, 1.0
    v_fma_f32 v188, v188, -2.0, 1.0
    v_fma_f32 v189, v189, -2.0, 1.0
    v_mfma_f32_32x32x16_bf16 v[24:39], a[124:127], v[84:87], v[24:39]
    v_fma_f32 v190, v190, -2.0, 1.0
    v_fma_f32 v191, v191, -2.0, 1.0
    v_cvt_pk_bf16_f32 v204, v184, v185
    v_cvt_pk_bf16_f32 v205, v186, v187
    v_cvt_pk_bf16_f32 v206, v188, v189
    v_cvt_pk_bf16_f32 v207, v190, v191
    ds_write_b128 v2, v[204:207] offset:19456
    s_waitcnt lgkmcnt(0)
    s_barrier
    ds_read_b128 v[72:75], v3 offset:16384
    ds_read_b128 v[76:79], v3 offset:17408
    ds_read_b128 v[80:83], v3 offset:18432
    ds_read_b128 v[84:87], v3 offset:19456
    s_waitcnt lgkmcnt(3)
    v_mfma_f32_32x32x16_bf16 v[40:55], a[0:3], v[72:75], 0
    ds_read_b128 v[88:91], v3 offset:20480
    ds_read_b128 v[128:131], v4 offset:4096
    ds_read_b128 v[132:135], v4 offset:4128
    ds_read_b128 v[136:139], v4 offset:4160
    ds_read_b128 v[140:143], v4 offset:4192
    v_mfma_f32_32x32x16_bf16 v[56:71], a[64:67], v[72:75], 0
    ds_read_b128 v[144:147], v4 offset:4224
    ds_read_b128 v[148:151], v4 offset:4256
    ds_read_b128 v[152:155], v4 offset:4288
    ds_read_b128 v[156:159], v4 offset:4320
    s_waitcnt lgkmcnt(11)
    v_mfma_f32_32x32x16_bf16 v[40:55], a[4:7], v[76:79], v[40:55]
    ds_read_b128 v[92:95], v3 offset:21504
    v_cvt_pk_bf16_f32 v208, v8, v9
    v_cvt_pk_bf16_f32 v209, v10, v11
    v_cvt_pk_bf16_f32 v210, v12, v13
    v_cvt_pk_bf16_f32 v211, v14, v15
    v_cvt_pk_bf16_f32 v212, v16, v17
    v_cvt_pk_bf16_f32 v213, v18, v19
    v_cvt_pk_bf16_f32 v214, v20, v21
    v_cvt_pk_bf16_f32 v215, v22, v23
    v_mfma_f32_32x32x16_bf16 v[56:71], a[68:71], v[76:79], v[56:71]
    s_nop 1
    v_permlane16_swap_b32 v208, v212
    v_permlane16_swap_b32 v209, v213
    v_permlane16_swap_b32 v210, v214
    v_permlane16_swap_b32 v211, v215
    buffer_store_dwordx4 v[208:211], v6, s[16:19], 0 offen offset:1024
    buffer_store_dwordx4 v[212:215], v7, s[16:19], 0 offen offset:1024
    s_waitcnt lgkmcnt(11)
    v_mfma_f32_32x32x16_bf16 v[40:55], a[8:11], v[80:83], v[40:55]
    ds_read_b128 v[72:75], v3 offset:22528
    v_cvt_pk_bf16_f32 v216, v24, v25
    v_cvt_pk_bf16_f32 v217, v26, v27
    v_cvt_pk_bf16_f32 v218, v28, v29
    v_cvt_pk_bf16_f32 v219, v30, v31
    v_cvt_pk_bf16_f32 v220, v32, v33
    v_cvt_pk_bf16_f32 v221, v34, v35
    v_cvt_pk_bf16_f32 v222, v36, v37
    v_mfma_f32_32x32x16_bf16 v[56:71], a[72:75], v[80:83], v[56:71]
    v_cvt_pk_bf16_f32 v223, v38, v39
    s_nop 1
    v_permlane16_swap_b32 v216, v220
    v_permlane16_swap_b32 v217, v221
    v_permlane16_swap_b32 v218, v222
    v_permlane16_swap_b32 v219, v223
    buffer_store_dwordx4 v[216:219], v6, s[16:19], 0 offen offset:1088
    s_waitcnt lgkmcnt(11)
    v_mfma_f32_32x32x16_bf16 v[40:55], a[12:15], v[84:87], v[40:55]
    ds_read_b128 v[76:79], v3 offset:23552
    buffer_store_dwordx4 v[220:223], v7, s[16:19], 0 offen offset:1088
    s_waitcnt lgkmcnt(3)
    v_add_f32 v160, v96, v128
    v_add_f32 v161, v97, v129
    v_add_f32 v162, v98, v130
    v_add_f32 v163, v99, v131
    v_add_f32 v164, v100, v132
    v_mfma_f32_32x32x16_bf16 v[56:71], a[76:79], v[84:87], v[56:71]
    v_add_f32 v165, v101, v133
    v_add_f32 v166, v102, v134
    v_add_f32 v167, v103, v135
    v_exp_f32 v160, v160
    v_exp_f32 v161, v161
    v_exp_f32 v162, v162
    v_exp_f32 v163, v163
    v_mfma_f32_32x32x16_bf16 v[40:55], a[16:19], v[88:91], v[40:55]
    ds_read_b128 v[80:83], v3 offset:24576
    v_exp_f32 v164, v164
    v_exp_f32 v165, v165
    v_exp_f32 v166, v166
    v_exp_f32 v167, v167
    v_add_f32 v160, 1.0, v160
    v_add_f32 v161, 1.0, v161
    v_add_f32 v162, 1.0, v162
    v_mfma_f32_32x32x16_bf16 v[56:71], a[80:83], v[88:91], v[56:71]
    v_add_f32 v163, 1.0, v163
    v_add_f32 v164, 1.0, v164
    v_add_f32 v165, 1.0, v165
    v_add_f32 v166, 1.0, v166
    v_add_f32 v167, 1.0, v167
    v_rcp_f32 v160, v160
    v_rcp_f32 v161, v161
    s_waitcnt lgkmcnt(3)
    v_mfma_f32_32x32x16_bf16 v[40:55], a[20:23], v[92:95], v[40:55]
    ds_read_b128 v[84:87], v3 offset:25600
    v_rcp_f32 v162, v162
    v_rcp_f32 v163, v163
    v_rcp_f32 v164, v164
    v_rcp_f32 v165, v165
    v_rcp_f32 v166, v166
    v_rcp_f32 v167, v167
    v_fma_f32 v160, v160, -2.0, 1.0
    v_mfma_f32_32x32x16_bf16 v[56:71], a[84:87], v[92:95], v[56:71]
    v_fma_f32 v161, v161, -2.0, 1.0
    v_fma_f32 v162, v162, -2.0, 1.0
    v_fma_f32 v163, v163, -2.0, 1.0
    v_fma_f32 v164, v164, -2.0, 1.0
    v_fma_f32 v165, v165, -2.0, 1.0
    v_fma_f32 v166, v166, -2.0, 1.0
    v_fma_f32 v167, v167, -2.0, 1.0
    s_waitcnt lgkmcnt(3)
    v_mfma_f32_32x32x16_bf16 v[40:55], a[24:27], v[72:75], v[40:55]
    ds_read_b128 v[88:91], v3 offset:26624
    v_cvt_pk_bf16_f32 v192, v160, v161
    v_cvt_pk_bf16_f32 v193, v162, v163
    v_cvt_pk_bf16_f32 v194, v164, v165
    v_cvt_pk_bf16_f32 v195, v166, v167
    ds_write_b128 v2, v[192:195] offset:0
    v_add_f32 v168, v104, v136
    v_add_f32 v169, v105, v137
    v_mfma_f32_32x32x16_bf16 v[56:71], a[88:91], v[72:75], v[56:71]
    v_add_f32 v170, v106, v138
    v_add_f32 v171, v107, v139
    v_add_f32 v172, v108, v140
    v_add_f32 v173, v109, v141
    v_add_f32 v174, v110, v142
    v_add_f32 v175, v111, v143
    v_exp_f32 v168, v168
    s_waitcnt lgkmcnt(4)
    v_mfma_f32_32x32x16_bf16 v[40:55], a[28:31], v[76:79], v[40:55]
    ds_read_b128 v[92:95], v3 offset:27648
    v_exp_f32 v169, v169
    v_exp_f32 v170, v170
    v_exp_f32 v171, v171
    v_exp_f32 v172, v172
    v_exp_f32 v173, v173
    v_exp_f32 v174, v174
    v_exp_f32 v175, v175
    v_mfma_f32_32x32x16_bf16 v[56:71], a[92:95], v[76:79], v[56:71]
    v_add_f32 v168, 1.0, v168
    v_add_f32 v169, 1.0, v169
    v_add_f32 v170, 1.0, v170
    v_add_f32 v171, 1.0, v171
    v_add_f32 v172, 1.0, v172
    v_add_f32 v173, 1.0, v173
    v_add_f32 v174, 1.0, v174
    s_waitcnt lgkmcnt(4)
    v_mfma_f32_32x32x16_bf16 v[40:55], a[32:35], v[80:83], v[40:55]
    ds_read_b128 v[72:75], v3 offset:28672
    v_add_f32 v175, 1.0, v175
    v_rcp_f32 v168, v168
    v_rcp_f32 v169, v169
    v_rcp_f32 v170, v170
    v_rcp_f32 v171, v171
    v_rcp_f32 v172, v172
    v_rcp_f32 v173, v173
    v_mfma_f32_32x32x16_bf16 v[56:71], a[96:99], v[80:83], v[56:71]
    v_rcp_f32 v174, v174
    v_rcp_f32 v175, v175
    v_fma_f32 v168, v168, -2.0, 1.0
    v_fma_f32 v169, v169, -2.0, 1.0
    v_fma_f32 v170, v170, -2.0, 1.0
    v_fma_f32 v171, v171, -2.0, 1.0
    v_fma_f32 v172, v172, -2.0, 1.0
    s_waitcnt lgkmcnt(4)
    v_mfma_f32_32x32x16_bf16 v[40:55], a[36:39], v[84:87], v[40:55]
    ds_read_b128 v[76:79], v3 offset:29696
    v_fma_f32 v173, v173, -2.0, 1.0
    v_fma_f32 v174, v174, -2.0, 1.0
    v_fma_f32 v175, v175, -2.0, 1.0
    v_cvt_pk_bf16_f32 v196, v168, v169
    v_cvt_pk_bf16_f32 v197, v170, v171
    v_cvt_pk_bf16_f32 v198, v172, v173
    v_cvt_pk_bf16_f32 v199, v174, v175
    v_mfma_f32_32x32x16_bf16 v[56:71], a[100:103], v[84:87], v[56:71]
    ds_write_b128 v2, v[196:199] offset:1024
    v_add_f32 v176, v112, v144
    v_add_f32 v177, v113, v145
    v_add_f32 v178, v114, v146
    v_add_f32 v179, v115, v147
    v_add_f32 v180, v116, v148
    v_add_f32 v181, v117, v149
    s_waitcnt lgkmcnt(5)
    v_mfma_f32_32x32x16_bf16 v[40:55], a[40:43], v[88:91], v[40:55]
    ds_read_b128 v[80:83], v3 offset:30720
    v_add_f32 v182, v118, v150
    v_add_f32 v183, v119, v151
    v_exp_f32 v176, v176
    v_exp_f32 v177, v177
    v_exp_f32 v178, v178
    v_exp_f32 v179, v179
    v_exp_f32 v180, v180
    v_mfma_f32_32x32x16_bf16 v[56:71], a[104:107], v[88:91], v[56:71]
    v_exp_f32 v181, v181
    v_exp_f32 v182, v182
    v_exp_f32 v183, v183
    v_add_f32 v176, 1.0, v176
    v_add_f32 v177, 1.0, v177
    v_add_f32 v178, 1.0, v178
    v_add_f32 v179, 1.0, v179
    s_waitcnt lgkmcnt(4)
    v_mfma_f32_32x32x16_bf16 v[40:55], a[44:47], v[92:95], v[40:55]
    ds_read_b128 v[84:87], v3 offset:31744
    v_add_f32 v180, 1.0, v180
    v_add_f32 v181, 1.0, v181
    v_add_f32 v182, 1.0, v182
    v_add_f32 v183, 1.0, v183
    v_rcp_f32 v176, v176
    v_rcp_f32 v177, v177
    v_rcp_f32 v178, v178
    v_mfma_f32_32x32x16_bf16 v[56:71], a[108:111], v[92:95], v[56:71]
    v_rcp_f32 v179, v179
    v_rcp_f32 v180, v180
    v_rcp_f32 v181, v181
    v_rcp_f32 v182, v182
    v_rcp_f32 v183, v183
    v_fma_f32 v176, v176, -2.0, 1.0
    v_fma_f32 v177, v177, -2.0, 1.0
    s_waitcnt lgkmcnt(4)
    v_mfma_f32_32x32x16_bf16 v[40:55], a[48:51], v[72:75], v[40:55]
    v_fma_f32 v178, v178, -2.0, 1.0
    v_fma_f32 v179, v179, -2.0, 1.0
    v_fma_f32 v180, v180, -2.0, 1.0
    v_fma_f32 v181, v181, -2.0, 1.0
    v_fma_f32 v182, v182, -2.0, 1.0
    v_fma_f32 v183, v183, -2.0, 1.0
    v_cvt_pk_bf16_f32 v200, v176, v177
    v_mfma_f32_32x32x16_bf16 v[56:71], a[112:115], v[72:75], v[56:71]
    v_cvt_pk_bf16_f32 v201, v178, v179
    v_cvt_pk_bf16_f32 v202, v180, v181
    v_cvt_pk_bf16_f32 v203, v182, v183
    ds_write_b128 v2, v[200:203] offset:2048
    v_add_f32 v184, v120, v152
    v_add_f32 v185, v121, v153
    v_add_f32 v186, v122, v154
    s_waitcnt lgkmcnt(4)
    v_mfma_f32_32x32x16_bf16 v[40:55], a[52:55], v[76:79], v[40:55]
    v_add_f32 v187, v123, v155
    v_add_f32 v188, v124, v156
    v_add_f32 v189, v125, v157
    v_add_f32 v190, v126, v158
    v_add_f32 v191, v127, v159
    v_exp_f32 v184, v184
    v_exp_f32 v185, v185
    v_mfma_f32_32x32x16_bf16 v[56:71], a[116:119], v[76:79], v[56:71]
    v_exp_f32 v186, v186
    v_exp_f32 v187, v187
    v_exp_f32 v188, v188
    v_exp_f32 v189, v189
    v_exp_f32 v190, v190
    v_exp_f32 v191, v191
    v_add_f32 v184, 1.0, v184
    s_waitcnt lgkmcnt(2)
    v_mfma_f32_32x32x16_bf16 v[40:55], a[56:59], v[80:83], v[40:55]
    v_add_f32 v185, 1.0, v185
    v_add_f32 v186, 1.0, v186
    v_add_f32 v187, 1.0, v187
    v_add_f32 v188, 1.0, v188
    v_add_f32 v189, 1.0, v189
    v_add_f32 v190, 1.0, v190
    v_add_f32 v191, 1.0, v191
    v_mfma_f32_32x32x16_bf16 v[56:71], a[120:123], v[80:83], v[56:71]
    v_rcp_f32 v184, v184
    v_rcp_f32 v185, v185
    v_rcp_f32 v186, v186
    v_rcp_f32 v187, v187
    v_rcp_f32 v188, v188
    v_rcp_f32 v189, v189
    v_rcp_f32 v190, v190
    s_waitcnt lgkmcnt(1)
    v_mfma_f32_32x32x16_bf16 v[40:55], a[60:63], v[84:87], v[40:55]
    v_rcp_f32 v191, v191
    v_fma_f32 v184, v184, -2.0, 1.0
    v_fma_f32 v185, v185, -2.0, 1.0
    v_fma_f32 v186, v186, -2.0, 1.0
    v_fma_f32 v187, v187, -2.0, 1.0
    v_fma_f32 v188, v188, -2.0, 1.0
    v_fma_f32 v189, v189, -2.0, 1.0
    v_mfma_f32_32x32x16_bf16 v[56:71], a[124:127], v[84:87], v[56:71]
    v_fma_f32 v190, v190, -2.0, 1.0
    v_fma_f32 v191, v191, -2.0, 1.0
    v_cvt_pk_bf16_f32 v204, v184, v185
    v_cvt_pk_bf16_f32 v205, v186, v187
    v_cvt_pk_bf16_f32 v206, v188, v189
    v_cvt_pk_bf16_f32 v207, v190, v191
    ds_write_b128 v2, v[204:207] offset:3072
    s_waitcnt lgkmcnt(0)
    s_barrier
    ds_read_b128 v[72:75], v3 offset:0
    ds_read_b128 v[76:79], v3 offset:1024
    ds_read_b128 v[80:83], v3 offset:2048
    ds_read_b128 v[84:87], v3 offset:3072
    s_waitcnt lgkmcnt(3)
    v_mfma_f32_32x32x16_bf16 v[8:23], a[0:3], v[72:75], 0
    ds_read_b128 v[88:91], v3 offset:4096
    ds_read_b128 v[128:131], v4 offset:5120
    ds_read_b128 v[132:135], v4 offset:5152
    ds_read_b128 v[136:139], v4 offset:5184
    ds_read_b128 v[140:143], v4 offset:5216
    v_mfma_f32_32x32x16_bf16 v[24:39], a[64:67], v[72:75], 0
    ds_read_b128 v[144:147], v4 offset:5248
    ds_read_b128 v[148:151], v4 offset:5280
    ds_read_b128 v[152:155], v4 offset:5312
    ds_read_b128 v[156:159], v4 offset:5344
    s_waitcnt lgkmcnt(11)
    v_mfma_f32_32x32x16_bf16 v[8:23], a[4:7], v[76:79], v[8:23]
    ds_read_b128 v[92:95], v3 offset:5120
    v_cvt_pk_bf16_f32 v208, v40, v41
    v_cvt_pk_bf16_f32 v209, v42, v43
    v_cvt_pk_bf16_f32 v210, v44, v45
    v_cvt_pk_bf16_f32 v211, v46, v47
    v_cvt_pk_bf16_f32 v212, v48, v49
    v_cvt_pk_bf16_f32 v213, v50, v51
    v_cvt_pk_bf16_f32 v214, v52, v53
    v_cvt_pk_bf16_f32 v215, v54, v55
    v_mfma_f32_32x32x16_bf16 v[24:39], a[68:71], v[76:79], v[24:39]
    s_nop 1
    v_permlane16_swap_b32 v208, v212
    v_permlane16_swap_b32 v209, v213
    v_permlane16_swap_b32 v210, v214
    v_permlane16_swap_b32 v211, v215
    buffer_store_dwordx4 v[208:211], v6, s[16:19], 0 offen offset:1536
    buffer_store_dwordx4 v[212:215], v7, s[16:19], 0 offen offset:1536
    s_waitcnt lgkmcnt(11)
    v_mfma_f32_32x32x16_bf16 v[8:23], a[8:11], v[80:83], v[8:23]
    ds_read_b128 v[72:75], v3 offset:6144
    v_cvt_pk_bf16_f32 v216, v56, v57
    v_cvt_pk_bf16_f32 v217, v58, v59
    v_cvt_pk_bf16_f32 v218, v60, v61
    v_cvt_pk_bf16_f32 v219, v62, v63
    v_cvt_pk_bf16_f32 v220, v64, v65
    v_cvt_pk_bf16_f32 v221, v66, v67
    v_cvt_pk_bf16_f32 v222, v68, v69
    v_mfma_f32_32x32x16_bf16 v[24:39], a[72:75], v[80:83], v[24:39]
    v_cvt_pk_bf16_f32 v223, v70, v71
    s_nop 1
    v_permlane16_swap_b32 v216, v220
    v_permlane16_swap_b32 v217, v221
    v_permlane16_swap_b32 v218, v222
    v_permlane16_swap_b32 v219, v223
    buffer_store_dwordx4 v[216:219], v6, s[16:19], 0 offen offset:1600
    s_waitcnt lgkmcnt(11)
    v_mfma_f32_32x32x16_bf16 v[8:23], a[12:15], v[84:87], v[8:23]
    ds_read_b128 v[76:79], v3 offset:7168
    buffer_store_dwordx4 v[220:223], v7, s[16:19], 0 offen offset:1600
    s_waitcnt lgkmcnt(3)
    v_add_f32 v160, v96, v128
    v_add_f32 v161, v97, v129
    v_add_f32 v162, v98, v130
    v_add_f32 v163, v99, v131
    v_add_f32 v164, v100, v132
    v_mfma_f32_32x32x16_bf16 v[24:39], a[76:79], v[84:87], v[24:39]
    v_add_f32 v165, v101, v133
    v_add_f32 v166, v102, v134
    v_add_f32 v167, v103, v135
    v_exp_f32 v160, v160
    v_exp_f32 v161, v161
    v_exp_f32 v162, v162
    v_exp_f32 v163, v163
    v_mfma_f32_32x32x16_bf16 v[8:23], a[16:19], v[88:91], v[8:23]
    ds_read_b128 v[80:83], v3 offset:8192
    v_exp_f32 v164, v164
    v_exp_f32 v165, v165
    v_exp_f32 v166, v166
    v_exp_f32 v167, v167
    v_add_f32 v160, 1.0, v160
    v_add_f32 v161, 1.0, v161
    v_add_f32 v162, 1.0, v162
    v_mfma_f32_32x32x16_bf16 v[24:39], a[80:83], v[88:91], v[24:39]
    v_add_f32 v163, 1.0, v163
    v_add_f32 v164, 1.0, v164
    v_add_f32 v165, 1.0, v165
    v_add_f32 v166, 1.0, v166
    v_add_f32 v167, 1.0, v167
    v_rcp_f32 v160, v160
    v_rcp_f32 v161, v161
    s_waitcnt lgkmcnt(3)
    v_mfma_f32_32x32x16_bf16 v[8:23], a[20:23], v[92:95], v[8:23]
    ds_read_b128 v[84:87], v3 offset:9216
    v_rcp_f32 v162, v162
    v_rcp_f32 v163, v163
    v_rcp_f32 v164, v164
    v_rcp_f32 v165, v165
    v_rcp_f32 v166, v166
    v_rcp_f32 v167, v167
    v_fma_f32 v160, v160, -2.0, 1.0
    v_mfma_f32_32x32x16_bf16 v[24:39], a[84:87], v[92:95], v[24:39]
    v_fma_f32 v161, v161, -2.0, 1.0
    v_fma_f32 v162, v162, -2.0, 1.0
    v_fma_f32 v163, v163, -2.0, 1.0
    v_fma_f32 v164, v164, -2.0, 1.0
    v_fma_f32 v165, v165, -2.0, 1.0
    v_fma_f32 v166, v166, -2.0, 1.0
    v_fma_f32 v167, v167, -2.0, 1.0
    s_waitcnt lgkmcnt(3)
    v_mfma_f32_32x32x16_bf16 v[8:23], a[24:27], v[72:75], v[8:23]
    ds_read_b128 v[88:91], v3 offset:10240
    v_cvt_pk_bf16_f32 v192, v160, v161
    v_cvt_pk_bf16_f32 v193, v162, v163
    v_cvt_pk_bf16_f32 v194, v164, v165
    v_cvt_pk_bf16_f32 v195, v166, v167
    ds_write_b128 v2, v[192:195] offset:16384
    v_add_f32 v168, v104, v136
    v_add_f32 v169, v105, v137
    v_mfma_f32_32x32x16_bf16 v[24:39], a[88:91], v[72:75], v[24:39]
    v_add_f32 v170, v106, v138
    v_add_f32 v171, v107, v139
    v_add_f32 v172, v108, v140
    v_add_f32 v173, v109, v141
    v_add_f32 v174, v110, v142
    v_add_f32 v175, v111, v143
    v_exp_f32 v168, v168
    s_waitcnt lgkmcnt(4)
    v_mfma_f32_32x32x16_bf16 v[8:23], a[28:31], v[76:79], v[8:23]
    ds_read_b128 v[92:95], v3 offset:11264
    v_exp_f32 v169, v169
    v_exp_f32 v170, v170
    v_exp_f32 v171, v171
    v_exp_f32 v172, v172
    v_exp_f32 v173, v173
    v_exp_f32 v174, v174
    v_exp_f32 v175, v175
    v_mfma_f32_32x32x16_bf16 v[24:39], a[92:95], v[76:79], v[24:39]
    v_add_f32 v168, 1.0, v168
    v_add_f32 v169, 1.0, v169
    v_add_f32 v170, 1.0, v170
    v_add_f32 v171, 1.0, v171
    v_add_f32 v172, 1.0, v172
    v_add_f32 v173, 1.0, v173
    v_add_f32 v174, 1.0, v174
    s_waitcnt lgkmcnt(4)
    v_mfma_f32_32x32x16_bf16 v[8:23], a[32:35], v[80:83], v[8:23]
    ds_read_b128 v[72:75], v3 offset:12288
    v_add_f32 v175, 1.0, v175
    v_rcp_f32 v168, v168
    v_rcp_f32 v169, v169
    v_rcp_f32 v170, v170
    v_rcp_f32 v171, v171
    v_rcp_f32 v172, v172
    v_rcp_f32 v173, v173
    v_mfma_f32_32x32x16_bf16 v[24:39], a[96:99], v[80:83], v[24:39]
    v_rcp_f32 v174, v174
    v_rcp_f32 v175, v175
    v_fma_f32 v168, v168, -2.0, 1.0
    v_fma_f32 v169, v169, -2.0, 1.0
    v_fma_f32 v170, v170, -2.0, 1.0
    v_fma_f32 v171, v171, -2.0, 1.0
    v_fma_f32 v172, v172, -2.0, 1.0
    s_waitcnt lgkmcnt(4)
    v_mfma_f32_32x32x16_bf16 v[8:23], a[36:39], v[84:87], v[8:23]
    ds_read_b128 v[76:79], v3 offset:13312
    v_fma_f32 v173, v173, -2.0, 1.0
    v_fma_f32 v174, v174, -2.0, 1.0
    v_fma_f32 v175, v175, -2.0, 1.0
    v_cvt_pk_bf16_f32 v196, v168, v169
    v_cvt_pk_bf16_f32 v197, v170, v171
    v_cvt_pk_bf16_f32 v198, v172, v173
    v_cvt_pk_bf16_f32 v199, v174, v175
    v_mfma_f32_32x32x16_bf16 v[24:39], a[100:103], v[84:87], v[24:39]
    ds_write_b128 v2, v[196:199] offset:17408
    v_add_f32 v176, v112, v144
    v_add_f32 v177, v113, v145
    v_add_f32 v178, v114, v146
    v_add_f32 v179, v115, v147
    v_add_f32 v180, v116, v148
    v_add_f32 v181, v117, v149
    s_waitcnt lgkmcnt(5)
    v_mfma_f32_32x32x16_bf16 v[8:23], a[40:43], v[88:91], v[8:23]
    ds_read_b128 v[80:83], v3 offset:14336
    v_add_f32 v182, v118, v150
    v_add_f32 v183, v119, v151
    v_exp_f32 v176, v176
    v_exp_f32 v177, v177
    v_exp_f32 v178, v178
    v_exp_f32 v179, v179
    v_exp_f32 v180, v180
    v_mfma_f32_32x32x16_bf16 v[24:39], a[104:107], v[88:91], v[24:39]
    v_exp_f32 v181, v181
    v_exp_f32 v182, v182
    v_exp_f32 v183, v183
    v_add_f32 v176, 1.0, v176
    v_add_f32 v177, 1.0, v177
    v_add_f32 v178, 1.0, v178
    v_add_f32 v179, 1.0, v179
    s_waitcnt lgkmcnt(4)
    v_mfma_f32_32x32x16_bf16 v[8:23], a[44:47], v[92:95], v[8:23]
    ds_read_b128 v[84:87], v3 offset:15360
    v_add_f32 v180, 1.0, v180
    v_add_f32 v181, 1.0, v181
    v_add_f32 v182, 1.0, v182
    v_add_f32 v183, 1.0, v183
    v_rcp_f32 v176, v176
    v_rcp_f32 v177, v177
    v_rcp_f32 v178, v178
    v_mfma_f32_32x32x16_bf16 v[24:39], a[108:111], v[92:95], v[24:39]
    v_rcp_f32 v179, v179
    v_rcp_f32 v180, v180
    v_rcp_f32 v181, v181
    v_rcp_f32 v182, v182
    v_rcp_f32 v183, v183
    v_fma_f32 v176, v176, -2.0, 1.0
    v_fma_f32 v177, v177, -2.0, 1.0
    s_waitcnt lgkmcnt(4)
    v_mfma_f32_32x32x16_bf16 v[8:23], a[48:51], v[72:75], v[8:23]
    v_fma_f32 v178, v178, -2.0, 1.0
    v_fma_f32 v179, v179, -2.0, 1.0
    v_fma_f32 v180, v180, -2.0, 1.0
    v_fma_f32 v181, v181, -2.0, 1.0
    v_fma_f32 v182, v182, -2.0, 1.0
    v_fma_f32 v183, v183, -2.0, 1.0
    v_cvt_pk_bf16_f32 v200, v176, v177
    v_mfma_f32_32x32x16_bf16 v[24:39], a[112:115], v[72:75], v[24:39]
    v_cvt_pk_bf16_f32 v201, v178, v179
    v_cvt_pk_bf16_f32 v202, v180, v181
    v_cvt_pk_bf16_f32 v203, v182, v183
    ds_write_b128 v2, v[200:203] offset:18432
    v_add_f32 v184, v120, v152
    v_add_f32 v185, v121, v153
    v_add_f32 v186, v122, v154
    s_waitcnt lgkmcnt(4)
    v_mfma_f32_32x32x16_bf16 v[8:23], a[52:55], v[76:79], v[8:23]
    v_add_f32 v187, v123, v155
    v_add_f32 v188, v124, v156
    v_add_f32 v189, v125, v157
    v_add_f32 v190, v126, v158
    v_add_f32 v191, v127, v159
    v_exp_f32 v184, v184
    v_exp_f32 v185, v185
    v_mfma_f32_32x32x16_bf16 v[24:39], a[116:119], v[76:79], v[24:39]
    v_exp_f32 v186, v186
    v_exp_f32 v187, v187
    v_exp_f32 v188, v188
    v_exp_f32 v189, v189
    v_exp_f32 v190, v190
    v_exp_f32 v191, v191
    v_add_f32 v184, 1.0, v184
    s_waitcnt lgkmcnt(2)
    v_mfma_f32_32x32x16_bf16 v[8:23], a[56:59], v[80:83], v[8:23]
    v_add_f32 v185, 1.0, v185
    v_add_f32 v186, 1.0, v186
    v_add_f32 v187, 1.0, v187
    v_add_f32 v188, 1.0, v188
    v_add_f32 v189, 1.0, v189
    v_add_f32 v190, 1.0, v190
    v_add_f32 v191, 1.0, v191
    v_mfma_f32_32x32x16_bf16 v[24:39], a[120:123], v[80:83], v[24:39]
    v_rcp_f32 v184, v184
    v_rcp_f32 v185, v185
    v_rcp_f32 v186, v186
    v_rcp_f32 v187, v187
    v_rcp_f32 v188, v188
    v_rcp_f32 v189, v189
    v_rcp_f32 v190, v190
    s_waitcnt lgkmcnt(1)
    v_mfma_f32_32x32x16_bf16 v[8:23], a[60:63], v[84:87], v[8:23]
    v_rcp_f32 v191, v191
    v_fma_f32 v184, v184, -2.0, 1.0
    v_fma_f32 v185, v185, -2.0, 1.0
    v_fma_f32 v186, v186, -2.0, 1.0
    v_fma_f32 v187, v187, -2.0, 1.0
    v_fma_f32 v188, v188, -2.0, 1.0
    v_fma_f32 v189, v189, -2.0, 1.0
    v_mfma_f32_32x32x16_bf16 v[24:39], a[124:127], v[84:87], v[24:39]
    v_fma_f32 v190, v190, -2.0, 1.0
    v_fma_f32 v191, v191, -2.0, 1.0
    v_cvt_pk_bf16_f32 v204, v184, v185
    v_cvt_pk_bf16_f32 v205, v186, v187
    v_cvt_pk_bf16_f32 v206, v188, v189
    v_cvt_pk_bf16_f32 v207, v190, v191
    ds_write_b128 v2, v[204:207] offset:19456
    s_waitcnt lgkmcnt(0)
    s_barrier
    ds_read_b128 v[72:75], v3 offset:16384
    ds_read_b128 v[76:79], v3 offset:17408
    ds_read_b128 v[80:83], v3 offset:18432
    ds_read_b128 v[84:87], v3 offset:19456
    s_waitcnt lgkmcnt(3)
    v_mfma_f32_32x32x16_bf16 v[40:55], a[0:3], v[72:75], 0
    ds_read_b128 v[88:91], v3 offset:20480
    ds_read_b128 v[128:131], v4 offset:6144
    ds_read_b128 v[132:135], v4 offset:6176
    ds_read_b128 v[136:139], v4 offset:6208
    ds_read_b128 v[140:143], v4 offset:6240
    v_mfma_f32_32x32x16_bf16 v[56:71], a[64:67], v[72:75], 0
    ds_read_b128 v[144:147], v4 offset:6272
    ds_read_b128 v[148:151], v4 offset:6304
    ds_read_b128 v[152:155], v4 offset:6336
    ds_read_b128 v[156:159], v4 offset:6368
    s_waitcnt lgkmcnt(11)
    v_mfma_f32_32x32x16_bf16 v[40:55], a[4:7], v[76:79], v[40:55]
    ds_read_b128 v[92:95], v3 offset:21504
    v_cvt_pk_bf16_f32 v208, v8, v9
    v_cvt_pk_bf16_f32 v209, v10, v11
    v_cvt_pk_bf16_f32 v210, v12, v13
    v_cvt_pk_bf16_f32 v211, v14, v15
    v_cvt_pk_bf16_f32 v212, v16, v17
    v_cvt_pk_bf16_f32 v213, v18, v19
    v_cvt_pk_bf16_f32 v214, v20, v21
    v_cvt_pk_bf16_f32 v215, v22, v23
    v_mfma_f32_32x32x16_bf16 v[56:71], a[68:71], v[76:79], v[56:71]
    s_nop 1
    v_permlane16_swap_b32 v208, v212
    v_permlane16_swap_b32 v209, v213
    v_permlane16_swap_b32 v210, v214
    v_permlane16_swap_b32 v211, v215
    buffer_store_dwordx4 v[208:211], v6, s[16:19], 0 offen offset:2048
    buffer_store_dwordx4 v[212:215], v7, s[16:19], 0 offen offset:2048
    s_waitcnt lgkmcnt(11)
    v_mfma_f32_32x32x16_bf16 v[40:55], a[8:11], v[80:83], v[40:55]
    ds_read_b128 v[72:75], v3 offset:22528
    v_cvt_pk_bf16_f32 v216, v24, v25
    v_cvt_pk_bf16_f32 v217, v26, v27
    v_cvt_pk_bf16_f32 v218, v28, v29
    v_cvt_pk_bf16_f32 v219, v30, v31
    v_cvt_pk_bf16_f32 v220, v32, v33
    v_cvt_pk_bf16_f32 v221, v34, v35
    v_cvt_pk_bf16_f32 v222, v36, v37
    v_mfma_f32_32x32x16_bf16 v[56:71], a[72:75], v[80:83], v[56:71]
    v_cvt_pk_bf16_f32 v223, v38, v39
    s_nop 1
    v_permlane16_swap_b32 v216, v220
    v_permlane16_swap_b32 v217, v221
    v_permlane16_swap_b32 v218, v222
    v_permlane16_swap_b32 v219, v223
    buffer_store_dwordx4 v[216:219], v6, s[16:19], 0 offen offset:2112
    s_waitcnt lgkmcnt(11)
    v_mfma_f32_32x32x16_bf16 v[40:55], a[12:15], v[84:87], v[40:55]
    ds_read_b128 v[76:79], v3 offset:23552
    buffer_store_dwordx4 v[220:223], v7, s[16:19], 0 offen offset:2112
    s_waitcnt lgkmcnt(3)
    v_add_f32 v160, v96, v128
    v_add_f32 v161, v97, v129
    v_add_f32 v162, v98, v130
    v_add_f32 v163, v99, v131
    v_add_f32 v164, v100, v132
    v_mfma_f32_32x32x16_bf16 v[56:71], a[76:79], v[84:87], v[56:71]
    v_add_f32 v165, v101, v133
    v_add_f32 v166, v102, v134
    v_add_f32 v167, v103, v135
    v_exp_f32 v160, v160
    v_exp_f32 v161, v161
    v_exp_f32 v162, v162
    v_exp_f32 v163, v163
    v_mfma_f32_32x32x16_bf16 v[40:55], a[16:19], v[88:91], v[40:55]
    ds_read_b128 v[80:83], v3 offset:24576
    v_exp_f32 v164, v164
    v_exp_f32 v165, v165
    v_exp_f32 v166, v166
    v_exp_f32 v167, v167
    v_add_f32 v160, 1.0, v160
    v_add_f32 v161, 1.0, v161
    v_add_f32 v162, 1.0, v162
    v_mfma_f32_32x32x16_bf16 v[56:71], a[80:83], v[88:91], v[56:71]
    v_add_f32 v163, 1.0, v163
    v_add_f32 v164, 1.0, v164
    v_add_f32 v165, 1.0, v165
    v_add_f32 v166, 1.0, v166
    v_add_f32 v167, 1.0, v167
    v_rcp_f32 v160, v160
    v_rcp_f32 v161, v161
    s_waitcnt lgkmcnt(3)
    v_mfma_f32_32x32x16_bf16 v[40:55], a[20:23], v[92:95], v[40:55]
    ds_read_b128 v[84:87], v3 offset:25600
    v_rcp_f32 v162, v162
    v_rcp_f32 v163, v163
    v_rcp_f32 v164, v164
    v_rcp_f32 v165, v165
    v_rcp_f32 v166, v166
    v_rcp_f32 v167, v167
    v_fma_f32 v160, v160, -2.0, 1.0
    v_mfma_f32_32x32x16_bf16 v[56:71], a[84:87], v[92:95], v[56:71]
    v_fma_f32 v161, v161, -2.0, 1.0
    v_fma_f32 v162, v162, -2.0, 1.0
    v_fma_f32 v163, v163, -2.0, 1.0
    v_fma_f32 v164, v164, -2.0, 1.0
    v_fma_f32 v165, v165, -2.0, 1.0
    v_fma_f32 v166, v166, -2.0, 1.0
    v_fma_f32 v167, v167, -2.0, 1.0
    s_waitcnt lgkmcnt(3)
    v_mfma_f32_32x32x16_bf16 v[40:55], a[24:27], v[72:75], v[40:55]
    ds_read_b128 v[88:91], v3 offset:26624
    v_cvt_pk_bf16_f32 v192, v160, v161
    v_cvt_pk_bf16_f32 v193, v162, v163
    v_cvt_pk_bf16_f32 v194, v164, v165
    v_cvt_pk_bf16_f32 v195, v166, v167
    ds_write_b128 v2, v[192:195] offset:0
    v_add_f32 v168, v104, v136
    v_add_f32 v169, v105, v137
    v_mfma_f32_32x32x16_bf16 v[56:71], a[88:91], v[72:75], v[56:71]
    v_add_f32 v170, v106, v138
    v_add_f32 v171, v107, v139
    v_add_f32 v172, v108, v140
    v_add_f32 v173, v109, v141
    v_add_f32 v174, v110, v142
    v_add_f32 v175, v111, v143
    v_exp_f32 v168, v168
    s_waitcnt lgkmcnt(4)
    v_mfma_f32_32x32x16_bf16 v[40:55], a[28:31], v[76:79], v[40:55]
    ds_read_b128 v[92:95], v3 offset:27648
    v_exp_f32 v169, v169
    v_exp_f32 v170, v170
    v_exp_f32 v171, v171
    v_exp_f32 v172, v172
    v_exp_f32 v173, v173
    v_exp_f32 v174, v174
    v_exp_f32 v175, v175
    v_mfma_f32_32x32x16_bf16 v[56:71], a[92:95], v[76:79], v[56:71]
    v_add_f32 v168, 1.0, v168
    v_add_f32 v169, 1.0, v169
    v_add_f32 v170, 1.0, v170
    v_add_f32 v171, 1.0, v171
    v_add_f32 v172, 1.0, v172
    v_add_f32 v173, 1.0, v173
    v_add_f32 v174, 1.0, v174
    s_waitcnt lgkmcnt(4)
    v_mfma_f32_32x32x16_bf16 v[40:55], a[32:35], v[80:83], v[40:55]
    ds_read_b128 v[72:75], v3 offset:28672
    v_add_f32 v175, 1.0, v175
    v_rcp_f32 v168, v168
    v_rcp_f32 v169, v169
    v_rcp_f32 v170, v170
    v_rcp_f32 v171, v171
    v_rcp_f32 v172, v172
    v_rcp_f32 v173, v173
    v_mfma_f32_32x32x16_bf16 v[56:71], a[96:99], v[80:83], v[56:71]
    v_rcp_f32 v174, v174
    v_rcp_f32 v175, v175
    v_fma_f32 v168, v168, -2.0, 1.0
    v_fma_f32 v169, v169, -2.0, 1.0
    v_fma_f32 v170, v170, -2.0, 1.0
    v_fma_f32 v171, v171, -2.0, 1.0
    v_fma_f32 v172, v172, -2.0, 1.0
    s_waitcnt lgkmcnt(4)
    v_mfma_f32_32x32x16_bf16 v[40:55], a[36:39], v[84:87], v[40:55]
    ds_read_b128 v[76:79], v3 offset:29696
    v_fma_f32 v173, v173, -2.0, 1.0
    v_fma_f32 v174, v174, -2.0, 1.0
    v_fma_f32 v175, v175, -2.0, 1.0
    v_cvt_pk_bf16_f32 v196, v168, v169
    v_cvt_pk_bf16_f32 v197, v170, v171
    v_cvt_pk_bf16_f32 v198, v172, v173
    v_cvt_pk_bf16_f32 v199, v174, v175
    v_mfma_f32_32x32x16_bf16 v[56:71], a[100:103], v[84:87], v[56:71]
    ds_write_b128 v2, v[196:199] offset:1024
    v_add_f32 v176, v112, v144
    v_add_f32 v177, v113, v145
    v_add_f32 v178, v114, v146
    v_add_f32 v179, v115, v147
    v_add_f32 v180, v116, v148
    v_add_f32 v181, v117, v149
    s_waitcnt lgkmcnt(5)
    v_mfma_f32_32x32x16_bf16 v[40:55], a[40:43], v[88:91], v[40:55]
    ds_read_b128 v[80:83], v3 offset:30720
    v_add_f32 v182, v118, v150
    v_add_f32 v183, v119, v151
    v_exp_f32 v176, v176
    v_exp_f32 v177, v177
    v_exp_f32 v178, v178
    v_exp_f32 v179, v179
    v_exp_f32 v180, v180
    v_mfma_f32_32x32x16_bf16 v[56:71], a[104:107], v[88:91], v[56:71]
    v_exp_f32 v181, v181
    v_exp_f32 v182, v182
    v_exp_f32 v183, v183
    v_add_f32 v176, 1.0, v176
    v_add_f32 v177, 1.0, v177
    v_add_f32 v178, 1.0, v178
    v_add_f32 v179, 1.0, v179
    s_waitcnt lgkmcnt(4)
    v_mfma_f32_32x32x16_bf16 v[40:55], a[44:47], v[92:95], v[40:55]
    ds_read_b128 v[84:87], v3 offset:31744
    v_add_f32 v180, 1.0, v180
    v_add_f32 v181, 1.0, v181
    v_add_f32 v182, 1.0, v182
    v_add_f32 v183, 1.0, v183
    v_rcp_f32 v176, v176
    v_rcp_f32 v177, v177
    v_rcp_f32 v178, v178
    v_mfma_f32_32x32x16_bf16 v[56:71], a[108:111], v[92:95], v[56:71]
    v_rcp_f32 v179, v179
    v_rcp_f32 v180, v180
    v_rcp_f32 v181, v181
    v_rcp_f32 v182, v182
    v_rcp_f32 v183, v183
    v_fma_f32 v176, v176, -2.0, 1.0
    v_fma_f32 v177, v177, -2.0, 1.0
    s_waitcnt lgkmcnt(4)
    v_mfma_f32_32x32x16_bf16 v[40:55], a[48:51], v[72:75], v[40:55]
    v_fma_f32 v178, v178, -2.0, 1.0
    v_fma_f32 v179, v179, -2.0, 1.0
    v_fma_f32 v180, v180, -2.0, 1.0
    v_fma_f32 v181, v181, -2.0, 1.0
    v_fma_f32 v182, v182, -2.0, 1.0
    v_fma_f32 v183, v183, -2.0, 1.0
    v_cvt_pk_bf16_f32 v200, v176, v177
    v_mfma_f32_32x32x16_bf16 v[56:71], a[112:115], v[72:75], v[56:71]
    v_cvt_pk_bf16_f32 v201, v178, v179
    v_cvt_pk_bf16_f32 v202, v180, v181
    v_cvt_pk_bf16_f32 v203, v182, v183
    ds_write_b128 v2, v[200:203] offset:2048
    v_add_f32 v184, v120, v152
    v_add_f32 v185, v121, v153
    v_add_f32 v186, v122, v154
    s_waitcnt lgkmcnt(4)
    v_mfma_f32_32x32x16_bf16 v[40:55], a[52:55], v[76:79], v[40:55]
    v_add_f32 v187, v123, v155
    v_add_f32 v188, v124, v156
    v_add_f32 v189, v125, v157
    v_add_f32 v190, v126, v158
    v_add_f32 v191, v127, v159
    v_exp_f32 v184, v184
    v_exp_f32 v185, v185
    v_mfma_f32_32x32x16_bf16 v[56:71], a[116:119], v[76:79], v[56:71]
    v_exp_f32 v186, v186
    v_exp_f32 v187, v187
    v_exp_f32 v188, v188
    v_exp_f32 v189, v189
    v_exp_f32 v190, v190
    v_exp_f32 v191, v191
    v_add_f32 v184, 1.0, v184
    s_waitcnt lgkmcnt(2)
    v_mfma_f32_32x32x16_bf16 v[40:55], a[56:59], v[80:83], v[40:55]
    v_add_f32 v185, 1.0, v185
    v_add_f32 v186, 1.0, v186
    v_add_f32 v187, 1.0, v187
    v_add_f32 v188, 1.0, v188
    v_add_f32 v189, 1.0, v189
    v_add_f32 v190, 1.0, v190
    v_add_f32 v191, 1.0, v191
    v_mfma_f32_32x32x16_bf16 v[56:71], a[120:123], v[80:83], v[56:71]
    v_rcp_f32 v184, v184
    v_rcp_f32 v185, v185
    v_rcp_f32 v186, v186
    v_rcp_f32 v187, v187
    v_rcp_f32 v188, v188
    v_rcp_f32 v189, v189
    v_rcp_f32 v190, v190
    s_waitcnt lgkmcnt(1)
    v_mfma_f32_32x32x16_bf16 v[40:55], a[60:63], v[84:87], v[40:55]
    v_rcp_f32 v191, v191
    v_fma_f32 v184, v184, -2.0, 1.0
    v_fma_f32 v185, v185, -2.0, 1.0
    v_fma_f32 v186, v186, -2.0, 1.0
    v_fma_f32 v187, v187, -2.0, 1.0
    v_fma_f32 v188, v188, -2.0, 1.0
    v_fma_f32 v189, v189, -2.0, 1.0
    v_mfma_f32_32x32x16_bf16 v[56:71], a[124:127], v[84:87], v[56:71]
    v_fma_f32 v190, v190, -2.0, 1.0
    v_fma_f32 v191, v191, -2.0, 1.0
    v_cvt_pk_bf16_f32 v204, v184, v185
    v_cvt_pk_bf16_f32 v205, v186, v187
    v_cvt_pk_bf16_f32 v206, v188, v189
    v_cvt_pk_bf16_f32 v207, v190, v191
    ds_write_b128 v2, v[204:207] offset:3072
    s_waitcnt lgkmcnt(0)
    s_barrier
    ds_read_b128 v[72:75], v3 offset:0
    ds_read_b128 v[76:79], v3 offset:1024
    ds_read_b128 v[80:83], v3 offset:2048
    ds_read_b128 v[84:87], v3 offset:3072
    s_waitcnt lgkmcnt(3)
    v_mfma_f32_32x32x16_bf16 v[8:23], a[0:3], v[72:75], 0
    ds_read_b128 v[88:91], v3 offset:4096
    ds_read_b128 v[128:131], v4 offset:7168
    ds_read_b128 v[132:135], v4 offset:7200
    ds_read_b128 v[136:139], v4 offset:7232
    ds_read_b128 v[140:143], v4 offset:7264
    v_mfma_f32_32x32x16_bf16 v[24:39], a[64:67], v[72:75], 0
    ds_read_b128 v[144:147], v4 offset:7296
    ds_read_b128 v[148:151], v4 offset:7328
    ds_read_b128 v[152:155], v4 offset:7360
    ds_read_b128 v[156:159], v4 offset:7392
    s_waitcnt lgkmcnt(11)
    v_mfma_f32_32x32x16_bf16 v[8:23], a[4:7], v[76:79], v[8:23]
    ds_read_b128 v[92:95], v3 offset:5120
    v_cvt_pk_bf16_f32 v208, v40, v41
    v_cvt_pk_bf16_f32 v209, v42, v43
    v_cvt_pk_bf16_f32 v210, v44, v45
    v_cvt_pk_bf16_f32 v211, v46, v47
    v_cvt_pk_bf16_f32 v212, v48, v49
    v_cvt_pk_bf16_f32 v213, v50, v51
    v_cvt_pk_bf16_f32 v214, v52, v53
    v_cvt_pk_bf16_f32 v215, v54, v55
    v_mfma_f32_32x32x16_bf16 v[24:39], a[68:71], v[76:79], v[24:39]
    s_nop 1
    v_permlane16_swap_b32 v208, v212
    v_permlane16_swap_b32 v209, v213
    v_permlane16_swap_b32 v210, v214
    v_permlane16_swap_b32 v211, v215
    buffer_store_dwordx4 v[208:211], v6, s[16:19], 0 offen offset:2560
    buffer_store_dwordx4 v[212:215], v7, s[16:19], 0 offen offset:2560
    s_waitcnt lgkmcnt(11)
    v_mfma_f32_32x32x16_bf16 v[8:23], a[8:11], v[80:83], v[8:23]
    ds_read_b128 v[72:75], v3 offset:6144
    v_cvt_pk_bf16_f32 v216, v56, v57
    v_cvt_pk_bf16_f32 v217, v58, v59
    v_cvt_pk_bf16_f32 v218, v60, v61
    v_cvt_pk_bf16_f32 v219, v62, v63
    v_cvt_pk_bf16_f32 v220, v64, v65
    v_cvt_pk_bf16_f32 v221, v66, v67
    v_cvt_pk_bf16_f32 v222, v68, v69
    v_mfma_f32_32x32x16_bf16 v[24:39], a[72:75], v[80:83], v[24:39]
    v_cvt_pk_bf16_f32 v223, v70, v71
    s_nop 1
    v_permlane16_swap_b32 v216, v220
    v_permlane16_swap_b32 v217, v221
    v_permlane16_swap_b32 v218, v222
    v_permlane16_swap_b32 v219, v223
    buffer_store_dwordx4 v[216:219], v6, s[16:19], 0 offen offset:2624
    s_waitcnt lgkmcnt(11)
    v_mfma_f32_32x32x16_bf16 v[8:23], a[12:15], v[84:87], v[8:23]
    ds_read_b128 v[76:79], v3 offset:7168
    buffer_store_dwordx4 v[220:223], v7, s[16:19], 0 offen offset:2624
    s_waitcnt lgkmcnt(3)
    v_add_f32 v160, v96, v128
    v_add_f32 v161, v97, v129
    v_add_f32 v162, v98, v130
    v_add_f32 v163, v99, v131
    v_add_f32 v164, v100, v132
    v_mfma_f32_32x32x16_bf16 v[24:39], a[76:79], v[84:87], v[24:39]
    v_add_f32 v165, v101, v133
    v_add_f32 v166, v102, v134
    v_add_f32 v167, v103, v135
    v_exp_f32 v160, v160
    v_exp_f32 v161, v161
    v_exp_f32 v162, v162
    v_exp_f32 v163, v163
    v_mfma_f32_32x32x16_bf16 v[8:23], a[16:19], v[88:91], v[8:23]
    ds_read_b128 v[80:83], v3 offset:8192
    v_exp_f32 v164, v164
    v_exp_f32 v165, v165
    v_exp_f32 v166, v166
    v_exp_f32 v167, v167
    v_add_f32 v160, 1.0, v160
    v_add_f32 v161, 1.0, v161
    v_add_f32 v162, 1.0, v162
    v_mfma_f32_32x32x16_bf16 v[24:39], a[80:83], v[88:91], v[24:39]
    v_add_f32 v163, 1.0, v163
    v_add_f32 v164, 1.0, v164
    v_add_f32 v165, 1.0, v165
    v_add_f32 v166, 1.0, v166
    v_add_f32 v167, 1.0, v167
    v_rcp_f32 v160, v160
    v_rcp_f32 v161, v161
    s_waitcnt lgkmcnt(3)
    v_mfma_f32_32x32x16_bf16 v[8:23], a[20:23], v[92:95], v[8:23]
    ds_read_b128 v[84:87], v3 offset:9216
    v_rcp_f32 v162, v162
    v_rcp_f32 v163, v163
    v_rcp_f32 v164, v164
    v_rcp_f32 v165, v165
    v_rcp_f32 v166, v166
    v_rcp_f32 v167, v167
    v_fma_f32 v160, v160, -2.0, 1.0
    v_mfma_f32_32x32x16_bf16 v[24:39], a[84:87], v[92:95], v[24:39]
    v_fma_f32 v161, v161, -2.0, 1.0
    v_fma_f32 v162, v162, -2.0, 1.0
    v_fma_f32 v163, v163, -2.0, 1.0
    v_fma_f32 v164, v164, -2.0, 1.0
    v_fma_f32 v165, v165, -2.0, 1.0
    v_fma_f32 v166, v166, -2.0, 1.0
    v_fma_f32 v167, v167, -2.0, 1.0
    s_waitcnt lgkmcnt(3)
    v_mfma_f32_32x32x16_bf16 v[8:23], a[24:27], v[72:75], v[8:23]
    ds_read_b128 v[88:91], v3 offset:10240
    v_cvt_pk_bf16_f32 v192, v160, v161
    v_cvt_pk_bf16_f32 v193, v162, v163
    v_cvt_pk_bf16_f32 v194, v164, v165
    v_cvt_pk_bf16_f32 v195, v166, v167
    ds_write_b128 v2, v[192:195] offset:16384
    v_add_f32 v168, v104, v136
    v_add_f32 v169, v105, v137
    v_mfma_f32_32x32x16_bf16 v[24:39], a[88:91], v[72:75], v[24:39]
    v_add_f32 v170, v106, v138
    v_add_f32 v171, v107, v139
    v_add_f32 v172, v108, v140
    v_add_f32 v173, v109, v141
    v_add_f32 v174, v110, v142
    v_add_f32 v175, v111, v143
    v_exp_f32 v168, v168
    s_waitcnt lgkmcnt(4)
    v_mfma_f32_32x32x16_bf16 v[8:23], a[28:31], v[76:79], v[8:23]
    ds_read_b128 v[92:95], v3 offset:11264
    v_exp_f32 v169, v169
    v_exp_f32 v170, v170
    v_exp_f32 v171, v171
    v_exp_f32 v172, v172
    v_exp_f32 v173, v173
    v_exp_f32 v174, v174
    v_exp_f32 v175, v175
    v_mfma_f32_32x32x16_bf16 v[24:39], a[92:95], v[76:79], v[24:39]
    v_add_f32 v168, 1.0, v168
    v_add_f32 v169, 1.0, v169
    v_add_f32 v170, 1.0, v170
    v_add_f32 v171, 1.0, v171
    v_add_f32 v172, 1.0, v172
    v_add_f32 v173, 1.0, v173
    v_add_f32 v174, 1.0, v174
    s_waitcnt lgkmcnt(4)
    v_mfma_f32_32x32x16_bf16 v[8:23], a[32:35], v[80:83], v[8:23]
    ds_read_b128 v[72:75], v3 offset:12288
    v_add_f32 v175, 1.0, v175
    v_rcp_f32 v168, v168
    v_rcp_f32 v169, v169
    v_rcp_f32 v170, v170
    v_rcp_f32 v171, v171
    v_rcp_f32 v172, v172
    v_rcp_f32 v173, v173
    v_mfma_f32_32x32x16_bf16 v[24:39], a[96:99], v[80:83], v[24:39]
    v_rcp_f32 v174, v174
    v_rcp_f32 v175, v175
    v_fma_f32 v168, v168, -2.0, 1.0
    v_fma_f32 v169, v169, -2.0, 1.0
    v_fma_f32 v170, v170, -2.0, 1.0
    v_fma_f32 v171, v171, -2.0, 1.0
    v_fma_f32 v172, v172, -2.0, 1.0
    s_waitcnt lgkmcnt(4)
    v_mfma_f32_32x32x16_bf16 v[8:23], a[36:39], v[84:87], v[8:23]
    ds_read_b128 v[76:79], v3 offset:13312
    v_fma_f32 v173, v173, -2.0, 1.0
    v_fma_f32 v174, v174, -2.0, 1.0
    v_fma_f32 v175, v175, -2.0, 1.0
    v_cvt_pk_bf16_f32 v196, v168, v169
    v_cvt_pk_bf16_f32 v197, v170, v171
    v_cvt_pk_bf16_f32 v198, v172, v173
    v_cvt_pk_bf16_f32 v199, v174, v175
    v_mfma_f32_32x32x16_bf16 v[24:39], a[100:103], v[84:87], v[24:39]
    ds_write_b128 v2, v[196:199] offset:17408
    v_add_f32 v176, v112, v144
    v_add_f32 v177, v113, v145
    v_add_f32 v178, v114, v146
    v_add_f32 v179, v115, v147
    v_add_f32 v180, v116, v148
    v_add_f32 v181, v117, v149
    s_waitcnt lgkmcnt(5)
    v_mfma_f32_32x32x16_bf16 v[8:23], a[40:43], v[88:91], v[8:23]
    ds_read_b128 v[80:83], v3 offset:14336
    v_add_f32 v182, v118, v150
    v_add_f32 v183, v119, v151
    v_exp_f32 v176, v176
    v_exp_f32 v177, v177
    v_exp_f32 v178, v178
    v_exp_f32 v179, v179
    v_exp_f32 v180, v180
    v_mfma_f32_32x32x16_bf16 v[24:39], a[104:107], v[88:91], v[24:39]
    v_exp_f32 v181, v181
    v_exp_f32 v182, v182
    v_exp_f32 v183, v183
    v_add_f32 v176, 1.0, v176
    v_add_f32 v177, 1.0, v177
    v_add_f32 v178, 1.0, v178
    v_add_f32 v179, 1.0, v179
    s_waitcnt lgkmcnt(4)
    v_mfma_f32_32x32x16_bf16 v[8:23], a[44:47], v[92:95], v[8:23]
    ds_read_b128 v[84:87], v3 offset:15360
    v_add_f32 v180, 1.0, v180
    v_add_f32 v181, 1.0, v181
    v_add_f32 v182, 1.0, v182
    v_add_f32 v183, 1.0, v183
    v_rcp_f32 v176, v176
    v_rcp_f32 v177, v177
    v_rcp_f32 v178, v178
    v_mfma_f32_32x32x16_bf16 v[24:39], a[108:111], v[92:95], v[24:39]
    v_rcp_f32 v179, v179
    v_rcp_f32 v180, v180
    v_rcp_f32 v181, v181
    v_rcp_f32 v182, v182
    v_rcp_f32 v183, v183
    v_fma_f32 v176, v176, -2.0, 1.0
    v_fma_f32 v177, v177, -2.0, 1.0
    s_waitcnt lgkmcnt(4)
    v_mfma_f32_32x32x16_bf16 v[8:23], a[48:51], v[72:75], v[8:23]
    v_fma_f32 v178, v178, -2.0, 1.0
    v_fma_f32 v179, v179, -2.0, 1.0
    v_fma_f32 v180, v180, -2.0, 1.0
    v_fma_f32 v181, v181, -2.0, 1.0
    v_fma_f32 v182, v182, -2.0, 1.0
    v_fma_f32 v183, v183, -2.0, 1.0
    v_cvt_pk_bf16_f32 v200, v176, v177
    v_mfma_f32_32x32x16_bf16 v[24:39], a[112:115], v[72:75], v[24:39]
    v_cvt_pk_bf16_f32 v201, v178, v179
    v_cvt_pk_bf16_f32 v202, v180, v181
    v_cvt_pk_bf16_f32 v203, v182, v183
    ds_write_b128 v2, v[200:203] offset:18432
    v_add_f32 v184, v120, v152
    v_add_f32 v185, v121, v153
    v_add_f32 v186, v122, v154
    s_waitcnt lgkmcnt(4)
    v_mfma_f32_32x32x16_bf16 v[8:23], a[52:55], v[76:79], v[8:23]
    v_add_f32 v187, v123, v155
    v_add_f32 v188, v124, v156
    v_add_f32 v189, v125, v157
    v_add_f32 v190, v126, v158
    v_add_f32 v191, v127, v159
    v_exp_f32 v184, v184
    v_exp_f32 v185, v185
    v_mfma_f32_32x32x16_bf16 v[24:39], a[116:119], v[76:79], v[24:39]
    v_exp_f32 v186, v186
    v_exp_f32 v187, v187
    v_exp_f32 v188, v188
    v_exp_f32 v189, v189
    v_exp_f32 v190, v190
    v_exp_f32 v191, v191
    v_add_f32 v184, 1.0, v184
    s_waitcnt lgkmcnt(2)
    v_mfma_f32_32x32x16_bf16 v[8:23], a[56:59], v[80:83], v[8:23]
    v_add_f32 v185, 1.0, v185
    v_add_f32 v186, 1.0, v186
    v_add_f32 v187, 1.0, v187
    v_add_f32 v188, 1.0, v188
    v_add_f32 v189, 1.0, v189
    v_add_f32 v190, 1.0, v190
    v_add_f32 v191, 1.0, v191
    v_mfma_f32_32x32x16_bf16 v[24:39], a[120:123], v[80:83], v[24:39]
    v_rcp_f32 v184, v184
    v_rcp_f32 v185, v185
    v_rcp_f32 v186, v186
    v_rcp_f32 v187, v187
    v_rcp_f32 v188, v188
    v_rcp_f32 v189, v189
    v_rcp_f32 v190, v190
    s_waitcnt lgkmcnt(1)
    v_mfma_f32_32x32x16_bf16 v[8:23], a[60:63], v[84:87], v[8:23]
    v_rcp_f32 v191, v191
    v_fma_f32 v184, v184, -2.0, 1.0
    v_fma_f32 v185, v185, -2.0, 1.0
    v_fma_f32 v186, v186, -2.0, 1.0
    v_fma_f32 v187, v187, -2.0, 1.0
    v_fma_f32 v188, v188, -2.0, 1.0
    v_fma_f32 v189, v189, -2.0, 1.0
    v_mfma_f32_32x32x16_bf16 v[24:39], a[124:127], v[84:87], v[24:39]
    v_fma_f32 v190, v190, -2.0, 1.0
    v_fma_f32 v191, v191, -2.0, 1.0
    v_cvt_pk_bf16_f32 v204, v184, v185
    v_cvt_pk_bf16_f32 v205, v186, v187
    v_cvt_pk_bf16_f32 v206, v188, v189
    v_cvt_pk_bf16_f32 v207, v190, v191
    ds_write_b128 v2, v[204:207] offset:19456
    s_waitcnt lgkmcnt(0)
    s_barrier
    ds_read_b128 v[72:75], v3 offset:16384
    ds_read_b128 v[76:79], v3 offset:17408
    ds_read_b128 v[80:83], v3 offset:18432
    ds_read_b128 v[84:87], v3 offset:19456
    s_waitcnt lgkmcnt(3)
    v_mfma_f32_32x32x16_bf16 v[40:55], a[0:3], v[72:75], 0
    ds_read_b128 v[88:91], v3 offset:20480
    v_mfma_f32_32x32x16_bf16 v[56:71], a[64:67], v[72:75], 0
    s_waitcnt lgkmcnt(3)
    v_mfma_f32_32x32x16_bf16 v[40:55], a[4:7], v[76:79], v[40:55]
    ds_read_b128 v[92:95], v3 offset:21504
    v_cvt_pk_bf16_f32 v208, v8, v9
    v_mfma_f32_32x32x16_bf16 v[56:71], a[68:71], v[76:79], v[56:71]
    v_cvt_pk_bf16_f32 v209, v10, v11
    s_waitcnt lgkmcnt(3)
    v_mfma_f32_32x32x16_bf16 v[40:55], a[8:11], v[80:83], v[40:55]
    ds_read_b128 v[72:75], v3 offset:22528
    v_cvt_pk_bf16_f32 v210, v12, v13
    v_mfma_f32_32x32x16_bf16 v[56:71], a[72:75], v[80:83], v[56:71]
    v_cvt_pk_bf16_f32 v211, v14, v15
    s_waitcnt lgkmcnt(3)
    v_mfma_f32_32x32x16_bf16 v[40:55], a[12:15], v[84:87], v[40:55]
    ds_read_b128 v[76:79], v3 offset:23552
    v_cvt_pk_bf16_f32 v212, v16, v17
    v_mfma_f32_32x32x16_bf16 v[56:71], a[76:79], v[84:87], v[56:71]
    v_cvt_pk_bf16_f32 v213, v18, v19
    s_waitcnt lgkmcnt(3)
    v_mfma_f32_32x32x16_bf16 v[40:55], a[16:19], v[88:91], v[40:55]
    ds_read_b128 v[80:83], v3 offset:24576
    v_cvt_pk_bf16_f32 v214, v20, v21
    v_mfma_f32_32x32x16_bf16 v[56:71], a[80:83], v[88:91], v[56:71]
    v_cvt_pk_bf16_f32 v215, v22, v23
    s_waitcnt lgkmcnt(3)
    v_mfma_f32_32x32x16_bf16 v[40:55], a[20:23], v[92:95], v[40:55]
    ds_read_b128 v[84:87], v3 offset:25600
    s_nop 1
    v_mfma_f32_32x32x16_bf16 v[56:71], a[84:87], v[92:95], v[56:71]
    v_permlane16_swap_b32 v208, v212
    s_waitcnt lgkmcnt(3)
    v_mfma_f32_32x32x16_bf16 v[40:55], a[24:27], v[72:75], v[40:55]
    ds_read_b128 v[88:91], v3 offset:26624
    v_permlane16_swap_b32 v209, v213
    v_mfma_f32_32x32x16_bf16 v[56:71], a[88:91], v[72:75], v[56:71]
    v_permlane16_swap_b32 v210, v214
    s_waitcnt lgkmcnt(3)
    v_mfma_f32_32x32x16_bf16 v[40:55], a[28:31], v[76:79], v[40:55]
    ds_read_b128 v[92:95], v3 offset:27648
    v_permlane16_swap_b32 v211, v215
    v_mfma_f32_32x32x16_bf16 v[56:71], a[92:95], v[76:79], v[56:71]
    buffer_store_dwordx4 v[208:211], v6, s[16:19], 0 offen offset:3072
    s_waitcnt lgkmcnt(3)
    v_mfma_f32_32x32x16_bf16 v[40:55], a[32:35], v[80:83], v[40:55]
    ds_read_b128 v[72:75], v3 offset:28672
    buffer_store_dwordx4 v[212:215], v7, s[16:19], 0 offen offset:3072
    v_mfma_f32_32x32x16_bf16 v[56:71], a[96:99], v[80:83], v[56:71]
    v_cvt_pk_bf16_f32 v216, v24, v25
    s_waitcnt lgkmcnt(3)
    v_mfma_f32_32x32x16_bf16 v[40:55], a[36:39], v[84:87], v[40:55]
    ds_read_b128 v[76:79], v3 offset:29696
    v_cvt_pk_bf16_f32 v217, v26, v27
    v_mfma_f32_32x32x16_bf16 v[56:71], a[100:103], v[84:87], v[56:71]
    v_cvt_pk_bf16_f32 v218, v28, v29
    s_waitcnt lgkmcnt(3)
    v_mfma_f32_32x32x16_bf16 v[40:55], a[40:43], v[88:91], v[40:55]
    ds_read_b128 v[80:83], v3 offset:30720
    v_cvt_pk_bf16_f32 v219, v30, v31
    v_mfma_f32_32x32x16_bf16 v[56:71], a[104:107], v[88:91], v[56:71]
    v_cvt_pk_bf16_f32 v220, v32, v33
    s_waitcnt lgkmcnt(3)
    v_mfma_f32_32x32x16_bf16 v[40:55], a[44:47], v[92:95], v[40:55]
    ds_read_b128 v[84:87], v3 offset:31744
    v_cvt_pk_bf16_f32 v221, v34, v35
    v_mfma_f32_32x32x16_bf16 v[56:71], a[108:111], v[92:95], v[56:71]
    v_cvt_pk_bf16_f32 v222, v36, v37
    s_waitcnt lgkmcnt(3)
    v_mfma_f32_32x32x16_bf16 v[40:55], a[48:51], v[72:75], v[40:55]
    v_cvt_pk_bf16_f32 v223, v38, v39
    v_mfma_f32_32x32x16_bf16 v[56:71], a[112:115], v[72:75], v[56:71]
    s_nop 1
    s_waitcnt lgkmcnt(2)
    v_mfma_f32_32x32x16_bf16 v[40:55], a[52:55], v[76:79], v[40:55]
    v_permlane16_swap_b32 v216, v220
    v_mfma_f32_32x32x16_bf16 v[56:71], a[116:119], v[76:79], v[56:71]
    v_permlane16_swap_b32 v217, v221
    s_waitcnt lgkmcnt(1)
    v_mfma_f32_32x32x16_bf16 v[40:55], a[56:59], v[80:83], v[40:55]
    v_permlane16_swap_b32 v218, v222
    v_mfma_f32_32x32x16_bf16 v[56:71], a[120:123], v[80:83], v[56:71]
    v_permlane16_swap_b32 v219, v223
    s_waitcnt lgkmcnt(0)
    v_mfma_f32_32x32x16_bf16 v[40:55], a[60:63], v[84:87], v[40:55]
    buffer_store_dwordx4 v[216:219], v6, s[16:19], 0 offen offset:3136
    v_mfma_f32_32x32x16_bf16 v[56:71], a[124:127], v[84:87], v[56:71]
    buffer_store_dwordx4 v[220:223], v7, s[16:19], 0 offen offset:3136
    s_nop 7
    s_nop 7
    v_cvt_pk_bf16_f32 v208, v40, v41
    v_cvt_pk_bf16_f32 v209, v42, v43
    v_cvt_pk_bf16_f32 v210, v44, v45
    v_cvt_pk_bf16_f32 v211, v46, v47
    v_cvt_pk_bf16_f32 v212, v48, v49
    v_cvt_pk_bf16_f32 v213, v50, v51
    v_cvt_pk_bf16_f32 v214, v52, v53
    v_cvt_pk_bf16_f32 v215, v54, v55
    s_nop 1
    v_permlane16_swap_b32 v208, v212
    v_permlane16_swap_b32 v209, v213
    v_permlane16_swap_b32 v210, v214
    v_permlane16_swap_b32 v211, v215
    buffer_store_dwordx4 v[208:211], v6, s[16:19], 0 offen offset:3584
    buffer_store_dwordx4 v[212:215], v7, s[16:19], 0 offen offset:3584
    v_cvt_pk_bf16_f32 v216, v56, v57
    v_cvt_pk_bf16_f32 v217, v58, v59
    v_cvt_pk_bf16_f32 v218, v60, v61
    v_cvt_pk_bf16_f32 v219, v62, v63
    v_cvt_pk_bf16_f32 v220, v64, v65
    v_cvt_pk_bf16_f32 v221, v66, v67
    v_cvt_pk_bf16_f32 v222, v68, v69
    v_cvt_pk_bf16_f32 v223, v70, v71
    s_nop 1
    v_permlane16_swap_b32 v216, v220
    v_permlane16_swap_b32 v217, v221
    v_permlane16_swap_b32 v218, v222
    v_permlane16_swap_b32 v219, v223
    buffer_store_dwordx4 v[216:219], v6, s[16:19], 0 offen offset:3648
    buffer_store_dwordx4 v[220:223], v7, s[16:19], 0 offen offset:3648
    s_endpgm
L_joint_kernel_done:
    s_endpgm
.section .rodata,"a"
.p2align 6
.amdhsa_kernel prep_kernel
  .amdhsa_next_free_vgpr 128
  .amdhsa_next_free_sgpr 102
  .amdhsa_accum_offset 128
  .amdhsa_group_segment_fixed_size 0
  .amdhsa_kernarg_size 80
  .amdhsa_user_sgpr_count 2
  .amdhsa_user_sgpr_kernarg_segment_ptr 1
  .amdhsa_system_sgpr_workgroup_id_x 1
.end_amdhsa_kernel
.p2align 6
.amdhsa_kernel gemm1_kernel
  .amdhsa_next_free_vgpr 232
  .amdhsa_next_free_sgpr 102
  .amdhsa_accum_offset 232
  .amdhsa_group_segment_fixed_size 0
  .amdhsa_kernarg_size 80
  .amdhsa_user_sgpr_count 2
  .amdhsa_user_sgpr_kernarg_segment_ptr 1
  .amdhsa_system_sgpr_workgroup_id_x 1
.end_amdhsa_kernel
.p2align 6
.amdhsa_kernel mid_kernel
  .amdhsa_next_free_vgpr 128
  .amdhsa_next_free_sgpr 102
  .amdhsa_accum_offset 128
  .amdhsa_group_segment_fixed_size 0
  .amdhsa_kernarg_size 80
  .amdhsa_user_sgpr_count 2
  .amdhsa_user_sgpr_kernarg_segment_ptr 1
  .amdhsa_system_sgpr_workgroup_id_x 1
.end_amdhsa_kernel
.p2align 6
.amdhsa_kernel gemm2_kernel
  .amdhsa_next_free_vgpr 152
  .amdhsa_next_free_sgpr 102
  .amdhsa_accum_offset 152
  .amdhsa_group_segment_fixed_size 0
  .amdhsa_kernarg_size 80
  .amdhsa_user_sgpr_count 2
  .amdhsa_user_sgpr_kernarg_segment_ptr 1
  .amdhsa_system_sgpr_workgroup_id_x 1
.end_amdhsa_kernel
.p2align 6
.amdhsa_kernel joint_kernel
  .amdhsa_next_free_vgpr 384
  .amdhsa_next_free_sgpr 102
  .amdhsa_accum_offset 256
  .amdhsa_group_segment_fixed_size 0
  .amdhsa_kernarg_size 80
  .amdhsa_user_sgpr_count 2
  .amdhsa_user_sgpr_kernarg_segment_ptr 1
  .amdhsa_system_sgpr_workgroup_id_x 1
.end_amdhsa_kernel
```

```asm
; @launch kernel=prep_kernel grid=(937,1,1) block=(256,1,1) lds=40960
; @launch kernel=gemm1_kernel grid=(256,1,1) block=(512,1,1) lds=143360
; @launch kernel=mid_kernel grid=(704,1,1) block=(256,1,1) lds=57344
; @launch kernel=gemm2_kernel grid=(256,1,1) block=(512,1,1) lds=143360
; @launch kernel=joint_kernel grid=(250,1,1) block=(512,1,1) lds=149504
.amdgcn_target "amdgcn-amd-amdhsa--gfx950"
.text
.globl prep_kernel
.p2align 8
.type prep_kernel,@function
prep_kernel:
    s_cmp_ge_u32 s2, 937
    s_cbranch_scc1 L_prep_kernel_done
    v_readfirstlane_b32 s20, v0
    s_lshr_b32 s20, s20, 6
    s_cmp_lt_u32 s2, 13
    s_cbranch_scc1 L_prep_kernel_slab
    s_cmp_ge_u32 s2, 681
    s_cbranch_scc1 L_prep_kernel_g
    s_load_dwordx2 s[4:5], s[0:1], 0
    s_load_dwordx2 s[6:7], s[0:1], 72
    s_sub_u32 s24, s2, 13
    s_cmp_ge_u32 s24, 334
    s_cselect_b32 s25, 1, 0
    s_mul_i32 s26, s25, 334
    s_sub_u32 s24, s24, s26
    s_lshr_b32 s26, s24, 1
    s_and_b32 s27, s24, 1
    v_and_b32 v1, 63, v0
    v_lshrrev_b32 v2, 3, v1
    s_mul_i32 s28, s26, 96
    s_add_u32 s28, s28, s27
    s_sub_u32 s28, s28, 15
    v_lshlrev_b32 v3, 1, v2
    v_add_u32 v3, s28, v3
    v_lshlrev_b32 v3, 9, v3
    s_lshl_b32 s29, s20, 7
    v_add_u32 v3, s29, v3
    v_bfe_u32 v4, v2, 1, 1
    v_lshlrev_b32 v4, 1, v4
    v_and_b32 v5, 7, v1
    v_xor_b32 v4, v4, v5
    v_lshl_add_u32 v3, v4, 4, v3
    v_xor_b32 v4, 64, v3
    s_waitcnt lgkmcnt(0)
    s_mul_i32 s30, s25, 8192000
    s_add_u32 s8, s4, s30
    s_addc_u32 s9, s5, 0
    s_mov_b32 s10, 8192000
    s_mov_b32 s11, 0x00020000
    s_lshl_b32 s31, s20, 13
    s_add_u32 m0, s31, 0
    v_add_u32 v5, 0, v3
    buffer_load_dwordx4 v5, s[8:11], 0 offen lds
    s_add_u32 m0, s31, 1024
    v_add_u32 v5, 8192, v4
    buffer_load_dwordx4 v5, s[8:11], 0 offen lds
    s_add_u32 m0, s31, 2048
    v_add_u32 v5, 16384, v3
    buffer_load_dwordx4 v5, s[8:11], 0 offen lds
    s_add_u32 m0, s31, 3072
    v_add_u32 v5, 24576, v4
    buffer_load_dwordx4 v5, s[8:11], 0 offen lds
    s_add_u32 m0, s31, 4096
    v_add_u32 v5, 32768, v3
    buffer_load_dwordx4 v5, s[8:11], 0 offen lds
    s_add_u32 m0, s31, 5120
    v_add_u32 v5, 40960, v4
    buffer_load_dwordx4 v5, s[8:11], 0 offen lds
    s_add_u32 m0, s31, 6144
    v_add_u32 v5, 49152, v3
    buffer_load_dwordx4 v5, s[8:11], 0 offen lds
    s_add_u32 m0, s31, 7168
    v_add_u32 v5, 57344, v4
    buffer_load_dwordx4 v5, s[8:11], 0 offen lds
    s_add_u32 s12, s6, 0
    s_addc_u32 s13, s7, 0
    s_mov_b32 s14, 21889024
    s_mov_b32 s15, 0x00020000
    v_mov_b32 v8, v1
    s_lshl_b32 s32, s20, 4
    v_lshlrev_b32 v6, 4, v1
    s_lshl_b32 s33, s20, 11
    v_add_u32 v7, s33, v6
    v_and_b32 v9, 15, v8
    v_lshrrev_b32 v10, 4, v8
    v_or_b32 v11, 1, v9
    v_add_u32 v11, s32, v11
    v_cvt_f32_u32 v11, v11
    v_mul_f32 v11, 0x3c000000, v11
    v_lshlrev_b32 v10, 3, v10
    v_add_u32 v10, 0, v10
    v_cvt_f32_u32 v10, v10
    v_and_b32 v9, 1, v9
    v_cvt_f32_u32 v9, v9
    v_mul_f32 v9, 0x3e800000, v9
    v_fma_f32 v12, v11, v10, v9
    v_fract_f32 v13, v12
    v_add_f32 v12, v12, v11
    v_fract_f32 v14, v12
    v_add_f32 v12, v12, v11
    v_fract_f32 v15, v12
    v_add_f32 v12, v12, v11
    v_fract_f32 v16, v12
    v_add_f32 v12, v12, v11
    v_fract_f32 v17, v12
    v_add_f32 v12, v12, v11
    v_fract_f32 v18, v12
    v_add_f32 v12, v12, v11
    v_fract_f32 v19, v12
    v_add_f32 v12, v12, v11
    v_fract_f32 v20, v12
    v_cos_f32 v13, v13
    v_cos_f32 v14, v14
    v_cos_f32 v15, v15
    v_cos_f32 v16, v16
    v_cos_f32 v17, v17
    v_cos_f32 v18, v18
    v_cos_f32 v19, v19
    v_cos_f32 v20, v20
    s_nop 0
    v_cvt_pk_bf16_f32 v24, v13, v14
    v_cvt_pk_bf16_f32 v25, v15, v16
    v_cvt_pk_bf16_f32 v26, v17, v18
    v_cvt_pk_bf16_f32 v27, v19, v20
    ds_write_b128 v7, v[24:27] offset:32768
    v_and_b32 v9, 15, v8
    v_lshrrev_b32 v10, 4, v8
    v_or_b32 v11, 1, v9
    v_add_u32 v11, s32, v11
    v_cvt_f32_u32 v11, v11
    v_mul_f32 v11, 0x3c000000, v11
    v_lshlrev_b32 v10, 3, v10
    v_add_u32 v10, 32, v10
    v_cvt_f32_u32 v10, v10
    v_and_b32 v9, 1, v9
    v_cvt_f32_u32 v9, v9
    v_mul_f32 v9, 0x3e800000, v9
    v_fma_f32 v12, v11, v10, v9
    v_fract_f32 v13, v12
    v_add_f32 v12, v12, v11
    v_fract_f32 v14, v12
    v_add_f32 v12, v12, v11
    v_fract_f32 v15, v12
    v_add_f32 v12, v12, v11
    v_fract_f32 v16, v12
    v_add_f32 v12, v12, v11
    v_fract_f32 v17, v12
    v_add_f32 v12, v12, v11
    v_fract_f32 v18, v12
    v_add_f32 v12, v12, v11
    v_fract_f32 v19, v12
    v_add_f32 v12, v12, v11
    v_fract_f32 v20, v12
    v_cos_f32 v13, v13
    v_cos_f32 v14, v14
    v_cos_f32 v15, v15
    v_cos_f32 v16, v16
    v_cos_f32 v17, v17
    v_cos_f32 v18, v18
    v_cos_f32 v19, v19
    v_cos_f32 v20, v20
    s_nop 0
    v_cvt_pk_bf16_f32 v28, v13, v14
    v_cvt_pk_bf16_f32 v29, v15, v16
    v_cvt_pk_bf16_f32 v30, v17, v18
    v_cvt_pk_bf16_f32 v31, v19, v20
    ds_write_b128 v7, v[28:31] offset:33792
    v_bfe_u32 v8, v1, 2, 2
    v_lshrrev_b32 v9, 4, v1
    v_lshl_add_u32 v10, v9, 3, v8
    v_lshlrev_b32 v10, 7, v10
    v_lshrrev_b32 v8, 1, v8
    v_and_b32 v11, 1, v9
    v_lshl_add_u32 v8, v11, 1, v8
    v_lshlrev_b32 v8, 1, v8
    v_bfe_u32 v11, v1, 1, 1
    v_xor_b32 v8, v8, v11
    v_lshl_add_u32 v10, v8, 4, v10
    v_and_b32 v11, 1, v1
    v_lshl_add_u32 v10, v11, 3, v10
    v_add_u32 v10, s31, v10
    v_xor_b32 v12, 0, v10
    v_xor_b32 v13, 32, v10
    v_xor_b32 v14, 64, v10
    v_xor_b32 v15, 96, v10
    v_bfe_u32 v8, v1, 1, 3
    s_mov_b32 s33, 684032
    v_mul_lo_u32 v8, v8, s33
    v_and_b32 v11, 1, v1
    v_lshl_add_u32 v8, v11, 6, v8
    v_lshl_add_u32 v16, v9, 4, v8
    s_mul_i32 s34, s25, 167
    s_add_u32 s34, s34, s26
    s_lshl_b32 s34, s34, 11
    s_lshl_b32 s35, s27, 3
    s_lshl_b32 s36, s20, 1
    s_add_u32 s35, s35, s36
    s_lshl_b32 s35, s35, 7
    s_add_u32 s34, s34, s35
    s_waitcnt lgkmcnt(0)
    s_barrier
    ds_read_b128 v[24:27], v6 offset:32768
    ds_read_b128 v[28:31], v6 offset:33792
    ds_read_b128 v[32:35], v6 offset:34816
    ds_read_b128 v[36:39], v6 offset:35840
    ds_read_b128 v[40:43], v6 offset:36864
    ds_read_b128 v[44:47], v6 offset:37888
    ds_read_b128 v[48:51], v6 offset:38912
    ds_read_b128 v[52:55], v6 offset:39936
    s_waitcnt vmcnt(0)
    ds_read_b64_tr_b16 v[56:57], v12 offset:0
    ds_read_b64_tr_b16 v[58:59], v12 offset:512
    ds_read_b64_tr_b16 v[60:61], v12 offset:4096
    ds_read_b64_tr_b16 v[62:63], v12 offset:4608
    ds_read_b64_tr_b16 v[64:65], v13 offset:0
    ds_read_b64_tr_b16 v[66:67], v13 offset:512
    ds_read_b64_tr_b16 v[68:69], v13 offset:4096
    ds_read_b64_tr_b16 v[70:71], v13 offset:4608
    s_waitcnt lgkmcnt(0)
    v_mfma_f32_16x16x32_bf16 v[72:75], v[56:59], v[24:27], 0
    v_mfma_f32_16x16x32_bf16 v[76:79], v[56:59], v[32:35], 0
    v_mfma_f32_16x16x32_bf16 v[80:83], v[56:59], v[40:43], 0
    v_mfma_f32_16x16x32_bf16 v[84:87], v[56:59], v[48:51], 0
    v_mfma_f32_16x16x32_bf16 v[88:91], v[64:67], v[24:27], 0
    v_mfma_f32_16x16x32_bf16 v[92:95], v[64:67], v[32:35], 0
    v_mfma_f32_16x16x32_bf16 v[96:99], v[64:67], v[40:43], 0
    v_mfma_f32_16x16x32_bf16 v[100:103], v[64:67], v[48:51], 0
    v_mfma_f32_16x16x32_bf16 v[72:75], v[60:63], v[28:31], v[72:75]
    v_mfma_f32_16x16x32_bf16 v[76:79], v[60:63], v[36:39], v[76:79]
    v_mfma_f32_16x16x32_bf16 v[80:83], v[60:63], v[44:47], v[80:83]
    v_mfma_f32_16x16x32_bf16 v[84:87], v[60:63], v[52:55], v[84:87]
    v_mfma_f32_16x16x32_bf16 v[88:91], v[68:71], v[28:31], v[88:91]
    v_mfma_f32_16x16x32_bf16 v[92:95], v[68:71], v[36:39], v[92:95]
    v_mfma_f32_16x16x32_bf16 v[96:99], v[68:71], v[44:47], v[96:99]
    v_mfma_f32_16x16x32_bf16 v[100:103], v[68:71], v[52:55], v[100:103]
    s_nop 7
    v_cvt_pk_bf16_f32 v104, v72, v73
    v_cvt_pk_bf16_f32 v105, v74, v75
    v_cvt_pk_bf16_f32 v106, v88, v89
    v_cvt_pk_bf16_f32 v107, v90, v91
    s_add_u32 s35, s34, 0
    buffer_store_dwordx4 v[104:107], v16, s[12:15], s35 offen sc1
    s_nop 1
    v_cvt_pk_bf16_f32 v108, v76, v77
    v_cvt_pk_bf16_f32 v109, v78, v79
    v_cvt_pk_bf16_f32 v110, v92, v93
    v_cvt_pk_bf16_f32 v111, v94, v95
    s_add_u32 s35, s34, 5472256
    buffer_store_dwordx4 v[108:111], v16, s[12:15], s35 offen sc1
    s_nop 1
    v_cvt_pk_bf16_f32 v104, v80, v81
    v_cvt_pk_bf16_f32 v105, v82, v83
    v_cvt_pk_bf16_f32 v106, v96, v97
    v_cvt_pk_bf16_f32 v107, v98, v99
    s_add_u32 s35, s34, 10944512
    buffer_store_dwordx4 v[104:107], v16, s[12:15], s35 offen sc1
    s_nop 1
    v_cvt_pk_bf16_f32 v108, v84, v85
    v_cvt_pk_bf16_f32 v109, v86, v87
    v_cvt_pk_bf16_f32 v110, v100, v101
    v_cvt_pk_bf16_f32 v111, v102, v103
    s_add_u32 s35, s34, 16416768
    buffer_store_dwordx4 v[108:111], v16, s[12:15], s35 offen sc1
    s_nop 1
    ds_read_b64_tr_b16 v[56:57], v14 offset:0
    ds_read_b64_tr_b16 v[58:59], v14 offset:512
    ds_read_b64_tr_b16 v[60:61], v14 offset:4096
    ds_read_b64_tr_b16 v[62:63], v14 offset:4608
    ds_read_b64_tr_b16 v[64:65], v15 offset:0
    ds_read_b64_tr_b16 v[66:67], v15 offset:512
    ds_read_b64_tr_b16 v[68:69], v15 offset:4096
    ds_read_b64_tr_b16 v[70:71], v15 offset:4608
    s_waitcnt lgkmcnt(0)
    v_mfma_f32_16x16x32_bf16 v[72:75], v[56:59], v[24:27], 0
    v_mfma_f32_16x16x32_bf16 v[76:79], v[56:59], v[32:35], 0
    v_mfma_f32_16x16x32_bf16 v[80:83], v[56:59], v[40:43], 0
    v_mfma_f32_16x16x32_bf16 v[84:87], v[56:59], v[48:51], 0
    v_mfma_f32_16x16x32_bf16 v[88:91], v[64:67], v[24:27], 0
    v_mfma_f32_16x16x32_bf16 v[92:95], v[64:67], v[32:35], 0
    v_mfma_f32_16x16x32_bf16 v[96:99], v[64:67], v[40:43], 0
    v_mfma_f32_16x16x32_bf16 v[100:103], v[64:67], v[48:51], 0
    v_mfma_f32_16x16x32_bf16 v[72:75], v[60:63], v[28:31], v[72:75]
    v_mfma_f32_16x16x32_bf16 v[76:79], v[60:63], v[36:39], v[76:79]
    v_mfma_f32_16x16x32_bf16 v[80:83], v[60:63], v[44:47], v[80:83]
    v_mfma_f32_16x16x32_bf16 v[84:87], v[60:63], v[52:55], v[84:87]
    v_mfma_f32_16x16x32_bf16 v[88:91], v[68:71], v[28:31], v[88:91]
    v_mfma_f32_16x16x32_bf16 v[92:95], v[68:71], v[36:39], v[92:95]
    v_mfma_f32_16x16x32_bf16 v[96:99], v[68:71], v[44:47], v[96:99]
    v_mfma_f32_16x16x32_bf16 v[100:103], v[68:71], v[52:55], v[100:103]
    s_nop 7
    v_cvt_pk_bf16_f32 v104, v72, v73
    v_cvt_pk_bf16_f32 v105, v74, v75
    v_cvt_pk_bf16_f32 v106, v88, v89
    v_cvt_pk_bf16_f32 v107, v90, v91
    s_add_u32 s35, s34, 128
    buffer_store_dwordx4 v[104:107], v16, s[12:15], s35 offen sc1
    s_nop 1
    v_cvt_pk_bf16_f32 v108, v76, v77
    v_cvt_pk_bf16_f32 v109, v78, v79
    v_cvt_pk_bf16_f32 v110, v92, v93
    v_cvt_pk_bf16_f32 v111, v94, v95
    s_add_u32 s35, s34, 5472384
    buffer_store_dwordx4 v[108:111], v16, s[12:15], s35 offen sc1
    s_nop 1
    v_cvt_pk_bf16_f32 v104, v80, v81
    v_cvt_pk_bf16_f32 v105, v82, v83
    v_cvt_pk_bf16_f32 v106, v96, v97
    v_cvt_pk_bf16_f32 v107, v98, v99
    s_add_u32 s35, s34, 10944640
    buffer_store_dwordx4 v[104:107], v16, s[12:15], s35 offen sc1
    s_nop 1
    v_cvt_pk_bf16_f32 v108, v84, v85
    v_cvt_pk_bf16_f32 v109, v86, v87
    v_cvt_pk_bf16_f32 v110, v100, v101
    v_cvt_pk_bf16_f32 v111, v102, v103
    s_add_u32 s35, s34, 16416896
    buffer_store_dwordx4 v[108:111], v16, s[12:15], s35 offen sc1
    s_nop 1
    s_endpgm
L_prep_kernel_g:
    s_sub_u32 s3, s2, 681
    s_load_dwordx2 s[4:5], s[0:1], 8
    s_load_dwordx2 s[6:7], s[0:1], 72
    s_lshr_b32 s24, s3, 4
    s_bfe_u32 s25, s3, 0x20002
    s_and_b32 s26, s3, 3
    s_lshr_b32 s27, s24, 3
    s_and_b32 s28, s24, 7
    v_and_b32 v1, 63, v0
    v_lshrrev_b32 v2, 3, v1
    v_lshrrev_b32 v3, 2, v2
    v_lshlrev_b32 v3, 4, v3
    v_and_b32 v4, 3, v2
    v_add_u32 v3, v3, v4
    s_lshl_b32 s29, s25, 2
    s_lshl_b32 s30, s28, 5
    s_add_u32 s29, s29, s30
    v_add_u32 v3, s29, v3
    v_lshlrev_b32 v3, 9, v3
    v_and_b32 v4, 7, v1
    s_lshr_b32 s30, s20, 1
    s_lshl_b32 s30, s30, 2
    v_xor_b32 v4, s30, v4
    v_lshl_add_u32 v3, v4, 4, v3
    s_lshl_b32 s30, s26, 7
    v_add_u32 v3, s30, v3
    v_xor_b32 v4, 32, v3
    s_waitcnt lgkmcnt(0)
    s_mov_b32 s8, s4
    s_mov_b32 s9, s5
    s_mov_b32 s10, 4063232
    s_mov_b32 s11, 0x00020000
    s_add_u32 s12, s6, 21954560
    s_addc_u32 s13, s7, 0
    s_mov_b32 s14, 16916480
    s_mov_b32 s15, 0x00020000
    s_lshl_b32 s30, s20, 3
    s_add_u32 s30, s30, s27
    s_lshl_b32 s30, s30, 17
    s_mul_i32 s31, s20, 4608
    s_add_u32 m0, s31, 0
    s_add_u32 s32, s30, 0
    buffer_load_dwordx4 v3, s[8:11], s32 offen lds
    s_add_u32 m0, s31, 1152
    s_add_u32 s32, s30, 262144
    buffer_load_dwordx4 v3, s[8:11], s32 offen lds
    s_add_u32 m0, s31, 2304
    s_add_u32 s32, s30, 524288
    buffer_load_dwordx4 v4, s[8:11], s32 offen lds
    s_add_u32 m0, s31, 3456
    s_add_u32 s32, s30, 786432
    buffer_load_dwordx4 v4, s[8:11], s32 offen lds
    v_and_b32 v8, 15, v1
    v_or_b32 v9, 1, v8
    s_lshl_b32 s33, s20, 4
    v_add_u32 v9, s33, v9
    v_cvt_f32_u32 v9, v9
    v_mul_f32 v9, 0x3c000000, v9
    v_bfe_u32 v10, v1, 4, 1
    v_lshlrev_b32 v10, 3, v10
    v_cvt_f32_u32 v10, v10
    v_and_b32 v8, 1, v8
    v_cvt_f32_u32 v8, v8
    v_mul_f32 v8, 0x3f400000, v8
    v_fma_f32 v11, v9, v10, v8
    v_fract_f32 v12, v11
    v_add_f32 v11, v11, v9
    v_fract_f32 v13, v11
    v_add_f32 v11, v11, v9
    v_fract_f32 v14, v11
    v_add_f32 v11, v11, v9
    v_fract_f32 v15, v11
    v_add_f32 v11, v11, v9
    v_fract_f32 v16, v11
    v_add_f32 v11, v11, v9
    v_fract_f32 v17, v11
    v_add_f32 v11, v11, v9
    v_fract_f32 v18, v11
    v_add_f32 v11, v11, v9
    v_fract_f32 v19, v11
    v_cos_f32 v12, v12
    v_cos_f32 v13, v13
    v_cos_f32 v14, v14
    v_cos_f32 v15, v15
    v_cos_f32 v16, v16
    v_cos_f32 v17, v17
    v_cos_f32 v18, v18
    v_cos_f32 v19, v19
    s_nop 0
    v_mul_f32 v12, 0x3d000000, v12
    v_mul_f32 v13, 0x3d000000, v13
    v_mul_f32 v14, 0x3d000000, v14
    v_mul_f32 v15, 0x3d000000, v15
    v_mul_f32 v16, 0x3d000000, v16
    v_mul_f32 v17, 0x3d000000, v17
    v_mul_f32 v18, 0x3d000000, v18
    v_mul_f32 v19, 0x3d000000, v19
    v_cvt_pk_bf16_f32 v20, v12, v13
    v_cvt_pk_bf16_f32 v21, v14, v15
    v_cvt_pk_bf16_f32 v22, v16, v17
    v_cvt_pk_bf16_f32 v23, v18, v19
    v_lshlrev_b32 v28, 16, v20
    v_and_b32 v29, 0xffff0000, v20
    v_sub_f32 v28, v12, v28
    v_sub_f32 v29, v13, v29
    v_cvt_pk_bf16_f32 v24, v28, v29
    v_lshlrev_b32 v28, 16, v21
    v_and_b32 v29, 0xffff0000, v21
    v_sub_f32 v28, v14, v28
    v_sub_f32 v29, v15, v29
    v_cvt_pk_bf16_f32 v25, v28, v29
    v_lshlrev_b32 v28, 16, v22
    v_and_b32 v29, 0xffff0000, v22
    v_sub_f32 v28, v16, v28
    v_sub_f32 v29, v17, v29
    v_cvt_pk_bf16_f32 v26, v28, v29
    v_lshlrev_b32 v28, 16, v23
    v_and_b32 v29, 0xffff0000, v23
    v_sub_f32 v28, v18, v28
    v_sub_f32 v29, v19, v29
    v_cvt_pk_bf16_f32 v27, v28, v29
    v_cmp_gt_u32 vcc, 32, v1
    s_nop 1
    v_cndmask_b32 v20, v24, v20, vcc
    v_cndmask_b32 v21, v25, v21, vcc
    v_cndmask_b32 v22, v26, v22, vcc
    v_cndmask_b32 v23, v27, v23, vcc
    v_lshlrev_b32 v28, 4, v1
    s_lshl_b32 s33, s20, 10
    v_add_u32 v29, s33, v28
    ds_write_b128 v29, v[20:23] offset:18432
    v_bfe_u32 v30, v1, 2, 2
    v_bfe_u32 v31, v1, 4, 1
    v_lshl_add_u32 v32, v31, 3, v30
    v_mul_u32_u24 v32, 1152, v32
    v_lshrrev_b32 v30, 1, v30
    v_lshl_add_u32 v30, v31, 1, v30
    v_lshlrev_b32 v30, 1, v30
    v_bfe_u32 v31, v1, 1, 1
    s_lshl_b32 s33, s20, 1
    v_add_u32 v31, s33, v31
    v_xor_b32 v30, v30, v31
    v_lshl_add_u32 v32, v30, 4, v32
    v_and_b32 v30, 1, v1
    v_lshl_add_u32 v32, v30, 3, v32
    v_lshrrev_b32 v30, 4, v1
    s_mov_b32 s33, 1057280
    v_mul_lo_u32 v30, v30, s33
    v_and_b32 v31, 15, v1
    v_lshl_add_u32 v33, v31, 4, v30
    s_lshl_b32 s34, s24, 15
    s_lshl_b32 s35, s26, 2
    s_add_u32 s35, s35, s20
    s_lshl_b32 s35, s35, 11
    s_add_u32 s34, s34, s35
    s_lshl_b32 s35, s25, 8
    s_add_u32 s34, s34, s35
    s_waitcnt vmcnt(0) lgkmcnt(0)
    s_barrier
    ds_read_b128 v[36:39], v28 offset:18432
    ds_read_b128 v[40:43], v28 offset:19456
    ds_read_b128 v[44:47], v28 offset:20480
    ds_read_b128 v[48:51], v28 offset:21504
    ds_read_b64_tr_b16 v[52:53], v32 offset:0
    ds_read_b64_tr_b16 v[54:55], v32 offset:4608
    ds_read_b64_tr_b16 v[56:57], v32 offset:128
    ds_read_b64_tr_b16 v[58:59], v32 offset:4736
    ds_read_b64_tr_b16 v[60:61], v32 offset:256
    ds_read_b64_tr_b16 v[62:63], v32 offset:4864
    ds_read_b64_tr_b16 v[64:65], v32 offset:384
    ds_read_b64_tr_b16 v[66:67], v32 offset:4992
    ds_read_b64_tr_b16 v[68:69], v32 offset:512
    ds_read_b64_tr_b16 v[70:71], v32 offset:5120
    s_waitcnt lgkmcnt(8)
    ds_read_b64_tr_b16 v[72:73], v32 offset:640
    ds_read_b64_tr_b16 v[74:75], v32 offset:5248
    ds_read_b64_tr_b16 v[76:77], v32 offset:768
    ds_read_b64_tr_b16 v[78:79], v32 offset:5376
    ds_read_b64_tr_b16 v[80:81], v32 offset:896
    ds_read_b64_tr_b16 v[82:83], v32 offset:5504
    s_waitcnt lgkmcnt(0)
    v_mfma_f32_16x16x32_bf16 v[84:87], v[36:39], v[52:55], 0
    v_mfma_f32_16x16x32_bf16 v[88:91], v[36:39], v[56:59], 0
    v_mfma_f32_16x16x32_bf16 v[92:95], v[36:39], v[60:63], 0
    v_mfma_f32_16x16x32_bf16 v[96:99], v[36:39], v[64:67], 0
    v_mfma_f32_16x16x32_bf16 v[100:103], v[36:39], v[68:71], 0
    v_mfma_f32_16x16x32_bf16 v[104:107], v[36:39], v[72:75], 0
    v_mfma_f32_16x16x32_bf16 v[108:111], v[36:39], v[76:79], 0
    v_mfma_f32_16x16x32_bf16 v[112:115], v[36:39], v[80:83], 0
    s_nop 7
    v_cvt_pk_bf16_f32 v116, v84, v88
    v_cvt_pk_bf16_f32 v117, v92, v96
    v_cvt_pk_bf16_f32 v118, v100, v104
    v_cvt_pk_bf16_f32 v119, v108, v112
    s_add_u32 s35, s34, 0
    buffer_store_dwordx4 v[116:119], v33, s[12:15], s35 offen sc1
    s_nop 1
    v_cvt_pk_bf16_f32 v120, v85, v89
    v_cvt_pk_bf16_f32 v121, v93, v97
    v_cvt_pk_bf16_f32 v122, v101, v105
    v_cvt_pk_bf16_f32 v123, v109, v113
    s_add_u32 s35, s34, 1024
    buffer_store_dwordx4 v[120:123], v33, s[12:15], s35 offen sc1
    s_nop 1
    v_cvt_pk_bf16_f32 v116, v86, v90
    v_cvt_pk_bf16_f32 v117, v94, v98
    v_cvt_pk_bf16_f32 v118, v102, v106
    v_cvt_pk_bf16_f32 v119, v110, v114
    s_add_u32 s35, s34, 528640
    buffer_store_dwordx4 v[116:119], v33, s[12:15], s35 offen sc1
    s_nop 1
    v_cvt_pk_bf16_f32 v120, v87, v91
    v_cvt_pk_bf16_f32 v121, v95, v99
    v_cvt_pk_bf16_f32 v122, v103, v107
    v_cvt_pk_bf16_f32 v123, v111, v115
    s_add_u32 s35, s34, 529664
    buffer_store_dwordx4 v[120:123], v33, s[12:15], s35 offen sc1
    s_nop 1
    v_mfma_f32_16x16x32_bf16 v[84:87], v[40:43], v[52:55], 0
    v_mfma_f32_16x16x32_bf16 v[88:91], v[40:43], v[56:59], 0
    v_mfma_f32_16x16x32_bf16 v[92:95], v[40:43], v[60:63], 0
    v_mfma_f32_16x16x32_bf16 v[96:99], v[40:43], v[64:67], 0
    v_mfma_f32_16x16x32_bf16 v[100:103], v[40:43], v[68:71], 0
    v_mfma_f32_16x16x32_bf16 v[104:107], v[40:43], v[72:75], 0
    v_mfma_f32_16x16x32_bf16 v[108:111], v[40:43], v[76:79], 0
    v_mfma_f32_16x16x32_bf16 v[112:115], v[40:43], v[80:83], 0
    s_nop 7
    v_cvt_pk_bf16_f32 v116, v84, v88
    v_cvt_pk_bf16_f32 v117, v92, v96
    v_cvt_pk_bf16_f32 v118, v100, v104
    v_cvt_pk_bf16_f32 v119, v108, v112
    s_add_u32 s35, s34, 4229120
    buffer_store_dwordx4 v[116:119], v33, s[12:15], s35 offen sc1
    s_nop 1
    v_cvt_pk_bf16_f32 v120, v85, v89
    v_cvt_pk_bf16_f32 v121, v93, v97
    v_cvt_pk_bf16_f32 v122, v101, v105
    v_cvt_pk_bf16_f32 v123, v109, v113
    s_add_u32 s35, s34, 4230144
    buffer_store_dwordx4 v[120:123], v33, s[12:15], s35 offen sc1
    s_nop 1
    v_cvt_pk_bf16_f32 v116, v86, v90
    v_cvt_pk_bf16_f32 v117, v94, v98
    v_cvt_pk_bf16_f32 v118, v102, v106
    v_cvt_pk_bf16_f32 v119, v110, v114
    s_add_u32 s35, s34, 4757760
    buffer_store_dwordx4 v[116:119], v33, s[12:15], s35 offen sc1
    s_nop 1
    v_cvt_pk_bf16_f32 v120, v87, v91
    v_cvt_pk_bf16_f32 v121, v95, v99
    v_cvt_pk_bf16_f32 v122, v103, v107
    v_cvt_pk_bf16_f32 v123, v111, v115
    s_add_u32 s35, s34, 4758784
    buffer_store_dwordx4 v[120:123], v33, s[12:15], s35 offen sc1
    s_nop 1
    v_mfma_f32_16x16x32_bf16 v[84:87], v[44:47], v[52:55], 0
    v_mfma_f32_16x16x32_bf16 v[88:91], v[44:47], v[56:59], 0
    v_mfma_f32_16x16x32_bf16 v[92:95], v[44:47], v[60:63], 0
    v_mfma_f32_16x16x32_bf16 v[96:99], v[44:47], v[64:67], 0
    v_mfma_f32_16x16x32_bf16 v[100:103], v[44:47], v[68:71], 0
    v_mfma_f32_16x16x32_bf16 v[104:107], v[44:47], v[72:75], 0
    v_mfma_f32_16x16x32_bf16 v[108:111], v[44:47], v[76:79], 0
    v_mfma_f32_16x16x32_bf16 v[112:115], v[44:47], v[80:83], 0
    s_nop 7
    v_cvt_pk_bf16_f32 v116, v84, v88
    v_cvt_pk_bf16_f32 v117, v92, v96
    v_cvt_pk_bf16_f32 v118, v100, v104
    v_cvt_pk_bf16_f32 v119, v108, v112
    s_add_u32 s35, s34, 8458240
    buffer_store_dwordx4 v[116:119], v33, s[12:15], s35 offen sc1
    s_nop 1
    v_cvt_pk_bf16_f32 v120, v85, v89
    v_cvt_pk_bf16_f32 v121, v93, v97
    v_cvt_pk_bf16_f32 v122, v101, v105
    v_cvt_pk_bf16_f32 v123, v109, v113
    s_add_u32 s35, s34, 8459264
    buffer_store_dwordx4 v[120:123], v33, s[12:15], s35 offen sc1
    s_nop 1
    v_cvt_pk_bf16_f32 v116, v86, v90
    v_cvt_pk_bf16_f32 v117, v94, v98
    v_cvt_pk_bf16_f32 v118, v102, v106
    v_cvt_pk_bf16_f32 v119, v110, v114
    s_add_u32 s35, s34, 8986880
    buffer_store_dwordx4 v[116:119], v33, s[12:15], s35 offen sc1
    s_nop 1
    v_cvt_pk_bf16_f32 v120, v87, v91
    v_cvt_pk_bf16_f32 v121, v95, v99
    v_cvt_pk_bf16_f32 v122, v103, v107
    v_cvt_pk_bf16_f32 v123, v111, v115
    s_add_u32 s35, s34, 8987904
    buffer_store_dwordx4 v[120:123], v33, s[12:15], s35 offen sc1
    s_nop 1
    v_mfma_f32_16x16x32_bf16 v[84:87], v[48:51], v[52:55], 0
    v_mfma_f32_16x16x32_bf16 v[88:91], v[48:51], v[56:59], 0
    v_mfma_f32_16x16x32_bf16 v[92:95], v[48:51], v[60:63], 0
    v_mfma_f32_16x16x32_bf16 v[96:99], v[48:51], v[64:67], 0
    v_mfma_f32_16x16x32_bf16 v[100:103], v[48:51], v[68:71], 0
    v_mfma_f32_16x16x32_bf16 v[104:107], v[48:51], v[72:75], 0
    v_mfma_f32_16x16x32_bf16 v[108:111], v[48:51], v[76:79], 0
    v_mfma_f32_16x16x32_bf16 v[112:115], v[48:51], v[80:83], 0
    s_nop 7
    v_cvt_pk_bf16_f32 v116, v84, v88
    v_cvt_pk_bf16_f32 v117, v92, v96
    v_cvt_pk_bf16_f32 v118, v100, v104
    v_cvt_pk_bf16_f32 v119, v108, v112
    s_add_u32 s35, s34, 12687360
    buffer_store_dwordx4 v[116:119], v33, s[12:15], s35 offen sc1
    s_nop 1
    v_cvt_pk_bf16_f32 v120, v85, v89
    v_cvt_pk_bf16_f32 v121, v93, v97
    v_cvt_pk_bf16_f32 v122, v101, v105
    v_cvt_pk_bf16_f32 v123, v109, v113
    s_add_u32 s35, s34, 12688384
    buffer_store_dwordx4 v[120:123], v33, s[12:15], s35 offen sc1
    s_nop 1
    v_cvt_pk_bf16_f32 v116, v86, v90
    v_cvt_pk_bf16_f32 v117, v94, v98
    v_cvt_pk_bf16_f32 v118, v102, v106
    v_cvt_pk_bf16_f32 v119, v110, v114
    s_add_u32 s35, s34, 13216000
    buffer_store_dwordx4 v[116:119], v33, s[12:15], s35 offen sc1
    s_nop 1
    v_cvt_pk_bf16_f32 v120, v87, v91
    v_cvt_pk_bf16_f32 v121, v95, v99
    v_cvt_pk_bf16_f32 v122, v103, v107
    v_cvt_pk_bf16_f32 v123, v111, v115
    s_add_u32 s35, s34, 13217024
    buffer_store_dwordx4 v[120:123], v33, s[12:15], s35 offen sc1
    s_nop 1
    s_endpgm
L_prep_kernel_slab:
    s_load_dwordx2 s[6:7], s[0:1], 72
    s_cmp_eq_u32 s2, 12
    s_cbranch_scc1 L_prep_kernel_tab
    s_lshr_b32 s24, s2, 2
    s_and_b32 s26, s2, 3
    s_mov_b32 s25, 40
    s_cmp_eq_u32 s24, 1
    s_cselect_b32 s25, 32, s25
    s_cmp_eq_u32 s24, 2
    s_cselect_b32 s25, 48, s25
    s_load_dwordx2 s[4:5], s[0:1], s25
    s_load_dwordx2 s[28:29], s[0:1], 24
    v_and_b32 v1, 63, v0
    v_lshrrev_b32 v2, 3, v1
    s_lshl_b32 s27, s20, 6
    v_add_u32 v2, s27, v2
    v_lshlrev_b32 v2, 9, v2
    v_and_b32 v3, 7, v1
    v_lshl_add_u32 v2, v3, 4, v2
    s_lshl_b32 s27, s26, 7
    v_add_u32 v2, s27, v2
    s_waitcnt lgkmcnt(0)
    s_mov_b32 s8, s4
    s_mov_b32 s9, s5
    s_mov_b32 s10, 131072
    s_mov_b32 s11, 0x00020000
    s_add_u32 s12, s6, 83312640
    s_addc_u32 s13, s7, 0
    s_mov_b32 s14, 294912
    s_mov_b32 s15, 0x00020000
    s_lshl_b32 s31, s20, 13
    s_add_u32 m0, s31, 0
    s_mov_b32 s32, 0
    buffer_load_dwordx4 v2, s[8:11], s32 offen lds
    s_add_u32 m0, s31, 1024
    s_mov_b32 s32, 4096
    buffer_load_dwordx4 v2, s[8:11], s32 offen lds
    s_add_u32 m0, s31, 2048
    s_mov_b32 s32, 8192
    buffer_load_dwordx4 v2, s[8:11], s32 offen lds
    s_add_u32 m0, s31, 3072
    s_mov_b32 s32, 12288
    buffer_load_dwordx4 v2, s[8:11], s32 offen lds
    s_add_u32 m0, s31, 4096
    s_mov_b32 s32, 16384
    buffer_load_dwordx4 v2, s[8:11], s32 offen lds
    s_add_u32 m0, s31, 5120
    s_mov_b32 s32, 20480
    buffer_load_dwordx4 v2, s[8:11], s32 offen lds
    s_add_u32 m0, s31, 6144
    s_mov_b32 s32, 24576
    buffer_load_dwordx4 v2, s[8:11], s32 offen lds
    s_add_u32 m0, s31, 7168
    s_mov_b32 s32, 28672
    buffer_load_dwordx4 v2, s[8:11], s32 offen lds
    s_cmp_eq_u32 s24, 0
    s_cbranch_scc1 L_prep_kernel_ge
    v_bfe_u32 v4, v1, 2, 2
    v_lshrrev_b32 v5, 5, v1
    v_bfe_u32 v6, v1, 4, 1
    v_and_b32 v7, 3, v1
    s_cmp_eq_u32 s24, 1
    s_cbranch_scc0 L_prep_kernel_wo
    v_lshl_add_u32 v8, v5, 4, v4
    v_lshlrev_b32 v8, 7, v8
    v_lshl_add_u32 v8, v6, 5, v8
    v_lshl_add_u32 v8, v7, 3, v8
    s_lshl_b32 s33, s20, 13
    v_add_u32 v8, s33, v8
    s_mov_b32 s34, 32768
    s_lshl_b32 s35, s26, 15
    s_add_u32 s34, s34, s35
    s_lshl_b32 s35, s20, 12
    s_add_u32 s34, s34, s35
    v_lshlrev_b32 v9, 4, v1
    s_waitcnt vmcnt(0)
    s_barrier
    ds_read_b64_tr_b16 v[16:17], v8 offset:0
    ds_read_b64_tr_b16 v[18:19], v8 offset:1024
    ds_read_b64_tr_b16 v[20:21], v8 offset:512
    ds_read_b64_tr_b16 v[22:23], v8 offset:1536
    ds_read_b64_tr_b16 v[24:25], v8 offset:4096
    ds_read_b64_tr_b16 v[26:27], v8 offset:5120
    ds_read_b64_tr_b16 v[28:29], v8 offset:4608
    ds_read_b64_tr_b16 v[30:31], v8 offset:5632
    s_waitcnt lgkmcnt(0)
    s_add_u32 s35, s34, 0
    buffer_store_dwordx4 v[16:19], v9, s[12:15], s35 offen sc1
    s_add_u32 s35, s34, 1024
    buffer_store_dwordx4 v[20:23], v9, s[12:15], s35 offen sc1
    s_add_u32 s35, s34, 2048
    buffer_store_dwordx4 v[24:27], v9, s[12:15], s35 offen sc1
    s_add_u32 s35, s34, 3072
    buffer_store_dwordx4 v[28:31], v9, s[12:15], s35 offen sc1
    ds_read_b64_tr_b16 v[32:33], v8 offset:64
    ds_read_b64_tr_b16 v[34:35], v8 offset:1088
    ds_read_b64_tr_b16 v[36:37], v8 offset:576
    ds_read_b64_tr_b16 v[38:39], v8 offset:1600
    ds_read_b64_tr_b16 v[40:41], v8 offset:4160
    ds_read_b64_tr_b16 v[42:43], v8 offset:5184
    ds_read_b64_tr_b16 v[44:45], v8 offset:4672
    ds_read_b64_tr_b16 v[46:47], v8 offset:5696
    s_waitcnt lgkmcnt(0)
    s_add_u32 s35, s34, 16384
    buffer_store_dwordx4 v[32:35], v9, s[12:15], s35 offen sc1
    s_add_u32 s35, s34, 17408
    buffer_store_dwordx4 v[36:39], v9, s[12:15], s35 offen sc1
    s_add_u32 s35, s34, 18432
    buffer_store_dwordx4 v[40:43], v9, s[12:15], s35 offen sc1
    s_add_u32 s35, s34, 19456
    buffer_store_dwordx4 v[44:47], v9, s[12:15], s35 offen sc1
    s_endpgm
L_prep_kernel_wo:
    v_lshl_add_u32 v8, v5, 2, v4
    v_lshlrev_b32 v8, 7, v8
    v_lshl_add_u32 v8, v6, 5, v8
    v_and_b32 v10, 1, v7
    v_lshl_add_u32 v8, v10, 4, v8
    v_lshrrev_b32 v10, 1, v7
    v_lshl_add_u32 v8, v10, 3, v8
    s_lshl_b32 s33, s20, 13
    v_add_u32 v8, s33, v8
    s_mov_b32 s34, 163840
    s_lshl_b32 s35, s26, 15
    s_add_u32 s34, s34, s35
    s_lshl_b32 s35, s20, 12
    s_add_u32 s34, s34, s35
    v_lshlrev_b32 v9, 4, v1
    s_waitcnt vmcnt(0)
    s_barrier
    ds_read_b64_tr_b16 v[16:17], v8 offset:0
    ds_read_b64_tr_b16 v[18:19], v8 offset:1024
    ds_read_b64_tr_b16 v[20:21], v8 offset:2048
    ds_read_b64_tr_b16 v[22:23], v8 offset:3072
    ds_read_b64_tr_b16 v[24:25], v8 offset:4096
    ds_read_b64_tr_b16 v[26:27], v8 offset:5120
    ds_read_b64_tr_b16 v[28:29], v8 offset:6144
    ds_read_b64_tr_b16 v[30:31], v8 offset:7168
    s_waitcnt lgkmcnt(0)
    v_mov_b32 v48, 0x3f803f80
    v_mov_b32 v49, 0x3f803f80
    v_mov_b32 v50, 0x3f803f80
    v_mov_b32 v51, 0x3f803f80
    s_nop 1
    v_mfma_f32_32x32x16_bf16 v[64:79], v[16:19], v[48:51], 0
    v_mfma_f32_32x32x16_bf16 v[64:79], v[20:23], v[48:51], v[64:79]
    v_mfma_f32_32x32x16_bf16 v[64:79], v[24:27], v[48:51], v[64:79]
    v_mfma_f32_32x32x16_bf16 v[64:79], v[28:31], v[48:51], v[64:79]
    v_lshlrev_b32 v52, 16, v16
    v_and_b32 v53, 0xffff0000, v16
    v_mul_f32 v52, -2.0, v52
    v_mul_f32 v53, -2.0, v53
    v_cvt_pk_bf16_f32 v16, v52, v53
    v_lshlrev_b32 v52, 16, v17
    v_and_b32 v53, 0xffff0000, v17
    v_mul_f32 v52, -2.0, v52
    v_mul_f32 v53, -2.0, v53
    v_cvt_pk_bf16_f32 v17, v52, v53
    v_lshlrev_b32 v52, 16, v18
    v_and_b32 v53, 0xffff0000, v18
    v_mul_f32 v52, -2.0, v52
    v_mul_f32 v53, -2.0, v53
    v_cvt_pk_bf16_f32 v18, v52, v53
    v_lshlrev_b32 v52, 16, v19
    v_and_b32 v53, 0xffff0000, v19
    v_mul_f32 v52, -2.0, v52
    v_mul_f32 v53, -2.0, v53
    v_cvt_pk_bf16_f32 v19, v52, v53
    v_lshlrev_b32 v52, 16, v20
    v_and_b32 v53, 0xffff0000, v20
    v_mul_f32 v52, -2.0, v52
    v_mul_f32 v53, -2.0, v53
    v_cvt_pk_bf16_f32 v20, v52, v53
    v_lshlrev_b32 v52, 16, v21
    v_and_b32 v53, 0xffff0000, v21
    v_mul_f32 v52, -2.0, v52
    v_mul_f32 v53, -2.0, v53
    v_cvt_pk_bf16_f32 v21, v52, v53
    v_lshlrev_b32 v52, 16, v22
    v_and_b32 v53, 0xffff0000, v22
    v_mul_f32 v52, -2.0, v52
    v_mul_f32 v53, -2.0, v53
    v_cvt_pk_bf16_f32 v22, v52, v53
    v_lshlrev_b32 v52, 16, v23
    v_and_b32 v53, 0xffff0000, v23
    v_mul_f32 v52, -2.0, v52
    v_mul_f32 v53, -2.0, v53
    v_cvt_pk_bf16_f32 v23, v52, v53
    v_lshlrev_b32 v52, 16, v24
    v_and_b32 v53, 0xffff0000, v24
    v_mul_f32 v52, -2.0, v52
    v_mul_f32 v53, -2.0, v53
    v_cvt_pk_bf16_f32 v24, v52, v53
    v_lshlrev_b32 v52, 16, v25
    v_and_b32 v53, 0xffff0000, v25
    v_mul_f32 v52, -2.0, v52
    v_mul_f32 v53, -2.0, v53
    v_cvt_pk_bf16_f32 v25, v52, v53
    v_lshlrev_b32 v52, 16, v26
    v_and_b32 v53, 0xffff0000, v26
    v_mul_f32 v52, -2.0, v52
    v_mul_f32 v53, -2.0, v53
    v_cvt_pk_bf16_f32 v26, v52, v53
    v_lshlrev_b32 v52, 16, v27
    v_and_b32 v53, 0xffff0000, v27
    v_mul_f32 v52, -2.0, v52
    v_mul_f32 v53, -2.0, v53
    v_cvt_pk_bf16_f32 v27, v52, v53
    v_lshlrev_b32 v52, 16, v28
    v_and_b32 v53, 0xffff0000, v28
    v_mul_f32 v52, -2.0, v52
    v_mul_f32 v53, -2.0, v53
    v_cvt_pk_bf16_f32 v28, v52, v53
    v_lshlrev_b32 v52, 16, v29
    v_and_b32 v53, 0xffff0000, v29
    v_mul_f32 v52, -2.0, v52
    v_mul_f32 v53, -2.0, v53
    v_cvt_pk_bf16_f32 v29, v52, v53
    v_lshlrev_b32 v52, 16, v30
    v_and_b32 v53, 0xffff0000, v30
    v_mul_f32 v52, -2.0, v52
    v_mul_f32 v53, -2.0, v53
    v_cvt_pk_bf16_f32 v30, v52, v53
    v_lshlrev_b32 v52, 16, v31
    v_and_b32 v53, 0xffff0000, v31
    v_mul_f32 v52, -2.0, v52
    v_mul_f32 v53, -2.0, v53
    v_cvt_pk_bf16_f32 v31, v52, v53
    s_add_u32 s35, s34, 0
    buffer_store_dwordx4 v[16:19], v9, s[12:15], s35 offen sc1
    s_add_u32 s35, s34, 1024
    buffer_store_dwordx4 v[20:23], v9, s[12:15], s35 offen sc1
    s_add_u32 s35, s34, 2048
    buffer_store_dwordx4 v[24:27], v9, s[12:15], s35 offen sc1
    s_add_u32 s35, s34, 3072
    buffer_store_dwordx4 v[28:31], v9, s[12:15], s35 offen sc1
    ds_read_b64_tr_b16 v[32:33], v8 offset:64
    ds_read_b64_tr_b16 v[34:35], v8 offset:1088
    ds_read_b64_tr_b16 v[36:37], v8 offset:2112
    ds_read_b64_tr_b16 v[38:39], v8 offset:3136
    ds_read_b64_tr_b16 v[40:41], v8 offset:4160
    ds_read_b64_tr_b16 v[42:43], v8 offset:5184
    ds_read_b64_tr_b16 v[44:45], v8 offset:6208
    ds_read_b64_tr_b16 v[46:47], v8 offset:7232
    s_waitcnt lgkmcnt(0)
    v_mfma_f32_32x32x16_bf16 v[80:95], v[32:35], v[48:51], 0
    v_mfma_f32_32x32x16_bf16 v[80:95], v[36:39], v[48:51], v[80:95]
    v_mfma_f32_32x32x16_bf16 v[80:95], v[40:43], v[48:51], v[80:95]
    v_mfma_f32_32x32x16_bf16 v[80:95], v[44:47], v[48:51], v[80:95]
    v_lshlrev_b32 v52, 16, v32
    v_and_b32 v53, 0xffff0000, v32
    v_mul_f32 v52, -2.0, v52
    v_mul_f32 v53, -2.0, v53
    v_cvt_pk_bf16_f32 v32, v52, v53
    v_lshlrev_b32 v52, 16, v33
    v_and_b32 v53, 0xffff0000, v33
    v_mul_f32 v52, -2.0, v52
    v_mul_f32 v53, -2.0, v53
    v_cvt_pk_bf16_f32 v33, v52, v53
    v_lshlrev_b32 v52, 16, v34
    v_and_b32 v53, 0xffff0000, v34
    v_mul_f32 v52, -2.0, v52
    v_mul_f32 v53, -2.0, v53
    v_cvt_pk_bf16_f32 v34, v52, v53
    v_lshlrev_b32 v52, 16, v35
    v_and_b32 v53, 0xffff0000, v35
    v_mul_f32 v52, -2.0, v52
    v_mul_f32 v53, -2.0, v53
    v_cvt_pk_bf16_f32 v35, v52, v53
    v_lshlrev_b32 v52, 16, v36
    v_and_b32 v53, 0xffff0000, v36
    v_mul_f32 v52, -2.0, v52
    v_mul_f32 v53, -2.0, v53
    v_cvt_pk_bf16_f32 v36, v52, v53
    v_lshlrev_b32 v52, 16, v37
    v_and_b32 v53, 0xffff0000, v37
    v_mul_f32 v52, -2.0, v52
    v_mul_f32 v53, -2.0, v53
    v_cvt_pk_bf16_f32 v37, v52, v53
    v_lshlrev_b32 v52, 16, v38
    v_and_b32 v53, 0xffff0000, v38
    v_mul_f32 v52, -2.0, v52
    v_mul_f32 v53, -2.0, v53
    v_cvt_pk_bf16_f32 v38, v52, v53
    v_lshlrev_b32 v52, 16, v39
    v_and_b32 v53, 0xffff0000, v39
    v_mul_f32 v52, -2.0, v52
    v_mul_f32 v53, -2.0, v53
    v_cvt_pk_bf16_f32 v39, v52, v53
    v_lshlrev_b32 v52, 16, v40
    v_and_b32 v53, 0xffff0000, v40
    v_mul_f32 v52, -2.0, v52
    v_mul_f32 v53, -2.0, v53
    v_cvt_pk_bf16_f32 v40, v52, v53
    v_lshlrev_b32 v52, 16, v41
    v_and_b32 v53, 0xffff0000, v41
    v_mul_f32 v52, -2.0, v52
    v_mul_f32 v53, -2.0, v53
    v_cvt_pk_bf16_f32 v41, v52, v53
    v_lshlrev_b32 v52, 16, v42
    v_and_b32 v53, 0xffff0000, v42
    v_mul_f32 v52, -2.0, v52
    v_mul_f32 v53, -2.0, v53
    v_cvt_pk_bf16_f32 v42, v52, v53
    v_lshlrev_b32 v52, 16, v43
    v_and_b32 v53, 0xffff0000, v43
    v_mul_f32 v52, -2.0, v52
    v_mul_f32 v53, -2.0, v53
    v_cvt_pk_bf16_f32 v43, v52, v53
    v_lshlrev_b32 v52, 16, v44
    v_and_b32 v53, 0xffff0000, v44
    v_mul_f32 v52, -2.0, v52
    v_mul_f32 v53, -2.0, v53
    v_cvt_pk_bf16_f32 v44, v52, v53
    v_lshlrev_b32 v52, 16, v45
    v_and_b32 v53, 0xffff0000, v45
    v_mul_f32 v52, -2.0, v52
    v_mul_f32 v53, -2.0, v53
    v_cvt_pk_bf16_f32 v45, v52, v53
    v_lshlrev_b32 v52, 16, v46
    v_and_b32 v53, 0xffff0000, v46
    v_mul_f32 v52, -2.0, v52
    v_mul_f32 v53, -2.0, v53
    v_cvt_pk_bf16_f32 v46, v52, v53
    v_lshlrev_b32 v52, 16, v47
    v_and_b32 v53, 0xffff0000, v47
    v_mul_f32 v52, -2.0, v52
    v_mul_f32 v53, -2.0, v53
    v_cvt_pk_bf16_f32 v47, v52, v53
    s_add_u32 s35, s34, 16384
    buffer_store_dwordx4 v[32:35], v9, s[12:15], s35 offen sc1
    s_add_u32 s35, s34, 17408
    buffer_store_dwordx4 v[36:39], v9, s[12:15], s35 offen sc1
    s_add_u32 s35, s34, 18432
    buffer_store_dwordx4 v[40:43], v9, s[12:15], s35 offen sc1
    s_add_u32 s35, s34, 19456
    buffer_store_dwordx4 v[44:47], v9, s[12:15], s35 offen sc1
    s_nop 7
    s_barrier
    v_lshlrev_b32 v10, 6, v1
    s_lshl_b32 s35, s20, 13
    v_add_u32 v11, s35, v10
    ds_write_b128 v11, v[64:67] offset:0
    ds_write_b128 v11, v[68:71] offset:16
    ds_write_b128 v11, v[72:75] offset:32
    ds_write_b128 v11, v[76:79] offset:48
    ds_write_b128 v11, v[80:83] offset:4096
    ds_write_b128 v11, v[84:87] offset:4112
    ds_write_b128 v11, v[88:91] offset:4128
    ds_write_b128 v11, v[92:95] offset:4144
    s_waitcnt lgkmcnt(0)
    s_barrier
    s_cmp_ge_u32 s20, 2
    s_cbranch_scc1 L_prep_kernel_done
    s_lshl_b32 s35, s20, 12
    v_add_u32 v11, s35, v10
    ds_read_b128 v[16:19], v11 offset:0
    ds_read_b128 v[20:23], v11 offset:16
    ds_read_b128 v[24:27], v11 offset:32
    ds_read_b128 v[28:31], v11 offset:48
    ds_read_b128 v[32:35], v11 offset:8192
    ds_read_b128 v[36:39], v11 offset:8208
    ds_read_b128 v[40:43], v11 offset:8224
    ds_read_b128 v[44:47], v11 offset:8240
    s_waitcnt lgkmcnt(0)
    ds_read_b128 v[48:51], v11 offset:16384
    ds_read_b128 v[52:55], v11 offset:16400
    ds_read_b128 v[56:59], v11 offset:16416
    ds_read_b128 v[60:63], v11 offset:16432
    ds_read_b128 v[64:67], v11 offset:24576
    ds_read_b128 v[68:71], v11 offset:24592
    ds_read_b128 v[72:75], v11 offset:24608
    ds_read_b128 v[76:79], v11 offset:24624
    s_waitcnt lgkmcnt(0)
    v_add_f32 v16, v16, v32
    v_add_f32 v48, v48, v64
    v_add_f32 v17, v17, v33
    v_add_f32 v49, v49, v65
    v_add_f32 v18, v18, v34
    v_add_f32 v50, v50, v66
    v_add_f32 v19, v19, v35
    v_add_f32 v51, v51, v67
    v_add_f32 v20, v20, v36
    v_add_f32 v52, v52, v68
    v_add_f32 v21, v21, v37
    v_add_f32 v53, v53, v69
    v_add_f32 v22, v22, v38
    v_add_f32 v54, v54, v70
    v_add_f32 v23, v23, v39
    v_add_f32 v55, v55, v71
    v_add_f32 v24, v24, v40
    v_add_f32 v56, v56, v72
    v_add_f32 v25, v25, v41
    v_add_f32 v57, v57, v73
    v_add_f32 v26, v26, v42
    v_add_f32 v58, v58, v74
    v_add_f32 v27, v27, v43
    v_add_f32 v59, v59, v75
    v_add_f32 v28, v28, v44
    v_add_f32 v60, v60, v76
    v_add_f32 v29, v29, v45
    v_add_f32 v61, v61, v77
    v_add_f32 v30, v30, v46
    v_add_f32 v62, v62, v78
    v_add_f32 v31, v31, v47
    v_add_f32 v63, v63, v79
    v_add_f32 v16, v16, v48
    v_add_f32 v17, v17, v49
    v_add_f32 v18, v18, v50
    v_add_f32 v19, v19, v51
    v_add_f32 v20, v20, v52
    v_add_f32 v21, v21, v53
    v_add_f32 v22, v22, v54
    v_add_f32 v23, v23, v55
    v_add_f32 v24, v24, v56
    v_add_f32 v25, v25, v57
    v_add_f32 v26, v26, v58
    v_add_f32 v27, v27, v59
    v_add_f32 v28, v28, v60
    v_add_f32 v29, v29, v61
    v_add_f32 v30, v30, v62
    v_add_f32 v31, v31, v63
    v_and_b32 v10, 31, v1
    v_cmp_eq_u32 vcc, 0, v10
    v_lshrrev_b32 v10, 5, v1
    v_lshlrev_b32 v10, 6, v10
    s_lshl_b32 s35, s26, 8
    s_lshl_b32 s36, s20, 7
    s_add_u32 s35, s35, s36
    s_add_u32 s35, s35, 14336
    s_and_saveexec_b64 s[38:39], vcc
    buffer_store_dwordx4 v[16:19], v10, s[12:15], s35 offen offset:0 sc1
    buffer_store_dwordx4 v[20:23], v10, s[12:15], s35 offen offset:16 sc1
    buffer_store_dwordx4 v[24:27], v10, s[12:15], s35 offen offset:32 sc1
    buffer_store_dwordx4 v[28:31], v10, s[12:15], s35 offen offset:48 sc1
    s_endpgm
L_prep_kernel_ge:
    s_mov_b32 s36, s28
    s_mov_b32 s37, s29
    s_mov_b32 s38, 8192
    s_mov_b32 s39, 0x00020000
    v_and_b32 v4, 15, v1
    v_lshrrev_b32 v5, 4, v1
    v_lshlrev_b32 v6, 9, v4
    v_lshl_add_u32 v6, v5, 4, v6
    buffer_load_dwordx4 v[16:19], v6, s[36:39], 0 offen offset:0
    buffer_load_dwordx4 v[20:23], v6, s[36:39], 0 offen offset:64
    buffer_load_dwordx4 v[24:27], v6, s[36:39], 0 offen offset:128
    buffer_load_dwordx4 v[28:31], v6, s[36:39], 0 offen offset:192
    buffer_load_dwordx4 v[32:35], v6, s[36:39], 0 offen offset:256
    buffer_load_dwordx4 v[36:39], v6, s[36:39], 0 offen offset:320
    buffer_load_dwordx4 v[40:43], v6, s[36:39], 0 offen offset:384
    buffer_load_dwordx4 v[44:47], v6, s[36:39], 0 offen offset:448
    v_bfe_u32 v7, v1, 2, 2
    v_lshl_add_u32 v7, v5, 3, v7
    v_lshlrev_b32 v7, 7, v7
    v_and_b32 v8, 3, v1
    v_lshl_add_u32 v7, v8, 3, v7
    s_lshl_b32 s33, s20, 5
    v_add_u32 v7, s33, v7
    s_waitcnt vmcnt(0)
    s_barrier
    ds_read_b64_tr_b16 v[48:49], v7 offset:0
    ds_read_b64_tr_b16 v[50:51], v7 offset:512
    ds_read_b64_tr_b16 v[52:53], v7 offset:4096
    ds_read_b64_tr_b16 v[54:55], v7 offset:4608
    ds_read_b64_tr_b16 v[56:57], v7 offset:8192
    ds_read_b64_tr_b16 v[58:59], v7 offset:8704
    ds_read_b64_tr_b16 v[60:61], v7 offset:12288
    ds_read_b64_tr_b16 v[62:63], v7 offset:12800
    s_waitcnt lgkmcnt(0)
    ds_read_b64_tr_b16 v[64:65], v7 offset:16384
    ds_read_b64_tr_b16 v[66:67], v7 offset:16896
    ds_read_b64_tr_b16 v[68:69], v7 offset:20480
    ds_read_b64_tr_b16 v[70:71], v7 offset:20992
    ds_read_b64_tr_b16 v[72:73], v7 offset:24576
    ds_read_b64_tr_b16 v[74:75], v7 offset:25088
    ds_read_b64_tr_b16 v[76:77], v7 offset:28672
    ds_read_b64_tr_b16 v[78:79], v7 offset:29184
    s_waitcnt lgkmcnt(0)
    v_mfma_f32_16x16x32_bf16 v[80:83], v[48:51], v[16:19], 0
    v_mfma_f32_16x16x32_bf16 v[80:83], v[52:55], v[20:23], v[80:83]
    v_mfma_f32_16x16x32_bf16 v[80:83], v[56:59], v[24:27], v[80:83]
    v_mfma_f32_16x16x32_bf16 v[80:83], v[60:63], v[28:31], v[80:83]
    v_mfma_f32_16x16x32_bf16 v[80:83], v[64:67], v[32:35], v[80:83]
    v_mfma_f32_16x16x32_bf16 v[80:83], v[68:71], v[36:39], v[80:83]
    v_mfma_f32_16x16x32_bf16 v[80:83], v[72:75], v[40:43], v[80:83]
    v_mfma_f32_16x16x32_bf16 v[80:83], v[76:79], v[44:47], v[80:83]
    s_nop 7
    v_cvt_pk_bf16_f32 v84, v80, v81
    v_cvt_pk_bf16_f32 v85, v82, v83
    s_mov_b32 s33, 0x4038aa3b
    v_lshlrev_b32 v80, 16, v84
    v_and_b32 v81, 0xffff0000, v84
    v_lshlrev_b32 v82, 16, v85
    v_and_b32 v83, 0xffff0000, v85
    v_mul_f32 v80, s33, v80
    v_mul_f32 v81, s33, v81
    v_mul_f32 v82, s33, v82
    v_mul_f32 v83, s33, v83
    v_lshlrev_b32 v6, 10, v4
    v_lshl_add_u32 v6, v5, 4, v6
    s_lshl_b32 s33, s26, 8
    s_lshl_b32 s34, s20, 6
    s_add_u32 s33, s33, s34
    s_add_u32 s33, s33, 16384
    buffer_store_dwordx4 v[80:83], v6, s[12:15], s33 offen sc1
    s_endpgm
L_prep_kernel_tab:
    v_and_b32 v8, 63, v0
    v_lshlrev_b32 v6, 4, v8
    s_waitcnt lgkmcnt(0)
    s_add_u32 s12, s6, 83312640
    s_addc_u32 s13, s7, 0
    s_mov_b32 s14, 294912
    s_mov_b32 s15, 0x00020000
    s_lshl_b32 s32, s20, 4
    s_lshl_b32 s33, s20, 11
    v_and_b32 v9, 15, v8
    v_lshrrev_b32 v10, 4, v8
    v_or_b32 v11, 1, v9
    v_add_u32 v11, s32, v11
    v_cvt_f32_u32 v11, v11
    v_mul_f32 v11, 0x3c000000, v11
    v_lshlrev_b32 v10, 3, v10
    v_add_u32 v10, 0, v10
    v_cvt_f32_u32 v10, v10
    v_and_b32 v9, 1, v9
    v_cvt_f32_u32 v9, v9
    v_mul_f32 v9, 0x3e800000, v9
    v_fma_f32 v12, v11, v10, v9
    v_fract_f32 v13, v12
    v_add_f32 v12, v12, v11
    v_fract_f32 v14, v12
    v_add_f32 v12, v12, v11
    v_fract_f32 v15, v12
    v_add_f32 v12, v12, v11
    v_fract_f32 v16, v12
    v_add_f32 v12, v12, v11
    v_fract_f32 v17, v12
    v_add_f32 v12, v12, v11
    v_fract_f32 v18, v12
    v_add_f32 v12, v12, v11
    v_fract_f32 v19, v12
    v_add_f32 v12, v12, v11
    v_fract_f32 v20, v12
    v_cos_f32 v13, v13
    v_cos_f32 v14, v14
    v_cos_f32 v15, v15
    v_cos_f32 v16, v16
    v_cos_f32 v17, v17
    v_cos_f32 v18, v18
    v_cos_f32 v19, v19
    v_cos_f32 v20, v20
    s_nop 0
    v_cvt_pk_bf16_f32 v24, v13, v14
    v_cvt_pk_bf16_f32 v25, v15, v16
    v_cvt_pk_bf16_f32 v26, v17, v18
    v_cvt_pk_bf16_f32 v27, v19, v20
    s_add_u32 s34, s33, 0
    buffer_store_dwordx4 v[24:27], v6, s[12:15], s34 offen sc1
    v_and_b32 v9, 15, v8
    v_lshrrev_b32 v10, 4, v8
    v_or_b32 v11, 1, v9
    v_add_u32 v11, s32, v11
    v_cvt_f32_u32 v11, v11
    v_mul_f32 v11, 0x3c000000, v11
    v_lshlrev_b32 v10, 3, v10
    v_add_u32 v10, 32, v10
    v_cvt_f32_u32 v10, v10
    v_and_b32 v9, 1, v9
    v_cvt_f32_u32 v9, v9
    v_mul_f32 v9, 0x3e800000, v9
    v_fma_f32 v12, v11, v10, v9
    v_fract_f32 v13, v12
    v_add_f32 v12, v12, v11
    v_fract_f32 v14, v12
    v_add_f32 v12, v12, v11
    v_fract_f32 v15, v12
    v_add_f32 v12, v12, v11
    v_fract_f32 v16, v12
    v_add_f32 v12, v12, v11
    v_fract_f32 v17, v12
    v_add_f32 v12, v12, v11
    v_fract_f32 v18, v12
    v_add_f32 v12, v12, v11
    v_fract_f32 v19, v12
    v_add_f32 v12, v12, v11
    v_fract_f32 v20, v12
    v_cos_f32 v13, v13
    v_cos_f32 v14, v14
    v_cos_f32 v15, v15
    v_cos_f32 v16, v16
    v_cos_f32 v17, v17
    v_cos_f32 v18, v18
    v_cos_f32 v19, v19
    v_cos_f32 v20, v20
    s_nop 0
    v_cvt_pk_bf16_f32 v28, v13, v14
    v_cvt_pk_bf16_f32 v29, v15, v16
    v_cvt_pk_bf16_f32 v30, v17, v18
    v_cvt_pk_bf16_f32 v31, v19, v20
    s_add_u32 s34, s33, 1024
    buffer_store_dwordx4 v[28:31], v6, s[12:15], s34 offen sc1
    s_cmp_ge_u32 s20, 3
    s_cbranch_scc1 L_prep_kernel_done
    v_and_b32 v9, 15, v8
    v_add_u32 v9, s32, v9
    v_cvt_f32_u32 v9, v9
    v_mul_f32 v9, 0x3c000000, v9
    v_lshrrev_b32 v10, 4, v8
    v_lshlrev_b32 v10, 3, v10
    v_add_u32 v11, 1, v10
    v_cvt_f32_u32 v11, v11
    v_mul_f32 v11, v11, v9
    v_fract_f32 v12, v11
    v_add_u32 v11, 1, v10
    v_cvt_f32_u32 v11, v11
    v_mul_f32 v11, v11, v9
    v_add_f32 v11, 0x3e800000, v11
    v_fract_f32 v13, v11
    v_add_u32 v11, 3, v10
    v_cvt_f32_u32 v11, v11
    v_mul_f32 v11, v11, v9
    v_fract_f32 v14, v11
    v_add_u32 v11, 3, v10
    v_cvt_f32_u32 v11, v11
    v_mul_f32 v11, v11, v9
    v_add_f32 v11, 0x3e800000, v11
    v_fract_f32 v15, v11
    v_add_u32 v11, 5, v10
    v_cvt_f32_u32 v11, v11
    v_mul_f32 v11, v11, v9
    v_fract_f32 v16, v11
    v_add_u32 v11, 5, v10
    v_cvt_f32_u32 v11, v11
    v_mul_f32 v11, v11, v9
    v_add_f32 v11, 0x3e800000, v11
    v_fract_f32 v17, v11
    v_add_u32 v11, 7, v10
    v_cvt_f32_u32 v11, v11
    v_mul_f32 v11, v11, v9
    v_fract_f32 v18, v11
    v_add_u32 v11, 7, v10
    v_cvt_f32_u32 v11, v11
    v_mul_f32 v11, v11, v9
    v_add_f32 v11, 0x3e800000, v11
    v_fract_f32 v19, v11
    v_cos_f32 v12, v12
    v_cos_f32 v13, v13
    v_cos_f32 v14, v14
    v_cos_f32 v15, v15
    v_cos_f32 v16, v16
    v_cos_f32 v17, v17
    v_cos_f32 v18, v18
    v_cos_f32 v19, v19
    s_nop 0
    v_cvt_pk_bf16_f32 v24, v12, v13
    v_cvt_pk_bf16_f32 v25, v14, v15
    v_cvt_pk_bf16_f32 v26, v16, v17
    v_cvt_pk_bf16_f32 v27, v18, v19
    s_add_u32 s34, s33, 8192
    buffer_store_dwordx4 v[24:27], v6, s[12:15], s34 offen sc1
    s_nop 1
    v_add_u32 v11, 33, v10
    v_cvt_f32_u32 v11, v11
    v_mul_f32 v11, v11, v9
    v_fract_f32 v12, v11
    v_add_u32 v11, 33, v10
    v_cvt_f32_u32 v11, v11
    v_mul_f32 v11, v11, v9
    v_add_f32 v11, 0x3e800000, v11
    v_fract_f32 v13, v11
    v_add_u32 v11, 35, v10
    v_cvt_f32_u32 v11, v11
    v_mul_f32 v11, v11, v9
    v_fract_f32 v14, v11
    v_add_u32 v11, 35, v10
    v_cvt_f32_u32 v11, v11
    v_mul_f32 v11, v11, v9
    v_add_f32 v11, 0x3e800000, v11
    v_fract_f32 v15, v11
    v_add_u32 v11, 37, v10
    v_cvt_f32_u32 v11, v11
    v_mul_f32 v11, v11, v9
    v_fract_f32 v16, v11
    v_add_u32 v11, 37, v10
    v_cvt_f32_u32 v11, v11
    v_mul_f32 v11, v11, v9
    v_add_f32 v11, 0x3e800000, v11
    v_fract_f32 v17, v11
    v_add_u32 v11, 39, v10
    v_cvt_f32_u32 v11, v11
    v_mul_f32 v11, v11, v9
    v_fract_f32 v18, v11
    v_add_u32 v11, 39, v10
    v_cvt_f32_u32 v11, v11
    v_mul_f32 v11, v11, v9
    v_add_f32 v11, 0x3e800000, v11
    v_fract_f32 v19, v11
    v_cos_f32 v12, v12
    v_cos_f32 v13, v13
    v_cos_f32 v14, v14
    v_cos_f32 v15, v15
    v_cos_f32 v16, v16
    v_cos_f32 v17, v17
    v_cos_f32 v18, v18
    v_cos_f32 v19, v19
    s_nop 0
    v_cvt_pk_bf16_f32 v24, v12, v13
    v_cvt_pk_bf16_f32 v25, v14, v15
    v_cvt_pk_bf16_f32 v26, v16, v17
    v_cvt_pk_bf16_f32 v27, v18, v19
    s_add_u32 s34, s33, 9216
    buffer_store_dwordx4 v[24:27], v6, s[12:15], s34 offen sc1
    s_nop 1
L_prep_kernel_done:
    s_endpgm
.globl gemm1_kernel
.p2align 8
.type gemm1_kernel,@function
gemm1_kernel:
    s_cmp_ge_u32 s2, 256
    s_cbranch_scc1 L_gemm1_kernel_done
    s_load_dwordx2 s[4:5], s[0:1], 72
    v_readfirstlane_b32 s20, v0
    s_lshr_b32 s20, s20, 6
    s_and_b32 s24, s2, 7
    s_lshr_b32 s25, s2, 3
    s_lshr_b32 s26, s25, 3
    s_lshl_b32 s24, s24, 2
    s_add_u32 s21, s24, s26
    s_and_b32 s25, s25, 7
    s_lshr_b32 s26, s25, 1
    s_and_b32 s27, s25, 1
    s_mul_i32 s22, s26, 84
    s_sub_u32 s28, 334, s22
    s_min_u32 s28, s28, 84
    s_waitcnt lgkmcnt(0)
    s_mul_i32 s29, s21, 684032
    s_lshl_b32 s30, s22, 11
    s_add_u32 s29, s29, s30
    s_add_u32 s29, s29, 0
    s_add_u32 s8, s4, s29
    s_addc_u32 s9, s5, 0
    s_lshl_b32 s10, s28, 11
    s_mov_b32 s11, 0x00020000
    s_mul_i32 s29, s21, 528640
    s_mul_i32 s30, s27, 16384
    s_add_u32 s29, s29, s30
    s_add_u32 s29, s29, 21954560
    s_add_u32 s12, s4, s29
    s_addc_u32 s13, s5, 0
    s_mov_b32 s14, 507904
    s_mov_b32 s15, 0x00020000
    s_cmp_ge_u32 s20, 4
    s_cbranch_scc1 L_gemm1_kernel_loader
    s_lshl_b32 s29, s22, 15
    s_add_u32 s29, s29, 38871040
    s_add_u32 s16, s4, s29
    s_addc_u32 s17, s5, 0
    s_lshl_b32 s18, s28, 15
    s_mov_b32 s19, 0x00020000
    s_lshr_b32 s29, s20, 1
    s_and_b32 s30, s20, 1
    v_and_b32 v217, 15, v0
    v_bfe_u32 v218, v0, 4, 2
    v_and_b32 v219, 63, v0
    s_mul_i32 s31, s29, 6144
    v_and_b32 v220, 7, v217
    v_xor_b32 v220, v218, v220
    v_lshlrev_b32 v220, 4, v220
    v_lshl_add_u32 v220, v217, 7, v220
    v_add_u32 v220, s31, v220
    v_add_u32 v208, 0, v220
    v_xor_b32 v211, 64, v208
    v_add_u32 v209, 57344, v220
    v_xor_b32 v212, 64, v209
    v_add_u32 v210, 114688, v220
    v_xor_b32 v213, 64, v210
    s_mul_i32 s31, s30, 8192
    s_add_u32 s31, s31, 12288
    v_lshlrev_b32 v220, 4, v219
    v_add_u32 v220, s31, v220
    v_add_u32 v214, 0, v220
    v_add_u32 v215, 57344, v220
    v_add_u32 v216, 114688, v220
    s_mul_i32 s31, s29, 1572864
    v_lshlrev_b32 v221, 15, v217
    v_lshl_add_u32 v221, v218, 4, v221
    v_add_u32 v221, s31, v221
    s_mul_i32 s31, s27, 4
    s_mul_i32 s29, s30, 2
    s_add_u32 s31, s31, s29
    s_lshl_b32 s31, s31, 12
    s_lshl_b32 s29, s21, 7
    s_add_u32 s33, s31, s29
    s_mov_b32 s34, 0x80008000
    s_barrier
    ds_read_b128 v[96:99], v214 offset:0
    ds_read_b128 v[128:131], v208 offset:0
    ds_read_b128 v[136:139], v208 offset:2048
    ds_read_b128 v[144:147], v208 offset:4096
    ds_read_b128 v[104:107], v214 offset:2048
    ds_read_b128 v[112:115], v214 offset:4096
    ds_read_b128 v[120:123], v214 offset:6144
    ds_read_b128 v[132:135], v211 offset:0
    ds_read_b128 v[140:143], v211 offset:2048
    ds_read_b128 v[148:151], v211 offset:4096
    ds_read_b128 v[100:103], v214 offset:1024
    ds_read_b128 v[108:111], v214 offset:3072
    ds_read_b128 v[116:119], v214 offset:5120
    ds_read_b128 v[124:127], v214 offset:7168
    s_waitcnt lgkmcnt(0)
    s_barrier
    v_mfma_f32_16x16x32_bf16 v[0:3], v[96:99], v[128:131], 0
    ds_read_b128 v[152:155], v214 offset:28672
    v_mfma_f32_16x16x32_bf16 v[4:7], v[96:99], v[136:139], 0
    v_mfma_f32_16x16x32_bf16 v[8:11], v[96:99], v[144:147], 0
    ds_read_b128 v[184:187], v208 offset:28672
    v_mfma_f32_16x16x32_bf16 v[12:15], v[104:107], v[128:131], 0
    v_mfma_f32_16x16x32_bf16 v[16:19], v[104:107], v[136:139], 0
    ds_read_b128 v[192:195], v208 offset:30720
    v_mfma_f32_16x16x32_bf16 v[20:23], v[104:107], v[144:147], 0
    v_mfma_f32_16x16x32_bf16 v[24:27], v[112:115], v[128:131], 0
    ds_read_b128 v[200:203], v208 offset:32768
    v_mfma_f32_16x16x32_bf16 v[28:31], v[112:115], v[136:139], 0
    v_mfma_f32_16x16x32_bf16 v[32:35], v[112:115], v[144:147], 0
    ds_read_b128 v[160:163], v214 offset:30720
    v_mfma_f32_16x16x32_bf16 v[36:39], v[120:123], v[128:131], 0
    v_mfma_f32_16x16x32_bf16 v[40:43], v[120:123], v[136:139], 0
    ds_read_b128 v[168:171], v214 offset:32768
    v_mfma_f32_16x16x32_bf16 v[44:47], v[120:123], v[144:147], 0
    v_mfma_f32_16x16x32_bf16 v[48:51], v[96:99], v[132:135], 0
    ds_read_b128 v[176:179], v214 offset:34816
    v_mfma_f32_16x16x32_bf16 v[52:55], v[96:99], v[140:143], 0
    v_mfma_f32_16x16x32_bf16 v[56:59], v[96:99], v[148:151], 0
    ds_read_b128 v[188:191], v211 offset:28672
    v_mfma_f32_16x16x32_bf16 v[60:63], v[104:107], v[132:135], 0
    v_mfma_f32_16x16x32_bf16 v[64:67], v[104:107], v[140:143], 0
    ds_read_b128 v[196:199], v211 offset:30720
    v_mfma_f32_16x16x32_bf16 v[68:71], v[104:107], v[148:151], 0
    v_mfma_f32_16x16x32_bf16 v[72:75], v[112:115], v[132:135], 0
    ds_read_b128 v[204:207], v211 offset:32768
    v_mfma_f32_16x16x32_bf16 v[76:79], v[112:115], v[140:143], 0
    v_mfma_f32_16x16x32_bf16 v[80:83], v[112:115], v[148:151], 0
    ds_read_b128 v[156:159], v214 offset:29696
    v_mfma_f32_16x16x32_bf16 v[84:87], v[120:123], v[132:135], 0
    v_mfma_f32_16x16x32_bf16 v[88:91], v[120:123], v[140:143], 0
    ds_read_b128 v[164:167], v214 offset:31744
    v_mfma_f32_16x16x32_bf16 v[92:95], v[120:123], v[148:151], 0
    v_mfma_f32_16x16x32_bf16 v[48:51], v[100:103], v[128:131], v[48:51]
    ds_read_b128 v[172:175], v214 offset:33792
    v_xor_b32 v132, s34, v132
    v_xor_b32 v133, s34, v133
    v_mfma_f32_16x16x32_bf16 v[52:55], v[100:103], v[136:139], v[52:55]
    v_xor_b32 v134, s34, v134
    v_xor_b32 v135, s34, v135
    v_mfma_f32_16x16x32_bf16 v[56:59], v[100:103], v[144:147], v[56:59]
    ds_read_b128 v[180:183], v214 offset:35840
    v_xor_b32 v140, s34, v140
    v_xor_b32 v141, s34, v141
    v_mfma_f32_16x16x32_bf16 v[60:63], v[108:111], v[128:131], v[60:63]
    v_xor_b32 v142, s34, v142
    v_xor_b32 v143, s34, v143
    v_mfma_f32_16x16x32_bf16 v[64:67], v[108:111], v[136:139], v[64:67]
    v_xor_b32 v148, s34, v148
    v_xor_b32 v149, s34, v149
    v_mfma_f32_16x16x32_bf16 v[68:71], v[108:111], v[144:147], v[68:71]
    v_xor_b32 v150, s34, v150
    v_xor_b32 v151, s34, v151
    v_mfma_f32_16x16x32_bf16 v[72:75], v[116:119], v[128:131], v[72:75]
    v_mfma_f32_16x16x32_bf16 v[76:79], v[116:119], v[136:139], v[76:79]
    v_mfma_f32_16x16x32_bf16 v[80:83], v[116:119], v[144:147], v[80:83]
    v_mfma_f32_16x16x32_bf16 v[84:87], v[124:127], v[128:131], v[84:87]
    v_mfma_f32_16x16x32_bf16 v[88:91], v[124:127], v[136:139], v[88:91]
    v_mfma_f32_16x16x32_bf16 v[92:95], v[124:127], v[144:147], v[92:95]
    v_mfma_f32_16x16x32_bf16 v[0:3], v[100:103], v[132:135], v[0:3]
    v_mfma_f32_16x16x32_bf16 v[4:7], v[100:103], v[140:143], v[4:7]
    v_mfma_f32_16x16x32_bf16 v[8:11], v[100:103], v[148:151], v[8:11]
    v_mfma_f32_16x16x32_bf16 v[12:15], v[108:111], v[132:135], v[12:15]
    v_mfma_f32_16x16x32_bf16 v[16:19], v[108:111], v[140:143], v[16:19]
    s_waitcnt lgkmcnt(0)
    s_barrier
    v_mfma_f32_16x16x32_bf16 v[20:23], v[108:111], v[148:151], v[20:23]
    v_mfma_f32_16x16x32_bf16 v[24:27], v[116:119], v[132:135], v[24:27]
    v_mfma_f32_16x16x32_bf16 v[28:31], v[116:119], v[140:143], v[28:31]
    v_mfma_f32_16x16x32_bf16 v[32:35], v[116:119], v[148:151], v[32:35]
    v_mfma_f32_16x16x32_bf16 v[36:39], v[124:127], v[132:135], v[36:39]
    v_mfma_f32_16x16x32_bf16 v[40:43], v[124:127], v[140:143], v[40:43]
    v_mfma_f32_16x16x32_bf16 v[44:47], v[124:127], v[148:151], v[44:47]
    v_mfma_f32_16x16x32_bf16 v[0:3], v[152:155], v[184:187], v[0:3]
    ds_read_b128 v[96:99], v215 offset:0
    v_mfma_f32_16x16x32_bf16 v[4:7], v[152:155], v[192:195], v[4:7]
    v_mfma_f32_16x16x32_bf16 v[8:11], v[152:155], v[200:203], v[8:11]
    ds_read_b128 v[128:131], v209 offset:0
    v_mfma_f32_16x16x32_bf16 v[12:15], v[160:163], v[184:187], v[12:15]
    v_mfma_f32_16x16x32_bf16 v[16:19], v[160:163], v[192:195], v[16:19]
    ds_read_b128 v[136:139], v209 offset:2048
    v_mfma_f32_16x16x32_bf16 v[20:23], v[160:163], v[200:203], v[20:23]
    v_mfma_f32_16x16x32_bf16 v[24:27], v[168:171], v[184:187], v[24:27]
    ds_read_b128 v[144:147], v209 offset:4096
    v_mfma_f32_16x16x32_bf16 v[28:31], v[168:171], v[192:195], v[28:31]
    v_mfma_f32_16x16x32_bf16 v[32:35], v[168:171], v[200:203], v[32:35]
    ds_read_b128 v[104:107], v215 offset:2048
    v_mfma_f32_16x16x32_bf16 v[36:39], v[176:179], v[184:187], v[36:39]
    v_mfma_f32_16x16x32_bf16 v[40:43], v[176:179], v[192:195], v[40:43]
    ds_read_b128 v[112:115], v215 offset:4096
    v_mfma_f32_16x16x32_bf16 v[44:47], v[176:179], v[200:203], v[44:47]
    v_mfma_f32_16x16x32_bf16 v[48:51], v[152:155], v[188:191], v[48:51]
    ds_read_b128 v[120:123], v215 offset:6144
    v_mfma_f32_16x16x32_bf16 v[52:55], v[152:155], v[196:199], v[52:55]
    v_mfma_f32_16x16x32_bf16 v[56:59], v[152:155], v[204:207], v[56:59]
    ds_read_b128 v[132:135], v212 offset:0
    v_mfma_f32_16x16x32_bf16 v[60:63], v[160:163], v[188:191], v[60:63]
    v_mfma_f32_16x16x32_bf16 v[64:67], v[160:163], v[196:199], v[64:67]
    ds_read_b128 v[140:143], v212 offset:2048
    v_mfma_f32_16x16x32_bf16 v[68:71], v[160:163], v[204:207], v[68:71]
    v_mfma_f32_16x16x32_bf16 v[72:75], v[168:171], v[188:191], v[72:75]
    ds_read_b128 v[148:151], v212 offset:4096
    v_mfma_f32_16x16x32_bf16 v[76:79], v[168:171], v[196:199], v[76:79]
    v_mfma_f32_16x16x32_bf16 v[80:83], v[168:171], v[204:207], v[80:83]
    ds_read_b128 v[100:103], v215 offset:1024
    v_mfma_f32_16x16x32_bf16 v[84:87], v[176:179], v[188:191], v[84:87]
    v_mfma_f32_16x16x32_bf16 v[88:91], v[176:179], v[196:199], v[88:91]
    ds_read_b128 v[108:111], v215 offset:3072
    v_mfma_f32_16x16x32_bf16 v[92:95], v[176:179], v[204:207], v[92:95]
    v_mfma_f32_16x16x32_bf16 v[48:51], v[156:159], v[184:187], v[48:51]
    ds_read_b128 v[116:119], v215 offset:5120
    v_xor_b32 v188, s34, v188
    v_xor_b32 v189, s34, v189
    v_mfma_f32_16x16x32_bf16 v[52:55], v[156:159], v[192:195], v[52:55]
    v_xor_b32 v190, s34, v190
    v_xor_b32 v191, s34, v191
    v_mfma_f32_16x16x32_bf16 v[56:59], v[156:159], v[200:203], v[56:59]
    ds_read_b128 v[124:127], v215 offset:7168
    v_xor_b32 v196, s34, v196
    v_xor_b32 v197, s34, v197
    v_mfma_f32_16x16x32_bf16 v[60:63], v[164:167], v[184:187], v[60:63]
    v_xor_b32 v198, s34, v198
    v_xor_b32 v199, s34, v199
    v_mfma_f32_16x16x32_bf16 v[64:67], v[164:167], v[192:195], v[64:67]
    v_xor_b32 v204, s34, v204
    v_xor_b32 v205, s34, v205
    v_mfma_f32_16x16x32_bf16 v[68:71], v[164:167], v[200:203], v[68:71]
    v_xor_b32 v206, s34, v206
    v_xor_b32 v207, s34, v207
    v_mfma_f32_16x16x32_bf16 v[72:75], v[172:175], v[184:187], v[72:75]
    v_mfma_f32_16x16x32_bf16 v[76:79], v[172:175], v[192:195], v[76:79]
    v_mfma_f32_16x16x32_bf16 v[80:83], v[172:175], v[200:203], v[80:83]
    v_mfma_f32_16x16x32_bf16 v[84:87], v[180:183], v[184:187], v[84:87]
    v_mfma_f32_16x16x32_bf16 v[88:91], v[180:183], v[192:195], v[88:91]
    v_mfma_f32_16x16x32_bf16 v[92:95], v[180:183], v[200:203], v[92:95]
    v_mfma_f32_16x16x32_bf16 v[0:3], v[156:159], v[188:191], v[0:3]
    v_mfma_f32_16x16x32_bf16 v[4:7], v[156:159], v[196:199], v[4:7]
    v_mfma_f32_16x16x32_bf16 v[8:11], v[156:159], v[204:207], v[8:11]
    v_mfma_f32_16x16x32_bf16 v[12:15], v[164:167], v[188:191], v[12:15]
    v_mfma_f32_16x16x32_bf16 v[16:19], v[164:167], v[196:199], v[16:19]
    s_waitcnt lgkmcnt(0)
    s_barrier
    v_mfma_f32_16x16x32_bf16 v[20:23], v[164:167], v[204:207], v[20:23]
    v_mfma_f32_16x16x32_bf16 v[24:27], v[172:175], v[188:191], v[24:27]
    v_mfma_f32_16x16x32_bf16 v[28:31], v[172:175], v[196:199], v[28:31]
    v_mfma_f32_16x16x32_bf16 v[32:35], v[172:175], v[204:207], v[32:35]
    v_mfma_f32_16x16x32_bf16 v[36:39], v[180:183], v[188:191], v[36:39]
    v_mfma_f32_16x16x32_bf16 v[40:43], v[180:183], v[196:199], v[40:43]
    v_mfma_f32_16x16x32_bf16 v[44:47], v[180:183], v[204:207], v[44:47]
    v_mfma_f32_16x16x32_bf16 v[0:3], v[96:99], v[128:131], v[0:3]
    ds_read_b128 v[152:155], v215 offset:28672
    v_mfma_f32_16x16x32_bf16 v[4:7], v[96:99], v[136:139], v[4:7]
    v_mfma_f32_16x16x32_bf16 v[8:11], v[96:99], v[144:147], v[8:11]
    ds_read_b128 v[184:187], v209 offset:28672
    v_mfma_f32_16x16x32_bf16 v[12:15], v[104:107], v[128:131], v[12:15]
    v_mfma_f32_16x16x32_bf16 v[16:19], v[104:107], v[136:139], v[16:19]
    ds_read_b128 v[192:195], v209 offset:30720
    v_mfma_f32_16x16x32_bf16 v[20:23], v[104:107], v[144:147], v[20:23]
    v_mfma_f32_16x16x32_bf16 v[24:27], v[112:115], v[128:131], v[24:27]
    ds_read_b128 v[200:203], v209 offset:32768
    v_mfma_f32_16x16x32_bf16 v[28:31], v[112:115], v[136:139], v[28:31]
    v_mfma_f32_16x16x32_bf16 v[32:35], v[112:115], v[144:147], v[32:35]
    ds_read_b128 v[160:163], v215 offset:30720
    v_mfma_f32_16x16x32_bf16 v[36:39], v[120:123], v[128:131], v[36:39]
    v_mfma_f32_16x16x32_bf16 v[40:43], v[120:123], v[136:139], v[40:43]
    ds_read_b128 v[168:171], v215 offset:32768
    v_mfma_f32_16x16x32_bf16 v[44:47], v[120:123], v[144:147], v[44:47]
    v_mfma_f32_16x16x32_bf16 v[48:51], v[96:99], v[132:135], v[48:51]
    ds_read_b128 v[176:179], v215 offset:34816
    v_mfma_f32_16x16x32_bf16 v[52:55], v[96:99], v[140:143], v[52:55]
    v_mfma_f32_16x16x32_bf16 v[56:59], v[96:99], v[148:151], v[56:59]
    ds_read_b128 v[188:191], v212 offset:28672
    v_mfma_f32_16x16x32_bf16 v[60:63], v[104:107], v[132:135], v[60:63]
    v_mfma_f32_16x16x32_bf16 v[64:67], v[104:107], v[140:143], v[64:67]
    ds_read_b128 v[196:199], v212 offset:30720
    v_mfma_f32_16x16x32_bf16 v[68:71], v[104:107], v[148:151], v[68:71]
    v_mfma_f32_16x16x32_bf16 v[72:75], v[112:115], v[132:135], v[72:75]
    ds_read_b128 v[204:207], v212 offset:32768
    v_mfma_f32_16x16x32_bf16 v[76:79], v[112:115], v[140:143], v[76:79]
    v_mfma_f32_16x16x32_bf16 v[80:83], v[112:115], v[148:151], v[80:83]
    ds_read_b128 v[156:159], v215 offset:29696
    v_mfma_f32_16x16x32_bf16 v[84:87], v[120:123], v[132:135], v[84:87]
    v_mfma_f32_16x16x32_bf16 v[88:91], v[120:123], v[140:143], v[88:91]
    ds_read_b128 v[164:167], v215 offset:31744
    v_mfma_f32_16x16x32_bf16 v[92:95], v[120:123], v[148:151], v[92:95]
    v_mfma_f32_16x16x32_bf16 v[48:51], v[100:103], v[128:131], v[48:51]
    ds_read_b128 v[172:175], v215 offset:33792
    v_xor_b32 v132, s34, v132
    v_xor_b32 v133, s34, v133
    v_mfma_f32_16x16x32_bf16 v[52:55], v[100:103], v[136:139], v[52:55]
    v_xor_b32 v134, s34, v134
    v_xor_b32 v135, s34, v135
    v_mfma_f32_16x16x32_bf16 v[56:59], v[100:103], v[144:147], v[56:59]
    ds_read_b128 v[180:183], v215 offset:35840
    v_xor_b32 v140, s34, v140
    v_xor_b32 v141, s34, v141
    v_mfma_f32_16x16x32_bf16 v[60:63], v[108:111], v[128:131], v[60:63]
    v_xor_b32 v142, s34, v142
    v_xor_b32 v143, s34, v143
    v_mfma_f32_16x16x32_bf16 v[64:67], v[108:111], v[136:139], v[64:67]
    v_xor_b32 v148, s34, v148
    v_xor_b32 v149, s34, v149
    v_mfma_f32_16x16x32_bf16 v[68:71], v[108:111], v[144:147], v[68:71]
    v_xor_b32 v150, s34, v150
    v_xor_b32 v151, s34, v151
    v_mfma_f32_16x16x32_bf16 v[72:75], v[116:119], v[128:131], v[72:75]
    v_mfma_f32_16x16x32_bf16 v[76:79], v[116:119], v[136:139], v[76:79]
    v_mfma_f32_16x16x32_bf16 v[80:83], v[116:119], v[144:147], v[80:83]
    v_mfma_f32_16x16x32_bf16 v[84:87], v[124:127], v[128:131], v[84:87]
    v_mfma_f32_16x16x32_bf16 v[88:91], v[124:127], v[136:139], v[88:91]
    v_mfma_f32_16x16x32_bf16 v[92:95], v[124:127], v[144:147], v[92:95]
    v_mfma_f32_16x16x32_bf16 v[0:3], v[100:103], v[132:135], v[0:3]
    v_mfma_f32_16x16x32_bf16 v[4:7], v[100:103], v[140:143], v[4:7]
    v_mfma_f32_16x16x32_bf16 v[8:11], v[100:103], v[148:151], v[8:11]
    v_mfma_f32_16x16x32_bf16 v[12:15], v[108:111], v[132:135], v[12:15]
    v_mfma_f32_16x16x32_bf16 v[16:19], v[108:111], v[140:143], v[16:19]
    s_waitcnt lgkmcnt(0)
    s_barrier
    v_mfma_f32_16x16x32_bf16 v[20:23], v[108:111], v[148:151], v[20:23]
    v_mfma_f32_16x16x32_bf16 v[24:27], v[116:119], v[132:135], v[24:27]
    v_mfma_f32_16x16x32_bf16 v[28:31], v[116:119], v[140:143], v[28:31]
    v_mfma_f32_16x16x32_bf16 v[32:35], v[116:119], v[148:151], v[32:35]
    v_mfma_f32_16x16x32_bf16 v[36:39], v[124:127], v[132:135], v[36:39]
    v_mfma_f32_16x16x32_bf16 v[40:43], v[124:127], v[140:143], v[40:43]
    v_mfma_f32_16x16x32_bf16 v[44:47], v[124:127], v[148:151], v[44:47]
    v_mfma_f32_16x16x32_bf16 v[0:3], v[152:155], v[184:187], v[0:3]
    ds_read_b128 v[96:99], v216 offset:0
    v_mfma_f32_16x16x32_bf16 v[4:7], v[152:155], v[192:195], v[4:7]
    v_mfma_f32_16x16x32_bf16 v[8:11], v[152:155], v[200:203], v[8:11]
    ds_read_b128 v[128:131], v210 offset:0
    v_mfma_f32_16x16x32_bf16 v[12:15], v[160:163], v[184:187], v[12:15]
    v_mfma_f32_16x16x32_bf16 v[16:19], v[160:163], v[192:195], v[16:19]
    ds_read_b128 v[136:139], v210 offset:2048
    v_mfma_f32_16x16x32_bf16 v[20:23], v[160:163], v[200:203], v[20:23]
    v_mfma_f32_16x16x32_bf16 v[24:27], v[168:171], v[184:187], v[24:27]
    ds_read_b128 v[144:147], v210 offset:4096
    v_mfma_f32_16x16x32_bf16 v[28:31], v[168:171], v[192:195], v[28:31]
    v_mfma_f32_16x16x32_bf16 v[32:35], v[168:171], v[200:203], v[32:35]
    ds_read_b128 v[104:107], v216 offset:2048
    v_mfma_f32_16x16x32_bf16 v[36:39], v[176:179], v[184:187], v[36:39]
    v_mfma_f32_16x16x32_bf16 v[40:43], v[176:179], v[192:195], v[40:43]
    ds_read_b128 v[112:115], v216 offset:4096
    v_mfma_f32_16x16x32_bf16 v[44:47], v[176:179], v[200:203], v[44:47]
    v_mfma_f32_16x16x32_bf16 v[48:51], v[152:155], v[188:191], v[48:51]
    ds_read_b128 v[120:123], v216 offset:6144
    v_mfma_f32_16x16x32_bf16 v[52:55], v[152:155], v[196:199], v[52:55]
    v_mfma_f32_16x16x32_bf16 v[56:59], v[152:155], v[204:207], v[56:59]
    ds_read_b128 v[132:135], v213 offset:0
    v_mfma_f32_16x16x32_bf16 v[60:63], v[160:163], v[188:191], v[60:63]
    v_mfma_f32_16x16x32_bf16 v[64:67], v[160:163], v[196:199], v[64:67]
    ds_read_b128 v[140:143], v213 offset:2048
    v_mfma_f32_16x16x32_bf16 v[68:71], v[160:163], v[204:207], v[68:71]
    v_mfma_f32_16x16x32_bf16 v[72:75], v[168:171], v[188:191], v[72:75]
    ds_read_b128 v[148:151], v213 offset:4096
    v_mfma_f32_16x16x32_bf16 v[76:79], v[168:171], v[196:199], v[76:79]
    v_mfma_f32_16x16x32_bf16 v[80:83], v[168:171], v[204:207], v[80:83]
    ds_read_b128 v[100:103], v216 offset:1024
    v_mfma_f32_16x16x32_bf16 v[84:87], v[176:179], v[188:191], v[84:87]
    v_mfma_f32_16x16x32_bf16 v[88:91], v[176:179], v[196:199], v[88:91]
    ds_read_b128 v[108:111], v216 offset:3072
    v_mfma_f32_16x16x32_bf16 v[92:95], v[176:179], v[204:207], v[92:95]
    v_mfma_f32_16x16x32_bf16 v[48:51], v[156:159], v[184:187], v[48:51]
    ds_read_b128 v[116:119], v216 offset:5120
    v_xor_b32 v188, s34, v188
    v_xor_b32 v189, s34, v189
    v_mfma_f32_16x16x32_bf16 v[52:55], v[156:159], v[192:195], v[52:55]
    v_xor_b32 v190, s34, v190
    v_xor_b32 v191, s34, v191
    v_mfma_f32_16x16x32_bf16 v[56:59], v[156:159], v[200:203], v[56:59]
    ds_read_b128 v[124:127], v216 offset:7168
    v_xor_b32 v196, s34, v196
    v_xor_b32 v197, s34, v197
    v_mfma_f32_16x16x32_bf16 v[60:63], v[164:167], v[184:187], v[60:63]
    v_xor_b32 v198, s34, v198
    v_xor_b32 v199, s34, v199
    v_mfma_f32_16x16x32_bf16 v[64:67], v[164:167], v[192:195], v[64:67]
    v_xor_b32 v204, s34, v204
    v_xor_b32 v205, s34, v205
    v_mfma_f32_16x16x32_bf16 v[68:71], v[164:167], v[200:203], v[68:71]
    v_xor_b32 v206, s34, v206
    v_xor_b32 v207, s34, v207
    v_mfma_f32_16x16x32_bf16 v[72:75], v[172:175], v[184:187], v[72:75]
    v_mfma_f32_16x16x32_bf16 v[76:79], v[172:175], v[192:195], v[76:79]
    v_mfma_f32_16x16x32_bf16 v[80:83], v[172:175], v[200:203], v[80:83]
    v_mfma_f32_16x16x32_bf16 v[84:87], v[180:183], v[184:187], v[84:87]
    v_mfma_f32_16x16x32_bf16 v[88:91], v[180:183], v[192:195], v[88:91]
    v_mfma_f32_16x16x32_bf16 v[92:95], v[180:183], v[200:203], v[92:95]
    v_mfma_f32_16x16x32_bf16 v[0:3], v[156:159], v[188:191], v[0:3]
    v_mfma_f32_16x16x32_bf16 v[4:7], v[156:159], v[196:199], v[4:7]
    v_mfma_f32_16x16x32_bf16 v[8:11], v[156:159], v[204:207], v[8:11]
    v_mfma_f32_16x16x32_bf16 v[12:15], v[164:167], v[188:191], v[12:15]
    v_mfma_f32_16x16x32_bf16 v[16:19], v[164:167], v[196:199], v[16:19]
    s_waitcnt lgkmcnt(0)
    s_barrier
    v_mfma_f32_16x16x32_bf16 v[20:23], v[164:167], v[204:207], v[20:23]
    v_mfma_f32_16x16x32_bf16 v[24:27], v[172:175], v[188:191], v[24:27]
    v_mfma_f32_16x16x32_bf16 v[28:31], v[172:175], v[196:199], v[28:31]
    v_mfma_f32_16x16x32_bf16 v[32:35], v[172:175], v[204:207], v[32:35]
    v_mfma_f32_16x16x32_bf16 v[36:39], v[180:183], v[188:191], v[36:39]
    v_mfma_f32_16x16x32_bf16 v[40:43], v[180:183], v[196:199], v[40:43]
    v_mfma_f32_16x16x32_bf16 v[44:47], v[180:183], v[204:207], v[44:47]
    v_mfma_f32_16x16x32_bf16 v[0:3], v[96:99], v[128:131], v[0:3]
    ds_read_b128 v[152:155], v214 offset:0
    v_mfma_f32_16x16x32_bf16 v[4:7], v[96:99], v[136:139], v[4:7]
    v_mfma_f32_16x16x32_bf16 v[8:11], v[96:99], v[144:147], v[8:11]
    ds_read_b128 v[184:187], v208 offset:0
    v_mfma_f32_16x16x32_bf16 v[12:15], v[104:107], v[128:131], v[12:15]
    v_mfma_f32_16x16x32_bf16 v[16:19], v[104:107], v[136:139], v[16:19]
    ds_read_b128 v[192:195], v208 offset:2048
    v_mfma_f32_16x16x32_bf16 v[20:23], v[104:107], v[144:147], v[20:23]
    v_mfma_f32_16x16x32_bf16 v[24:27], v[112:115], v[128:131], v[24:27]
    ds_read_b128 v[200:203], v208 offset:4096
    v_mfma_f32_16x16x32_bf16 v[28:31], v[112:115], v[136:139], v[28:31]
    v_mfma_f32_16x16x32_bf16 v[32:35], v[112:115], v[144:147], v[32:35]
    ds_read_b128 v[160:163], v214 offset:2048
    v_mfma_f32_16x16x32_bf16 v[36:39], v[120:123], v[128:131], v[36:39]
    v_mfma_f32_16x16x32_bf16 v[40:43], v[120:123], v[136:139], v[40:43]
    ds_read_b128 v[168:171], v214 offset:4096
    v_mfma_f32_16x16x32_bf16 v[44:47], v[120:123], v[144:147], v[44:47]
    v_mfma_f32_16x16x32_bf16 v[48:51], v[96:99], v[132:135], v[48:51]
    ds_read_b128 v[176:179], v214 offset:6144
    v_mfma_f32_16x16x32_bf16 v[52:55], v[96:99], v[140:143], v[52:55]
    v_mfma_f32_16x16x32_bf16 v[56:59], v[96:99], v[148:151], v[56:59]
    ds_read_b128 v[188:191], v211 offset:0
    v_mfma_f32_16x16x32_bf16 v[60:63], v[104:107], v[132:135], v[60:63]
    v_mfma_f32_16x16x32_bf16 v[64:67], v[104:107], v[140:143], v[64:67]
    ds_read_b128 v[196:199], v211 offset:2048
    v_mfma_f32_16x16x32_bf16 v[68:71], v[104:107], v[148:151], v[68:71]
    v_mfma_f32_16x16x32_bf16 v[72:75], v[112:115], v[132:135], v[72:75]
    ds_read_b128 v[204:207], v211 offset:4096
    v_mfma_f32_16x16x32_bf16 v[76:79], v[112:115], v[140:143], v[76:79]
    v_mfma_f32_16x16x32_bf16 v[80:83], v[112:115], v[148:151], v[80:83]
    ds_read_b128 v[156:159], v214 offset:1024
    v_mfma_f32_16x16x32_bf16 v[84:87], v[120:123], v[132:135], v[84:87]
    v_mfma_f32_16x16x32_bf16 v[88:91], v[120:123], v[140:143], v[88:91]
    ds_read_b128 v[164:167], v214 offset:3072
    v_mfma_f32_16x16x32_bf16 v[92:95], v[120:123], v[148:151], v[92:95]
    v_mfma_f32_16x16x32_bf16 v[48:51], v[100:103], v[128:131], v[48:51]
    ds_read_b128 v[172:175], v214 offset:5120
    v_xor_b32 v132, s34, v132
    v_xor_b32 v133, s34, v133
    v_mfma_f32_16x16x32_bf16 v[52:55], v[100:103], v[136:139], v[52:55]
    v_xor_b32 v134, s34, v134
    v_xor_b32 v135, s34, v135
    v_mfma_f32_16x16x32_bf16 v[56:59], v[100:103], v[144:147], v[56:59]
    ds_read_b128 v[180:183], v214 offset:7168
    v_xor_b32 v140, s34, v140
    v_xor_b32 v141, s34, v141
    v_mfma_f32_16x16x32_bf16 v[60:63], v[108:111], v[128:131], v[60:63]
    v_xor_b32 v142, s34, v142
    v_xor_b32 v143, s34, v143
    v_mfma_f32_16x16x32_bf16 v[64:67], v[108:111], v[136:139], v[64:67]
    v_xor_b32 v148, s34, v148
    v_xor_b32 v149, s34, v149
    v_mfma_f32_16x16x32_bf16 v[68:71], v[108:111], v[144:147], v[68:71]
    v_xor_b32 v150, s34, v150
    v_xor_b32 v151, s34, v151
    v_mfma_f32_16x16x32_bf16 v[72:75], v[116:119], v[128:131], v[72:75]
    v_mfma_f32_16x16x32_bf16 v[76:79], v[116:119], v[136:139], v[76:79]
    v_mfma_f32_16x16x32_bf16 v[80:83], v[116:119], v[144:147], v[80:83]
    v_mfma_f32_16x16x32_bf16 v[84:87], v[124:127], v[128:131], v[84:87]
    v_mfma_f32_16x16x32_bf16 v[88:91], v[124:127], v[136:139], v[88:91]
    v_mfma_f32_16x16x32_bf16 v[92:95], v[124:127], v[144:147], v[92:95]
    v_mfma_f32_16x16x32_bf16 v[0:3], v[100:103], v[132:135], v[0:3]
    v_mfma_f32_16x16x32_bf16 v[4:7], v[100:103], v[140:143], v[4:7]
    v_mfma_f32_16x16x32_bf16 v[8:11], v[100:103], v[148:151], v[8:11]
    v_mfma_f32_16x16x32_bf16 v[12:15], v[108:111], v[132:135], v[12:15]
    v_mfma_f32_16x16x32_bf16 v[16:19], v[108:111], v[140:143], v[16:19]
    s_waitcnt lgkmcnt(0)
    s_barrier
    v_mfma_f32_16x16x32_bf16 v[20:23], v[108:111], v[148:151], v[20:23]
    v_mfma_f32_16x16x32_bf16 v[24:27], v[116:119], v[132:135], v[24:27]
    v_mfma_f32_16x16x32_bf16 v[28:31], v[116:119], v[140:143], v[28:31]
    v_mfma_f32_16x16x32_bf16 v[32:35], v[116:119], v[148:151], v[32:35]
    v_mfma_f32_16x16x32_bf16 v[36:39], v[124:127], v[132:135], v[36:39]
    v_mfma_f32_16x16x32_bf16 v[40:43], v[124:127], v[140:143], v[40:43]
    v_mfma_f32_16x16x32_bf16 v[44:47], v[124:127], v[148:151], v[44:47]
    v_mfma_f32_16x16x32_bf16 v[0:3], v[152:155], v[184:187], v[0:3]
    ds_read_b128 v[96:99], v214 offset:28672
    v_mfma_f32_16x16x32_bf16 v[4:7], v[152:155], v[192:195], v[4:7]
    v_mfma_f32_16x16x32_bf16 v[8:11], v[152:155], v[200:203], v[8:11]
    ds_read_b128 v[128:131], v208 offset:28672
    v_mfma_f32_16x16x32_bf16 v[12:15], v[160:163], v[184:187], v[12:15]
    v_mfma_f32_16x16x32_bf16 v[16:19], v[160:163], v[192:195], v[16:19]
    ds_read_b128 v[136:139], v208 offset:30720
    v_mfma_f32_16x16x32_bf16 v[20:23], v[160:163], v[200:203], v[20:23]
    v_mfma_f32_16x16x32_bf16 v[24:27], v[168:171], v[184:187], v[24:27]
    ds_read_b128 v[144:147], v208 offset:32768
    v_mfma_f32_16x16x32_bf16 v[28:31], v[168:171], v[192:195], v[28:31]
    v_mfma_f32_16x16x32_bf16 v[32:35], v[168:171], v[200:203], v[32:35]
    ds_read_b128 v[104:107], v214 offset:30720
    v_mfma_f32_16x16x32_bf16 v[36:39], v[176:179], v[184:187], v[36:39]
    v_mfma_f32_16x16x32_bf16 v[40:43], v[176:179], v[192:195], v[40:43]
    ds_read_b128 v[112:115], v214 offset:32768
    v_mfma_f32_16x16x32_bf16 v[44:47], v[176:179], v[200:203], v[44:47]
    v_mfma_f32_16x16x32_bf16 v[48:51], v[152:155], v[188:191], v[48:51]
    ds_read_b128 v[120:123], v214 offset:34816
    v_mfma_f32_16x16x32_bf16 v[52:55], v[152:155], v[196:199], v[52:55]
    v_mfma_f32_16x16x32_bf16 v[56:59], v[152:155], v[204:207], v[56:59]
    ds_read_b128 v[132:135], v211 offset:28672
    v_mfma_f32_16x16x32_bf16 v[60:63], v[160:163], v[188:191], v[60:63]
    v_mfma_f32_16x16x32_bf16 v[64:67], v[160:163], v[196:199], v[64:67]
    ds_read_b128 v[140:143], v211 offset:30720
    v_mfma_f32_16x16x32_bf16 v[68:71], v[160:163], v[204:207], v[68:71]
    v_mfma_f32_16x16x32_bf16 v[72:75], v[168:171], v[188:191], v[72:75]
    ds_read_b128 v[148:151], v211 offset:32768
    v_mfma_f32_16x16x32_bf16 v[76:79], v[168:171], v[196:199], v[76:79]
    v_mfma_f32_16x16x32_bf16 v[80:83], v[168:171], v[204:207], v[80:83]
    ds_read_b128 v[100:103], v214 offset:29696
    v_mfma_f32_16x16x32_bf16 v[84:87], v[176:179], v[188:191], v[84:87]
    v_mfma_f32_16x16x32_bf16 v[88:91], v[176:179], v[196:199], v[88:91]
    ds_read_b128 v[108:111], v214 offset:31744
    v_mfma_f32_16x16x32_bf16 v[92:95], v[176:179], v[204:207], v[92:95]
    v_mfma_f32_16x16x32_bf16 v[48:51], v[156:159], v[184:187], v[48:51]
    ds_read_b128 v[116:119], v214 offset:33792
    v_xor_b32 v188, s34, v188
    v_xor_b32 v189, s34, v189
    v_mfma_f32_16x16x32_bf16 v[52:55], v[156:159], v[192:195], v[52:55]
    v_xor_b32 v190, s34, v190
    v_xor_b32 v191, s34, v191
    v_mfma_f32_16x16x32_bf16 v[56:59], v[156:159], v[200:203], v[56:59]
    ds_read_b128 v[124:127], v214 offset:35840
    v_xor_b32 v196, s34, v196
    v_xor_b32 v197, s34, v197
    v_mfma_f32_16x16x32_bf16 v[60:63], v[164:167], v[184:187], v[60:63]
    v_xor_b32 v198, s34, v198
    v_xor_b32 v199, s34, v199
    v_mfma_f32_16x16x32_bf16 v[64:67], v[164:167], v[192:195], v[64:67]
    v_xor_b32 v204, s34, v204
    v_xor_b32 v205, s34, v205
    v_mfma_f32_16x16x32_bf16 v[68:71], v[164:167], v[200:203], v[68:71]
    v_xor_b32 v206, s34, v206
    v_xor_b32 v207, s34, v207
    v_mfma_f32_16x16x32_bf16 v[72:75], v[172:175], v[184:187], v[72:75]
    v_mfma_f32_16x16x32_bf16 v[76:79], v[172:175], v[192:195], v[76:79]
    v_mfma_f32_16x16x32_bf16 v[80:83], v[172:175], v[200:203], v[80:83]
    v_mfma_f32_16x16x32_bf16 v[84:87], v[180:183], v[184:187], v[84:87]
    v_mfma_f32_16x16x32_bf16 v[88:91], v[180:183], v[192:195], v[88:91]
    v_mfma_f32_16x16x32_bf16 v[92:95], v[180:183], v[200:203], v[92:95]
    v_mfma_f32_16x16x32_bf16 v[0:3], v[156:159], v[188:191], v[0:3]
    v_mfma_f32_16x16x32_bf16 v[4:7], v[156:159], v[196:199], v[4:7]
    v_mfma_f32_16x16x32_bf16 v[8:11], v[156:159], v[204:207], v[8:11]
    v_mfma_f32_16x16x32_bf16 v[12:15], v[164:167], v[188:191], v[12:15]
    v_mfma_f32_16x16x32_bf16 v[16:19], v[164:167], v[196:199], v[16:19]
    s_waitcnt lgkmcnt(0)
    s_barrier
    v_mfma_f32_16x16x32_bf16 v[20:23], v[164:167], v[204:207], v[20:23]
    v_mfma_f32_16x16x32_bf16 v[24:27], v[172:175], v[188:191], v[24:27]
    v_mfma_f32_16x16x32_bf16 v[28:31], v[172:175], v[196:199], v[28:31]
    v_mfma_f32_16x16x32_bf16 v[32:35], v[172:175], v[204:207], v[32:35]
    v_mfma_f32_16x16x32_bf16 v[36:39], v[180:183], v[188:191], v[36:39]
    v_mfma_f32_16x16x32_bf16 v[40:43], v[180:183], v[196:199], v[40:43]
    v_mfma_f32_16x16x32_bf16 v[44:47], v[180:183], v[204:207], v[44:47]
    v_mfma_f32_16x16x32_bf16 v[0:3], v[96:99], v[128:131], v[0:3]
    ds_read_b128 v[152:155], v215 offset:0
    v_mfma_f32_16x16x32_bf16 v[4:7], v[96:99], v[136:139], v[4:7]
    v_mfma_f32_16x16x32_bf16 v[8:11], v[96:99], v[144:147], v[8:11]
    ds_read_b128 v[184:187], v209 offset:0
    v_mfma_f32_16x16x32_bf16 v[12:15], v[104:107], v[128:131], v[12:15]
    v_mfma_f32_16x16x32_bf16 v[16:19], v[104:107], v[136:139], v[16:19]
    ds_read_b128 v[192:195], v209 offset:2048
    v_mfma_f32_16x16x32_bf16 v[20:23], v[104:107], v[144:147], v[20:23]
    v_mfma_f32_16x16x32_bf16 v[24:27], v[112:115], v[128:131], v[24:27]
    ds_read_b128 v[200:203], v209 offset:4096
    v_mfma_f32_16x16x32_bf16 v[28:31], v[112:115], v[136:139], v[28:31]
    v_mfma_f32_16x16x32_bf16 v[32:35], v[112:115], v[144:147], v[32:35]
    ds_read_b128 v[160:163], v215 offset:2048
    v_mfma_f32_16x16x32_bf16 v[36:39], v[120:123], v[128:131], v[36:39]
    v_mfma_f32_16x16x32_bf16 v[40:43], v[120:123], v[136:139], v[40:43]
    ds_read_b128 v[168:171], v215 offset:4096
    v_mfma_f32_16x16x32_bf16 v[44:47], v[120:123], v[144:147], v[44:47]
    v_mfma_f32_16x16x32_bf16 v[48:51], v[96:99], v[132:135], v[48:51]
    ds_read_b128 v[176:179], v215 offset:6144
    v_mfma_f32_16x16x32_bf16 v[52:55], v[96:99], v[140:143], v[52:55]
    v_mfma_f32_16x16x32_bf16 v[56:59], v[96:99], v[148:151], v[56:59]
    ds_read_b128 v[188:191], v212 offset:0
    v_mfma_f32_16x16x32_bf16 v[60:63], v[104:107], v[132:135], v[60:63]
    v_mfma_f32_16x16x32_bf16 v[64:67], v[104:107], v[140:143], v[64:67]
    ds_read_b128 v[196:199], v212 offset:2048
    v_mfma_f32_16x16x32_bf16 v[68:71], v[104:107], v[148:151], v[68:71]
    v_mfma_f32_16x16x32_bf16 v[72:75], v[112:115], v[132:135], v[72:75]
    ds_read_b128 v[204:207], v212 offset:4096
    v_mfma_f32_16x16x32_bf16 v[76:79], v[112:115], v[140:143], v[76:79]
    v_mfma_f32_16x16x32_bf16 v[80:83], v[112:115], v[148:151], v[80:83]
    ds_read_b128 v[156:159], v215 offset:1024
    v_mfma_f32_16x16x32_bf16 v[84:87], v[120:123], v[132:135], v[84:87]
    v_mfma_f32_16x16x32_bf16 v[88:91], v[120:123], v[140:143], v[88:91]
    ds_read_b128 v[164:167], v215 offset:3072
    v_mfma_f32_16x16x32_bf16 v[92:95], v[120:123], v[148:151], v[92:95]
    v_mfma_f32_16x16x32_bf16 v[48:51], v[100:103], v[128:131], v[48:51]
    ds_read_b128 v[172:175], v215 offset:5120
    v_xor_b32 v132, s34, v132
    v_xor_b32 v133, s34, v133
    v_mfma_f32_16x16x32_bf16 v[52:55], v[100:103], v[136:139], v[52:55]
    v_xor_b32 v134, s34, v134
    v_xor_b32 v135, s34, v135
    v_mfma_f32_16x16x32_bf16 v[56:59], v[100:103], v[144:147], v[56:59]
    ds_read_b128 v[180:183], v215 offset:7168
    v_xor_b32 v140, s34, v140
    v_xor_b32 v141, s34, v141
    v_mfma_f32_16x16x32_bf16 v[60:63], v[108:111], v[128:131], v[60:63]
    v_xor_b32 v142, s34, v142
    v_xor_b32 v143, s34, v143
    v_mfma_f32_16x16x32_bf16 v[64:67], v[108:111], v[136:139], v[64:67]
    v_xor_b32 v148, s34, v148
    v_xor_b32 v149, s34, v149
    v_mfma_f32_16x16x32_bf16 v[68:71], v[108:111], v[144:147], v[68:71]
    v_xor_b32 v150, s34, v150
    v_xor_b32 v151, s34, v151
    v_mfma_f32_16x16x32_bf16 v[72:75], v[116:119], v[128:131], v[72:75]
    v_mfma_f32_16x16x32_bf16 v[76:79], v[116:119], v[136:139], v[76:79]
    v_mfma_f32_16x16x32_bf16 v[80:83], v[116:119], v[144:147], v[80:83]
    v_mfma_f32_16x16x32_bf16 v[84:87], v[124:127], v[128:131], v[84:87]
    v_mfma_f32_16x16x32_bf16 v[88:91], v[124:127], v[136:139], v[88:91]
    v_mfma_f32_16x16x32_bf16 v[92:95], v[124:127], v[144:147], v[92:95]
    v_mfma_f32_16x16x32_bf16 v[0:3], v[100:103], v[132:135], v[0:3]
    v_mfma_f32_16x16x32_bf16 v[4:7], v[100:103], v[140:143], v[4:7]
    v_mfma_f32_16x16x32_bf16 v[8:11], v[100:103], v[148:151], v[8:11]
    v_mfma_f32_16x16x32_bf16 v[12:15], v[108:111], v[132:135], v[12:15]
    v_mfma_f32_16x16x32_bf16 v[16:19], v[108:111], v[140:143], v[16:19]
    s_waitcnt lgkmcnt(0)
    s_barrier
    v_mfma_f32_16x16x32_bf16 v[20:23], v[108:111], v[148:151], v[20:23]
    v_mfma_f32_16x16x32_bf16 v[24:27], v[116:119], v[132:135], v[24:27]
    v_mfma_f32_16x16x32_bf16 v[28:31], v[116:119], v[140:143], v[28:31]
    v_mfma_f32_16x16x32_bf16 v[32:35], v[116:119], v[148:151], v[32:35]
    v_mfma_f32_16x16x32_bf16 v[36:39], v[124:127], v[132:135], v[36:39]
    v_mfma_f32_16x16x32_bf16 v[40:43], v[124:127], v[140:143], v[40:43]
    v_mfma_f32_16x16x32_bf16 v[44:47], v[124:127], v[148:151], v[44:47]
    v_mfma_f32_16x16x32_bf16 v[0:3], v[152:155], v[184:187], v[0:3]
    ds_read_b128 v[96:99], v215 offset:28672
    v_mfma_f32_16x16x32_bf16 v[4:7], v[152:155], v[192:195], v[4:7]
    v_mfma_f32_16x16x32_bf16 v[8:11], v[152:155], v[200:203], v[8:11]
    ds_read_b128 v[128:131], v209 offset:28672
    v_mfma_f32_16x16x32_bf16 v[12:15], v[160:163], v[184:187], v[12:15]
    v_mfma_f32_16x16x32_bf16 v[16:19], v[160:163], v[192:195], v[16:19]
    ds_read_b128 v[136:139], v209 offset:30720
    v_mfma_f32_16x16x32_bf16 v[20:23], v[160:163], v[200:203], v[20:23]
    v_mfma_f32_16x16x32_bf16 v[24:27], v[168:171], v[184:187], v[24:27]
    ds_read_b128 v[144:147], v209 offset:32768
    v_mfma_f32_16x16x32_bf16 v[28:31], v[168:171], v[192:195], v[28:31]
    v_mfma_f32_16x16x32_bf16 v[32:35], v[168:171], v[200:203], v[32:35]
    ds_read_b128 v[104:107], v215 offset:30720
    v_mfma_f32_16x16x32_bf16 v[36:39], v[176:179], v[184:187], v[36:39]
    v_mfma_f32_16x16x32_bf16 v[40:43], v[176:179], v[192:195], v[40:43]
    ds_read_b128 v[112:115], v215 offset:32768
    v_mfma_f32_16x16x32_bf16 v[44:47], v[176:179], v[200:203], v[44:47]
    v_mfma_f32_16x16x32_bf16 v[48:51], v[152:155], v[188:191], v[48:51]
    ds_read_b128 v[120:123], v215 offset:34816
    v_mfma_f32_16x16x32_bf16 v[52:55], v[152:155], v[196:199], v[52:55]
    v_mfma_f32_16x16x32_bf16 v[56:59], v[152:155], v[204:207], v[56:59]
    ds_read_b128 v[132:135], v212 offset:28672
    v_mfma_f32_16x16x32_bf16 v[60:63], v[160:163], v[188:191], v[60:63]
    v_mfma_f32_16x16x32_bf16 v[64:67], v[160:163], v[196:199], v[64:67]
    ds_read_b128 v[140:143], v212 offset:30720
    v_mfma_f32_16x16x32_bf16 v[68:71], v[160:163], v[204:207], v[68:71]
    v_mfma_f32_16x16x32_bf16 v[72:75], v[168:171], v[188:191], v[72:75]
    ds_read_b128 v[148:151], v212 offset:32768
    v_mfma_f32_16x16x32_bf16 v[76:79], v[168:171], v[196:199], v[76:79]
    v_mfma_f32_16x16x32_bf16 v[80:83], v[168:171], v[204:207], v[80:83]
    ds_read_b128 v[100:103], v215 offset:29696
    v_mfma_f32_16x16x32_bf16 v[84:87], v[176:179], v[188:191], v[84:87]
    v_mfma_f32_16x16x32_bf16 v[88:91], v[176:179], v[196:199], v[88:91]
    ds_read_b128 v[108:111], v215 offset:31744
    v_mfma_f32_16x16x32_bf16 v[92:95], v[176:179], v[204:207], v[92:95]
    v_mfma_f32_16x16x32_bf16 v[48:51], v[156:159], v[184:187], v[48:51]
    ds_read_b128 v[116:119], v215 offset:33792
    v_xor_b32 v188, s34, v188
    v_xor_b32 v189, s34, v189
    v_mfma_f32_16x16x32_bf16 v[52:55], v[156:159], v[192:195], v[52:55]
    v_xor_b32 v190, s34, v190
    v_xor_b32 v191, s34, v191
    v_mfma_f32_16x16x32_bf16 v[56:59], v[156:159], v[200:203], v[56:59]
    ds_read_b128 v[124:127], v215 offset:35840
    v_xor_b32 v196, s34, v196
    v_xor_b32 v197, s34, v197
    v_mfma_f32_16x16x32_bf16 v[60:63], v[164:167], v[184:187], v[60:63]
    v_xor_b32 v198, s34, v198
    v_xor_b32 v199, s34, v199
    v_mfma_f32_16x16x32_bf16 v[64:67], v[164:167], v[192:195], v[64:67]
    v_xor_b32 v204, s34, v204
    v_xor_b32 v205, s34, v205
    v_mfma_f32_16x16x32_bf16 v[68:71], v[164:167], v[200:203], v[68:71]
    v_xor_b32 v206, s34, v206
    v_xor_b32 v207, s34, v207
    v_mfma_f32_16x16x32_bf16 v[72:75], v[172:175], v[184:187], v[72:75]
    v_mfma_f32_16x16x32_bf16 v[76:79], v[172:175], v[192:195], v[76:79]
    v_mfma_f32_16x16x32_bf16 v[80:83], v[172:175], v[200:203], v[80:83]
    v_mfma_f32_16x16x32_bf16 v[84:87], v[180:183], v[184:187], v[84:87]
    v_mfma_f32_16x16x32_bf16 v[88:91], v[180:183], v[192:195], v[88:91]
    v_mfma_f32_16x16x32_bf16 v[92:95], v[180:183], v[200:203], v[92:95]
    v_mfma_f32_16x16x32_bf16 v[0:3], v[156:159], v[188:191], v[0:3]
    v_mfma_f32_16x16x32_bf16 v[4:7], v[156:159], v[196:199], v[4:7]
    v_mfma_f32_16x16x32_bf16 v[8:11], v[156:159], v[204:207], v[8:11]
    v_mfma_f32_16x16x32_bf16 v[12:15], v[164:167], v[188:191], v[12:15]
    v_mfma_f32_16x16x32_bf16 v[16:19], v[164:167], v[196:199], v[16:19]
    s_waitcnt lgkmcnt(0)
    s_barrier
    v_mfma_f32_16x16x32_bf16 v[20:23], v[164:167], v[204:207], v[20:23]
    v_mfma_f32_16x16x32_bf16 v[24:27], v[172:175], v[188:191], v[24:27]
    v_mfma_f32_16x16x32_bf16 v[28:31], v[172:175], v[196:199], v[28:31]
    v_mfma_f32_16x16x32_bf16 v[32:35], v[172:175], v[204:207], v[32:35]
    v_mfma_f32_16x16x32_bf16 v[36:39], v[180:183], v[188:191], v[36:39]
    v_mfma_f32_16x16x32_bf16 v[40:43], v[180:183], v[196:199], v[40:43]
    v_mfma_f32_16x16x32_bf16 v[44:47], v[180:183], v[204:207], v[44:47]
    v_mfma_f32_16x16x32_bf16 v[0:3], v[96:99], v[128:131], v[0:3]
    ds_read_b128 v[152:155], v216 offset:0
    v_mfma_f32_16x16x32_bf16 v[4:7], v[96:99], v[136:139], v[4:7]
    v_mfma_f32_16x16x32_bf16 v[8:11], v[96:99], v[144:147], v[8:11]
    ds_read_b128 v[184:187], v210 offset:0
    v_mfma_f32_16x16x32_bf16 v[12:15], v[104:107], v[128:131], v[12:15]
    v_mfma_f32_16x16x32_bf16 v[16:19], v[104:107], v[136:139], v[16:19]
    ds_read_b128 v[192:195], v210 offset:2048
    v_mfma_f32_16x16x32_bf16 v[20:23], v[104:107], v[144:147], v[20:23]
    v_mfma_f32_16x16x32_bf16 v[24:27], v[112:115], v[128:131], v[24:27]
    ds_read_b128 v[200:203], v210 offset:4096
    v_mfma_f32_16x16x32_bf16 v[28:31], v[112:115], v[136:139], v[28:31]
    v_mfma_f32_16x16x32_bf16 v[32:35], v[112:115], v[144:147], v[32:35]
    ds_read_b128 v[160:163], v216 offset:2048
    v_mfma_f32_16x16x32_bf16 v[36:39], v[120:123], v[128:131], v[36:39]
    v_mfma_f32_16x16x32_bf16 v[40:43], v[120:123], v[136:139], v[40:43]
    ds_read_b128 v[168:171], v216 offset:4096
    v_mfma_f32_16x16x32_bf16 v[44:47], v[120:123], v[144:147], v[44:47]
    v_mfma_f32_16x16x32_bf16 v[48:51], v[96:99], v[132:135], v[48:51]
    ds_read_b128 v[176:179], v216 offset:6144
    v_mfma_f32_16x16x32_bf16 v[52:55], v[96:99], v[140:143], v[52:55]
    v_mfma_f32_16x16x32_bf16 v[56:59], v[96:99], v[148:151], v[56:59]
    ds_read_b128 v[188:191], v213 offset:0
    v_mfma_f32_16x16x32_bf16 v[60:63], v[104:107], v[132:135], v[60:63]
    v_mfma_f32_16x16x32_bf16 v[64:67], v[104:107], v[140:143], v[64:67]
    ds_read_b128 v[196:199], v213 offset:2048
    v_mfma_f32_16x16x32_bf16 v[68:71], v[104:107], v[148:151], v[68:71]
    v_mfma_f32_16x16x32_bf16 v[72:75], v[112:115], v[132:135], v[72:75]
    ds_read_b128 v[204:207], v213 offset:4096
    v_mfma_f32_16x16x32_bf16 v[76:79], v[112:115], v[140:143], v[76:79]
    v_mfma_f32_16x16x32_bf16 v[80:83], v[112:115], v[148:151], v[80:83]
    ds_read_b128 v[156:159], v216 offset:1024
    v_mfma_f32_16x16x32_bf16 v[84:87], v[120:123], v[132:135], v[84:87]
    v_mfma_f32_16x16x32_bf16 v[88:91], v[120:123], v[140:143], v[88:91]
    ds_read_b128 v[164:167], v216 offset:3072
    v_mfma_f32_16x16x32_bf16 v[92:95], v[120:123], v[148:151], v[92:95]
    v_mfma_f32_16x16x32_bf16 v[48:51], v[100:103], v[128:131], v[48:51]
    ds_read_b128 v[172:175], v216 offset:5120
    v_xor_b32 v132, s34, v132
    v_xor_b32 v133, s34, v133
    v_mfma_f32_16x16x32_bf16 v[52:55], v[100:103], v[136:139], v[52:55]
    v_xor_b32 v134, s34, v134
    v_xor_b32 v135, s34, v135
    v_mfma_f32_16x16x32_bf16 v[56:59], v[100:103], v[144:147], v[56:59]
    ds_read_b128 v[180:183], v216 offset:7168
    v_xor_b32 v140, s34, v140
    v_xor_b32 v141, s34, v141
    v_mfma_f32_16x16x32_bf16 v[60:63], v[108:111], v[128:131], v[60:63]
    v_xor_b32 v142, s34, v142
    v_xor_b32 v143, s34, v143
    v_mfma_f32_16x16x32_bf16 v[64:67], v[108:111], v[136:139], v[64:67]
    v_xor_b32 v148, s34, v148
    v_xor_b32 v149, s34, v149
    v_mfma_f32_16x16x32_bf16 v[68:71], v[108:111], v[144:147], v[68:71]
    v_xor_b32 v150, s34, v150
    v_xor_b32 v151, s34, v151
    v_mfma_f32_16x16x32_bf16 v[72:75], v[116:119], v[128:131], v[72:75]
    v_mfma_f32_16x16x32_bf16 v[76:79], v[116:119], v[136:139], v[76:79]
    v_mfma_f32_16x16x32_bf16 v[80:83], v[116:119], v[144:147], v[80:83]
    v_mfma_f32_16x16x32_bf16 v[84:87], v[124:127], v[128:131], v[84:87]
    v_mfma_f32_16x16x32_bf16 v[88:91], v[124:127], v[136:139], v[88:91]
    v_mfma_f32_16x16x32_bf16 v[92:95], v[124:127], v[144:147], v[92:95]
    v_mfma_f32_16x16x32_bf16 v[0:3], v[100:103], v[132:135], v[0:3]
    v_mfma_f32_16x16x32_bf16 v[4:7], v[100:103], v[140:143], v[4:7]
    v_mfma_f32_16x16x32_bf16 v[8:11], v[100:103], v[148:151], v[8:11]
    v_mfma_f32_16x16x32_bf16 v[12:15], v[108:111], v[132:135], v[12:15]
    v_mfma_f32_16x16x32_bf16 v[16:19], v[108:111], v[140:143], v[16:19]
    s_waitcnt lgkmcnt(0)
    s_barrier
    v_mfma_f32_16x16x32_bf16 v[20:23], v[108:111], v[148:151], v[20:23]
    v_mfma_f32_16x16x32_bf16 v[24:27], v[116:119], v[132:135], v[24:27]
    v_mfma_f32_16x16x32_bf16 v[28:31], v[116:119], v[140:143], v[28:31]
    v_mfma_f32_16x16x32_bf16 v[32:35], v[116:119], v[148:151], v[32:35]
    v_mfma_f32_16x16x32_bf16 v[36:39], v[124:127], v[132:135], v[36:39]
    v_mfma_f32_16x16x32_bf16 v[40:43], v[124:127], v[140:143], v[40:43]
    v_mfma_f32_16x16x32_bf16 v[44:47], v[124:127], v[148:151], v[44:47]
    v_mfma_f32_16x16x32_bf16 v[0:3], v[152:155], v[184:187], v[0:3]
    ds_read_b128 v[96:99], v214 offset:0
    v_mfma_f32_16x16x32_bf16 v[4:7], v[152:155], v[192:195], v[4:7]
    v_mfma_f32_16x16x32_bf16 v[8:11], v[152:155], v[200:203], v[8:11]
    ds_read_b128 v[128:131], v208 offset:0
    v_mfma_f32_16x16x32_bf16 v[12:15], v[160:163], v[184:187], v[12:15]
    v_mfma_f32_16x16x32_bf16 v[16:19], v[160:163], v[192:195], v[16:19]
    ds_read_b128 v[136:139], v208 offset:2048
    v_mfma_f32_16x16x32_bf16 v[20:23], v[160:163], v[200:203], v[20:23]
    v_mfma_f32_16x16x32_bf16 v[24:27], v[168:171], v[184:187], v[24:27]
    ds_read_b128 v[144:147], v208 offset:4096
    v_mfma_f32_16x16x32_bf16 v[28:31], v[168:171], v[192:195], v[28:31]
    v_mfma_f32_16x16x32_bf16 v[32:35], v[168:171], v[200:203], v[32:35]
    ds_read_b128 v[104:107], v214 offset:2048
    v_mfma_f32_16x16x32_bf16 v[36:39], v[176:179], v[184:187], v[36:39]
    v_mfma_f32_16x16x32_bf16 v[40:43], v[176:179], v[192:195], v[40:43]
    ds_read_b128 v[112:115], v214 offset:4096
    v_mfma_f32_16x16x32_bf16 v[44:47], v[176:179], v[200:203], v[44:47]
    v_mfma_f32_16x16x32_bf16 v[48:51], v[152:155], v[188:191], v[48:51]
    ds_read_b128 v[120:123], v214 offset:6144
    v_mfma_f32_16x16x32_bf16 v[52:55], v[152:155], v[196:199], v[52:55]
    v_mfma_f32_16x16x32_bf16 v[56:59], v[152:155], v[204:207], v[56:59]
    ds_read_b128 v[132:135], v211 offset:0
    v_mfma_f32_16x16x32_bf16 v[60:63], v[160:163], v[188:191], v[60:63]
    v_mfma_f32_16x16x32_bf16 v[64:67], v[160:163], v[196:199], v[64:67]
    ds_read_b128 v[140:143], v211 offset:2048
    v_mfma_f32_16x16x32_bf16 v[68:71], v[160:163], v[204:207], v[68:71]
    v_mfma_f32_16x16x32_bf16 v[72:75], v[168:171], v[188:191], v[72:75]
    ds_read_b128 v[148:151], v211 offset:4096
    v_mfma_f32_16x16x32_bf16 v[76:79], v[168:171], v[196:199], v[76:79]
    v_mfma_f32_16x16x32_bf16 v[80:83], v[168:171], v[204:207], v[80:83]
    ds_read_b128 v[100:103], v214 offset:1024
    v_mfma_f32_16x16x32_bf16 v[84:87], v[176:179], v[188:191], v[84:87]
    v_mfma_f32_16x16x32_bf16 v[88:91], v[176:179], v[196:199], v[88:91]
    ds_read_b128 v[108:111], v214 offset:3072
    v_mfma_f32_16x16x32_bf16 v[92:95], v[176:179], v[204:207], v[92:95]
    v_mfma_f32_16x16x32_bf16 v[48:51], v[156:159], v[184:187], v[48:51]
    ds_read_b128 v[116:119], v214 offset:5120
    v_xor_b32 v188, s34, v188
    v_xor_b32 v189, s34, v189
    v_mfma_f32_16x16x32_bf16 v[52:55], v[156:159], v[192:195], v[52:55]
    v_xor_b32 v190, s34, v190
    v_xor_b32 v191, s34, v191
    v_mfma_f32_16x16x32_bf16 v[56:59], v[156:159], v[200:203], v[56:59]
    ds_read_b128 v[124:127], v214 offset:7168
    v_xor_b32 v196, s34, v196
    v_xor_b32 v197, s34, v197
    v_mfma_f32_16x16x32_bf16 v[60:63], v[164:167], v[184:187], v[60:63]
    v_xor_b32 v198, s34, v198
    v_xor_b32 v199, s34, v199
    v_mfma_f32_16x16x32_bf16 v[64:67], v[164:167], v[192:195], v[64:67]
    v_xor_b32 v204, s34, v204
    v_xor_b32 v205, s34, v205
    v_mfma_f32_16x16x32_bf16 v[68:71], v[164:167], v[200:203], v[68:71]
    v_xor_b32 v206, s34, v206
    v_xor_b32 v207, s34, v207
    v_mfma_f32_16x16x32_bf16 v[72:75], v[172:175], v[184:187], v[72:75]
    v_mfma_f32_16x16x32_bf16 v[76:79], v[172:175], v[192:195], v[76:79]
    v_mfma_f32_16x16x32_bf16 v[80:83], v[172:175], v[200:203], v[80:83]
    v_mfma_f32_16x16x32_bf16 v[84:87], v[180:183], v[184:187], v[84:87]
    v_mfma_f32_16x16x32_bf16 v[88:91], v[180:183], v[192:195], v[88:91]
    v_mfma_f32_16x16x32_bf16 v[92:95], v[180:183], v[200:203], v[92:95]
    v_mfma_f32_16x16x32_bf16 v[0:3], v[156:159], v[188:191], v[0:3]
    v_mfma_f32_16x16x32_bf16 v[4:7], v[156:159], v[196:199], v[4:7]
    v_mfma_f32_16x16x32_bf16 v[8:11], v[156:159], v[204:207], v[8:11]
    v_mfma_f32_16x16x32_bf16 v[12:15], v[164:167], v[188:191], v[12:15]
    v_mfma_f32_16x16x32_bf16 v[16:19], v[164:167], v[196:199], v[16:19]
    s_waitcnt lgkmcnt(0)
    s_barrier
    v_mfma_f32_16x16x32_bf16 v[20:23], v[164:167], v[204:207], v[20:23]
    v_mfma_f32_16x16x32_bf16 v[24:27], v[172:175], v[188:191], v[24:27]
    v_mfma_f32_16x16x32_bf16 v[28:31], v[172:175], v[196:199], v[28:31]
    v_mfma_f32_16x16x32_bf16 v[32:35], v[172:175], v[204:207], v[32:35]
    v_mfma_f32_16x16x32_bf16 v[36:39], v[180:183], v[188:191], v[36:39]
    v_mfma_f32_16x16x32_bf16 v[40:43], v[180:183], v[196:199], v[40:43]
    v_mfma_f32_16x16x32_bf16 v[44:47], v[180:183], v[204:207], v[44:47]
    v_mfma_f32_16x16x32_bf16 v[0:3], v[96:99], v[128:131], v[0:3]
    ds_read_b128 v[152:155], v214 offset:28672
    v_mfma_f32_16x16x32_bf16 v[4:7], v[96:99], v[136:139], v[4:7]
    v_mfma_f32_16x16x32_bf16 v[8:11], v[96:99], v[144:147], v[8:11]
    ds_read_b128 v[184:187], v208 offset:28672
    v_mfma_f32_16x16x32_bf16 v[12:15], v[104:107], v[128:131], v[12:15]
    v_mfma_f32_16x16x32_bf16 v[16:19], v[104:107], v[136:139], v[16:19]
    ds_read_b128 v[192:195], v208 offset:30720
    v_mfma_f32_16x16x32_bf16 v[20:23], v[104:107], v[144:147], v[20:23]
    v_mfma_f32_16x16x32_bf16 v[24:27], v[112:115], v[128:131], v[24:27]
    ds_read_b128 v[200:203], v208 offset:32768
    v_mfma_f32_16x16x32_bf16 v[28:31], v[112:115], v[136:139], v[28:31]
    v_mfma_f32_16x16x32_bf16 v[32:35], v[112:115], v[144:147], v[32:35]
    ds_read_b128 v[160:163], v214 offset:30720
    v_mfma_f32_16x16x32_bf16 v[36:39], v[120:123], v[128:131], v[36:39]
    v_mfma_f32_16x16x32_bf16 v[40:43], v[120:123], v[136:139], v[40:43]
    ds_read_b128 v[168:171], v214 offset:32768
    v_mfma_f32_16x16x32_bf16 v[44:47], v[120:123], v[144:147], v[44:47]
    v_mfma_f32_16x16x32_bf16 v[48:51], v[96:99], v[132:135], v[48:51]
    ds_read_b128 v[176:179], v214 offset:34816
    v_mfma_f32_16x16x32_bf16 v[52:55], v[96:99], v[140:143], v[52:55]
    v_mfma_f32_16x16x32_bf16 v[56:59], v[96:99], v[148:151], v[56:59]
    ds_read_b128 v[188:191], v211 offset:28672
    v_mfma_f32_16x16x32_bf16 v[60:63], v[104:107], v[132:135], v[60:63]
    v_mfma_f32_16x16x32_bf16 v[64:67], v[104:107], v[140:143], v[64:67]
    ds_read_b128 v[196:199], v211 offset:30720
    v_mfma_f32_16x16x32_bf16 v[68:71], v[104:107], v[148:151], v[68:71]
    v_mfma_f32_16x16x32_bf16 v[72:75], v[112:115], v[132:135], v[72:75]
    ds_read_b128 v[204:207], v211 offset:32768
    v_mfma_f32_16x16x32_bf16 v[76:79], v[112:115], v[140:143], v[76:79]
    v_mfma_f32_16x16x32_bf16 v[80:83], v[112:115], v[148:151], v[80:83]
    ds_read_b128 v[156:159], v214 offset:29696
    v_mfma_f32_16x16x32_bf16 v[84:87], v[120:123], v[132:135], v[84:87]
    v_mfma_f32_16x16x32_bf16 v[88:91], v[120:123], v[140:143], v[88:91]
    ds_read_b128 v[164:167], v214 offset:31744
    v_mfma_f32_16x16x32_bf16 v[92:95], v[120:123], v[148:151], v[92:95]
    v_mfma_f32_16x16x32_bf16 v[48:51], v[100:103], v[128:131], v[48:51]
    ds_read_b128 v[172:175], v214 offset:33792
    v_xor_b32 v132, s34, v132
    v_xor_b32 v133, s34, v133
    v_mfma_f32_16x16x32_bf16 v[52:55], v[100:103], v[136:139], v[52:55]
    v_xor_b32 v134, s34, v134
    v_xor_b32 v135, s34, v135
    v_mfma_f32_16x16x32_bf16 v[56:59], v[100:103], v[144:147], v[56:59]
    ds_read_b128 v[180:183], v214 offset:35840
    v_xor_b32 v140, s34, v140
    v_xor_b32 v141, s34, v141
    v_mfma_f32_16x16x32_bf16 v[60:63], v[108:111], v[128:131], v[60:63]
    v_xor_b32 v142, s34, v142
    v_xor_b32 v143, s34, v143
    v_mfma_f32_16x16x32_bf16 v[64:67], v[108:111], v[136:139], v[64:67]
    v_xor_b32 v148, s34, v148
    v_xor_b32 v149, s34, v149
    v_mfma_f32_16x16x32_bf16 v[68:71], v[108:111], v[144:147], v[68:71]
    v_xor_b32 v150, s34, v150
    v_xor_b32 v151, s34, v151
    v_mfma_f32_16x16x32_bf16 v[72:75], v[116:119], v[128:131], v[72:75]
    v_mfma_f32_16x16x32_bf16 v[76:79], v[116:119], v[136:139], v[76:79]
    v_mfma_f32_16x16x32_bf16 v[80:83], v[116:119], v[144:147], v[80:83]
    v_mfma_f32_16x16x32_bf16 v[84:87], v[124:127], v[128:131], v[84:87]
    v_mfma_f32_16x16x32_bf16 v[88:91], v[124:127], v[136:139], v[88:91]
    v_mfma_f32_16x16x32_bf16 v[92:95], v[124:127], v[144:147], v[92:95]
    v_mfma_f32_16x16x32_bf16 v[0:3], v[100:103], v[132:135], v[0:3]
    v_mfma_f32_16x16x32_bf16 v[4:7], v[100:103], v[140:143], v[4:7]
    v_mfma_f32_16x16x32_bf16 v[8:11], v[100:103], v[148:151], v[8:11]
    v_mfma_f32_16x16x32_bf16 v[12:15], v[108:111], v[132:135], v[12:15]
    v_mfma_f32_16x16x32_bf16 v[16:19], v[108:111], v[140:143], v[16:19]
    s_waitcnt lgkmcnt(0)
    s_barrier
    v_mfma_f32_16x16x32_bf16 v[20:23], v[108:111], v[148:151], v[20:23]
    v_mfma_f32_16x16x32_bf16 v[24:27], v[116:119], v[132:135], v[24:27]
    v_mfma_f32_16x16x32_bf16 v[28:31], v[116:119], v[140:143], v[28:31]
    v_mfma_f32_16x16x32_bf16 v[32:35], v[116:119], v[148:151], v[32:35]
    v_mfma_f32_16x16x32_bf16 v[36:39], v[124:127], v[132:135], v[36:39]
    v_mfma_f32_16x16x32_bf16 v[40:43], v[124:127], v[140:143], v[40:43]
    v_mfma_f32_16x16x32_bf16 v[44:47], v[124:127], v[148:151], v[44:47]
    v_mfma_f32_16x16x32_bf16 v[0:3], v[152:155], v[184:187], v[0:3]
    ds_read_b128 v[96:99], v215 offset:0
    v_mfma_f32_16x16x32_bf16 v[4:7], v[152:155], v[192:195], v[4:7]
    v_mfma_f32_16x16x32_bf16 v[8:11], v[152:155], v[200:203], v[8:11]
    ds_read_b128 v[128:131], v209 offset:0
    v_mfma_f32_16x16x32_bf16 v[12:15], v[160:163], v[184:187], v[12:15]
    v_mfma_f32_16x16x32_bf16 v[16:19], v[160:163], v[192:195], v[16:19]
    ds_read_b128 v[136:139], v209 offset:2048
    v_mfma_f32_16x16x32_bf16 v[20:23], v[160:163], v[200:203], v[20:23]
    v_mfma_f32_16x16x32_bf16 v[24:27], v[168:171], v[184:187], v[24:27]
    ds_read_b128 v[144:147], v209 offset:4096
    v_mfma_f32_16x16x32_bf16 v[28:31], v[168:171], v[192:195], v[28:31]
    v_mfma_f32_16x16x32_bf16 v[32:35], v[168:171], v[200:203], v[32:35]
    ds_read_b128 v[104:107], v215 offset:2048
    v_mfma_f32_16x16x32_bf16 v[36:39], v[176:179], v[184:187], v[36:39]
    v_mfma_f32_16x16x32_bf16 v[40:43], v[176:179], v[192:195], v[40:43]
    ds_read_b128 v[112:115], v215 offset:4096
    v_mfma_f32_16x16x32_bf16 v[44:47], v[176:179], v[200:203], v[44:47]
    v_mfma_f32_16x16x32_bf16 v[48:51], v[152:155], v[188:191], v[48:51]
    ds_read_b128 v[120:123], v215 offset:6144
    v_mfma_f32_16x16x32_bf16 v[52:55], v[152:155], v[196:199], v[52:55]
    v_mfma_f32_16x16x32_bf16 v[56:59], v[152:155], v[204:207], v[56:59]
    ds_read_b128 v[132:135], v212 offset:0
    v_mfma_f32_16x16x32_bf16 v[60:63], v[160:163], v[188:191], v[60:63]
    v_mfma_f32_16x16x32_bf16 v[64:67], v[160:163], v[196:199], v[64:67]
    ds_read_b128 v[140:143], v212 offset:2048
    v_mfma_f32_16x16x32_bf16 v[68:71], v[160:163], v[204:207], v[68:71]
    v_mfma_f32_16x16x32_bf16 v[72:75], v[168:171], v[188:191], v[72:75]
    ds_read_b128 v[148:151], v212 offset:4096
    v_mfma_f32_16x16x32_bf16 v[76:79], v[168:171], v[196:199], v[76:79]
    v_mfma_f32_16x16x32_bf16 v[80:83], v[168:171], v[204:207], v[80:83]
    ds_read_b128 v[100:103], v215 offset:1024
    v_mfma_f32_16x16x32_bf16 v[84:87], v[176:179], v[188:191], v[84:87]
    v_mfma_f32_16x16x32_bf16 v[88:91], v[176:179], v[196:199], v[88:91]
    ds_read_b128 v[108:111], v215 offset:3072
    v_mfma_f32_16x16x32_bf16 v[92:95], v[176:179], v[204:207], v[92:95]
    v_mfma_f32_16x16x32_bf16 v[48:51], v[156:159], v[184:187], v[48:51]
    ds_read_b128 v[116:119], v215 offset:5120
    v_xor_b32 v188, s34, v188
    v_xor_b32 v189, s34, v189
    v_mfma_f32_16x16x32_bf16 v[52:55], v[156:159], v[192:195], v[52:55]
    v_xor_b32 v190, s34, v190
    v_xor_b32 v191, s34, v191
    v_mfma_f32_16x16x32_bf16 v[56:59], v[156:159], v[200:203], v[56:59]
    ds_read_b128 v[124:127], v215 offset:7168
    v_xor_b32 v196, s34, v196
    v_xor_b32 v197, s34, v197
    v_mfma_f32_16x16x32_bf16 v[60:63], v[164:167], v[184:187], v[60:63]
    v_xor_b32 v198, s34, v198
    v_xor_b32 v199, s34, v199
    v_mfma_f32_16x16x32_bf16 v[64:67], v[164:167], v[192:195], v[64:67]
    v_xor_b32 v204, s34, v204
    v_xor_b32 v205, s34, v205
    v_mfma_f32_16x16x32_bf16 v[68:71], v[164:167], v[200:203], v[68:71]
    v_xor_b32 v206, s34, v206
    v_xor_b32 v207, s34, v207
    v_mfma_f32_16x16x32_bf16 v[72:75], v[172:175], v[184:187], v[72:75]
    v_mfma_f32_16x16x32_bf16 v[76:79], v[172:175], v[192:195], v[76:79]
    v_mfma_f32_16x16x32_bf16 v[80:83], v[172:175], v[200:203], v[80:83]
    v_mfma_f32_16x16x32_bf16 v[84:87], v[180:183], v[184:187], v[84:87]
    v_mfma_f32_16x16x32_bf16 v[88:91], v[180:183], v[192:195], v[88:91]
    v_mfma_f32_16x16x32_bf16 v[92:95], v[180:183], v[200:203], v[92:95]
    v_mfma_f32_16x16x32_bf16 v[0:3], v[156:159], v[188:191], v[0:3]
    v_mfma_f32_16x16x32_bf16 v[4:7], v[156:159], v[196:199], v[4:7]
    v_mfma_f32_16x16x32_bf16 v[8:11], v[156:159], v[204:207], v[8:11]
    v_mfma_f32_16x16x32_bf16 v[12:15], v[164:167], v[188:191], v[12:15]
    v_mfma_f32_16x16x32_bf16 v[16:19], v[164:167], v[196:199], v[16:19]
    s_waitcnt lgkmcnt(0)
    s_barrier
    v_mfma_f32_16x16x32_bf16 v[20:23], v[164:167], v[204:207], v[20:23]
    v_mfma_f32_16x16x32_bf16 v[24:27], v[172:175], v[188:191], v[24:27]
    v_mfma_f32_16x16x32_bf16 v[28:31], v[172:175], v[196:199], v[28:31]
    v_mfma_f32_16x16x32_bf16 v[32:35], v[172:175], v[204:207], v[32:35]
    v_mfma_f32_16x16x32_bf16 v[36:39], v[180:183], v[188:191], v[36:39]
    v_mfma_f32_16x16x32_bf16 v[40:43], v[180:183], v[196:199], v[40:43]
    v_mfma_f32_16x16x32_bf16 v[44:47], v[180:183], v[204:207], v[44:47]
    v_mfma_f32_16x16x32_bf16 v[0:3], v[96:99], v[128:131], v[0:3]
    ds_read_b128 v[152:155], v215 offset:28672
    v_mfma_f32_16x16x32_bf16 v[4:7], v[96:99], v[136:139], v[4:7]
    v_mfma_f32_16x16x32_bf16 v[8:11], v[96:99], v[144:147], v[8:11]
    ds_read_b128 v[184:187], v209 offset:28672
    v_mfma_f32_16x16x32_bf16 v[12:15], v[104:107], v[128:131], v[12:15]
    v_mfma_f32_16x16x32_bf16 v[16:19], v[104:107], v[136:139], v[16:19]
    ds_read_b128 v[192:195], v209 offset:30720
    v_mfma_f32_16x16x32_bf16 v[20:23], v[104:107], v[144:147], v[20:23]
    v_mfma_f32_16x16x32_bf16 v[24:27], v[112:115], v[128:131], v[24:27]
    ds_read_b128 v[200:203], v209 offset:32768
    v_mfma_f32_16x16x32_bf16 v[28:31], v[112:115], v[136:139], v[28:31]
    v_mfma_f32_16x16x32_bf16 v[32:35], v[112:115], v[144:147], v[32:35]
    ds_read_b128 v[160:163], v215 offset:30720
    v_mfma_f32_16x16x32_bf16 v[36:39], v[120:123], v[128:131], v[36:39]
    v_mfma_f32_16x16x32_bf16 v[40:43], v[120:123], v[136:139], v[40:43]
    ds_read_b128 v[168:171], v215 offset:32768
    v_mfma_f32_16x16x32_bf16 v[44:47], v[120:123], v[144:147], v[44:47]
    v_mfma_f32_16x16x32_bf16 v[48:51], v[96:99], v[132:135], v[48:51]
    ds_read_b128 v[176:179], v215 offset:34816
    v_mfma_f32_16x16x32_bf16 v[52:55], v[96:99], v[140:143], v[52:55]
    v_mfma_f32_16x16x32_bf16 v[56:59], v[96:99], v[148:151], v[56:59]
    ds_read_b128 v[188:191], v212 offset:28672
    v_mfma_f32_16x16x32_bf16 v[60:63], v[104:107], v[132:135], v[60:63]
    v_mfma_f32_16x16x32_bf16 v[64:67], v[104:107], v[140:143], v[64:67]
    ds_read_b128 v[196:199], v212 offset:30720
    v_mfma_f32_16x16x32_bf16 v[68:71], v[104:107], v[148:151], v[68:71]
    v_mfma_f32_16x16x32_bf16 v[72:75], v[112:115], v[132:135], v[72:75]
    ds_read_b128 v[204:207], v212 offset:32768
    v_mfma_f32_16x16x32_bf16 v[76:79], v[112:115], v[140:143], v[76:79]
    v_mfma_f32_16x16x32_bf16 v[80:83], v[112:115], v[148:151], v[80:83]
    ds_read_b128 v[156:159], v215 offset:29696
    v_mfma_f32_16x16x32_bf16 v[84:87], v[120:123], v[132:135], v[84:87]
    v_mfma_f32_16x16x32_bf16 v[88:91], v[120:123], v[140:143], v[88:91]
    ds_read_b128 v[164:167], v215 offset:31744
    v_mfma_f32_16x16x32_bf16 v[92:95], v[120:123], v[148:151], v[92:95]
    v_mfma_f32_16x16x32_bf16 v[48:51], v[100:103], v[128:131], v[48:51]
    ds_read_b128 v[172:175], v215 offset:33792
    v_xor_b32 v132, s34, v132
    v_xor_b32 v133, s34, v133
    v_mfma_f32_16x16x32_bf16 v[52:55], v[100:103], v[136:139], v[52:55]
    v_xor_b32 v134, s34, v134
    v_xor_b32 v135, s34, v135
    v_mfma_f32_16x16x32_bf16 v[56:59], v[100:103], v[144:147], v[56:59]
    ds_read_b128 v[180:183], v215 offset:35840
    v_xor_b32 v140, s34, v140
    v_xor_b32 v141, s34, v141
    v_mfma_f32_16x16x32_bf16 v[60:63], v[108:111], v[128:131], v[60:63]
    v_xor_b32 v142, s34, v142
    v_xor_b32 v143, s34, v143
    v_mfma_f32_16x16x32_bf16 v[64:67], v[108:111], v[136:139], v[64:67]
    v_xor_b32 v148, s34, v148
    v_xor_b32 v149, s34, v149
    v_mfma_f32_16x16x32_bf16 v[68:71], v[108:111], v[144:147], v[68:71]
    v_xor_b32 v150, s34, v150
    v_xor_b32 v151, s34, v151
    v_mfma_f32_16x16x32_bf16 v[72:75], v[116:119], v[128:131], v[72:75]
    v_mfma_f32_16x16x32_bf16 v[76:79], v[116:119], v[136:139], v[76:79]
    v_mfma_f32_16x16x32_bf16 v[80:83], v[116:119], v[144:147], v[80:83]
    v_mfma_f32_16x16x32_bf16 v[84:87], v[124:127], v[128:131], v[84:87]
    v_mfma_f32_16x16x32_bf16 v[88:91], v[124:127], v[136:139], v[88:91]
    v_mfma_f32_16x16x32_bf16 v[92:95], v[124:127], v[144:147], v[92:95]
    v_mfma_f32_16x16x32_bf16 v[0:3], v[100:103], v[132:135], v[0:3]
    v_mfma_f32_16x16x32_bf16 v[4:7], v[100:103], v[140:143], v[4:7]
    v_mfma_f32_16x16x32_bf16 v[8:11], v[100:103], v[148:151], v[8:11]
    v_mfma_f32_16x16x32_bf16 v[12:15], v[108:111], v[132:135], v[12:15]
    v_mfma_f32_16x16x32_bf16 v[16:19], v[108:111], v[140:143], v[16:19]
    s_waitcnt lgkmcnt(0)
    s_barrier
    v_mfma_f32_16x16x32_bf16 v[20:23], v[108:111], v[148:151], v[20:23]
    v_mfma_f32_16x16x32_bf16 v[24:27], v[116:119], v[132:135], v[24:27]
    v_mfma_f32_16x16x32_bf16 v[28:31], v[116:119], v[140:143], v[28:31]
    v_mfma_f32_16x16x32_bf16 v[32:35], v[116:119], v[148:151], v[32:35]
    v_mfma_f32_16x16x32_bf16 v[36:39], v[124:127], v[132:135], v[36:39]
    v_mfma_f32_16x16x32_bf16 v[40:43], v[124:127], v[140:143], v[40:43]
    v_mfma_f32_16x16x32_bf16 v[44:47], v[124:127], v[148:151], v[44:47]
    v_mfma_f32_16x16x32_bf16 v[0:3], v[152:155], v[184:187], v[0:3]
    ds_read_b128 v[96:99], v216 offset:0
    v_mfma_f32_16x16x32_bf16 v[4:7], v[152:155], v[192:195], v[4:7]
    v_mfma_f32_16x16x32_bf16 v[8:11], v[152:155], v[200:203], v[8:11]
    ds_read_b128 v[128:131], v210 offset:0
    v_mfma_f32_16x16x32_bf16 v[12:15], v[160:163], v[184:187], v[12:15]
    v_mfma_f32_16x16x32_bf16 v[16:19], v[160:163], v[192:195], v[16:19]
    ds_read_b128 v[136:139], v210 offset:2048
    v_mfma_f32_16x16x32_bf16 v[20:23], v[160:163], v[200:203], v[20:23]
    v_mfma_f32_16x16x32_bf16 v[24:27], v[168:171], v[184:187], v[24:27]
    ds_read_b128 v[144:147], v210 offset:4096
    v_mfma_f32_16x16x32_bf16 v[28:31], v[168:171], v[192:195], v[28:31]
    v_mfma_f32_16x16x32_bf16 v[32:35], v[168:171], v[200:203], v[32:35]
    ds_read_b128 v[104:107], v216 offset:2048
    v_mfma_f32_16x16x32_bf16 v[36:39], v[176:179], v[184:187], v[36:39]
    v_mfma_f32_16x16x32_bf16 v[40:43], v[176:179], v[192:195], v[40:43]
    ds_read_b128 v[112:115], v216 offset:4096
    v_mfma_f32_16x16x32_bf16 v[44:47], v[176:179], v[200:203], v[44:47]
    v_mfma_f32_16x16x32_bf16 v[48:51], v[152:155], v[188:191], v[48:51]
    ds_read_b128 v[120:123], v216 offset:6144
    v_mfma_f32_16x16x32_bf16 v[52:55], v[152:155], v[196:199], v[52:55]
    v_mfma_f32_16x16x32_bf16 v[56:59], v[152:155], v[204:207], v[56:59]
    ds_read_b128 v[132:135], v213 offset:0
    v_mfma_f32_16x16x32_bf16 v[60:63], v[160:163], v[188:191], v[60:63]
    v_mfma_f32_16x16x32_bf16 v[64:67], v[160:163], v[196:199], v[64:67]
    ds_read_b128 v[140:143], v213 offset:2048
    v_mfma_f32_16x16x32_bf16 v[68:71], v[160:163], v[204:207], v[68:71]
    v_mfma_f32_16x16x32_bf16 v[72:75], v[168:171], v[188:191], v[72:75]
    ds_read_b128 v[148:151], v213 offset:4096
    v_mfma_f32_16x16x32_bf16 v[76:79], v[168:171], v[196:199], v[76:79]
    v_mfma_f32_16x16x32_bf16 v[80:83], v[168:171], v[204:207], v[80:83]
    ds_read_b128 v[100:103], v216 offset:1024
    v_mfma_f32_16x16x32_bf16 v[84:87], v[176:179], v[188:191], v[84:87]
    v_mfma_f32_16x16x32_bf16 v[88:91], v[176:179], v[196:199], v[88:91]
    ds_read_b128 v[108:111], v216 offset:3072
    v_mfma_f32_16x16x32_bf16 v[92:95], v[176:179], v[204:207], v[92:95]
    v_mfma_f32_16x16x32_bf16 v[48:51], v[156:159], v[184:187], v[48:51]
    ds_read_b128 v[116:119], v216 offset:5120
    v_xor_b32 v188, s34, v188
    v_xor_b32 v189, s34, v189
    v_mfma_f32_16x16x32_bf16 v[52:55], v[156:159], v[192:195], v[52:55]
    v_xor_b32 v190, s34, v190
    v_xor_b32 v191, s34, v191
    v_mfma_f32_16x16x32_bf16 v[56:59], v[156:159], v[200:203], v[56:59]
    ds_read_b128 v[124:127], v216 offset:7168
    v_xor_b32 v196, s34, v196
    v_xor_b32 v197, s34, v197
    v_mfma_f32_16x16x32_bf16 v[60:63], v[164:167], v[184:187], v[60:63]
    v_xor_b32 v198, s34, v198
    v_xor_b32 v199, s34, v199
    v_mfma_f32_16x16x32_bf16 v[64:67], v[164:167], v[192:195], v[64:67]
    v_xor_b32 v204, s34, v204
    v_xor_b32 v205, s34, v205
    v_mfma_f32_16x16x32_bf16 v[68:71], v[164:167], v[200:203], v[68:71]
    v_xor_b32 v206, s34, v206
    v_xor_b32 v207, s34, v207
    v_mfma_f32_16x16x32_bf16 v[72:75], v[172:175], v[184:187], v[72:75]
    v_mfma_f32_16x16x32_bf16 v[76:79], v[172:175], v[192:195], v[76:79]
    v_mfma_f32_16x16x32_bf16 v[80:83], v[172:175], v[200:203], v[80:83]
    v_mfma_f32_16x16x32_bf16 v[84:87], v[180:183], v[184:187], v[84:87]
    v_mfma_f32_16x16x32_bf16 v[88:91], v[180:183], v[192:195], v[88:91]
    v_mfma_f32_16x16x32_bf16 v[92:95], v[180:183], v[200:203], v[92:95]
    v_mfma_f32_16x16x32_bf16 v[0:3], v[156:159], v[188:191], v[0:3]
    v_mfma_f32_16x16x32_bf16 v[4:7], v[156:159], v[196:199], v[4:7]
    v_mfma_f32_16x16x32_bf16 v[8:11], v[156:159], v[204:207], v[8:11]
    v_mfma_f32_16x16x32_bf16 v[12:15], v[164:167], v[188:191], v[12:15]
    v_mfma_f32_16x16x32_bf16 v[16:19], v[164:167], v[196:199], v[16:19]
    s_waitcnt lgkmcnt(0)
    s_barrier
    v_mfma_f32_16x16x32_bf16 v[20:23], v[164:167], v[204:207], v[20:23]
    v_mfma_f32_16x16x32_bf16 v[24:27], v[172:175], v[188:191], v[24:27]
    v_mfma_f32_16x16x32_bf16 v[28:31], v[172:175], v[196:199], v[28:31]
    v_mfma_f32_16x16x32_bf16 v[32:35], v[172:175], v[204:207], v[32:35]
    v_mfma_f32_16x16x32_bf16 v[36:39], v[180:183], v[188:191], v[36:39]
    v_mfma_f32_16x16x32_bf16 v[40:43], v[180:183], v[196:199], v[40:43]
    v_mfma_f32_16x16x32_bf16 v[44:47], v[180:183], v[204:207], v[44:47]
    v_mfma_f32_16x16x32_bf16 v[0:3], v[96:99], v[128:131], v[0:3]
    ds_read_b128 v[152:155], v214 offset:0
    v_mfma_f32_16x16x32_bf16 v[4:7], v[96:99], v[136:139], v[4:7]
    v_mfma_f32_16x16x32_bf16 v[8:11], v[96:99], v[144:147], v[8:11]
    ds_read_b128 v[184:187], v208 offset:0
    v_mfma_f32_16x16x32_bf16 v[12:15], v[104:107], v[128:131], v[12:15]
    v_mfma_f32_16x16x32_bf16 v[16:19], v[104:107], v[136:139], v[16:19]
    ds_read_b128 v[192:195], v208 offset:2048
    v_mfma_f32_16x16x32_bf16 v[20:23], v[104:107], v[144:147], v[20:23]
    v_mfma_f32_16x16x32_bf16 v[24:27], v[112:115], v[128:131], v[24:27]
    ds_read_b128 v[200:203], v208 offset:4096
    v_mfma_f32_16x16x32_bf16 v[28:31], v[112:115], v[136:139], v[28:31]
    v_mfma_f32_16x16x32_bf16 v[32:35], v[112:115], v[144:147], v[32:35]
    ds_read_b128 v[160:163], v214 offset:2048
    v_mfma_f32_16x16x32_bf16 v[36:39], v[120:123], v[128:131], v[36:39]
    v_mfma_f32_16x16x32_bf16 v[40:43], v[120:123], v[136:139], v[40:43]
    ds_read_b128 v[168:171], v214 offset:4096
    v_mfma_f32_16x16x32_bf16 v[44:47], v[120:123], v[144:147], v[44:47]
    v_mfma_f32_16x16x32_bf16 v[48:51], v[96:99], v[132:135], v[48:51]
    ds_read_b128 v[176:179], v214 offset:6144
    v_mfma_f32_16x16x32_bf16 v[52:55], v[96:99], v[140:143], v[52:55]
    v_mfma_f32_16x16x32_bf16 v[56:59], v[96:99], v[148:151], v[56:59]
    ds_read_b128 v[188:191], v211 offset:0
    v_mfma_f32_16x16x32_bf16 v[60:63], v[104:107], v[132:135], v[60:63]
    v_mfma_f32_16x16x32_bf16 v[64:67], v[104:107], v[140:143], v[64:67]
    ds_read_b128 v[196:199], v211 offset:2048
    v_mfma_f32_16x16x32_bf16 v[68:71], v[104:107], v[148:151], v[68:71]
    v_mfma_f32_16x16x32_bf16 v[72:75], v[112:115], v[132:135], v[72:75]
    ds_read_b128 v[204:207], v211 offset:4096
    v_mfma_f32_16x16x32_bf16 v[76:79], v[112:115], v[140:143], v[76:79]
    v_mfma_f32_16x16x32_bf16 v[80:83], v[112:115], v[148:151], v[80:83]
    ds_read_b128 v[156:159], v214 offset:1024
    v_mfma_f32_16x16x32_bf16 v[84:87], v[120:123], v[132:135], v[84:87]
    v_mfma_f32_16x16x32_bf16 v[88:91], v[120:123], v[140:143], v[88:91]
    ds_read_b128 v[164:167], v214 offset:3072
    v_mfma_f32_16x16x32_bf16 v[92:95], v[120:123], v[148:151], v[92:95]
    v_mfma_f32_16x16x32_bf16 v[48:51], v[100:103], v[128:131], v[48:51]
    ds_read_b128 v[172:175], v214 offset:5120
    v_xor_b32 v132, s34, v132
    v_xor_b32 v133, s34, v133
    v_mfma_f32_16x16x32_bf16 v[52:55], v[100:103], v[136:139], v[52:55]
    v_xor_b32 v134, s34, v134
    v_xor_b32 v135, s34, v135
    v_mfma_f32_16x16x32_bf16 v[56:59], v[100:103], v[144:147], v[56:59]
    ds_read_b128 v[180:183], v214 offset:7168
    v_xor_b32 v140, s34, v140
    v_xor_b32 v141, s34, v141
    v_mfma_f32_16x16x32_bf16 v[60:63], v[108:111], v[128:131], v[60:63]
    v_xor_b32 v142, s34, v142
    v_xor_b32 v143, s34, v143
    v_mfma_f32_16x16x32_bf16 v[64:67], v[108:111], v[136:139], v[64:67]
    v_xor_b32 v148, s34, v148
    v_xor_b32 v149, s34, v149
    v_mfma_f32_16x16x32_bf16 v[68:71], v[108:111], v[144:147], v[68:71]
    v_xor_b32 v150, s34, v150
    v_xor_b32 v151, s34, v151
    v_mfma_f32_16x16x32_bf16 v[72:75], v[116:119], v[128:131], v[72:75]
    v_mfma_f32_16x16x32_bf16 v[76:79], v[116:119], v[136:139], v[76:79]
    v_mfma_f32_16x16x32_bf16 v[80:83], v[116:119], v[144:147], v[80:83]
    v_mfma_f32_16x16x32_bf16 v[84:87], v[124:127], v[128:131], v[84:87]
    v_mfma_f32_16x16x32_bf16 v[88:91], v[124:127], v[136:139], v[88:91]
    v_mfma_f32_16x16x32_bf16 v[92:95], v[124:127], v[144:147], v[92:95]
    v_mfma_f32_16x16x32_bf16 v[0:3], v[100:103], v[132:135], v[0:3]
    v_mfma_f32_16x16x32_bf16 v[4:7], v[100:103], v[140:143], v[4:7]
    v_mfma_f32_16x16x32_bf16 v[8:11], v[100:103], v[148:151], v[8:11]
    v_mfma_f32_16x16x32_bf16 v[12:15], v[108:111], v[132:135], v[12:15]
    v_mfma_f32_16x16x32_bf16 v[16:19], v[108:111], v[140:143], v[16:19]
    s_waitcnt lgkmcnt(0)
    v_mfma_f32_16x16x32_bf16 v[20:23], v[108:111], v[148:151], v[20:23]
    v_mfma_f32_16x16x32_bf16 v[24:27], v[116:119], v[132:135], v[24:27]
    v_mfma_f32_16x16x32_bf16 v[28:31], v[116:119], v[140:143], v[28:31]
    v_mfma_f32_16x16x32_bf16 v[32:35], v[116:119], v[148:151], v[32:35]
    v_mfma_f32_16x16x32_bf16 v[36:39], v[124:127], v[132:135], v[36:39]
    v_mfma_f32_16x16x32_bf16 v[40:43], v[124:127], v[140:143], v[40:43]
    v_mfma_f32_16x16x32_bf16 v[44:47], v[124:127], v[148:151], v[44:47]
    v_mfma_f32_16x16x32_bf16 v[0:3], v[152:155], v[184:187], v[0:3]
    v_mfma_f32_16x16x32_bf16 v[4:7], v[152:155], v[192:195], v[4:7]
    v_mfma_f32_16x16x32_bf16 v[8:11], v[152:155], v[200:203], v[8:11]
    v_mfma_f32_16x16x32_bf16 v[12:15], v[160:163], v[184:187], v[12:15]
    v_mfma_f32_16x16x32_bf16 v[16:19], v[160:163], v[192:195], v[16:19]
    v_mfma_f32_16x16x32_bf16 v[20:23], v[160:163], v[200:203], v[20:23]
    v_mfma_f32_16x16x32_bf16 v[24:27], v[168:171], v[184:187], v[24:27]
    v_mfma_f32_16x16x32_bf16 v[28:31], v[168:171], v[192:195], v[28:31]
    v_mfma_f32_16x16x32_bf16 v[32:35], v[168:171], v[200:203], v[32:35]
    v_mfma_f32_16x16x32_bf16 v[36:39], v[176:179], v[184:187], v[36:39]
    v_mfma_f32_16x16x32_bf16 v[40:43], v[176:179], v[192:195], v[40:43]
    v_mfma_f32_16x16x32_bf16 v[44:47], v[176:179], v[200:203], v[44:47]
    v_mfma_f32_16x16x32_bf16 v[48:51], v[152:155], v[188:191], v[48:51]
    v_mfma_f32_16x16x32_bf16 v[52:55], v[152:155], v[196:199], v[52:55]
    v_mfma_f32_16x16x32_bf16 v[56:59], v[152:155], v[204:207], v[56:59]
    v_mfma_f32_16x16x32_bf16 v[60:63], v[160:163], v[188:191], v[60:63]
    v_mfma_f32_16x16x32_bf16 v[64:67], v[160:163], v[196:199], v[64:67]
    v_mfma_f32_16x16x32_bf16 v[68:71], v[160:163], v[204:207], v[68:71]
    v_mfma_f32_16x16x32_bf16 v[72:75], v[168:171], v[188:191], v[72:75]
    v_mfma_f32_16x16x32_bf16 v[76:79], v[168:171], v[196:199], v[76:79]
    v_mfma_f32_16x16x32_bf16 v[80:83], v[168:171], v[204:207], v[80:83]
    v_mfma_f32_16x16x32_bf16 v[84:87], v[176:179], v[188:191], v[84:87]
    v_mfma_f32_16x16x32_bf16 v[88:91], v[176:179], v[196:199], v[88:91]
    v_mfma_f32_16x16x32_bf16 v[92:95], v[176:179], v[204:207], v[92:95]
    v_mfma_f32_16x16x32_bf16 v[48:51], v[156:159], v[184:187], v[48:51]
    v_xor_b32 v188, s34, v188
    v_xor_b32 v189, s34, v189
    v_mfma_f32_16x16x32_bf16 v[52:55], v[156:159], v[192:195], v[52:55]
    v_xor_b32 v190, s34, v190
    v_xor_b32 v191, s34, v191
    v_mfma_f32_16x16x32_bf16 v[56:59], v[156:159], v[200:203], v[56:59]
    v_xor_b32 v196, s34, v196
    v_xor_b32 v197, s34, v197
    v_mfma_f32_16x16x32_bf16 v[60:63], v[164:167], v[184:187], v[60:63]
    v_xor_b32 v198, s34, v198
    v_xor_b32 v199, s34, v199
    v_mfma_f32_16x16x32_bf16 v[64:67], v[164:167], v[192:195], v[64:67]
    v_xor_b32 v204, s34, v204
    v_xor_b32 v205, s34, v205
    v_mfma_f32_16x16x32_bf16 v[68:71], v[164:167], v[200:203], v[68:71]
    v_xor_b32 v206, s34, v206
    v_xor_b32 v207, s34, v207
    v_mfma_f32_16x16x32_bf16 v[72:75], v[172:175], v[184:187], v[72:75]
    v_mfma_f32_16x16x32_bf16 v[76:79], v[172:175], v[192:195], v[76:79]
    v_mfma_f32_16x16x32_bf16 v[80:83], v[172:175], v[200:203], v[80:83]
    v_mfma_f32_16x16x32_bf16 v[84:87], v[180:183], v[184:187], v[84:87]
    v_mfma_f32_16x16x32_bf16 v[88:91], v[180:183], v[192:195], v[88:91]
    v_mfma_f32_16x16x32_bf16 v[92:95], v[180:183], v[200:203], v[92:95]
    v_mfma_f32_16x16x32_bf16 v[0:3], v[156:159], v[188:191], v[0:3]
    v_mfma_f32_16x16x32_bf16 v[4:7], v[156:159], v[196:199], v[4:7]
    v_mfma_f32_16x16x32_bf16 v[8:11], v[156:159], v[204:207], v[8:11]
    v_mfma_f32_16x16x32_bf16 v[12:15], v[164:167], v[188:191], v[12:15]
    v_mfma_f32_16x16x32_bf16 v[16:19], v[164:167], v[196:199], v[16:19]
    v_mfma_f32_16x16x32_bf16 v[20:23], v[164:167], v[204:207], v[20:23]
    v_mfma_f32_16x16x32_bf16 v[24:27], v[172:175], v[188:191], v[24:27]
    v_mfma_f32_16x16x32_bf16 v[28:31], v[172:175], v[196:199], v[28:31]
    v_mfma_f32_16x16x32_bf16 v[32:35], v[172:175], v[204:207], v[32:35]
    v_mfma_f32_16x16x32_bf16 v[36:39], v[180:183], v[188:191], v[36:39]
    v_mfma_f32_16x16x32_bf16 v[40:43], v[180:183], v[196:199], v[40:43]
    v_mfma_f32_16x16x32_bf16 v[44:47], v[180:183], v[204:207], v[44:47]
    s_nop 7
    s_nop 7
    v_cvt_pk_bf16_f32 v96, v48, v49
    v_cvt_pk_bf16_f32 v97, v50, v51
    v_cvt_pk_bf16_f32 v98, v60, v61
    v_cvt_pk_bf16_f32 v99, v62, v63
    s_add_u32 s35, s33, 0
    buffer_store_dwordx4 v[96:99], v221, s[16:19], s35 offen offset:64 sc1
    v_cvt_pk_bf16_f32 v100, v52, v53
    v_cvt_pk_bf16_f32 v101, v54, v55
    v_cvt_pk_bf16_f32 v102, v64, v65
    v_cvt_pk_bf16_f32 v103, v66, v67
    s_add_u32 s35, s33, 524288
    buffer_store_dwordx4 v[100:103], v221, s[16:19], s35 offen offset:64 sc1
    v_cvt_pk_bf16_f32 v104, v56, v57
    v_cvt_pk_bf16_f32 v105, v58, v59
    v_cvt_pk_bf16_f32 v106, v68, v69
    v_cvt_pk_bf16_f32 v107, v70, v71
    s_add_u32 s35, s33, 1048576
    buffer_store_dwordx4 v[104:107], v221, s[16:19], s35 offen offset:64 sc1
    v_cvt_pk_bf16_f32 v108, v72, v73
    v_cvt_pk_bf16_f32 v109, v74, v75
    v_cvt_pk_bf16_f32 v110, v84, v85
    v_cvt_pk_bf16_f32 v111, v86, v87
    s_add_u32 s35, s33, 4096
    buffer_store_dwordx4 v[108:111], v221, s[16:19], s35 offen offset:64 sc1
    v_cvt_pk_bf16_f32 v112, v76, v77
    v_cvt_pk_bf16_f32 v113, v78, v79
    v_cvt_pk_bf16_f32 v114, v88, v89
    v_cvt_pk_bf16_f32 v115, v90, v91
    s_add_u32 s35, s33, 528384
    buffer_store_dwordx4 v[112:115], v221, s[16:19], s35 offen offset:64 sc1
    v_cvt_pk_bf16_f32 v116, v80, v81
    v_cvt_pk_bf16_f32 v117, v82, v83
    v_cvt_pk_bf16_f32 v118, v92, v93
    v_cvt_pk_bf16_f32 v119, v94, v95
    s_add_u32 s35, s33, 1052672
    buffer_store_dwordx4 v[116:119], v221, s[16:19], s35 offen offset:64 sc1
    v_cvt_pk_bf16_f32 v120, v0, v1
    v_cvt_pk_bf16_f32 v121, v2, v3
    v_cvt_pk_bf16_f32 v122, v12, v13
    v_cvt_pk_bf16_f32 v123, v14, v15
    s_add_u32 s35, s33, 0
    buffer_store_dwordx4 v[120:123], v221, s[16:19], s35 offen offset:0 sc1
    v_cvt_pk_bf16_f32 v124, v4, v5
    v_cvt_pk_bf16_f32 v125, v6, v7
    v_cvt_pk_bf16_f32 v126, v16, v17
    v_cvt_pk_bf16_f32 v127, v18, v19
    s_add_u32 s35, s33, 524288
    buffer_store_dwordx4 v[124:127], v221, s[16:19], s35 offen offset:0 sc1
    v_cvt_pk_bf16_f32 v96, v8, v9
    v_cvt_pk_bf16_f32 v97, v10, v11
    v_cvt_pk_bf16_f32 v98, v20, v21
    v_cvt_pk_bf16_f32 v99, v22, v23
    s_add_u32 s35, s33, 1048576
    buffer_store_dwordx4 v[96:99], v221, s[16:19], s35 offen offset:0 sc1
    v_cvt_pk_bf16_f32 v100, v24, v25
    v_cvt_pk_bf16_f32 v101, v26, v27
    v_cvt_pk_bf16_f32 v102, v36, v37
    v_cvt_pk_bf16_f32 v103, v38, v39
    s_add_u32 s35, s33, 4096
    buffer_store_dwordx4 v[100:103], v221, s[16:19], s35 offen offset:0 sc1
    v_cvt_pk_bf16_f32 v104, v28, v29
    v_cvt_pk_bf16_f32 v105, v30, v31
    v_cvt_pk_bf16_f32 v106, v40, v41
    v_cvt_pk_bf16_f32 v107, v42, v43
    s_add_u32 s35, s33, 528384
    buffer_store_dwordx4 v[104:107], v221, s[16:19], s35 offen offset:0 sc1
    v_cvt_pk_bf16_f32 v108, v32, v33
    v_cvt_pk_bf16_f32 v109, v34, v35
    v_cvt_pk_bf16_f32 v110, v44, v45
    v_cvt_pk_bf16_f32 v111, v46, v47
    s_add_u32 s35, s33, 1052672
    buffer_store_dwordx4 v[108:111], v221, s[16:19], s35 offen offset:0 sc1
    s_endpgm
L_gemm1_kernel_loader:
    s_sub_u32 s20, s20, 4
    v_and_b32 v3, 63, v0
    v_lshrrev_b32 v4, 3, v3
    v_and_b32 v5, 7, v3
    v_xor_b32 v5, v5, v4
    v_lshlrev_b32 v5, 4, v5
    v_lshl_add_u32 v1, v4, 11, v5
    v_lshlrev_b32 v2, 4, v3
    s_add_u32 s24, s20, 0
    s_lshl_b32 s40, s24, 10
    s_lshl_b32 s43, s24, 14
    s_add_u32 s24, s20, 4
    s_lshl_b32 s41, s24, 10
    s_lshl_b32 s44, s24, 14
    s_add_u32 s24, s20, 8
    s_lshl_b32 s42, s24, 10
    s_lshl_b32 s45, s24, 14
    s_mul_i32 s46, s20, 4096
    s_add_u32 s47, s46, 12288
    s_add_u32 m0, s40, 0
    s_add_u32 s24, s43, 0
    buffer_load_dwordx4 v1, s[8:11], s24 offen lds
    s_add_u32 m0, s41, 0
    s_add_u32 s24, s44, 0
    buffer_load_dwordx4 v1, s[8:11], s24 offen lds
    s_add_u32 m0, s42, 0
    s_add_u32 s24, s45, 0
    buffer_load_dwordx4 v1, s[8:11], s24 offen lds
    s_add_u32 m0, s47, 0
    s_add_u32 s24, s46, 0
    buffer_load_dwordx4 v2, s[12:15], s24 offen offset:0 lds
    buffer_load_dwordx4 v2, s[12:15], s24 offen offset:1024 lds
    buffer_load_dwordx4 v2, s[12:15], s24 offen offset:2048 lds
    buffer_load_dwordx4 v2, s[12:15], s24 offen offset:3072 lds
    s_add_u32 m0, s40, 28672
    s_add_u32 s24, s43, 128
    buffer_load_dwordx4 v1, s[8:11], s24 offen lds
    s_add_u32 m0, s41, 28672
    s_add_u32 s24, s44, 128
    buffer_load_dwordx4 v1, s[8:11], s24 offen lds
    s_add_u32 m0, s42, 28672
    s_add_u32 s24, s45, 128
    buffer_load_dwordx4 v1, s[8:11], s24 offen lds
    s_add_u32 m0, s47, 28672
    s_add_u32 s24, s46, 32768
    buffer_load_dwordx4 v2, s[12:15], s24 offen offset:0 lds
    buffer_load_dwordx4 v2, s[12:15], s24 offen offset:1024 lds
    buffer_load_dwordx4 v2, s[12:15], s24 offen offset:2048 lds
    buffer_load_dwordx4 v2, s[12:15], s24 offen offset:3072 lds
    s_add_u32 m0, s40, 57344
    s_add_u32 s24, s43, 256
    buffer_load_dwordx4 v1, s[8:11], s24 offen lds
    s_add_u32 m0, s41, 57344
    s_add_u32 s24, s44, 256
    buffer_load_dwordx4 v1, s[8:11], s24 offen lds
    s_add_u32 m0, s42, 57344
    s_add_u32 s24, s45, 256
    buffer_load_dwordx4 v1, s[8:11], s24 offen lds
    s_add_u32 m0, s47, 57344
    s_add_u32 s24, s46, 65536
    buffer_load_dwordx4 v2, s[12:15], s24 offen offset:0 lds
    buffer_load_dwordx4 v2, s[12:15], s24 offen offset:1024 lds
    buffer_load_dwordx4 v2, s[12:15], s24 offen offset:2048 lds
    buffer_load_dwordx4 v2, s[12:15], s24 offen offset:3072 lds
    s_add_u32 m0, s40, 86016
    s_add_u32 s24, s43, 384
    buffer_load_dwordx4 v1, s[8:11], s24 offen lds
    s_add_u32 m0, s41, 86016
    s_add_u32 s24, s44, 384
    buffer_load_dwordx4 v1, s[8:11], s24 offen lds
    s_add_u32 m0, s42, 86016
    s_add_u32 s24, s45, 384
    buffer_load_dwordx4 v1, s[8:11], s24 offen lds
    s_add_u32 m0, s47, 86016
    s_add_u32 s24, s46, 98304
    buffer_load_dwordx4 v2, s[12:15], s24 offen offset:0 lds
    buffer_load_dwordx4 v2, s[12:15], s24 offen offset:1024 lds
    buffer_load_dwordx4 v2, s[12:15], s24 offen offset:2048 lds
    buffer_load_dwordx4 v2, s[12:15], s24 offen offset:3072 lds
    s_add_u32 m0, s40, 114688
    s_add_u32 s24, s43, 512
    buffer_load_dwordx4 v1, s[8:11], s24 offen lds
    s_add_u32 m0, s41, 114688
    s_add_u32 s24, s44, 512
    buffer_load_dwordx4 v1, s[8:11], s24 offen lds
    s_add_u32 m0, s42, 114688
    s_add_u32 s24, s45, 512
    buffer_load_dwordx4 v1, s[8:11], s24 offen lds
    s_add_u32 m0, s47, 114688
    s_add_u32 s24, s46, 131072
    buffer_load_dwordx4 v2, s[12:15], s24 offen offset:0 lds
    buffer_load_dwordx4 v2, s[12:15], s24 offen offset:1024 lds
    buffer_load_dwordx4 v2, s[12:15], s24 offen offset:2048 lds
    buffer_load_dwordx4 v2, s[12:15], s24 offen offset:3072 lds
    s_waitcnt vmcnt(28)
    s_barrier
    s_waitcnt vmcnt(21)
    s_barrier
    s_add_u32 m0, s40, 0
    s_add_u32 s24, s43, 640
    buffer_load_dwordx4 v1, s[8:11], s24 offen lds
    s_add_u32 m0, s41, 0
    s_add_u32 s24, s44, 640
    buffer_load_dwordx4 v1, s[8:11], s24 offen lds
    s_add_u32 m0, s42, 0
    s_add_u32 s24, s45, 640
    buffer_load_dwordx4 v1, s[8:11], s24 offen lds
    s_add_u32 m0, s47, 0
    s_add_u32 s24, s46, 163840
    buffer_load_dwordx4 v2, s[12:15], s24 offen offset:0 lds
    buffer_load_dwordx4 v2, s[12:15], s24 offen offset:1024 lds
    buffer_load_dwordx4 v2, s[12:15], s24 offen offset:2048 lds
    buffer_load_dwordx4 v2, s[12:15], s24 offen offset:3072 lds
    s_waitcnt vmcnt(21)
    s_barrier
    s_add_u32 m0, s40, 28672
    s_add_u32 s24, s43, 768
    buffer_load_dwordx4 v1, s[8:11], s24 offen lds
    s_add_u32 m0, s41, 28672
    s_add_u32 s24, s44, 768
    buffer_load_dwordx4 v1, s[8:11], s24 offen lds
    s_add_u32 m0, s42, 28672
    s_add_u32 s24, s45, 768
    buffer_load_dwordx4 v1, s[8:11], s24 offen lds
    s_add_u32 m0, s47, 28672
    s_add_u32 s24, s46, 196608
    buffer_load_dwordx4 v2, s[12:15], s24 offen offset:0 lds
    buffer_load_dwordx4 v2, s[12:15], s24 offen offset:1024 lds
    buffer_load_dwordx4 v2, s[12:15], s24 offen offset:2048 lds
    buffer_load_dwordx4 v2, s[12:15], s24 offen offset:3072 lds
    s_waitcnt vmcnt(21)
    s_barrier
    s_add_u32 m0, s40, 57344
    s_add_u32 s24, s43, 896
    buffer_load_dwordx4 v1, s[8:11], s24 offen lds
    s_add_u32 m0, s41, 57344
    s_add_u32 s24, s44, 896
    buffer_load_dwordx4 v1, s[8:11], s24 offen lds
    s_add_u32 m0, s42, 57344
    s_add_u32 s24, s45, 896
    buffer_load_dwordx4 v1, s[8:11], s24 offen lds
    s_add_u32 m0, s47, 57344
    s_add_u32 s24, s46, 229376
    buffer_load_dwordx4 v2, s[12:15], s24 offen offset:0 lds
    buffer_load_dwordx4 v2, s[12:15], s24 offen offset:1024 lds
    buffer_load_dwordx4 v2, s[12:15], s24 offen offset:2048 lds
    buffer_load_dwordx4 v2, s[12:15], s24 offen offset:3072 lds
    s_waitcnt vmcnt(21)
    s_barrier
    s_add_u32 m0, s40, 86016
    s_add_u32 s24, s43, 1024
    buffer_load_dwordx4 v1, s[8:11], s24 offen lds
    s_add_u32 m0, s41, 86016
    s_add_u32 s24, s44, 1024
    buffer_load_dwordx4 v1, s[8:11], s24 offen lds
    s_add_u32 m0, s42, 86016
    s_add_u32 s24, s45, 1024
    buffer_load_dwordx4 v1, s[8:11], s24 offen lds
    s_add_u32 m0, s47, 86016
    s_add_u32 s24, s46, 262144
    buffer_load_dwordx4 v2, s[12:15], s24 offen offset:0 lds
    buffer_load_dwordx4 v2, s[12:15], s24 offen offset:1024 lds
    buffer_load_dwordx4 v2, s[12:15], s24 offen offset:2048 lds
    buffer_load_dwordx4 v2, s[12:15], s24 offen offset:3072 lds
    s_waitcnt vmcnt(21)
    s_barrier
    s_add_u32 m0, s40, 114688
    s_add_u32 s24, s43, 1152
    buffer_load_dwordx4 v1, s[8:11], s24 offen lds
    s_add_u32 m0, s41, 114688
    s_add_u32 s24, s44, 1152
    buffer_load_dwordx4 v1, s[8:11], s24 offen lds
    s_add_u32 m0, s42, 114688
    s_add_u32 s24, s45, 1152
    buffer_load_dwordx4 v1, s[8:11], s24 offen lds
    s_add_u32 m0, s47, 114688
    s_add_u32 s24, s46, 294912
    buffer_load_dwordx4 v2, s[12:15], s24 offen offset:0 lds
    buffer_load_dwordx4 v2, s[12:15], s24 offen offset:1024 lds
    buffer_load_dwordx4 v2, s[12:15], s24 offen offset:2048 lds
    buffer_load_dwordx4 v2, s[12:15], s24 offen offset:3072 lds
    s_waitcnt vmcnt(21)
    s_barrier
    s_add_u32 m0, s40, 0
    s_add_u32 s24, s43, 1280
    buffer_load_dwordx4 v1, s[8:11], s24 offen lds
    s_add_u32 m0, s41, 0
    s_add_u32 s24, s44, 1280
    buffer_load_dwordx4 v1, s[8:11], s24 offen lds
    s_add_u32 m0, s42, 0
    s_add_u32 s24, s45, 1280
    buffer_load_dwordx4 v1, s[8:11], s24 offen lds
    s_add_u32 m0, s47, 0
    s_add_u32 s24, s46, 327680
    buffer_load_dwordx4 v2, s[12:15], s24 offen offset:0 lds
    buffer_load_dwordx4 v2, s[12:15], s24 offen offset:1024 lds
    buffer_load_dwordx4 v2, s[12:15], s24 offen offset:2048 lds
    buffer_load_dwordx4 v2, s[12:15], s24 offen offset:3072 lds
    s_waitcnt vmcnt(21)
    s_barrier
    s_add_u32 m0, s40, 28672
    s_add_u32 s24, s43, 1408
    buffer_load_dwordx4 v1, s[8:11], s24 offen lds
    s_add_u32 m0, s41, 28672
    s_add_u32 s24, s44, 1408
    buffer_load_dwordx4 v1, s[8:11], s24 offen lds
    s_add_u32 m0, s42, 28672
    s_add_u32 s24, s45, 1408
    buffer_load_dwordx4 v1, s[8:11], s24 offen lds
    s_add_u32 m0, s47, 28672
    s_add_u32 s24, s46, 360448
    buffer_load_dwordx4 v2, s[12:15], s24 offen offset:0 lds
    buffer_load_dwordx4 v2, s[12:15], s24 offen offset:1024 lds
    buffer_load_dwordx4 v2, s[12:15], s24 offen offset:2048 lds
    buffer_load_dwordx4 v2, s[12:15], s24 offen offset:3072 lds
    s_waitcnt vmcnt(21)
    s_barrier
    s_add_u32 m0, s40, 57344
    s_add_u32 s24, s43, 1536
    buffer_load_dwordx4 v1, s[8:11], s24 offen lds
    s_add_u32 m0, s41, 57344
    s_add_u32 s24, s44, 1536
    buffer_load_dwordx4 v1, s[8:11], s24 offen lds
    s_add_u32 m0, s42, 57344
    s_add_u32 s24, s45, 1536
    buffer_load_dwordx4 v1, s[8:11], s24 offen lds
    s_add_u32 m0, s47, 57344
    s_add_u32 s24, s46, 393216
    buffer_load_dwordx4 v2, s[12:15], s24 offen offset:0 lds
    buffer_load_dwordx4 v2, s[12:15], s24 offen offset:1024 lds
    buffer_load_dwordx4 v2, s[12:15], s24 offen offset:2048 lds
    buffer_load_dwordx4 v2, s[12:15], s24 offen offset:3072 lds
    s_waitcnt vmcnt(21)
    s_barrier
    s_add_u32 m0, s40, 86016
    s_add_u32 s24, s43, 1664
    buffer_load_dwordx4 v1, s[8:11], s24 offen lds
    s_add_u32 m0, s41, 86016
    s_add_u32 s24, s44, 1664
    buffer_load_dwordx4 v1, s[8:11], s24 offen lds
    s_add_u32 m0, s42, 86016
    s_add_u32 s24, s45, 1664
    buffer_load_dwordx4 v1, s[8:11], s24 offen lds
    s_add_u32 m0, s47, 86016
    s_add_u32 s24, s46, 425984
    buffer_load_dwordx4 v2, s[12:15], s24 offen offset:0 lds
    buffer_load_dwordx4 v2, s[12:15], s24 offen offset:1024 lds
    buffer_load_dwordx4 v2, s[12:15], s24 offen offset:2048 lds
    buffer_load_dwordx4 v2, s[12:15], s24 offen offset:3072 lds
    s_waitcnt vmcnt(21)
    s_barrier
    s_add_u32 m0, s40, 114688
    s_add_u32 s24, s43, 1792
    buffer_load_dwordx4 v1, s[8:11], s24 offen lds
    s_add_u32 m0, s41, 114688
    s_add_u32 s24, s44, 1792
    buffer_load_dwordx4 v1, s[8:11], s24 offen lds
    s_add_u32 m0, s42, 114688
    s_add_u32 s24, s45, 1792
    buffer_load_dwordx4 v1, s[8:11], s24 offen lds
    s_add_u32 m0, s47, 114688
    s_add_u32 s24, s46, 458752
    buffer_load_dwordx4 v2, s[12:15], s24 offen offset:0 lds
    buffer_load_dwordx4 v2, s[12:15], s24 offen offset:1024 lds
    buffer_load_dwordx4 v2, s[12:15], s24 offen offset:2048 lds
    buffer_load_dwordx4 v2, s[12:15], s24 offen offset:3072 lds
    s_waitcnt vmcnt(21)
    s_barrier
    s_add_u32 m0, s40, 0
    s_add_u32 s24, s43, 1920
    buffer_load_dwordx4 v1, s[8:11], s24 offen lds
    s_add_u32 m0, s41, 0
    s_add_u32 s24, s44, 1920
    buffer_load_dwordx4 v1, s[8:11], s24 offen lds
    s_add_u32 m0, s42, 0
    s_add_u32 s24, s45, 1920
    buffer_load_dwordx4 v1, s[8:11], s24 offen lds
    s_add_u32 m0, s47, 0
    s_add_u32 s24, s46, 491520
    buffer_load_dwordx4 v2, s[12:15], s24 offen offset:0 lds
    buffer_load_dwordx4 v2, s[12:15], s24 offen offset:1024 lds
    buffer_load_dwordx4 v2, s[12:15], s24 offen offset:2048 lds
    buffer_load_dwordx4 v2, s[12:15], s24 offen offset:3072 lds
    s_waitcnt vmcnt(21)
    s_barrier
    s_waitcnt vmcnt(14)
    s_barrier
    s_waitcnt vmcnt(7)
    s_barrier
    s_waitcnt vmcnt(0)
    s_barrier
L_gemm1_kernel_done:
    s_endpgm
.globl mid_kernel
.p2align 8
.type mid_kernel,@function
mid_kernel:
    s_cmp_ge_u32 s2, 704
    s_cbranch_scc1 L_mid_kernel_done
    v_readfirstlane_b32 s20, v0
    s_lshr_b32 s20, s20, 6
    s_cmp_ge_u32 s2, 448
    s_cbranch_scc1 L_mid_kernel_g
    s_load_dwordx2 s[6:7], s[0:1], 72
    s_cmp_ge_u32 s2, 224
    s_cselect_b32 s24, 1, 0
    s_mul_i32 s25, s24, 224
    s_sub_u32 s25, s2, s25
    s_lshr_b32 s26, s25, 3
    s_and_b32 s27, s25, 7
    v_and_b32 v1, 63, v0
    v_lshrrev_b32 v2, 2, v1
    v_lshlrev_b32 v2, 6, v2
    v_lshrrev_b32 v3, 5, v1
    v_lshlrev_b32 v3, 1, v3
    v_and_b32 v4, 3, v1
    v_xor_b32 v3, v3, v4
    v_lshl_add_u32 v2, v3, 4, v2
    s_mul_i32 s28, s26, 6
    s_lshl_b32 s29, s20, 1
    s_add_u32 s28, s28, s29
    s_sub_u32 s28, s28, 1
    s_lshl_b32 s30, s27, 12
    s_add_u32 s31, s28, 0
    s_lshl_b32 s32, s31, 15
    s_add_u32 s32, s32, s30
    s_cmp_lt_i32 s31, 0
    s_cselect_b32 s32, 0x7f000000, s32
    v_add_u32 v3, s32, v2
    s_add_u32 s31, s28, 1
    s_lshl_b32 s32, s31, 15
    s_add_u32 s32, s32, s30
    s_cmp_lt_i32 s31, 0
    s_cselect_b32 s32, 0x7f000000, s32
    v_add_u32 v4, s32, v2
    s_waitcnt lgkmcnt(0)
    s_mul_i32 s33, s24, 5472256
    s_add_u32 s33, s33, 38871040
    s_add_u32 s8, s6, s33
    s_addc_u32 s9, s7, 0
    s_mov_b32 s10, 5472256
    s_mov_b32 s11, 0x00020000
    s_add_u32 s12, s6, 83312640
    s_addc_u32 s13, s7, 0
    s_mov_b32 s14, 16384
    s_mov_b32 s15, 0x00020000
    s_lshl_b32 s34, s20, 13
    s_add_u32 m0, s34, 0
    s_nop 0
    buffer_load_dwordx4 v3, s[8:11], 0 offen offset:0 lds
    buffer_load_dwordx4 v3, s[8:11], 0 offen offset:1024 lds
    buffer_load_dwordx4 v3, s[8:11], 0 offen offset:2048 lds
    buffer_load_dwordx4 v3, s[8:11], 0 offen offset:3072 lds
    s_add_u32 m0, s34, 4096
    s_nop 0
    buffer_load_dwordx4 v4, s[8:11], 0 offen offset:0 lds
    buffer_load_dwordx4 v4, s[8:11], 0 offen offset:1024 lds
    buffer_load_dwordx4 v4, s[8:11], 0 offen offset:2048 lds
    buffer_load_dwordx4 v4, s[8:11], 0 offen offset:3072 lds
    v_lshlrev_b32 v5, 4, v1
    s_mov_b32 s35, 8192
    buffer_load_dwordx4 v[8:11], v5, s[12:15], s35 offen
    s_mov_b32 s35, 9216
    buffer_load_dwordx4 v[12:15], v5, s[12:15], s35 offen
    s_mov_b32 s35, 10240
    buffer_load_dwordx4 v[16:19], v5, s[12:15], s35 offen
    s_mov_b32 s35, 11264
    buffer_load_dwordx4 v[20:23], v5, s[12:15], s35 offen
    s_mov_b32 s35, 12288
    buffer_load_dwordx4 v[24:27], v5, s[12:15], s35 offen
    s_mov_b32 s35, 13312
    buffer_load_dwordx4 v[28:31], v5, s[12:15], s35 offen
    s_lshl_b32 s35, s20, 11
    buffer_load_dwordx4 v[32:35], v5, s[12:15], s35 offen offset:0
    buffer_load_dwordx4 v[36:39], v5, s[12:15], s35 offen offset:1024
    v_bfe_u32 v40, v1, 2, 2
    v_lshrrev_b32 v41, 4, v1
    v_and_b32 v42, 3, v1
    v_lshl_add_u32 v43, v41, 3, v40
    v_lshlrev_b32 v46, 6, v43
    v_and_b32 v47, 1, v41
    v_lshlrev_b32 v47, 1, v47
    v_lshrrev_b32 v48, 1, v42
    v_xor_b32 v47, v47, v48
    v_lshl_add_u32 v46, v47, 4, v46
    v_and_b32 v48, 1, v42
    v_lshl_add_u32 v46, v48, 3, v46
    v_add_u32 v44, s34, v46
    v_xor_b32 v45, 32, v44
    v_add_u32 v49, 46080, v46
    v_xor_b32 v50, 32, v49
    v_add_u32 v47, 1, v43
    v_bfe_u32 v48, v47, 3, 1
    v_lshlrev_b32 v48, 1, v48
    v_lshrrev_b32 v55, 1, v42
    v_xor_b32 v48, v48, v55
    v_lshlrev_b32 v47, 6, v47
    v_lshl_add_u32 v47, v48, 4, v47
    v_and_b32 v48, 1, v42
    v_lshl_add_u32 v47, v48, 3, v47
    v_add_u32 v51, 33792, v47
    v_xor_b32 v52, 32, v51
    v_add_u32 v47, 5, v43
    v_bfe_u32 v48, v47, 3, 1
    v_lshlrev_b32 v48, 1, v48
    v_lshrrev_b32 v55, 1, v42
    v_xor_b32 v48, v48, v55
    v_lshlrev_b32 v47, 6, v47
    v_lshl_add_u32 v47, v48, 4, v47
    v_and_b32 v48, 1, v42
    v_lshl_add_u32 v47, v48, 3, v47
    v_add_u32 v53, 33792, v47
    v_xor_b32 v54, 32, v53
    v_and_b32 v47, 1, v1
    v_mul_u32_u24 v47, 12288, v47
    v_bfe_u32 v48, v1, 1, 3
    v_lshl_add_u32 v47, v48, 6, v47
    v_lshl_add_u32 v47, v41, 4, v47
    s_mul_i32 s35, s20, 3072
    s_add_u32 s35, s35, 32768
    v_add_u32 v56, s35, v47
    v_xor_b32 v57, 32, v56
    s_mov_b32 s35, 344064
    v_mul_lo_u32 v58, v48, s35
    v_and_b32 v47, 1, v1
    v_lshl_add_u32 v58, v47, 6, v58
    v_lshl_add_u32 v58, v41, 4, v58
    s_mov_b32 s36, 0xbdd2d3e8
    v_mov_b32 v59, 0xc0135761
    s_add_u32 s16, s6, 49815552
    s_addc_u32 s17, s7, 0
    s_mov_b32 s18, 11010048
    s_mov_b32 s19, 0x00020000
    s_mul_i32 s37, s20, 2752512
    s_mul_i32 s38, s24, 84
    s_mul_i32 s39, s26, 3
    s_add_u32 s38, s38, s39
    s_lshl_b32 s38, s38, 11
    s_add_u32 s37, s37, s38
    s_lshl_b32 s38, s27, 7
    s_add_u32 s37, s37, s38
    s_waitcnt vmcnt(2)
    ds_read_b64_tr_b16 v[60:61], v44 offset:0
    ds_read_b64_tr_b16 v[62:63], v44 offset:256
    ds_read_b64_tr_b16 v[64:65], v44 offset:2048
    ds_read_b64_tr_b16 v[66:67], v44 offset:2304
    ds_read_b64_tr_b16 v[68:69], v45 offset:0
    ds_read_b64_tr_b16 v[70:71], v45 offset:256
    ds_read_b64_tr_b16 v[72:73], v45 offset:2048
    ds_read_b64_tr_b16 v[74:75], v45 offset:2304
    s_waitcnt lgkmcnt(0)
    v_mfma_f32_16x16x32_bf16 v[76:79], v[60:63], v[8:11], 0
    v_mfma_f32_16x16x32_bf16 v[80:83], v[68:71], v[8:11], 0
    v_mfma_f32_16x16x32_bf16 v[84:87], v[60:63], v[16:19], 0
    v_mfma_f32_16x16x32_bf16 v[88:91], v[68:71], v[16:19], 0
    v_mfma_f32_16x16x32_bf16 v[92:95], v[60:63], v[24:27], 0
    v_mfma_f32_16x16x32_bf16 v[96:99], v[68:71], v[24:27], 0
    v_mfma_f32_16x16x32_bf16 v[76:79], v[64:67], v[12:15], v[76:79]
    v_mfma_f32_16x16x32_bf16 v[80:83], v[72:75], v[12:15], v[80:83]
    v_mfma_f32_16x16x32_bf16 v[84:87], v[64:67], v[20:23], v[84:87]
    v_mfma_f32_16x16x32_bf16 v[88:91], v[72:75], v[20:23], v[88:91]
    v_mfma_f32_16x16x32_bf16 v[92:95], v[64:67], v[28:31], v[92:95]
    v_mfma_f32_16x16x32_bf16 v[96:99], v[72:75], v[28:31], v[96:99]
    s_add_u32 s31, s28, 0
    s_cmp_eq_u32 s31, 166
    s_cselect_b32 s39, 0, -1
    s_nop 4
    v_mul_f32 v100, v76, v76
    v_mul_f32 v101, v77, v77
    v_mul_f32 v102, v78, v78
    v_mul_f32 v103, v79, v79
    v_mul_f32 v104, v80, v80
    v_mul_f32 v105, v81, v81
    v_mul_f32 v106, v82, v82
    v_mul_f32 v107, v83, v83
    v_fma_f32 v100, v100, s36, v59
    v_fma_f32 v101, v101, s36, v59
    v_fma_f32 v102, v102, s36, v59
    v_fma_f32 v103, v103, s36, v59
    v_fma_f32 v104, v104, s36, v59
    v_fma_f32 v105, v105, s36, v59
    v_fma_f32 v106, v106, s36, v59
    v_fma_f32 v107, v107, s36, v59
    v_mul_f32 v100, v100, v76
    v_mul_f32 v101, v101, v77
    v_mul_f32 v102, v102, v78
    v_mul_f32 v103, v103, v79
    v_mul_f32 v104, v104, v80
    v_mul_f32 v105, v105, v81
    v_mul_f32 v106, v106, v82
    v_mul_f32 v107, v107, v83
    v_exp_f32 v100, v100
    v_exp_f32 v101, v101
    v_exp_f32 v102, v102
    v_exp_f32 v103, v103
    v_exp_f32 v104, v104
    v_exp_f32 v105, v105
    v_exp_f32 v106, v106
    v_exp_f32 v107, v107
    v_add_f32 v100, 1.0, v100
    v_add_f32 v101, 1.0, v101
    v_add_f32 v102, 1.0, v102
    v_add_f32 v103, 1.0, v103
    v_add_f32 v104, 1.0, v104
    v_add_f32 v105, 1.0, v105
    v_add_f32 v106, 1.0, v106
    v_add_f32 v107, 1.0, v107
    v_rcp_f32 v100, v100
    v_rcp_f32 v101, v101
    v_rcp_f32 v102, v102
    v_rcp_f32 v103, v103
    v_rcp_f32 v104, v104
    v_rcp_f32 v105, v105
    v_rcp_f32 v106, v106
    v_rcp_f32 v107, v107
    v_mul_f32 v76, v76, v100
    v_mul_f32 v77, v77, v101
    v_mul_f32 v78, v78, v102
    v_mul_f32 v79, v79, v103
    v_mul_f32 v80, v80, v104
    v_mul_f32 v81, v81, v105
    v_mul_f32 v82, v82, v106
    v_mul_f32 v83, v83, v107
    v_cvt_pk_bf16_f32 v108, v76, v77
    v_cvt_pk_bf16_f32 v109, v78, v79
    v_cvt_pk_bf16_f32 v110, v80, v81
    v_cvt_pk_bf16_f32 v111, v82, v83
    ds_write_b128 v56, v[108:111] offset:0
    v_mul_f32 v100, v84, v84
    v_mul_f32 v101, v85, v85
    v_mul_f32 v102, v86, v86
    v_mul_f32 v103, v87, v87
    v_mul_f32 v104, v88, v88
    v_mul_f32 v105, v89, v89
    v_mul_f32 v106, v90, v90
    v_mul_f32 v107, v91, v91
    v_fma_f32 v100, v100, s36, v59
    v_fma_f32 v101, v101, s36, v59
    v_fma_f32 v102, v102, s36, v59
    v_fma_f32 v103, v103, s36, v59
    v_fma_f32 v104, v104, s36, v59
    v_fma_f32 v105, v105, s36, v59
    v_fma_f32 v106, v106, s36, v59
    v_fma_f32 v107, v107, s36, v59
    v_mul_f32 v100, v100, v84
    v_mul_f32 v101, v101, v85
    v_mul_f32 v102, v102, v86
    v_mul_f32 v103, v103, v87
    v_mul_f32 v104, v104, v88
    v_mul_f32 v105, v105, v89
    v_mul_f32 v106, v106, v90
    v_mul_f32 v107, v107, v91
    v_exp_f32 v100, v100
    v_exp_f32 v101, v101
    v_exp_f32 v102, v102
    v_exp_f32 v103, v103
    v_exp_f32 v104, v104
    v_exp_f32 v105, v105
    v_exp_f32 v106, v106
    v_exp_f32 v107, v107
    v_add_f32 v100, 1.0, v100
    v_add_f32 v101, 1.0, v101
    v_add_f32 v102, 1.0, v102
    v_add_f32 v103, 1.0, v103
    v_add_f32 v104, 1.0, v104
    v_add_f32 v105, 1.0, v105
    v_add_f32 v106, 1.0, v106
    v_add_f32 v107, 1.0, v107
    v_rcp_f32 v100, v100
    v_rcp_f32 v101, v101
    v_rcp_f32 v102, v102
    v_rcp_f32 v103, v103
    v_rcp_f32 v104, v104
    v_rcp_f32 v105, v105
    v_rcp_f32 v106, v106
    v_rcp_f32 v107, v107
    v_mul_f32 v84, v84, v100
    v_mul_f32 v85, v85, v101
    v_mul_f32 v86, v86, v102
    v_mul_f32 v87, v87, v103
    v_mul_f32 v88, v88, v104
    v_mul_f32 v89, v89, v105
    v_mul_f32 v90, v90, v106
    v_mul_f32 v91, v91, v107
    v_cvt_pk_bf16_f32 v112, v84, v85
    v_cvt_pk_bf16_f32 v113, v86, v87
    v_cvt_pk_bf16_f32 v114, v88, v89
    v_cvt_pk_bf16_f32 v115, v90, v91
    ds_write_b128 v57, v[112:115] offset:512
    v_mul_f32 v100, v92, v92
    v_mul_f32 v101, v93, v93
    v_mul_f32 v102, v94, v94
    v_mul_f32 v103, v95, v95
    v_mul_f32 v104, v96, v96
    v_mul_f32 v105, v97, v97
    v_mul_f32 v106, v98, v98
    v_mul_f32 v107, v99, v99
    v_fma_f32 v100, v100, s36, v59
    v_fma_f32 v101, v101, s36, v59
    v_fma_f32 v102, v102, s36, v59
    v_fma_f32 v103, v103, s36, v59
    v_fma_f32 v104, v104, s36, v59
    v_fma_f32 v105, v105, s36, v59
    v_fma_f32 v106, v106, s36, v59
    v_fma_f32 v107, v107, s36, v59
    v_mul_f32 v100, v100, v92
    v_mul_f32 v101, v101, v93
    v_mul_f32 v102, v102, v94
    v_mul_f32 v103, v103, v95
    v_mul_f32 v104, v104, v96
    v_mul_f32 v105, v105, v97
    v_mul_f32 v106, v106, v98
    v_mul_f32 v107, v107, v99
    v_exp_f32 v100, v100
    v_exp_f32 v101, v101
    v_exp_f32 v102, v102
    v_exp_f32 v103, v103
    v_exp_f32 v104, v104
    v_exp_f32 v105, v105
    v_exp_f32 v106, v106
    v_exp_f32 v107, v107
    v_add_f32 v100, 1.0, v100
    v_add_f32 v101, 1.0, v101
    v_add_f32 v102, 1.0, v102
    v_add_f32 v103, 1.0, v103
    v_add_f32 v104, 1.0, v104
    v_add_f32 v105, 1.0, v105
    v_add_f32 v106, 1.0, v106
    v_add_f32 v107, 1.0, v107
    v_rcp_f32 v100, v100
    v_rcp_f32 v101, v101
    v_rcp_f32 v102, v102
    v_rcp_f32 v103, v103
    v_rcp_f32 v104, v104
    v_rcp_f32 v105, v105
    v_rcp_f32 v106, v106
    v_rcp_f32 v107, v107
    v_mul_f32 v92, v92, v100
    v_mul_f32 v93, v93, v101
    v_mul_f32 v94, v94, v102
    v_mul_f32 v95, v95, v103
    v_mul_f32 v96, v96, v104
    v_mul_f32 v97, v97, v105
    v_mul_f32 v98, v98, v106
    v_mul_f32 v99, v99, v107
    v_cvt_pk_bf16_f32 v116, v92, v93
    v_cvt_pk_bf16_f32 v117, v94, v95
    v_cvt_pk_bf16_f32 v118, v96, v97
    v_cvt_pk_bf16_f32 v119, v98, v99
    v_and_b32 v116, s39, v116
    v_and_b32 v117, s39, v117
    v_and_b32 v118, s39, v118
    v_and_b32 v119, s39, v119
    ds_write_b128 v56, v[116:119] offset:1024
    ds_read_b64_tr_b16 v[60:61], v44 offset:4096
    ds_read_b64_tr_b16 v[62:63], v44 offset:4352
    ds_read_b64_tr_b16 v[64:65], v44 offset:6144
    ds_read_b64_tr_b16 v[66:67], v44 offset:6400
    ds_read_b64_tr_b16 v[68:69], v45 offset:4096
    ds_read_b64_tr_b16 v[70:71], v45 offset:4352
    ds_read_b64_tr_b16 v[72:73], v45 offset:6144
    ds_read_b64_tr_b16 v[74:75], v45 offset:6400
    s_waitcnt lgkmcnt(0)
    v_mfma_f32_16x16x32_bf16 v[76:79], v[60:63], v[8:11], 0
    v_mfma_f32_16x16x32_bf16 v[80:83], v[68:71], v[8:11], 0
    v_mfma_f32_16x16x32_bf16 v[84:87], v[60:63], v[16:19], 0
    v_mfma_f32_16x16x32_bf16 v[88:91], v[68:71], v[16:19], 0
    v_mfma_f32_16x16x32_bf16 v[92:95], v[60:63], v[24:27], 0
    v_mfma_f32_16x16x32_bf16 v[96:99], v[68:71], v[24:27], 0
    v_mfma_f32_16x16x32_bf16 v[76:79], v[64:67], v[12:15], v[76:79]
    v_mfma_f32_16x16x32_bf16 v[80:83], v[72:75], v[12:15], v[80:83]
    v_mfma_f32_16x16x32_bf16 v[84:87], v[64:67], v[20:23], v[84:87]
    v_mfma_f32_16x16x32_bf16 v[88:91], v[72:75], v[20:23], v[88:91]
    v_mfma_f32_16x16x32_bf16 v[92:95], v[64:67], v[28:31], v[92:95]
    v_mfma_f32_16x16x32_bf16 v[96:99], v[72:75], v[28:31], v[96:99]
    s_add_u32 s31, s28, 1
    s_cmp_eq_u32 s31, 166
    s_cselect_b32 s39, 0, -1
    s_nop 4
    v_mul_f32 v100, v76, v76
    v_mul_f32 v101, v77, v77
    v_mul_f32 v102, v78, v78
    v_mul_f32 v103, v79, v79
    v_mul_f32 v104, v80, v80
    v_mul_f32 v105, v81, v81
    v_mul_f32 v106, v82, v82
    v_mul_f32 v107, v83, v83
    v_fma_f32 v100, v100, s36, v59
    v_fma_f32 v101, v101, s36, v59
    v_fma_f32 v102, v102, s36, v59
    v_fma_f32 v103, v103, s36, v59
    v_fma_f32 v104, v104, s36, v59
    v_fma_f32 v105, v105, s36, v59
    v_fma_f32 v106, v106, s36, v59
    v_fma_f32 v107, v107, s36, v59
    v_mul_f32 v100, v100, v76
    v_mul_f32 v101, v101, v77
    v_mul_f32 v102, v102, v78
    v_mul_f32 v103, v103, v79
    v_mul_f32 v104, v104, v80
    v_mul_f32 v105, v105, v81
    v_mul_f32 v106, v106, v82
    v_mul_f32 v107, v107, v83
    v_exp_f32 v100, v100
    v_exp_f32 v101, v101
    v_exp_f32 v102, v102
    v_exp_f32 v103, v103
    v_exp_f32 v104, v104
    v_exp_f32 v105, v105
    v_exp_f32 v106, v106
    v_exp_f32 v107, v107
    v_add_f32 v100, 1.0, v100
    v_add_f32 v101, 1.0, v101
    v_add_f32 v102, 1.0, v102
    v_add_f32 v103, 1.0, v103
    v_add_f32 v104, 1.0, v104
    v_add_f32 v105, 1.0, v105
    v_add_f32 v106, 1.0, v106
    v_add_f32 v107, 1.0, v107
    v_rcp_f32 v100, v100
    v_rcp_f32 v101, v101
    v_rcp_f32 v102, v102
    v_rcp_f32 v103, v103
    v_rcp_f32 v104, v104
    v_rcp_f32 v105, v105
    v_rcp_f32 v106, v106
    v_rcp_f32 v107, v107
    v_mul_f32 v76, v76, v100
    v_mul_f32 v77, v77, v101
    v_mul_f32 v78, v78, v102
    v_mul_f32 v79, v79, v103
    v_mul_f32 v80, v80, v104
    v_mul_f32 v81, v81, v105
    v_mul_f32 v82, v82, v106
    v_mul_f32 v83, v83, v107
    v_cvt_pk_bf16_f32 v108, v76, v77
    v_cvt_pk_bf16_f32 v109, v78, v79
    v_cvt_pk_bf16_f32 v110, v80, v81
    v_cvt_pk_bf16_f32 v111, v82, v83
    ds_write_b128 v57, v[108:111] offset:1536
    v_mul_f32 v100, v84, v84
    v_mul_f32 v101, v85, v85
    v_mul_f32 v102, v86, v86
    v_mul_f32 v103, v87, v87
    v_mul_f32 v104, v88, v88
    v_mul_f32 v105, v89, v89
    v_mul_f32 v106, v90, v90
    v_mul_f32 v107, v91, v91
    v_fma_f32 v100, v100, s36, v59
    v_fma_f32 v101, v101, s36, v59
    v_fma_f32 v102, v102, s36, v59
    v_fma_f32 v103, v103, s36, v59
    v_fma_f32 v104, v104, s36, v59
    v_fma_f32 v105, v105, s36, v59
    v_fma_f32 v106, v106, s36, v59
    v_fma_f32 v107, v107, s36, v59
    v_mul_f32 v100, v100, v84
    v_mul_f32 v101, v101, v85
    v_mul_f32 v102, v102, v86
    v_mul_f32 v103, v103, v87
    v_mul_f32 v104, v104, v88
    v_mul_f32 v105, v105, v89
    v_mul_f32 v106, v106, v90
    v_mul_f32 v107, v107, v91
    v_exp_f32 v100, v100
    v_exp_f32 v101, v101
    v_exp_f32 v102, v102
    v_exp_f32 v103, v103
    v_exp_f32 v104, v104
    v_exp_f32 v105, v105
    v_exp_f32 v106, v106
    v_exp_f32 v107, v107
    v_add_f32 v100, 1.0, v100
    v_add_f32 v101, 1.0, v101
    v_add_f32 v102, 1.0, v102
    v_add_f32 v103, 1.0, v103
    v_add_f32 v104, 1.0, v104
    v_add_f32 v105, 1.0, v105
    v_add_f32 v106, 1.0, v106
    v_add_f32 v107, 1.0, v107
    v_rcp_f32 v100, v100
    v_rcp_f32 v101, v101
    v_rcp_f32 v102, v102
    v_rcp_f32 v103, v103
    v_rcp_f32 v104, v104
    v_rcp_f32 v105, v105
    v_rcp_f32 v106, v106
    v_rcp_f32 v107, v107
    v_mul_f32 v84, v84, v100
    v_mul_f32 v85, v85, v101
    v_mul_f32 v86, v86, v102
    v_mul_f32 v87, v87, v103
    v_mul_f32 v88, v88, v104
    v_mul_f32 v89, v89, v105
    v_mul_f32 v90, v90, v106
    v_mul_f32 v91, v91, v107
    v_cvt_pk_bf16_f32 v112, v84, v85
    v_cvt_pk_bf16_f32 v113, v86, v87
    v_cvt_pk_bf16_f32 v114, v88, v89
    v_cvt_pk_bf16_f32 v115, v90, v91
    ds_write_b128 v56, v[112:115] offset:2048
    v_mul_f32 v100, v92, v92
    v_mul_f32 v101, v93, v93
    v_mul_f32 v102, v94, v94
    v_mul_f32 v103, v95, v95
    v_mul_f32 v104, v96, v96
    v_mul_f32 v105, v97, v97
    v_mul_f32 v106, v98, v98
    v_mul_f32 v107, v99, v99
    v_fma_f32 v100, v100, s36, v59
    v_fma_f32 v101, v101, s36, v59
    v_fma_f32 v102, v102, s36, v59
    v_fma_f32 v103, v103, s36, v59
    v_fma_f32 v104, v104, s36, v59
    v_fma_f32 v105, v105, s36, v59
    v_fma_f32 v106, v106, s36, v59
    v_fma_f32 v107, v107, s36, v59
    v_mul_f32 v100, v100, v92
    v_mul_f32 v101, v101, v93
    v_mul_f32 v102, v102, v94
    v_mul_f32 v103, v103, v95
    v_mul_f32 v104, v104, v96
    v_mul_f32 v105, v105, v97
    v_mul_f32 v106, v106, v98
    v_mul_f32 v107, v107, v99
    v_exp_f32 v100, v100
    v_exp_f32 v101, v101
    v_exp_f32 v102, v102
    v_exp_f32 v103, v103
    v_exp_f32 v104, v104
    v_exp_f32 v105, v105
    v_exp_f32 v106, v106
    v_exp_f32 v107, v107
    v_add_f32 v100, 1.0, v100
    v_add_f32 v101, 1.0, v101
    v_add_f32 v102, 1.0, v102
    v_add_f32 v103, 1.0, v103
    v_add_f32 v104, 1.0, v104
    v_add_f32 v105, 1.0, v105
    v_add_f32 v106, 1.0, v106
    v_add_f32 v107, 1.0, v107
    v_rcp_f32 v100, v100
    v_rcp_f32 v101, v101
    v_rcp_f32 v102, v102
    v_rcp_f32 v103, v103
    v_rcp_f32 v104, v104
    v_rcp_f32 v105, v105
    v_rcp_f32 v106, v106
    v_rcp_f32 v107, v107
    v_mul_f32 v92, v92, v100
    v_mul_f32 v93, v93, v101
    v_mul_f32 v94, v94, v102
    v_mul_f32 v95, v95, v103
    v_mul_f32 v96, v96, v104
    v_mul_f32 v97, v97, v105
    v_mul_f32 v98, v98, v106
    v_mul_f32 v99, v99, v107
    v_cvt_pk_bf16_f32 v116, v92, v93
    v_cvt_pk_bf16_f32 v117, v94, v95
    v_cvt_pk_bf16_f32 v118, v96, v97
    v_cvt_pk_bf16_f32 v119, v98, v99
    v_and_b32 v116, s39, v116
    v_and_b32 v117, s39, v117
    v_and_b32 v118, s39, v118
    v_and_b32 v119, s39, v119
    ds_write_b128 v57, v[116:119] offset:2560
    s_waitcnt vmcnt(0)
    s_waitcnt lgkmcnt(0)
    s_barrier
    ds_read_b64_tr_b16 v[60:61], v49 offset:0
    ds_read_b64_tr_b16 v[62:63], v49 offset:256
    ds_read_b64_tr_b16 v[64:65], v49 offset:2048
    ds_read_b64_tr_b16 v[66:67], v49 offset:2304
    ds_read_b64_tr_b16 v[68:69], v50 offset:0
    ds_read_b64_tr_b16 v[70:71], v50 offset:256
    ds_read_b64_tr_b16 v[72:73], v50 offset:2048
    ds_read_b64_tr_b16 v[74:75], v50 offset:2304
    s_waitcnt lgkmcnt(0)
    v_mfma_f32_16x16x32_bf16 v[92:95], v[60:63], v[32:35], 0
    v_mfma_f32_16x16x32_bf16 v[96:99], v[68:71], v[32:35], 0
    v_mfma_f32_16x16x32_bf16 v[92:95], v[64:67], v[36:39], v[92:95]
    v_mfma_f32_16x16x32_bf16 v[96:99], v[72:75], v[36:39], v[96:99]
    ds_read_b64_tr_b16 v[76:77], v51 offset:0
    ds_read_b64_tr_b16 v[78:79], v53 offset:0
    ds_read_b64_tr_b16 v[80:81], v51 offset:2048
    ds_read_b64_tr_b16 v[82:83], v53 offset:2048
    ds_read_b64_tr_b16 v[84:85], v52 offset:0
    ds_read_b64_tr_b16 v[86:87], v54 offset:0
    ds_read_b64_tr_b16 v[88:89], v52 offset:2048
    ds_read_b64_tr_b16 v[90:91], v54 offset:2048
    v_cvt_pk_bf16_f32 v108, v92, v93
    v_cvt_pk_bf16_f32 v109, v94, v95
    v_cvt_pk_bf16_f32 v110, v96, v97
    v_cvt_pk_bf16_f32 v111, v98, v99
    s_add_u32 s38, s37, 0
    buffer_store_dwordx4 v[108:111], v58, s[16:19], s38 offen sc1
    s_waitcnt lgkmcnt(0)
    v_mfma_f32_16x16x32_bf16 v[100:103], v[76:79], v[32:35], 0
    v_mfma_f32_16x16x32_bf16 v[104:107], v[84:87], v[32:35], 0
    v_mfma_f32_16x16x32_bf16 v[100:103], v[80:83], v[36:39], v[100:103]
    v_mfma_f32_16x16x32_bf16 v[104:107], v[88:91], v[36:39], v[104:107]
    ds_read_b64_tr_b16 v[60:61], v49 offset:3072
    ds_read_b64_tr_b16 v[62:63], v49 offset:3328
    ds_read_b64_tr_b16 v[64:65], v49 offset:5120
    ds_read_b64_tr_b16 v[66:67], v49 offset:5376
    ds_read_b64_tr_b16 v[68:69], v50 offset:3072
    ds_read_b64_tr_b16 v[70:71], v50 offset:3328
    ds_read_b64_tr_b16 v[72:73], v50 offset:5120
    ds_read_b64_tr_b16 v[74:75], v50 offset:5376
    v_cvt_pk_bf16_f32 v112, v100, v101
    v_cvt_pk_bf16_f32 v113, v102, v103
    v_cvt_pk_bf16_f32 v114, v104, v105
    v_cvt_pk_bf16_f32 v115, v106, v107
    s_add_u32 s38, s37, 1024
    buffer_store_dwordx4 v[112:115], v58, s[16:19], s38 offen sc1
    s_waitcnt lgkmcnt(0)
    v_mfma_f32_16x16x32_bf16 v[92:95], v[60:63], v[32:35], 0
    v_mfma_f32_16x16x32_bf16 v[96:99], v[68:71], v[32:35], 0
    v_mfma_f32_16x16x32_bf16 v[92:95], v[64:67], v[36:39], v[92:95]
    v_mfma_f32_16x16x32_bf16 v[96:99], v[72:75], v[36:39], v[96:99]
    ds_read_b64_tr_b16 v[76:77], v51 offset:3072
    ds_read_b64_tr_b16 v[78:79], v53 offset:3072
    ds_read_b64_tr_b16 v[80:81], v51 offset:5120
    ds_read_b64_tr_b16 v[82:83], v53 offset:5120
    ds_read_b64_tr_b16 v[84:85], v52 offset:3072
    ds_read_b64_tr_b16 v[86:87], v54 offset:3072
    ds_read_b64_tr_b16 v[88:89], v52 offset:5120
    ds_read_b64_tr_b16 v[90:91], v54 offset:5120
    v_cvt_pk_bf16_f32 v108, v92, v93
    v_cvt_pk_bf16_f32 v109, v94, v95
    v_cvt_pk_bf16_f32 v110, v96, v97
    v_cvt_pk_bf16_f32 v111, v98, v99
    s_add_u32 s38, s37, 2048
    buffer_store_dwordx4 v[108:111], v58, s[16:19], s38 offen sc1
    s_waitcnt lgkmcnt(0)
    v_mfma_f32_16x16x32_bf16 v[100:103], v[76:79], v[32:35], 0
    v_mfma_f32_16x16x32_bf16 v[104:107], v[84:87], v[32:35], 0
    v_mfma_f32_16x16x32_bf16 v[100:103], v[80:83], v[36:39], v[100:103]
    v_mfma_f32_16x16x32_bf16 v[104:107], v[88:91], v[36:39], v[104:107]
    ds_read_b64_tr_b16 v[60:61], v49 offset:6144
    ds_read_b64_tr_b16 v[62:63], v49 offset:6400
    ds_read_b64_tr_b16 v[64:65], v49 offset:8192
    ds_read_b64_tr_b16 v[66:67], v49 offset:8448
    ds_read_b64_tr_b16 v[68:69], v50 offset:6144
    ds_read_b64_tr_b16 v[70:71], v50 offset:6400
    ds_read_b64_tr_b16 v[72:73], v50 offset:8192
    ds_read_b64_tr_b16 v[74:75], v50 offset:8448
    v_cvt_pk_bf16_f32 v112, v100, v101
    v_cvt_pk_bf16_f32 v113, v102, v103
    v_cvt_pk_bf16_f32 v114, v104, v105
    v_cvt_pk_bf16_f32 v115, v106, v107
    s_add_u32 s38, s37, 3072
    buffer_store_dwordx4 v[112:115], v58, s[16:19], s38 offen sc1
    s_waitcnt lgkmcnt(0)
    v_mfma_f32_16x16x32_bf16 v[92:95], v[60:63], v[32:35], 0
    v_mfma_f32_16x16x32_bf16 v[96:99], v[68:71], v[32:35], 0
    v_mfma_f32_16x16x32_bf16 v[92:95], v[64:67], v[36:39], v[92:95]
    v_mfma_f32_16x16x32_bf16 v[96:99], v[72:75], v[36:39], v[96:99]
    ds_read_b64_tr_b16 v[76:77], v51 offset:6144
    ds_read_b64_tr_b16 v[78:79], v53 offset:6144
    ds_read_b64_tr_b16 v[80:81], v51 offset:8192
    ds_read_b64_tr_b16 v[82:83], v53 offset:8192
    ds_read_b64_tr_b16 v[84:85], v52 offset:6144
    ds_read_b64_tr_b16 v[86:87], v54 offset:6144
    ds_read_b64_tr_b16 v[88:89], v52 offset:8192
    ds_read_b64_tr_b16 v[90:91], v54 offset:8192
    v_cvt_pk_bf16_f32 v108, v92, v93
    v_cvt_pk_bf16_f32 v109, v94, v95
    v_cvt_pk_bf16_f32 v110, v96, v97
    v_cvt_pk_bf16_f32 v111, v98, v99
    s_add_u32 s38, s37, 4096
    buffer_store_dwordx4 v[108:111], v58, s[16:19], s38 offen sc1
    s_waitcnt lgkmcnt(0)
    v_mfma_f32_16x16x32_bf16 v[100:103], v[76:79], v[32:35], 0
    v_mfma_f32_16x16x32_bf16 v[104:107], v[84:87], v[32:35], 0
    v_mfma_f32_16x16x32_bf16 v[100:103], v[80:83], v[36:39], v[100:103]
    v_mfma_f32_16x16x32_bf16 v[104:107], v[88:91], v[36:39], v[104:107]
    s_nop 7
    v_cvt_pk_bf16_f32 v112, v100, v101
    v_cvt_pk_bf16_f32 v113, v102, v103
    v_cvt_pk_bf16_f32 v114, v104, v105
    v_cvt_pk_bf16_f32 v115, v106, v107
    s_add_u32 s38, s37, 5120
    buffer_store_dwordx4 v[112:115], v58, s[16:19], s38 offen sc1
    s_endpgm
L_mid_kernel_g:
    s_sub_u32 s3, s2, 448
    s_load_dwordx2 s[4:5], s[0:1], 16
    s_load_dwordx2 s[6:7], s[0:1], 72
    s_lshr_b32 s24, s3, 4
    s_bfe_u32 s25, s3, 0x20002
    s_and_b32 s26, s3, 3
    s_lshr_b32 s27, s24, 3
    s_and_b32 s28, s24, 7
    v_and_b32 v1, 63, v0
    v_lshrrev_b32 v2, 3, v1
    v_mov_b32 v3, v2
    s_lshl_b32 s29, s25, 3
    s_lshl_b32 s30, s28, 5
    s_add_u32 s29, s29, s30
    v_add_u32 v3, s29, v3
    v_lshlrev_b32 v3, 9, v3
    v_and_b32 v4, 7, v1
    s_lshr_b32 s30, s20, 1
    s_lshl_b32 s30, s30, 2
    v_xor_b32 v4, s30, v4
    v_lshl_add_u32 v3, v4, 4, v3
    s_lshl_b32 s30, s26, 7
    v_add_u32 v3, s30, v3
    v_xor_b32 v4, 32, v3
    s_waitcnt lgkmcnt(0)
    s_mov_b32 s8, s4
    s_mov_b32 s9, s5
    s_mov_b32 s10, 4063232
    s_mov_b32 s11, 0x00020000
    s_add_u32 s12, s6, 60891136
    s_addc_u32 s13, s7, 0
    s_mov_b32 s14, 16916480
    s_mov_b32 s15, 0x00020000
    s_lshl_b32 s30, s20, 3
    s_add_u32 s30, s30, s27
    s_lshl_b32 s30, s30, 17
    s_mul_i32 s31, s20, 4608
    s_add_u32 m0, s31, 0
    s_add_u32 s32, s30, 0
    buffer_load_dwordx4 v3, s[8:11], s32 offen lds
    s_add_u32 m0, s31, 1152
    s_add_u32 s32, s30, 262144
    buffer_load_dwordx4 v3, s[8:11], s32 offen lds
    s_add_u32 m0, s31, 2304
    s_add_u32 s32, s30, 524288
    buffer_load_dwordx4 v4, s[8:11], s32 offen lds
    s_add_u32 m0, s31, 3456
    s_add_u32 s32, s30, 786432
    buffer_load_dwordx4 v4, s[8:11], s32 offen lds
    v_and_b32 v8, 15, v1
    v_or_b32 v9, 1, v8
    s_lshl_b32 s33, s20, 4
    v_add_u32 v9, s33, v9
    v_cvt_f32_u32 v9, v9
    v_mul_f32 v9, 0x3c000000, v9
    v_bfe_u32 v10, v1, 4, 1
    v_lshlrev_b32 v10, 3, v10
    v_cvt_f32_u32 v10, v10
    v_and_b32 v8, 1, v8
    v_cvt_f32_u32 v8, v8
    v_mul_f32 v8, 0x3f400000, v8
    v_fma_f32 v11, v9, v10, v8
    v_fract_f32 v12, v11
    v_add_f32 v11, v11, v9
    v_fract_f32 v13, v11
    v_add_f32 v11, v11, v9
    v_fract_f32 v14, v11
    v_add_f32 v11, v11, v9
    v_fract_f32 v15, v11
    v_add_f32 v11, v11, v9
    v_fract_f32 v16, v11
    v_add_f32 v11, v11, v9
    v_fract_f32 v17, v11
    v_add_f32 v11, v11, v9
    v_fract_f32 v18, v11
    v_add_f32 v11, v11, v9
    v_fract_f32 v19, v11
    v_cos_f32 v12, v12
    v_cos_f32 v13, v13
    v_cos_f32 v14, v14
    v_cos_f32 v15, v15
    v_cos_f32 v16, v16
    v_cos_f32 v17, v17
    v_cos_f32 v18, v18
    v_cos_f32 v19, v19
    s_nop 0
    v_mul_f32 v12, 0x3d000000, v12
    v_mul_f32 v13, 0x3d000000, v13
    v_mul_f32 v14, 0x3d000000, v14
    v_mul_f32 v15, 0x3d000000, v15
    v_mul_f32 v16, 0x3d000000, v16
    v_mul_f32 v17, 0x3d000000, v17
    v_mul_f32 v18, 0x3d000000, v18
    v_mul_f32 v19, 0x3d000000, v19
    v_cvt_pk_bf16_f32 v20, v12, v13
    v_cvt_pk_bf16_f32 v21, v14, v15
    v_cvt_pk_bf16_f32 v22, v16, v17
    v_cvt_pk_bf16_f32 v23, v18, v19
    v_lshlrev_b32 v28, 16, v20
    v_and_b32 v29, 0xffff0000, v20
    v_sub_f32 v28, v12, v28
    v_sub_f32 v29, v13, v29
    v_cvt_pk_bf16_f32 v24, v28, v29
    v_lshlrev_b32 v28, 16, v21
    v_and_b32 v29, 0xffff0000, v21
    v_sub_f32 v28, v14, v28
    v_sub_f32 v29, v15, v29
    v_cvt_pk_bf16_f32 v25, v28, v29
    v_lshlrev_b32 v28, 16, v22
    v_and_b32 v29, 0xffff0000, v22
    v_sub_f32 v28, v16, v28
    v_sub_f32 v29, v17, v29
    v_cvt_pk_bf16_f32 v26, v28, v29
    v_lshlrev_b32 v28, 16, v23
    v_and_b32 v29, 0xffff0000, v23
    v_sub_f32 v28, v18, v28
    v_sub_f32 v29, v19, v29
    v_cvt_pk_bf16_f32 v27, v28, v29
    v_cmp_gt_u32 vcc, 32, v1
    s_nop 1
    v_cndmask_b32 v20, v24, v20, vcc
    v_cndmask_b32 v21, v25, v21, vcc
    v_cndmask_b32 v22, v26, v22, vcc
    v_cndmask_b32 v23, v27, v23, vcc
    v_lshlrev_b32 v28, 4, v1
    s_lshl_b32 s33, s20, 10
    v_add_u32 v29, s33, v28
    ds_write_b128 v29, v[20:23] offset:18432
    v_bfe_u32 v30, v1, 2, 2
    v_bfe_u32 v31, v1, 4, 1
    v_lshl_add_u32 v32, v31, 3, v30
    v_mul_u32_u24 v32, 1152, v32
    v_lshrrev_b32 v30, 1, v30
    v_lshl_add_u32 v30, v31, 1, v30
    v_lshlrev_b32 v30, 1, v30
    v_bfe_u32 v31, v1, 1, 1
    s_lshl_b32 s33, s20, 1
    v_add_u32 v31, s33, v31
    v_xor_b32 v30, v30, v31
    v_lshl_add_u32 v32, v30, 4, v32
    v_and_b32 v30, 1, v1
    v_lshl_add_u32 v32, v30, 3, v32
    v_lshrrev_b32 v30, 4, v1
    s_mov_b32 s33, 1057280
    v_mul_lo_u32 v30, v30, s33
    v_and_b32 v31, 15, v1
    v_lshl_add_u32 v33, v31, 4, v30
    s_lshl_b32 s34, s24, 15
    s_lshl_b32 s35, s26, 2
    s_add_u32 s35, s35, s20
    s_lshl_b32 s35, s35, 11
    s_add_u32 s34, s34, s35
    s_lshl_b32 s35, s25, 8
    s_add_u32 s34, s34, s35
    s_waitcnt vmcnt(0) lgkmcnt(0)
    s_barrier
    ds_read_b128 v[36:39], v28 offset:18432
    ds_read_b128 v[40:43], v28 offset:19456
    ds_read_b128 v[44:47], v28 offset:20480
    ds_read_b128 v[48:51], v28 offset:21504
    ds_read_b64_tr_b16 v[52:53], v32 offset:0
    ds_read_b64_tr_b16 v[54:55], v32 offset:4608
    ds_read_b64_tr_b16 v[56:57], v32 offset:128
    ds_read_b64_tr_b16 v[58:59], v32 offset:4736
    ds_read_b64_tr_b16 v[60:61], v32 offset:256
    ds_read_b64_tr_b16 v[62:63], v32 offset:4864
    ds_read_b64_tr_b16 v[64:65], v32 offset:384
    ds_read_b64_tr_b16 v[66:67], v32 offset:4992
    ds_read_b64_tr_b16 v[68:69], v32 offset:512
    ds_read_b64_tr_b16 v[70:71], v32 offset:5120
    s_waitcnt lgkmcnt(8)
    ds_read_b64_tr_b16 v[72:73], v32 offset:640
    ds_read_b64_tr_b16 v[74:75], v32 offset:5248
    ds_read_b64_tr_b16 v[76:77], v32 offset:768
    ds_read_b64_tr_b16 v[78:79], v32 offset:5376
    ds_read_b64_tr_b16 v[80:81], v32 offset:896
    ds_read_b64_tr_b16 v[82:83], v32 offset:5504
    s_waitcnt lgkmcnt(0)
    v_mfma_f32_16x16x32_bf16 v[84:87], v[36:39], v[52:55], 0
    v_mfma_f32_16x16x32_bf16 v[88:91], v[36:39], v[56:59], 0
    v_mfma_f32_16x16x32_bf16 v[92:95], v[36:39], v[60:63], 0
    v_mfma_f32_16x16x32_bf16 v[96:99], v[36:39], v[64:67], 0
    v_mfma_f32_16x16x32_bf16 v[100:103], v[36:39], v[68:71], 0
    v_mfma_f32_16x16x32_bf16 v[104:107], v[36:39], v[72:75], 0
    v_mfma_f32_16x16x32_bf16 v[108:111], v[36:39], v[76:79], 0
    v_mfma_f32_16x16x32_bf16 v[112:115], v[36:39], v[80:83], 0
    s_nop 7
    v_cvt_pk_bf16_f32 v116, v84, v88
    v_cvt_pk_bf16_f32 v117, v92, v96
    v_cvt_pk_bf16_f32 v118, v100, v104
    v_cvt_pk_bf16_f32 v119, v108, v112
    s_add_u32 s35, s34, 0
    buffer_store_dwordx4 v[116:119], v33, s[12:15], s35 offen sc1
    s_nop 1
    v_cvt_pk_bf16_f32 v120, v85, v89
    v_cvt_pk_bf16_f32 v121, v93, v97
    v_cvt_pk_bf16_f32 v122, v101, v105
    v_cvt_pk_bf16_f32 v123, v109, v113
    s_add_u32 s35, s34, 1024
    buffer_store_dwordx4 v[120:123], v33, s[12:15], s35 offen sc1
    s_nop 1
    v_cvt_pk_bf16_f32 v116, v86, v90
    v_cvt_pk_bf16_f32 v117, v94, v98
    v_cvt_pk_bf16_f32 v118, v102, v106
    v_cvt_pk_bf16_f32 v119, v110, v114
    s_add_u32 s35, s34, 528640
    buffer_store_dwordx4 v[116:119], v33, s[12:15], s35 offen sc1
    s_nop 1
    v_cvt_pk_bf16_f32 v120, v87, v91
    v_cvt_pk_bf16_f32 v121, v95, v99
    v_cvt_pk_bf16_f32 v122, v103, v107
    v_cvt_pk_bf16_f32 v123, v111, v115
    s_add_u32 s35, s34, 529664
    buffer_store_dwordx4 v[120:123], v33, s[12:15], s35 offen sc1
    s_nop 1
    v_mfma_f32_16x16x32_bf16 v[84:87], v[40:43], v[52:55], 0
    v_mfma_f32_16x16x32_bf16 v[88:91], v[40:43], v[56:59], 0
    v_mfma_f32_16x16x32_bf16 v[92:95], v[40:43], v[60:63], 0
    v_mfma_f32_16x16x32_bf16 v[96:99], v[40:43], v[64:67], 0
    v_mfma_f32_16x16x32_bf16 v[100:103], v[40:43], v[68:71], 0
    v_mfma_f32_16x16x32_bf16 v[104:107], v[40:43], v[72:75], 0
    v_mfma_f32_16x16x32_bf16 v[108:111], v[40:43], v[76:79], 0
    v_mfma_f32_16x16x32_bf16 v[112:115], v[40:43], v[80:83], 0
    s_nop 7
    v_cvt_pk_bf16_f32 v116, v84, v88
    v_cvt_pk_bf16_f32 v117, v92, v96
    v_cvt_pk_bf16_f32 v118, v100, v104
    v_cvt_pk_bf16_f32 v119, v108, v112
    s_add_u32 s35, s34, 4229120
    buffer_store_dwordx4 v[116:119], v33, s[12:15], s35 offen sc1
    s_nop 1
    v_cvt_pk_bf16_f32 v120, v85, v89
    v_cvt_pk_bf16_f32 v121, v93, v97
    v_cvt_pk_bf16_f32 v122, v101, v105
    v_cvt_pk_bf16_f32 v123, v109, v113
    s_add_u32 s35, s34, 4230144
    buffer_store_dwordx4 v[120:123], v33, s[12:15], s35 offen sc1
    s_nop 1
    v_cvt_pk_bf16_f32 v116, v86, v90
    v_cvt_pk_bf16_f32 v117, v94, v98
    v_cvt_pk_bf16_f32 v118, v102, v106
    v_cvt_pk_bf16_f32 v119, v110, v114
    s_add_u32 s35, s34, 4757760
    buffer_store_dwordx4 v[116:119], v33, s[12:15], s35 offen sc1
    s_nop 1
    v_cvt_pk_bf16_f32 v120, v87, v91
    v_cvt_pk_bf16_f32 v121, v95, v99
    v_cvt_pk_bf16_f32 v122, v103, v107
    v_cvt_pk_bf16_f32 v123, v111, v115
    s_add_u32 s35, s34, 4758784
    buffer_store_dwordx4 v[120:123], v33, s[12:15], s35 offen sc1
    s_nop 1
    v_mfma_f32_16x16x32_bf16 v[84:87], v[44:47], v[52:55], 0
    v_mfma_f32_16x16x32_bf16 v[88:91], v[44:47], v[56:59], 0
    v_mfma_f32_16x16x32_bf16 v[92:95], v[44:47], v[60:63], 0
    v_mfma_f32_16x16x32_bf16 v[96:99], v[44:47], v[64:67], 0
    v_mfma_f32_16x16x32_bf16 v[100:103], v[44:47], v[68:71], 0
    v_mfma_f32_16x16x32_bf16 v[104:107], v[44:47], v[72:75], 0
    v_mfma_f32_16x16x32_bf16 v[108:111], v[44:47], v[76:79], 0
    v_mfma_f32_16x16x32_bf16 v[112:115], v[44:47], v[80:83], 0
    s_nop 7
    v_cvt_pk_bf16_f32 v116, v84, v88
    v_cvt_pk_bf16_f32 v117, v92, v96
    v_cvt_pk_bf16_f32 v118, v100, v104
    v_cvt_pk_bf16_f32 v119, v108, v112
    s_add_u32 s35, s34, 8458240
    buffer_store_dwordx4 v[116:119], v33, s[12:15], s35 offen sc1
    s_nop 1
    v_cvt_pk_bf16_f32 v120, v85, v89
    v_cvt_pk_bf16_f32 v121, v93, v97
    v_cvt_pk_bf16_f32 v122, v101, v105
    v_cvt_pk_bf16_f32 v123, v109, v113
    s_add_u32 s35, s34, 8459264
    buffer_store_dwordx4 v[120:123], v33, s[12:15], s35 offen sc1
    s_nop 1
    v_cvt_pk_bf16_f32 v116, v86, v90
    v_cvt_pk_bf16_f32 v117, v94, v98
    v_cvt_pk_bf16_f32 v118, v102, v106
    v_cvt_pk_bf16_f32 v119, v110, v114
    s_add_u32 s35, s34, 8986880
    buffer_store_dwordx4 v[116:119], v33, s[12:15], s35 offen sc1
    s_nop 1
    v_cvt_pk_bf16_f32 v120, v87, v91
    v_cvt_pk_bf16_f32 v121, v95, v99
    v_cvt_pk_bf16_f32 v122, v103, v107
    v_cvt_pk_bf16_f32 v123, v111, v115
    s_add_u32 s35, s34, 8987904
    buffer_store_dwordx4 v[120:123], v33, s[12:15], s35 offen sc1
    s_nop 1
    v_mfma_f32_16x16x32_bf16 v[84:87], v[48:51], v[52:55], 0
    v_mfma_f32_16x16x32_bf16 v[88:91], v[48:51], v[56:59], 0
    v_mfma_f32_16x16x32_bf16 v[92:95], v[48:51], v[60:63], 0
    v_mfma_f32_16x16x32_bf16 v[96:99], v[48:51], v[64:67], 0
    v_mfma_f32_16x16x32_bf16 v[100:103], v[48:51], v[68:71], 0
    v_mfma_f32_16x16x32_bf16 v[104:107], v[48:51], v[72:75], 0
    v_mfma_f32_16x16x32_bf16 v[108:111], v[48:51], v[76:79], 0
    v_mfma_f32_16x16x32_bf16 v[112:115], v[48:51], v[80:83], 0
    s_nop 7
    v_cvt_pk_bf16_f32 v116, v84, v88
    v_cvt_pk_bf16_f32 v117, v92, v96
    v_cvt_pk_bf16_f32 v118, v100, v104
    v_cvt_pk_bf16_f32 v119, v108, v112
    s_add_u32 s35, s34, 12687360
    buffer_store_dwordx4 v[116:119], v33, s[12:15], s35 offen sc1
    s_nop 1
    v_cvt_pk_bf16_f32 v120, v85, v89
    v_cvt_pk_bf16_f32 v121, v93, v97
    v_cvt_pk_bf16_f32 v122, v101, v105
    v_cvt_pk_bf16_f32 v123, v109, v113
    s_add_u32 s35, s34, 12688384
    buffer_store_dwordx4 v[120:123], v33, s[12:15], s35 offen sc1
    s_nop 1
    v_cvt_pk_bf16_f32 v116, v86, v90
    v_cvt_pk_bf16_f32 v117, v94, v98
    v_cvt_pk_bf16_f32 v118, v102, v106
    v_cvt_pk_bf16_f32 v119, v110, v114
    s_add_u32 s35, s34, 13216000
    buffer_store_dwordx4 v[116:119], v33, s[12:15], s35 offen sc1
    s_nop 1
    v_cvt_pk_bf16_f32 v120, v87, v91
    v_cvt_pk_bf16_f32 v121, v95, v99
    v_cvt_pk_bf16_f32 v122, v103, v107
    v_cvt_pk_bf16_f32 v123, v111, v115
    s_add_u32 s35, s34, 13217024
    buffer_store_dwordx4 v[120:123], v33, s[12:15], s35 offen sc1
    s_nop 1
    s_endpgm
L_mid_kernel_done:
    s_endpgm
.globl gemm2_kernel
.p2align 8
.type gemm2_kernel,@function
gemm2_kernel:
    s_cmp_ge_u32 s2, 256
    s_cbranch_scc1 L_gemm2_kernel_done
    s_load_dwordx2 s[4:5], s[0:1], 72
    v_readfirstlane_b32 s20, v0
    s_lshr_b32 s20, s20, 6
    s_and_b32 s24, s2, 7
    s_lshr_b32 s25, s2, 3
    s_lshr_b32 s26, s25, 3
    s_lshl_b32 s24, s24, 2
    s_add_u32 s21, s24, s26
    s_and_b32 s25, s25, 7
    s_lshr_b32 s26, s25, 2
    s_and_b32 s27, s25, 3
    s_mul_i32 s22, s26, 84
    s_sub_u32 s28, 168, s22
    s_min_u32 s28, s28, 84
    s_waitcnt lgkmcnt(0)
    s_mul_i32 s29, s21, 344064
    s_lshl_b32 s30, s22, 11
    s_add_u32 s29, s29, s30
    s_add_u32 s29, s29, 49815552
    s_add_u32 s8, s4, s29
    s_addc_u32 s9, s5, 0
    s_lshl_b32 s10, s28, 11
    s_mov_b32 s11, 0x00020000
    s_mul_i32 s29, s21, 528640
    s_mul_i32 s30, s27, 8192
    s_add_u32 s29, s29, s30
    s_add_u32 s29, s29, 60891136
    s_add_u32 s12, s4, s29
    s_addc_u32 s13, s5, 0
    s_mov_b32 s14, 499712
    s_mov_b32 s15, 0x00020000
    s_cmp_ge_u32 s20, 4
    s_cbranch_scc1 L_gemm2_kernel_loader
    s_lshl_b32 s29, s22, 15
    s_add_u32 s29, s29, 77807616
    s_add_u32 s16, s4, s29
    s_addc_u32 s17, s5, 0
    s_lshl_b32 s18, s28, 15
    s_mov_b32 s19, 0x00020000
    s_lshr_b32 s29, s20, 1
    s_and_b32 s30, s20, 1
    v_and_b32 v137, 15, v0
    v_bfe_u32 v138, v0, 4, 2
    v_and_b32 v139, 63, v0
    s_mul_i32 s31, s29, 6144
    v_and_b32 v140, 7, v137
    v_xor_b32 v140, v138, v140
    v_lshlrev_b32 v140, 4, v140
    v_lshl_add_u32 v140, v137, 7, v140
    v_add_u32 v140, s31, v140
    v_add_u32 v128, 0, v140
    v_xor_b32 v131, 64, v128
    v_add_u32 v129, 61440, v140
    v_xor_b32 v132, 64, v129
    v_add_u32 v130, 122880, v140
    v_xor_b32 v133, 64, v130
    s_mul_i32 s31, s30, 4096
    s_add_u32 s31, s31, 12288
    v_lshlrev_b32 v140, 4, v139
    v_add_u32 v140, s31, v140
    v_add_u32 v134, 0, v140
    v_add_u32 v135, 61440, v140
    v_add_u32 v136, 122880, v140
    s_mul_i32 s31, s29, 1572864
    v_lshlrev_b32 v141, 15, v137
    v_lshl_add_u32 v141, v138, 4, v141
    v_add_u32 v141, s31, v141
    s_mul_i32 s31, s27, 2
    s_mul_i32 s29, s30, 1
    s_add_u32 s31, s31, s29
    s_lshl_b32 s31, s31, 12
    s_lshl_b32 s29, s21, 7
    s_add_u32 s33, s31, s29
    s_mov_b32 s34, 0x80008000
    s_barrier
    ds_read_b128 v[48:51], v134 offset:0
    ds_read_b128 v[64:67], v128 offset:0
    ds_read_b128 v[72:75], v128 offset:2048
    ds_read_b128 v[80:83], v128 offset:4096
    ds_read_b128 v[56:59], v134 offset:2048
    ds_read_b128 v[68:71], v131 offset:0
    ds_read_b128 v[76:79], v131 offset:2048
    ds_read_b128 v[84:87], v131 offset:4096
    ds_read_b128 v[52:55], v134 offset:1024
    ds_read_b128 v[60:63], v134 offset:3072
    s_waitcnt lgkmcnt(0)
    s_barrier
    v_mfma_f32_16x16x32_bf16 v[0:3], v[48:51], v[64:67], 0
    ds_read_b128 v[88:91], v134 offset:20480
    v_mfma_f32_16x16x32_bf16 v[4:7], v[48:51], v[72:75], 0
    ds_read_b128 v[104:107], v128 offset:20480
    v_mfma_f32_16x16x32_bf16 v[8:11], v[48:51], v[80:83], 0
    ds_read_b128 v[112:115], v128 offset:22528
    v_mfma_f32_16x16x32_bf16 v[12:15], v[56:59], v[64:67], 0
    ds_read_b128 v[120:123], v128 offset:24576
    v_mfma_f32_16x16x32_bf16 v[16:19], v[56:59], v[72:75], 0
    ds_read_b128 v[96:99], v134 offset:22528
    v_mfma_f32_16x16x32_bf16 v[20:23], v[56:59], v[80:83], 0
    ds_read_b128 v[108:111], v131 offset:20480
    v_mfma_f32_16x16x32_bf16 v[24:27], v[48:51], v[68:71], 0
    ds_read_b128 v[116:119], v131 offset:22528
    v_mfma_f32_16x16x32_bf16 v[28:31], v[48:51], v[76:79], 0
    ds_read_b128 v[124:127], v131 offset:24576
    v_mfma_f32_16x16x32_bf16 v[32:35], v[48:51], v[84:87], 0
    ds_read_b128 v[92:95], v134 offset:21504
    v_mfma_f32_16x16x32_bf16 v[36:39], v[56:59], v[68:71], 0
    ds_read_b128 v[100:103], v134 offset:23552
    v_mfma_f32_16x16x32_bf16 v[40:43], v[56:59], v[76:79], 0
    v_mfma_f32_16x16x32_bf16 v[44:47], v[56:59], v[84:87], 0
    v_mfma_f32_16x16x32_bf16 v[24:27], v[52:55], v[64:67], v[24:27]
    v_xor_b32 v68, s34, v68
    v_xor_b32 v69, s34, v69
    v_mfma_f32_16x16x32_bf16 v[28:31], v[52:55], v[72:75], v[28:31]
    v_xor_b32 v70, s34, v70
    v_xor_b32 v71, s34, v71
    v_mfma_f32_16x16x32_bf16 v[32:35], v[52:55], v[80:83], v[32:35]
    v_xor_b32 v76, s34, v76
    v_xor_b32 v77, s34, v77
    v_mfma_f32_16x16x32_bf16 v[36:39], v[60:63], v[64:67], v[36:39]
    v_xor_b32 v78, s34, v78
    v_xor_b32 v79, s34, v79
    v_mfma_f32_16x16x32_bf16 v[40:43], v[60:63], v[72:75], v[40:43]
    v_xor_b32 v84, s34, v84
    v_xor_b32 v85, s34, v85
    v_mfma_f32_16x16x32_bf16 v[44:47], v[60:63], v[80:83], v[44:47]
    v_xor_b32 v86, s34, v86
    v_xor_b32 v87, s34, v87
    v_mfma_f32_16x16x32_bf16 v[0:3], v[52:55], v[68:71], v[0:3]
    v_mfma_f32_16x16x32_bf16 v[4:7], v[52:55], v[76:79], v[4:7]
    v_mfma_f32_16x16x32_bf16 v[8:11], v[52:55], v[84:87], v[8:11]
    s_waitcnt lgkmcnt(0)
    s_barrier
    v_mfma_f32_16x16x32_bf16 v[12:15], v[60:63], v[68:71], v[12:15]
    v_mfma_f32_16x16x32_bf16 v[16:19], v[60:63], v[76:79], v[16:19]
    v_mfma_f32_16x16x32_bf16 v[20:23], v[60:63], v[84:87], v[20:23]
    v_mfma_f32_16x16x32_bf16 v[0:3], v[88:91], v[104:107], v[0:3]
    ds_read_b128 v[48:51], v134 offset:40960
    v_mfma_f32_16x16x32_bf16 v[4:7], v[88:91], v[112:115], v[4:7]
    ds_read_b128 v[64:67], v128 offset:40960
    v_mfma_f32_16x16x32_bf16 v[8:11], v[88:91], v[120:123], v[8:11]
    ds_read_b128 v[72:75], v128 offset:43008
    v_mfma_f32_16x16x32_bf16 v[12:15], v[96:99], v[104:107], v[12:15]
    ds_read_b128 v[80:83], v128 offset:45056
    v_mfma_f32_16x16x32_bf16 v[16:19], v[96:99], v[112:115], v[16:19]
    ds_read_b128 v[56:59], v134 offset:43008
    v_mfma_f32_16x16x32_bf16 v[20:23], v[96:99], v[120:123], v[20:23]
    ds_read_b128 v[68:71], v131 offset:40960
    v_mfma_f32_16x16x32_bf16 v[24:27], v[88:91], v[108:111], v[24:27]
    ds_read_b128 v[76:79], v131 offset:43008
    v_mfma_f32_16x16x32_bf16 v[28:31], v[88:91], v[116:119], v[28:31]
    ds_read_b128 v[84:87], v131 offset:45056
    v_mfma_f32_16x16x32_bf16 v[32:35], v[88:91], v[124:127], v[32:35]
    ds_read_b128 v[52:55], v134 offset:41984
    v_mfma_f32_16x16x32_bf16 v[36:39], v[96:99], v[108:111], v[36:39]
    ds_read_b128 v[60:63], v134 offset:44032
    v_mfma_f32_16x16x32_bf16 v[40:43], v[96:99], v[116:119], v[40:43]
    v_mfma_f32_16x16x32_bf16 v[44:47], v[96:99], v[124:127], v[44:47]
    v_mfma_f32_16x16x32_bf16 v[24:27], v[92:95], v[104:107], v[24:27]
    v_xor_b32 v108, s34, v108
    v_xor_b32 v109, s34, v109
    v_mfma_f32_16x16x32_bf16 v[28:31], v[92:95], v[112:115], v[28:31]
    v_xor_b32 v110, s34, v110
    v_xor_b32 v111, s34, v111
    v_mfma_f32_16x16x32_bf16 v[32:35], v[92:95], v[120:123], v[32:35]
    v_xor_b32 v116, s34, v116
    v_xor_b32 v117, s34, v117
    v_mfma_f32_16x16x32_bf16 v[36:39], v[100:103], v[104:107], v[36:39]
    v_xor_b32 v118, s34, v118
    v_xor_b32 v119, s34, v119
    v_mfma_f32_16x16x32_bf16 v[40:43], v[100:103], v[112:115], v[40:43]
    v_xor_b32 v124, s34, v124
    v_xor_b32 v125, s34, v125
    v_mfma_f32_16x16x32_bf16 v[44:47], v[100:103], v[120:123], v[44:47]
    v_xor_b32 v126, s34, v126
    v_xor_b32 v127, s34, v127
    v_mfma_f32_16x16x32_bf16 v[0:3], v[92:95], v[108:111], v[0:3]
    v_mfma_f32_16x16x32_bf16 v[4:7], v[92:95], v[116:119], v[4:7]
    v_mfma_f32_16x16x32_bf16 v[8:11], v[92:95], v[124:127], v[8:11]
    s_waitcnt lgkmcnt(0)
    s_barrier
    v_mfma_f32_16x16x32_bf16 v[12:15], v[100:103], v[108:111], v[12:15]
    v_mfma_f32_16x16x32_bf16 v[16:19], v[100:103], v[116:119], v[16:19]
    v_mfma_f32_16x16x32_bf16 v[20:23], v[100:103], v[124:127], v[20:23]
    v_mfma_f32_16x16x32_bf16 v[0:3], v[48:51], v[64:67], v[0:3]
    ds_read_b128 v[88:91], v135 offset:0
    v_mfma_f32_16x16x32_bf16 v[4:7], v[48:51], v[72:75], v[4:7]
    ds_read_b128 v[104:107], v129 offset:0
    v_mfma_f32_16x16x32_bf16 v[8:11], v[48:51], v[80:83], v[8:11]
    ds_read_b128 v[112:115], v129 offset:2048
    v_mfma_f32_16x16x32_bf16 v[12:15], v[56:59], v[64:67], v[12:15]
    ds_read_b128 v[120:123], v129 offset:4096
    v_mfma_f32_16x16x32_bf16 v[16:19], v[56:59], v[72:75], v[16:19]
    ds_read_b128 v[96:99], v135 offset:2048
    v_mfma_f32_16x16x32_bf16 v[20:23], v[56:59], v[80:83], v[20:23]
    ds_read_b128 v[108:111], v132 offset:0
    v_mfma_f32_16x16x32_bf16 v[24:27], v[48:51], v[68:71], v[24:27]
    ds_read_b128 v[116:119], v132 offset:2048
    v_mfma_f32_16x16x32_bf16 v[28:31], v[48:51], v[76:79], v[28:31]
    ds_read_b128 v[124:127], v132 offset:4096
    v_mfma_f32_16x16x32_bf16 v[32:35], v[48:51], v[84:87], v[32:35]
    ds_read_b128 v[92:95], v135 offset:1024
    v_mfma_f32_16x16x32_bf16 v[36:39], v[56:59], v[68:71], v[36:39]
    ds_read_b128 v[100:103], v135 offset:3072
    v_mfma_f32_16x16x32_bf16 v[40:43], v[56:59], v[76:79], v[40:43]
    v_mfma_f32_16x16x32_bf16 v[44:47], v[56:59], v[84:87], v[44:47]
    v_mfma_f32_16x16x32_bf16 v[24:27], v[52:55], v[64:67], v[24:27]
    v_xor_b32 v68, s34, v68
    v_xor_b32 v69, s34, v69
    v_mfma_f32_16x16x32_bf16 v[28:31], v[52:55], v[72:75], v[28:31]
    v_xor_b32 v70, s34, v70
    v_xor_b32 v71, s34, v71
    v_mfma_f32_16x16x32_bf16 v[32:35], v[52:55], v[80:83], v[32:35]
    v_xor_b32 v76, s34, v76
    v_xor_b32 v77, s34, v77
    v_mfma_f32_16x16x32_bf16 v[36:39], v[60:63], v[64:67], v[36:39]
    v_xor_b32 v78, s34, v78
    v_xor_b32 v79, s34, v79
    v_mfma_f32_16x16x32_bf16 v[40:43], v[60:63], v[72:75], v[40:43]
    v_xor_b32 v84, s34, v84
    v_xor_b32 v85, s34, v85
    v_mfma_f32_16x16x32_bf16 v[44:47], v[60:63], v[80:83], v[44:47]
    v_xor_b32 v86, s34, v86
    v_xor_b32 v87, s34, v87
    v_mfma_f32_16x16x32_bf16 v[0:3], v[52:55], v[68:71], v[0:3]
    v_mfma_f32_16x16x32_bf16 v[4:7], v[52:55], v[76:79], v[4:7]
    v_mfma_f32_16x16x32_bf16 v[8:11], v[52:55], v[84:87], v[8:11]
    s_waitcnt lgkmcnt(0)
    s_barrier
    v_mfma_f32_16x16x32_bf16 v[12:15], v[60:63], v[68:71], v[12:15]
    v_mfma_f32_16x16x32_bf16 v[16:19], v[60:63], v[76:79], v[16:19]
    v_mfma_f32_16x16x32_bf16 v[20:23], v[60:63], v[84:87], v[20:23]
    v_mfma_f32_16x16x32_bf16 v[0:3], v[88:91], v[104:107], v[0:3]
    ds_read_b128 v[48:51], v135 offset:20480
    v_mfma_f32_16x16x32_bf16 v[4:7], v[88:91], v[112:115], v[4:7]
    ds_read_b128 v[64:67], v129 offset:20480
    v_mfma_f32_16x16x32_bf16 v[8:11], v[88:91], v[120:123], v[8:11]
    ds_read_b128 v[72:75], v129 offset:22528
    v_mfma_f32_16x16x32_bf16 v[12:15], v[96:99], v[104:107], v[12:15]
    ds_read_b128 v[80:83], v129 offset:24576
    v_mfma_f32_16x16x32_bf16 v[16:19], v[96:99], v[112:115], v[16:19]
    ds_read_b128 v[56:59], v135 offset:22528
    v_mfma_f32_16x16x32_bf16 v[20:23], v[96:99], v[120:123], v[20:23]
    ds_read_b128 v[68:71], v132 offset:20480
    v_mfma_f32_16x16x32_bf16 v[24:27], v[88:91], v[108:111], v[24:27]
    ds_read_b128 v[76:79], v132 offset:22528
    v_mfma_f32_16x16x32_bf16 v[28:31], v[88:91], v[116:119], v[28:31]
    ds_read_b128 v[84:87], v132 offset:24576
    v_mfma_f32_16x16x32_bf16 v[32:35], v[88:91], v[124:127], v[32:35]
    ds_read_b128 v[52:55], v135 offset:21504
    v_mfma_f32_16x16x32_bf16 v[36:39], v[96:99], v[108:111], v[36:39]
    ds_read_b128 v[60:63], v135 offset:23552
    v_mfma_f32_16x16x32_bf16 v[40:43], v[96:99], v[116:119], v[40:43]
    v_mfma_f32_16x16x32_bf16 v[44:47], v[96:99], v[124:127], v[44:47]
    v_mfma_f32_16x16x32_bf16 v[24:27], v[92:95], v[104:107], v[24:27]
    v_xor_b32 v108, s34, v108
    v_xor_b32 v109, s34, v109
    v_mfma_f32_16x16x32_bf16 v[28:31], v[92:95], v[112:115], v[28:31]
    v_xor_b32 v110, s34, v110
    v_xor_b32 v111, s34, v111
    v_mfma_f32_16x16x32_bf16 v[32:35], v[92:95], v[120:123], v[32:35]
    v_xor_b32 v116, s34, v116
    v_xor_b32 v117, s34, v117
    v_mfma_f32_16x16x32_bf16 v[36:39], v[100:103], v[104:107], v[36:39]
    v_xor_b32 v118, s34, v118
    v_xor_b32 v119, s34, v119
    v_mfma_f32_16x16x32_bf16 v[40:43], v[100:103], v[112:115], v[40:43]
    v_xor_b32 v124, s34, v124
    v_xor_b32 v125, s34, v125
    v_mfma_f32_16x16x32_bf16 v[44:47], v[100:103], v[120:123], v[44:47]
    v_xor_b32 v126, s34, v126
    v_xor_b32 v127, s34, v127
    v_mfma_f32_16x16x32_bf16 v[0:3], v[92:95], v[108:111], v[0:3]
    v_mfma_f32_16x16x32_bf16 v[4:7], v[92:95], v[116:119], v[4:7]
    v_mfma_f32_16x16x32_bf16 v[8:11], v[92:95], v[124:127], v[8:11]
    s_waitcnt lgkmcnt(0)
    s_barrier
    v_mfma_f32_16x16x32_bf16 v[12:15], v[100:103], v[108:111], v[12:15]
    v_mfma_f32_16x16x32_bf16 v[16:19], v[100:103], v[116:119], v[16:19]
    v_mfma_f32_16x16x32_bf16 v[20:23], v[100:103], v[124:127], v[20:23]
    v_mfma_f32_16x16x32_bf16 v[0:3], v[48:51], v[64:67], v[0:3]
    ds_read_b128 v[88:91], v135 offset:40960
    v_mfma_f32_16x16x32_bf16 v[4:7], v[48:51], v[72:75], v[4:7]
    ds_read_b128 v[104:107], v129 offset:40960
    v_mfma_f32_16x16x32_bf16 v[8:11], v[48:51], v[80:83], v[8:11]
    ds_read_b128 v[112:115], v129 offset:43008
    v_mfma_f32_16x16x32_bf16 v[12:15], v[56:59], v[64:67], v[12:15]
    ds_read_b128 v[120:123], v129 offset:45056
    v_mfma_f32_16x16x32_bf16 v[16:19], v[56:59], v[72:75], v[16:19]
    ds_read_b128 v[96:99], v135 offset:43008
    v_mfma_f32_16x16x32_bf16 v[20:23], v[56:59], v[80:83], v[20:23]
    ds_read_b128 v[108:111], v132 offset:40960
    v_mfma_f32_16x16x32_bf16 v[24:27], v[48:51], v[68:71], v[24:27]
    ds_read_b128 v[116:119], v132 offset:43008
    v_mfma_f32_16x16x32_bf16 v[28:31], v[48:51], v[76:79], v[28:31]
    ds_read_b128 v[124:127], v132 offset:45056
    v_mfma_f32_16x16x32_bf16 v[32:35], v[48:51], v[84:87], v[32:35]
    ds_read_b128 v[92:95], v135 offset:41984
    v_mfma_f32_16x16x32_bf16 v[36:39], v[56:59], v[68:71], v[36:39]
    ds_read_b128 v[100:103], v135 offset:44032
    v_mfma_f32_16x16x32_bf16 v[40:43], v[56:59], v[76:79], v[40:43]
    v_mfma_f32_16x16x32_bf16 v[44:47], v[56:59], v[84:87], v[44:47]
    v_mfma_f32_16x16x32_bf16 v[24:27], v[52:55], v[64:67], v[24:27]
    v_xor_b32 v68, s34, v68
    v_xor_b32 v69, s34, v69
    v_mfma_f32_16x16x32_bf16 v[28:31], v[52:55], v[72:75], v[28:31]
    v_xor_b32 v70, s34, v70
    v_xor_b32 v71, s34, v71
    v_mfma_f32_16x16x32_bf16 v[32:35], v[52:55], v[80:83], v[32:35]
    v_xor_b32 v76, s34, v76
    v_xor_b32 v77, s34, v77
    v_mfma_f32_16x16x32_bf16 v[36:39], v[60:63], v[64:67], v[36:39]
    v_xor_b32 v78, s34, v78
    v_xor_b32 v79, s34, v79
    v_mfma_f32_16x16x32_bf16 v[40:43], v[60:63], v[72:75], v[40:43]
    v_xor_b32 v84, s34, v84
    v_xor_b32 v85, s34, v85
    v_mfma_f32_16x16x32_bf16 v[44:47], v[60:63], v[80:83], v[44:47]
    v_xor_b32 v86, s34, v86
    v_xor_b32 v87, s34, v87
    v_mfma_f32_16x16x32_bf16 v[0:3], v[52:55], v[68:71], v[0:3]
    v_mfma_f32_16x16x32_bf16 v[4:7], v[52:55], v[76:79], v[4:7]
    v_mfma_f32_16x16x32_bf16 v[8:11], v[52:55], v[84:87], v[8:11]
    s_waitcnt lgkmcnt(0)
    s_barrier
    v_mfma_f32_16x16x32_bf16 v[12:15], v[60:63], v[68:71], v[12:15]
    v_mfma_f32_16x16x32_bf16 v[16:19], v[60:63], v[76:79], v[16:19]
    v_mfma_f32_16x16x32_bf16 v[20:23], v[60:63], v[84:87], v[20:23]
    v_mfma_f32_16x16x32_bf16 v[0:3], v[88:91], v[104:107], v[0:3]
    ds_read_b128 v[48:51], v136 offset:0
    v_mfma_f32_16x16x32_bf16 v[4:7], v[88:91], v[112:115], v[4:7]
    ds_read_b128 v[64:67], v130 offset:0
    v_mfma_f32_16x16x32_bf16 v[8:11], v[88:91], v[120:123], v[8:11]
    ds_read_b128 v[72:75], v130 offset:2048
    v_mfma_f32_16x16x32_bf16 v[12:15], v[96:99], v[104:107], v[12:15]
    ds_read_b128 v[80:83], v130 offset:4096
    v_mfma_f32_16x16x32_bf16 v[16:19], v[96:99], v[112:115], v[16:19]
    ds_read_b128 v[56:59], v136 offset:2048
    v_mfma_f32_16x16x32_bf16 v[20:23], v[96:99], v[120:123], v[20:23]
    ds_read_b128 v[68:71], v133 offset:0
    v_mfma_f32_16x16x32_bf16 v[24:27], v[88:91], v[108:111], v[24:27]
    ds_read_b128 v[76:79], v133 offset:2048
    v_mfma_f32_16x16x32_bf16 v[28:31], v[88:91], v[116:119], v[28:31]
    ds_read_b128 v[84:87], v133 offset:4096
    v_mfma_f32_16x16x32_bf16 v[32:35], v[88:91], v[124:127], v[32:35]
    ds_read_b128 v[52:55], v136 offset:1024
    v_mfma_f32_16x16x32_bf16 v[36:39], v[96:99], v[108:111], v[36:39]
    ds_read_b128 v[60:63], v136 offset:3072
    v_mfma_f32_16x16x32_bf16 v[40:43], v[96:99], v[116:119], v[40:43]
    v_mfma_f32_16x16x32_bf16 v[44:47], v[96:99], v[124:127], v[44:47]
    v_mfma_f32_16x16x32_bf16 v[24:27], v[92:95], v[104:107], v[24:27]
    v_xor_b32 v108, s34, v108
    v_xor_b32 v109, s34, v109
    v_mfma_f32_16x16x32_bf16 v[28:31], v[92:95], v[112:115], v[28:31]
    v_xor_b32 v110, s34, v110
    v_xor_b32 v111, s34, v111
    v_mfma_f32_16x16x32_bf16 v[32:35], v[92:95], v[120:123], v[32:35]
    v_xor_b32 v116, s34, v116
    v_xor_b32 v117, s34, v117
    v_mfma_f32_16x16x32_bf16 v[36:39], v[100:103], v[104:107], v[36:39]
    v_xor_b32 v118, s34, v118
    v_xor_b32 v119, s34, v119
    v_mfma_f32_16x16x32_bf16 v[40:43], v[100:103], v[112:115], v[40:43]
    v_xor_b32 v124, s34, v124
    v_xor_b32 v125, s34, v125
    v_mfma_f32_16x16x32_bf16 v[44:47], v[100:103], v[120:123], v[44:47]
    v_xor_b32 v126, s34, v126
    v_xor_b32 v127, s34, v127
    v_mfma_f32_16x16x32_bf16 v[0:3], v[92:95], v[108:111], v[0:3]
    v_mfma_f32_16x16x32_bf16 v[4:7], v[92:95], v[116:119], v[4:7]
    v_mfma_f32_16x16x32_bf16 v[8:11], v[92:95], v[124:127], v[8:11]
    s_waitcnt lgkmcnt(0)
    s_barrier
    v_mfma_f32_16x16x32_bf16 v[12:15], v[100:103], v[108:111], v[12:15]
    v_mfma_f32_16x16x32_bf16 v[16:19], v[100:103], v[116:119], v[16:19]
    v_mfma_f32_16x16x32_bf16 v[20:23], v[100:103], v[124:127], v[20:23]
    v_mfma_f32_16x16x32_bf16 v[0:3], v[48:51], v[64:67], v[0:3]
    ds_read_b128 v[88:91], v134 offset:0
    v_mfma_f32_16x16x32_bf16 v[4:7], v[48:51], v[72:75], v[4:7]
    ds_read_b128 v[104:107], v128 offset:0
    v_mfma_f32_16x16x32_bf16 v[8:11], v[48:51], v[80:83], v[8:11]
    ds_read_b128 v[112:115], v128 offset:2048
    v_mfma_f32_16x16x32_bf16 v[12:15], v[56:59], v[64:67], v[12:15]
    ds_read_b128 v[120:123], v128 offset:4096
    v_mfma_f32_16x16x32_bf16 v[16:19], v[56:59], v[72:75], v[16:19]
    ds_read_b128 v[96:99], v134 offset:2048
    v_mfma_f32_16x16x32_bf16 v[20:23], v[56:59], v[80:83], v[20:23]
    ds_read_b128 v[108:111], v131 offset:0
    v_mfma_f32_16x16x32_bf16 v[24:27], v[48:51], v[68:71], v[24:27]
    ds_read_b128 v[116:119], v131 offset:2048
    v_mfma_f32_16x16x32_bf16 v[28:31], v[48:51], v[76:79], v[28:31]
    ds_read_b128 v[124:127], v131 offset:4096
    v_mfma_f32_16x16x32_bf16 v[32:35], v[48:51], v[84:87], v[32:35]
    ds_read_b128 v[92:95], v134 offset:1024
    v_mfma_f32_16x16x32_bf16 v[36:39], v[56:59], v[68:71], v[36:39]
    ds_read_b128 v[100:103], v134 offset:3072
    v_mfma_f32_16x16x32_bf16 v[40:43], v[56:59], v[76:79], v[40:43]
    v_mfma_f32_16x16x32_bf16 v[44:47], v[56:59], v[84:87], v[44:47]
    v_mfma_f32_16x16x32_bf16 v[24:27], v[52:55], v[64:67], v[24:27]
    v_xor_b32 v68, s34, v68
    v_xor_b32 v69, s34, v69
    v_mfma_f32_16x16x32_bf16 v[28:31], v[52:55], v[72:75], v[28:31]
    v_xor_b32 v70, s34, v70
    v_xor_b32 v71, s34, v71
    v_mfma_f32_16x16x32_bf16 v[32:35], v[52:55], v[80:83], v[32:35]
    v_xor_b32 v76, s34, v76
    v_xor_b32 v77, s34, v77
    v_mfma_f32_16x16x32_bf16 v[36:39], v[60:63], v[64:67], v[36:39]
    v_xor_b32 v78, s34, v78
    v_xor_b32 v79, s34, v79
    v_mfma_f32_16x16x32_bf16 v[40:43], v[60:63], v[72:75], v[40:43]
    v_xor_b32 v84, s34, v84
    v_xor_b32 v85, s34, v85
    v_mfma_f32_16x16x32_bf16 v[44:47], v[60:63], v[80:83], v[44:47]
    v_xor_b32 v86, s34, v86
    v_xor_b32 v87, s34, v87
    v_mfma_f32_16x16x32_bf16 v[0:3], v[52:55], v[68:71], v[0:3]
    v_mfma_f32_16x16x32_bf16 v[4:7], v[52:55], v[76:79], v[4:7]
    v_mfma_f32_16x16x32_bf16 v[8:11], v[52:55], v[84:87], v[8:11]
    s_waitcnt lgkmcnt(0)
    s_barrier
    v_mfma_f32_16x16x32_bf16 v[12:15], v[60:63], v[68:71], v[12:15]
    v_mfma_f32_16x16x32_bf16 v[16:19], v[60:63], v[76:79], v[16:19]
    v_mfma_f32_16x16x32_bf16 v[20:23], v[60:63], v[84:87], v[20:23]
    v_mfma_f32_16x16x32_bf16 v[0:3], v[88:91], v[104:107], v[0:3]
    ds_read_b128 v[48:51], v134 offset:20480
    v_mfma_f32_16x16x32_bf16 v[4:7], v[88:91], v[112:115], v[4:7]
    ds_read_b128 v[64:67], v128 offset:20480
    v_mfma_f32_16x16x32_bf16 v[8:11], v[88:91], v[120:123], v[8:11]
    ds_read_b128 v[72:75], v128 offset:22528
    v_mfma_f32_16x16x32_bf16 v[12:15], v[96:99], v[104:107], v[12:15]
    ds_read_b128 v[80:83], v128 offset:24576
    v_mfma_f32_16x16x32_bf16 v[16:19], v[96:99], v[112:115], v[16:19]
    ds_read_b128 v[56:59], v134 offset:22528
    v_mfma_f32_16x16x32_bf16 v[20:23], v[96:99], v[120:123], v[20:23]
    ds_read_b128 v[68:71], v131 offset:20480
    v_mfma_f32_16x16x32_bf16 v[24:27], v[88:91], v[108:111], v[24:27]
    ds_read_b128 v[76:79], v131 offset:22528
    v_mfma_f32_16x16x32_bf16 v[28:31], v[88:91], v[116:119], v[28:31]
    ds_read_b128 v[84:87], v131 offset:24576
    v_mfma_f32_16x16x32_bf16 v[32:35], v[88:91], v[124:127], v[32:35]
    ds_read_b128 v[52:55], v134 offset:21504
    v_mfma_f32_16x16x32_bf16 v[36:39], v[96:99], v[108:111], v[36:39]
    ds_read_b128 v[60:63], v134 offset:23552
    v_mfma_f32_16x16x32_bf16 v[40:43], v[96:99], v[116:119], v[40:43]
    v_mfma_f32_16x16x32_bf16 v[44:47], v[96:99], v[124:127], v[44:47]
    v_mfma_f32_16x16x32_bf16 v[24:27], v[92:95], v[104:107], v[24:27]
    v_xor_b32 v108, s34, v108
    v_xor_b32 v109, s34, v109
    v_mfma_f32_16x16x32_bf16 v[28:31], v[92:95], v[112:115], v[28:31]
    v_xor_b32 v110, s34, v110
    v_xor_b32 v111, s34, v111
    v_mfma_f32_16x16x32_bf16 v[32:35], v[92:95], v[120:123], v[32:35]
    v_xor_b32 v116, s34, v116
    v_xor_b32 v117, s34, v117
    v_mfma_f32_16x16x32_bf16 v[36:39], v[100:103], v[104:107], v[36:39]
    v_xor_b32 v118, s34, v118
    v_xor_b32 v119, s34, v119
    v_mfma_f32_16x16x32_bf16 v[40:43], v[100:103], v[112:115], v[40:43]
    v_xor_b32 v124, s34, v124
    v_xor_b32 v125, s34, v125
    v_mfma_f32_16x16x32_bf16 v[44:47], v[100:103], v[120:123], v[44:47]
    v_xor_b32 v126, s34, v126
    v_xor_b32 v127, s34, v127
    v_mfma_f32_16x16x32_bf16 v[0:3], v[92:95], v[108:111], v[0:3]
    v_mfma_f32_16x16x32_bf16 v[4:7], v[92:95], v[116:119], v[4:7]
    v_mfma_f32_16x16x32_bf16 v[8:11], v[92:95], v[124:127], v[8:11]
    s_waitcnt lgkmcnt(0)
    s_barrier
    v_mfma_f32_16x16x32_bf16 v[12:15], v[100:103], v[108:111], v[12:15]
    v_mfma_f32_16x16x32_bf16 v[16:19], v[100:103], v[116:119], v[16:19]
    v_mfma_f32_16x16x32_bf16 v[20:23], v[100:103], v[124:127], v[20:23]
    v_mfma_f32_16x16x32_bf16 v[0:3], v[48:51], v[64:67], v[0:3]
    ds_read_b128 v[88:91], v134 offset:40960
    v_mfma_f32_16x16x32_bf16 v[4:7], v[48:51], v[72:75], v[4:7]
    ds_read_b128 v[104:107], v128 offset:40960
    v_mfma_f32_16x16x32_bf16 v[8:11], v[48:51], v[80:83], v[8:11]
    ds_read_b128 v[112:115], v128 offset:43008
    v_mfma_f32_16x16x32_bf16 v[12:15], v[56:59], v[64:67], v[12:15]
    ds_read_b128 v[120:123], v128 offset:45056
    v_mfma_f32_16x16x32_bf16 v[16:19], v[56:59], v[72:75], v[16:19]
    ds_read_b128 v[96:99], v134 offset:43008
    v_mfma_f32_16x16x32_bf16 v[20:23], v[56:59], v[80:83], v[20:23]
    ds_read_b128 v[108:111], v131 offset:40960
    v_mfma_f32_16x16x32_bf16 v[24:27], v[48:51], v[68:71], v[24:27]
    ds_read_b128 v[116:119], v131 offset:43008
    v_mfma_f32_16x16x32_bf16 v[28:31], v[48:51], v[76:79], v[28:31]
    ds_read_b128 v[124:127], v131 offset:45056
    v_mfma_f32_16x16x32_bf16 v[32:35], v[48:51], v[84:87], v[32:35]
    ds_read_b128 v[92:95], v134 offset:41984
    v_mfma_f32_16x16x32_bf16 v[36:39], v[56:59], v[68:71], v[36:39]
    ds_read_b128 v[100:103], v134 offset:44032
    v_mfma_f32_16x16x32_bf16 v[40:43], v[56:59], v[76:79], v[40:43]
    v_mfma_f32_16x16x32_bf16 v[44:47], v[56:59], v[84:87], v[44:47]
    v_mfma_f32_16x16x32_bf16 v[24:27], v[52:55], v[64:67], v[24:27]
    v_xor_b32 v68, s34, v68
    v_xor_b32 v69, s34, v69
    v_mfma_f32_16x16x32_bf16 v[28:31], v[52:55], v[72:75], v[28:31]
    v_xor_b32 v70, s34, v70
    v_xor_b32 v71, s34, v71
    v_mfma_f32_16x16x32_bf16 v[32:35], v[52:55], v[80:83], v[32:35]
    v_xor_b32 v76, s34, v76
    v_xor_b32 v77, s34, v77
    v_mfma_f32_16x16x32_bf16 v[36:39], v[60:63], v[64:67], v[36:39]
    v_xor_b32 v78, s34, v78
    v_xor_b32 v79, s34, v79
    v_mfma_f32_16x16x32_bf16 v[40:43], v[60:63], v[72:75], v[40:43]
    v_xor_b32 v84, s34, v84
    v_xor_b32 v85, s34, v85
    v_mfma_f32_16x16x32_bf16 v[44:47], v[60:63], v[80:83], v[44:47]
    v_xor_b32 v86, s34, v86
    v_xor_b32 v87, s34, v87
    v_mfma_f32_16x16x32_bf16 v[0:3], v[52:55], v[68:71], v[0:3]
    v_mfma_f32_16x16x32_bf16 v[4:7], v[52:55], v[76:79], v[4:7]
    v_mfma_f32_16x16x32_bf16 v[8:11], v[52:55], v[84:87], v[8:11]
    s_waitcnt lgkmcnt(0)
    s_barrier
    v_mfma_f32_16x16x32_bf16 v[12:15], v[60:63], v[68:71], v[12:15]
    v_mfma_f32_16x16x32_bf16 v[16:19], v[60:63], v[76:79], v[16:19]
    v_mfma_f32_16x16x32_bf16 v[20:23], v[60:63], v[84:87], v[20:23]
    v_mfma_f32_16x16x32_bf16 v[0:3], v[88:91], v[104:107], v[0:3]
    ds_read_b128 v[48:51], v135 offset:0
    v_mfma_f32_16x16x32_bf16 v[4:7], v[88:91], v[112:115], v[4:7]
    ds_read_b128 v[64:67], v129 offset:0
    v_mfma_f32_16x16x32_bf16 v[8:11], v[88:91], v[120:123], v[8:11]
    ds_read_b128 v[72:75], v129 offset:2048
    v_mfma_f32_16x16x32_bf16 v[12:15], v[96:99], v[104:107], v[12:15]
    ds_read_b128 v[80:83], v129 offset:4096
    v_mfma_f32_16x16x32_bf16 v[16:19], v[96:99], v[112:115], v[16:19]
    ds_read_b128 v[56:59], v135 offset:2048
    v_mfma_f32_16x16x32_bf16 v[20:23], v[96:99], v[120:123], v[20:23]
    ds_read_b128 v[68:71], v132 offset:0
    v_mfma_f32_16x16x32_bf16 v[24:27], v[88:91], v[108:111], v[24:27]
    ds_read_b128 v[76:79], v132 offset:2048
    v_mfma_f32_16x16x32_bf16 v[28:31], v[88:91], v[116:119], v[28:31]
    ds_read_b128 v[84:87], v132 offset:4096
    v_mfma_f32_16x16x32_bf16 v[32:35], v[88:91], v[124:127], v[32:35]
    ds_read_b128 v[52:55], v135 offset:1024
    v_mfma_f32_16x16x32_bf16 v[36:39], v[96:99], v[108:111], v[36:39]
    ds_read_b128 v[60:63], v135 offset:3072
    v_mfma_f32_16x16x32_bf16 v[40:43], v[96:99], v[116:119], v[40:43]
    v_mfma_f32_16x16x32_bf16 v[44:47], v[96:99], v[124:127], v[44:47]
    v_mfma_f32_16x16x32_bf16 v[24:27], v[92:95], v[104:107], v[24:27]
    v_xor_b32 v108, s34, v108
    v_xor_b32 v109, s34, v109
    v_mfma_f32_16x16x32_bf16 v[28:31], v[92:95], v[112:115], v[28:31]
    v_xor_b32 v110, s34, v110
    v_xor_b32 v111, s34, v111
    v_mfma_f32_16x16x32_bf16 v[32:35], v[92:95], v[120:123], v[32:35]
    v_xor_b32 v116, s34, v116
    v_xor_b32 v117, s34, v117
    v_mfma_f32_16x16x32_bf16 v[36:39], v[100:103], v[104:107], v[36:39]
    v_xor_b32 v118, s34, v118
    v_xor_b32 v119, s34, v119
    v_mfma_f32_16x16x32_bf16 v[40:43], v[100:103], v[112:115], v[40:43]
    v_xor_b32 v124, s34, v124
    v_xor_b32 v125, s34, v125
    v_mfma_f32_16x16x32_bf16 v[44:47], v[100:103], v[120:123], v[44:47]
    v_xor_b32 v126, s34, v126
    v_xor_b32 v127, s34, v127
    v_mfma_f32_16x16x32_bf16 v[0:3], v[92:95], v[108:111], v[0:3]
    v_mfma_f32_16x16x32_bf16 v[4:7], v[92:95], v[116:119], v[4:7]
    v_mfma_f32_16x16x32_bf16 v[8:11], v[92:95], v[124:127], v[8:11]
    s_waitcnt lgkmcnt(0)
    s_barrier
    v_mfma_f32_16x16x32_bf16 v[12:15], v[100:103], v[108:111], v[12:15]
    v_mfma_f32_16x16x32_bf16 v[16:19], v[100:103], v[116:119], v[16:19]
    v_mfma_f32_16x16x32_bf16 v[20:23], v[100:103], v[124:127], v[20:23]
    v_mfma_f32_16x16x32_bf16 v[0:3], v[48:51], v[64:67], v[0:3]
    ds_read_b128 v[88:91], v135 offset:20480
    v_mfma_f32_16x16x32_bf16 v[4:7], v[48:51], v[72:75], v[4:7]
    ds_read_b128 v[104:107], v129 offset:20480
    v_mfma_f32_16x16x32_bf16 v[8:11], v[48:51], v[80:83], v[8:11]
    ds_read_b128 v[112:115], v129 offset:22528
    v_mfma_f32_16x16x32_bf16 v[12:15], v[56:59], v[64:67], v[12:15]
    ds_read_b128 v[120:123], v129 offset:24576
    v_mfma_f32_16x16x32_bf16 v[16:19], v[56:59], v[72:75], v[16:19]
    ds_read_b128 v[96:99], v135 offset:22528
    v_mfma_f32_16x16x32_bf16 v[20:23], v[56:59], v[80:83], v[20:23]
    ds_read_b128 v[108:111], v132 offset:20480
    v_mfma_f32_16x16x32_bf16 v[24:27], v[48:51], v[68:71], v[24:27]
    ds_read_b128 v[116:119], v132 offset:22528
    v_mfma_f32_16x16x32_bf16 v[28:31], v[48:51], v[76:79], v[28:31]
    ds_read_b128 v[124:127], v132 offset:24576
    v_mfma_f32_16x16x32_bf16 v[32:35], v[48:51], v[84:87], v[32:35]
    ds_read_b128 v[92:95], v135 offset:21504
    v_mfma_f32_16x16x32_bf16 v[36:39], v[56:59], v[68:71], v[36:39]
    ds_read_b128 v[100:103], v135 offset:23552
    v_mfma_f32_16x16x32_bf16 v[40:43], v[56:59], v[76:79], v[40:43]
    v_mfma_f32_16x16x32_bf16 v[44:47], v[56:59], v[84:87], v[44:47]
    v_mfma_f32_16x16x32_bf16 v[24:27], v[52:55], v[64:67], v[24:27]
    v_xor_b32 v68, s34, v68
    v_xor_b32 v69, s34, v69
    v_mfma_f32_16x16x32_bf16 v[28:31], v[52:55], v[72:75], v[28:31]
    v_xor_b32 v70, s34, v70
    v_xor_b32 v71, s34, v71
    v_mfma_f32_16x16x32_bf16 v[32:35], v[52:55], v[80:83], v[32:35]
    v_xor_b32 v76, s34, v76
    v_xor_b32 v77, s34, v77
    v_mfma_f32_16x16x32_bf16 v[36:39], v[60:63], v[64:67], v[36:39]
    v_xor_b32 v78, s34, v78
    v_xor_b32 v79, s34, v79
    v_mfma_f32_16x16x32_bf16 v[40:43], v[60:63], v[72:75], v[40:43]
    v_xor_b32 v84, s34, v84
    v_xor_b32 v85, s34, v85
    v_mfma_f32_16x16x32_bf16 v[44:47], v[60:63], v[80:83], v[44:47]
    v_xor_b32 v86, s34, v86
    v_xor_b32 v87, s34, v87
    v_mfma_f32_16x16x32_bf16 v[0:3], v[52:55], v[68:71], v[0:3]
    v_mfma_f32_16x16x32_bf16 v[4:7], v[52:55], v[76:79], v[4:7]
    v_mfma_f32_16x16x32_bf16 v[8:11], v[52:55], v[84:87], v[8:11]
    s_waitcnt lgkmcnt(0)
    s_barrier
    v_mfma_f32_16x16x32_bf16 v[12:15], v[60:63], v[68:71], v[12:15]
    v_mfma_f32_16x16x32_bf16 v[16:19], v[60:63], v[76:79], v[16:19]
    v_mfma_f32_16x16x32_bf16 v[20:23], v[60:63], v[84:87], v[20:23]
    v_mfma_f32_16x16x32_bf16 v[0:3], v[88:91], v[104:107], v[0:3]
    ds_read_b128 v[48:51], v135 offset:40960
    v_mfma_f32_16x16x32_bf16 v[4:7], v[88:91], v[112:115], v[4:7]
    ds_read_b128 v[64:67], v129 offset:40960
    v_mfma_f32_16x16x32_bf16 v[8:11], v[88:91], v[120:123], v[8:11]
    ds_read_b128 v[72:75], v129 offset:43008
    v_mfma_f32_16x16x32_bf16 v[12:15], v[96:99], v[104:107], v[12:15]
    ds_read_b128 v[80:83], v129 offset:45056
    v_mfma_f32_16x16x32_bf16 v[16:19], v[96:99], v[112:115], v[16:19]
    ds_read_b128 v[56:59], v135 offset:43008
    v_mfma_f32_16x16x32_bf16 v[20:23], v[96:99], v[120:123], v[20:23]
    ds_read_b128 v[68:71], v132 offset:40960
    v_mfma_f32_16x16x32_bf16 v[24:27], v[88:91], v[108:111], v[24:27]
    ds_read_b128 v[76:79], v132 offset:43008
    v_mfma_f32_16x16x32_bf16 v[28:31], v[88:91], v[116:119], v[28:31]
    ds_read_b128 v[84:87], v132 offset:45056
    v_mfma_f32_16x16x32_bf16 v[32:35], v[88:91], v[124:127], v[32:35]
    ds_read_b128 v[52:55], v135 offset:41984
    v_mfma_f32_16x16x32_bf16 v[36:39], v[96:99], v[108:111], v[36:39]
    ds_read_b128 v[60:63], v135 offset:44032
    v_mfma_f32_16x16x32_bf16 v[40:43], v[96:99], v[116:119], v[40:43]
    v_mfma_f32_16x16x32_bf16 v[44:47], v[96:99], v[124:127], v[44:47]
    v_mfma_f32_16x16x32_bf16 v[24:27], v[92:95], v[104:107], v[24:27]
    v_xor_b32 v108, s34, v108
    v_xor_b32 v109, s34, v109
    v_mfma_f32_16x16x32_bf16 v[28:31], v[92:95], v[112:115], v[28:31]
    v_xor_b32 v110, s34, v110
    v_xor_b32 v111, s34, v111
    v_mfma_f32_16x16x32_bf16 v[32:35], v[92:95], v[120:123], v[32:35]
    v_xor_b32 v116, s34, v116
    v_xor_b32 v117, s34, v117
    v_mfma_f32_16x16x32_bf16 v[36:39], v[100:103], v[104:107], v[36:39]
    v_xor_b32 v118, s34, v118
    v_xor_b32 v119, s34, v119
    v_mfma_f32_16x16x32_bf16 v[40:43], v[100:103], v[112:115], v[40:43]
    v_xor_b32 v124, s34, v124
    v_xor_b32 v125, s34, v125
    v_mfma_f32_16x16x32_bf16 v[44:47], v[100:103], v[120:123], v[44:47]
    v_xor_b32 v126, s34, v126
    v_xor_b32 v127, s34, v127
    v_mfma_f32_16x16x32_bf16 v[0:3], v[92:95], v[108:111], v[0:3]
    v_mfma_f32_16x16x32_bf16 v[4:7], v[92:95], v[116:119], v[4:7]
    v_mfma_f32_16x16x32_bf16 v[8:11], v[92:95], v[124:127], v[8:11]
    s_waitcnt lgkmcnt(0)
    s_barrier
    v_mfma_f32_16x16x32_bf16 v[12:15], v[100:103], v[108:111], v[12:15]
    v_mfma_f32_16x16x32_bf16 v[16:19], v[100:103], v[116:119], v[16:19]
    v_mfma_f32_16x16x32_bf16 v[20:23], v[100:103], v[124:127], v[20:23]
    v_mfma_f32_16x16x32_bf16 v[0:3], v[48:51], v[64:67], v[0:3]
    ds_read_b128 v[88:91], v136 offset:0
    v_mfma_f32_16x16x32_bf16 v[4:7], v[48:51], v[72:75], v[4:7]
    ds_read_b128 v[104:107], v130 offset:0
    v_mfma_f32_16x16x32_bf16 v[8:11], v[48:51], v[80:83], v[8:11]
    ds_read_b128 v[112:115], v130 offset:2048
    v_mfma_f32_16x16x32_bf16 v[12:15], v[56:59], v[64:67], v[12:15]
    ds_read_b128 v[120:123], v130 offset:4096
    v_mfma_f32_16x16x32_bf16 v[16:19], v[56:59], v[72:75], v[16:19]
    ds_read_b128 v[96:99], v136 offset:2048
    v_mfma_f32_16x16x32_bf16 v[20:23], v[56:59], v[80:83], v[20:23]
    ds_read_b128 v[108:111], v133 offset:0
    v_mfma_f32_16x16x32_bf16 v[24:27], v[48:51], v[68:71], v[24:27]
    ds_read_b128 v[116:119], v133 offset:2048
    v_mfma_f32_16x16x32_bf16 v[28:31], v[48:51], v[76:79], v[28:31]
    ds_read_b128 v[124:127], v133 offset:4096
    v_mfma_f32_16x16x32_bf16 v[32:35], v[48:51], v[84:87], v[32:35]
    ds_read_b128 v[92:95], v136 offset:1024
    v_mfma_f32_16x16x32_bf16 v[36:39], v[56:59], v[68:71], v[36:39]
    ds_read_b128 v[100:103], v136 offset:3072
    v_mfma_f32_16x16x32_bf16 v[40:43], v[56:59], v[76:79], v[40:43]
    v_mfma_f32_16x16x32_bf16 v[44:47], v[56:59], v[84:87], v[44:47]
    v_mfma_f32_16x16x32_bf16 v[24:27], v[52:55], v[64:67], v[24:27]
    v_xor_b32 v68, s34, v68
    v_xor_b32 v69, s34, v69
    v_mfma_f32_16x16x32_bf16 v[28:31], v[52:55], v[72:75], v[28:31]
    v_xor_b32 v70, s34, v70
    v_xor_b32 v71, s34, v71
    v_mfma_f32_16x16x32_bf16 v[32:35], v[52:55], v[80:83], v[32:35]
    v_xor_b32 v76, s34, v76
    v_xor_b32 v77, s34, v77
    v_mfma_f32_16x16x32_bf16 v[36:39], v[60:63], v[64:67], v[36:39]
    v_xor_b32 v78, s34, v78
    v_xor_b32 v79, s34, v79
    v_mfma_f32_16x16x32_bf16 v[40:43], v[60:63], v[72:75], v[40:43]
    v_xor_b32 v84, s34, v84
    v_xor_b32 v85, s34, v85
    v_mfma_f32_16x16x32_bf16 v[44:47], v[60:63], v[80:83], v[44:47]
    v_xor_b32 v86, s34, v86
    v_xor_b32 v87, s34, v87
    v_mfma_f32_16x16x32_bf16 v[0:3], v[52:55], v[68:71], v[0:3]
    v_mfma_f32_16x16x32_bf16 v[4:7], v[52:55], v[76:79], v[4:7]
    v_mfma_f32_16x16x32_bf16 v[8:11], v[52:55], v[84:87], v[8:11]
    s_waitcnt lgkmcnt(0)
    s_barrier
    v_mfma_f32_16x16x32_bf16 v[12:15], v[60:63], v[68:71], v[12:15]
    v_mfma_f32_16x16x32_bf16 v[16:19], v[60:63], v[76:79], v[16:19]
    v_mfma_f32_16x16x32_bf16 v[20:23], v[60:63], v[84:87], v[20:23]
    v_mfma_f32_16x16x32_bf16 v[0:3], v[88:91], v[104:107], v[0:3]
    ds_read_b128 v[48:51], v134 offset:0
    v_mfma_f32_16x16x32_bf16 v[4:7], v[88:91], v[112:115], v[4:7]
    ds_read_b128 v[64:67], v128 offset:0
    v_mfma_f32_16x16x32_bf16 v[8:11], v[88:91], v[120:123], v[8:11]
    ds_read_b128 v[72:75], v128 offset:2048
    v_mfma_f32_16x16x32_bf16 v[12:15], v[96:99], v[104:107], v[12:15]
    ds_read_b128 v[80:83], v128 offset:4096
    v_mfma_f32_16x16x32_bf16 v[16:19], v[96:99], v[112:115], v[16:19]
    ds_read_b128 v[56:59], v134 offset:2048
    v_mfma_f32_16x16x32_bf16 v[20:23], v[96:99], v[120:123], v[20:23]
    ds_read_b128 v[68:71], v131 offset:0
    v_mfma_f32_16x16x32_bf16 v[24:27], v[88:91], v[108:111], v[24:27]
    ds_read_b128 v[76:79], v131 offset:2048
    v_mfma_f32_16x16x32_bf16 v[28:31], v[88:91], v[116:119], v[28:31]
    ds_read_b128 v[84:87], v131 offset:4096
    v_mfma_f32_16x16x32_bf16 v[32:35], v[88:91], v[124:127], v[32:35]
    ds_read_b128 v[52:55], v134 offset:1024
    v_mfma_f32_16x16x32_bf16 v[36:39], v[96:99], v[108:111], v[36:39]
    ds_read_b128 v[60:63], v134 offset:3072
    v_mfma_f32_16x16x32_bf16 v[40:43], v[96:99], v[116:119], v[40:43]
    v_mfma_f32_16x16x32_bf16 v[44:47], v[96:99], v[124:127], v[44:47]
    v_mfma_f32_16x16x32_bf16 v[24:27], v[92:95], v[104:107], v[24:27]
    v_xor_b32 v108, s34, v108
    v_xor_b32 v109, s34, v109
    v_mfma_f32_16x16x32_bf16 v[28:31], v[92:95], v[112:115], v[28:31]
    v_xor_b32 v110, s34, v110
    v_xor_b32 v111, s34, v111
    v_mfma_f32_16x16x32_bf16 v[32:35], v[92:95], v[120:123], v[32:35]
    v_xor_b32 v116, s34, v116
    v_xor_b32 v117, s34, v117
    v_mfma_f32_16x16x32_bf16 v[36:39], v[100:103], v[104:107], v[36:39]
    v_xor_b32 v118, s34, v118
    v_xor_b32 v119, s34, v119
    v_mfma_f32_16x16x32_bf16 v[40:43], v[100:103], v[112:115], v[40:43]
    v_xor_b32 v124, s34, v124
    v_xor_b32 v125, s34, v125
    v_mfma_f32_16x16x32_bf16 v[44:47], v[100:103], v[120:123], v[44:47]
    v_xor_b32 v126, s34, v126
    v_xor_b32 v127, s34, v127
    v_mfma_f32_16x16x32_bf16 v[0:3], v[92:95], v[108:111], v[0:3]
    v_mfma_f32_16x16x32_bf16 v[4:7], v[92:95], v[116:119], v[4:7]
    v_mfma_f32_16x16x32_bf16 v[8:11], v[92:95], v[124:127], v[8:11]
    s_waitcnt lgkmcnt(0)
    s_barrier
    v_mfma_f32_16x16x32_bf16 v[12:15], v[100:103], v[108:111], v[12:15]
    v_mfma_f32_16x16x32_bf16 v[16:19], v[100:103], v[116:119], v[16:19]
    v_mfma_f32_16x16x32_bf16 v[20:23], v[100:103], v[124:127], v[20:23]
    v_mfma_f32_16x16x32_bf16 v[0:3], v[48:51], v[64:67], v[0:3]
    ds_read_b128 v[88:91], v134 offset:20480
    v_mfma_f32_16x16x32_bf16 v[4:7], v[48:51], v[72:75], v[4:7]
    ds_read_b128 v[104:107], v128 offset:20480
    v_mfma_f32_16x16x32_bf16 v[8:11], v[48:51], v[80:83], v[8:11]
    ds_read_b128 v[112:115], v128 offset:22528
    v_mfma_f32_16x16x32_bf16 v[12:15], v[56:59], v[64:67], v[12:15]
    ds_read_b128 v[120:123], v128 offset:24576
    v_mfma_f32_16x16x32_bf16 v[16:19], v[56:59], v[72:75], v[16:19]
    ds_read_b128 v[96:99], v134 offset:22528
    v_mfma_f32_16x16x32_bf16 v[20:23], v[56:59], v[80:83], v[20:23]
    ds_read_b128 v[108:111], v131 offset:20480
    v_mfma_f32_16x16x32_bf16 v[24:27], v[48:51], v[68:71], v[24:27]
    ds_read_b128 v[116:119], v131 offset:22528
    v_mfma_f32_16x16x32_bf16 v[28:31], v[48:51], v[76:79], v[28:31]
    ds_read_b128 v[124:127], v131 offset:24576
    v_mfma_f32_16x16x32_bf16 v[32:35], v[48:51], v[84:87], v[32:35]
    ds_read_b128 v[92:95], v134 offset:21504
    v_mfma_f32_16x16x32_bf16 v[36:39], v[56:59], v[68:71], v[36:39]
    ds_read_b128 v[100:103], v134 offset:23552
    v_mfma_f32_16x16x32_bf16 v[40:43], v[56:59], v[76:79], v[40:43]
    v_mfma_f32_16x16x32_bf16 v[44:47], v[56:59], v[84:87], v[44:47]
    v_mfma_f32_16x16x32_bf16 v[24:27], v[52:55], v[64:67], v[24:27]
    v_xor_b32 v68, s34, v68
    v_xor_b32 v69, s34, v69
    v_mfma_f32_16x16x32_bf16 v[28:31], v[52:55], v[72:75], v[28:31]
    v_xor_b32 v70, s34, v70
    v_xor_b32 v71, s34, v71
    v_mfma_f32_16x16x32_bf16 v[32:35], v[52:55], v[80:83], v[32:35]
    v_xor_b32 v76, s34, v76
    v_xor_b32 v77, s34, v77
    v_mfma_f32_16x16x32_bf16 v[36:39], v[60:63], v[64:67], v[36:39]
    v_xor_b32 v78, s34, v78
    v_xor_b32 v79, s34, v79
    v_mfma_f32_16x16x32_bf16 v[40:43], v[60:63], v[72:75], v[40:43]
    v_xor_b32 v84, s34, v84
    v_xor_b32 v85, s34, v85
    v_mfma_f32_16x16x32_bf16 v[44:47], v[60:63], v[80:83], v[44:47]
    v_xor_b32 v86, s34, v86
    v_xor_b32 v87, s34, v87
    v_mfma_f32_16x16x32_bf16 v[0:3], v[52:55], v[68:71], v[0:3]
    v_mfma_f32_16x16x32_bf16 v[4:7], v[52:55], v[76:79], v[4:7]
    v_mfma_f32_16x16x32_bf16 v[8:11], v[52:55], v[84:87], v[8:11]
    s_waitcnt lgkmcnt(0)
    v_mfma_f32_16x16x32_bf16 v[12:15], v[60:63], v[68:71], v[12:15]
    v_mfma_f32_16x16x32_bf16 v[16:19], v[60:63], v[76:79], v[16:19]
    v_mfma_f32_16x16x32_bf16 v[20:23], v[60:63], v[84:87], v[20:23]
    v_mfma_f32_16x16x32_bf16 v[0:3], v[88:91], v[104:107], v[0:3]
    v_mfma_f32_16x16x32_bf16 v[4:7], v[88:91], v[112:115], v[4:7]
    v_mfma_f32_16x16x32_bf16 v[8:11], v[88:91], v[120:123], v[8:11]
    v_mfma_f32_16x16x32_bf16 v[12:15], v[96:99], v[104:107], v[12:15]
    v_mfma_f32_16x16x32_bf16 v[16:19], v[96:99], v[112:115], v[16:19]
    v_mfma_f32_16x16x32_bf16 v[20:23], v[96:99], v[120:123], v[20:23]
    v_mfma_f32_16x16x32_bf16 v[24:27], v[88:91], v[108:111], v[24:27]
    v_mfma_f32_16x16x32_bf16 v[28:31], v[88:91], v[116:119], v[28:31]
    v_mfma_f32_16x16x32_bf16 v[32:35], v[88:91], v[124:127], v[32:35]
    v_mfma_f32_16x16x32_bf16 v[36:39], v[96:99], v[108:111], v[36:39]
    v_mfma_f32_16x16x32_bf16 v[40:43], v[96:99], v[116:119], v[40:43]
    v_mfma_f32_16x16x32_bf16 v[44:47], v[96:99], v[124:127], v[44:47]
    v_mfma_f32_16x16x32_bf16 v[24:27], v[92:95], v[104:107], v[24:27]
    v_xor_b32 v108, s34, v108
    v_xor_b32 v109, s34, v109
    v_mfma_f32_16x16x32_bf16 v[28:31], v[92:95], v[112:115], v[28:31]
    v_xor_b32 v110, s34, v110
    v_xor_b32 v111, s34, v111
    v_mfma_f32_16x16x32_bf16 v[32:35], v[92:95], v[120:123], v[32:35]
    v_xor_b32 v116, s34, v116
    v_xor_b32 v117, s34, v117
    v_mfma_f32_16x16x32_bf16 v[36:39], v[100:103], v[104:107], v[36:39]
    v_xor_b32 v118, s34, v118
    v_xor_b32 v119, s34, v119
    v_mfma_f32_16x16x32_bf16 v[40:43], v[100:103], v[112:115], v[40:43]
    v_xor_b32 v124, s34, v124
    v_xor_b32 v125, s34, v125
    v_mfma_f32_16x16x32_bf16 v[44:47], v[100:103], v[120:123], v[44:47]
    v_xor_b32 v126, s34, v126
    v_xor_b32 v127, s34, v127
    v_mfma_f32_16x16x32_bf16 v[0:3], v[92:95], v[108:111], v[0:3]
    v_mfma_f32_16x16x32_bf16 v[4:7], v[92:95], v[116:119], v[4:7]
    v_mfma_f32_16x16x32_bf16 v[8:11], v[92:95], v[124:127], v[8:11]
    v_mfma_f32_16x16x32_bf16 v[12:15], v[100:103], v[108:111], v[12:15]
    v_mfma_f32_16x16x32_bf16 v[16:19], v[100:103], v[116:119], v[16:19]
    v_mfma_f32_16x16x32_bf16 v[20:23], v[100:103], v[124:127], v[20:23]
    s_nop 7
    s_nop 7
    v_cvt_pk_bf16_f32 v48, v24, v25
    v_cvt_pk_bf16_f32 v49, v26, v27
    v_cvt_pk_bf16_f32 v50, v36, v37
    v_cvt_pk_bf16_f32 v51, v38, v39
    s_add_u32 s35, s33, 0
    buffer_store_dwordx4 v[48:51], v141, s[16:19], s35 offen offset:64 sc1
    v_cvt_pk_bf16_f32 v52, v28, v29
    v_cvt_pk_bf16_f32 v53, v30, v31
    v_cvt_pk_bf16_f32 v54, v40, v41
    v_cvt_pk_bf16_f32 v55, v42, v43
    s_add_u32 s35, s33, 524288
    buffer_store_dwordx4 v[52:55], v141, s[16:19], s35 offen offset:64 sc1
    v_cvt_pk_bf16_f32 v56, v32, v33
    v_cvt_pk_bf16_f32 v57, v34, v35
    v_cvt_pk_bf16_f32 v58, v44, v45
    v_cvt_pk_bf16_f32 v59, v46, v47
    s_add_u32 s35, s33, 1048576
    buffer_store_dwordx4 v[56:59], v141, s[16:19], s35 offen offset:64 sc1
    v_cvt_pk_bf16_f32 v60, v0, v1
    v_cvt_pk_bf16_f32 v61, v2, v3
    v_cvt_pk_bf16_f32 v62, v12, v13
    v_cvt_pk_bf16_f32 v63, v14, v15
    s_add_u32 s35, s33, 0
    buffer_store_dwordx4 v[60:63], v141, s[16:19], s35 offen offset:0 sc1
    v_cvt_pk_bf16_f32 v64, v4, v5
    v_cvt_pk_bf16_f32 v65, v6, v7
    v_cvt_pk_bf16_f32 v66, v16, v17
    v_cvt_pk_bf16_f32 v67, v18, v19
    s_add_u32 s35, s33, 524288
    buffer_store_dwordx4 v[64:67], v141, s[16:19], s35 offen offset:0 sc1
    v_cvt_pk_bf16_f32 v68, v8, v9
    v_cvt_pk_bf16_f32 v69, v10, v11
    v_cvt_pk_bf16_f32 v70, v20, v21
    v_cvt_pk_bf16_f32 v71, v22, v23
    s_add_u32 s35, s33, 1048576
    buffer_store_dwordx4 v[68:71], v141, s[16:19], s35 offen offset:0 sc1
    s_endpgm
L_gemm2_kernel_loader:
    s_sub_u32 s20, s20, 4
    v_and_b32 v3, 63, v0
    v_lshrrev_b32 v4, 3, v3
    v_and_b32 v5, 7, v3
    v_xor_b32 v5, v5, v4
    v_lshlrev_b32 v5, 4, v5
    v_lshl_add_u32 v1, v4, 11, v5
    v_lshlrev_b32 v2, 4, v3
    s_add_u32 s24, s20, 0
    s_lshl_b32 s40, s24, 10
    s_lshl_b32 s43, s24, 14
    s_add_u32 s24, s20, 4
    s_lshl_b32 s41, s24, 10
    s_lshl_b32 s44, s24, 14
    s_add_u32 s24, s20, 8
    s_lshl_b32 s42, s24, 10
    s_lshl_b32 s45, s24, 14
    s_mul_i32 s46, s20, 2048
    s_add_u32 s47, s46, 12288
    s_add_u32 m0, s40, 0
    s_add_u32 s24, s43, 0
    buffer_load_dwordx4 v1, s[8:11], s24 offen lds
    s_add_u32 m0, s41, 0
    s_add_u32 s24, s44, 0
    buffer_load_dwordx4 v1, s[8:11], s24 offen lds
    s_add_u32 m0, s42, 0
    s_add_u32 s24, s45, 0
    buffer_load_dwordx4 v1, s[8:11], s24 offen lds
    s_add_u32 m0, s47, 0
    s_add_u32 s24, s46, 0
    buffer_load_dwordx4 v2, s[12:15], s24 offen offset:0 lds
    buffer_load_dwordx4 v2, s[12:15], s24 offen offset:1024 lds
    s_add_u32 m0, s40, 20480
    s_add_u32 s24, s43, 128
    buffer_load_dwordx4 v1, s[8:11], s24 offen lds
    s_add_u32 m0, s41, 20480
    s_add_u32 s24, s44, 128
    buffer_load_dwordx4 v1, s[8:11], s24 offen lds
    s_add_u32 m0, s42, 20480
    s_add_u32 s24, s45, 128
    buffer_load_dwordx4 v1, s[8:11], s24 offen lds
    s_add_u32 m0, s47, 20480
    s_add_u32 s24, s46, 32768
    buffer_load_dwordx4 v2, s[12:15], s24 offen offset:0 lds
    buffer_load_dwordx4 v2, s[12:15], s24 offen offset:1024 lds
    s_add_u32 m0, s40, 40960
    s_add_u32 s24, s43, 256
    buffer_load_dwordx4 v1, s[8:11], s24 offen lds
    s_add_u32 m0, s41, 40960
    s_add_u32 s24, s44, 256
    buffer_load_dwordx4 v1, s[8:11], s24 offen lds
    s_add_u32 m0, s42, 40960
    s_add_u32 s24, s45, 256
    buffer_load_dwordx4 v1, s[8:11], s24 offen lds
    s_add_u32 m0, s47, 40960
    s_add_u32 s24, s46, 65536
    buffer_load_dwordx4 v2, s[12:15], s24 offen offset:0 lds
    buffer_load_dwordx4 v2, s[12:15], s24 offen offset:1024 lds
    s_add_u32 m0, s40, 61440
    s_add_u32 s24, s43, 384
    buffer_load_dwordx4 v1, s[8:11], s24 offen lds
    s_add_u32 m0, s41, 61440
    s_add_u32 s24, s44, 384
    buffer_load_dwordx4 v1, s[8:11], s24 offen lds
    s_add_u32 m0, s42, 61440
    s_add_u32 s24, s45, 384
    buffer_load_dwordx4 v1, s[8:11], s24 offen lds
    s_add_u32 m0, s47, 61440
    s_add_u32 s24, s46, 98304
    buffer_load_dwordx4 v2, s[12:15], s24 offen offset:0 lds
    buffer_load_dwordx4 v2, s[12:15], s24 offen offset:1024 lds
    s_add_u32 m0, s40, 81920
    s_add_u32 s24, s43, 512
    buffer_load_dwordx4 v1, s[8:11], s24 offen lds
    s_add_u32 m0, s41, 81920
    s_add_u32 s24, s44, 512
    buffer_load_dwordx4 v1, s[8:11], s24 offen lds
    s_add_u32 m0, s42, 81920
    s_add_u32 s24, s45, 512
    buffer_load_dwordx4 v1, s[8:11], s24 offen lds
    s_add_u32 m0, s47, 81920
    s_add_u32 s24, s46, 131072
    buffer_load_dwordx4 v2, s[12:15], s24 offen offset:0 lds
    buffer_load_dwordx4 v2, s[12:15], s24 offen offset:1024 lds
    s_add_u32 m0, s40, 102400
    s_add_u32 s24, s43, 640
    buffer_load_dwordx4 v1, s[8:11], s24 offen lds
    s_add_u32 m0, s41, 102400
    s_add_u32 s24, s44, 640
    buffer_load_dwordx4 v1, s[8:11], s24 offen lds
    s_add_u32 m0, s42, 102400
    s_add_u32 s24, s45, 640
    buffer_load_dwordx4 v1, s[8:11], s24 offen lds
    s_add_u32 m0, s47, 102400
    s_add_u32 s24, s46, 163840
    buffer_load_dwordx4 v2, s[12:15], s24 offen offset:0 lds
    buffer_load_dwordx4 v2, s[12:15], s24 offen offset:1024 lds
    s_add_u32 m0, s40, 122880
    s_add_u32 s24, s43, 768
    buffer_load_dwordx4 v1, s[8:11], s24 offen lds
    s_add_u32 m0, s41, 122880
    s_add_u32 s24, s44, 768
    buffer_load_dwordx4 v1, s[8:11], s24 offen lds
    s_add_u32 m0, s42, 122880
    s_add_u32 s24, s45, 768
    buffer_load_dwordx4 v1, s[8:11], s24 offen lds
    s_add_u32 m0, s47, 122880
    s_add_u32 s24, s46, 196608
    buffer_load_dwordx4 v2, s[12:15], s24 offen offset:0 lds
    buffer_load_dwordx4 v2, s[12:15], s24 offen offset:1024 lds
    s_waitcnt vmcnt(30)
    s_barrier
    s_waitcnt vmcnt(25)
    s_barrier
    s_add_u32 m0, s40, 0
    s_add_u32 s24, s43, 896
    buffer_load_dwordx4 v1, s[8:11], s24 offen lds
    s_add_u32 m0, s41, 0
    s_add_u32 s24, s44, 896
    buffer_load_dwordx4 v1, s[8:11], s24 offen lds
    s_add_u32 m0, s42, 0
    s_add_u32 s24, s45, 896
    buffer_load_dwordx4 v1, s[8:11], s24 offen lds
    s_add_u32 m0, s47, 0
    s_add_u32 s24, s46, 229376
    buffer_load_dwordx4 v2, s[12:15], s24 offen offset:0 lds
    buffer_load_dwordx4 v2, s[12:15], s24 offen offset:1024 lds
    s_waitcnt vmcnt(25)
    s_barrier
    s_add_u32 m0, s40, 20480
    s_add_u32 s24, s43, 1024
    buffer_load_dwordx4 v1, s[8:11], s24 offen lds
    s_add_u32 m0, s41, 20480
    s_add_u32 s24, s44, 1024
    buffer_load_dwordx4 v1, s[8:11], s24 offen lds
    s_add_u32 m0, s42, 20480
    s_add_u32 s24, s45, 1024
    buffer_load_dwordx4 v1, s[8:11], s24 offen lds
    s_add_u32 m0, s47, 20480
    s_add_u32 s24, s46, 262144
    buffer_load_dwordx4 v2, s[12:15], s24 offen offset:0 lds
    buffer_load_dwordx4 v2, s[12:15], s24 offen offset:1024 lds
    s_waitcnt vmcnt(25)
    s_barrier
    s_add_u32 m0, s40, 40960
    s_add_u32 s24, s43, 1152
    buffer_load_dwordx4 v1, s[8:11], s24 offen lds
    s_add_u32 m0, s41, 40960
    s_add_u32 s24, s44, 1152
    buffer_load_dwordx4 v1, s[8:11], s24 offen lds
    s_add_u32 m0, s42, 40960
    s_add_u32 s24, s45, 1152
    buffer_load_dwordx4 v1, s[8:11], s24 offen lds
    s_add_u32 m0, s47, 40960
    s_add_u32 s24, s46, 294912
    buffer_load_dwordx4 v2, s[12:15], s24 offen offset:0 lds
    buffer_load_dwordx4 v2, s[12:15], s24 offen offset:1024 lds
    s_waitcnt vmcnt(25)
    s_barrier
    s_add_u32 m0, s40, 61440
    s_add_u32 s24, s43, 1280
    buffer_load_dwordx4 v1, s[8:11], s24 offen lds
    s_add_u32 m0, s41, 61440
    s_add_u32 s24, s44, 1280
    buffer_load_dwordx4 v1, s[8:11], s24 offen lds
    s_add_u32 m0, s42, 61440
    s_add_u32 s24, s45, 1280
    buffer_load_dwordx4 v1, s[8:11], s24 offen lds
    s_add_u32 m0, s47, 61440
    s_add_u32 s24, s46, 327680
    buffer_load_dwordx4 v2, s[12:15], s24 offen offset:0 lds
    buffer_load_dwordx4 v2, s[12:15], s24 offen offset:1024 lds
    s_waitcnt vmcnt(25)
    s_barrier
    s_add_u32 m0, s40, 81920
    s_add_u32 s24, s43, 1408
    buffer_load_dwordx4 v1, s[8:11], s24 offen lds
    s_add_u32 m0, s41, 81920
    s_add_u32 s24, s44, 1408
    buffer_load_dwordx4 v1, s[8:11], s24 offen lds
    s_add_u32 m0, s42, 81920
    s_add_u32 s24, s45, 1408
    buffer_load_dwordx4 v1, s[8:11], s24 offen lds
    s_add_u32 m0, s47, 81920
    s_add_u32 s24, s46, 360448
    buffer_load_dwordx4 v2, s[12:15], s24 offen offset:0 lds
    buffer_load_dwordx4 v2, s[12:15], s24 offen offset:1024 lds
    s_waitcnt vmcnt(25)
    s_barrier
    s_add_u32 m0, s40, 102400
    s_add_u32 s24, s43, 1536
    buffer_load_dwordx4 v1, s[8:11], s24 offen lds
    s_add_u32 m0, s41, 102400
    s_add_u32 s24, s44, 1536
    buffer_load_dwordx4 v1, s[8:11], s24 offen lds
    s_add_u32 m0, s42, 102400
    s_add_u32 s24, s45, 1536
    buffer_load_dwordx4 v1, s[8:11], s24 offen lds
    s_add_u32 m0, s47, 102400
    s_add_u32 s24, s46, 393216
    buffer_load_dwordx4 v2, s[12:15], s24 offen offset:0 lds
    buffer_load_dwordx4 v2, s[12:15], s24 offen offset:1024 lds
    s_waitcnt vmcnt(25)
    s_barrier
    s_add_u32 m0, s40, 122880
    s_add_u32 s24, s43, 1664
    buffer_load_dwordx4 v1, s[8:11], s24 offen lds
    s_add_u32 m0, s41, 122880
    s_add_u32 s24, s44, 1664
    buffer_load_dwordx4 v1, s[8:11], s24 offen lds
    s_add_u32 m0, s42, 122880
    s_add_u32 s24, s45, 1664
    buffer_load_dwordx4 v1, s[8:11], s24 offen lds
    s_add_u32 m0, s47, 122880
    s_add_u32 s24, s46, 425984
    buffer_load_dwordx4 v2, s[12:15], s24 offen offset:0 lds
    buffer_load_dwordx4 v2, s[12:15], s24 offen offset:1024 lds
    s_waitcnt vmcnt(25)
    s_barrier
    s_add_u32 m0, s40, 0
    s_add_u32 s24, s43, 1792
    buffer_load_dwordx4 v1, s[8:11], s24 offen lds
    s_add_u32 m0, s41, 0
    s_add_u32 s24, s44, 1792
    buffer_load_dwordx4 v1, s[8:11], s24 offen lds
    s_add_u32 m0, s42, 0
    s_add_u32 s24, s45, 1792
    buffer_load_dwordx4 v1, s[8:11], s24 offen lds
    s_add_u32 m0, s47, 0
    s_add_u32 s24, s46, 458752
    buffer_load_dwordx4 v2, s[12:15], s24 offen offset:0 lds
    buffer_load_dwordx4 v2, s[12:15], s24 offen offset:1024 lds
    s_waitcnt vmcnt(25)
    s_barrier
    s_add_u32 m0, s40, 20480
    s_add_u32 s24, s43, 1920
    buffer_load_dwordx4 v1, s[8:11], s24 offen lds
    s_add_u32 m0, s41, 20480
    s_add_u32 s24, s44, 1920
    buffer_load_dwordx4 v1, s[8:11], s24 offen lds
    s_add_u32 m0, s42, 20480
    s_add_u32 s24, s45, 1920
    buffer_load_dwordx4 v1, s[8:11], s24 offen lds
    s_add_u32 m0, s47, 20480
    s_add_u32 s24, s46, 491520
    buffer_load_dwordx4 v2, s[12:15], s24 offen offset:0 lds
    buffer_load_dwordx4 v2, s[12:15], s24 offen offset:1024 lds
    s_waitcnt vmcnt(25)
    s_barrier
    s_waitcnt vmcnt(20)
    s_barrier
    s_waitcnt vmcnt(15)
    s_barrier
    s_waitcnt vmcnt(10)
    s_barrier
    s_waitcnt vmcnt(5)
    s_barrier
    s_waitcnt vmcnt(0)
    s_barrier
L_gemm2_kernel_done:
    s_endpgm
.globl joint_kernel
.p2align 8
.type joint_kernel,@function
joint_kernel:
    s_cmp_ge_u32 s2, 250
    s_cbranch_scc1 L_joint_kernel_done
    s_load_dwordx2 s[6:7], s[0:1], 72
    s_load_dwordx2 s[4:5], s[0:1], 56
    v_readfirstlane_b32 s20, v0
    s_lshr_b32 s20, s20, 6
    s_and_b32 s21, s20, 3
    s_cmp_ge_u32 s2, 125
    s_cselect_b32 s24, 1, 0
    s_mul_i32 s25, s24, 125
    s_sub_u32 s25, s2, s25
    s_lshl_b32 s26, s25, 1
    s_add_u32 s26, s26, 0
    s_mul_i32 s27, s26, 171
    s_lshr_b32 s28, s27, 9
    s_mul_i32 s27, s28, 3
    s_sub_u32 s30, s26, s27
    s_lshl_b32 s26, s25, 1
    s_add_u32 s26, s26, 1
    s_mul_i32 s27, s26, 171
    s_lshr_b32 s29, s27, 9
    s_mul_i32 s27, s29, 3
    s_sub_u32 s31, s26, s27
    v_and_b32 v1, 63, v0
    v_lshlrev_b32 v5, 4, v1
    s_waitcnt lgkmcnt(0)
    s_add_u32 s12, s6, 83312640
    s_addc_u32 s13, s7, 0
    s_mov_b32 s14, 294912
    s_mov_b32 s15, 0x00020000
    s_mul_i32 s36, s24, 4000
    s_lshl_b32 s37, s25, 5
    s_add_u32 s36, s36, s37
    s_lshl_b32 s36, s36, 12
    s_add_u32 s16, s4, s36
    s_addc_u32 s17, s5, 0
    s_mov_b32 s18, 131072
    s_mov_b32 s19, 0x00020000
    s_lshl_b32 s38, s21, 15
    s_cmp_ge_u32 s20, 4
    s_cbranch_scc1 L_joint_kernel_helper
    v_lshrrev_b32 v2, 2, v1
    v_lshlrev_b32 v2, 6, v2
    v_lshrrev_b32 v3, 5, v1
    v_lshlrev_b32 v3, 1, v3
    v_and_b32 v4, 3, v1
    v_xor_b32 v3, v3, v4
    v_lshl_add_u32 v2, v3, 4, v2
    s_lshl_b32 s34, s21, 14
    s_lshl_b32 s35, s21, 13
    s_mul_i32 s33, s24, 2752512
    s_add_u32 s33, s33, 77807616
    s_add_u32 s8, s6, s33
    s_addc_u32 s9, s7, 0
    s_mov_b32 s10, 2752512
    s_mov_b32 s11, 0x00020000
    s_mov_b32 s46, 0
    s_cmp_eq_u32 s28, s29
    s_cbranch_scc1 L_joint_kernel_same
    s_lshl_b32 s36, s29, 15
    s_add_u32 s36, s36, s35
    s_add_u32 m0, s34, 8192
    s_add_u32 s37, s36, 0
    buffer_load_dwordx4 v2, s[8:11], s37 offen offset:0 lds
    buffer_load_dwordx4 v2, s[8:11], s37 offen offset:1024 lds
    buffer_load_dwordx4 v2, s[8:11], s37 offen offset:2048 lds
    buffer_load_dwordx4 v2, s[8:11], s37 offen offset:3072 lds
    s_add_u32 m0, s34, 12288
    s_add_u32 s37, s36, 4096
    buffer_load_dwordx4 v2, s[8:11], s37 offen offset:0 lds
    buffer_load_dwordx4 v2, s[8:11], s37 offen offset:1024 lds
    buffer_load_dwordx4 v2, s[8:11], s37 offen offset:2048 lds
    buffer_load_dwordx4 v2, s[8:11], s37 offen offset:3072 lds
    s_mov_b32 s46, 8192
L_joint_kernel_same:
    s_lshl_b32 s36, s30, 11
    s_add_u32 s36, s36, 8192
    buffer_load_dwordx4 v[8:11], v5, s[12:15], s36 offen offset:0
    buffer_load_dwordx4 v[12:15], v5, s[12:15], s36 offen offset:1024
    s_lshl_b32 s36, s31, 11
    s_add_u32 s36, s36, 8192
    buffer_load_dwordx4 v[16:19], v5, s[12:15], s36 offen offset:0
    buffer_load_dwordx4 v[20:23], v5, s[12:15], s36 offen offset:1024
    s_lshl_b32 s36, s28, 15
    s_add_u32 s36, s36, s35
    s_add_u32 m0, s34, 0
    s_add_u32 s37, s36, 0
    buffer_load_dwordx4 v2, s[8:11], s37 offen offset:0 lds
    buffer_load_dwordx4 v2, s[8:11], s37 offen offset:1024 lds
    buffer_load_dwordx4 v2, s[8:11], s37 offen offset:2048 lds
    buffer_load_dwordx4 v2, s[8:11], s37 offen offset:3072 lds
    s_add_u32 m0, s34, 4096
    s_add_u32 s37, s36, 4096
    buffer_load_dwordx4 v2, s[8:11], s37 offen offset:0 lds
    buffer_load_dwordx4 v2, s[8:11], s37 offen offset:1024 lds
    buffer_load_dwordx4 v2, s[8:11], s37 offen offset:2048 lds
    buffer_load_dwordx4 v2, s[8:11], s37 offen offset:3072 lds
    v_bfe_u32 v32, v1, 2, 2
    v_lshrrev_b32 v33, 4, v1
    v_and_b32 v34, 3, v1
    v_lshl_add_u32 v35, v33, 3, v32
    v_lshlrev_b32 v40, 6, v35
    v_and_b32 v41, 1, v33
    v_lshlrev_b32 v41, 1, v41
    v_lshrrev_b32 v42, 1, v34
    v_xor_b32 v41, v41, v42
    v_lshl_add_u32 v40, v41, 4, v40
    v_and_b32 v42, 1, v34
    v_lshl_add_u32 v40, v42, 3, v40
    v_add_u32 v36, s34, v40
    v_xor_b32 v37, 32, v36
    v_add_u32 v38, s46, v36
    v_add_u32 v39, s46, v37
    v_lshrrev_b32 v41, 1, v33
    v_lshlrev_b32 v41, 10, v41
    v_and_b32 v42, 1, v33
    v_lshl_add_u32 v41, v42, 9, v41
    v_and_b32 v42, 15, v1
    v_lshl_add_u32 v41, v42, 4, v41
    s_lshl_b32 s36, s21, 12
    s_add_u32 s36, s36, 65536
    v_add_u32 v43, s36, v41
    s_mov_b32 s40, 0xbdd2d3e8
    v_mov_b32 v44, 0xc0135761
    s_waitcnt vmcnt(4)
    ds_read_b64_tr_b16 v[48:49], v36 offset:0
    ds_read_b64_tr_b16 v[50:51], v36 offset:256
    ds_read_b64_tr_b16 v[52:53], v36 offset:2048
    ds_read_b64_tr_b16 v[54:55], v36 offset:2304
    ds_read_b64_tr_b16 v[56:57], v37 offset:0
    ds_read_b64_tr_b16 v[58:59], v37 offset:256
    ds_read_b64_tr_b16 v[60:61], v37 offset:2048
    ds_read_b64_tr_b16 v[62:63], v37 offset:2304
    s_waitcnt lgkmcnt(0)
    v_mfma_f32_16x16x32_bf16 v[64:67], v[48:51], v[8:11], 0
    v_mfma_f32_16x16x32_bf16 v[68:71], v[56:59], v[8:11], 0
    v_mfma_f32_16x16x32_bf16 v[64:67], v[52:55], v[12:15], v[64:67]
    v_mfma_f32_16x16x32_bf16 v[68:71], v[60:63], v[12:15], v[68:71]
    ds_read_b64_tr_b16 v[84:85], v38 offset:0
    ds_read_b64_tr_b16 v[86:87], v38 offset:256
    ds_read_b64_tr_b16 v[88:89], v38 offset:2048
    ds_read_b64_tr_b16 v[90:91], v38 offset:2304
    ds_read_b64_tr_b16 v[92:93], v39 offset:0
    ds_read_b64_tr_b16 v[94:95], v39 offset:256
    ds_read_b64_tr_b16 v[96:97], v39 offset:2048
    ds_read_b64_tr_b16 v[98:99], v39 offset:2304
    v_mul_f32 v72, v64, v64
    v_mul_f32 v73, v65, v65
    v_mul_f32 v74, v66, v66
    v_mul_f32 v75, v67, v67
    v_mul_f32 v76, v68, v68
    v_mul_f32 v77, v69, v69
    v_mul_f32 v78, v70, v70
    v_mul_f32 v79, v71, v71
    v_fma_f32 v72, v72, s40, v44
    v_fma_f32 v73, v73, s40, v44
    v_fma_f32 v74, v74, s40, v44
    v_fma_f32 v75, v75, s40, v44
    v_fma_f32 v76, v76, s40, v44
    v_fma_f32 v77, v77, s40, v44
    v_fma_f32 v78, v78, s40, v44
    v_fma_f32 v79, v79, s40, v44
    v_mul_f32 v72, v72, v64
    v_mul_f32 v73, v73, v65
    v_mul_f32 v74, v74, v66
    v_mul_f32 v75, v75, v67
    v_mul_f32 v76, v76, v68
    v_mul_f32 v77, v77, v69
    v_mul_f32 v78, v78, v70
    v_mul_f32 v79, v79, v71
    v_exp_f32 v72, v72
    v_exp_f32 v73, v73
    v_exp_f32 v74, v74
    v_exp_f32 v75, v75
    v_exp_f32 v76, v76
    v_exp_f32 v77, v77
    v_exp_f32 v78, v78
    v_exp_f32 v79, v79
    v_add_f32 v72, 1.0, v72
    v_add_f32 v73, 1.0, v73
    v_add_f32 v74, 1.0, v74
    v_add_f32 v75, 1.0, v75
    v_add_f32 v76, 1.0, v76
    v_add_f32 v77, 1.0, v77
    v_add_f32 v78, 1.0, v78
    v_add_f32 v79, 1.0, v79
    v_rcp_f32 v72, v72
    v_rcp_f32 v73, v73
    v_rcp_f32 v74, v74
    v_rcp_f32 v75, v75
    v_rcp_f32 v76, v76
    v_rcp_f32 v77, v77
    v_rcp_f32 v78, v78
    v_rcp_f32 v79, v79
    v_mul_f32 v64, v64, v72
    v_mul_f32 v65, v65, v73
    v_mul_f32 v66, v66, v74
    v_mul_f32 v67, v67, v75
    v_mul_f32 v68, v68, v76
    v_mul_f32 v69, v69, v77
    v_mul_f32 v70, v70, v78
    v_mul_f32 v71, v71, v79
    v_cvt_pk_bf16_f32 v80, v64, v65
    v_cvt_pk_bf16_f32 v81, v66, v67
    v_cvt_pk_bf16_f32 v82, v68, v69
    v_cvt_pk_bf16_f32 v83, v70, v71
    ds_write_b128 v43, v[80:83] offset:0
    s_waitcnt vmcnt(0)
    s_waitcnt lgkmcnt(1)
    v_mfma_f32_16x16x32_bf16 v[100:103], v[84:87], v[16:19], 0
    v_mfma_f32_16x16x32_bf16 v[104:107], v[92:95], v[16:19], 0
    v_mfma_f32_16x16x32_bf16 v[100:103], v[88:91], v[20:23], v[100:103]
    v_mfma_f32_16x16x32_bf16 v[104:107], v[96:99], v[20:23], v[104:107]
    ds_read_b64_tr_b16 v[48:49], v36 offset:4096
    ds_read_b64_tr_b16 v[50:51], v36 offset:4352
    ds_read_b64_tr_b16 v[52:53], v36 offset:6144
    ds_read_b64_tr_b16 v[54:55], v36 offset:6400
    ds_read_b64_tr_b16 v[56:57], v37 offset:4096
    ds_read_b64_tr_b16 v[58:59], v37 offset:4352
    ds_read_b64_tr_b16 v[60:61], v37 offset:6144
    ds_read_b64_tr_b16 v[62:63], v37 offset:6400
    v_mul_f32 v72, v100, v100
    v_mul_f32 v73, v101, v101
    v_mul_f32 v74, v102, v102
    v_mul_f32 v75, v103, v103
    v_mul_f32 v76, v104, v104
    v_mul_f32 v77, v105, v105
    v_mul_f32 v78, v106, v106
    v_mul_f32 v79, v107, v107
    v_fma_f32 v72, v72, s40, v44
    v_fma_f32 v73, v73, s40, v44
    v_fma_f32 v74, v74, s40, v44
    v_fma_f32 v75, v75, s40, v44
    v_fma_f32 v76, v76, s40, v44
    v_fma_f32 v77, v77, s40, v44
    v_fma_f32 v78, v78, s40, v44
    v_fma_f32 v79, v79, s40, v44
    v_mul_f32 v72, v72, v100
    v_mul_f32 v73, v73, v101
    v_mul_f32 v74, v74, v102
    v_mul_f32 v75, v75, v103
    v_mul_f32 v76, v76, v104
    v_mul_f32 v77, v77, v105
    v_mul_f32 v78, v78, v106
    v_mul_f32 v79, v79, v107
    v_exp_f32 v72, v72
    v_exp_f32 v73, v73
    v_exp_f32 v74, v74
    v_exp_f32 v75, v75
    v_exp_f32 v76, v76
    v_exp_f32 v77, v77
    v_exp_f32 v78, v78
    v_exp_f32 v79, v79
    v_add_f32 v72, 1.0, v72
    v_add_f32 v73, 1.0, v73
    v_add_f32 v74, 1.0, v74
    v_add_f32 v75, 1.0, v75
    v_add_f32 v76, 1.0, v76
    v_add_f32 v77, 1.0, v77
    v_add_f32 v78, 1.0, v78
    v_add_f32 v79, 1.0, v79
    v_rcp_f32 v72, v72
    v_rcp_f32 v73, v73
    v_rcp_f32 v74, v74
    v_rcp_f32 v75, v75
    v_rcp_f32 v76, v76
    v_rcp_f32 v77, v77
    v_rcp_f32 v78, v78
    v_rcp_f32 v79, v79
    v_mul_f32 v100, v100, v72
    v_mul_f32 v101, v101, v73
    v_mul_f32 v102, v102, v74
    v_mul_f32 v103, v103, v75
    v_mul_f32 v104, v104, v76
    v_mul_f32 v105, v105, v77
    v_mul_f32 v106, v106, v78
    v_mul_f32 v107, v107, v79
    v_cvt_pk_bf16_f32 v108, v100, v101
    v_cvt_pk_bf16_f32 v109, v102, v103
    v_cvt_pk_bf16_f32 v110, v104, v105
    v_cvt_pk_bf16_f32 v111, v106, v107
    ds_write_b128 v43, v[108:111] offset:256
    s_waitcnt lgkmcnt(1)
    v_mfma_f32_16x16x32_bf16 v[64:67], v[48:51], v[8:11], 0
    v_mfma_f32_16x16x32_bf16 v[68:71], v[56:59], v[8:11], 0
    v_mfma_f32_16x16x32_bf16 v[64:67], v[52:55], v[12:15], v[64:67]
    v_mfma_f32_16x16x32_bf16 v[68:71], v[60:63], v[12:15], v[68:71]
    ds_read_b64_tr_b16 v[84:85], v38 offset:4096
    ds_read_b64_tr_b16 v[86:87], v38 offset:4352
    ds_read_b64_tr_b16 v[88:89], v38 offset:6144
    ds_read_b64_tr_b16 v[90:91], v38 offset:6400
    ds_read_b64_tr_b16 v[92:93], v39 offset:4096
    ds_read_b64_tr_b16 v[94:95], v39 offset:4352
    ds_read_b64_tr_b16 v[96:97], v39 offset:6144
    ds_read_b64_tr_b16 v[98:99], v39 offset:6400
    v_mul_f32 v72, v64, v64
    v_mul_f32 v73, v65, v65
    v_mul_f32 v74, v66, v66
    v_mul_f32 v75, v67, v67
    v_mul_f32 v76, v68, v68
    v_mul_f32 v77, v69, v69
    v_mul_f32 v78, v70, v70
    v_mul_f32 v79, v71, v71
    v_fma_f32 v72, v72, s40, v44
    v_fma_f32 v73, v73, s40, v44
    v_fma_f32 v74, v74, s40, v44
    v_fma_f32 v75, v75, s40, v44
    v_fma_f32 v76, v76, s40, v44
    v_fma_f32 v77, v77, s40, v44
    v_fma_f32 v78, v78, s40, v44
    v_fma_f32 v79, v79, s40, v44
    v_mul_f32 v72, v72, v64
    v_mul_f32 v73, v73, v65
    v_mul_f32 v74, v74, v66
    v_mul_f32 v75, v75, v67
    v_mul_f32 v76, v76, v68
    v_mul_f32 v77, v77, v69
    v_mul_f32 v78, v78, v70
    v_mul_f32 v79, v79, v71
    v_exp_f32 v72, v72
    v_exp_f32 v73, v73
    v_exp_f32 v74, v74
    v_exp_f32 v75, v75
    v_exp_f32 v76, v76
    v_exp_f32 v77, v77
    v_exp_f32 v78, v78
    v_exp_f32 v79, v79
    v_add_f32 v72, 1.0, v72
    v_add_f32 v73, 1.0, v73
    v_add_f32 v74, 1.0, v74
    v_add_f32 v75, 1.0, v75
    v_add_f32 v76, 1.0, v76
    v_add_f32 v77, 1.0, v77
    v_add_f32 v78, 1.0, v78
    v_add_f32 v79, 1.0, v79
    v_rcp_f32 v72, v72
    v_rcp_f32 v73, v73
    v_rcp_f32 v74, v74
    v_rcp_f32 v75, v75
    v_rcp_f32 v76, v76
    v_rcp_f32 v77, v77
    v_rcp_f32 v78, v78
    v_rcp_f32 v79, v79
    v_mul_f32 v64, v64, v72
    v_mul_f32 v65, v65, v73
    v_mul_f32 v66, v66, v74
    v_mul_f32 v67, v67, v75
    v_mul_f32 v68, v68, v76
    v_mul_f32 v69, v69, v77
    v_mul_f32 v70, v70, v78
    v_mul_f32 v71, v71, v79
    v_cvt_pk_bf16_f32 v80, v64, v65
    v_cvt_pk_bf16_f32 v81, v66, v67
    v_cvt_pk_bf16_f32 v82, v68, v69
    v_cvt_pk_bf16_f32 v83, v70, v71
    ds_write_b128 v43, v[80:83] offset:2048
    s_waitcnt lgkmcnt(1)
    v_mfma_f32_16x16x32_bf16 v[100:103], v[84:87], v[16:19], 0
    v_mfma_f32_16x16x32_bf16 v[104:107], v[92:95], v[16:19], 0
    v_mfma_f32_16x16x32_bf16 v[100:103], v[88:91], v[20:23], v[100:103]
    v_mfma_f32_16x16x32_bf16 v[104:107], v[96:99], v[20:23], v[104:107]
    s_nop 7
    v_mul_f32 v72, v100, v100
    v_mul_f32 v73, v101, v101
    v_mul_f32 v74, v102, v102
    v_mul_f32 v75, v103, v103
    v_mul_f32 v76, v104, v104
    v_mul_f32 v77, v105, v105
    v_mul_f32 v78, v106, v106
    v_mul_f32 v79, v107, v107
    v_fma_f32 v72, v72, s40, v44
    v_fma_f32 v73, v73, s40, v44
    v_fma_f32 v74, v74, s40, v44
    v_fma_f32 v75, v75, s40, v44
    v_fma_f32 v76, v76, s40, v44
    v_fma_f32 v77, v77, s40, v44
    v_fma_f32 v78, v78, s40, v44
    v_fma_f32 v79, v79, s40, v44
    v_mul_f32 v72, v72, v100
    v_mul_f32 v73, v73, v101
    v_mul_f32 v74, v74, v102
    v_mul_f32 v75, v75, v103
    v_mul_f32 v76, v76, v104
    v_mul_f32 v77, v77, v105
    v_mul_f32 v78, v78, v106
    v_mul_f32 v79, v79, v107
    v_exp_f32 v72, v72
    v_exp_f32 v73, v73
    v_exp_f32 v74, v74
    v_exp_f32 v75, v75
    v_exp_f32 v76, v76
    v_exp_f32 v77, v77
    v_exp_f32 v78, v78
    v_exp_f32 v79, v79
    v_add_f32 v72, 1.0, v72
    v_add_f32 v73, 1.0, v73
    v_add_f32 v74, 1.0, v74
    v_add_f32 v75, 1.0, v75
    v_add_f32 v76, 1.0, v76
    v_add_f32 v77, 1.0, v77
    v_add_f32 v78, 1.0, v78
    v_add_f32 v79, 1.0, v79
    v_rcp_f32 v72, v72
    v_rcp_f32 v73, v73
    v_rcp_f32 v74, v74
    v_rcp_f32 v75, v75
    v_rcp_f32 v76, v76
    v_rcp_f32 v77, v77
    v_rcp_f32 v78, v78
    v_rcp_f32 v79, v79
    v_mul_f32 v100, v100, v72
    v_mul_f32 v101, v101, v73
    v_mul_f32 v102, v102, v74
    v_mul_f32 v103, v103, v75
    v_mul_f32 v104, v104, v76
    v_mul_f32 v105, v105, v77
    v_mul_f32 v106, v106, v78
    v_mul_f32 v107, v107, v79
    v_cvt_pk_bf16_f32 v108, v100, v101
    v_cvt_pk_bf16_f32 v109, v102, v103
    v_cvt_pk_bf16_f32 v110, v104, v105
    v_cvt_pk_bf16_f32 v111, v106, v107
    ds_write_b128 v43, v[108:111] offset:2304
    s_waitcnt lgkmcnt(0)
    s_barrier
    s_add_u32 s36, s38, 163840
    buffer_load_dwordx4 a[0:3], v5, s[12:15], s36 offen
    s_add_u32 s36, s38, 180224
    buffer_load_dwordx4 a[64:67], v5, s[12:15], s36 offen
    s_add_u32 s36, s38, 164864
    buffer_load_dwordx4 a[4:7], v5, s[12:15], s36 offen
    s_add_u32 s36, s38, 181248
    buffer_load_dwordx4 a[68:71], v5, s[12:15], s36 offen
    s_add_u32 s36, s38, 165888
    buffer_load_dwordx4 a[8:11], v5, s[12:15], s36 offen
    s_add_u32 s36, s38, 182272
    buffer_load_dwordx4 a[72:75], v5, s[12:15], s36 offen
    s_add_u32 s36, s38, 166912
    buffer_load_dwordx4 a[12:15], v5, s[12:15], s36 offen
    s_add_u32 s36, s38, 183296
    buffer_load_dwordx4 a[76:79], v5, s[12:15], s36 offen
    s_add_u32 s36, s38, 167936
    buffer_load_dwordx4 a[16:19], v5, s[12:15], s36 offen
    s_add_u32 s36, s38, 184320
    buffer_load_dwordx4 a[80:83], v5, s[12:15], s36 offen
    s_add_u32 s36, s38, 168960
    buffer_load_dwordx4 a[20:23], v5, s[12:15], s36 offen
    s_add_u32 s36, s38, 185344
    buffer_load_dwordx4 a[84:87], v5, s[12:15], s36 offen
    s_add_u32 s36, s38, 169984
    buffer_load_dwordx4 a[24:27], v5, s[12:15], s36 offen
    s_add_u32 s36, s38, 186368
    buffer_load_dwordx4 a[88:91], v5, s[12:15], s36 offen
    s_add_u32 s36, s38, 171008
    buffer_load_dwordx4 a[28:31], v5, s[12:15], s36 offen
    s_add_u32 s36, s38, 187392
    buffer_load_dwordx4 a[92:95], v5, s[12:15], s36 offen
    s_add_u32 s36, s38, 172032
    buffer_load_dwordx4 a[32:35], v5, s[12:15], s36 offen
    s_add_u32 s36, s38, 188416
    buffer_load_dwordx4 a[96:99], v5, s[12:15], s36 offen
    s_add_u32 s36, s38, 173056
    buffer_load_dwordx4 a[36:39], v5, s[12:15], s36 offen
    s_add_u32 s36, s38, 189440
    buffer_load_dwordx4 a[100:103], v5, s[12:15], s36 offen
    s_add_u32 s36, s38, 174080
    buffer_load_dwordx4 a[40:43], v5, s[12:15], s36 offen
    s_add_u32 s36, s38, 190464
    buffer_load_dwordx4 a[104:107], v5, s[12:15], s36 offen
    s_add_u32 s36, s38, 175104
    buffer_load_dwordx4 a[44:47], v5, s[12:15], s36 offen
    s_add_u32 s36, s38, 191488
    buffer_load_dwordx4 a[108:111], v5, s[12:15], s36 offen
    s_add_u32 s36, s38, 176128
    buffer_load_dwordx4 a[48:51], v5, s[12:15], s36 offen
    s_add_u32 s36, s38, 192512
    buffer_load_dwordx4 a[112:115], v5, s[12:15], s36 offen
    s_add_u32 s36, s38, 177152
    buffer_load_dwordx4 a[52:55], v5, s[12:15], s36 offen
    s_add_u32 s36, s38, 193536
    buffer_load_dwordx4 a[116:119], v5, s[12:15], s36 offen
    s_add_u32 s36, s38, 178176
    buffer_load_dwordx4 a[56:59], v5, s[12:15], s36 offen
    s_add_u32 s36, s38, 194560
    buffer_load_dwordx4 a[120:123], v5, s[12:15], s36 offen
    s_add_u32 s36, s38, 179200
    buffer_load_dwordx4 a[60:63], v5, s[12:15], s36 offen
    s_add_u32 s36, s38, 195584
    buffer_load_dwordx4 a[124:127], v5, s[12:15], s36 offen
    v_and_b32 v46, 31, v1
    v_mul_u32_u24 v47, 528, v46
    v_lshrrev_b32 v45, 5, v1
    v_lshl_add_u32 v47, v45, 4, v47
    s_lshl_b32 s36, s21, 7
    s_add_u32 s36, s36, 115712
    v_add_u32 v6, s36, v47
    v_lshlrev_b32 v7, 6, v45
    s_lshl_b32 s36, s21, 8
    s_add_u32 s36, s36, 14336
    buffer_load_dwordx4 v[72:75], v7, s[12:15], s36 offen offset:0
    buffer_load_dwordx4 v[76:79], v7, s[12:15], s36 offen offset:16
    buffer_load_dwordx4 v[80:83], v7, s[12:15], s36 offen offset:32
    buffer_load_dwordx4 v[84:87], v7, s[12:15], s36 offen offset:48
    buffer_load_dwordx4 v[88:91], v7, s[12:15], s36 offen offset:128
    buffer_load_dwordx4 v[92:95], v7, s[12:15], s36 offen offset:144
    buffer_load_dwordx4 v[96:99], v7, s[12:15], s36 offen offset:160
    buffer_load_dwordx4 v[100:103], v7, s[12:15], s36 offen offset:176
    s_setprio 1
    s_waitcnt vmcnt(0)
    s_barrier
    ds_read_b128 v[104:107], v5 offset:0
    ds_read_b128 v[108:111], v5 offset:1024
    ds_read_b128 v[112:115], v5 offset:2048
    s_waitcnt lgkmcnt(2)
    v_mfma_f32_32x32x16_bf16 v[8:23], a[0:3], v[104:107], v[72:87]
    ds_read_b128 v[116:119], v5 offset:3072
    v_mfma_f32_32x32x16_bf16 v[24:39], a[64:67], v[104:107], v[88:103]
    s_waitcnt lgkmcnt(2)
    v_mfma_f32_32x32x16_bf16 v[8:23], a[4:7], v[108:111], v[8:23]
    ds_read_b128 v[104:107], v5 offset:4096
    v_mfma_f32_32x32x16_bf16 v[24:39], a[68:71], v[108:111], v[24:39]
    s_waitcnt lgkmcnt(2)
    v_mfma_f32_32x32x16_bf16 v[8:23], a[8:11], v[112:115], v[8:23]
    ds_read_b128 v[108:111], v5 offset:5120
    v_mfma_f32_32x32x16_bf16 v[24:39], a[72:75], v[112:115], v[24:39]
    s_waitcnt lgkmcnt(2)
    v_mfma_f32_32x32x16_bf16 v[8:23], a[12:15], v[116:119], v[8:23]
    ds_read_b128 v[112:115], v5 offset:6144
    v_mfma_f32_32x32x16_bf16 v[24:39], a[76:79], v[116:119], v[24:39]
    s_waitcnt lgkmcnt(2)
    v_mfma_f32_32x32x16_bf16 v[8:23], a[16:19], v[104:107], v[8:23]
    ds_read_b128 v[116:119], v5 offset:7168
    v_mfma_f32_32x32x16_bf16 v[24:39], a[80:83], v[104:107], v[24:39]
    s_waitcnt lgkmcnt(2)
    v_mfma_f32_32x32x16_bf16 v[8:23], a[20:23], v[108:111], v[8:23]
    ds_read_b128 v[104:107], v5 offset:8192
    v_mfma_f32_32x32x16_bf16 v[24:39], a[84:87], v[108:111], v[24:39]
    s_waitcnt lgkmcnt(2)
    v_mfma_f32_32x32x16_bf16 v[8:23], a[24:27], v[112:115], v[8:23]
    ds_read_b128 v[108:111], v5 offset:9216
    v_mfma_f32_32x32x16_bf16 v[24:39], a[88:91], v[112:115], v[24:39]
    s_waitcnt lgkmcnt(2)
    v_mfma_f32_32x32x16_bf16 v[8:23], a[28:31], v[116:119], v[8:23]
    ds_read_b128 v[112:115], v5 offset:10240
    v_mfma_f32_32x32x16_bf16 v[24:39], a[92:95], v[116:119], v[24:39]
    s_waitcnt lgkmcnt(2)
    v_mfma_f32_32x32x16_bf16 v[8:23], a[32:35], v[104:107], v[8:23]
    ds_read_b128 v[116:119], v5 offset:11264
    v_mfma_f32_32x32x16_bf16 v[24:39], a[96:99], v[104:107], v[24:39]
    s_waitcnt lgkmcnt(2)
    v_mfma_f32_32x32x16_bf16 v[8:23], a[36:39], v[108:111], v[8:23]
    ds_read_b128 v[104:107], v5 offset:12288
    v_mfma_f32_32x32x16_bf16 v[24:39], a[100:103], v[108:111], v[24:39]
    s_waitcnt lgkmcnt(2)
    v_mfma_f32_32x32x16_bf16 v[8:23], a[40:43], v[112:115], v[8:23]
    ds_read_b128 v[108:111], v5 offset:13312
    v_mfma_f32_32x32x16_bf16 v[24:39], a[104:107], v[112:115], v[24:39]
    s_waitcnt lgkmcnt(2)
    v_mfma_f32_32x32x16_bf16 v[8:23], a[44:47], v[116:119], v[8:23]
    ds_read_b128 v[112:115], v5 offset:14336
    v_mfma_f32_32x32x16_bf16 v[24:39], a[108:111], v[116:119], v[24:39]
    s_waitcnt lgkmcnt(2)
    v_mfma_f32_32x32x16_bf16 v[8:23], a[48:51], v[104:107], v[8:23]
    ds_read_b128 v[116:119], v5 offset:15360
    v_mfma_f32_32x32x16_bf16 v[24:39], a[112:115], v[104:107], v[24:39]
    s_waitcnt lgkmcnt(2)
    v_mfma_f32_32x32x16_bf16 v[8:23], a[52:55], v[108:111], v[8:23]
    ds_read_b128 v[104:107], v5 offset:16384
    v_mfma_f32_32x32x16_bf16 v[24:39], a[116:119], v[108:111], v[24:39]
    s_waitcnt lgkmcnt(2)
    v_mfma_f32_32x32x16_bf16 v[8:23], a[56:59], v[112:115], v[8:23]
    ds_read_b128 v[108:111], v5 offset:17408
    v_mfma_f32_32x32x16_bf16 v[24:39], a[120:123], v[112:115], v[24:39]
    s_waitcnt lgkmcnt(2)
    v_mfma_f32_32x32x16_bf16 v[8:23], a[60:63], v[116:119], v[8:23]
    ds_read_b128 v[112:115], v5 offset:18432
    v_mfma_f32_32x32x16_bf16 v[24:39], a[124:127], v[116:119], v[24:39]
    s_barrier
    s_waitcnt lgkmcnt(2)
    v_mfma_f32_32x32x16_bf16 v[40:55], a[0:3], v[104:107], v[72:87]
    ds_read_b128 v[116:119], v5 offset:19456
    v_mfma_f32_32x32x16_bf16 v[56:71], a[64:67], v[104:107], v[88:103]
    s_waitcnt lgkmcnt(2)
    v_mfma_f32_32x32x16_bf16 v[40:55], a[4:7], v[108:111], v[40:55]
    ds_read_b128 v[104:107], v5 offset:20480
    v_cvt_pk_bf16_f32 v120, v8, v9
    v_mfma_f32_32x32x16_bf16 v[56:71], a[68:71], v[108:111], v[56:71]
    v_cvt_pk_bf16_f32 v121, v10, v11
    s_waitcnt lgkmcnt(2)
    v_mfma_f32_32x32x16_bf16 v[40:55], a[8:11], v[112:115], v[40:55]
    ds_read_b128 v[108:111], v5 offset:21504
    v_cvt_pk_bf16_f32 v122, v12, v13
    v_mfma_f32_32x32x16_bf16 v[56:71], a[72:75], v[112:115], v[56:71]
    v_cvt_pk_bf16_f32 v123, v14, v15
    s_waitcnt lgkmcnt(2)
    v_mfma_f32_32x32x16_bf16 v[40:55], a[12:15], v[116:119], v[40:55]
    ds_read_b128 v[112:115], v5 offset:22528
    ds_write_b128 v6, v[120:123] offset:0
    v_mfma_f32_32x32x16_bf16 v[56:71], a[76:79], v[116:119], v[56:71]
    v_cvt_pk_bf16_f32 v124, v16, v17
    s_waitcnt lgkmcnt(3)
    v_mfma_f32_32x32x16_bf16 v[40:55], a[16:19], v[104:107], v[40:55]
    ds_read_b128 v[116:119], v5 offset:23552
    v_cvt_pk_bf16_f32 v125, v18, v19
    v_mfma_f32_32x32x16_bf16 v[56:71], a[80:83], v[104:107], v[56:71]
    v_cvt_pk_bf16_f32 v126, v20, v21
    s_waitcnt lgkmcnt(3)
    v_mfma_f32_32x32x16_bf16 v[40:55], a[20:23], v[108:111], v[40:55]
    ds_read_b128 v[104:107], v5 offset:24576
    v_cvt_pk_bf16_f32 v127, v22, v23
    v_mfma_f32_32x32x16_bf16 v[56:71], a[84:87], v[108:111], v[56:71]
    ds_write_b128 v6, v[124:127] offset:32
    s_waitcnt lgkmcnt(4)
    v_mfma_f32_32x32x16_bf16 v[40:55], a[24:27], v[112:115], v[40:55]
    ds_read_b128 v[108:111], v5 offset:25600
    v_cvt_pk_bf16_f32 v120, v24, v25
    v_mfma_f32_32x32x16_bf16 v[56:71], a[88:91], v[112:115], v[56:71]
    v_cvt_pk_bf16_f32 v121, v26, v27
    s_waitcnt lgkmcnt(3)
    v_mfma_f32_32x32x16_bf16 v[40:55], a[28:31], v[116:119], v[40:55]
    ds_read_b128 v[112:115], v5 offset:26624
    v_cvt_pk_bf16_f32 v122, v28, v29
    v_mfma_f32_32x32x16_bf16 v[56:71], a[92:95], v[116:119], v[56:71]
    v_cvt_pk_bf16_f32 v123, v30, v31
    s_waitcnt lgkmcnt(3)
    v_mfma_f32_32x32x16_bf16 v[40:55], a[32:35], v[104:107], v[40:55]
    ds_read_b128 v[116:119], v5 offset:27648
    ds_write_b128 v6, v[120:123] offset:64
    v_mfma_f32_32x32x16_bf16 v[56:71], a[96:99], v[104:107], v[56:71]
    v_cvt_pk_bf16_f32 v124, v32, v33
    s_waitcnt lgkmcnt(3)
    v_mfma_f32_32x32x16_bf16 v[40:55], a[36:39], v[108:111], v[40:55]
    ds_read_b128 v[104:107], v5 offset:28672
    v_cvt_pk_bf16_f32 v125, v34, v35
    v_mfma_f32_32x32x16_bf16 v[56:71], a[100:103], v[108:111], v[56:71]
    v_cvt_pk_bf16_f32 v126, v36, v37
    s_waitcnt lgkmcnt(3)
    v_mfma_f32_32x32x16_bf16 v[40:55], a[40:43], v[112:115], v[40:55]
    ds_read_b128 v[108:111], v5 offset:29696
    v_cvt_pk_bf16_f32 v127, v38, v39
    v_mfma_f32_32x32x16_bf16 v[56:71], a[104:107], v[112:115], v[56:71]
    ds_write_b128 v6, v[124:127] offset:96
    s_waitcnt lgkmcnt(4)
    v_mfma_f32_32x32x16_bf16 v[40:55], a[44:47], v[116:119], v[40:55]
    ds_read_b128 v[112:115], v5 offset:30720
    v_mfma_f32_32x32x16_bf16 v[56:71], a[108:111], v[116:119], v[56:71]
    s_waitcnt lgkmcnt(3)
    v_mfma_f32_32x32x16_bf16 v[40:55], a[48:51], v[104:107], v[40:55]
    ds_read_b128 v[116:119], v5 offset:31744
    v_mfma_f32_32x32x16_bf16 v[56:71], a[112:115], v[104:107], v[56:71]
    s_waitcnt lgkmcnt(3)
    v_mfma_f32_32x32x16_bf16 v[40:55], a[52:55], v[108:111], v[40:55]
    ds_read_b128 v[104:107], v5 offset:32768
    v_mfma_f32_32x32x16_bf16 v[56:71], a[116:119], v[108:111], v[56:71]
    s_waitcnt lgkmcnt(2)
    v_mfma_f32_32x32x16_bf16 v[40:55], a[56:59], v[112:115], v[40:55]
    ds_read_b128 v[108:111], v5 offset:33792
    v_mfma_f32_32x32x16_bf16 v[56:71], a[120:123], v[112:115], v[56:71]
    s_waitcnt lgkmcnt(2)
    v_mfma_f32_32x32x16_bf16 v[40:55], a[60:63], v[116:119], v[40:55]
    ds_read_b128 v[112:115], v5 offset:34816
    v_mfma_f32_32x32x16_bf16 v[56:71], a[124:127], v[116:119], v[56:71]
    s_barrier
    s_waitcnt lgkmcnt(2)
    v_mfma_f32_32x32x16_bf16 v[8:23], a[0:3], v[104:107], v[72:87]
    ds_read_b128 v[116:119], v5 offset:35840
    v_mfma_f32_32x32x16_bf16 v[24:39], a[64:67], v[104:107], v[88:103]
    s_waitcnt lgkmcnt(2)
    v_mfma_f32_32x32x16_bf16 v[8:23], a[4:7], v[108:111], v[8:23]
    ds_read_b128 v[104:107], v5 offset:36864
    v_cvt_pk_bf16_f32 v120, v40, v41
    v_mfma_f32_32x32x16_bf16 v[24:39], a[68:71], v[108:111], v[24:39]
    v_cvt_pk_bf16_f32 v121, v42, v43
    s_waitcnt lgkmcnt(2)
    v_mfma_f32_32x32x16_bf16 v[8:23], a[8:11], v[112:115], v[8:23]
    ds_read_b128 v[108:111], v5 offset:37888
    v_cvt_pk_bf16_f32 v122, v44, v45
    v_mfma_f32_32x32x16_bf16 v[24:39], a[72:75], v[112:115], v[24:39]
    v_cvt_pk_bf16_f32 v123, v46, v47
    s_waitcnt lgkmcnt(2)
    v_mfma_f32_32x32x16_bf16 v[8:23], a[12:15], v[116:119], v[8:23]
    ds_read_b128 v[112:115], v5 offset:38912
    ds_write_b128 v6, v[120:123] offset:16896
    v_mfma_f32_32x32x16_bf16 v[24:39], a[76:79], v[116:119], v[24:39]
    v_cvt_pk_bf16_f32 v124, v48, v49
    s_waitcnt lgkmcnt(3)
    v_mfma_f32_32x32x16_bf16 v[8:23], a[16:19], v[104:107], v[8:23]
    ds_read_b128 v[116:119], v5 offset:39936
    v_cvt_pk_bf16_f32 v125, v50, v51
    v_mfma_f32_32x32x16_bf16 v[24:39], a[80:83], v[104:107], v[24:39]
    v_cvt_pk_bf16_f32 v126, v52, v53
    s_waitcnt lgkmcnt(3)
    v_mfma_f32_32x32x16_bf16 v[8:23], a[20:23], v[108:111], v[8:23]
    ds_read_b128 v[104:107], v5 offset:40960
    v_cvt_pk_bf16_f32 v127, v54, v55
    v_mfma_f32_32x32x16_bf16 v[24:39], a[84:87], v[108:111], v[24:39]
    ds_write_b128 v6, v[124:127] offset:16928
    s_waitcnt lgkmcnt(4)
    v_mfma_f32_32x32x16_bf16 v[8:23], a[24:27], v[112:115], v[8:23]
    ds_read_b128 v[108:111], v5 offset:41984
    v_cvt_pk_bf16_f32 v120, v56, v57
    v_mfma_f32_32x32x16_bf16 v[24:39], a[88:91], v[112:115], v[24:39]
    v_cvt_pk_bf16_f32 v121, v58, v59
    s_waitcnt lgkmcnt(3)
    v_mfma_f32_32x32x16_bf16 v[8:23], a[28:31], v[116:119], v[8:23]
    ds_read_b128 v[112:115], v5 offset:43008
    v_cvt_pk_bf16_f32 v122, v60, v61
    v_mfma_f32_32x32x16_bf16 v[24:39], a[92:95], v[116:119], v[24:39]
    v_cvt_pk_bf16_f32 v123, v62, v63
    s_waitcnt lgkmcnt(3)
    v_mfma_f32_32x32x16_bf16 v[8:23], a[32:35], v[104:107], v[8:23]
    ds_read_b128 v[116:119], v5 offset:44032
    ds_write_b128 v6, v[120:123] offset:16960
    v_mfma_f32_32x32x16_bf16 v[24:39], a[96:99], v[104:107], v[24:39]
    v_cvt_pk_bf16_f32 v124, v64, v65
    s_waitcnt lgkmcnt(3)
    v_mfma_f32_32x32x16_bf16 v[8:23], a[36:39], v[108:111], v[8:23]
    ds_read_b128 v[104:107], v5 offset:45056
    v_cvt_pk_bf16_f32 v125, v66, v67
    v_mfma_f32_32x32x16_bf16 v[24:39], a[100:103], v[108:111], v[24:39]
    v_cvt_pk_bf16_f32 v126, v68, v69
    s_waitcnt lgkmcnt(3)
    v_mfma_f32_32x32x16_bf16 v[8:23], a[40:43], v[112:115], v[8:23]
    ds_read_b128 v[108:111], v5 offset:46080
    v_cvt_pk_bf16_f32 v127, v70, v71
    v_mfma_f32_32x32x16_bf16 v[24:39], a[104:107], v[112:115], v[24:39]
    ds_write_b128 v6, v[124:127] offset:16992
    s_waitcnt lgkmcnt(4)
    v_mfma_f32_32x32x16_bf16 v[8:23], a[44:47], v[116:119], v[8:23]
    ds_read_b128 v[112:115], v5 offset:47104
    v_mfma_f32_32x32x16_bf16 v[24:39], a[108:111], v[116:119], v[24:39]
    s_waitcnt lgkmcnt(3)
    v_mfma_f32_32x32x16_bf16 v[8:23], a[48:51], v[104:107], v[8:23]
    ds_read_b128 v[116:119], v5 offset:48128
    v_mfma_f32_32x32x16_bf16 v[24:39], a[112:115], v[104:107], v[24:39]
    s_waitcnt lgkmcnt(3)
    v_mfma_f32_32x32x16_bf16 v[8:23], a[52:55], v[108:111], v[8:23]
    ds_read_b128 v[104:107], v5 offset:0
    v_mfma_f32_32x32x16_bf16 v[24:39], a[116:119], v[108:111], v[24:39]
    s_waitcnt lgkmcnt(2)
    v_mfma_f32_32x32x16_bf16 v[8:23], a[56:59], v[112:115], v[8:23]
    ds_read_b128 v[108:111], v5 offset:1024
    v_mfma_f32_32x32x16_bf16 v[24:39], a[120:123], v[112:115], v[24:39]
    s_waitcnt lgkmcnt(2)
    v_mfma_f32_32x32x16_bf16 v[8:23], a[60:63], v[116:119], v[8:23]
    ds_read_b128 v[112:115], v5 offset:2048
    v_mfma_f32_32x32x16_bf16 v[24:39], a[124:127], v[116:119], v[24:39]
    s_barrier
    s_waitcnt lgkmcnt(2)
    v_mfma_f32_32x32x16_bf16 v[40:55], a[0:3], v[104:107], v[72:87]
    ds_read_b128 v[116:119], v5 offset:3072
    v_mfma_f32_32x32x16_bf16 v[56:71], a[64:67], v[104:107], v[88:103]
    s_waitcnt lgkmcnt(2)
    v_mfma_f32_32x32x16_bf16 v[40:55], a[4:7], v[108:111], v[40:55]
    ds_read_b128 v[104:107], v5 offset:4096
    v_cvt_pk_bf16_f32 v120, v8, v9
    v_mfma_f32_32x32x16_bf16 v[56:71], a[68:71], v[108:111], v[56:71]
    v_cvt_pk_bf16_f32 v121, v10, v11
    s_waitcnt lgkmcnt(2)
    v_mfma_f32_32x32x16_bf16 v[40:55], a[8:11], v[112:115], v[40:55]
    ds_read_b128 v[108:111], v5 offset:5120
    v_cvt_pk_bf16_f32 v122, v12, v13
    v_mfma_f32_32x32x16_bf16 v[56:71], a[72:75], v[112:115], v[56:71]
    v_cvt_pk_bf16_f32 v123, v14, v15
    s_waitcnt lgkmcnt(2)
    v_mfma_f32_32x32x16_bf16 v[40:55], a[12:15], v[116:119], v[40:55]
    ds_read_b128 v[112:115], v5 offset:6144
    ds_write_b128 v6, v[120:123] offset:0
    v_mfma_f32_32x32x16_bf16 v[56:71], a[76:79], v[116:119], v[56:71]
    v_cvt_pk_bf16_f32 v124, v16, v17
    s_waitcnt lgkmcnt(3)
    v_mfma_f32_32x32x16_bf16 v[40:55], a[16:19], v[104:107], v[40:55]
    ds_read_b128 v[116:119], v5 offset:7168
    v_cvt_pk_bf16_f32 v125, v18, v19
    v_mfma_f32_32x32x16_bf16 v[56:71], a[80:83], v[104:107], v[56:71]
    v_cvt_pk_bf16_f32 v126, v20, v21
    s_waitcnt lgkmcnt(3)
    v_mfma_f32_32x32x16_bf16 v[40:55], a[20:23], v[108:111], v[40:55]
    ds_read_b128 v[104:107], v5 offset:8192
    v_cvt_pk_bf16_f32 v127, v22, v23
    v_mfma_f32_32x32x16_bf16 v[56:71], a[84:87], v[108:111], v[56:71]
    ds_write_b128 v6, v[124:127] offset:32
    s_waitcnt lgkmcnt(4)
    v_mfma_f32_32x32x16_bf16 v[40:55], a[24:27], v[112:115], v[40:55]
    ds_read_b128 v[108:111], v5 offset:9216
    v_cvt_pk_bf16_f32 v120, v24, v25
    v_mfma_f32_32x32x16_bf16 v[56:71], a[88:91], v[112:115], v[56:71]
    v_cvt_pk_bf16_f32 v121, v26, v27
    s_waitcnt lgkmcnt(3)
    v_mfma_f32_32x32x16_bf16 v[40:55], a[28:31], v[116:119], v[40:55]
    ds_read_b128 v[112:115], v5 offset:10240
    v_cvt_pk_bf16_f32 v122, v28, v29
    v_mfma_f32_32x32x16_bf16 v[56:71], a[92:95], v[116:119], v[56:71]
    v_cvt_pk_bf16_f32 v123, v30, v31
    s_waitcnt lgkmcnt(3)
    v_mfma_f32_32x32x16_bf16 v[40:55], a[32:35], v[104:107], v[40:55]
    ds_read_b128 v[116:119], v5 offset:11264
    ds_write_b128 v6, v[120:123] offset:64
    v_mfma_f32_32x32x16_bf16 v[56:71], a[96:99], v[104:107], v[56:71]
    v_cvt_pk_bf16_f32 v124, v32, v33
    s_waitcnt lgkmcnt(3)
    v_mfma_f32_32x32x16_bf16 v[40:55], a[36:39], v[108:111], v[40:55]
    ds_read_b128 v[104:107], v5 offset:12288
    v_cvt_pk_bf16_f32 v125, v34, v35
    v_mfma_f32_32x32x16_bf16 v[56:71], a[100:103], v[108:111], v[56:71]
    v_cvt_pk_bf16_f32 v126, v36, v37
    s_waitcnt lgkmcnt(3)
    v_mfma_f32_32x32x16_bf16 v[40:55], a[40:43], v[112:115], v[40:55]
    ds_read_b128 v[108:111], v5 offset:13312
    v_cvt_pk_bf16_f32 v127, v38, v39
    v_mfma_f32_32x32x16_bf16 v[56:71], a[104:107], v[112:115], v[56:71]
    ds_write_b128 v6, v[124:127] offset:96
    s_waitcnt lgkmcnt(4)
    v_mfma_f32_32x32x16_bf16 v[40:55], a[44:47], v[116:119], v[40:55]
    ds_read_b128 v[112:115], v5 offset:14336
    v_mfma_f32_32x32x16_bf16 v[56:71], a[108:111], v[116:119], v[56:71]
    s_waitcnt lgkmcnt(3)
    v_mfma_f32_32x32x16_bf16 v[40:55], a[48:51], v[104:107], v[40:55]
    ds_read_b128 v[116:119], v5 offset:15360
    v_mfma_f32_32x32x16_bf16 v[56:71], a[112:115], v[104:107], v[56:71]
    s_waitcnt lgkmcnt(3)
    v_mfma_f32_32x32x16_bf16 v[40:55], a[52:55], v[108:111], v[40:55]
    ds_read_b128 v[104:107], v5 offset:16384
    v_mfma_f32_32x32x16_bf16 v[56:71], a[116:119], v[108:111], v[56:71]
    s_waitcnt lgkmcnt(2)
    v_mfma_f32_32x32x16_bf16 v[40:55], a[56:59], v[112:115], v[40:55]
    ds_read_b128 v[108:111], v5 offset:17408
    v_mfma_f32_32x32x16_bf16 v[56:71], a[120:123], v[112:115], v[56:71]
    s_waitcnt lgkmcnt(2)
    v_mfma_f32_32x32x16_bf16 v[40:55], a[60:63], v[116:119], v[40:55]
    ds_read_b128 v[112:115], v5 offset:18432
    v_mfma_f32_32x32x16_bf16 v[56:71], a[124:127], v[116:119], v[56:71]
    s_barrier
    s_waitcnt lgkmcnt(2)
    v_mfma_f32_32x32x16_bf16 v[8:23], a[0:3], v[104:107], v[72:87]
    ds_read_b128 v[116:119], v5 offset:19456
    v_mfma_f32_32x32x16_bf16 v[24:39], a[64:67], v[104:107], v[88:103]
    s_waitcnt lgkmcnt(2)
    v_mfma_f32_32x32x16_bf16 v[8:23], a[4:7], v[108:111], v[8:23]
    ds_read_b128 v[104:107], v5 offset:20480
    v_cvt_pk_bf16_f32 v120, v40, v41
    v_mfma_f32_32x32x16_bf16 v[24:39], a[68:71], v[108:111], v[24:39]
    v_cvt_pk_bf16_f32 v121, v42, v43
    s_waitcnt lgkmcnt(2)
    v_mfma_f32_32x32x16_bf16 v[8:23], a[8:11], v[112:115], v[8:23]
    ds_read_b128 v[108:111], v5 offset:21504
    v_cvt_pk_bf16_f32 v122, v44, v45
    v_mfma_f32_32x32x16_bf16 v[24:39], a[72:75], v[112:115], v[24:39]
    v_cvt_pk_bf16_f32 v123, v46, v47
    s_waitcnt lgkmcnt(2)
    v_mfma_f32_32x32x16_bf16 v[8:23], a[12:15], v[116:119], v[8:23]
    ds_read_b128 v[112:115], v5 offset:22528
    ds_write_b128 v6, v[120:123] offset:16896
    v_mfma_f32_32x32x16_bf16 v[24:39], a[76:79], v[116:119], v[24:39]
    v_cvt_pk_bf16_f32 v124, v48, v49
    s_waitcnt lgkmcnt(3)
    v_mfma_f32_32x32x16_bf16 v[8:23], a[16:19], v[104:107], v[8:23]
    ds_read_b128 v[116:119], v5 offset:23552
    v_cvt_pk_bf16_f32 v125, v50, v51
    v_mfma_f32_32x32x16_bf16 v[24:39], a[80:83], v[104:107], v[24:39]
    v_cvt_pk_bf16_f32 v126, v52, v53
    s_waitcnt lgkmcnt(3)
    v_mfma_f32_32x32x16_bf16 v[8:23], a[20:23], v[108:111], v[8:23]
    ds_read_b128 v[104:107], v5 offset:24576
    v_cvt_pk_bf16_f32 v127, v54, v55
    v_mfma_f32_32x32x16_bf16 v[24:39], a[84:87], v[108:111], v[24:39]
    ds_write_b128 v6, v[124:127] offset:16928
    s_waitcnt lgkmcnt(4)
    v_mfma_f32_32x32x16_bf16 v[8:23], a[24:27], v[112:115], v[8:23]
    ds_read_b128 v[108:111], v5 offset:25600
    v_cvt_pk_bf16_f32 v120, v56, v57
    v_mfma_f32_32x32x16_bf16 v[24:39], a[88:91], v[112:115], v[24:39]
    v_cvt_pk_bf16_f32 v121, v58, v59
    s_waitcnt lgkmcnt(3)
    v_mfma_f32_32x32x16_bf16 v[8:23], a[28:31], v[116:119], v[8:23]
    ds_read_b128 v[112:115], v5 offset:26624
    v_cvt_pk_bf16_f32 v122, v60, v61
    v_mfma_f32_32x32x16_bf16 v[24:39], a[92:95], v[116:119], v[24:39]
    v_cvt_pk_bf16_f32 v123, v62, v63
    s_waitcnt lgkmcnt(3)
    v_mfma_f32_32x32x16_bf16 v[8:23], a[32:35], v[104:107], v[8:23]
    ds_read_b128 v[116:119], v5 offset:27648
    ds_write_b128 v6, v[120:123] offset:16960
    v_mfma_f32_32x32x16_bf16 v[24:39], a[96:99], v[104:107], v[24:39]
    v_cvt_pk_bf16_f32 v124, v64, v65
    s_waitcnt lgkmcnt(3)
    v_mfma_f32_32x32x16_bf16 v[8:23], a[36:39], v[108:111], v[8:23]
    ds_read_b128 v[104:107], v5 offset:28672
    v_cvt_pk_bf16_f32 v125, v66, v67
    v_mfma_f32_32x32x16_bf16 v[24:39], a[100:103], v[108:111], v[24:39]
    v_cvt_pk_bf16_f32 v126, v68, v69
    s_waitcnt lgkmcnt(3)
    v_mfma_f32_32x32x16_bf16 v[8:23], a[40:43], v[112:115], v[8:23]
    ds_read_b128 v[108:111], v5 offset:29696
    v_cvt_pk_bf16_f32 v127, v70, v71
    v_mfma_f32_32x32x16_bf16 v[24:39], a[104:107], v[112:115], v[24:39]
    ds_write_b128 v6, v[124:127] offset:16992
    s_waitcnt lgkmcnt(4)
    v_mfma_f32_32x32x16_bf16 v[8:23], a[44:47], v[116:119], v[8:23]
    ds_read_b128 v[112:115], v5 offset:30720
    v_mfma_f32_32x32x16_bf16 v[24:39], a[108:111], v[116:119], v[24:39]
    s_waitcnt lgkmcnt(3)
    v_mfma_f32_32x32x16_bf16 v[8:23], a[48:51], v[104:107], v[8:23]
    ds_read_b128 v[116:119], v5 offset:31744
    v_mfma_f32_32x32x16_bf16 v[24:39], a[112:115], v[104:107], v[24:39]
    s_waitcnt lgkmcnt(3)
    v_mfma_f32_32x32x16_bf16 v[8:23], a[52:55], v[108:111], v[8:23]
    ds_read_b128 v[104:107], v5 offset:32768
    v_mfma_f32_32x32x16_bf16 v[24:39], a[116:119], v[108:111], v[24:39]
    s_waitcnt lgkmcnt(2)
    v_mfma_f32_32x32x16_bf16 v[8:23], a[56:59], v[112:115], v[8:23]
    ds_read_b128 v[108:111], v5 offset:33792
    v_mfma_f32_32x32x16_bf16 v[24:39], a[120:123], v[112:115], v[24:39]
    s_waitcnt lgkmcnt(2)
    v_mfma_f32_32x32x16_bf16 v[8:23], a[60:63], v[116:119], v[8:23]
    ds_read_b128 v[112:115], v5 offset:34816
    v_mfma_f32_32x32x16_bf16 v[24:39], a[124:127], v[116:119], v[24:39]
    s_barrier
    s_waitcnt lgkmcnt(2)
    v_mfma_f32_32x32x16_bf16 v[40:55], a[0:3], v[104:107], v[72:87]
    ds_read_b128 v[116:119], v5 offset:35840
    v_mfma_f32_32x32x16_bf16 v[56:71], a[64:67], v[104:107], v[88:103]
    s_waitcnt lgkmcnt(2)
    v_mfma_f32_32x32x16_bf16 v[40:55], a[4:7], v[108:111], v[40:55]
    ds_read_b128 v[104:107], v5 offset:36864
    v_cvt_pk_bf16_f32 v120, v8, v9
    v_mfma_f32_32x32x16_bf16 v[56:71], a[68:71], v[108:111], v[56:71]
    v_cvt_pk_bf16_f32 v121, v10, v11
    s_waitcnt lgkmcnt(2)
    v_mfma_f32_32x32x16_bf16 v[40:55], a[8:11], v[112:115], v[40:55]
    ds_read_b128 v[108:111], v5 offset:37888
    v_cvt_pk_bf16_f32 v122, v12, v13
    v_mfma_f32_32x32x16_bf16 v[56:71], a[72:75], v[112:115], v[56:71]
    v_cvt_pk_bf16_f32 v123, v14, v15
    s_waitcnt lgkmcnt(2)
    v_mfma_f32_32x32x16_bf16 v[40:55], a[12:15], v[116:119], v[40:55]
    ds_read_b128 v[112:115], v5 offset:38912
    ds_write_b128 v6, v[120:123] offset:0
    v_mfma_f32_32x32x16_bf16 v[56:71], a[76:79], v[116:119], v[56:71]
    v_cvt_pk_bf16_f32 v124, v16, v17
    s_waitcnt lgkmcnt(3)
    v_mfma_f32_32x32x16_bf16 v[40:55], a[16:19], v[104:107], v[40:55]
    ds_read_b128 v[116:119], v5 offset:39936
    v_cvt_pk_bf16_f32 v125, v18, v19
    v_mfma_f32_32x32x16_bf16 v[56:71], a[80:83], v[104:107], v[56:71]
    v_cvt_pk_bf16_f32 v126, v20, v21
    s_waitcnt lgkmcnt(3)
    v_mfma_f32_32x32x16_bf16 v[40:55], a[20:23], v[108:111], v[40:55]
    ds_read_b128 v[104:107], v5 offset:40960
    v_cvt_pk_bf16_f32 v127, v22, v23
    v_mfma_f32_32x32x16_bf16 v[56:71], a[84:87], v[108:111], v[56:71]
    ds_write_b128 v6, v[124:127] offset:32
    s_waitcnt lgkmcnt(4)
    v_mfma_f32_32x32x16_bf16 v[40:55], a[24:27], v[112:115], v[40:55]
    ds_read_b128 v[108:111], v5 offset:41984
    v_cvt_pk_bf16_f32 v120, v24, v25
    v_mfma_f32_32x32x16_bf16 v[56:71], a[88:91], v[112:115], v[56:71]
    v_cvt_pk_bf16_f32 v121, v26, v27
    s_waitcnt lgkmcnt(3)
    v_mfma_f32_32x32x16_bf16 v[40:55], a[28:31], v[116:119], v[40:55]
    ds_read_b128 v[112:115], v5 offset:43008
    v_cvt_pk_bf16_f32 v122, v28, v29
    v_mfma_f32_32x32x16_bf16 v[56:71], a[92:95], v[116:119], v[56:71]
    v_cvt_pk_bf16_f32 v123, v30, v31
    s_waitcnt lgkmcnt(3)
    v_mfma_f32_32x32x16_bf16 v[40:55], a[32:35], v[104:107], v[40:55]
    ds_read_b128 v[116:119], v5 offset:44032
    ds_write_b128 v6, v[120:123] offset:64
    v_mfma_f32_32x32x16_bf16 v[56:71], a[96:99], v[104:107], v[56:71]
    v_cvt_pk_bf16_f32 v124, v32, v33
    s_waitcnt lgkmcnt(3)
    v_mfma_f32_32x32x16_bf16 v[40:55], a[36:39], v[108:111], v[40:55]
    ds_read_b128 v[104:107], v5 offset:45056
    v_cvt_pk_bf16_f32 v125, v34, v35
    v_mfma_f32_32x32x16_bf16 v[56:71], a[100:103], v[108:111], v[56:71]
    v_cvt_pk_bf16_f32 v126, v36, v37
    s_waitcnt lgkmcnt(3)
    v_mfma_f32_32x32x16_bf16 v[40:55], a[40:43], v[112:115], v[40:55]
    ds_read_b128 v[108:111], v5 offset:46080
    v_cvt_pk_bf16_f32 v127, v38, v39
    v_mfma_f32_32x32x16_bf16 v[56:71], a[104:107], v[112:115], v[56:71]
    ds_write_b128 v6, v[124:127] offset:96
    s_waitcnt lgkmcnt(4)
    v_mfma_f32_32x32x16_bf16 v[40:55], a[44:47], v[116:119], v[40:55]
    ds_read_b128 v[112:115], v5 offset:47104
    v_mfma_f32_32x32x16_bf16 v[56:71], a[108:111], v[116:119], v[56:71]
    s_waitcnt lgkmcnt(3)
    v_mfma_f32_32x32x16_bf16 v[40:55], a[48:51], v[104:107], v[40:55]
    ds_read_b128 v[116:119], v5 offset:48128
    v_mfma_f32_32x32x16_bf16 v[56:71], a[112:115], v[104:107], v[56:71]
    s_waitcnt lgkmcnt(3)
    v_mfma_f32_32x32x16_bf16 v[40:55], a[52:55], v[108:111], v[40:55]
    ds_read_b128 v[104:107], v5 offset:0
    v_mfma_f32_32x32x16_bf16 v[56:71], a[116:119], v[108:111], v[56:71]
    s_waitcnt lgkmcnt(2)
    v_mfma_f32_32x32x16_bf16 v[40:55], a[56:59], v[112:115], v[40:55]
    ds_read_b128 v[108:111], v5 offset:1024
    v_mfma_f32_32x32x16_bf16 v[56:71], a[120:123], v[112:115], v[56:71]
    s_waitcnt lgkmcnt(2)
    v_mfma_f32_32x32x16_bf16 v[40:55], a[60:63], v[116:119], v[40:55]
    ds_read_b128 v[112:115], v5 offset:2048
    v_mfma_f32_32x32x16_bf16 v[56:71], a[124:127], v[116:119], v[56:71]
    s_barrier
    s_waitcnt lgkmcnt(2)
    v_mfma_f32_32x32x16_bf16 v[8:23], a[0:3], v[104:107], v[72:87]
    ds_read_b128 v[116:119], v5 offset:3072
    v_mfma_f32_32x32x16_bf16 v[24:39], a[64:67], v[104:107], v[88:103]
    s_waitcnt lgkmcnt(2)
    v_mfma_f32_32x32x16_bf16 v[8:23], a[4:7], v[108:111], v[8:23]
    ds_read_b128 v[104:107], v5 offset:4096
    v_cvt_pk_bf16_f32 v120, v40, v41
    v_mfma_f32_32x32x16_bf16 v[24:39], a[68:71], v[108:111], v[24:39]
    v_cvt_pk_bf16_f32 v121, v42, v43
    s_waitcnt lgkmcnt(2)
    v_mfma_f32_32x32x16_bf16 v[8:23], a[8:11], v[112:115], v[8:23]
    ds_read_b128 v[108:111], v5 offset:5120
    v_cvt_pk_bf16_f32 v122, v44, v45
    v_mfma_f32_32x32x16_bf16 v[24:39], a[72:75], v[112:115], v[24:39]
    v_cvt_pk_bf16_f32 v123, v46, v47
    s_waitcnt lgkmcnt(2)
    v_mfma_f32_32x32x16_bf16 v[8:23], a[12:15], v[116:119], v[8:23]
    ds_read_b128 v[112:115], v5 offset:6144
    ds_write_b128 v6, v[120:123] offset:16896
    v_mfma_f32_32x32x16_bf16 v[24:39], a[76:79], v[116:119], v[24:39]
    v_cvt_pk_bf16_f32 v124, v48, v49
    s_waitcnt lgkmcnt(3)
    v_mfma_f32_32x32x16_bf16 v[8:23], a[16:19], v[104:107], v[8:23]
    ds_read_b128 v[116:119], v5 offset:7168
    v_cvt_pk_bf16_f32 v125, v50, v51
    v_mfma_f32_32x32x16_bf16 v[24:39], a[80:83], v[104:107], v[24:39]
    v_cvt_pk_bf16_f32 v126, v52, v53
    s_waitcnt lgkmcnt(3)
    v_mfma_f32_32x32x16_bf16 v[8:23], a[20:23], v[108:111], v[8:23]
    ds_read_b128 v[104:107], v5 offset:8192
    v_cvt_pk_bf16_f32 v127, v54, v55
    v_mfma_f32_32x32x16_bf16 v[24:39], a[84:87], v[108:111], v[24:39]
    ds_write_b128 v6, v[124:127] offset:16928
    s_waitcnt lgkmcnt(4)
    v_mfma_f32_32x32x16_bf16 v[8:23], a[24:27], v[112:115], v[8:23]
    ds_read_b128 v[108:111], v5 offset:9216
    v_cvt_pk_bf16_f32 v120, v56, v57
    v_mfma_f32_32x32x16_bf16 v[24:39], a[88:91], v[112:115], v[24:39]
    v_cvt_pk_bf16_f32 v121, v58, v59
    s_waitcnt lgkmcnt(3)
    v_mfma_f32_32x32x16_bf16 v[8:23], a[28:31], v[116:119], v[8:23]
    ds_read_b128 v[112:115], v5 offset:10240
    v_cvt_pk_bf16_f32 v122, v60, v61
    v_mfma_f32_32x32x16_bf16 v[24:39], a[92:95], v[116:119], v[24:39]
    v_cvt_pk_bf16_f32 v123, v62, v63
    s_waitcnt lgkmcnt(3)
    v_mfma_f32_32x32x16_bf16 v[8:23], a[32:35], v[104:107], v[8:23]
    ds_read_b128 v[116:119], v5 offset:11264
    ds_write_b128 v6, v[120:123] offset:16960
    v_mfma_f32_32x32x16_bf16 v[24:39], a[96:99], v[104:107], v[24:39]
    v_cvt_pk_bf16_f32 v124, v64, v65
    s_waitcnt lgkmcnt(3)
    v_mfma_f32_32x32x16_bf16 v[8:23], a[36:39], v[108:111], v[8:23]
    ds_read_b128 v[104:107], v5 offset:12288
    v_cvt_pk_bf16_f32 v125, v66, v67
    v_mfma_f32_32x32x16_bf16 v[24:39], a[100:103], v[108:111], v[24:39]
    v_cvt_pk_bf16_f32 v126, v68, v69
    s_waitcnt lgkmcnt(3)
    v_mfma_f32_32x32x16_bf16 v[8:23], a[40:43], v[112:115], v[8:23]
    ds_read_b128 v[108:111], v5 offset:13312
    v_cvt_pk_bf16_f32 v127, v70, v71
    v_mfma_f32_32x32x16_bf16 v[24:39], a[104:107], v[112:115], v[24:39]
    ds_write_b128 v6, v[124:127] offset:16992
    s_waitcnt lgkmcnt(4)
    v_mfma_f32_32x32x16_bf16 v[8:23], a[44:47], v[116:119], v[8:23]
    ds_read_b128 v[112:115], v5 offset:14336
    v_mfma_f32_32x32x16_bf16 v[24:39], a[108:111], v[116:119], v[24:39]
    s_waitcnt lgkmcnt(3)
    v_mfma_f32_32x32x16_bf16 v[8:23], a[48:51], v[104:107], v[8:23]
    ds_read_b128 v[116:119], v5 offset:15360
    v_mfma_f32_32x32x16_bf16 v[24:39], a[112:115], v[104:107], v[24:39]
    s_waitcnt lgkmcnt(3)
    v_mfma_f32_32x32x16_bf16 v[8:23], a[52:55], v[108:111], v[8:23]
    ds_read_b128 v[104:107], v5 offset:16384
    v_mfma_f32_32x32x16_bf16 v[24:39], a[116:119], v[108:111], v[24:39]
    s_waitcnt lgkmcnt(2)
    v_mfma_f32_32x32x16_bf16 v[8:23], a[56:59], v[112:115], v[8:23]
    ds_read_b128 v[108:111], v5 offset:17408
    v_mfma_f32_32x32x16_bf16 v[24:39], a[120:123], v[112:115], v[24:39]
    s_waitcnt lgkmcnt(2)
    v_mfma_f32_32x32x16_bf16 v[8:23], a[60:63], v[116:119], v[8:23]
    ds_read_b128 v[112:115], v5 offset:18432
    v_mfma_f32_32x32x16_bf16 v[24:39], a[124:127], v[116:119], v[24:39]
    s_barrier
    s_waitcnt lgkmcnt(2)
    v_mfma_f32_32x32x16_bf16 v[40:55], a[0:3], v[104:107], v[72:87]
    ds_read_b128 v[116:119], v5 offset:19456
    v_mfma_f32_32x32x16_bf16 v[56:71], a[64:67], v[104:107], v[88:103]
    s_waitcnt lgkmcnt(2)
    v_mfma_f32_32x32x16_bf16 v[40:55], a[4:7], v[108:111], v[40:55]
    ds_read_b128 v[104:107], v5 offset:20480
    v_cvt_pk_bf16_f32 v120, v8, v9
    v_mfma_f32_32x32x16_bf16 v[56:71], a[68:71], v[108:111], v[56:71]
    v_cvt_pk_bf16_f32 v121, v10, v11
    s_waitcnt lgkmcnt(2)
    v_mfma_f32_32x32x16_bf16 v[40:55], a[8:11], v[112:115], v[40:55]
    ds_read_b128 v[108:111], v5 offset:21504
    v_cvt_pk_bf16_f32 v122, v12, v13
    v_mfma_f32_32x32x16_bf16 v[56:71], a[72:75], v[112:115], v[56:71]
    v_cvt_pk_bf16_f32 v123, v14, v15
    s_waitcnt lgkmcnt(2)
    v_mfma_f32_32x32x16_bf16 v[40:55], a[12:15], v[116:119], v[40:55]
    ds_read_b128 v[112:115], v5 offset:22528
    ds_write_b128 v6, v[120:123] offset:0
    v_mfma_f32_32x32x16_bf16 v[56:71], a[76:79], v[116:119], v[56:71]
    v_cvt_pk_bf16_f32 v124, v16, v17
    s_waitcnt lgkmcnt(3)
    v_mfma_f32_32x32x16_bf16 v[40:55], a[16:19], v[104:107], v[40:55]
    ds_read_b128 v[116:119], v5 offset:23552
    v_cvt_pk_bf16_f32 v125, v18, v19
    v_mfma_f32_32x32x16_bf16 v[56:71], a[80:83], v[104:107], v[56:71]
    v_cvt_pk_bf16_f32 v126, v20, v21
    s_waitcnt lgkmcnt(3)
    v_mfma_f32_32x32x16_bf16 v[40:55], a[20:23], v[108:111], v[40:55]
    ds_read_b128 v[104:107], v5 offset:24576
    v_cvt_pk_bf16_f32 v127, v22, v23
    v_mfma_f32_32x32x16_bf16 v[56:71], a[84:87], v[108:111], v[56:71]
    ds_write_b128 v6, v[124:127] offset:32
    s_waitcnt lgkmcnt(4)
    v_mfma_f32_32x32x16_bf16 v[40:55], a[24:27], v[112:115], v[40:55]
    ds_read_b128 v[108:111], v5 offset:25600
    v_cvt_pk_bf16_f32 v120, v24, v25
    v_mfma_f32_32x32x16_bf16 v[56:71], a[88:91], v[112:115], v[56:71]
    v_cvt_pk_bf16_f32 v121, v26, v27
    s_waitcnt lgkmcnt(3)
    v_mfma_f32_32x32x16_bf16 v[40:55], a[28:31], v[116:119], v[40:55]
    ds_read_b128 v[112:115], v5 offset:26624
    v_cvt_pk_bf16_f32 v122, v28, v29
    v_mfma_f32_32x32x16_bf16 v[56:71], a[92:95], v[116:119], v[56:71]
    v_cvt_pk_bf16_f32 v123, v30, v31
    s_waitcnt lgkmcnt(3)
    v_mfma_f32_32x32x16_bf16 v[40:55], a[32:35], v[104:107], v[40:55]
    ds_read_b128 v[116:119], v5 offset:27648
    ds_write_b128 v6, v[120:123] offset:64
    v_mfma_f32_32x32x16_bf16 v[56:71], a[96:99], v[104:107], v[56:71]
    v_cvt_pk_bf16_f32 v124, v32, v33
    s_waitcnt lgkmcnt(3)
    v_mfma_f32_32x32x16_bf16 v[40:55], a[36:39], v[108:111], v[40:55]
    ds_read_b128 v[104:107], v5 offset:28672
    v_cvt_pk_bf16_f32 v125, v34, v35
    v_mfma_f32_32x32x16_bf16 v[56:71], a[100:103], v[108:111], v[56:71]
    v_cvt_pk_bf16_f32 v126, v36, v37
    s_waitcnt lgkmcnt(3)
    v_mfma_f32_32x32x16_bf16 v[40:55], a[40:43], v[112:115], v[40:55]
    ds_read_b128 v[108:111], v5 offset:29696
    v_cvt_pk_bf16_f32 v127, v38, v39
    v_mfma_f32_32x32x16_bf16 v[56:71], a[104:107], v[112:115], v[56:71]
    ds_write_b128 v6, v[124:127] offset:96
    s_waitcnt lgkmcnt(4)
    v_mfma_f32_32x32x16_bf16 v[40:55], a[44:47], v[116:119], v[40:55]
    ds_read_b128 v[112:115], v5 offset:30720
    v_mfma_f32_32x32x16_bf16 v[56:71], a[108:111], v[116:119], v[56:71]
    s_waitcnt lgkmcnt(3)
    v_mfma_f32_32x32x16_bf16 v[40:55], a[48:51], v[104:107], v[40:55]
    ds_read_b128 v[116:119], v5 offset:31744
    v_mfma_f32_32x32x16_bf16 v[56:71], a[112:115], v[104:107], v[56:71]
    s_waitcnt lgkmcnt(3)
    v_mfma_f32_32x32x16_bf16 v[40:55], a[52:55], v[108:111], v[40:55]
    v_mfma_f32_32x32x16_bf16 v[56:71], a[116:119], v[108:111], v[56:71]
    s_waitcnt lgkmcnt(1)
    v_mfma_f32_32x32x16_bf16 v[40:55], a[56:59], v[112:115], v[40:55]
    v_mfma_f32_32x32x16_bf16 v[56:71], a[120:123], v[112:115], v[56:71]
    s_waitcnt lgkmcnt(0)
    v_mfma_f32_32x32x16_bf16 v[40:55], a[60:63], v[116:119], v[40:55]
    v_mfma_f32_32x32x16_bf16 v[56:71], a[124:127], v[116:119], v[56:71]
    s_barrier
    s_nop 7
    s_nop 7
    v_cvt_pk_bf16_f32 v120, v40, v41
    v_cvt_pk_bf16_f32 v121, v42, v43
    v_cvt_pk_bf16_f32 v122, v44, v45
    v_cvt_pk_bf16_f32 v123, v46, v47
    ds_write_b128 v6, v[120:123] offset:16896
    v_cvt_pk_bf16_f32 v124, v48, v49
    v_cvt_pk_bf16_f32 v125, v50, v51
    v_cvt_pk_bf16_f32 v126, v52, v53
    v_cvt_pk_bf16_f32 v127, v54, v55
    ds_write_b128 v6, v[124:127] offset:16928
    v_cvt_pk_bf16_f32 v120, v56, v57
    v_cvt_pk_bf16_f32 v121, v58, v59
    v_cvt_pk_bf16_f32 v122, v60, v61
    v_cvt_pk_bf16_f32 v123, v62, v63
    ds_write_b128 v6, v[120:123] offset:16960
    v_cvt_pk_bf16_f32 v124, v64, v65
    v_cvt_pk_bf16_f32 v125, v66, v67
    v_cvt_pk_bf16_f32 v126, v68, v69
    v_cvt_pk_bf16_f32 v127, v70, v71
    ds_write_b128 v6, v[124:127] offset:16992
    s_waitcnt lgkmcnt(0)
    s_barrier
    s_endpgm
L_joint_kernel_helper:
    s_add_u32 s36, s38, 32768
    buffer_load_dwordx4 a[0:3], v5, s[12:15], s36 offen
    s_add_u32 s36, s38, 49152
    buffer_load_dwordx4 a[64:67], v5, s[12:15], s36 offen
    s_add_u32 s36, s38, 33792
    buffer_load_dwordx4 a[4:7], v5, s[12:15], s36 offen
    s_add_u32 s36, s38, 50176
    buffer_load_dwordx4 a[68:71], v5, s[12:15], s36 offen
    s_add_u32 s36, s38, 34816
    buffer_load_dwordx4 a[8:11], v5, s[12:15], s36 offen
    s_add_u32 s36, s38, 51200
    buffer_load_dwordx4 a[72:75], v5, s[12:15], s36 offen
    s_add_u32 s36, s38, 35840
    buffer_load_dwordx4 a[12:15], v5, s[12:15], s36 offen
    s_add_u32 s36, s38, 52224
    buffer_load_dwordx4 a[76:79], v5, s[12:15], s36 offen
    s_add_u32 s36, s38, 36864
    buffer_load_dwordx4 a[16:19], v5, s[12:15], s36 offen
    s_add_u32 s36, s38, 53248
    buffer_load_dwordx4 a[80:83], v5, s[12:15], s36 offen
    s_add_u32 s36, s38, 37888
    buffer_load_dwordx4 a[20:23], v5, s[12:15], s36 offen
    s_add_u32 s36, s38, 54272
    buffer_load_dwordx4 a[84:87], v5, s[12:15], s36 offen
    s_add_u32 s36, s38, 38912
    buffer_load_dwordx4 a[24:27], v5, s[12:15], s36 offen
    s_add_u32 s36, s38, 55296
    buffer_load_dwordx4 a[88:91], v5, s[12:15], s36 offen
    s_add_u32 s36, s38, 39936
    buffer_load_dwordx4 a[28:31], v5, s[12:15], s36 offen
    s_add_u32 s36, s38, 56320
    buffer_load_dwordx4 a[92:95], v5, s[12:15], s36 offen
    s_add_u32 s36, s38, 40960
    buffer_load_dwordx4 a[32:35], v5, s[12:15], s36 offen
    s_add_u32 s36, s38, 57344
    buffer_load_dwordx4 a[96:99], v5, s[12:15], s36 offen
    s_add_u32 s36, s38, 41984
    buffer_load_dwordx4 a[36:39], v5, s[12:15], s36 offen
    s_add_u32 s36, s38, 58368
    buffer_load_dwordx4 a[100:103], v5, s[12:15], s36 offen
    s_add_u32 s36, s38, 43008
    buffer_load_dwordx4 a[40:43], v5, s[12:15], s36 offen
    s_add_u32 s36, s38, 59392
    buffer_load_dwordx4 a[104:107], v5, s[12:15], s36 offen
    s_add_u32 s36, s38, 44032
    buffer_load_dwordx4 a[44:47], v5, s[12:15], s36 offen
    s_add_u32 s36, s38, 60416
    buffer_load_dwordx4 a[108:111], v5, s[12:15], s36 offen
    s_add_u32 s36, s38, 45056
    buffer_load_dwordx4 a[48:51], v5, s[12:15], s36 offen
    s_add_u32 s36, s38, 61440
    buffer_load_dwordx4 a[112:115], v5, s[12:15], s36 offen
    s_add_u32 s36, s38, 46080
    buffer_load_dwordx4 a[52:55], v5, s[12:15], s36 offen
    s_add_u32 s36, s38, 62464
    buffer_load_dwordx4 a[116:119], v5, s[12:15], s36 offen
    s_add_u32 s36, s38, 47104
    buffer_load_dwordx4 a[56:59], v5, s[12:15], s36 offen
    s_add_u32 s36, s38, 63488
    buffer_load_dwordx4 a[120:123], v5, s[12:15], s36 offen
    s_add_u32 s36, s38, 48128
    buffer_load_dwordx4 a[60:63], v5, s[12:15], s36 offen
    s_add_u32 s36, s38, 64512
    buffer_load_dwordx4 a[124:127], v5, s[12:15], s36 offen
    v_and_b32 v45, 7, v1
    v_lshlrev_b32 v45, 10, v45
    v_lshrrev_b32 v46, 5, v1
    v_lshl_add_u32 v45, v46, 4, v45
    s_lshl_b32 s36, s24, 13
    s_lshl_b32 s37, s21, 8
    s_add_u32 s36, s36, s37
    s_add_u32 s37, s36, 16384
    buffer_load_dwordx4 v[96:99], v45, s[12:15], s37 offen offset:0
    buffer_load_dwordx4 v[100:103], v45, s[12:15], s37 offen offset:32
    buffer_load_dwordx4 v[104:107], v45, s[12:15], s37 offen offset:64
    buffer_load_dwordx4 v[108:111], v45, s[12:15], s37 offen offset:96
    buffer_load_dwordx4 v[112:115], v45, s[12:15], s37 offen offset:128
    buffer_load_dwordx4 v[116:119], v45, s[12:15], s37 offen offset:160
    buffer_load_dwordx4 v[120:123], v45, s[12:15], s37 offen offset:192
    buffer_load_dwordx4 v[124:127], v45, s[12:15], s37 offen offset:224
    s_barrier
    v_add_u32 v7, 65536, v5
    ds_read_b128 v[64:67], v7 offset:0
    ds_read_b128 v[68:71], v7 offset:1024
    ds_read_b128 v[72:75], v7 offset:2048
    ds_read_b128 v[76:79], v7 offset:3072
    ds_read_b128 v[80:83], v7 offset:4096
    ds_read_b128 v[84:87], v7 offset:5120
    ds_read_b128 v[88:91], v7 offset:6144
    ds_read_b128 v[92:95], v7 offset:7168
    s_waitcnt lgkmcnt(0)
    s_waitcnt vmcnt(38)
    v_mfma_f32_32x32x16_bf16 v[32:47], a[0:3], v[64:67], 0
    v_mfma_f32_32x32x16_bf16 v[48:63], a[64:67], v[64:67], 0
    s_waitcnt vmcnt(36)
    v_mfma_f32_32x32x16_bf16 v[32:47], a[4:7], v[68:71], v[32:47]
    v_mfma_f32_32x32x16_bf16 v[48:63], a[68:71], v[68:71], v[48:63]
    s_waitcnt vmcnt(34)
    v_mfma_f32_32x32x16_bf16 v[32:47], a[8:11], v[72:75], v[32:47]
    v_mfma_f32_32x32x16_bf16 v[48:63], a[72:75], v[72:75], v[48:63]
    s_waitcnt vmcnt(32)
    v_mfma_f32_32x32x16_bf16 v[32:47], a[12:15], v[76:79], v[32:47]
    v_mfma_f32_32x32x16_bf16 v[48:63], a[76:79], v[76:79], v[48:63]
    s_waitcnt vmcnt(30)
    v_mfma_f32_32x32x16_bf16 v[32:47], a[16:19], v[80:83], v[32:47]
    v_mfma_f32_32x32x16_bf16 v[48:63], a[80:83], v[80:83], v[48:63]
    s_waitcnt vmcnt(28)
    v_mfma_f32_32x32x16_bf16 v[32:47], a[20:23], v[84:87], v[32:47]
    v_mfma_f32_32x32x16_bf16 v[48:63], a[84:87], v[84:87], v[48:63]
    s_waitcnt vmcnt(26)
    v_mfma_f32_32x32x16_bf16 v[32:47], a[24:27], v[88:91], v[32:47]
    v_mfma_f32_32x32x16_bf16 v[48:63], a[88:91], v[88:91], v[48:63]
    s_waitcnt vmcnt(24)
    v_mfma_f32_32x32x16_bf16 v[32:47], a[28:31], v[92:95], v[32:47]
    v_mfma_f32_32x32x16_bf16 v[48:63], a[92:95], v[92:95], v[48:63]
    ds_read_b128 v[64:67], v7 offset:8192
    ds_read_b128 v[68:71], v7 offset:9216
    ds_read_b128 v[72:75], v7 offset:10240
    ds_read_b128 v[76:79], v7 offset:11264
    ds_read_b128 v[80:83], v7 offset:12288
    ds_read_b128 v[84:87], v7 offset:13312
    ds_read_b128 v[88:91], v7 offset:14336
    ds_read_b128 v[92:95], v7 offset:15360
    s_waitcnt lgkmcnt(0)
    s_waitcnt vmcnt(22)
    v_mfma_f32_32x32x16_bf16 v[32:47], a[32:35], v[64:67], v[32:47]
    v_mfma_f32_32x32x16_bf16 v[48:63], a[96:99], v[64:67], v[48:63]
    s_waitcnt vmcnt(20)
    v_mfma_f32_32x32x16_bf16 v[32:47], a[36:39], v[68:71], v[32:47]
    v_mfma_f32_32x32x16_bf16 v[48:63], a[100:103], v[68:71], v[48:63]
    s_waitcnt vmcnt(18)
    v_mfma_f32_32x32x16_bf16 v[32:47], a[40:43], v[72:75], v[32:47]
    v_mfma_f32_32x32x16_bf16 v[48:63], a[104:107], v[72:75], v[48:63]
    s_waitcnt vmcnt(16)
    v_mfma_f32_32x32x16_bf16 v[32:47], a[44:47], v[76:79], v[32:47]
    v_mfma_f32_32x32x16_bf16 v[48:63], a[108:111], v[76:79], v[48:63]
    s_waitcnt vmcnt(14)
    v_mfma_f32_32x32x16_bf16 v[32:47], a[48:51], v[80:83], v[32:47]
    v_mfma_f32_32x32x16_bf16 v[48:63], a[112:115], v[80:83], v[48:63]
    s_waitcnt vmcnt(12)
    v_mfma_f32_32x32x16_bf16 v[32:47], a[52:55], v[84:87], v[32:47]
    v_mfma_f32_32x32x16_bf16 v[48:63], a[116:119], v[84:87], v[48:63]
    s_waitcnt vmcnt(10)
    v_mfma_f32_32x32x16_bf16 v[32:47], a[56:59], v[88:91], v[32:47]
    v_mfma_f32_32x32x16_bf16 v[48:63], a[120:123], v[88:91], v[48:63]
    s_waitcnt vmcnt(8)
    v_mfma_f32_32x32x16_bf16 v[32:47], a[60:63], v[92:95], v[32:47]
    v_mfma_f32_32x32x16_bf16 v[48:63], a[124:127], v[92:95], v[48:63]
    s_waitcnt vmcnt(0)
    v_max3_f32 v8, |v96|, |v97|, |v98|
    v_max3_f32 v8, v8, |v99|, |v100|
    v_max3_f32 v8, v8, |v101|, |v102|
    v_max3_f32 v8, v8, |v103|, |v104|
    v_max3_f32 v8, v8, |v105|, |v106|
    v_max3_f32 v8, v8, |v107|, |v108|
    v_max3_f32 v8, v8, |v109|, |v110|
    v_max3_f32 v8, v8, |v111|, |v112|
    v_max3_f32 v8, v8, |v113|, |v114|
    v_max3_f32 v8, v8, |v115|, |v116|
    v_max3_f32 v8, v8, |v117|, |v118|
    v_max3_f32 v8, v8, |v119|, |v120|
    v_max3_f32 v8, v8, |v121|, |v122|
    v_max3_f32 v8, v8, |v123|, |v124|
    v_max3_f32 v8, v8, |v125|, |v126|
    v_max_f32 v8, v8, |v127|
    s_mov_b32 s41, 0x42a80000
    v_cmp_lt_f32 s[42:43], s41, v8
    s_lshl_b32 s36, s21, 12
    v_add_u32 v2, s36, v5
    v_lshrrev_b32 v10, 5, v1
    v_lshlrev_b32 v11, 4, v10
    s_lshl_b32 s36, s21, 8
    s_add_u32 s36, s36, 81920
    v_add_u32 v11, s36, v11
    v_and_b32 v12, 31, v1
    v_mul_u32_u24 v13, 1056, v12
    v_add_u32 v9, v11, v13
    v_lshrrev_b32 v13, 3, v12
    v_mul_u32_u24 v13, 1056, v13
    v_add_u32 v4, v11, v13
    s_lshl_b32 s36, s21, 3
    v_add_u32 v10, s36, v10
    v_mul_u32_u24 v13, 528, v10
    v_lshl_add_u32 v13, v12, 4, v13
    v_add_u32 v6, 115712, v13
    v_lshlrev_b32 v13, 9, v10
    v_lshl_add_u32 v7, v12, 4, v13
    s_mov_b32 s41, 0x4038aa3b
    v_mul_f32 v64, s41, v32
    v_mul_f32 v65, s41, v33
    v_mul_f32 v66, s41, v34
    v_mul_f32 v67, s41, v35
    v_mul_f32 v68, s41, v36
    v_mul_f32 v69, s41, v37
    v_mul_f32 v70, s41, v38
    v_mul_f32 v71, s41, v39
    v_mul_f32 v72, s41, v40
    v_mul_f32 v73, s41, v41
    v_mul_f32 v74, s41, v42
    v_mul_f32 v75, s41, v43
    v_mul_f32 v76, s41, v44
    v_mul_f32 v77, s41, v45
    v_mul_f32 v78, s41, v46
    v_mul_f32 v79, s41, v47
    v_mul_f32 v80, s41, v48
    v_mul_f32 v81, s41, v49
    v_mul_f32 v82, s41, v50
    v_mul_f32 v83, s41, v51
    v_mul_f32 v84, s41, v52
    v_mul_f32 v85, s41, v53
    v_mul_f32 v86, s41, v54
    v_mul_f32 v87, s41, v55
    v_mul_f32 v88, s41, v56
    v_mul_f32 v89, s41, v57
    v_mul_f32 v90, s41, v58
    v_mul_f32 v91, s41, v59
    v_mul_f32 v92, s41, v60
    v_mul_f32 v93, s41, v61
    v_mul_f32 v94, s41, v62
    v_mul_f32 v95, s41, v63
    v_max3_f32 v8, |v64|, |v65|, |v66|
    v_max3_f32 v8, v8, |v67|, |v68|
    v_max3_f32 v8, v8, |v69|, |v70|
    v_max3_f32 v8, v8, |v71|, |v72|
    v_max3_f32 v8, v8, |v73|, |v74|
    v_max3_f32 v8, v8, |v75|, |v76|
    v_max3_f32 v8, v8, |v77|, |v78|
    v_max3_f32 v8, v8, |v79|, |v80|
    v_max3_f32 v8, v8, |v81|, |v82|
    v_max3_f32 v8, v8, |v83|, |v84|
    v_max3_f32 v8, v8, |v85|, |v86|
    v_max3_f32 v8, v8, |v87|, |v88|
    v_max3_f32 v8, v8, |v89|, |v90|
    v_max3_f32 v8, v8, |v91|, |v92|
    v_max3_f32 v8, v8, |v93|, |v94|
    v_max_f32 v8, v8, |v95|
    s_mov_b32 s41, 0x42200000
    v_cmp_lt_f32 vcc, s41, v8
    s_nop 3
    s_or_b64 s[42:43], s[42:43], vcc
    s_cmp_lg_u64 s[42:43], 0
    s_cselect_b32 s44, 1, 0
    s_cmp_lg_u32 s44, 0
    s_cbranch_scc1 L_joint_kernel_slow
    v_exp_f32 v32, v64
    v_exp_f32 v33, v65
    v_exp_f32 v34, v66
    v_exp_f32 v35, v67
    v_exp_f32 v36, v68
    v_exp_f32 v37, v69
    v_exp_f32 v38, v70
    v_exp_f32 v39, v71
    v_exp_f32 v40, v72
    v_exp_f32 v41, v73
    v_exp_f32 v42, v74
    v_exp_f32 v43, v75
    v_exp_f32 v44, v76
    v_exp_f32 v45, v77
    v_exp_f32 v46, v78
    v_exp_f32 v47, v79
    v_exp_f32 v48, v80
    v_exp_f32 v49, v81
    v_exp_f32 v50, v82
    v_exp_f32 v51, v83
    v_exp_f32 v52, v84
    v_exp_f32 v53, v85
    v_exp_f32 v54, v86
    v_exp_f32 v55, v87
    v_exp_f32 v56, v88
    v_exp_f32 v57, v89
    v_exp_f32 v58, v90
    v_exp_f32 v59, v91
    v_exp_f32 v60, v92
    v_exp_f32 v61, v93
    v_exp_f32 v62, v94
    v_exp_f32 v63, v95
    v_exp_f32 v96, v96
    v_exp_f32 v97, v97
    v_exp_f32 v98, v98
    v_exp_f32 v99, v99
    v_exp_f32 v100, v100
    v_exp_f32 v101, v101
    v_exp_f32 v102, v102
    v_exp_f32 v103, v103
    v_exp_f32 v104, v104
    v_exp_f32 v105, v105
    v_exp_f32 v106, v106
    v_exp_f32 v107, v107
    v_exp_f32 v108, v108
    v_exp_f32 v109, v109
    v_exp_f32 v110, v110
    v_exp_f32 v111, v111
    v_exp_f32 v112, v112
    v_exp_f32 v113, v113
    v_exp_f32 v114, v114
    v_exp_f32 v115, v115
    v_exp_f32 v116, v116
    v_exp_f32 v117, v117
    v_exp_f32 v118, v118
    v_exp_f32 v119, v119
    v_exp_f32 v120, v120
    v_exp_f32 v121, v121
    v_exp_f32 v122, v122
    v_exp_f32 v123, v123
    v_exp_f32 v124, v124
    v_exp_f32 v125, v125
    v_exp_f32 v126, v126
    v_exp_f32 v127, v127
    ds_write_b128 v9, v[32:35] offset:0
    ds_write_b128 v9, v[36:39] offset:32
    ds_write_b128 v9, v[40:43] offset:64
    ds_write_b128 v9, v[44:47] offset:96
    ds_write_b128 v9, v[48:51] offset:128
    ds_write_b128 v9, v[52:55] offset:160
    ds_write_b128 v9, v[56:59] offset:192
    ds_write_b128 v9, v[60:63] offset:224
    s_waitcnt lgkmcnt(0)
    ds_read_b128 v[32:35], v4 offset:0
    ds_read_b128 v[36:39], v4 offset:32
    ds_read_b128 v[40:43], v4 offset:64
    ds_read_b128 v[44:47], v4 offset:96
    ds_read_b128 v[48:51], v4 offset:128
    ds_read_b128 v[52:55], v4 offset:160
    ds_read_b128 v[56:59], v4 offset:192
    ds_read_b128 v[60:63], v4 offset:224
    s_waitcnt lgkmcnt(6)
    v_fma_f32 v64, v32, v96, 1.0
    v_fma_f32 v65, v33, v97, 1.0
    v_fma_f32 v66, v34, v98, 1.0
    v_fma_f32 v67, v35, v99, 1.0
    v_fma_f32 v68, v36, v100, 1.0
    v_fma_f32 v69, v37, v101, 1.0
    v_fma_f32 v70, v38, v102, 1.0
    v_fma_f32 v71, v39, v103, 1.0
    ds_read_b128 v[32:35], v4 offset:4224
    ds_read_b128 v[36:39], v4 offset:4256
    v_rcp_f32 v64, v64
    v_rcp_f32 v65, v65
    v_rcp_f32 v66, v66
    v_rcp_f32 v67, v67
    v_rcp_f32 v68, v68
    v_rcp_f32 v69, v69
    v_rcp_f32 v70, v70
    v_rcp_f32 v71, v71
    s_nop 0
    v_cvt_pk_bf16_f32 v80, v64, v65
    v_cvt_pk_bf16_f32 v81, v66, v67
    v_cvt_pk_bf16_f32 v82, v68, v69
    v_cvt_pk_bf16_f32 v83, v70, v71
    ds_write_b128 v2, v[80:83] offset:0
    s_waitcnt lgkmcnt(7)
    v_fma_f32 v72, v40, v104, 1.0
    v_fma_f32 v73, v41, v105, 1.0
    v_fma_f32 v74, v42, v106, 1.0
    v_fma_f32 v75, v43, v107, 1.0
    v_fma_f32 v76, v44, v108, 1.0
    v_fma_f32 v77, v45, v109, 1.0
    v_fma_f32 v78, v46, v110, 1.0
    v_fma_f32 v79, v47, v111, 1.0
    ds_read_b128 v[40:43], v4 offset:4288
    ds_read_b128 v[44:47], v4 offset:4320
    v_rcp_f32 v72, v72
    v_rcp_f32 v73, v73
    v_rcp_f32 v74, v74
    v_rcp_f32 v75, v75
    v_rcp_f32 v76, v76
    v_rcp_f32 v77, v77
    v_rcp_f32 v78, v78
    v_rcp_f32 v79, v79
    s_nop 0
    v_cvt_pk_bf16_f32 v84, v72, v73
    v_cvt_pk_bf16_f32 v85, v74, v75
    v_cvt_pk_bf16_f32 v86, v76, v77
    v_cvt_pk_bf16_f32 v87, v78, v79
    ds_write_b128 v2, v[84:87] offset:1024
    s_waitcnt lgkmcnt(8)
    v_fma_f32 v64, v48, v112, 1.0
    v_fma_f32 v65, v49, v113, 1.0
    v_fma_f32 v66, v50, v114, 1.0
    v_fma_f32 v67, v51, v115, 1.0
    v_fma_f32 v68, v52, v116, 1.0
    v_fma_f32 v69, v53, v117, 1.0
    v_fma_f32 v70, v54, v118, 1.0
    v_fma_f32 v71, v55, v119, 1.0
    ds_read_b128 v[48:51], v4 offset:4352
    ds_read_b128 v[52:55], v4 offset:4384
    v_rcp_f32 v64, v64
    v_rcp_f32 v65, v65
    v_rcp_f32 v66, v66
    v_rcp_f32 v67, v67
    v_rcp_f32 v68, v68
    v_rcp_f32 v69, v69
    v_rcp_f32 v70, v70
    v_rcp_f32 v71, v71
    s_nop 0
    v_cvt_pk_bf16_f32 v80, v64, v65
    v_cvt_pk_bf16_f32 v81, v66, v67
    v_cvt_pk_bf16_f32 v82, v68, v69
    v_cvt_pk_bf16_f32 v83, v70, v71
    ds_write_b128 v2, v[80:83] offset:2048
    s_waitcnt lgkmcnt(9)
    v_fma_f32 v72, v56, v120, 1.0
    v_fma_f32 v73, v57, v121, 1.0
    v_fma_f32 v74, v58, v122, 1.0
    v_fma_f32 v75, v59, v123, 1.0
    v_fma_f32 v76, v60, v124, 1.0
    v_fma_f32 v77, v61, v125, 1.0
    v_fma_f32 v78, v62, v126, 1.0
    v_fma_f32 v79, v63, v127, 1.0
    ds_read_b128 v[56:59], v4 offset:4416
    ds_read_b128 v[60:63], v4 offset:4448
    v_rcp_f32 v72, v72
    v_rcp_f32 v73, v73
    v_rcp_f32 v74, v74
    v_rcp_f32 v75, v75
    v_rcp_f32 v76, v76
    v_rcp_f32 v77, v77
    v_rcp_f32 v78, v78
    v_rcp_f32 v79, v79
    s_nop 0
    v_cvt_pk_bf16_f32 v84, v72, v73
    v_cvt_pk_bf16_f32 v85, v74, v75
    v_cvt_pk_bf16_f32 v86, v76, v77
    v_cvt_pk_bf16_f32 v87, v78, v79
    ds_write_b128 v2, v[84:87] offset:3072
    s_waitcnt lgkmcnt(10)
    v_fma_f32 v64, v32, v96, 1.0
    v_fma_f32 v65, v33, v97, 1.0
    v_fma_f32 v66, v34, v98, 1.0
    v_fma_f32 v67, v35, v99, 1.0
    v_fma_f32 v68, v36, v100, 1.0
    v_fma_f32 v69, v37, v101, 1.0
    v_fma_f32 v70, v38, v102, 1.0
    v_fma_f32 v71, v39, v103, 1.0
    ds_read_b128 v[32:35], v4 offset:8448
    ds_read_b128 v[36:39], v4 offset:8480
    v_rcp_f32 v64, v64
    v_rcp_f32 v65, v65
    v_rcp_f32 v66, v66
    v_rcp_f32 v67, v67
    v_rcp_f32 v68, v68
    v_rcp_f32 v69, v69
    v_rcp_f32 v70, v70
    v_rcp_f32 v71, v71
    s_nop 0
    v_cvt_pk_bf16_f32 v80, v64, v65
    v_cvt_pk_bf16_f32 v81, v66, v67
    v_cvt_pk_bf16_f32 v82, v68, v69
    v_cvt_pk_bf16_f32 v83, v70, v71
    ds_write_b128 v2, v[80:83] offset:16384
    s_waitcnt lgkmcnt(10)
    v_fma_f32 v72, v40, v104, 1.0
    v_fma_f32 v73, v41, v105, 1.0
    v_fma_f32 v74, v42, v106, 1.0
    v_fma_f32 v75, v43, v107, 1.0
    v_fma_f32 v76, v44, v108, 1.0
    v_fma_f32 v77, v45, v109, 1.0
    v_fma_f32 v78, v46, v110, 1.0
    v_fma_f32 v79, v47, v111, 1.0
    ds_read_b128 v[40:43], v4 offset:8512
    ds_read_b128 v[44:47], v4 offset:8544
    v_rcp_f32 v72, v72
    v_rcp_f32 v73, v73
    v_rcp_f32 v74, v74
    v_rcp_f32 v75, v75
    v_rcp_f32 v76, v76
    v_rcp_f32 v77, v77
    v_rcp_f32 v78, v78
    v_rcp_f32 v79, v79
    s_nop 0
    v_cvt_pk_bf16_f32 v84, v72, v73
    v_cvt_pk_bf16_f32 v85, v74, v75
    v_cvt_pk_bf16_f32 v86, v76, v77
    v_cvt_pk_bf16_f32 v87, v78, v79
    ds_write_b128 v2, v[84:87] offset:17408
    s_waitcnt lgkmcnt(10)
    v_fma_f32 v64, v48, v112, 1.0
    v_fma_f32 v65, v49, v113, 1.0
    v_fma_f32 v66, v50, v114, 1.0
    v_fma_f32 v67, v51, v115, 1.0
    v_fma_f32 v68, v52, v116, 1.0
    v_fma_f32 v69, v53, v117, 1.0
    v_fma_f32 v70, v54, v118, 1.0
    v_fma_f32 v71, v55, v119, 1.0
    ds_read_b128 v[48:51], v4 offset:8576
    ds_read_b128 v[52:55], v4 offset:8608
    v_rcp_f32 v64, v64
    v_rcp_f32 v65, v65
    v_rcp_f32 v66, v66
    v_rcp_f32 v67, v67
    v_rcp_f32 v68, v68
    v_rcp_f32 v69, v69
    v_rcp_f32 v70, v70
    v_rcp_f32 v71, v71
    s_nop 0
    v_cvt_pk_bf16_f32 v80, v64, v65
    v_cvt_pk_bf16_f32 v81, v66, v67
    v_cvt_pk_bf16_f32 v82, v68, v69
    v_cvt_pk_bf16_f32 v83, v70, v71
    ds_write_b128 v2, v[80:83] offset:18432
    s_waitcnt lgkmcnt(10)
    v_fma_f32 v72, v56, v120, 1.0
    v_fma_f32 v73, v57, v121, 1.0
    v_fma_f32 v74, v58, v122, 1.0
    v_fma_f32 v75, v59, v123, 1.0
    v_fma_f32 v76, v60, v124, 1.0
    v_fma_f32 v77, v61, v125, 1.0
    v_fma_f32 v78, v62, v126, 1.0
    v_fma_f32 v79, v63, v127, 1.0
    ds_read_b128 v[56:59], v4 offset:8640
    ds_read_b128 v[60:63], v4 offset:8672
    v_rcp_f32 v72, v72
    v_rcp_f32 v73, v73
    v_rcp_f32 v74, v74
    v_rcp_f32 v75, v75
    v_rcp_f32 v76, v76
    v_rcp_f32 v77, v77
    v_rcp_f32 v78, v78
    v_rcp_f32 v79, v79
    s_nop 0
    v_cvt_pk_bf16_f32 v84, v72, v73
    v_cvt_pk_bf16_f32 v85, v74, v75
    v_cvt_pk_bf16_f32 v86, v76, v77
    v_cvt_pk_bf16_f32 v87, v78, v79
    ds_write_b128 v2, v[84:87] offset:19456
    s_waitcnt lgkmcnt(0)
    s_barrier
    v_fma_f32 v64, v32, v96, 1.0
    v_fma_f32 v65, v33, v97, 1.0
    v_fma_f32 v66, v34, v98, 1.0
    v_fma_f32 v67, v35, v99, 1.0
    v_fma_f32 v68, v36, v100, 1.0
    v_fma_f32 v69, v37, v101, 1.0
    v_fma_f32 v70, v38, v102, 1.0
    v_fma_f32 v71, v39, v103, 1.0
    ds_read_b128 v[32:35], v4 offset:12672
    ds_read_b128 v[36:39], v4 offset:12704
    v_rcp_f32 v64, v64
    v_rcp_f32 v65, v65
    v_rcp_f32 v66, v66
    v_rcp_f32 v67, v67
    v_rcp_f32 v68, v68
    v_rcp_f32 v69, v69
    v_rcp_f32 v70, v70
    v_rcp_f32 v71, v71
    s_nop 0
    v_cvt_pk_bf16_f32 v80, v64, v65
    v_cvt_pk_bf16_f32 v81, v66, v67
    v_cvt_pk_bf16_f32 v82, v68, v69
    v_cvt_pk_bf16_f32 v83, v70, v71
    ds_write_b128 v2, v[80:83] offset:32768
    v_fma_f32 v72, v40, v104, 1.0
    v_fma_f32 v73, v41, v105, 1.0
    v_fma_f32 v74, v42, v106, 1.0
    v_fma_f32 v75, v43, v107, 1.0
    v_fma_f32 v76, v44, v108, 1.0
    v_fma_f32 v77, v45, v109, 1.0
    v_fma_f32 v78, v46, v110, 1.0
    v_fma_f32 v79, v47, v111, 1.0
    ds_read_b128 v[40:43], v4 offset:12736
    ds_read_b128 v[44:47], v4 offset:12768
    v_rcp_f32 v72, v72
    v_rcp_f32 v73, v73
    v_rcp_f32 v74, v74
    v_rcp_f32 v75, v75
    v_rcp_f32 v76, v76
    v_rcp_f32 v77, v77
    v_rcp_f32 v78, v78
    v_rcp_f32 v79, v79
    s_nop 0
    v_cvt_pk_bf16_f32 v84, v72, v73
    v_cvt_pk_bf16_f32 v85, v74, v75
    v_cvt_pk_bf16_f32 v86, v76, v77
    v_cvt_pk_bf16_f32 v87, v78, v79
    ds_write_b128 v2, v[84:87] offset:33792
    v_fma_f32 v64, v48, v112, 1.0
    v_fma_f32 v65, v49, v113, 1.0
    v_fma_f32 v66, v50, v114, 1.0
    v_fma_f32 v67, v51, v115, 1.0
    v_fma_f32 v68, v52, v116, 1.0
    v_fma_f32 v69, v53, v117, 1.0
    v_fma_f32 v70, v54, v118, 1.0
    v_fma_f32 v71, v55, v119, 1.0
    ds_read_b128 v[48:51], v4 offset:12800
    ds_read_b128 v[52:55], v4 offset:12832
    v_rcp_f32 v64, v64
    v_rcp_f32 v65, v65
    v_rcp_f32 v66, v66
    v_rcp_f32 v67, v67
    v_rcp_f32 v68, v68
    v_rcp_f32 v69, v69
    v_rcp_f32 v70, v70
    v_rcp_f32 v71, v71
    s_nop 0
    v_cvt_pk_bf16_f32 v80, v64, v65
    v_cvt_pk_bf16_f32 v81, v66, v67
    v_cvt_pk_bf16_f32 v82, v68, v69
    v_cvt_pk_bf16_f32 v83, v70, v71
    ds_write_b128 v2, v[80:83] offset:34816
    v_fma_f32 v72, v56, v120, 1.0
    v_fma_f32 v73, v57, v121, 1.0
    v_fma_f32 v74, v58, v122, 1.0
    v_fma_f32 v75, v59, v123, 1.0
    v_fma_f32 v76, v60, v124, 1.0
    v_fma_f32 v77, v61, v125, 1.0
    v_fma_f32 v78, v62, v126, 1.0
    v_fma_f32 v79, v63, v127, 1.0
    ds_read_b128 v[56:59], v4 offset:12864
    ds_read_b128 v[60:63], v4 offset:12896
    v_rcp_f32 v72, v72
    v_rcp_f32 v73, v73
    v_rcp_f32 v74, v74
    v_rcp_f32 v75, v75
    v_rcp_f32 v76, v76
    v_rcp_f32 v77, v77
    v_rcp_f32 v78, v78
    v_rcp_f32 v79, v79
    s_nop 0
    v_cvt_pk_bf16_f32 v84, v72, v73
    v_cvt_pk_bf16_f32 v85, v74, v75
    v_cvt_pk_bf16_f32 v86, v76, v77
    v_cvt_pk_bf16_f32 v87, v78, v79
    ds_write_b128 v2, v[84:87] offset:35840
    s_waitcnt lgkmcnt(0)
    s_barrier
    v_fma_f32 v64, v32, v96, 1.0
    v_fma_f32 v65, v33, v97, 1.0
    v_fma_f32 v66, v34, v98, 1.0
    v_fma_f32 v67, v35, v99, 1.0
    v_fma_f32 v68, v36, v100, 1.0
    v_fma_f32 v69, v37, v101, 1.0
    v_fma_f32 v70, v38, v102, 1.0
    v_fma_f32 v71, v39, v103, 1.0
    ds_read_b128 v[32:35], v4 offset:16896
    ds_read_b128 v[36:39], v4 offset:16928
    v_rcp_f32 v64, v64
    v_rcp_f32 v65, v65
    v_rcp_f32 v66, v66
    v_rcp_f32 v67, v67
    v_rcp_f32 v68, v68
    v_rcp_f32 v69, v69
    v_rcp_f32 v70, v70
    v_rcp_f32 v71, v71
    s_nop 0
    v_cvt_pk_bf16_f32 v80, v64, v65
    v_cvt_pk_bf16_f32 v81, v66, v67
    v_cvt_pk_bf16_f32 v82, v68, v69
    v_cvt_pk_bf16_f32 v83, v70, v71
    ds_write_b128 v2, v[80:83] offset:0
    v_fma_f32 v72, v40, v104, 1.0
    v_fma_f32 v73, v41, v105, 1.0
    v_fma_f32 v74, v42, v106, 1.0
    v_fma_f32 v75, v43, v107, 1.0
    v_fma_f32 v76, v44, v108, 1.0
    v_fma_f32 v77, v45, v109, 1.0
    v_fma_f32 v78, v46, v110, 1.0
    v_fma_f32 v79, v47, v111, 1.0
    ds_read_b128 v[40:43], v4 offset:16960
    ds_read_b128 v[44:47], v4 offset:16992
    v_rcp_f32 v72, v72
    v_rcp_f32 v73, v73
    v_rcp_f32 v74, v74
    v_rcp_f32 v75, v75
    v_rcp_f32 v76, v76
    v_rcp_f32 v77, v77
    v_rcp_f32 v78, v78
    v_rcp_f32 v79, v79
    s_nop 0
    v_cvt_pk_bf16_f32 v84, v72, v73
    v_cvt_pk_bf16_f32 v85, v74, v75
    v_cvt_pk_bf16_f32 v86, v76, v77
    v_cvt_pk_bf16_f32 v87, v78, v79
    ds_write_b128 v2, v[84:87] offset:1024
    v_fma_f32 v64, v48, v112, 1.0
    v_fma_f32 v65, v49, v113, 1.0
    v_fma_f32 v66, v50, v114, 1.0
    v_fma_f32 v67, v51, v115, 1.0
    v_fma_f32 v68, v52, v116, 1.0
    v_fma_f32 v69, v53, v117, 1.0
    v_fma_f32 v70, v54, v118, 1.0
    v_fma_f32 v71, v55, v119, 1.0
    ds_read_b128 v[48:51], v4 offset:17024
    ds_read_b128 v[52:55], v4 offset:17056
    v_rcp_f32 v64, v64
    v_rcp_f32 v65, v65
    v_rcp_f32 v66, v66
    v_rcp_f32 v67, v67
    v_rcp_f32 v68, v68
    v_rcp_f32 v69, v69
    v_rcp_f32 v70, v70
    v_rcp_f32 v71, v71
    s_nop 0
    v_cvt_pk_bf16_f32 v80, v64, v65
    v_cvt_pk_bf16_f32 v81, v66, v67
    v_cvt_pk_bf16_f32 v82, v68, v69
    v_cvt_pk_bf16_f32 v83, v70, v71
    ds_write_b128 v2, v[80:83] offset:2048
    v_fma_f32 v72, v56, v120, 1.0
    v_fma_f32 v73, v57, v121, 1.0
    v_fma_f32 v74, v58, v122, 1.0
    v_fma_f32 v75, v59, v123, 1.0
    v_fma_f32 v76, v60, v124, 1.0
    v_fma_f32 v77, v61, v125, 1.0
    v_fma_f32 v78, v62, v126, 1.0
    v_fma_f32 v79, v63, v127, 1.0
    ds_read_b128 v[56:59], v4 offset:17088
    ds_read_b128 v[60:63], v4 offset:17120
    v_rcp_f32 v72, v72
    v_rcp_f32 v73, v73
    v_rcp_f32 v74, v74
    v_rcp_f32 v75, v75
    v_rcp_f32 v76, v76
    v_rcp_f32 v77, v77
    v_rcp_f32 v78, v78
    v_rcp_f32 v79, v79
    s_nop 0
    v_cvt_pk_bf16_f32 v84, v72, v73
    v_cvt_pk_bf16_f32 v85, v74, v75
    v_cvt_pk_bf16_f32 v86, v76, v77
    v_cvt_pk_bf16_f32 v87, v78, v79
    ds_write_b128 v2, v[84:87] offset:3072
    s_waitcnt lgkmcnt(0)
    s_barrier
    ds_read_b128 a[0:3], v6 offset:0
    ds_read_b128 a[4:7], v6 offset:1056
    ds_read_b128 a[8:11], v6 offset:2112
    ds_read_b128 a[12:15], v6 offset:3168
    v_fma_f32 v64, v32, v96, 1.0
    v_fma_f32 v65, v33, v97, 1.0
    v_fma_f32 v66, v34, v98, 1.0
    v_fma_f32 v67, v35, v99, 1.0
    v_fma_f32 v68, v36, v100, 1.0
    v_fma_f32 v69, v37, v101, 1.0
    v_fma_f32 v70, v38, v102, 1.0
    v_fma_f32 v71, v39, v103, 1.0
    ds_read_b128 v[32:35], v4 offset:21120
    ds_read_b128 v[36:39], v4 offset:21152
    v_rcp_f32 v64, v64
    v_rcp_f32 v65, v65
    v_rcp_f32 v66, v66
    v_rcp_f32 v67, v67
    v_rcp_f32 v68, v68
    v_rcp_f32 v69, v69
    v_rcp_f32 v70, v70
    v_rcp_f32 v71, v71
    s_waitcnt lgkmcnt(5)
    s_mov_b32 s36, 0
    buffer_store_dwordx4 a[0:3], v7, s[16:19], s36 offen sc1
    s_waitcnt lgkmcnt(4)
    s_mov_b32 s36, 1024
    buffer_store_dwordx4 a[4:7], v7, s[16:19], s36 offen sc1
    v_cvt_pk_bf16_f32 v80, v64, v65
    v_cvt_pk_bf16_f32 v81, v66, v67
    v_cvt_pk_bf16_f32 v82, v68, v69
    v_cvt_pk_bf16_f32 v83, v70, v71
    ds_write_b128 v2, v[80:83] offset:16384
    v_fma_f32 v72, v40, v104, 1.0
    v_fma_f32 v73, v41, v105, 1.0
    v_fma_f32 v74, v42, v106, 1.0
    v_fma_f32 v75, v43, v107, 1.0
    v_fma_f32 v76, v44, v108, 1.0
    v_fma_f32 v77, v45, v109, 1.0
    v_fma_f32 v78, v46, v110, 1.0
    v_fma_f32 v79, v47, v111, 1.0
    ds_read_b128 v[40:43], v4 offset:21184
    ds_read_b128 v[44:47], v4 offset:21216
    v_rcp_f32 v72, v72
    v_rcp_f32 v73, v73
    v_rcp_f32 v74, v74
    v_rcp_f32 v75, v75
    v_rcp_f32 v76, v76
    v_rcp_f32 v77, v77
    v_rcp_f32 v78, v78
    v_rcp_f32 v79, v79
    s_waitcnt lgkmcnt(6)
    s_mov_b32 s36, 2048
    buffer_store_dwordx4 a[8:11], v7, s[16:19], s36 offen sc1
    s_waitcnt lgkmcnt(5)
    s_mov_b32 s36, 3072
    buffer_store_dwordx4 a[12:15], v7, s[16:19], s36 offen sc1
    v_cvt_pk_bf16_f32 v84, v72, v73
    v_cvt_pk_bf16_f32 v85, v74, v75
    v_cvt_pk_bf16_f32 v86, v76, v77
    v_cvt_pk_bf16_f32 v87, v78, v79
    ds_write_b128 v2, v[84:87] offset:17408
    v_fma_f32 v64, v48, v112, 1.0
    v_fma_f32 v65, v49, v113, 1.0
    v_fma_f32 v66, v50, v114, 1.0
    v_fma_f32 v67, v51, v115, 1.0
    v_fma_f32 v68, v52, v116, 1.0
    v_fma_f32 v69, v53, v117, 1.0
    v_fma_f32 v70, v54, v118, 1.0
    v_fma_f32 v71, v55, v119, 1.0
    ds_read_b128 v[48:51], v4 offset:21248
    ds_read_b128 v[52:55], v4 offset:21280
    v_rcp_f32 v64, v64
    v_rcp_f32 v65, v65
    v_rcp_f32 v66, v66
    v_rcp_f32 v67, v67
    v_rcp_f32 v68, v68
    v_rcp_f32 v69, v69
    v_rcp_f32 v70, v70
    v_rcp_f32 v71, v71
    s_nop 0
    v_cvt_pk_bf16_f32 v80, v64, v65
    v_cvt_pk_bf16_f32 v81, v66, v67
    v_cvt_pk_bf16_f32 v82, v68, v69
    v_cvt_pk_bf16_f32 v83, v70, v71
    ds_write_b128 v2, v[80:83] offset:18432
    v_fma_f32 v72, v56, v120, 1.0
    v_fma_f32 v73, v57, v121, 1.0
    v_fma_f32 v74, v58, v122, 1.0
    v_fma_f32 v75, v59, v123, 1.0
    v_fma_f32 v76, v60, v124, 1.0
    v_fma_f32 v77, v61, v125, 1.0
    v_fma_f32 v78, v62, v126, 1.0
    v_fma_f32 v79, v63, v127, 1.0
    ds_read_b128 v[56:59], v4 offset:21312
    ds_read_b128 v[60:63], v4 offset:21344
    v_rcp_f32 v72, v72
    v_rcp_f32 v73, v73
    v_rcp_f32 v74, v74
    v_rcp_f32 v75, v75
    v_rcp_f32 v76, v76
    v_rcp_f32 v77, v77
    v_rcp_f32 v78, v78
    v_rcp_f32 v79, v79
    s_nop 0
    v_cvt_pk_bf16_f32 v84, v72, v73
    v_cvt_pk_bf16_f32 v85, v74, v75
    v_cvt_pk_bf16_f32 v86, v76, v77
    v_cvt_pk_bf16_f32 v87, v78, v79
    ds_write_b128 v2, v[84:87] offset:19456
    s_waitcnt lgkmcnt(0)
    s_barrier
    ds_read_b128 a[0:3], v6 offset:16896
    ds_read_b128 a[4:7], v6 offset:17952
    ds_read_b128 a[8:11], v6 offset:19008
    ds_read_b128 a[12:15], v6 offset:20064
    v_fma_f32 v64, v32, v96, 1.0
    v_fma_f32 v65, v33, v97, 1.0
    v_fma_f32 v66, v34, v98, 1.0
    v_fma_f32 v67, v35, v99, 1.0
    v_fma_f32 v68, v36, v100, 1.0
    v_fma_f32 v69, v37, v101, 1.0
    v_fma_f32 v70, v38, v102, 1.0
    v_fma_f32 v71, v39, v103, 1.0
    ds_read_b128 v[32:35], v4 offset:25344
    ds_read_b128 v[36:39], v4 offset:25376
    v_rcp_f32 v64, v64
    v_rcp_f32 v65, v65
    v_rcp_f32 v66, v66
    v_rcp_f32 v67, v67
    v_rcp_f32 v68, v68
    v_rcp_f32 v69, v69
    v_rcp_f32 v70, v70
    v_rcp_f32 v71, v71
    s_waitcnt lgkmcnt(5)
    s_mov_b32 s36, 16384
    buffer_store_dwordx4 a[0:3], v7, s[16:19], s36 offen sc1
    s_waitcnt lgkmcnt(4)
    s_mov_b32 s36, 17408
    buffer_store_dwordx4 a[4:7], v7, s[16:19], s36 offen sc1
    v_cvt_pk_bf16_f32 v80, v64, v65
    v_cvt_pk_bf16_f32 v81, v66, v67
    v_cvt_pk_bf16_f32 v82, v68, v69
    v_cvt_pk_bf16_f32 v83, v70, v71
    ds_write_b128 v2, v[80:83] offset:32768
    v_fma_f32 v72, v40, v104, 1.0
    v_fma_f32 v73, v41, v105, 1.0
    v_fma_f32 v74, v42, v106, 1.0
    v_fma_f32 v75, v43, v107, 1.0
    v_fma_f32 v76, v44, v108, 1.0
    v_fma_f32 v77, v45, v109, 1.0
    v_fma_f32 v78, v46, v110, 1.0
    v_fma_f32 v79, v47, v111, 1.0
    ds_read_b128 v[40:43], v4 offset:25408
    ds_read_b128 v[44:47], v4 offset:25440
    v_rcp_f32 v72, v72
    v_rcp_f32 v73, v73
    v_rcp_f32 v74, v74
    v_rcp_f32 v75, v75
    v_rcp_f32 v76, v76
    v_rcp_f32 v77, v77
    v_rcp_f32 v78, v78
    v_rcp_f32 v79, v79
    s_waitcnt lgkmcnt(6)
    s_mov_b32 s36, 18432
    buffer_store_dwordx4 a[8:11], v7, s[16:19], s36 offen sc1
    s_waitcnt lgkmcnt(5)
    s_mov_b32 s36, 19456
    buffer_store_dwordx4 a[12:15], v7, s[16:19], s36 offen sc1
    v_cvt_pk_bf16_f32 v84, v72, v73
    v_cvt_pk_bf16_f32 v85, v74, v75
    v_cvt_pk_bf16_f32 v86, v76, v77
    v_cvt_pk_bf16_f32 v87, v78, v79
    ds_write_b128 v2, v[84:87] offset:33792
    v_fma_f32 v64, v48, v112, 1.0
    v_fma_f32 v65, v49, v113, 1.0
    v_fma_f32 v66, v50, v114, 1.0
    v_fma_f32 v67, v51, v115, 1.0
    v_fma_f32 v68, v52, v116, 1.0
    v_fma_f32 v69, v53, v117, 1.0
    v_fma_f32 v70, v54, v118, 1.0
    v_fma_f32 v71, v55, v119, 1.0
    ds_read_b128 v[48:51], v4 offset:25472
    ds_read_b128 v[52:55], v4 offset:25504
    v_rcp_f32 v64, v64
    v_rcp_f32 v65, v65
    v_rcp_f32 v66, v66
    v_rcp_f32 v67, v67
    v_rcp_f32 v68, v68
    v_rcp_f32 v69, v69
    v_rcp_f32 v70, v70
    v_rcp_f32 v71, v71
    s_nop 0
    v_cvt_pk_bf16_f32 v80, v64, v65
    v_cvt_pk_bf16_f32 v81, v66, v67
    v_cvt_pk_bf16_f32 v82, v68, v69
    v_cvt_pk_bf16_f32 v83, v70, v71
    ds_write_b128 v2, v[80:83] offset:34816
    v_fma_f32 v72, v56, v120, 1.0
    v_fma_f32 v73, v57, v121, 1.0
    v_fma_f32 v74, v58, v122, 1.0
    v_fma_f32 v75, v59, v123, 1.0
    v_fma_f32 v76, v60, v124, 1.0
    v_fma_f32 v77, v61, v125, 1.0
    v_fma_f32 v78, v62, v126, 1.0
    v_fma_f32 v79, v63, v127, 1.0
    ds_read_b128 v[56:59], v4 offset:25536
    ds_read_b128 v[60:63], v4 offset:25568
    v_rcp_f32 v72, v72
    v_rcp_f32 v73, v73
    v_rcp_f32 v74, v74
    v_rcp_f32 v75, v75
    v_rcp_f32 v76, v76
    v_rcp_f32 v77, v77
    v_rcp_f32 v78, v78
    v_rcp_f32 v79, v79
    s_nop 0
    v_cvt_pk_bf16_f32 v84, v72, v73
    v_cvt_pk_bf16_f32 v85, v74, v75
    v_cvt_pk_bf16_f32 v86, v76, v77
    v_cvt_pk_bf16_f32 v87, v78, v79
    ds_write_b128 v2, v[84:87] offset:35840
    s_waitcnt lgkmcnt(0)
    s_barrier
    ds_read_b128 a[0:3], v6 offset:0
    ds_read_b128 a[4:7], v6 offset:1056
    ds_read_b128 a[8:11], v6 offset:2112
    ds_read_b128 a[12:15], v6 offset:3168
    v_fma_f32 v64, v32, v96, 1.0
    v_fma_f32 v65, v33, v97, 1.0
    v_fma_f32 v66, v34, v98, 1.0
    v_fma_f32 v67, v35, v99, 1.0
    v_fma_f32 v68, v36, v100, 1.0
    v_fma_f32 v69, v37, v101, 1.0
    v_fma_f32 v70, v38, v102, 1.0
    v_fma_f32 v71, v39, v103, 1.0
    ds_read_b128 v[32:35], v4 offset:29568
    ds_read_b128 v[36:39], v4 offset:29600
    v_rcp_f32 v64, v64
    v_rcp_f32 v65, v65
    v_rcp_f32 v66, v66
    v_rcp_f32 v67, v67
    v_rcp_f32 v68, v68
    v_rcp_f32 v69, v69
    v_rcp_f32 v70, v70
    v_rcp_f32 v71, v71
    s_waitcnt lgkmcnt(5)
    s_mov_b32 s36, 32768
    buffer_store_dwordx4 a[0:3], v7, s[16:19], s36 offen sc1
    s_waitcnt lgkmcnt(4)
    s_mov_b32 s36, 33792
    buffer_store_dwordx4 a[4:7], v7, s[16:19], s36 offen sc1
    v_cvt_pk_bf16_f32 v80, v64, v65
    v_cvt_pk_bf16_f32 v81, v66, v67
    v_cvt_pk_bf16_f32 v82, v68, v69
    v_cvt_pk_bf16_f32 v83, v70, v71
    ds_write_b128 v2, v[80:83] offset:0
    v_fma_f32 v72, v40, v104, 1.0
    v_fma_f32 v73, v41, v105, 1.0
    v_fma_f32 v74, v42, v106, 1.0
    v_fma_f32 v75, v43, v107, 1.0
    v_fma_f32 v76, v44, v108, 1.0
    v_fma_f32 v77, v45, v109, 1.0
    v_fma_f32 v78, v46, v110, 1.0
    v_fma_f32 v79, v47, v111, 1.0
    ds_read_b128 v[40:43], v4 offset:29632
    ds_read_b128 v[44:47], v4 offset:29664
    v_rcp_f32 v72, v72
    v_rcp_f32 v73, v73
    v_rcp_f32 v74, v74
    v_rcp_f32 v75, v75
    v_rcp_f32 v76, v76
    v_rcp_f32 v77, v77
    v_rcp_f32 v78, v78
    v_rcp_f32 v79, v79
    s_waitcnt lgkmcnt(6)
    s_mov_b32 s36, 34816
    buffer_store_dwordx4 a[8:11], v7, s[16:19], s36 offen sc1
    s_waitcnt lgkmcnt(5)
    s_mov_b32 s36, 35840
    buffer_store_dwordx4 a[12:15], v7, s[16:19], s36 offen sc1
    v_cvt_pk_bf16_f32 v84, v72, v73
    v_cvt_pk_bf16_f32 v85, v74, v75
    v_cvt_pk_bf16_f32 v86, v76, v77
    v_cvt_pk_bf16_f32 v87, v78, v79
    ds_write_b128 v2, v[84:87] offset:1024
    v_fma_f32 v64, v48, v112, 1.0
    v_fma_f32 v65, v49, v113, 1.0
    v_fma_f32 v66, v50, v114, 1.0
    v_fma_f32 v67, v51, v115, 1.0
    v_fma_f32 v68, v52, v116, 1.0
    v_fma_f32 v69, v53, v117, 1.0
    v_fma_f32 v70, v54, v118, 1.0
    v_fma_f32 v71, v55, v119, 1.0
    ds_read_b128 v[48:51], v4 offset:29696
    ds_read_b128 v[52:55], v4 offset:29728
    v_rcp_f32 v64, v64
    v_rcp_f32 v65, v65
    v_rcp_f32 v66, v66
    v_rcp_f32 v67, v67
    v_rcp_f32 v68, v68
    v_rcp_f32 v69, v69
    v_rcp_f32 v70, v70
    v_rcp_f32 v71, v71
    s_nop 0
    v_cvt_pk_bf16_f32 v80, v64, v65
    v_cvt_pk_bf16_f32 v81, v66, v67
    v_cvt_pk_bf16_f32 v82, v68, v69
    v_cvt_pk_bf16_f32 v83, v70, v71
    ds_write_b128 v2, v[80:83] offset:2048
    v_fma_f32 v72, v56, v120, 1.0
    v_fma_f32 v73, v57, v121, 1.0
    v_fma_f32 v74, v58, v122, 1.0
    v_fma_f32 v75, v59, v123, 1.0
    v_fma_f32 v76, v60, v124, 1.0
    v_fma_f32 v77, v61, v125, 1.0
    v_fma_f32 v78, v62, v126, 1.0
    v_fma_f32 v79, v63, v127, 1.0
    ds_read_b128 v[56:59], v4 offset:29760
    ds_read_b128 v[60:63], v4 offset:29792
    v_rcp_f32 v72, v72
    v_rcp_f32 v73, v73
    v_rcp_f32 v74, v74
    v_rcp_f32 v75, v75
    v_rcp_f32 v76, v76
    v_rcp_f32 v77, v77
    v_rcp_f32 v78, v78
    v_rcp_f32 v79, v79
    s_nop 0
    v_cvt_pk_bf16_f32 v84, v72, v73
    v_cvt_pk_bf16_f32 v85, v74, v75
    v_cvt_pk_bf16_f32 v86, v76, v77
    v_cvt_pk_bf16_f32 v87, v78, v79
    ds_write_b128 v2, v[84:87] offset:3072
    s_waitcnt lgkmcnt(0)
    s_barrier
    ds_read_b128 a[0:3], v6 offset:16896
    ds_read_b128 a[4:7], v6 offset:17952
    ds_read_b128 a[8:11], v6 offset:19008
    ds_read_b128 a[12:15], v6 offset:20064
    v_fma_f32 v64, v32, v96, 1.0
    v_fma_f32 v65, v33, v97, 1.0
    v_fma_f32 v66, v34, v98, 1.0
    v_fma_f32 v67, v35, v99, 1.0
    v_fma_f32 v68, v36, v100, 1.0
    v_fma_f32 v69, v37, v101, 1.0
    v_fma_f32 v70, v38, v102, 1.0
    v_fma_f32 v71, v39, v103, 1.0
    v_rcp_f32 v64, v64
    v_rcp_f32 v65, v65
    v_rcp_f32 v66, v66
    v_rcp_f32 v67, v67
    v_rcp_f32 v68, v68
    v_rcp_f32 v69, v69
    v_rcp_f32 v70, v70
    v_rcp_f32 v71, v71
    s_waitcnt lgkmcnt(3)
    s_mov_b32 s36, 49152
    buffer_store_dwordx4 a[0:3], v7, s[16:19], s36 offen sc1
    s_waitcnt lgkmcnt(2)
    s_mov_b32 s36, 50176
    buffer_store_dwordx4 a[4:7], v7, s[16:19], s36 offen sc1
    v_cvt_pk_bf16_f32 v80, v64, v65
    v_cvt_pk_bf16_f32 v81, v66, v67
    v_cvt_pk_bf16_f32 v82, v68, v69
    v_cvt_pk_bf16_f32 v83, v70, v71
    ds_write_b128 v2, v[80:83] offset:16384
    v_fma_f32 v72, v40, v104, 1.0
    v_fma_f32 v73, v41, v105, 1.0
    v_fma_f32 v74, v42, v106, 1.0
    v_fma_f32 v75, v43, v107, 1.0
    v_fma_f32 v76, v44, v108, 1.0
    v_fma_f32 v77, v45, v109, 1.0
    v_fma_f32 v78, v46, v110, 1.0
    v_fma_f32 v79, v47, v111, 1.0
    v_rcp_f32 v72, v72
    v_rcp_f32 v73, v73
    v_rcp_f32 v74, v74
    v_rcp_f32 v75, v75
    v_rcp_f32 v76, v76
    v_rcp_f32 v77, v77
    v_rcp_f32 v78, v78
    v_rcp_f32 v79, v79
    s_waitcnt lgkmcnt(2)
    s_mov_b32 s36, 51200
    buffer_store_dwordx4 a[8:11], v7, s[16:19], s36 offen sc1
    s_waitcnt lgkmcnt(1)
    s_mov_b32 s36, 52224
    buffer_store_dwordx4 a[12:15], v7, s[16:19], s36 offen sc1
    v_cvt_pk_bf16_f32 v84, v72, v73
    v_cvt_pk_bf16_f32 v85, v74, v75
    v_cvt_pk_bf16_f32 v86, v76, v77
    v_cvt_pk_bf16_f32 v87, v78, v79
    ds_write_b128 v2, v[84:87] offset:17408
    v_fma_f32 v64, v48, v112, 1.0
    v_fma_f32 v65, v49, v113, 1.0
    v_fma_f32 v66, v50, v114, 1.0
    v_fma_f32 v67, v51, v115, 1.0
    v_fma_f32 v68, v52, v116, 1.0
    v_fma_f32 v69, v53, v117, 1.0
    v_fma_f32 v70, v54, v118, 1.0
    v_fma_f32 v71, v55, v119, 1.0
    v_rcp_f32 v64, v64
    v_rcp_f32 v65, v65
    v_rcp_f32 v66, v66
    v_rcp_f32 v67, v67
    v_rcp_f32 v68, v68
    v_rcp_f32 v69, v69
    v_rcp_f32 v70, v70
    v_rcp_f32 v71, v71
    s_nop 0
    v_cvt_pk_bf16_f32 v80, v64, v65
    v_cvt_pk_bf16_f32 v81, v66, v67
    v_cvt_pk_bf16_f32 v82, v68, v69
    v_cvt_pk_bf16_f32 v83, v70, v71
    ds_write_b128 v2, v[80:83] offset:18432
    v_fma_f32 v72, v56, v120, 1.0
    v_fma_f32 v73, v57, v121, 1.0
    v_fma_f32 v74, v58, v122, 1.0
    v_fma_f32 v75, v59, v123, 1.0
    v_fma_f32 v76, v60, v124, 1.0
    v_fma_f32 v77, v61, v125, 1.0
    v_fma_f32 v78, v62, v126, 1.0
    v_fma_f32 v79, v63, v127, 1.0
    v_rcp_f32 v72, v72
    v_rcp_f32 v73, v73
    v_rcp_f32 v74, v74
    v_rcp_f32 v75, v75
    v_rcp_f32 v76, v76
    v_rcp_f32 v77, v77
    v_rcp_f32 v78, v78
    v_rcp_f32 v79, v79
    s_nop 0
    v_cvt_pk_bf16_f32 v84, v72, v73
    v_cvt_pk_bf16_f32 v85, v74, v75
    v_cvt_pk_bf16_f32 v86, v76, v77
    v_cvt_pk_bf16_f32 v87, v78, v79
    ds_write_b128 v2, v[84:87] offset:19456
    s_waitcnt lgkmcnt(0)
    s_barrier
    ds_read_b128 a[0:3], v6 offset:0
    ds_read_b128 a[4:7], v6 offset:1056
    ds_read_b128 a[8:11], v6 offset:2112
    ds_read_b128 a[12:15], v6 offset:3168
    s_waitcnt lgkmcnt(3)
    s_mov_b32 s36, 65536
    buffer_store_dwordx4 a[0:3], v7, s[16:19], s36 offen sc1
    s_waitcnt lgkmcnt(2)
    s_mov_b32 s36, 66560
    buffer_store_dwordx4 a[4:7], v7, s[16:19], s36 offen sc1
    s_waitcnt lgkmcnt(1)
    s_mov_b32 s36, 67584
    buffer_store_dwordx4 a[8:11], v7, s[16:19], s36 offen sc1
    s_waitcnt lgkmcnt(0)
    s_mov_b32 s36, 68608
    buffer_store_dwordx4 a[12:15], v7, s[16:19], s36 offen sc1
    s_barrier
    ds_read_b128 a[0:3], v6 offset:16896
    ds_read_b128 a[4:7], v6 offset:17952
    ds_read_b128 a[8:11], v6 offset:19008
    ds_read_b128 a[12:15], v6 offset:20064
    s_waitcnt lgkmcnt(3)
    s_mov_b32 s36, 81920
    buffer_store_dwordx4 a[0:3], v7, s[16:19], s36 offen sc1
    s_waitcnt lgkmcnt(2)
    s_mov_b32 s36, 82944
    buffer_store_dwordx4 a[4:7], v7, s[16:19], s36 offen sc1
    s_waitcnt lgkmcnt(1)
    s_mov_b32 s36, 83968
    buffer_store_dwordx4 a[8:11], v7, s[16:19], s36 offen sc1
    s_waitcnt lgkmcnt(0)
    s_mov_b32 s36, 84992
    buffer_store_dwordx4 a[12:15], v7, s[16:19], s36 offen sc1
    s_barrier
    ds_read_b128 a[0:3], v6 offset:0
    ds_read_b128 a[4:7], v6 offset:1056
    ds_read_b128 a[8:11], v6 offset:2112
    ds_read_b128 a[12:15], v6 offset:3168
    s_waitcnt lgkmcnt(3)
    s_mov_b32 s36, 98304
    buffer_store_dwordx4 a[0:3], v7, s[16:19], s36 offen sc1
    s_waitcnt lgkmcnt(2)
    s_mov_b32 s36, 99328
    buffer_store_dwordx4 a[4:7], v7, s[16:19], s36 offen sc1
    s_waitcnt lgkmcnt(1)
    s_mov_b32 s36, 100352
    buffer_store_dwordx4 a[8:11], v7, s[16:19], s36 offen sc1
    s_waitcnt lgkmcnt(0)
    s_mov_b32 s36, 101376
    buffer_store_dwordx4 a[12:15], v7, s[16:19], s36 offen sc1
    s_barrier
    ds_read_b128 a[0:3], v6 offset:16896
    ds_read_b128 a[4:7], v6 offset:17952
    ds_read_b128 a[8:11], v6 offset:19008
    ds_read_b128 a[12:15], v6 offset:20064
    s_waitcnt lgkmcnt(3)
    s_mov_b32 s36, 114688
    buffer_store_dwordx4 a[0:3], v7, s[16:19], s36 offen sc1
    s_waitcnt lgkmcnt(2)
    s_mov_b32 s36, 115712
    buffer_store_dwordx4 a[4:7], v7, s[16:19], s36 offen sc1
    s_waitcnt lgkmcnt(1)
    s_mov_b32 s36, 116736
    buffer_store_dwordx4 a[8:11], v7, s[16:19], s36 offen sc1
    s_waitcnt lgkmcnt(0)
    s_mov_b32 s36, 117760
    buffer_store_dwordx4 a[12:15], v7, s[16:19], s36 offen sc1
    s_endpgm
L_joint_kernel_slow:
    ds_write_b128 v9, v[64:67] offset:0
    ds_write_b128 v9, v[68:71] offset:32
    ds_write_b128 v9, v[72:75] offset:64
    ds_write_b128 v9, v[76:79] offset:96
    ds_write_b128 v9, v[80:83] offset:128
    ds_write_b128 v9, v[84:87] offset:160
    ds_write_b128 v9, v[88:91] offset:192
    ds_write_b128 v9, v[92:95] offset:224
    s_waitcnt lgkmcnt(0)
    ds_read_b128 v[32:35], v4 offset:0
    ds_read_b128 v[36:39], v4 offset:32
    ds_read_b128 v[40:43], v4 offset:64
    ds_read_b128 v[44:47], v4 offset:96
    ds_read_b128 v[48:51], v4 offset:128
    ds_read_b128 v[52:55], v4 offset:160
    ds_read_b128 v[56:59], v4 offset:192
    ds_read_b128 v[60:63], v4 offset:224
    s_waitcnt lgkmcnt(6)
    v_add_f32 v64, v32, v96
    v_add_f32 v65, v33, v97
    v_add_f32 v66, v34, v98
    v_add_f32 v67, v35, v99
    v_add_f32 v68, v36, v100
    v_add_f32 v69, v37, v101
    v_add_f32 v70, v38, v102
    v_add_f32 v71, v39, v103
    ds_read_b128 v[32:35], v4 offset:4224
    ds_read_b128 v[36:39], v4 offset:4256
    v_exp_f32 v64, v64
    v_exp_f32 v65, v65
    v_exp_f32 v66, v66
    v_exp_f32 v67, v67
    v_exp_f32 v68, v68
    v_exp_f32 v69, v69
    v_exp_f32 v70, v70
    v_exp_f32 v71, v71
    v_add_f32 v64, 1.0, v64
    v_add_f32 v65, 1.0, v65
    v_add_f32 v66, 1.0, v66
    v_add_f32 v67, 1.0, v67
    v_add_f32 v68, 1.0, v68
    v_add_f32 v69, 1.0, v69
    v_add_f32 v70, 1.0, v70
    v_add_f32 v71, 1.0, v71
    v_rcp_f32 v64, v64
    v_rcp_f32 v65, v65
    v_rcp_f32 v66, v66
    v_rcp_f32 v67, v67
    v_rcp_f32 v68, v68
    v_rcp_f32 v69, v69
    v_rcp_f32 v70, v70
    v_rcp_f32 v71, v71
    s_nop 0
    v_cvt_pk_bf16_f32 v80, v64, v65
    v_cvt_pk_bf16_f32 v81, v66, v67
    v_cvt_pk_bf16_f32 v82, v68, v69
    v_cvt_pk_bf16_f32 v83, v70, v71
    ds_write_b128 v2, v[80:83] offset:0
    s_waitcnt lgkmcnt(7)
    v_add_f32 v72, v40, v104
    v_add_f32 v73, v41, v105
    v_add_f32 v74, v42, v106
    v_add_f32 v75, v43, v107
    v_add_f32 v76, v44, v108
    v_add_f32 v77, v45, v109
    v_add_f32 v78, v46, v110
    v_add_f32 v79, v47, v111
    ds_read_b128 v[40:43], v4 offset:4288
    ds_read_b128 v[44:47], v4 offset:4320
    v_exp_f32 v72, v72
    v_exp_f32 v73, v73
    v_exp_f32 v74, v74
    v_exp_f32 v75, v75
    v_exp_f32 v76, v76
    v_exp_f32 v77, v77
    v_exp_f32 v78, v78
    v_exp_f32 v79, v79
    v_add_f32 v72, 1.0, v72
    v_add_f32 v73, 1.0, v73
    v_add_f32 v74, 1.0, v74
    v_add_f32 v75, 1.0, v75
    v_add_f32 v76, 1.0, v76
    v_add_f32 v77, 1.0, v77
    v_add_f32 v78, 1.0, v78
    v_add_f32 v79, 1.0, v79
    v_rcp_f32 v72, v72
    v_rcp_f32 v73, v73
    v_rcp_f32 v74, v74
    v_rcp_f32 v75, v75
    v_rcp_f32 v76, v76
    v_rcp_f32 v77, v77
    v_rcp_f32 v78, v78
    v_rcp_f32 v79, v79
    s_nop 0
    v_cvt_pk_bf16_f32 v84, v72, v73
    v_cvt_pk_bf16_f32 v85, v74, v75
    v_cvt_pk_bf16_f32 v86, v76, v77
    v_cvt_pk_bf16_f32 v87, v78, v79
    ds_write_b128 v2, v[84:87] offset:1024
    s_waitcnt lgkmcnt(8)
    v_add_f32 v64, v48, v112
    v_add_f32 v65, v49, v113
    v_add_f32 v66, v50, v114
    v_add_f32 v67, v51, v115
    v_add_f32 v68, v52, v116
    v_add_f32 v69, v53, v117
    v_add_f32 v70, v54, v118
    v_add_f32 v71, v55, v119
    ds_read_b128 v[48:51], v4 offset:4352
    ds_read_b128 v[52:55], v4 offset:4384
    v_exp_f32 v64, v64
    v_exp_f32 v65, v65
    v_exp_f32 v66, v66
    v_exp_f32 v67, v67
    v_exp_f32 v68, v68
    v_exp_f32 v69, v69
    v_exp_f32 v70, v70
    v_exp_f32 v71, v71
    v_add_f32 v64, 1.0, v64
    v_add_f32 v65, 1.0, v65
    v_add_f32 v66, 1.0, v66
    v_add_f32 v67, 1.0, v67
    v_add_f32 v68, 1.0, v68
    v_add_f32 v69, 1.0, v69
    v_add_f32 v70, 1.0, v70
    v_add_f32 v71, 1.0, v71
    v_rcp_f32 v64, v64
    v_rcp_f32 v65, v65
    v_rcp_f32 v66, v66
    v_rcp_f32 v67, v67
    v_rcp_f32 v68, v68
    v_rcp_f32 v69, v69
    v_rcp_f32 v70, v70
    v_rcp_f32 v71, v71
    s_nop 0
    v_cvt_pk_bf16_f32 v80, v64, v65
    v_cvt_pk_bf16_f32 v81, v66, v67
    v_cvt_pk_bf16_f32 v82, v68, v69
    v_cvt_pk_bf16_f32 v83, v70, v71
    ds_write_b128 v2, v[80:83] offset:2048
    s_waitcnt lgkmcnt(9)
    v_add_f32 v72, v56, v120
    v_add_f32 v73, v57, v121
    v_add_f32 v74, v58, v122
    v_add_f32 v75, v59, v123
    v_add_f32 v76, v60, v124
    v_add_f32 v77, v61, v125
    v_add_f32 v78, v62, v126
    v_add_f32 v79, v63, v127
    ds_read_b128 v[56:59], v4 offset:4416
    ds_read_b128 v[60:63], v4 offset:4448
    v_exp_f32 v72, v72
    v_exp_f32 v73, v73
    v_exp_f32 v74, v74
    v_exp_f32 v75, v75
    v_exp_f32 v76, v76
    v_exp_f32 v77, v77
    v_exp_f32 v78, v78
    v_exp_f32 v79, v79
    v_add_f32 v72, 1.0, v72
    v_add_f32 v73, 1.0, v73
    v_add_f32 v74, 1.0, v74
    v_add_f32 v75, 1.0, v75
    v_add_f32 v76, 1.0, v76
    v_add_f32 v77, 1.0, v77
    v_add_f32 v78, 1.0, v78
    v_add_f32 v79, 1.0, v79
    v_rcp_f32 v72, v72
    v_rcp_f32 v73, v73
    v_rcp_f32 v74, v74
    v_rcp_f32 v75, v75
    v_rcp_f32 v76, v76
    v_rcp_f32 v77, v77
    v_rcp_f32 v78, v78
    v_rcp_f32 v79, v79
    s_nop 0
    v_cvt_pk_bf16_f32 v84, v72, v73
    v_cvt_pk_bf16_f32 v85, v74, v75
    v_cvt_pk_bf16_f32 v86, v76, v77
    v_cvt_pk_bf16_f32 v87, v78, v79
    ds_write_b128 v2, v[84:87] offset:3072
    s_waitcnt lgkmcnt(10)
    v_add_f32 v64, v32, v96
    v_add_f32 v65, v33, v97
    v_add_f32 v66, v34, v98
    v_add_f32 v67, v35, v99
    v_add_f32 v68, v36, v100
    v_add_f32 v69, v37, v101
    v_add_f32 v70, v38, v102
    v_add_f32 v71, v39, v103
    ds_read_b128 v[32:35], v4 offset:8448
    ds_read_b128 v[36:39], v4 offset:8480
    v_exp_f32 v64, v64
    v_exp_f32 v65, v65
    v_exp_f32 v66, v66
    v_exp_f32 v67, v67
    v_exp_f32 v68, v68
    v_exp_f32 v69, v69
    v_exp_f32 v70, v70
    v_exp_f32 v71, v71
    v_add_f32 v64, 1.0, v64
    v_add_f32 v65, 1.0, v65
    v_add_f32 v66, 1.0, v66
    v_add_f32 v67, 1.0, v67
    v_add_f32 v68, 1.0, v68
    v_add_f32 v69, 1.0, v69
    v_add_f32 v70, 1.0, v70
    v_add_f32 v71, 1.0, v71
    v_rcp_f32 v64, v64
    v_rcp_f32 v65, v65
    v_rcp_f32 v66, v66
    v_rcp_f32 v67, v67
    v_rcp_f32 v68, v68
    v_rcp_f32 v69, v69
    v_rcp_f32 v70, v70
    v_rcp_f32 v71, v71
    s_nop 0
    v_cvt_pk_bf16_f32 v80, v64, v65
    v_cvt_pk_bf16_f32 v81, v66, v67
    v_cvt_pk_bf16_f32 v82, v68, v69
    v_cvt_pk_bf16_f32 v83, v70, v71
    ds_write_b128 v2, v[80:83] offset:16384
    s_waitcnt lgkmcnt(10)
    v_add_f32 v72, v40, v104
    v_add_f32 v73, v41, v105
    v_add_f32 v74, v42, v106
    v_add_f32 v75, v43, v107
    v_add_f32 v76, v44, v108
    v_add_f32 v77, v45, v109
    v_add_f32 v78, v46, v110
    v_add_f32 v79, v47, v111
    ds_read_b128 v[40:43], v4 offset:8512
    ds_read_b128 v[44:47], v4 offset:8544
    v_exp_f32 v72, v72
    v_exp_f32 v73, v73
    v_exp_f32 v74, v74
    v_exp_f32 v75, v75
    v_exp_f32 v76, v76
    v_exp_f32 v77, v77
    v_exp_f32 v78, v78
    v_exp_f32 v79, v79
    v_add_f32 v72, 1.0, v72
    v_add_f32 v73, 1.0, v73
    v_add_f32 v74, 1.0, v74
    v_add_f32 v75, 1.0, v75
    v_add_f32 v76, 1.0, v76
    v_add_f32 v77, 1.0, v77
    v_add_f32 v78, 1.0, v78
    v_add_f32 v79, 1.0, v79
    v_rcp_f32 v72, v72
    v_rcp_f32 v73, v73
    v_rcp_f32 v74, v74
    v_rcp_f32 v75, v75
    v_rcp_f32 v76, v76
    v_rcp_f32 v77, v77
    v_rcp_f32 v78, v78
    v_rcp_f32 v79, v79
    s_nop 0
    v_cvt_pk_bf16_f32 v84, v72, v73
    v_cvt_pk_bf16_f32 v85, v74, v75
    v_cvt_pk_bf16_f32 v86, v76, v77
    v_cvt_pk_bf16_f32 v87, v78, v79
    ds_write_b128 v2, v[84:87] offset:17408
    s_waitcnt lgkmcnt(10)
    v_add_f32 v64, v48, v112
    v_add_f32 v65, v49, v113
    v_add_f32 v66, v50, v114
    v_add_f32 v67, v51, v115
    v_add_f32 v68, v52, v116
    v_add_f32 v69, v53, v117
    v_add_f32 v70, v54, v118
    v_add_f32 v71, v55, v119
    ds_read_b128 v[48:51], v4 offset:8576
    ds_read_b128 v[52:55], v4 offset:8608
    v_exp_f32 v64, v64
    v_exp_f32 v65, v65
    v_exp_f32 v66, v66
    v_exp_f32 v67, v67
    v_exp_f32 v68, v68
    v_exp_f32 v69, v69
    v_exp_f32 v70, v70
    v_exp_f32 v71, v71
    v_add_f32 v64, 1.0, v64
    v_add_f32 v65, 1.0, v65
    v_add_f32 v66, 1.0, v66
    v_add_f32 v67, 1.0, v67
    v_add_f32 v68, 1.0, v68
    v_add_f32 v69, 1.0, v69
    v_add_f32 v70, 1.0, v70
    v_add_f32 v71, 1.0, v71
    v_rcp_f32 v64, v64
    v_rcp_f32 v65, v65
    v_rcp_f32 v66, v66
    v_rcp_f32 v67, v67
    v_rcp_f32 v68, v68
    v_rcp_f32 v69, v69
    v_rcp_f32 v70, v70
    v_rcp_f32 v71, v71
    s_nop 0
    v_cvt_pk_bf16_f32 v80, v64, v65
    v_cvt_pk_bf16_f32 v81, v66, v67
    v_cvt_pk_bf16_f32 v82, v68, v69
    v_cvt_pk_bf16_f32 v83, v70, v71
    ds_write_b128 v2, v[80:83] offset:18432
    s_waitcnt lgkmcnt(10)
    v_add_f32 v72, v56, v120
    v_add_f32 v73, v57, v121
    v_add_f32 v74, v58, v122
    v_add_f32 v75, v59, v123
    v_add_f32 v76, v60, v124
    v_add_f32 v77, v61, v125
    v_add_f32 v78, v62, v126
    v_add_f32 v79, v63, v127
    ds_read_b128 v[56:59], v4 offset:8640
    ds_read_b128 v[60:63], v4 offset:8672
    v_exp_f32 v72, v72
    v_exp_f32 v73, v73
    v_exp_f32 v74, v74
    v_exp_f32 v75, v75
    v_exp_f32 v76, v76
    v_exp_f32 v77, v77
    v_exp_f32 v78, v78
    v_exp_f32 v79, v79
    v_add_f32 v72, 1.0, v72
    v_add_f32 v73, 1.0, v73
    v_add_f32 v74, 1.0, v74
    v_add_f32 v75, 1.0, v75
    v_add_f32 v76, 1.0, v76
    v_add_f32 v77, 1.0, v77
    v_add_f32 v78, 1.0, v78
    v_add_f32 v79, 1.0, v79
    v_rcp_f32 v72, v72
    v_rcp_f32 v73, v73
    v_rcp_f32 v74, v74
    v_rcp_f32 v75, v75
    v_rcp_f32 v76, v76
    v_rcp_f32 v77, v77
    v_rcp_f32 v78, v78
    v_rcp_f32 v79, v79
    s_nop 0
    v_cvt_pk_bf16_f32 v84, v72, v73
    v_cvt_pk_bf16_f32 v85, v74, v75
    v_cvt_pk_bf16_f32 v86, v76, v77
    v_cvt_pk_bf16_f32 v87, v78, v79
    ds_write_b128 v2, v[84:87] offset:19456
    s_waitcnt lgkmcnt(0)
    s_barrier
    v_add_f32 v64, v32, v96
    v_add_f32 v65, v33, v97
    v_add_f32 v66, v34, v98
    v_add_f32 v67, v35, v99
    v_add_f32 v68, v36, v100
    v_add_f32 v69, v37, v101
    v_add_f32 v70, v38, v102
    v_add_f32 v71, v39, v103
    ds_read_b128 v[32:35], v4 offset:12672
    ds_read_b128 v[36:39], v4 offset:12704
    v_exp_f32 v64, v64
    v_exp_f32 v65, v65
    v_exp_f32 v66, v66
    v_exp_f32 v67, v67
    v_exp_f32 v68, v68
    v_exp_f32 v69, v69
    v_exp_f32 v70, v70
    v_exp_f32 v71, v71
    v_add_f32 v64, 1.0, v64
    v_add_f32 v65, 1.0, v65
    v_add_f32 v66, 1.0, v66
    v_add_f32 v67, 1.0, v67
    v_add_f32 v68, 1.0, v68
    v_add_f32 v69, 1.0, v69
    v_add_f32 v70, 1.0, v70
    v_add_f32 v71, 1.0, v71
    v_rcp_f32 v64, v64
    v_rcp_f32 v65, v65
    v_rcp_f32 v66, v66
    v_rcp_f32 v67, v67
    v_rcp_f32 v68, v68
    v_rcp_f32 v69, v69
    v_rcp_f32 v70, v70
    v_rcp_f32 v71, v71
    s_nop 0
    v_cvt_pk_bf16_f32 v80, v64, v65
    v_cvt_pk_bf16_f32 v81, v66, v67
    v_cvt_pk_bf16_f32 v82, v68, v69
    v_cvt_pk_bf16_f32 v83, v70, v71
    ds_write_b128 v2, v[80:83] offset:32768
    v_add_f32 v72, v40, v104
    v_add_f32 v73, v41, v105
    v_add_f32 v74, v42, v106
    v_add_f32 v75, v43, v107
    v_add_f32 v76, v44, v108
    v_add_f32 v77, v45, v109
    v_add_f32 v78, v46, v110
    v_add_f32 v79, v47, v111
    ds_read_b128 v[40:43], v4 offset:12736
    ds_read_b128 v[44:47], v4 offset:12768
    v_exp_f32 v72, v72
    v_exp_f32 v73, v73
    v_exp_f32 v74, v74
    v_exp_f32 v75, v75
    v_exp_f32 v76, v76
    v_exp_f32 v77, v77
    v_exp_f32 v78, v78
    v_exp_f32 v79, v79
    v_add_f32 v72, 1.0, v72
    v_add_f32 v73, 1.0, v73
    v_add_f32 v74, 1.0, v74
    v_add_f32 v75, 1.0, v75
    v_add_f32 v76, 1.0, v76
    v_add_f32 v77, 1.0, v77
    v_add_f32 v78, 1.0, v78
    v_add_f32 v79, 1.0, v79
    v_rcp_f32 v72, v72
    v_rcp_f32 v73, v73
    v_rcp_f32 v74, v74
    v_rcp_f32 v75, v75
    v_rcp_f32 v76, v76
    v_rcp_f32 v77, v77
    v_rcp_f32 v78, v78
    v_rcp_f32 v79, v79
    s_nop 0
    v_cvt_pk_bf16_f32 v84, v72, v73
    v_cvt_pk_bf16_f32 v85, v74, v75
    v_cvt_pk_bf16_f32 v86, v76, v77
    v_cvt_pk_bf16_f32 v87, v78, v79
    ds_write_b128 v2, v[84:87] offset:33792
    v_add_f32 v64, v48, v112
    v_add_f32 v65, v49, v113
    v_add_f32 v66, v50, v114
    v_add_f32 v67, v51, v115
    v_add_f32 v68, v52, v116
    v_add_f32 v69, v53, v117
    v_add_f32 v70, v54, v118
    v_add_f32 v71, v55, v119
    ds_read_b128 v[48:51], v4 offset:12800
    ds_read_b128 v[52:55], v4 offset:12832
    v_exp_f32 v64, v64
    v_exp_f32 v65, v65
    v_exp_f32 v66, v66
    v_exp_f32 v67, v67
    v_exp_f32 v68, v68
    v_exp_f32 v69, v69
    v_exp_f32 v70, v70
    v_exp_f32 v71, v71
    v_add_f32 v64, 1.0, v64
    v_add_f32 v65, 1.0, v65
    v_add_f32 v66, 1.0, v66
    v_add_f32 v67, 1.0, v67
    v_add_f32 v68, 1.0, v68
    v_add_f32 v69, 1.0, v69
    v_add_f32 v70, 1.0, v70
    v_add_f32 v71, 1.0, v71
    v_rcp_f32 v64, v64
    v_rcp_f32 v65, v65
    v_rcp_f32 v66, v66
    v_rcp_f32 v67, v67
    v_rcp_f32 v68, v68
    v_rcp_f32 v69, v69
    v_rcp_f32 v70, v70
    v_rcp_f32 v71, v71
    s_nop 0
    v_cvt_pk_bf16_f32 v80, v64, v65
    v_cvt_pk_bf16_f32 v81, v66, v67
    v_cvt_pk_bf16_f32 v82, v68, v69
    v_cvt_pk_bf16_f32 v83, v70, v71
    ds_write_b128 v2, v[80:83] offset:34816
    v_add_f32 v72, v56, v120
    v_add_f32 v73, v57, v121
    v_add_f32 v74, v58, v122
    v_add_f32 v75, v59, v123
    v_add_f32 v76, v60, v124
    v_add_f32 v77, v61, v125
    v_add_f32 v78, v62, v126
    v_add_f32 v79, v63, v127
    ds_read_b128 v[56:59], v4 offset:12864
    ds_read_b128 v[60:63], v4 offset:12896
    v_exp_f32 v72, v72
    v_exp_f32 v73, v73
    v_exp_f32 v74, v74
    v_exp_f32 v75, v75
    v_exp_f32 v76, v76
    v_exp_f32 v77, v77
    v_exp_f32 v78, v78
    v_exp_f32 v79, v79
    v_add_f32 v72, 1.0, v72
    v_add_f32 v73, 1.0, v73
    v_add_f32 v74, 1.0, v74
    v_add_f32 v75, 1.0, v75
    v_add_f32 v76, 1.0, v76
    v_add_f32 v77, 1.0, v77
    v_add_f32 v78, 1.0, v78
    v_add_f32 v79, 1.0, v79
    v_rcp_f32 v72, v72
    v_rcp_f32 v73, v73
    v_rcp_f32 v74, v74
    v_rcp_f32 v75, v75
    v_rcp_f32 v76, v76
    v_rcp_f32 v77, v77
    v_rcp_f32 v78, v78
    v_rcp_f32 v79, v79
    s_nop 0
    v_cvt_pk_bf16_f32 v84, v72, v73
    v_cvt_pk_bf16_f32 v85, v74, v75
    v_cvt_pk_bf16_f32 v86, v76, v77
    v_cvt_pk_bf16_f32 v87, v78, v79
    ds_write_b128 v2, v[84:87] offset:35840
    s_waitcnt lgkmcnt(0)
    s_barrier
    v_add_f32 v64, v32, v96
    v_add_f32 v65, v33, v97
    v_add_f32 v66, v34, v98
    v_add_f32 v67, v35, v99
    v_add_f32 v68, v36, v100
    v_add_f32 v69, v37, v101
    v_add_f32 v70, v38, v102
    v_add_f32 v71, v39, v103
    ds_read_b128 v[32:35], v4 offset:16896
    ds_read_b128 v[36:39], v4 offset:16928
    v_exp_f32 v64, v64
    v_exp_f32 v65, v65
    v_exp_f32 v66, v66
    v_exp_f32 v67, v67
    v_exp_f32 v68, v68
    v_exp_f32 v69, v69
    v_exp_f32 v70, v70
    v_exp_f32 v71, v71
    v_add_f32 v64, 1.0, v64
    v_add_f32 v65, 1.0, v65
    v_add_f32 v66, 1.0, v66
    v_add_f32 v67, 1.0, v67
    v_add_f32 v68, 1.0, v68
    v_add_f32 v69, 1.0, v69
    v_add_f32 v70, 1.0, v70
    v_add_f32 v71, 1.0, v71
    v_rcp_f32 v64, v64
    v_rcp_f32 v65, v65
    v_rcp_f32 v66, v66
    v_rcp_f32 v67, v67
    v_rcp_f32 v68, v68
    v_rcp_f32 v69, v69
    v_rcp_f32 v70, v70
    v_rcp_f32 v71, v71
    s_nop 0
    v_cvt_pk_bf16_f32 v80, v64, v65
    v_cvt_pk_bf16_f32 v81, v66, v67
    v_cvt_pk_bf16_f32 v82, v68, v69
    v_cvt_pk_bf16_f32 v83, v70, v71
    ds_write_b128 v2, v[80:83] offset:0
    v_add_f32 v72, v40, v104
    v_add_f32 v73, v41, v105
    v_add_f32 v74, v42, v106
    v_add_f32 v75, v43, v107
    v_add_f32 v76, v44, v108
    v_add_f32 v77, v45, v109
    v_add_f32 v78, v46, v110
    v_add_f32 v79, v47, v111
    ds_read_b128 v[40:43], v4 offset:16960
    ds_read_b128 v[44:47], v4 offset:16992
    v_exp_f32 v72, v72
    v_exp_f32 v73, v73
    v_exp_f32 v74, v74
    v_exp_f32 v75, v75
    v_exp_f32 v76, v76
    v_exp_f32 v77, v77
    v_exp_f32 v78, v78
    v_exp_f32 v79, v79
    v_add_f32 v72, 1.0, v72
    v_add_f32 v73, 1.0, v73
    v_add_f32 v74, 1.0, v74
    v_add_f32 v75, 1.0, v75
    v_add_f32 v76, 1.0, v76
    v_add_f32 v77, 1.0, v77
    v_add_f32 v78, 1.0, v78
    v_add_f32 v79, 1.0, v79
    v_rcp_f32 v72, v72
    v_rcp_f32 v73, v73
    v_rcp_f32 v74, v74
    v_rcp_f32 v75, v75
    v_rcp_f32 v76, v76
    v_rcp_f32 v77, v77
    v_rcp_f32 v78, v78
    v_rcp_f32 v79, v79
    s_nop 0
    v_cvt_pk_bf16_f32 v84, v72, v73
    v_cvt_pk_bf16_f32 v85, v74, v75
    v_cvt_pk_bf16_f32 v86, v76, v77
    v_cvt_pk_bf16_f32 v87, v78, v79
    ds_write_b128 v2, v[84:87] offset:1024
    v_add_f32 v64, v48, v112
    v_add_f32 v65, v49, v113
    v_add_f32 v66, v50, v114
    v_add_f32 v67, v51, v115
    v_add_f32 v68, v52, v116
    v_add_f32 v69, v53, v117
    v_add_f32 v70, v54, v118
    v_add_f32 v71, v55, v119
    ds_read_b128 v[48:51], v4 offset:17024
    ds_read_b128 v[52:55], v4 offset:17056
    v_exp_f32 v64, v64
    v_exp_f32 v65, v65
    v_exp_f32 v66, v66
    v_exp_f32 v67, v67
    v_exp_f32 v68, v68
    v_exp_f32 v69, v69
    v_exp_f32 v70, v70
    v_exp_f32 v71, v71
    v_add_f32 v64, 1.0, v64
    v_add_f32 v65, 1.0, v65
    v_add_f32 v66, 1.0, v66
    v_add_f32 v67, 1.0, v67
    v_add_f32 v68, 1.0, v68
    v_add_f32 v69, 1.0, v69
    v_add_f32 v70, 1.0, v70
    v_add_f32 v71, 1.0, v71
    v_rcp_f32 v64, v64
    v_rcp_f32 v65, v65
    v_rcp_f32 v66, v66
    v_rcp_f32 v67, v67
    v_rcp_f32 v68, v68
    v_rcp_f32 v69, v69
    v_rcp_f32 v70, v70
    v_rcp_f32 v71, v71
    s_nop 0
    v_cvt_pk_bf16_f32 v80, v64, v65
    v_cvt_pk_bf16_f32 v81, v66, v67
    v_cvt_pk_bf16_f32 v82, v68, v69
    v_cvt_pk_bf16_f32 v83, v70, v71
    ds_write_b128 v2, v[80:83] offset:2048
    v_add_f32 v72, v56, v120
    v_add_f32 v73, v57, v121
    v_add_f32 v74, v58, v122
    v_add_f32 v75, v59, v123
    v_add_f32 v76, v60, v124
    v_add_f32 v77, v61, v125
    v_add_f32 v78, v62, v126
    v_add_f32 v79, v63, v127
    ds_read_b128 v[56:59], v4 offset:17088
    ds_read_b128 v[60:63], v4 offset:17120
    v_exp_f32 v72, v72
    v_exp_f32 v73, v73
    v_exp_f32 v74, v74
    v_exp_f32 v75, v75
    v_exp_f32 v76, v76
    v_exp_f32 v77, v77
    v_exp_f32 v78, v78
    v_exp_f32 v79, v79
    v_add_f32 v72, 1.0, v72
    v_add_f32 v73, 1.0, v73
    v_add_f32 v74, 1.0, v74
    v_add_f32 v75, 1.0, v75
    v_add_f32 v76, 1.0, v76
    v_add_f32 v77, 1.0, v77
    v_add_f32 v78, 1.0, v78
    v_add_f32 v79, 1.0, v79
    v_rcp_f32 v72, v72
    v_rcp_f32 v73, v73
    v_rcp_f32 v74, v74
    v_rcp_f32 v75, v75
    v_rcp_f32 v76, v76
    v_rcp_f32 v77, v77
    v_rcp_f32 v78, v78
    v_rcp_f32 v79, v79
    s_nop 0
    v_cvt_pk_bf16_f32 v84, v72, v73
    v_cvt_pk_bf16_f32 v85, v74, v75
    v_cvt_pk_bf16_f32 v86, v76, v77
    v_cvt_pk_bf16_f32 v87, v78, v79
    ds_write_b128 v2, v[84:87] offset:3072
    s_waitcnt lgkmcnt(0)
    s_barrier
    ds_read_b128 a[0:3], v6 offset:0
    ds_read_b128 a[4:7], v6 offset:1056
    ds_read_b128 a[8:11], v6 offset:2112
    ds_read_b128 a[12:15], v6 offset:3168
    v_add_f32 v64, v32, v96
    v_add_f32 v65, v33, v97
    v_add_f32 v66, v34, v98
    v_add_f32 v67, v35, v99
    v_add_f32 v68, v36, v100
    v_add_f32 v69, v37, v101
    v_add_f32 v70, v38, v102
    v_add_f32 v71, v39, v103
    ds_read_b128 v[32:35], v4 offset:21120
    ds_read_b128 v[36:39], v4 offset:21152
    v_exp_f32 v64, v64
    v_exp_f32 v65, v65
    v_exp_f32 v66, v66
    v_exp_f32 v67, v67
    v_exp_f32 v68, v68
    v_exp_f32 v69, v69
    v_exp_f32 v70, v70
    v_exp_f32 v71, v71
    v_add_f32 v64, 1.0, v64
    v_add_f32 v65, 1.0, v65
    v_add_f32 v66, 1.0, v66
    v_add_f32 v67, 1.0, v67
    v_add_f32 v68, 1.0, v68
    v_add_f32 v69, 1.0, v69
    v_add_f32 v70, 1.0, v70
    v_add_f32 v71, 1.0, v71
    v_rcp_f32 v64, v64
    v_rcp_f32 v65, v65
    v_rcp_f32 v66, v66
    v_rcp_f32 v67, v67
    v_rcp_f32 v68, v68
    v_rcp_f32 v69, v69
    v_rcp_f32 v70, v70
    v_rcp_f32 v71, v71
    s_waitcnt lgkmcnt(5)
    s_mov_b32 s36, 0
    buffer_store_dwordx4 a[0:3], v7, s[16:19], s36 offen sc1
    s_waitcnt lgkmcnt(4)
    s_mov_b32 s36, 1024
    buffer_store_dwordx4 a[4:7], v7, s[16:19], s36 offen sc1
    v_cvt_pk_bf16_f32 v80, v64, v65
    v_cvt_pk_bf16_f32 v81, v66, v67
    v_cvt_pk_bf16_f32 v82, v68, v69
    v_cvt_pk_bf16_f32 v83, v70, v71
    ds_write_b128 v2, v[80:83] offset:16384
    v_add_f32 v72, v40, v104
    v_add_f32 v73, v41, v105
    v_add_f32 v74, v42, v106
    v_add_f32 v75, v43, v107
    v_add_f32 v76, v44, v108
    v_add_f32 v77, v45, v109
    v_add_f32 v78, v46, v110
    v_add_f32 v79, v47, v111
    ds_read_b128 v[40:43], v4 offset:21184
    ds_read_b128 v[44:47], v4 offset:21216
    v_exp_f32 v72, v72
    v_exp_f32 v73, v73
    v_exp_f32 v74, v74
    v_exp_f32 v75, v75
    v_exp_f32 v76, v76
    v_exp_f32 v77, v77
    v_exp_f32 v78, v78
    v_exp_f32 v79, v79
    v_add_f32 v72, 1.0, v72
    v_add_f32 v73, 1.0, v73
    v_add_f32 v74, 1.0, v74
    v_add_f32 v75, 1.0, v75
    v_add_f32 v76, 1.0, v76
    v_add_f32 v77, 1.0, v77
    v_add_f32 v78, 1.0, v78
    v_add_f32 v79, 1.0, v79
    v_rcp_f32 v72, v72
    v_rcp_f32 v73, v73
    v_rcp_f32 v74, v74
    v_rcp_f32 v75, v75
    v_rcp_f32 v76, v76
    v_rcp_f32 v77, v77
    v_rcp_f32 v78, v78
    v_rcp_f32 v79, v79
    s_waitcnt lgkmcnt(6)
    s_mov_b32 s36, 2048
    buffer_store_dwordx4 a[8:11], v7, s[16:19], s36 offen sc1
    s_waitcnt lgkmcnt(5)
    s_mov_b32 s36, 3072
    buffer_store_dwordx4 a[12:15], v7, s[16:19], s36 offen sc1
    v_cvt_pk_bf16_f32 v84, v72, v73
    v_cvt_pk_bf16_f32 v85, v74, v75
    v_cvt_pk_bf16_f32 v86, v76, v77
    v_cvt_pk_bf16_f32 v87, v78, v79
    ds_write_b128 v2, v[84:87] offset:17408
    v_add_f32 v64, v48, v112
    v_add_f32 v65, v49, v113
    v_add_f32 v66, v50, v114
    v_add_f32 v67, v51, v115
    v_add_f32 v68, v52, v116
    v_add_f32 v69, v53, v117
    v_add_f32 v70, v54, v118
    v_add_f32 v71, v55, v119
    ds_read_b128 v[48:51], v4 offset:21248
    ds_read_b128 v[52:55], v4 offset:21280
    v_exp_f32 v64, v64
    v_exp_f32 v65, v65
    v_exp_f32 v66, v66
    v_exp_f32 v67, v67
    v_exp_f32 v68, v68
    v_exp_f32 v69, v69
    v_exp_f32 v70, v70
    v_exp_f32 v71, v71
    v_add_f32 v64, 1.0, v64
    v_add_f32 v65, 1.0, v65
    v_add_f32 v66, 1.0, v66
    v_add_f32 v67, 1.0, v67
    v_add_f32 v68, 1.0, v68
    v_add_f32 v69, 1.0, v69
    v_add_f32 v70, 1.0, v70
    v_add_f32 v71, 1.0, v71
    v_rcp_f32 v64, v64
    v_rcp_f32 v65, v65
    v_rcp_f32 v66, v66
    v_rcp_f32 v67, v67
    v_rcp_f32 v68, v68
    v_rcp_f32 v69, v69
    v_rcp_f32 v70, v70
    v_rcp_f32 v71, v71
    s_nop 0
    v_cvt_pk_bf16_f32 v80, v64, v65
    v_cvt_pk_bf16_f32 v81, v66, v67
    v_cvt_pk_bf16_f32 v82, v68, v69
    v_cvt_pk_bf16_f32 v83, v70, v71
    ds_write_b128 v2, v[80:83] offset:18432
    v_add_f32 v72, v56, v120
    v_add_f32 v73, v57, v121
    v_add_f32 v74, v58, v122
    v_add_f32 v75, v59, v123
    v_add_f32 v76, v60, v124
    v_add_f32 v77, v61, v125
    v_add_f32 v78, v62, v126
    v_add_f32 v79, v63, v127
    ds_read_b128 v[56:59], v4 offset:21312
    ds_read_b128 v[60:63], v4 offset:21344
    v_exp_f32 v72, v72
    v_exp_f32 v73, v73
    v_exp_f32 v74, v74
    v_exp_f32 v75, v75
    v_exp_f32 v76, v76
    v_exp_f32 v77, v77
    v_exp_f32 v78, v78
    v_exp_f32 v79, v79
    v_add_f32 v72, 1.0, v72
    v_add_f32 v73, 1.0, v73
    v_add_f32 v74, 1.0, v74
    v_add_f32 v75, 1.0, v75
    v_add_f32 v76, 1.0, v76
    v_add_f32 v77, 1.0, v77
    v_add_f32 v78, 1.0, v78
    v_add_f32 v79, 1.0, v79
    v_rcp_f32 v72, v72
    v_rcp_f32 v73, v73
    v_rcp_f32 v74, v74
    v_rcp_f32 v75, v75
    v_rcp_f32 v76, v76
    v_rcp_f32 v77, v77
    v_rcp_f32 v78, v78
    v_rcp_f32 v79, v79
    s_nop 0
    v_cvt_pk_bf16_f32 v84, v72, v73
    v_cvt_pk_bf16_f32 v85, v74, v75
    v_cvt_pk_bf16_f32 v86, v76, v77
    v_cvt_pk_bf16_f32 v87, v78, v79
    ds_write_b128 v2, v[84:87] offset:19456
    s_waitcnt lgkmcnt(0)
    s_barrier
    ds_read_b128 a[0:3], v6 offset:16896
    ds_read_b128 a[4:7], v6 offset:17952
    ds_read_b128 a[8:11], v6 offset:19008
    ds_read_b128 a[12:15], v6 offset:20064
    v_add_f32 v64, v32, v96
    v_add_f32 v65, v33, v97
    v_add_f32 v66, v34, v98
    v_add_f32 v67, v35, v99
    v_add_f32 v68, v36, v100
    v_add_f32 v69, v37, v101
    v_add_f32 v70, v38, v102
    v_add_f32 v71, v39, v103
    ds_read_b128 v[32:35], v4 offset:25344
    ds_read_b128 v[36:39], v4 offset:25376
    v_exp_f32 v64, v64
    v_exp_f32 v65, v65
    v_exp_f32 v66, v66
    v_exp_f32 v67, v67
    v_exp_f32 v68, v68
    v_exp_f32 v69, v69
    v_exp_f32 v70, v70
    v_exp_f32 v71, v71
    v_add_f32 v64, 1.0, v64
    v_add_f32 v65, 1.0, v65
    v_add_f32 v66, 1.0, v66
    v_add_f32 v67, 1.0, v67
    v_add_f32 v68, 1.0, v68
    v_add_f32 v69, 1.0, v69
    v_add_f32 v70, 1.0, v70
    v_add_f32 v71, 1.0, v71
    v_rcp_f32 v64, v64
    v_rcp_f32 v65, v65
    v_rcp_f32 v66, v66
    v_rcp_f32 v67, v67
    v_rcp_f32 v68, v68
    v_rcp_f32 v69, v69
    v_rcp_f32 v70, v70
    v_rcp_f32 v71, v71
    s_waitcnt lgkmcnt(5)
    s_mov_b32 s36, 16384
    buffer_store_dwordx4 a[0:3], v7, s[16:19], s36 offen sc1
    s_waitcnt lgkmcnt(4)
    s_mov_b32 s36, 17408
    buffer_store_dwordx4 a[4:7], v7, s[16:19], s36 offen sc1
    v_cvt_pk_bf16_f32 v80, v64, v65
    v_cvt_pk_bf16_f32 v81, v66, v67
    v_cvt_pk_bf16_f32 v82, v68, v69
    v_cvt_pk_bf16_f32 v83, v70, v71
    ds_write_b128 v2, v[80:83] offset:32768
    v_add_f32 v72, v40, v104
    v_add_f32 v73, v41, v105
    v_add_f32 v74, v42, v106
    v_add_f32 v75, v43, v107
    v_add_f32 v76, v44, v108
    v_add_f32 v77, v45, v109
    v_add_f32 v78, v46, v110
    v_add_f32 v79, v47, v111
    ds_read_b128 v[40:43], v4 offset:25408
    ds_read_b128 v[44:47], v4 offset:25440
    v_exp_f32 v72, v72
    v_exp_f32 v73, v73
    v_exp_f32 v74, v74
    v_exp_f32 v75, v75
    v_exp_f32 v76, v76
    v_exp_f32 v77, v77
    v_exp_f32 v78, v78
    v_exp_f32 v79, v79
    v_add_f32 v72, 1.0, v72
    v_add_f32 v73, 1.0, v73
    v_add_f32 v74, 1.0, v74
    v_add_f32 v75, 1.0, v75
    v_add_f32 v76, 1.0, v76
    v_add_f32 v77, 1.0, v77
    v_add_f32 v78, 1.0, v78
    v_add_f32 v79, 1.0, v79
    v_rcp_f32 v72, v72
    v_rcp_f32 v73, v73
    v_rcp_f32 v74, v74
    v_rcp_f32 v75, v75
    v_rcp_f32 v76, v76
    v_rcp_f32 v77, v77
    v_rcp_f32 v78, v78
    v_rcp_f32 v79, v79
    s_waitcnt lgkmcnt(6)
    s_mov_b32 s36, 18432
    buffer_store_dwordx4 a[8:11], v7, s[16:19], s36 offen sc1
    s_waitcnt lgkmcnt(5)
    s_mov_b32 s36, 19456
    buffer_store_dwordx4 a[12:15], v7, s[16:19], s36 offen sc1
    v_cvt_pk_bf16_f32 v84, v72, v73
    v_cvt_pk_bf16_f32 v85, v74, v75
    v_cvt_pk_bf16_f32 v86, v76, v77
    v_cvt_pk_bf16_f32 v87, v78, v79
    ds_write_b128 v2, v[84:87] offset:33792
    v_add_f32 v64, v48, v112
    v_add_f32 v65, v49, v113
    v_add_f32 v66, v50, v114
    v_add_f32 v67, v51, v115
    v_add_f32 v68, v52, v116
    v_add_f32 v69, v53, v117
    v_add_f32 v70, v54, v118
    v_add_f32 v71, v55, v119
    ds_read_b128 v[48:51], v4 offset:25472
    ds_read_b128 v[52:55], v4 offset:25504
    v_exp_f32 v64, v64
    v_exp_f32 v65, v65
    v_exp_f32 v66, v66
    v_exp_f32 v67, v67
    v_exp_f32 v68, v68
    v_exp_f32 v69, v69
    v_exp_f32 v70, v70
    v_exp_f32 v71, v71
    v_add_f32 v64, 1.0, v64
    v_add_f32 v65, 1.0, v65
    v_add_f32 v66, 1.0, v66
    v_add_f32 v67, 1.0, v67
    v_add_f32 v68, 1.0, v68
    v_add_f32 v69, 1.0, v69
    v_add_f32 v70, 1.0, v70
    v_add_f32 v71, 1.0, v71
    v_rcp_f32 v64, v64
    v_rcp_f32 v65, v65
    v_rcp_f32 v66, v66
    v_rcp_f32 v67, v67
    v_rcp_f32 v68, v68
    v_rcp_f32 v69, v69
    v_rcp_f32 v70, v70
    v_rcp_f32 v71, v71
    s_nop 0
    v_cvt_pk_bf16_f32 v80, v64, v65
    v_cvt_pk_bf16_f32 v81, v66, v67
    v_cvt_pk_bf16_f32 v82, v68, v69
    v_cvt_pk_bf16_f32 v83, v70, v71
    ds_write_b128 v2, v[80:83] offset:34816
    v_add_f32 v72, v56, v120
    v_add_f32 v73, v57, v121
    v_add_f32 v74, v58, v122
    v_add_f32 v75, v59, v123
    v_add_f32 v76, v60, v124
    v_add_f32 v77, v61, v125
    v_add_f32 v78, v62, v126
    v_add_f32 v79, v63, v127
    ds_read_b128 v[56:59], v4 offset:25536
    ds_read_b128 v[60:63], v4 offset:25568
    v_exp_f32 v72, v72
    v_exp_f32 v73, v73
    v_exp_f32 v74, v74
    v_exp_f32 v75, v75
    v_exp_f32 v76, v76
    v_exp_f32 v77, v77
    v_exp_f32 v78, v78
    v_exp_f32 v79, v79
    v_add_f32 v72, 1.0, v72
    v_add_f32 v73, 1.0, v73
    v_add_f32 v74, 1.0, v74
    v_add_f32 v75, 1.0, v75
    v_add_f32 v76, 1.0, v76
    v_add_f32 v77, 1.0, v77
    v_add_f32 v78, 1.0, v78
    v_add_f32 v79, 1.0, v79
    v_rcp_f32 v72, v72
    v_rcp_f32 v73, v73
    v_rcp_f32 v74, v74
    v_rcp_f32 v75, v75
    v_rcp_f32 v76, v76
    v_rcp_f32 v77, v77
    v_rcp_f32 v78, v78
    v_rcp_f32 v79, v79
    s_nop 0
    v_cvt_pk_bf16_f32 v84, v72, v73
    v_cvt_pk_bf16_f32 v85, v74, v75
    v_cvt_pk_bf16_f32 v86, v76, v77
    v_cvt_pk_bf16_f32 v87, v78, v79
    ds_write_b128 v2, v[84:87] offset:35840
    s_waitcnt lgkmcnt(0)
    s_barrier
    ds_read_b128 a[0:3], v6 offset:0
    ds_read_b128 a[4:7], v6 offset:1056
    ds_read_b128 a[8:11], v6 offset:2112
    ds_read_b128 a[12:15], v6 offset:3168
    v_add_f32 v64, v32, v96
    v_add_f32 v65, v33, v97
    v_add_f32 v66, v34, v98
    v_add_f32 v67, v35, v99
    v_add_f32 v68, v36, v100
    v_add_f32 v69, v37, v101
    v_add_f32 v70, v38, v102
    v_add_f32 v71, v39, v103
    ds_read_b128 v[32:35], v4 offset:29568
    ds_read_b128 v[36:39], v4 offset:29600
    v_exp_f32 v64, v64
    v_exp_f32 v65, v65
    v_exp_f32 v66, v66
    v_exp_f32 v67, v67
    v_exp_f32 v68, v68
    v_exp_f32 v69, v69
    v_exp_f32 v70, v70
    v_exp_f32 v71, v71
    v_add_f32 v64, 1.0, v64
    v_add_f32 v65, 1.0, v65
    v_add_f32 v66, 1.0, v66
    v_add_f32 v67, 1.0, v67
    v_add_f32 v68, 1.0, v68
    v_add_f32 v69, 1.0, v69
    v_add_f32 v70, 1.0, v70
    v_add_f32 v71, 1.0, v71
    v_rcp_f32 v64, v64
    v_rcp_f32 v65, v65
    v_rcp_f32 v66, v66
    v_rcp_f32 v67, v67
    v_rcp_f32 v68, v68
    v_rcp_f32 v69, v69
    v_rcp_f32 v70, v70
    v_rcp_f32 v71, v71
    s_waitcnt lgkmcnt(5)
    s_mov_b32 s36, 32768
    buffer_store_dwordx4 a[0:3], v7, s[16:19], s36 offen sc1
    s_waitcnt lgkmcnt(4)
    s_mov_b32 s36, 33792
    buffer_store_dwordx4 a[4:7], v7, s[16:19], s36 offen sc1
    v_cvt_pk_bf16_f32 v80, v64, v65
    v_cvt_pk_bf16_f32 v81, v66, v67
    v_cvt_pk_bf16_f32 v82, v68, v69
    v_cvt_pk_bf16_f32 v83, v70, v71
    ds_write_b128 v2, v[80:83] offset:0
    v_add_f32 v72, v40, v104
    v_add_f32 v73, v41, v105
    v_add_f32 v74, v42, v106
    v_add_f32 v75, v43, v107
    v_add_f32 v76, v44, v108
    v_add_f32 v77, v45, v109
    v_add_f32 v78, v46, v110
    v_add_f32 v79, v47, v111
    ds_read_b128 v[40:43], v4 offset:29632
    ds_read_b128 v[44:47], v4 offset:29664
    v_exp_f32 v72, v72
    v_exp_f32 v73, v73
    v_exp_f32 v74, v74
    v_exp_f32 v75, v75
    v_exp_f32 v76, v76
    v_exp_f32 v77, v77
    v_exp_f32 v78, v78
    v_exp_f32 v79, v79
    v_add_f32 v72, 1.0, v72
    v_add_f32 v73, 1.0, v73
    v_add_f32 v74, 1.0, v74
    v_add_f32 v75, 1.0, v75
    v_add_f32 v76, 1.0, v76
    v_add_f32 v77, 1.0, v77
    v_add_f32 v78, 1.0, v78
    v_add_f32 v79, 1.0, v79
    v_rcp_f32 v72, v72
    v_rcp_f32 v73, v73
    v_rcp_f32 v74, v74
    v_rcp_f32 v75, v75
    v_rcp_f32 v76, v76
    v_rcp_f32 v77, v77
    v_rcp_f32 v78, v78
    v_rcp_f32 v79, v79
    s_waitcnt lgkmcnt(6)
    s_mov_b32 s36, 34816
    buffer_store_dwordx4 a[8:11], v7, s[16:19], s36 offen sc1
    s_waitcnt lgkmcnt(5)
    s_mov_b32 s36, 35840
    buffer_store_dwordx4 a[12:15], v7, s[16:19], s36 offen sc1
    v_cvt_pk_bf16_f32 v84, v72, v73
    v_cvt_pk_bf16_f32 v85, v74, v75
    v_cvt_pk_bf16_f32 v86, v76, v77
    v_cvt_pk_bf16_f32 v87, v78, v79
    ds_write_b128 v2, v[84:87] offset:1024
    v_add_f32 v64, v48, v112
    v_add_f32 v65, v49, v113
    v_add_f32 v66, v50, v114
    v_add_f32 v67, v51, v115
    v_add_f32 v68, v52, v116
    v_add_f32 v69, v53, v117
    v_add_f32 v70, v54, v118
    v_add_f32 v71, v55, v119
    ds_read_b128 v[48:51], v4 offset:29696
    ds_read_b128 v[52:55], v4 offset:29728
    v_exp_f32 v64, v64
    v_exp_f32 v65, v65
    v_exp_f32 v66, v66
    v_exp_f32 v67, v67
    v_exp_f32 v68, v68
    v_exp_f32 v69, v69
    v_exp_f32 v70, v70
    v_exp_f32 v71, v71
    v_add_f32 v64, 1.0, v64
    v_add_f32 v65, 1.0, v65
    v_add_f32 v66, 1.0, v66
    v_add_f32 v67, 1.0, v67
    v_add_f32 v68, 1.0, v68
    v_add_f32 v69, 1.0, v69
    v_add_f32 v70, 1.0, v70
    v_add_f32 v71, 1.0, v71
    v_rcp_f32 v64, v64
    v_rcp_f32 v65, v65
    v_rcp_f32 v66, v66
    v_rcp_f32 v67, v67
    v_rcp_f32 v68, v68
    v_rcp_f32 v69, v69
    v_rcp_f32 v70, v70
    v_rcp_f32 v71, v71
    s_nop 0
    v_cvt_pk_bf16_f32 v80, v64, v65
    v_cvt_pk_bf16_f32 v81, v66, v67
    v_cvt_pk_bf16_f32 v82, v68, v69
    v_cvt_pk_bf16_f32 v83, v70, v71
    ds_write_b128 v2, v[80:83] offset:2048
    v_add_f32 v72, v56, v120
    v_add_f32 v73, v57, v121
    v_add_f32 v74, v58, v122
    v_add_f32 v75, v59, v123
    v_add_f32 v76, v60, v124
    v_add_f32 v77, v61, v125
    v_add_f32 v78, v62, v126
    v_add_f32 v79, v63, v127
    ds_read_b128 v[56:59], v4 offset:29760
    ds_read_b128 v[60:63], v4 offset:29792
    v_exp_f32 v72, v72
    v_exp_f32 v73, v73
    v_exp_f32 v74, v74
    v_exp_f32 v75, v75
    v_exp_f32 v76, v76
    v_exp_f32 v77, v77
    v_exp_f32 v78, v78
    v_exp_f32 v79, v79
    v_add_f32 v72, 1.0, v72
    v_add_f32 v73, 1.0, v73
    v_add_f32 v74, 1.0, v74
    v_add_f32 v75, 1.0, v75
    v_add_f32 v76, 1.0, v76
    v_add_f32 v77, 1.0, v77
    v_add_f32 v78, 1.0, v78
    v_add_f32 v79, 1.0, v79
    v_rcp_f32 v72, v72
    v_rcp_f32 v73, v73
    v_rcp_f32 v74, v74
    v_rcp_f32 v75, v75
    v_rcp_f32 v76, v76
    v_rcp_f32 v77, v77
    v_rcp_f32 v78, v78
    v_rcp_f32 v79, v79
    s_nop 0
    v_cvt_pk_bf16_f32 v84, v72, v73
    v_cvt_pk_bf16_f32 v85, v74, v75
    v_cvt_pk_bf16_f32 v86, v76, v77
    v_cvt_pk_bf16_f32 v87, v78, v79
    ds_write_b128 v2, v[84:87] offset:3072
    s_waitcnt lgkmcnt(0)
    s_barrier
    ds_read_b128 a[0:3], v6 offset:16896
    ds_read_b128 a[4:7], v6 offset:17952
    ds_read_b128 a[8:11], v6 offset:19008
    ds_read_b128 a[12:15], v6 offset:20064
    v_add_f32 v64, v32, v96
    v_add_f32 v65, v33, v97
    v_add_f32 v66, v34, v98
    v_add_f32 v67, v35, v99
    v_add_f32 v68, v36, v100
    v_add_f32 v69, v37, v101
    v_add_f32 v70, v38, v102
    v_add_f32 v71, v39, v103
    v_exp_f32 v64, v64
    v_exp_f32 v65, v65
    v_exp_f32 v66, v66
    v_exp_f32 v67, v67
    v_exp_f32 v68, v68
    v_exp_f32 v69, v69
    v_exp_f32 v70, v70
    v_exp_f32 v71, v71
    v_add_f32 v64, 1.0, v64
    v_add_f32 v65, 1.0, v65
    v_add_f32 v66, 1.0, v66
    v_add_f32 v67, 1.0, v67
    v_add_f32 v68, 1.0, v68
    v_add_f32 v69, 1.0, v69
    v_add_f32 v70, 1.0, v70
    v_add_f32 v71, 1.0, v71
    v_rcp_f32 v64, v64
    v_rcp_f32 v65, v65
    v_rcp_f32 v66, v66
    v_rcp_f32 v67, v67
    v_rcp_f32 v68, v68
    v_rcp_f32 v69, v69
    v_rcp_f32 v70, v70
    v_rcp_f32 v71, v71
    s_waitcnt lgkmcnt(3)
    s_mov_b32 s36, 49152
    buffer_store_dwordx4 a[0:3], v7, s[16:19], s36 offen sc1
    s_waitcnt lgkmcnt(2)
    s_mov_b32 s36, 50176
    buffer_store_dwordx4 a[4:7], v7, s[16:19], s36 offen sc1
    v_cvt_pk_bf16_f32 v80, v64, v65
    v_cvt_pk_bf16_f32 v81, v66, v67
    v_cvt_pk_bf16_f32 v82, v68, v69
    v_cvt_pk_bf16_f32 v83, v70, v71
    ds_write_b128 v2, v[80:83] offset:16384
    v_add_f32 v72, v40, v104
    v_add_f32 v73, v41, v105
    v_add_f32 v74, v42, v106
    v_add_f32 v75, v43, v107
    v_add_f32 v76, v44, v108
    v_add_f32 v77, v45, v109
    v_add_f32 v78, v46, v110
    v_add_f32 v79, v47, v111
    v_exp_f32 v72, v72
    v_exp_f32 v73, v73
    v_exp_f32 v74, v74
    v_exp_f32 v75, v75
    v_exp_f32 v76, v76
    v_exp_f32 v77, v77
    v_exp_f32 v78, v78
    v_exp_f32 v79, v79
    v_add_f32 v72, 1.0, v72
    v_add_f32 v73, 1.0, v73
    v_add_f32 v74, 1.0, v74
    v_add_f32 v75, 1.0, v75
    v_add_f32 v76, 1.0, v76
    v_add_f32 v77, 1.0, v77
    v_add_f32 v78, 1.0, v78
    v_add_f32 v79, 1.0, v79
    v_rcp_f32 v72, v72
    v_rcp_f32 v73, v73
    v_rcp_f32 v74, v74
    v_rcp_f32 v75, v75
    v_rcp_f32 v76, v76
    v_rcp_f32 v77, v77
    v_rcp_f32 v78, v78
    v_rcp_f32 v79, v79
    s_waitcnt lgkmcnt(2)
    s_mov_b32 s36, 51200
    buffer_store_dwordx4 a[8:11], v7, s[16:19], s36 offen sc1
    s_waitcnt lgkmcnt(1)
    s_mov_b32 s36, 52224
    buffer_store_dwordx4 a[12:15], v7, s[16:19], s36 offen sc1
    v_cvt_pk_bf16_f32 v84, v72, v73
    v_cvt_pk_bf16_f32 v85, v74, v75
    v_cvt_pk_bf16_f32 v86, v76, v77
    v_cvt_pk_bf16_f32 v87, v78, v79
    ds_write_b128 v2, v[84:87] offset:17408
    v_add_f32 v64, v48, v112
    v_add_f32 v65, v49, v113
    v_add_f32 v66, v50, v114
    v_add_f32 v67, v51, v115
    v_add_f32 v68, v52, v116
    v_add_f32 v69, v53, v117
    v_add_f32 v70, v54, v118
    v_add_f32 v71, v55, v119
    v_exp_f32 v64, v64
    v_exp_f32 v65, v65
    v_exp_f32 v66, v66
    v_exp_f32 v67, v67
    v_exp_f32 v68, v68
    v_exp_f32 v69, v69
    v_exp_f32 v70, v70
    v_exp_f32 v71, v71
    v_add_f32 v64, 1.0, v64
    v_add_f32 v65, 1.0, v65
    v_add_f32 v66, 1.0, v66
    v_add_f32 v67, 1.0, v67
    v_add_f32 v68, 1.0, v68
    v_add_f32 v69, 1.0, v69
    v_add_f32 v70, 1.0, v70
    v_add_f32 v71, 1.0, v71
    v_rcp_f32 v64, v64
    v_rcp_f32 v65, v65
    v_rcp_f32 v66, v66
    v_rcp_f32 v67, v67
    v_rcp_f32 v68, v68
    v_rcp_f32 v69, v69
    v_rcp_f32 v70, v70
    v_rcp_f32 v71, v71
    s_nop 0
    v_cvt_pk_bf16_f32 v80, v64, v65
    v_cvt_pk_bf16_f32 v81, v66, v67
    v_cvt_pk_bf16_f32 v82, v68, v69
    v_cvt_pk_bf16_f32 v83, v70, v71
    ds_write_b128 v2, v[80:83] offset:18432
    v_add_f32 v72, v56, v120
    v_add_f32 v73, v57, v121
    v_add_f32 v74, v58, v122
    v_add_f32 v75, v59, v123
    v_add_f32 v76, v60, v124
    v_add_f32 v77, v61, v125
    v_add_f32 v78, v62, v126
    v_add_f32 v79, v63, v127
    v_exp_f32 v72, v72
    v_exp_f32 v73, v73
    v_exp_f32 v74, v74
    v_exp_f32 v75, v75
    v_exp_f32 v76, v76
    v_exp_f32 v77, v77
    v_exp_f32 v78, v78
    v_exp_f32 v79, v79
    v_add_f32 v72, 1.0, v72
    v_add_f32 v73, 1.0, v73
    v_add_f32 v74, 1.0, v74
    v_add_f32 v75, 1.0, v75
    v_add_f32 v76, 1.0, v76
    v_add_f32 v77, 1.0, v77
    v_add_f32 v78, 1.0, v78
    v_add_f32 v79, 1.0, v79
    v_rcp_f32 v72, v72
    v_rcp_f32 v73, v73
    v_rcp_f32 v74, v74
    v_rcp_f32 v75, v75
    v_rcp_f32 v76, v76
    v_rcp_f32 v77, v77
    v_rcp_f32 v78, v78
    v_rcp_f32 v79, v79
    s_nop 0
    v_cvt_pk_bf16_f32 v84, v72, v73
    v_cvt_pk_bf16_f32 v85, v74, v75
    v_cvt_pk_bf16_f32 v86, v76, v77
    v_cvt_pk_bf16_f32 v87, v78, v79
    ds_write_b128 v2, v[84:87] offset:19456
    s_waitcnt lgkmcnt(0)
    s_barrier
    ds_read_b128 a[0:3], v6 offset:0
    ds_read_b128 a[4:7], v6 offset:1056
    ds_read_b128 a[8:11], v6 offset:2112
    ds_read_b128 a[12:15], v6 offset:3168
    s_waitcnt lgkmcnt(3)
    s_mov_b32 s36, 65536
    buffer_store_dwordx4 a[0:3], v7, s[16:19], s36 offen sc1
    s_waitcnt lgkmcnt(2)
    s_mov_b32 s36, 66560
    buffer_store_dwordx4 a[4:7], v7, s[16:19], s36 offen sc1
    s_waitcnt lgkmcnt(1)
    s_mov_b32 s36, 67584
    buffer_store_dwordx4 a[8:11], v7, s[16:19], s36 offen sc1
    s_waitcnt lgkmcnt(0)
    s_mov_b32 s36, 68608
    buffer_store_dwordx4 a[12:15], v7, s[16:19], s36 offen sc1
    s_barrier
    ds_read_b128 a[0:3], v6 offset:16896
    ds_read_b128 a[4:7], v6 offset:17952
    ds_read_b128 a[8:11], v6 offset:19008
    ds_read_b128 a[12:15], v6 offset:20064
    s_waitcnt lgkmcnt(3)
    s_mov_b32 s36, 81920
    buffer_store_dwordx4 a[0:3], v7, s[16:19], s36 offen sc1
    s_waitcnt lgkmcnt(2)
    s_mov_b32 s36, 82944
    buffer_store_dwordx4 a[4:7], v7, s[16:19], s36 offen sc1
    s_waitcnt lgkmcnt(1)
    s_mov_b32 s36, 83968
    buffer_store_dwordx4 a[8:11], v7, s[16:19], s36 offen sc1
    s_waitcnt lgkmcnt(0)
    s_mov_b32 s36, 84992
    buffer_store_dwordx4 a[12:15], v7, s[16:19], s36 offen sc1
    s_barrier
    ds_read_b128 a[0:3], v6 offset:0
    ds_read_b128 a[4:7], v6 offset:1056
    ds_read_b128 a[8:11], v6 offset:2112
    ds_read_b128 a[12:15], v6 offset:3168
    s_waitcnt lgkmcnt(3)
    s_mov_b32 s36, 98304
    buffer_store_dwordx4 a[0:3], v7, s[16:19], s36 offen sc1
    s_waitcnt lgkmcnt(2)
    s_mov_b32 s36, 99328
    buffer_store_dwordx4 a[4:7], v7, s[16:19], s36 offen sc1
    s_waitcnt lgkmcnt(1)
    s_mov_b32 s36, 100352
    buffer_store_dwordx4 a[8:11], v7, s[16:19], s36 offen sc1
    s_waitcnt lgkmcnt(0)
    s_mov_b32 s36, 101376
    buffer_store_dwordx4 a[12:15], v7, s[16:19], s36 offen sc1
    s_barrier
    ds_read_b128 a[0:3], v6 offset:16896
    ds_read_b128 a[4:7], v6 offset:17952
    ds_read_b128 a[8:11], v6 offset:19008
    ds_read_b128 a[12:15], v6 offset:20064
    s_waitcnt lgkmcnt(3)
    s_mov_b32 s36, 114688
    buffer_store_dwordx4 a[0:3], v7, s[16:19], s36 offen sc1
    s_waitcnt lgkmcnt(2)
    s_mov_b32 s36, 115712
    buffer_store_dwordx4 a[4:7], v7, s[16:19], s36 offen sc1
    s_waitcnt lgkmcnt(1)
    s_mov_b32 s36, 116736
    buffer_store_dwordx4 a[8:11], v7, s[16:19], s36 offen sc1
    s_waitcnt lgkmcnt(0)
    s_mov_b32 s36, 117760
    buffer_store_dwordx4 a[12:15], v7, s[16:19], s36 offen sc1
    s_endpgm
L_joint_kernel_done:
    s_endpgm
.section .rodata,"a"
.p2align 6
.amdhsa_kernel prep_kernel
  .amdhsa_next_free_vgpr 128
  .amdhsa_next_free_sgpr 102
  .amdhsa_accum_offset 128
  .amdhsa_group_segment_fixed_size 0
  .amdhsa_kernarg_size 80
  .amdhsa_user_sgpr_count 2
  .amdhsa_user_sgpr_kernarg_segment_ptr 1
  .amdhsa_system_sgpr_workgroup_id_x 1
.end_amdhsa_kernel
.p2align 6
.amdhsa_kernel gemm1_kernel
  .amdhsa_next_free_vgpr 232
  .amdhsa_next_free_sgpr 102
  .amdhsa_accum_offset 232
  .amdhsa_group_segment_fixed_size 0
  .amdhsa_kernarg_size 80
  .amdhsa_user_sgpr_count 2
  .amdhsa_user_sgpr_kernarg_segment_ptr 1
  .amdhsa_system_sgpr_workgroup_id_x 1
.end_amdhsa_kernel
.p2align 6
.amdhsa_kernel mid_kernel
  .amdhsa_next_free_vgpr 128
  .amdhsa_next_free_sgpr 102
  .amdhsa_accum_offset 128
  .amdhsa_group_segment_fixed_size 0
  .amdhsa_kernarg_size 80
  .amdhsa_user_sgpr_count 2
  .amdhsa_user_sgpr_kernarg_segment_ptr 1
  .amdhsa_system_sgpr_workgroup_id_x 1
.end_amdhsa_kernel
.p2align 6
.amdhsa_kernel gemm2_kernel
  .amdhsa_next_free_vgpr 152
  .amdhsa_next_free_sgpr 102
  .amdhsa_accum_offset 152
  .amdhsa_group_segment_fixed_size 0
  .amdhsa_kernarg_size 80
  .amdhsa_user_sgpr_count 2
  .amdhsa_user_sgpr_kernarg_segment_ptr 1
  .amdhsa_system_sgpr_workgroup_id_x 1
.end_amdhsa_kernel
.p2align 6
.amdhsa_kernel joint_kernel
  .amdhsa_next_free_vgpr 256
  .amdhsa_next_free_sgpr 102
  .amdhsa_accum_offset 128
  .amdhsa_group_segment_fixed_size 0
  .amdhsa_kernarg_size 80
  .amdhsa_user_sgpr_count 2
  .amdhsa_user_sgpr_kernarg_segment_ptr 1
  .amdhsa_system_sgpr_workgroup_id_x 1
.end_amdhsa_kernel
```

```asm
; @launch kernel=prep_kernel grid=(937,1,1) block=(256,1,1) lds=40960
; @launch kernel=gemm1_kernel grid=(256,1,1) block=(512,1,1) lds=143360
; @launch kernel=mid_kernel grid=(704,1,1) block=(256,1,1) lds=53248
; @launch kernel=gemm2_kernel grid=(256,1,1) block=(512,1,1) lds=143360
; @launch kernel=joint_kernel grid=(250,1,1) block=(512,1,1) lds=149504
.amdgcn_target "amdgcn-amd-amdhsa--gfx950"
.text
.globl prep_kernel
.p2align 8
.type prep_kernel,@function
prep_kernel:
    s_cmp_ge_u32 s2, 937
    s_cbranch_scc1 L_prep_kernel_done
    v_readfirstlane_b32 s20, v0
    s_lshr_b32 s20, s20, 6
    s_cmp_lt_u32 s2, 13
    s_cbranch_scc1 L_prep_kernel_slab
    s_cmp_lt_u32 s2, 269
    s_cbranch_scc1 L_prep_kernel_g
    s_load_dwordx2 s[4:5], s[0:1], 0
    s_load_dwordx2 s[6:7], s[0:1], 72
    s_sub_u32 s24, s2, 269
    s_cmp_ge_u32 s24, 334
    s_cselect_b32 s25, 1, 0
    s_mul_i32 s26, s25, 334
    s_sub_u32 s24, s24, s26
    s_lshr_b32 s26, s24, 1
    s_and_b32 s27, s24, 1
    v_and_b32 v1, 63, v0
    v_lshrrev_b32 v2, 3, v1
    s_mul_i32 s28, s26, 96
    s_add_u32 s28, s28, s27
    s_sub_u32 s28, s28, 15
    v_lshlrev_b32 v3, 1, v2
    v_add_u32 v3, s28, v3
    v_lshlrev_b32 v3, 9, v3
    s_lshl_b32 s29, s20, 7
    v_add_u32 v3, s29, v3
    v_bfe_u32 v4, v2, 1, 1
    v_lshlrev_b32 v4, 1, v4
    v_and_b32 v5, 7, v1
    v_xor_b32 v4, v4, v5
    v_lshl_add_u32 v3, v4, 4, v3
    v_xor_b32 v4, 64, v3
    s_waitcnt lgkmcnt(0)
    s_mul_i32 s30, s25, 8192000
    s_add_u32 s8, s4, s30
    s_addc_u32 s9, s5, 0
    s_mov_b32 s10, 8192000
    s_mov_b32 s11, 0x00020000
    s_lshl_b32 s31, s20, 13
    s_add_u32 m0, s31, 0
    v_add_u32 v5, 0, v3
    buffer_load_dwordx4 v5, s[8:11], 0 offen nt lds
    s_add_u32 m0, s31, 1024
    v_add_u32 v5, 8192, v4
    buffer_load_dwordx4 v5, s[8:11], 0 offen nt lds
    s_add_u32 m0, s31, 2048
    v_add_u32 v5, 16384, v3
    buffer_load_dwordx4 v5, s[8:11], 0 offen nt lds
    s_add_u32 m0, s31, 3072
    v_add_u32 v5, 24576, v4
    buffer_load_dwordx4 v5, s[8:11], 0 offen nt lds
    s_add_u32 m0, s31, 4096
    v_add_u32 v5, 32768, v3
    buffer_load_dwordx4 v5, s[8:11], 0 offen nt lds
    s_add_u32 m0, s31, 5120
    v_add_u32 v5, 40960, v4
    buffer_load_dwordx4 v5, s[8:11], 0 offen nt lds
    s_add_u32 m0, s31, 6144
    v_add_u32 v5, 49152, v3
    buffer_load_dwordx4 v5, s[8:11], 0 offen nt lds
    s_add_u32 m0, s31, 7168
    v_add_u32 v5, 57344, v4
    buffer_load_dwordx4 v5, s[8:11], 0 offen nt lds
    s_add_u32 s12, s6, 0
    s_addc_u32 s13, s7, 0
    s_mov_b32 s14, 21889024
    s_mov_b32 s15, 0x00020000
    v_mov_b32 v8, v1
    s_lshl_b32 s32, s20, 4
    v_lshlrev_b32 v6, 4, v1
    s_lshl_b32 s33, s20, 11
    v_add_u32 v7, s33, v6
    v_and_b32 v9, 15, v8
    v_lshrrev_b32 v10, 4, v8
    v_or_b32 v11, 1, v9
    v_add_u32 v11, s32, v11
    v_cvt_f32_u32 v11, v11
    v_mul_f32 v11, 0x3c000000, v11
    v_lshlrev_b32 v10, 3, v10
    v_add_u32 v10, 0, v10
    v_cvt_f32_u32 v10, v10
    v_and_b32 v9, 1, v9
    v_cvt_f32_u32 v9, v9
    v_mul_f32 v9, 0x3e800000, v9
    v_fma_f32 v12, v11, v10, v9
    v_fract_f32 v13, v12
    v_add_f32 v12, v12, v11
    v_fract_f32 v14, v12
    v_add_f32 v12, v12, v11
    v_fract_f32 v15, v12
    v_add_f32 v12, v12, v11
    v_fract_f32 v16, v12
    v_add_f32 v12, v12, v11
    v_fract_f32 v17, v12
    v_add_f32 v12, v12, v11
    v_fract_f32 v18, v12
    v_add_f32 v12, v12, v11
    v_fract_f32 v19, v12
    v_add_f32 v12, v12, v11
    v_fract_f32 v20, v12
    v_cos_f32 v13, v13
    v_cos_f32 v14, v14
    v_cos_f32 v15, v15
    v_cos_f32 v16, v16
    v_cos_f32 v17, v17
    v_cos_f32 v18, v18
    v_cos_f32 v19, v19
    v_cos_f32 v20, v20
    s_nop 0
    v_cvt_pk_bf16_f32 v24, v13, v14
    v_cvt_pk_bf16_f32 v25, v15, v16
    v_cvt_pk_bf16_f32 v26, v17, v18
    v_cvt_pk_bf16_f32 v27, v19, v20
    ds_write_b128 v7, v[24:27] offset:32768
    v_and_b32 v9, 15, v8
    v_lshrrev_b32 v10, 4, v8
    v_or_b32 v11, 1, v9
    v_add_u32 v11, s32, v11
    v_cvt_f32_u32 v11, v11
    v_mul_f32 v11, 0x3c000000, v11
    v_lshlrev_b32 v10, 3, v10
    v_add_u32 v10, 32, v10
    v_cvt_f32_u32 v10, v10
    v_and_b32 v9, 1, v9
    v_cvt_f32_u32 v9, v9
    v_mul_f32 v9, 0x3e800000, v9
    v_fma_f32 v12, v11, v10, v9
    v_fract_f32 v13, v12
    v_add_f32 v12, v12, v11
    v_fract_f32 v14, v12
    v_add_f32 v12, v12, v11
    v_fract_f32 v15, v12
    v_add_f32 v12, v12, v11
    v_fract_f32 v16, v12
    v_add_f32 v12, v12, v11
    v_fract_f32 v17, v12
    v_add_f32 v12, v12, v11
    v_fract_f32 v18, v12
    v_add_f32 v12, v12, v11
    v_fract_f32 v19, v12
    v_add_f32 v12, v12, v11
    v_fract_f32 v20, v12
    v_cos_f32 v13, v13
    v_cos_f32 v14, v14
    v_cos_f32 v15, v15
    v_cos_f32 v16, v16
    v_cos_f32 v17, v17
    v_cos_f32 v18, v18
    v_cos_f32 v19, v19
    v_cos_f32 v20, v20
    s_nop 0
    v_cvt_pk_bf16_f32 v28, v13, v14
    v_cvt_pk_bf16_f32 v29, v15, v16
    v_cvt_pk_bf16_f32 v30, v17, v18
    v_cvt_pk_bf16_f32 v31, v19, v20
    ds_write_b128 v7, v[28:31] offset:33792
    v_bfe_u32 v8, v1, 2, 2
    v_lshrrev_b32 v9, 4, v1
    v_lshl_add_u32 v10, v9, 3, v8
    v_lshlrev_b32 v10, 7, v10
    v_lshrrev_b32 v8, 1, v8
    v_and_b32 v11, 1, v9
    v_lshl_add_u32 v8, v11, 1, v8
    v_lshlrev_b32 v8, 1, v8
    v_bfe_u32 v11, v1, 1, 1
    v_xor_b32 v8, v8, v11
    v_lshl_add_u32 v10, v8, 4, v10
    v_and_b32 v11, 1, v1
    v_lshl_add_u32 v10, v11, 3, v10
    v_add_u32 v10, s31, v10
    v_xor_b32 v12, 0, v10
    v_xor_b32 v13, 32, v10
    v_xor_b32 v14, 64, v10
    v_xor_b32 v15, 96, v10
    v_bfe_u32 v8, v1, 1, 3
    s_mov_b32 s33, 684032
    v_mul_lo_u32 v8, v8, s33
    v_and_b32 v11, 1, v1
    v_lshl_add_u32 v8, v11, 6, v8
    v_lshl_add_u32 v16, v9, 4, v8
    s_mul_i32 s34, s25, 167
    s_add_u32 s34, s34, s26
    s_lshl_b32 s34, s34, 11
    s_lshl_b32 s35, s27, 3
    s_lshl_b32 s36, s20, 1
    s_add_u32 s35, s35, s36
    s_lshl_b32 s35, s35, 7
    s_add_u32 s34, s34, s35
    s_waitcnt lgkmcnt(0)
    s_barrier
    ds_read_b128 v[24:27], v6 offset:32768
    ds_read_b128 v[28:31], v6 offset:33792
    ds_read_b128 v[32:35], v6 offset:34816
    ds_read_b128 v[36:39], v6 offset:35840
    ds_read_b128 v[40:43], v6 offset:36864
    ds_read_b128 v[44:47], v6 offset:37888
    ds_read_b128 v[48:51], v6 offset:38912
    ds_read_b128 v[52:55], v6 offset:39936
    s_waitcnt vmcnt(0)
    ds_read_b64_tr_b16 v[56:57], v12 offset:0
    ds_read_b64_tr_b16 v[58:59], v12 offset:512
    ds_read_b64_tr_b16 v[60:61], v12 offset:4096
    ds_read_b64_tr_b16 v[62:63], v12 offset:4608
    ds_read_b64_tr_b16 v[64:65], v13 offset:0
    ds_read_b64_tr_b16 v[66:67], v13 offset:512
    ds_read_b64_tr_b16 v[68:69], v13 offset:4096
    ds_read_b64_tr_b16 v[70:71], v13 offset:4608
    s_waitcnt lgkmcnt(0)
    v_mfma_f32_16x16x32_bf16 v[72:75], v[56:59], v[24:27], 0
    v_mfma_f32_16x16x32_bf16 v[76:79], v[56:59], v[32:35], 0
    v_mfma_f32_16x16x32_bf16 v[80:83], v[56:59], v[40:43], 0
    v_mfma_f32_16x16x32_bf16 v[84:87], v[56:59], v[48:51], 0
    v_mfma_f32_16x16x32_bf16 v[88:91], v[64:67], v[24:27], 0
    v_mfma_f32_16x16x32_bf16 v[92:95], v[64:67], v[32:35], 0
    v_mfma_f32_16x16x32_bf16 v[96:99], v[64:67], v[40:43], 0
    v_mfma_f32_16x16x32_bf16 v[100:103], v[64:67], v[48:51], 0
    v_mfma_f32_16x16x32_bf16 v[72:75], v[60:63], v[28:31], v[72:75]
    v_mfma_f32_16x16x32_bf16 v[76:79], v[60:63], v[36:39], v[76:79]
    v_mfma_f32_16x16x32_bf16 v[80:83], v[60:63], v[44:47], v[80:83]
    v_mfma_f32_16x16x32_bf16 v[84:87], v[60:63], v[52:55], v[84:87]
    v_mfma_f32_16x16x32_bf16 v[88:91], v[68:71], v[28:31], v[88:91]
    v_mfma_f32_16x16x32_bf16 v[92:95], v[68:71], v[36:39], v[92:95]
    v_mfma_f32_16x16x32_bf16 v[96:99], v[68:71], v[44:47], v[96:99]
    v_mfma_f32_16x16x32_bf16 v[100:103], v[68:71], v[52:55], v[100:103]
    s_nop 7
    v_cvt_pk_bf16_f32 v104, v72, v73
    v_cvt_pk_bf16_f32 v105, v74, v75
    v_cvt_pk_bf16_f32 v106, v88, v89
    v_cvt_pk_bf16_f32 v107, v90, v91
    s_add_u32 s35, s34, 0
    buffer_store_dwordx4 v[104:107], v16, s[12:15], s35 offen sc1
    s_nop 1
    v_cvt_pk_bf16_f32 v108, v76, v77
    v_cvt_pk_bf16_f32 v109, v78, v79
    v_cvt_pk_bf16_f32 v110, v92, v93
    v_cvt_pk_bf16_f32 v111, v94, v95
    s_add_u32 s35, s34, 5472256
    buffer_store_dwordx4 v[108:111], v16, s[12:15], s35 offen sc1
    s_nop 1
    v_cvt_pk_bf16_f32 v104, v80, v81
    v_cvt_pk_bf16_f32 v105, v82, v83
    v_cvt_pk_bf16_f32 v106, v96, v97
    v_cvt_pk_bf16_f32 v107, v98, v99
    s_add_u32 s35, s34, 10944512
    buffer_store_dwordx4 v[104:107], v16, s[12:15], s35 offen sc1
    s_nop 1
    v_cvt_pk_bf16_f32 v108, v84, v85
    v_cvt_pk_bf16_f32 v109, v86, v87
    v_cvt_pk_bf16_f32 v110, v100, v101
    v_cvt_pk_bf16_f32 v111, v102, v103
    s_add_u32 s35, s34, 16416768
    buffer_store_dwordx4 v[108:111], v16, s[12:15], s35 offen sc1
    s_nop 1
    ds_read_b64_tr_b16 v[56:57], v14 offset:0
    ds_read_b64_tr_b16 v[58:59], v14 offset:512
    ds_read_b64_tr_b16 v[60:61], v14 offset:4096
    ds_read_b64_tr_b16 v[62:63], v14 offset:4608
    ds_read_b64_tr_b16 v[64:65], v15 offset:0
    ds_read_b64_tr_b16 v[66:67], v15 offset:512
    ds_read_b64_tr_b16 v[68:69], v15 offset:4096
    ds_read_b64_tr_b16 v[70:71], v15 offset:4608
    s_waitcnt lgkmcnt(0)
    v_mfma_f32_16x16x32_bf16 v[72:75], v[56:59], v[24:27], 0
    v_mfma_f32_16x16x32_bf16 v[76:79], v[56:59], v[32:35], 0
    v_mfma_f32_16x16x32_bf16 v[80:83], v[56:59], v[40:43], 0
    v_mfma_f32_16x16x32_bf16 v[84:87], v[56:59], v[48:51], 0
    v_mfma_f32_16x16x32_bf16 v[88:91], v[64:67], v[24:27], 0
    v_mfma_f32_16x16x32_bf16 v[92:95], v[64:67], v[32:35], 0
    v_mfma_f32_16x16x32_bf16 v[96:99], v[64:67], v[40:43], 0
    v_mfma_f32_16x16x32_bf16 v[100:103], v[64:67], v[48:51], 0
    v_mfma_f32_16x16x32_bf16 v[72:75], v[60:63], v[28:31], v[72:75]
    v_mfma_f32_16x16x32_bf16 v[76:79], v[60:63], v[36:39], v[76:79]
    v_mfma_f32_16x16x32_bf16 v[80:83], v[60:63], v[44:47], v[80:83]
    v_mfma_f32_16x16x32_bf16 v[84:87], v[60:63], v[52:55], v[84:87]
    v_mfma_f32_16x16x32_bf16 v[88:91], v[68:71], v[28:31], v[88:91]
    v_mfma_f32_16x16x32_bf16 v[92:95], v[68:71], v[36:39], v[92:95]
    v_mfma_f32_16x16x32_bf16 v[96:99], v[68:71], v[44:47], v[96:99]
    v_mfma_f32_16x16x32_bf16 v[100:103], v[68:71], v[52:55], v[100:103]
    s_nop 7
    v_cvt_pk_bf16_f32 v104, v72, v73
    v_cvt_pk_bf16_f32 v105, v74, v75
    v_cvt_pk_bf16_f32 v106, v88, v89
    v_cvt_pk_bf16_f32 v107, v90, v91
    s_add_u32 s35, s34, 128
    buffer_store_dwordx4 v[104:107], v16, s[12:15], s35 offen sc1
    s_nop 1
    v_cvt_pk_bf16_f32 v108, v76, v77
    v_cvt_pk_bf16_f32 v109, v78, v79
    v_cvt_pk_bf16_f32 v110, v92, v93
    v_cvt_pk_bf16_f32 v111, v94, v95
    s_add_u32 s35, s34, 5472384
    buffer_store_dwordx4 v[108:111], v16, s[12:15], s35 offen sc1
    s_nop 1
    v_cvt_pk_bf16_f32 v104, v80, v81
    v_cvt_pk_bf16_f32 v105, v82, v83
    v_cvt_pk_bf16_f32 v106, v96, v97
    v_cvt_pk_bf16_f32 v107, v98, v99
    s_add_u32 s35, s34, 10944640
    buffer_store_dwordx4 v[104:107], v16, s[12:15], s35 offen sc1
    s_nop 1
    v_cvt_pk_bf16_f32 v108, v84, v85
    v_cvt_pk_bf16_f32 v109, v86, v87
    v_cvt_pk_bf16_f32 v110, v100, v101
    v_cvt_pk_bf16_f32 v111, v102, v103
    s_add_u32 s35, s34, 16416896
    buffer_store_dwordx4 v[108:111], v16, s[12:15], s35 offen sc1
    s_nop 1
    s_endpgm
L_prep_kernel_g:
    s_sub_u32 s3, s2, 13
    s_load_dwordx2 s[4:5], s[0:1], 8
    s_load_dwordx2 s[6:7], s[0:1], 72
    s_lshr_b32 s24, s3, 4
    s_bfe_u32 s25, s3, 0x20002
    s_and_b32 s26, s3, 3
    s_lshr_b32 s27, s24, 3
    s_and_b32 s28, s24, 7
    v_and_b32 v1, 63, v0
    v_lshrrev_b32 v2, 3, v1
    v_lshrrev_b32 v3, 2, v2
    v_lshlrev_b32 v3, 4, v3
    v_and_b32 v4, 3, v2
    v_add_u32 v3, v3, v4
    s_lshl_b32 s29, s25, 2
    s_lshl_b32 s30, s28, 5
    s_add_u32 s29, s29, s30
    v_add_u32 v3, s29, v3
    v_lshlrev_b32 v3, 9, v3
    v_and_b32 v4, 7, v1
    s_lshr_b32 s30, s20, 1
    s_lshl_b32 s30, s30, 2
    v_xor_b32 v4, s30, v4
    v_lshl_add_u32 v3, v4, 4, v3
    s_lshl_b32 s30, s26, 7
    v_add_u32 v3, s30, v3
    v_xor_b32 v4, 32, v3
    s_waitcnt lgkmcnt(0)
    s_mov_b32 s8, s4
    s_mov_b32 s9, s5
    s_mov_b32 s10, 4063232
    s_mov_b32 s11, 0x00020000
    s_add_u32 s12, s6, 21954560
    s_addc_u32 s13, s7, 0
    s_mov_b32 s14, 16916480
    s_mov_b32 s15, 0x00020000
    s_lshl_b32 s30, s20, 3
    s_add_u32 s30, s30, s27
    s_lshl_b32 s30, s30, 17
    s_mul_i32 s31, s20, 4608
    s_add_u32 m0, s31, 0
    s_add_u32 s32, s30, 0
    buffer_load_dwordx4 v3, s[8:11], s32 offen nt lds
    s_add_u32 m0, s31, 1152
    s_add_u32 s32, s30, 262144
    buffer_load_dwordx4 v3, s[8:11], s32 offen nt lds
    s_add_u32 m0, s31, 2304
    s_add_u32 s32, s30, 524288
    buffer_load_dwordx4 v4, s[8:11], s32 offen nt lds
    s_add_u32 m0, s31, 3456
    s_add_u32 s32, s30, 786432
    buffer_load_dwordx4 v4, s[8:11], s32 offen nt lds
    v_and_b32 v8, 15, v1
    v_or_b32 v9, 1, v8
    s_lshl_b32 s33, s20, 4
    v_add_u32 v9, s33, v9
    v_cvt_f32_u32 v9, v9
    v_mul_f32 v9, 0x3c000000, v9
    v_bfe_u32 v10, v1, 4, 1
    v_lshlrev_b32 v10, 3, v10
    v_cvt_f32_u32 v10, v10
    v_and_b32 v8, 1, v8
    v_cvt_f32_u32 v8, v8
    v_mul_f32 v8, 0x3f400000, v8
    v_fma_f32 v11, v9, v10, v8
    v_fract_f32 v12, v11
    v_add_f32 v11, v11, v9
    v_fract_f32 v13, v11
    v_add_f32 v11, v11, v9
    v_fract_f32 v14, v11
    v_add_f32 v11, v11, v9
    v_fract_f32 v15, v11
    v_add_f32 v11, v11, v9
    v_fract_f32 v16, v11
    v_add_f32 v11, v11, v9
    v_fract_f32 v17, v11
    v_add_f32 v11, v11, v9
    v_fract_f32 v18, v11
    v_add_f32 v11, v11, v9
    v_fract_f32 v19, v11
    v_cos_f32 v12, v12
    v_cos_f32 v13, v13
    v_cos_f32 v14, v14
    v_cos_f32 v15, v15
    v_cos_f32 v16, v16
    v_cos_f32 v17, v17
    v_cos_f32 v18, v18
    v_cos_f32 v19, v19
    s_nop 0
    v_mul_f32 v12, 0x3d000000, v12
    v_mul_f32 v13, 0x3d000000, v13
    v_mul_f32 v14, 0x3d000000, v14
    v_mul_f32 v15, 0x3d000000, v15
    v_mul_f32 v16, 0x3d000000, v16
    v_mul_f32 v17, 0x3d000000, v17
    v_mul_f32 v18, 0x3d000000, v18
    v_mul_f32 v19, 0x3d000000, v19
    v_cvt_pk_bf16_f32 v20, v12, v13
    v_cvt_pk_bf16_f32 v21, v14, v15
    v_cvt_pk_bf16_f32 v22, v16, v17
    v_cvt_pk_bf16_f32 v23, v18, v19
    v_lshlrev_b32 v28, 16, v20
    v_and_b32 v29, 0xffff0000, v20
    v_sub_f32 v28, v12, v28
    v_sub_f32 v29, v13, v29
    v_cvt_pk_bf16_f32 v24, v28, v29
    v_lshlrev_b32 v28, 16, v21
    v_and_b32 v29, 0xffff0000, v21
    v_sub_f32 v28, v14, v28
    v_sub_f32 v29, v15, v29
    v_cvt_pk_bf16_f32 v25, v28, v29
    v_lshlrev_b32 v28, 16, v22
    v_and_b32 v29, 0xffff0000, v22
    v_sub_f32 v28, v16, v28
    v_sub_f32 v29, v17, v29
    v_cvt_pk_bf16_f32 v26, v28, v29
    v_lshlrev_b32 v28, 16, v23
    v_and_b32 v29, 0xffff0000, v23
    v_sub_f32 v28, v18, v28
    v_sub_f32 v29, v19, v29
    v_cvt_pk_bf16_f32 v27, v28, v29
    v_cmp_gt_u32 vcc, 32, v1
    s_nop 1
    v_cndmask_b32 v20, v24, v20, vcc
    v_cndmask_b32 v21, v25, v21, vcc
    v_cndmask_b32 v22, v26, v22, vcc
    v_cndmask_b32 v23, v27, v23, vcc
    v_lshlrev_b32 v28, 4, v1
    s_lshl_b32 s33, s20, 10
    v_add_u32 v29, s33, v28
    ds_write_b128 v29, v[20:23] offset:18432
    v_bfe_u32 v30, v1, 2, 2
    v_bfe_u32 v31, v1, 4, 1
    v_lshl_add_u32 v32, v31, 3, v30
    v_mul_u32_u24 v32, 1152, v32
    v_lshrrev_b32 v30, 1, v30
    v_lshl_add_u32 v30, v31, 1, v30
    v_lshlrev_b32 v30, 1, v30
    v_bfe_u32 v31, v1, 1, 1
    s_lshl_b32 s33, s20, 1
    v_add_u32 v31, s33, v31
    v_xor_b32 v30, v30, v31
    v_lshl_add_u32 v32, v30, 4, v32
    v_and_b32 v30, 1, v1
    v_lshl_add_u32 v32, v30, 3, v32
    v_lshrrev_b32 v30, 4, v1
    s_mov_b32 s33, 1057280
    v_mul_lo_u32 v30, v30, s33
    v_and_b32 v31, 15, v1
    v_lshl_add_u32 v33, v31, 4, v30
    s_lshl_b32 s34, s24, 15
    s_lshl_b32 s35, s26, 2
    s_add_u32 s35, s35, s20
    s_lshl_b32 s35, s35, 11
    s_add_u32 s34, s34, s35
    s_lshl_b32 s35, s25, 8
    s_add_u32 s34, s34, s35
    s_waitcnt vmcnt(0) lgkmcnt(0)
    s_barrier
    ds_read_b128 v[36:39], v28 offset:18432
    ds_read_b128 v[40:43], v28 offset:19456
    ds_read_b128 v[44:47], v28 offset:20480
    ds_read_b128 v[48:51], v28 offset:21504
    ds_read_b64_tr_b16 v[52:53], v32 offset:0
    ds_read_b64_tr_b16 v[54:55], v32 offset:4608
    ds_read_b64_tr_b16 v[56:57], v32 offset:128
    ds_read_b64_tr_b16 v[58:59], v32 offset:4736
    ds_read_b64_tr_b16 v[60:61], v32 offset:256
    ds_read_b64_tr_b16 v[62:63], v32 offset:4864
    ds_read_b64_tr_b16 v[64:65], v32 offset:384
    ds_read_b64_tr_b16 v[66:67], v32 offset:4992
    ds_read_b64_tr_b16 v[68:69], v32 offset:512
    ds_read_b64_tr_b16 v[70:71], v32 offset:5120
    s_waitcnt lgkmcnt(8)
    ds_read_b64_tr_b16 v[72:73], v32 offset:640
    ds_read_b64_tr_b16 v[74:75], v32 offset:5248
    ds_read_b64_tr_b16 v[76:77], v32 offset:768
    ds_read_b64_tr_b16 v[78:79], v32 offset:5376
    ds_read_b64_tr_b16 v[80:81], v32 offset:896
    ds_read_b64_tr_b16 v[82:83], v32 offset:5504
    s_waitcnt lgkmcnt(0)
    v_mfma_f32_16x16x32_bf16 v[84:87], v[36:39], v[52:55], 0
    v_mfma_f32_16x16x32_bf16 v[88:91], v[36:39], v[56:59], 0
    v_mfma_f32_16x16x32_bf16 v[92:95], v[36:39], v[60:63], 0
    v_mfma_f32_16x16x32_bf16 v[96:99], v[36:39], v[64:67], 0
    v_mfma_f32_16x16x32_bf16 v[100:103], v[36:39], v[68:71], 0
    v_mfma_f32_16x16x32_bf16 v[104:107], v[36:39], v[72:75], 0
    v_mfma_f32_16x16x32_bf16 v[108:111], v[36:39], v[76:79], 0
    v_mfma_f32_16x16x32_bf16 v[112:115], v[36:39], v[80:83], 0
    s_nop 7
    v_cvt_pk_bf16_f32 v116, v84, v88
    v_cvt_pk_bf16_f32 v117, v92, v96
    v_cvt_pk_bf16_f32 v118, v100, v104
    v_cvt_pk_bf16_f32 v119, v108, v112
    s_add_u32 s35, s34, 0
    buffer_store_dwordx4 v[116:119], v33, s[12:15], s35 offen sc1
    s_nop 1
    v_cvt_pk_bf16_f32 v120, v85, v89
    v_cvt_pk_bf16_f32 v121, v93, v97
    v_cvt_pk_bf16_f32 v122, v101, v105
    v_cvt_pk_bf16_f32 v123, v109, v113
    s_add_u32 s35, s34, 1024
    buffer_store_dwordx4 v[120:123], v33, s[12:15], s35 offen sc1
    s_nop 1
    v_cvt_pk_bf16_f32 v116, v86, v90
    v_cvt_pk_bf16_f32 v117, v94, v98
    v_cvt_pk_bf16_f32 v118, v102, v106
    v_cvt_pk_bf16_f32 v119, v110, v114
    s_add_u32 s35, s34, 528640
    buffer_store_dwordx4 v[116:119], v33, s[12:15], s35 offen sc1
    s_nop 1
    v_cvt_pk_bf16_f32 v120, v87, v91
    v_cvt_pk_bf16_f32 v121, v95, v99
    v_cvt_pk_bf16_f32 v122, v103, v107
    v_cvt_pk_bf16_f32 v123, v111, v115
    s_add_u32 s35, s34, 529664
    buffer_store_dwordx4 v[120:123], v33, s[12:15], s35 offen sc1
    s_nop 1
    v_mfma_f32_16x16x32_bf16 v[84:87], v[40:43], v[52:55], 0
    v_mfma_f32_16x16x32_bf16 v[88:91], v[40:43], v[56:59], 0
    v_mfma_f32_16x16x32_bf16 v[92:95], v[40:43], v[60:63], 0
    v_mfma_f32_16x16x32_bf16 v[96:99], v[40:43], v[64:67], 0
    v_mfma_f32_16x16x32_bf16 v[100:103], v[40:43], v[68:71], 0
    v_mfma_f32_16x16x32_bf16 v[104:107], v[40:43], v[72:75], 0
    v_mfma_f32_16x16x32_bf16 v[108:111], v[40:43], v[76:79], 0
    v_mfma_f32_16x16x32_bf16 v[112:115], v[40:43], v[80:83], 0
    s_nop 7
    v_cvt_pk_bf16_f32 v116, v84, v88
    v_cvt_pk_bf16_f32 v117, v92, v96
    v_cvt_pk_bf16_f32 v118, v100, v104
    v_cvt_pk_bf16_f32 v119, v108, v112
    s_add_u32 s35, s34, 4229120
    buffer_store_dwordx4 v[116:119], v33, s[12:15], s35 offen sc1
    s_nop 1
    v_cvt_pk_bf16_f32 v120, v85, v89
    v_cvt_pk_bf16_f32 v121, v93, v97
    v_cvt_pk_bf16_f32 v122, v101, v105
    v_cvt_pk_bf16_f32 v123, v109, v113
    s_add_u32 s35, s34, 4230144
    buffer_store_dwordx4 v[120:123], v33, s[12:15], s35 offen sc1
    s_nop 1
    v_cvt_pk_bf16_f32 v116, v86, v90
    v_cvt_pk_bf16_f32 v117, v94, v98
    v_cvt_pk_bf16_f32 v118, v102, v106
    v_cvt_pk_bf16_f32 v119, v110, v114
    s_add_u32 s35, s34, 4757760
    buffer_store_dwordx4 v[116:119], v33, s[12:15], s35 offen sc1
    s_nop 1
    v_cvt_pk_bf16_f32 v120, v87, v91
    v_cvt_pk_bf16_f32 v121, v95, v99
    v_cvt_pk_bf16_f32 v122, v103, v107
    v_cvt_pk_bf16_f32 v123, v111, v115
    s_add_u32 s35, s34, 4758784
    buffer_store_dwordx4 v[120:123], v33, s[12:15], s35 offen sc1
    s_nop 1
    v_mfma_f32_16x16x32_bf16 v[84:87], v[44:47], v[52:55], 0
    v_mfma_f32_16x16x32_bf16 v[88:91], v[44:47], v[56:59], 0
    v_mfma_f32_16x16x32_bf16 v[92:95], v[44:47], v[60:63], 0
    v_mfma_f32_16x16x32_bf16 v[96:99], v[44:47], v[64:67], 0
    v_mfma_f32_16x16x32_bf16 v[100:103], v[44:47], v[68:71], 0
    v_mfma_f32_16x16x32_bf16 v[104:107], v[44:47], v[72:75], 0
    v_mfma_f32_16x16x32_bf16 v[108:111], v[44:47], v[76:79], 0
    v_mfma_f32_16x16x32_bf16 v[112:115], v[44:47], v[80:83], 0
    s_nop 7
    v_cvt_pk_bf16_f32 v116, v84, v88
    v_cvt_pk_bf16_f32 v117, v92, v96
    v_cvt_pk_bf16_f32 v118, v100, v104
    v_cvt_pk_bf16_f32 v119, v108, v112
    s_add_u32 s35, s34, 8458240
    buffer_store_dwordx4 v[116:119], v33, s[12:15], s35 offen sc1
    s_nop 1
    v_cvt_pk_bf16_f32 v120, v85, v89
    v_cvt_pk_bf16_f32 v121, v93, v97
    v_cvt_pk_bf16_f32 v122, v101, v105
    v_cvt_pk_bf16_f32 v123, v109, v113
    s_add_u32 s35, s34, 8459264
    buffer_store_dwordx4 v[120:123], v33, s[12:15], s35 offen sc1
    s_nop 1
    v_cvt_pk_bf16_f32 v116, v86, v90
    v_cvt_pk_bf16_f32 v117, v94, v98
    v_cvt_pk_bf16_f32 v118, v102, v106
    v_cvt_pk_bf16_f32 v119, v110, v114
    s_add_u32 s35, s34, 8986880
    buffer_store_dwordx4 v[116:119], v33, s[12:15], s35 offen sc1
    s_nop 1
    v_cvt_pk_bf16_f32 v120, v87, v91
    v_cvt_pk_bf16_f32 v121, v95, v99
    v_cvt_pk_bf16_f32 v122, v103, v107
    v_cvt_pk_bf16_f32 v123, v111, v115
    s_add_u32 s35, s34, 8987904
    buffer_store_dwordx4 v[120:123], v33, s[12:15], s35 offen sc1
    s_nop 1
    v_mfma_f32_16x16x32_bf16 v[84:87], v[48:51], v[52:55], 0
    v_mfma_f32_16x16x32_bf16 v[88:91], v[48:51], v[56:59], 0
    v_mfma_f32_16x16x32_bf16 v[92:95], v[48:51], v[60:63], 0
    v_mfma_f32_16x16x32_bf16 v[96:99], v[48:51], v[64:67], 0
    v_mfma_f32_16x16x32_bf16 v[100:103], v[48:51], v[68:71], 0
    v_mfma_f32_16x16x32_bf16 v[104:107], v[48:51], v[72:75], 0
    v_mfma_f32_16x16x32_bf16 v[108:111], v[48:51], v[76:79], 0
    v_mfma_f32_16x16x32_bf16 v[112:115], v[48:51], v[80:83], 0
    s_nop 7
    v_cvt_pk_bf16_f32 v116, v84, v88
    v_cvt_pk_bf16_f32 v117, v92, v96
    v_cvt_pk_bf16_f32 v118, v100, v104
    v_cvt_pk_bf16_f32 v119, v108, v112
    s_add_u32 s35, s34, 12687360
    buffer_store_dwordx4 v[116:119], v33, s[12:15], s35 offen sc1
    s_nop 1
    v_cvt_pk_bf16_f32 v120, v85, v89
    v_cvt_pk_bf16_f32 v121, v93, v97
    v_cvt_pk_bf16_f32 v122, v101, v105
    v_cvt_pk_bf16_f32 v123, v109, v113
    s_add_u32 s35, s34, 12688384
    buffer_store_dwordx4 v[120:123], v33, s[12:15], s35 offen sc1
    s_nop 1
    v_cvt_pk_bf16_f32 v116, v86, v90
    v_cvt_pk_bf16_f32 v117, v94, v98
    v_cvt_pk_bf16_f32 v118, v102, v106
    v_cvt_pk_bf16_f32 v119, v110, v114
    s_add_u32 s35, s34, 13216000
    buffer_store_dwordx4 v[116:119], v33, s[12:15], s35 offen sc1
    s_nop 1
    v_cvt_pk_bf16_f32 v120, v87, v91
    v_cvt_pk_bf16_f32 v121, v95, v99
    v_cvt_pk_bf16_f32 v122, v103, v107
    v_cvt_pk_bf16_f32 v123, v111, v115
    s_add_u32 s35, s34, 13217024
    buffer_store_dwordx4 v[120:123], v33, s[12:15], s35 offen sc1
    s_nop 1
    s_endpgm
L_prep_kernel_slab:
    s_load_dwordx2 s[6:7], s[0:1], 72
    s_cmp_eq_u32 s2, 12
    s_cbranch_scc1 L_prep_kernel_tab
    s_lshr_b32 s24, s2, 2
    s_and_b32 s26, s2, 3
    s_mov_b32 s25, 40
    s_cmp_eq_u32 s24, 1
    s_cselect_b32 s25, 32, s25
    s_cmp_eq_u32 s24, 2
    s_cselect_b32 s25, 48, s25
    s_load_dwordx2 s[4:5], s[0:1], s25
    s_load_dwordx2 s[28:29], s[0:1], 24
    v_and_b32 v1, 63, v0
    v_lshrrev_b32 v2, 3, v1
    s_lshl_b32 s27, s20, 6
    v_add_u32 v2, s27, v2
    v_lshlrev_b32 v2, 9, v2
    v_and_b32 v3, 7, v1
    v_lshl_add_u32 v2, v3, 4, v2
    s_lshl_b32 s27, s26, 7
    v_add_u32 v2, s27, v2
    s_waitcnt lgkmcnt(0)
    s_mov_b32 s8, s4
    s_mov_b32 s9, s5
    s_mov_b32 s10, 131072
    s_mov_b32 s11, 0x00020000
    s_add_u32 s12, s6, 83312640
    s_addc_u32 s13, s7, 0
    s_mov_b32 s14, 294912
    s_mov_b32 s15, 0x00020000
    s_lshl_b32 s31, s20, 13
    s_add_u32 m0, s31, 0
    s_mov_b32 s32, 0
    buffer_load_dwordx4 v2, s[8:11], s32 offen nt lds
    s_add_u32 m0, s31, 1024
    s_mov_b32 s32, 4096
    buffer_load_dwordx4 v2, s[8:11], s32 offen nt lds
    s_add_u32 m0, s31, 2048
    s_mov_b32 s32, 8192
    buffer_load_dwordx4 v2, s[8:11], s32 offen nt lds
    s_add_u32 m0, s31, 3072
    s_mov_b32 s32, 12288
    buffer_load_dwordx4 v2, s[8:11], s32 offen nt lds
    s_add_u32 m0, s31, 4096
    s_mov_b32 s32, 16384
    buffer_load_dwordx4 v2, s[8:11], s32 offen nt lds
    s_add_u32 m0, s31, 5120
    s_mov_b32 s32, 20480
    buffer_load_dwordx4 v2, s[8:11], s32 offen nt lds
    s_add_u32 m0, s31, 6144
    s_mov_b32 s32, 24576
    buffer_load_dwordx4 v2, s[8:11], s32 offen nt lds
    s_add_u32 m0, s31, 7168
    s_mov_b32 s32, 28672
    buffer_load_dwordx4 v2, s[8:11], s32 offen nt lds
    s_cmp_eq_u32 s24, 0
    s_cbranch_scc1 L_prep_kernel_ge
    v_bfe_u32 v4, v1, 2, 2
    v_lshrrev_b32 v5, 5, v1
    v_bfe_u32 v6, v1, 4, 1
    v_and_b32 v7, 3, v1
    s_cmp_eq_u32 s24, 1
    s_cbranch_scc0 L_prep_kernel_wo
    v_lshl_add_u32 v8, v5, 4, v4
    v_lshlrev_b32 v8, 7, v8
    v_lshl_add_u32 v8, v6, 5, v8
    v_lshl_add_u32 v8, v7, 3, v8
    s_lshl_b32 s33, s20, 13
    v_add_u32 v8, s33, v8
    s_mov_b32 s34, 32768
    s_lshl_b32 s35, s26, 15
    s_add_u32 s34, s34, s35
    s_lshl_b32 s35, s20, 12
    s_add_u32 s34, s34, s35
    v_lshlrev_b32 v9, 4, v1
    s_waitcnt vmcnt(0)
    s_barrier
    ds_read_b64_tr_b16 v[16:17], v8 offset:0
    ds_read_b64_tr_b16 v[18:19], v8 offset:1024
    ds_read_b64_tr_b16 v[20:21], v8 offset:512
    ds_read_b64_tr_b16 v[22:23], v8 offset:1536
    ds_read_b64_tr_b16 v[24:25], v8 offset:4096
    ds_read_b64_tr_b16 v[26:27], v8 offset:5120
    ds_read_b64_tr_b16 v[28:29], v8 offset:4608
    ds_read_b64_tr_b16 v[30:31], v8 offset:5632
    s_waitcnt lgkmcnt(0)
    s_add_u32 s35, s34, 0
    buffer_store_dwordx4 v[16:19], v9, s[12:15], s35 offen sc1
    s_add_u32 s35, s34, 1024
    buffer_store_dwordx4 v[20:23], v9, s[12:15], s35 offen sc1
    s_add_u32 s35, s34, 2048
    buffer_store_dwordx4 v[24:27], v9, s[12:15], s35 offen sc1
    s_add_u32 s35, s34, 3072
    buffer_store_dwordx4 v[28:31], v9, s[12:15], s35 offen sc1
    ds_read_b64_tr_b16 v[32:33], v8 offset:64
    ds_read_b64_tr_b16 v[34:35], v8 offset:1088
    ds_read_b64_tr_b16 v[36:37], v8 offset:576
    ds_read_b64_tr_b16 v[38:39], v8 offset:1600
    ds_read_b64_tr_b16 v[40:41], v8 offset:4160
    ds_read_b64_tr_b16 v[42:43], v8 offset:5184
    ds_read_b64_tr_b16 v[44:45], v8 offset:4672
    ds_read_b64_tr_b16 v[46:47], v8 offset:5696
    s_waitcnt lgkmcnt(0)
    s_add_u32 s35, s34, 16384
    buffer_store_dwordx4 v[32:35], v9, s[12:15], s35 offen sc1
    s_add_u32 s35, s34, 17408
    buffer_store_dwordx4 v[36:39], v9, s[12:15], s35 offen sc1
    s_add_u32 s35, s34, 18432
    buffer_store_dwordx4 v[40:43], v9, s[12:15], s35 offen sc1
    s_add_u32 s35, s34, 19456
    buffer_store_dwordx4 v[44:47], v9, s[12:15], s35 offen sc1
    s_endpgm
L_prep_kernel_wo:
    v_lshl_add_u32 v8, v5, 2, v4
    v_lshlrev_b32 v8, 7, v8
    v_lshl_add_u32 v8, v6, 5, v8
    v_and_b32 v10, 1, v7
    v_lshl_add_u32 v8, v10, 4, v8
    v_lshrrev_b32 v10, 1, v7
    v_lshl_add_u32 v8, v10, 3, v8
    s_lshl_b32 s33, s20, 13
    v_add_u32 v8, s33, v8
    s_mov_b32 s34, 163840
    s_lshl_b32 s35, s26, 15
    s_add_u32 s34, s34, s35
    s_lshl_b32 s35, s20, 12
    s_add_u32 s34, s34, s35
    v_lshlrev_b32 v9, 4, v1
    s_waitcnt vmcnt(0)
    s_barrier
    ds_read_b64_tr_b16 v[16:17], v8 offset:0
    ds_read_b64_tr_b16 v[18:19], v8 offset:1024
    ds_read_b64_tr_b16 v[20:21], v8 offset:2048
    ds_read_b64_tr_b16 v[22:23], v8 offset:3072
    ds_read_b64_tr_b16 v[24:25], v8 offset:4096
    ds_read_b64_tr_b16 v[26:27], v8 offset:5120
    ds_read_b64_tr_b16 v[28:29], v8 offset:6144
    ds_read_b64_tr_b16 v[30:31], v8 offset:7168
    s_waitcnt lgkmcnt(0)
    v_mov_b32 v48, 0x3f803f80
    v_mov_b32 v49, 0x3f803f80
    v_mov_b32 v50, 0x3f803f80
    v_mov_b32 v51, 0x3f803f80
    s_nop 1
    v_mfma_f32_32x32x16_bf16 v[64:79], v[16:19], v[48:51], 0
    v_mfma_f32_32x32x16_bf16 v[64:79], v[20:23], v[48:51], v[64:79]
    v_mfma_f32_32x32x16_bf16 v[64:79], v[24:27], v[48:51], v[64:79]
    v_mfma_f32_32x32x16_bf16 v[64:79], v[28:31], v[48:51], v[64:79]
    v_lshlrev_b32 v52, 16, v16
    v_and_b32 v53, 0xffff0000, v16
    v_mul_f32 v52, -2.0, v52
    v_mul_f32 v53, -2.0, v53
    v_cvt_pk_bf16_f32 v16, v52, v53
    v_lshlrev_b32 v52, 16, v17
    v_and_b32 v53, 0xffff0000, v17
    v_mul_f32 v52, -2.0, v52
    v_mul_f32 v53, -2.0, v53
    v_cvt_pk_bf16_f32 v17, v52, v53
    v_lshlrev_b32 v52, 16, v18
    v_and_b32 v53, 0xffff0000, v18
    v_mul_f32 v52, -2.0, v52
    v_mul_f32 v53, -2.0, v53
    v_cvt_pk_bf16_f32 v18, v52, v53
    v_lshlrev_b32 v52, 16, v19
    v_and_b32 v53, 0xffff0000, v19
    v_mul_f32 v52, -2.0, v52
    v_mul_f32 v53, -2.0, v53
    v_cvt_pk_bf16_f32 v19, v52, v53
    v_lshlrev_b32 v52, 16, v20
    v_and_b32 v53, 0xffff0000, v20
    v_mul_f32 v52, -2.0, v52
    v_mul_f32 v53, -2.0, v53
    v_cvt_pk_bf16_f32 v20, v52, v53
    v_lshlrev_b32 v52, 16, v21
    v_and_b32 v53, 0xffff0000, v21
    v_mul_f32 v52, -2.0, v52
    v_mul_f32 v53, -2.0, v53
    v_cvt_pk_bf16_f32 v21, v52, v53
    v_lshlrev_b32 v52, 16, v22
    v_and_b32 v53, 0xffff0000, v22
    v_mul_f32 v52, -2.0, v52
    v_mul_f32 v53, -2.0, v53
    v_cvt_pk_bf16_f32 v22, v52, v53
    v_lshlrev_b32 v52, 16, v23
    v_and_b32 v53, 0xffff0000, v23
    v_mul_f32 v52, -2.0, v52
    v_mul_f32 v53, -2.0, v53
    v_cvt_pk_bf16_f32 v23, v52, v53
    v_lshlrev_b32 v52, 16, v24
    v_and_b32 v53, 0xffff0000, v24
    v_mul_f32 v52, -2.0, v52
    v_mul_f32 v53, -2.0, v53
    v_cvt_pk_bf16_f32 v24, v52, v53
    v_lshlrev_b32 v52, 16, v25
    v_and_b32 v53, 0xffff0000, v25
    v_mul_f32 v52, -2.0, v52
    v_mul_f32 v53, -2.0, v53
    v_cvt_pk_bf16_f32 v25, v52, v53
    v_lshlrev_b32 v52, 16, v26
    v_and_b32 v53, 0xffff0000, v26
    v_mul_f32 v52, -2.0, v52
    v_mul_f32 v53, -2.0, v53
    v_cvt_pk_bf16_f32 v26, v52, v53
    v_lshlrev_b32 v52, 16, v27
    v_and_b32 v53, 0xffff0000, v27
    v_mul_f32 v52, -2.0, v52
    v_mul_f32 v53, -2.0, v53
    v_cvt_pk_bf16_f32 v27, v52, v53
    v_lshlrev_b32 v52, 16, v28
    v_and_b32 v53, 0xffff0000, v28
    v_mul_f32 v52, -2.0, v52
    v_mul_f32 v53, -2.0, v53
    v_cvt_pk_bf16_f32 v28, v52, v53
    v_lshlrev_b32 v52, 16, v29
    v_and_b32 v53, 0xffff0000, v29
    v_mul_f32 v52, -2.0, v52
    v_mul_f32 v53, -2.0, v53
    v_cvt_pk_bf16_f32 v29, v52, v53
    v_lshlrev_b32 v52, 16, v30
    v_and_b32 v53, 0xffff0000, v30
    v_mul_f32 v52, -2.0, v52
    v_mul_f32 v53, -2.0, v53
    v_cvt_pk_bf16_f32 v30, v52, v53
    v_lshlrev_b32 v52, 16, v31
    v_and_b32 v53, 0xffff0000, v31
    v_mul_f32 v52, -2.0, v52
    v_mul_f32 v53, -2.0, v53
    v_cvt_pk_bf16_f32 v31, v52, v53
    s_add_u32 s35, s34, 0
    buffer_store_dwordx4 v[16:19], v9, s[12:15], s35 offen sc1
    s_add_u32 s35, s34, 1024
    buffer_store_dwordx4 v[20:23], v9, s[12:15], s35 offen sc1
    s_add_u32 s35, s34, 2048
    buffer_store_dwordx4 v[24:27], v9, s[12:15], s35 offen sc1
    s_add_u32 s35, s34, 3072
    buffer_store_dwordx4 v[28:31], v9, s[12:15], s35 offen sc1
    ds_read_b64_tr_b16 v[32:33], v8 offset:64
    ds_read_b64_tr_b16 v[34:35], v8 offset:1088
    ds_read_b64_tr_b16 v[36:37], v8 offset:2112
    ds_read_b64_tr_b16 v[38:39], v8 offset:3136
    ds_read_b64_tr_b16 v[40:41], v8 offset:4160
    ds_read_b64_tr_b16 v[42:43], v8 offset:5184
    ds_read_b64_tr_b16 v[44:45], v8 offset:6208
    ds_read_b64_tr_b16 v[46:47], v8 offset:7232
    s_waitcnt lgkmcnt(0)
    v_mfma_f32_32x32x16_bf16 v[80:95], v[32:35], v[48:51], 0
    v_mfma_f32_32x32x16_bf16 v[80:95], v[36:39], v[48:51], v[80:95]
    v_mfma_f32_32x32x16_bf16 v[80:95], v[40:43], v[48:51], v[80:95]
    v_mfma_f32_32x32x16_bf16 v[80:95], v[44:47], v[48:51], v[80:95]
    v_lshlrev_b32 v52, 16, v32
    v_and_b32 v53, 0xffff0000, v32
    v_mul_f32 v52, -2.0, v52
    v_mul_f32 v53, -2.0, v53
    v_cvt_pk_bf16_f32 v32, v52, v53
    v_lshlrev_b32 v52, 16, v33
    v_and_b32 v53, 0xffff0000, v33
    v_mul_f32 v52, -2.0, v52
    v_mul_f32 v53, -2.0, v53
    v_cvt_pk_bf16_f32 v33, v52, v53
    v_lshlrev_b32 v52, 16, v34
    v_and_b32 v53, 0xffff0000, v34
    v_mul_f32 v52, -2.0, v52
    v_mul_f32 v53, -2.0, v53
    v_cvt_pk_bf16_f32 v34, v52, v53
    v_lshlrev_b32 v52, 16, v35
    v_and_b32 v53, 0xffff0000, v35
    v_mul_f32 v52, -2.0, v52
    v_mul_f32 v53, -2.0, v53
    v_cvt_pk_bf16_f32 v35, v52, v53
    v_lshlrev_b32 v52, 16, v36
    v_and_b32 v53, 0xffff0000, v36
    v_mul_f32 v52, -2.0, v52
    v_mul_f32 v53, -2.0, v53
    v_cvt_pk_bf16_f32 v36, v52, v53
    v_lshlrev_b32 v52, 16, v37
    v_and_b32 v53, 0xffff0000, v37
    v_mul_f32 v52, -2.0, v52
    v_mul_f32 v53, -2.0, v53
    v_cvt_pk_bf16_f32 v37, v52, v53
    v_lshlrev_b32 v52, 16, v38
    v_and_b32 v53, 0xffff0000, v38
    v_mul_f32 v52, -2.0, v52
    v_mul_f32 v53, -2.0, v53
    v_cvt_pk_bf16_f32 v38, v52, v53
    v_lshlrev_b32 v52, 16, v39
    v_and_b32 v53, 0xffff0000, v39
    v_mul_f32 v52, -2.0, v52
    v_mul_f32 v53, -2.0, v53
    v_cvt_pk_bf16_f32 v39, v52, v53
    v_lshlrev_b32 v52, 16, v40
    v_and_b32 v53, 0xffff0000, v40
    v_mul_f32 v52, -2.0, v52
    v_mul_f32 v53, -2.0, v53
    v_cvt_pk_bf16_f32 v40, v52, v53
    v_lshlrev_b32 v52, 16, v41
    v_and_b32 v53, 0xffff0000, v41
    v_mul_f32 v52, -2.0, v52
    v_mul_f32 v53, -2.0, v53
    v_cvt_pk_bf16_f32 v41, v52, v53
    v_lshlrev_b32 v52, 16, v42
    v_and_b32 v53, 0xffff0000, v42
    v_mul_f32 v52, -2.0, v52
    v_mul_f32 v53, -2.0, v53
    v_cvt_pk_bf16_f32 v42, v52, v53
    v_lshlrev_b32 v52, 16, v43
    v_and_b32 v53, 0xffff0000, v43
    v_mul_f32 v52, -2.0, v52
    v_mul_f32 v53, -2.0, v53
    v_cvt_pk_bf16_f32 v43, v52, v53
    v_lshlrev_b32 v52, 16, v44
    v_and_b32 v53, 0xffff0000, v44
    v_mul_f32 v52, -2.0, v52
    v_mul_f32 v53, -2.0, v53
    v_cvt_pk_bf16_f32 v44, v52, v53
    v_lshlrev_b32 v52, 16, v45
    v_and_b32 v53, 0xffff0000, v45
    v_mul_f32 v52, -2.0, v52
    v_mul_f32 v53, -2.0, v53
    v_cvt_pk_bf16_f32 v45, v52, v53
    v_lshlrev_b32 v52, 16, v46
    v_and_b32 v53, 0xffff0000, v46
    v_mul_f32 v52, -2.0, v52
    v_mul_f32 v53, -2.0, v53
    v_cvt_pk_bf16_f32 v46, v52, v53
    v_lshlrev_b32 v52, 16, v47
    v_and_b32 v53, 0xffff0000, v47
    v_mul_f32 v52, -2.0, v52
    v_mul_f32 v53, -2.0, v53
    v_cvt_pk_bf16_f32 v47, v52, v53
    s_add_u32 s35, s34, 16384
    buffer_store_dwordx4 v[32:35], v9, s[12:15], s35 offen sc1
    s_add_u32 s35, s34, 17408
    buffer_store_dwordx4 v[36:39], v9, s[12:15], s35 offen sc1
    s_add_u32 s35, s34, 18432
    buffer_store_dwordx4 v[40:43], v9, s[12:15], s35 offen sc1
    s_add_u32 s35, s34, 19456
    buffer_store_dwordx4 v[44:47], v9, s[12:15], s35 offen sc1
    s_nop 7
    s_barrier
    v_lshlrev_b32 v10, 6, v1
    s_lshl_b32 s35, s20, 13
    v_add_u32 v11, s35, v10
    ds_write_b128 v11, v[64:67] offset:0
    ds_write_b128 v11, v[68:71] offset:16
    ds_write_b128 v11, v[72:75] offset:32
    ds_write_b128 v11, v[76:79] offset:48
    ds_write_b128 v11, v[80:83] offset:4096
    ds_write_b128 v11, v[84:87] offset:4112
    ds_write_b128 v11, v[88:91] offset:4128
    ds_write_b128 v11, v[92:95] offset:4144
    s_waitcnt lgkmcnt(0)
    s_barrier
    s_cmp_ge_u32 s20, 2
    s_cbranch_scc1 L_prep_kernel_done
    s_lshl_b32 s35, s20, 12
    v_add_u32 v11, s35, v10
    ds_read_b128 v[16:19], v11 offset:0
    ds_read_b128 v[20:23], v11 offset:16
    ds_read_b128 v[24:27], v11 offset:32
    ds_read_b128 v[28:31], v11 offset:48
    ds_read_b128 v[32:35], v11 offset:8192
    ds_read_b128 v[36:39], v11 offset:8208
    ds_read_b128 v[40:43], v11 offset:8224
    ds_read_b128 v[44:47], v11 offset:8240
    s_waitcnt lgkmcnt(0)
    ds_read_b128 v[48:51], v11 offset:16384
    ds_read_b128 v[52:55], v11 offset:16400
    ds_read_b128 v[56:59], v11 offset:16416
    ds_read_b128 v[60:63], v11 offset:16432
    ds_read_b128 v[64:67], v11 offset:24576
    ds_read_b128 v[68:71], v11 offset:24592
    ds_read_b128 v[72:75], v11 offset:24608
    ds_read_b128 v[76:79], v11 offset:24624
    s_waitcnt lgkmcnt(0)
    v_add_f32 v16, v16, v32
    v_add_f32 v48, v48, v64
    v_add_f32 v17, v17, v33
    v_add_f32 v49, v49, v65
    v_add_f32 v18, v18, v34
    v_add_f32 v50, v50, v66
    v_add_f32 v19, v19, v35
    v_add_f32 v51, v51, v67
    v_add_f32 v20, v20, v36
    v_add_f32 v52, v52, v68
    v_add_f32 v21, v21, v37
    v_add_f32 v53, v53, v69
    v_add_f32 v22, v22, v38
    v_add_f32 v54, v54, v70
    v_add_f32 v23, v23, v39
    v_add_f32 v55, v55, v71
    v_add_f32 v24, v24, v40
    v_add_f32 v56, v56, v72
    v_add_f32 v25, v25, v41
    v_add_f32 v57, v57, v73
    v_add_f32 v26, v26, v42
    v_add_f32 v58, v58, v74
    v_add_f32 v27, v27, v43
    v_add_f32 v59, v59, v75
    v_add_f32 v28, v28, v44
    v_add_f32 v60, v60, v76
    v_add_f32 v29, v29, v45
    v_add_f32 v61, v61, v77
    v_add_f32 v30, v30, v46
    v_add_f32 v62, v62, v78
    v_add_f32 v31, v31, v47
    v_add_f32 v63, v63, v79
    v_add_f32 v16, v16, v48
    v_add_f32 v17, v17, v49
    v_add_f32 v18, v18, v50
    v_add_f32 v19, v19, v51
    v_add_f32 v20, v20, v52
    v_add_f32 v21, v21, v53
    v_add_f32 v22, v22, v54
    v_add_f32 v23, v23, v55
    v_add_f32 v24, v24, v56
    v_add_f32 v25, v25, v57
    v_add_f32 v26, v26, v58
    v_add_f32 v27, v27, v59
    v_add_f32 v28, v28, v60
    v_add_f32 v29, v29, v61
    v_add_f32 v30, v30, v62
    v_add_f32 v31, v31, v63
    v_and_b32 v10, 31, v1
    v_cmp_eq_u32 vcc, 0, v10
    v_lshrrev_b32 v10, 5, v1
    v_lshlrev_b32 v10, 6, v10
    s_lshl_b32 s35, s26, 8
    s_lshl_b32 s36, s20, 7
    s_add_u32 s35, s35, s36
    s_add_u32 s35, s35, 14336
    s_and_saveexec_b64 s[38:39], vcc
    buffer_store_dwordx4 v[16:19], v10, s[12:15], s35 offen offset:0 sc1
    buffer_store_dwordx4 v[20:23], v10, s[12:15], s35 offen offset:16 sc1
    buffer_store_dwordx4 v[24:27], v10, s[12:15], s35 offen offset:32 sc1
    buffer_store_dwordx4 v[28:31], v10, s[12:15], s35 offen offset:48 sc1
    s_endpgm
L_prep_kernel_ge:
    s_mov_b32 s36, s28
    s_mov_b32 s37, s29
    s_mov_b32 s38, 8192
    s_mov_b32 s39, 0x00020000
    v_and_b32 v4, 15, v1
    v_lshrrev_b32 v5, 4, v1
    v_lshlrev_b32 v6, 9, v4
    v_lshl_add_u32 v6, v5, 4, v6
    buffer_load_dwordx4 v[16:19], v6, s[36:39], 0 offen offset:0
    buffer_load_dwordx4 v[20:23], v6, s[36:39], 0 offen offset:64
    buffer_load_dwordx4 v[24:27], v6, s[36:39], 0 offen offset:128
    buffer_load_dwordx4 v[28:31], v6, s[36:39], 0 offen offset:192
    buffer_load_dwordx4 v[32:35], v6, s[36:39], 0 offen offset:256
    buffer_load_dwordx4 v[36:39], v6, s[36:39], 0 offen offset:320
    buffer_load_dwordx4 v[40:43], v6, s[36:39], 0 offen offset:384
    buffer_load_dwordx4 v[44:47], v6, s[36:39], 0 offen offset:448
    v_bfe_u32 v7, v1, 2, 2
    v_lshl_add_u32 v7, v5, 3, v7
    v_lshlrev_b32 v7, 7, v7
    v_and_b32 v8, 3, v1
    v_lshl_add_u32 v7, v8, 3, v7
    s_lshl_b32 s33, s20, 5
    v_add_u32 v7, s33, v7
    s_waitcnt vmcnt(0)
    s_barrier
    ds_read_b64_tr_b16 v[48:49], v7 offset:0
    ds_read_b64_tr_b16 v[50:51], v7 offset:512
    ds_read_b64_tr_b16 v[52:53], v7 offset:4096
    ds_read_b64_tr_b16 v[54:55], v7 offset:4608
    ds_read_b64_tr_b16 v[56:57], v7 offset:8192
    ds_read_b64_tr_b16 v[58:59], v7 offset:8704
    ds_read_b64_tr_b16 v[60:61], v7 offset:12288
    ds_read_b64_tr_b16 v[62:63], v7 offset:12800
    s_waitcnt lgkmcnt(0)
    ds_read_b64_tr_b16 v[64:65], v7 offset:16384
    ds_read_b64_tr_b16 v[66:67], v7 offset:16896
    ds_read_b64_tr_b16 v[68:69], v7 offset:20480
    ds_read_b64_tr_b16 v[70:71], v7 offset:20992
    ds_read_b64_tr_b16 v[72:73], v7 offset:24576
    ds_read_b64_tr_b16 v[74:75], v7 offset:25088
    ds_read_b64_tr_b16 v[76:77], v7 offset:28672
    ds_read_b64_tr_b16 v[78:79], v7 offset:29184
    s_waitcnt lgkmcnt(0)
    v_mfma_f32_16x16x32_bf16 v[80:83], v[48:51], v[16:19], 0
    v_mfma_f32_16x16x32_bf16 v[80:83], v[52:55], v[20:23], v[80:83]
    v_mfma_f32_16x16x32_bf16 v[80:83], v[56:59], v[24:27], v[80:83]
    v_mfma_f32_16x16x32_bf16 v[80:83], v[60:63], v[28:31], v[80:83]
    v_mfma_f32_16x16x32_bf16 v[80:83], v[64:67], v[32:35], v[80:83]
    v_mfma_f32_16x16x32_bf16 v[80:83], v[68:71], v[36:39], v[80:83]
    v_mfma_f32_16x16x32_bf16 v[80:83], v[72:75], v[40:43], v[80:83]
    v_mfma_f32_16x16x32_bf16 v[80:83], v[76:79], v[44:47], v[80:83]
    s_nop 7
    v_cvt_pk_bf16_f32 v84, v80, v81
    v_cvt_pk_bf16_f32 v85, v82, v83
    s_mov_b32 s33, 0x4038aa3b
    v_lshlrev_b32 v80, 16, v84
    v_and_b32 v81, 0xffff0000, v84
    v_lshlrev_b32 v82, 16, v85
    v_and_b32 v83, 0xffff0000, v85
    v_mul_f32 v80, s33, v80
    v_mul_f32 v81, s33, v81
    v_mul_f32 v82, s33, v82
    v_mul_f32 v83, s33, v83
    v_lshlrev_b32 v6, 10, v4
    v_lshl_add_u32 v6, v5, 4, v6
    s_lshl_b32 s33, s26, 8
    s_lshl_b32 s34, s20, 6
    s_add_u32 s33, s33, s34
    s_add_u32 s33, s33, 16384
    buffer_store_dwordx4 v[80:83], v6, s[12:15], s33 offen sc1
    s_endpgm
L_prep_kernel_tab:
    v_and_b32 v8, 63, v0
    v_lshlrev_b32 v6, 4, v8
    s_waitcnt lgkmcnt(0)
    s_add_u32 s12, s6, 83312640
    s_addc_u32 s13, s7, 0
    s_mov_b32 s14, 294912
    s_mov_b32 s15, 0x00020000
    s_lshl_b32 s32, s20, 4
    s_lshl_b32 s33, s20, 11
    v_and_b32 v9, 15, v8
    v_lshrrev_b32 v10, 4, v8
    v_or_b32 v11, 1, v9
    v_add_u32 v11, s32, v11
    v_cvt_f32_u32 v11, v11
    v_mul_f32 v11, 0x3c000000, v11
    v_lshlrev_b32 v10, 3, v10
    v_add_u32 v10, 0, v10
    v_cvt_f32_u32 v10, v10
    v_and_b32 v9, 1, v9
    v_cvt_f32_u32 v9, v9
    v_mul_f32 v9, 0x3e800000, v9
    v_fma_f32 v12, v11, v10, v9
    v_fract_f32 v13, v12
    v_add_f32 v12, v12, v11
    v_fract_f32 v14, v12
    v_add_f32 v12, v12, v11
    v_fract_f32 v15, v12
    v_add_f32 v12, v12, v11
    v_fract_f32 v16, v12
    v_add_f32 v12, v12, v11
    v_fract_f32 v17, v12
    v_add_f32 v12, v12, v11
    v_fract_f32 v18, v12
    v_add_f32 v12, v12, v11
    v_fract_f32 v19, v12
    v_add_f32 v12, v12, v11
    v_fract_f32 v20, v12
    v_cos_f32 v13, v13
    v_cos_f32 v14, v14
    v_cos_f32 v15, v15
    v_cos_f32 v16, v16
    v_cos_f32 v17, v17
    v_cos_f32 v18, v18
    v_cos_f32 v19, v19
    v_cos_f32 v20, v20
    s_nop 0
    v_cvt_pk_bf16_f32 v24, v13, v14
    v_cvt_pk_bf16_f32 v25, v15, v16
    v_cvt_pk_bf16_f32 v26, v17, v18
    v_cvt_pk_bf16_f32 v27, v19, v20
    s_add_u32 s34, s33, 0
    buffer_store_dwordx4 v[24:27], v6, s[12:15], s34 offen sc1
    v_and_b32 v9, 15, v8
    v_lshrrev_b32 v10, 4, v8
    v_or_b32 v11, 1, v9
    v_add_u32 v11, s32, v11
    v_cvt_f32_u32 v11, v11
    v_mul_f32 v11, 0x3c000000, v11
    v_lshlrev_b32 v10, 3, v10
    v_add_u32 v10, 32, v10
    v_cvt_f32_u32 v10, v10
    v_and_b32 v9, 1, v9
    v_cvt_f32_u32 v9, v9
    v_mul_f32 v9, 0x3e800000, v9
    v_fma_f32 v12, v11, v10, v9
    v_fract_f32 v13, v12
    v_add_f32 v12, v12, v11
    v_fract_f32 v14, v12
    v_add_f32 v12, v12, v11
    v_fract_f32 v15, v12
    v_add_f32 v12, v12, v11
    v_fract_f32 v16, v12
    v_add_f32 v12, v12, v11
    v_fract_f32 v17, v12
    v_add_f32 v12, v12, v11
    v_fract_f32 v18, v12
    v_add_f32 v12, v12, v11
    v_fract_f32 v19, v12
    v_add_f32 v12, v12, v11
    v_fract_f32 v20, v12
    v_cos_f32 v13, v13
    v_cos_f32 v14, v14
    v_cos_f32 v15, v15
    v_cos_f32 v16, v16
    v_cos_f32 v17, v17
    v_cos_f32 v18, v18
    v_cos_f32 v19, v19
    v_cos_f32 v20, v20
    s_nop 0
    v_cvt_pk_bf16_f32 v28, v13, v14
    v_cvt_pk_bf16_f32 v29, v15, v16
    v_cvt_pk_bf16_f32 v30, v17, v18
    v_cvt_pk_bf16_f32 v31, v19, v20
    s_add_u32 s34, s33, 1024
    buffer_store_dwordx4 v[28:31], v6, s[12:15], s34 offen sc1
    s_cmp_ge_u32 s20, 3
    s_cbranch_scc1 L_prep_kernel_done
    v_and_b32 v9, 15, v8
    v_add_u32 v9, s32, v9
    v_cvt_f32_u32 v9, v9
    v_mul_f32 v9, 0x3c000000, v9
    v_lshrrev_b32 v10, 4, v8
    v_lshlrev_b32 v10, 3, v10
    v_add_u32 v11, 1, v10
    v_cvt_f32_u32 v11, v11
    v_mul_f32 v11, v11, v9
    v_fract_f32 v12, v11
    v_add_u32 v11, 1, v10
    v_cvt_f32_u32 v11, v11
    v_mul_f32 v11, v11, v9
    v_add_f32 v11, 0x3e800000, v11
    v_fract_f32 v13, v11
    v_add_u32 v11, 3, v10
    v_cvt_f32_u32 v11, v11
    v_mul_f32 v11, v11, v9
    v_fract_f32 v14, v11
    v_add_u32 v11, 3, v10
    v_cvt_f32_u32 v11, v11
    v_mul_f32 v11, v11, v9
    v_add_f32 v11, 0x3e800000, v11
    v_fract_f32 v15, v11
    v_add_u32 v11, 5, v10
    v_cvt_f32_u32 v11, v11
    v_mul_f32 v11, v11, v9
    v_fract_f32 v16, v11
    v_add_u32 v11, 5, v10
    v_cvt_f32_u32 v11, v11
    v_mul_f32 v11, v11, v9
    v_add_f32 v11, 0x3e800000, v11
    v_fract_f32 v17, v11
    v_add_u32 v11, 7, v10
    v_cvt_f32_u32 v11, v11
    v_mul_f32 v11, v11, v9
    v_fract_f32 v18, v11
    v_add_u32 v11, 7, v10
    v_cvt_f32_u32 v11, v11
    v_mul_f32 v11, v11, v9
    v_add_f32 v11, 0x3e800000, v11
    v_fract_f32 v19, v11
    v_cos_f32 v12, v12
    v_cos_f32 v13, v13
    v_cos_f32 v14, v14
    v_cos_f32 v15, v15
    v_cos_f32 v16, v16
    v_cos_f32 v17, v17
    v_cos_f32 v18, v18
    v_cos_f32 v19, v19
    s_nop 0
    v_cvt_pk_bf16_f32 v24, v12, v13
    v_cvt_pk_bf16_f32 v25, v14, v15
    v_cvt_pk_bf16_f32 v26, v16, v17
    v_cvt_pk_bf16_f32 v27, v18, v19
    s_add_u32 s34, s33, 8192
    buffer_store_dwordx4 v[24:27], v6, s[12:15], s34 offen sc1
    s_nop 1
    v_add_u32 v11, 33, v10
    v_cvt_f32_u32 v11, v11
    v_mul_f32 v11, v11, v9
    v_fract_f32 v12, v11
    v_add_u32 v11, 33, v10
    v_cvt_f32_u32 v11, v11
    v_mul_f32 v11, v11, v9
    v_add_f32 v11, 0x3e800000, v11
    v_fract_f32 v13, v11
    v_add_u32 v11, 35, v10
    v_cvt_f32_u32 v11, v11
    v_mul_f32 v11, v11, v9
    v_fract_f32 v14, v11
    v_add_u32 v11, 35, v10
    v_cvt_f32_u32 v11, v11
    v_mul_f32 v11, v11, v9
    v_add_f32 v11, 0x3e800000, v11
    v_fract_f32 v15, v11
    v_add_u32 v11, 37, v10
    v_cvt_f32_u32 v11, v11
    v_mul_f32 v11, v11, v9
    v_fract_f32 v16, v11
    v_add_u32 v11, 37, v10
    v_cvt_f32_u32 v11, v11
    v_mul_f32 v11, v11, v9
    v_add_f32 v11, 0x3e800000, v11
    v_fract_f32 v17, v11
    v_add_u32 v11, 39, v10
    v_cvt_f32_u32 v11, v11
    v_mul_f32 v11, v11, v9
    v_fract_f32 v18, v11
    v_add_u32 v11, 39, v10
    v_cvt_f32_u32 v11, v11
    v_mul_f32 v11, v11, v9
    v_add_f32 v11, 0x3e800000, v11
    v_fract_f32 v19, v11
    v_cos_f32 v12, v12
    v_cos_f32 v13, v13
    v_cos_f32 v14, v14
    v_cos_f32 v15, v15
    v_cos_f32 v16, v16
    v_cos_f32 v17, v17
    v_cos_f32 v18, v18
    v_cos_f32 v19, v19
    s_nop 0
    v_cvt_pk_bf16_f32 v24, v12, v13
    v_cvt_pk_bf16_f32 v25, v14, v15
    v_cvt_pk_bf16_f32 v26, v16, v17
    v_cvt_pk_bf16_f32 v27, v18, v19
    s_add_u32 s34, s33, 9216
    buffer_store_dwordx4 v[24:27], v6, s[12:15], s34 offen sc1
    s_nop 1
L_prep_kernel_done:
    s_endpgm
.globl gemm1_kernel
.p2align 8
.type gemm1_kernel,@function
gemm1_kernel:
    s_cmp_ge_u32 s2, 256
    s_cbranch_scc1 L_gemm1_kernel_done
    s_load_dwordx2 s[4:5], s[0:1], 72
    s_load_dwordx2 s[6:7], s[0:1], 72
    v_readfirstlane_b32 s20, v0
    s_lshr_b32 s20, s20, 6
    s_and_b32 s24, s2, 7
    s_lshr_b32 s25, s2, 3
    s_lshr_b32 s26, s25, 3
    s_lshl_b32 s24, s24, 2
    s_add_u32 s21, s24, s26
    s_and_b32 s25, s25, 7
    s_lshr_b32 s26, s25, 1
    s_and_b32 s27, s25, 1
    s_mul_i32 s22, s26, 84
    s_sub_u32 s28, 334, s22
    s_min_u32 s28, s28, 84
    s_waitcnt lgkmcnt(0)
    s_mul_i32 s29, s21, 684032
    s_lshl_b32 s30, s22, 11
    s_add_u32 s29, s29, s30
    s_add_u32 s29, s29, 0
    s_add_u32 s8, s6, s29
    s_addc_u32 s9, s7, 0
    s_lshl_b32 s10, s28, 11
    s_mov_b32 s11, 0x00020000
    s_mul_i32 s29, s21, 528640
    s_mul_i32 s30, s27, 16384
    s_add_u32 s29, s29, s30
    s_add_u32 s29, s29, 21954560
    s_add_u32 s12, s4, s29
    s_addc_u32 s13, s5, 0
    s_mov_b32 s14, 507904
    s_mov_b32 s15, 0x00020000
    s_cmp_ge_u32 s20, 4
    s_cbranch_scc1 L_gemm1_kernel_loader
    s_lshl_b32 s29, s22, 15
    s_add_u32 s29, s29, 38871040
    s_add_u32 s16, s4, s29
    s_addc_u32 s17, s5, 0
    s_lshl_b32 s18, s28, 15
    s_mov_b32 s19, 0x00020000
    s_lshr_b32 s29, s20, 1
    s_and_b32 s30, s20, 1
    v_and_b32 v217, 15, v0
    v_bfe_u32 v218, v0, 4, 2
    v_and_b32 v219, 63, v0
    s_mul_i32 s31, s29, 6144
    v_and_b32 v220, 7, v217
    v_xor_b32 v220, v218, v220
    v_lshlrev_b32 v220, 4, v220
    v_lshl_add_u32 v220, v217, 7, v220
    v_add_u32 v220, s31, v220
    v_add_u32 v208, 0, v220
    v_xor_b32 v211, 64, v208
    v_add_u32 v209, 57344, v220
    v_xor_b32 v212, 64, v209
    v_add_u32 v210, 114688, v220
    v_xor_b32 v213, 64, v210
    s_mul_i32 s31, s30, 8192
    s_add_u32 s31, s31, 12288
    v_lshlrev_b32 v220, 4, v219
    v_add_u32 v220, s31, v220
    v_add_u32 v214, 0, v220
    v_add_u32 v215, 57344, v220
    v_add_u32 v216, 114688, v220
    s_mul_i32 s31, s29, 1572864
    v_lshlrev_b32 v221, 15, v217
    v_lshl_add_u32 v221, v218, 4, v221
    v_add_u32 v221, s31, v221
    s_mul_i32 s31, s27, 4
    s_mul_i32 s29, s30, 2
    s_add_u32 s31, s31, s29
    s_lshl_b32 s31, s31, 12
    s_lshl_b32 s29, s21, 7
    s_add_u32 s33, s31, s29
    s_mov_b32 s34, 0x80008000
    s_barrier
    ds_read_b128 v[96:99], v214 offset:0
    ds_read_b128 v[128:131], v208 offset:0
    ds_read_b128 v[136:139], v208 offset:2048
    ds_read_b128 v[144:147], v208 offset:4096
    ds_read_b128 v[104:107], v214 offset:2048
    ds_read_b128 v[112:115], v214 offset:4096
    ds_read_b128 v[120:123], v214 offset:6144
    ds_read_b128 v[132:135], v211 offset:0
    ds_read_b128 v[140:143], v211 offset:2048
    ds_read_b128 v[148:151], v211 offset:4096
    ds_read_b128 v[100:103], v214 offset:1024
    ds_read_b128 v[108:111], v214 offset:3072
    ds_read_b128 v[116:119], v214 offset:5120
    ds_read_b128 v[124:127], v214 offset:7168
    s_waitcnt lgkmcnt(0)
    s_barrier
    v_mfma_f32_16x16x32_bf16 v[0:3], v[96:99], v[128:131], 0
    ds_read_b128 v[152:155], v214 offset:28672
    v_mfma_f32_16x16x32_bf16 v[4:7], v[96:99], v[136:139], 0
    v_mfma_f32_16x16x32_bf16 v[8:11], v[96:99], v[144:147], 0
    ds_read_b128 v[184:187], v208 offset:28672
    v_mfma_f32_16x16x32_bf16 v[12:15], v[104:107], v[128:131], 0
    v_mfma_f32_16x16x32_bf16 v[16:19], v[104:107], v[136:139], 0
    ds_read_b128 v[192:195], v208 offset:30720
    v_mfma_f32_16x16x32_bf16 v[20:23], v[104:107], v[144:147], 0
    v_mfma_f32_16x16x32_bf16 v[24:27], v[112:115], v[128:131], 0
    ds_read_b128 v[200:203], v208 offset:32768
    v_mfma_f32_16x16x32_bf16 v[28:31], v[112:115], v[136:139], 0
    v_mfma_f32_16x16x32_bf16 v[32:35], v[112:115], v[144:147], 0
    ds_read_b128 v[160:163], v214 offset:30720
    v_mfma_f32_16x16x32_bf16 v[36:39], v[120:123], v[128:131], 0
    v_mfma_f32_16x16x32_bf16 v[40:43], v[120:123], v[136:139], 0
    ds_read_b128 v[168:171], v214 offset:32768
    v_mfma_f32_16x16x32_bf16 v[44:47], v[120:123], v[144:147], 0
    v_mfma_f32_16x16x32_bf16 v[48:51], v[96:99], v[132:135], 0
    ds_read_b128 v[176:179], v214 offset:34816
    v_mfma_f32_16x16x32_bf16 v[52:55], v[96:99], v[140:143], 0
    v_mfma_f32_16x16x32_bf16 v[56:59], v[96:99], v[148:151], 0
    ds_read_b128 v[188:191], v211 offset:28672
    v_mfma_f32_16x16x32_bf16 v[60:63], v[104:107], v[132:135], 0
    v_mfma_f32_16x16x32_bf16 v[64:67], v[104:107], v[140:143], 0
    ds_read_b128 v[196:199], v211 offset:30720
    v_mfma_f32_16x16x32_bf16 v[68:71], v[104:107], v[148:151], 0
    v_mfma_f32_16x16x32_bf16 v[72:75], v[112:115], v[132:135], 0
    ds_read_b128 v[204:207], v211 offset:32768
    v_mfma_f32_16x16x32_bf16 v[76:79], v[112:115], v[140:143], 0
    v_mfma_f32_16x16x32_bf16 v[80:83], v[112:115], v[148:151], 0
    ds_read_b128 v[156:159], v214 offset:29696
    v_mfma_f32_16x16x32_bf16 v[84:87], v[120:123], v[132:135], 0
    v_mfma_f32_16x16x32_bf16 v[88:91], v[120:123], v[140:143], 0
    ds_read_b128 v[164:167], v214 offset:31744
    v_mfma_f32_16x16x32_bf16 v[92:95], v[120:123], v[148:151], 0
    v_mfma_f32_16x16x32_bf16 v[48:51], v[100:103], v[128:131], v[48:51]
    ds_read_b128 v[172:175], v214 offset:33792
    v_xor_b32 v132, s34, v132
    v_xor_b32 v133, s34, v133
    v_mfma_f32_16x16x32_bf16 v[52:55], v[100:103], v[136:139], v[52:55]
    v_xor_b32 v134, s34, v134
    v_xor_b32 v135, s34, v135
    v_mfma_f32_16x16x32_bf16 v[56:59], v[100:103], v[144:147], v[56:59]
    ds_read_b128 v[180:183], v214 offset:35840
    v_xor_b32 v140, s34, v140
    v_xor_b32 v141, s34, v141
    v_mfma_f32_16x16x32_bf16 v[60:63], v[108:111], v[128:131], v[60:63]
    v_xor_b32 v142, s34, v142
    v_xor_b32 v143, s34, v143
    v_mfma_f32_16x16x32_bf16 v[64:67], v[108:111], v[136:139], v[64:67]
    v_xor_b32 v148, s34, v148
    v_xor_b32 v149, s34, v149
    v_mfma_f32_16x16x32_bf16 v[68:71], v[108:111], v[144:147], v[68:71]
    v_xor_b32 v150, s34, v150
    v_xor_b32 v151, s34, v151
    v_mfma_f32_16x16x32_bf16 v[72:75], v[116:119], v[128:131], v[72:75]
    v_mfma_f32_16x16x32_bf16 v[76:79], v[116:119], v[136:139], v[76:79]
    v_mfma_f32_16x16x32_bf16 v[80:83], v[116:119], v[144:147], v[80:83]
    v_mfma_f32_16x16x32_bf16 v[84:87], v[124:127], v[128:131], v[84:87]
    v_mfma_f32_16x16x32_bf16 v[88:91], v[124:127], v[136:139], v[88:91]
    v_mfma_f32_16x16x32_bf16 v[92:95], v[124:127], v[144:147], v[92:95]
    v_mfma_f32_16x16x32_bf16 v[0:3], v[100:103], v[132:135], v[0:3]
    v_mfma_f32_16x16x32_bf16 v[4:7], v[100:103], v[140:143], v[4:7]
    v_mfma_f32_16x16x32_bf16 v[8:11], v[100:103], v[148:151], v[8:11]
    v_mfma_f32_16x16x32_bf16 v[12:15], v[108:111], v[132:135], v[12:15]
    v_mfma_f32_16x16x32_bf16 v[16:19], v[108:111], v[140:143], v[16:19]
    s_waitcnt lgkmcnt(0)
    s_barrier
    v_mfma_f32_16x16x32_bf16 v[20:23], v[108:111], v[148:151], v[20:23]
    v_mfma_f32_16x16x32_bf16 v[24:27], v[116:119], v[132:135], v[24:27]
    v_mfma_f32_16x16x32_bf16 v[28:31], v[116:119], v[140:143], v[28:31]
    v_mfma_f32_16x16x32_bf16 v[32:35], v[116:119], v[148:151], v[32:35]
    v_mfma_f32_16x16x32_bf16 v[36:39], v[124:127], v[132:135], v[36:39]
    v_mfma_f32_16x16x32_bf16 v[40:43], v[124:127], v[140:143], v[40:43]
    v_mfma_f32_16x16x32_bf16 v[44:47], v[124:127], v[148:151], v[44:47]
    v_mfma_f32_16x16x32_bf16 v[0:3], v[152:155], v[184:187], v[0:3]
    ds_read_b128 v[96:99], v215 offset:0
    v_mfma_f32_16x16x32_bf16 v[4:7], v[152:155], v[192:195], v[4:7]
    v_mfma_f32_16x16x32_bf16 v[8:11], v[152:155], v[200:203], v[8:11]
    ds_read_b128 v[128:131], v209 offset:0
    v_mfma_f32_16x16x32_bf16 v[12:15], v[160:163], v[184:187], v[12:15]
    v_mfma_f32_16x16x32_bf16 v[16:19], v[160:163], v[192:195], v[16:19]
    ds_read_b128 v[136:139], v209 offset:2048
    v_mfma_f32_16x16x32_bf16 v[20:23], v[160:163], v[200:203], v[20:23]
    v_mfma_f32_16x16x32_bf16 v[24:27], v[168:171], v[184:187], v[24:27]
    ds_read_b128 v[144:147], v209 offset:4096
    v_mfma_f32_16x16x32_bf16 v[28:31], v[168:171], v[192:195], v[28:31]
    v_mfma_f32_16x16x32_bf16 v[32:35], v[168:171], v[200:203], v[32:35]
    ds_read_b128 v[104:107], v215 offset:2048
    v_mfma_f32_16x16x32_bf16 v[36:39], v[176:179], v[184:187], v[36:39]
    v_mfma_f32_16x16x32_bf16 v[40:43], v[176:179], v[192:195], v[40:43]
    ds_read_b128 v[112:115], v215 offset:4096
    v_mfma_f32_16x16x32_bf16 v[44:47], v[176:179], v[200:203], v[44:47]
    v_mfma_f32_16x16x32_bf16 v[48:51], v[152:155], v[188:191], v[48:51]
    ds_read_b128 v[120:123], v215 offset:6144
    v_mfma_f32_16x16x32_bf16 v[52:55], v[152:155], v[196:199], v[52:55]
    v_mfma_f32_16x16x32_bf16 v[56:59], v[152:155], v[204:207], v[56:59]
    ds_read_b128 v[132:135], v212 offset:0
    v_mfma_f32_16x16x32_bf16 v[60:63], v[160:163], v[188:191], v[60:63]
    v_mfma_f32_16x16x32_bf16 v[64:67], v[160:163], v[196:199], v[64:67]
    ds_read_b128 v[140:143], v212 offset:2048
    v_mfma_f32_16x16x32_bf16 v[68:71], v[160:163], v[204:207], v[68:71]
    v_mfma_f32_16x16x32_bf16 v[72:75], v[168:171], v[188:191], v[72:75]
    ds_read_b128 v[148:151], v212 offset:4096
    v_mfma_f32_16x16x32_bf16 v[76:79], v[168:171], v[196:199], v[76:79]
    v_mfma_f32_16x16x32_bf16 v[80:83], v[168:171], v[204:207], v[80:83]
    ds_read_b128 v[100:103], v215 offset:1024
    v_mfma_f32_16x16x32_bf16 v[84:87], v[176:179], v[188:191], v[84:87]
    v_mfma_f32_16x16x32_bf16 v[88:91], v[176:179], v[196:199], v[88:91]
    ds_read_b128 v[108:111], v215 offset:3072
    v_mfma_f32_16x16x32_bf16 v[92:95], v[176:179], v[204:207], v[92:95]
    v_mfma_f32_16x16x32_bf16 v[48:51], v[156:159], v[184:187], v[48:51]
    ds_read_b128 v[116:119], v215 offset:5120
    v_xor_b32 v188, s34, v188
    v_xor_b32 v189, s34, v189
    v_mfma_f32_16x16x32_bf16 v[52:55], v[156:159], v[192:195], v[52:55]
    v_xor_b32 v190, s34, v190
    v_xor_b32 v191, s34, v191
    v_mfma_f32_16x16x32_bf16 v[56:59], v[156:159], v[200:203], v[56:59]
    ds_read_b128 v[124:127], v215 offset:7168
    v_xor_b32 v196, s34, v196
    v_xor_b32 v197, s34, v197
    v_mfma_f32_16x16x32_bf16 v[60:63], v[164:167], v[184:187], v[60:63]
    v_xor_b32 v198, s34, v198
    v_xor_b32 v199, s34, v199
    v_mfma_f32_16x16x32_bf16 v[64:67], v[164:167], v[192:195], v[64:67]
    v_xor_b32 v204, s34, v204
    v_xor_b32 v205, s34, v205
    v_mfma_f32_16x16x32_bf16 v[68:71], v[164:167], v[200:203], v[68:71]
    v_xor_b32 v206, s34, v206
    v_xor_b32 v207, s34, v207
    v_mfma_f32_16x16x32_bf16 v[72:75], v[172:175], v[184:187], v[72:75]
    v_mfma_f32_16x16x32_bf16 v[76:79], v[172:175], v[192:195], v[76:79]
    v_mfma_f32_16x16x32_bf16 v[80:83], v[172:175], v[200:203], v[80:83]
    v_mfma_f32_16x16x32_bf16 v[84:87], v[180:183], v[184:187], v[84:87]
    v_mfma_f32_16x16x32_bf16 v[88:91], v[180:183], v[192:195], v[88:91]
    v_mfma_f32_16x16x32_bf16 v[92:95], v[180:183], v[200:203], v[92:95]
    v_mfma_f32_16x16x32_bf16 v[0:3], v[156:159], v[188:191], v[0:3]
    v_mfma_f32_16x16x32_bf16 v[4:7], v[156:159], v[196:199], v[4:7]
    v_mfma_f32_16x16x32_bf16 v[8:11], v[156:159], v[204:207], v[8:11]
    v_mfma_f32_16x16x32_bf16 v[12:15], v[164:167], v[188:191], v[12:15]
    v_mfma_f32_16x16x32_bf16 v[16:19], v[164:167], v[196:199], v[16:19]
    s_waitcnt lgkmcnt(0)
    s_barrier
    v_mfma_f32_16x16x32_bf16 v[20:23], v[164:167], v[204:207], v[20:23]
    v_mfma_f32_16x16x32_bf16 v[24:27], v[172:175], v[188:191], v[24:27]
    v_mfma_f32_16x16x32_bf16 v[28:31], v[172:175], v[196:199], v[28:31]
    v_mfma_f32_16x16x32_bf16 v[32:35], v[172:175], v[204:207], v[32:35]
    v_mfma_f32_16x16x32_bf16 v[36:39], v[180:183], v[188:191], v[36:39]
    v_mfma_f32_16x16x32_bf16 v[40:43], v[180:183], v[196:199], v[40:43]
    v_mfma_f32_16x16x32_bf16 v[44:47], v[180:183], v[204:207], v[44:47]
    v_mfma_f32_16x16x32_bf16 v[0:3], v[96:99], v[128:131], v[0:3]
    ds_read_b128 v[152:155], v215 offset:28672
    v_mfma_f32_16x16x32_bf16 v[4:7], v[96:99], v[136:139], v[4:7]
    v_mfma_f32_16x16x32_bf16 v[8:11], v[96:99], v[144:147], v[8:11]
    ds_read_b128 v[184:187], v209 offset:28672
    v_mfma_f32_16x16x32_bf16 v[12:15], v[104:107], v[128:131], v[12:15]
    v_mfma_f32_16x16x32_bf16 v[16:19], v[104:107], v[136:139], v[16:19]
    ds_read_b128 v[192:195], v209 offset:30720
    v_mfma_f32_16x16x32_bf16 v[20:23], v[104:107], v[144:147], v[20:23]
    v_mfma_f32_16x16x32_bf16 v[24:27], v[112:115], v[128:131], v[24:27]
    ds_read_b128 v[200:203], v209 offset:32768
    v_mfma_f32_16x16x32_bf16 v[28:31], v[112:115], v[136:139], v[28:31]
    v_mfma_f32_16x16x32_bf16 v[32:35], v[112:115], v[144:147], v[32:35]
    ds_read_b128 v[160:163], v215 offset:30720
    v_mfma_f32_16x16x32_bf16 v[36:39], v[120:123], v[128:131], v[36:39]
    v_mfma_f32_16x16x32_bf16 v[40:43], v[120:123], v[136:139], v[40:43]
    ds_read_b128 v[168:171], v215 offset:32768
    v_mfma_f32_16x16x32_bf16 v[44:47], v[120:123], v[144:147], v[44:47]
    v_mfma_f32_16x16x32_bf16 v[48:51], v[96:99], v[132:135], v[48:51]
    ds_read_b128 v[176:179], v215 offset:34816
    v_mfma_f32_16x16x32_bf16 v[52:55], v[96:99], v[140:143], v[52:55]
    v_mfma_f32_16x16x32_bf16 v[56:59], v[96:99], v[148:151], v[56:59]
    ds_read_b128 v[188:191], v212 offset:28672
    v_mfma_f32_16x16x32_bf16 v[60:63], v[104:107], v[132:135], v[60:63]
    v_mfma_f32_16x16x32_bf16 v[64:67], v[104:107], v[140:143], v[64:67]
    ds_read_b128 v[196:199], v212 offset:30720
    v_mfma_f32_16x16x32_bf16 v[68:71], v[104:107], v[148:151], v[68:71]
    v_mfma_f32_16x16x32_bf16 v[72:75], v[112:115], v[132:135], v[72:75]
    ds_read_b128 v[204:207], v212 offset:32768
    v_mfma_f32_16x16x32_bf16 v[76:79], v[112:115], v[140:143], v[76:79]
    v_mfma_f32_16x16x32_bf16 v[80:83], v[112:115], v[148:151], v[80:83]
    ds_read_b128 v[156:159], v215 offset:29696
    v_mfma_f32_16x16x32_bf16 v[84:87], v[120:123], v[132:135], v[84:87]
    v_mfma_f32_16x16x32_bf16 v[88:91], v[120:123], v[140:143], v[88:91]
    ds_read_b128 v[164:167], v215 offset:31744
    v_mfma_f32_16x16x32_bf16 v[92:95], v[120:123], v[148:151], v[92:95]
    v_mfma_f32_16x16x32_bf16 v[48:51], v[100:103], v[128:131], v[48:51]
    ds_read_b128 v[172:175], v215 offset:33792
    v_xor_b32 v132, s34, v132
    v_xor_b32 v133, s34, v133
    v_mfma_f32_16x16x32_bf16 v[52:55], v[100:103], v[136:139], v[52:55]
    v_xor_b32 v134, s34, v134
    v_xor_b32 v135, s34, v135
    v_mfma_f32_16x16x32_bf16 v[56:59], v[100:103], v[144:147], v[56:59]
    ds_read_b128 v[180:183], v215 offset:35840
    v_xor_b32 v140, s34, v140
    v_xor_b32 v141, s34, v141
    v_mfma_f32_16x16x32_bf16 v[60:63], v[108:111], v[128:131], v[60:63]
    v_xor_b32 v142, s34, v142
    v_xor_b32 v143, s34, v143
    v_mfma_f32_16x16x32_bf16 v[64:67], v[108:111], v[136:139], v[64:67]
    v_xor_b32 v148, s34, v148
    v_xor_b32 v149, s34, v149
    v_mfma_f32_16x16x32_bf16 v[68:71], v[108:111], v[144:147], v[68:71]
    v_xor_b32 v150, s34, v150
    v_xor_b32 v151, s34, v151
    v_mfma_f32_16x16x32_bf16 v[72:75], v[116:119], v[128:131], v[72:75]
    v_mfma_f32_16x16x32_bf16 v[76:79], v[116:119], v[136:139], v[76:79]
    v_mfma_f32_16x16x32_bf16 v[80:83], v[116:119], v[144:147], v[80:83]
    v_mfma_f32_16x16x32_bf16 v[84:87], v[124:127], v[128:131], v[84:87]
    v_mfma_f32_16x16x32_bf16 v[88:91], v[124:127], v[136:139], v[88:91]
    v_mfma_f32_16x16x32_bf16 v[92:95], v[124:127], v[144:147], v[92:95]
    v_mfma_f32_16x16x32_bf16 v[0:3], v[100:103], v[132:135], v[0:3]
    v_mfma_f32_16x16x32_bf16 v[4:7], v[100:103], v[140:143], v[4:7]
    v_mfma_f32_16x16x32_bf16 v[8:11], v[100:103], v[148:151], v[8:11]
    v_mfma_f32_16x16x32_bf16 v[12:15], v[108:111], v[132:135], v[12:15]
    v_mfma_f32_16x16x32_bf16 v[16:19], v[108:111], v[140:143], v[16:19]
    s_waitcnt lgkmcnt(0)
    s_barrier
    v_mfma_f32_16x16x32_bf16 v[20:23], v[108:111], v[148:151], v[20:23]
    v_mfma_f32_16x16x32_bf16 v[24:27], v[116:119], v[132:135], v[24:27]
    v_mfma_f32_16x16x32_bf16 v[28:31], v[116:119], v[140:143], v[28:31]
    v_mfma_f32_16x16x32_bf16 v[32:35], v[116:119], v[148:151], v[32:35]
    v_mfma_f32_16x16x32_bf16 v[36:39], v[124:127], v[132:135], v[36:39]
    v_mfma_f32_16x16x32_bf16 v[40:43], v[124:127], v[140:143], v[40:43]
    v_mfma_f32_16x16x32_bf16 v[44:47], v[124:127], v[148:151], v[44:47]
    v_mfma_f32_16x16x32_bf16 v[0:3], v[152:155], v[184:187], v[0:3]
    ds_read_b128 v[96:99], v216 offset:0
    v_mfma_f32_16x16x32_bf16 v[4:7], v[152:155], v[192:195], v[4:7]
    v_mfma_f32_16x16x32_bf16 v[8:11], v[152:155], v[200:203], v[8:11]
    ds_read_b128 v[128:131], v210 offset:0
    v_mfma_f32_16x16x32_bf16 v[12:15], v[160:163], v[184:187], v[12:15]
    v_mfma_f32_16x16x32_bf16 v[16:19], v[160:163], v[192:195], v[16:19]
    ds_read_b128 v[136:139], v210 offset:2048
    v_mfma_f32_16x16x32_bf16 v[20:23], v[160:163], v[200:203], v[20:23]
    v_mfma_f32_16x16x32_bf16 v[24:27], v[168:171], v[184:187], v[24:27]
    ds_read_b128 v[144:147], v210 offset:4096
    v_mfma_f32_16x16x32_bf16 v[28:31], v[168:171], v[192:195], v[28:31]
    v_mfma_f32_16x16x32_bf16 v[32:35], v[168:171], v[200:203], v[32:35]
    ds_read_b128 v[104:107], v216 offset:2048
    v_mfma_f32_16x16x32_bf16 v[36:39], v[176:179], v[184:187], v[36:39]
    v_mfma_f32_16x16x32_bf16 v[40:43], v[176:179], v[192:195], v[40:43]
    ds_read_b128 v[112:115], v216 offset:4096
    v_mfma_f32_16x16x32_bf16 v[44:47], v[176:179], v[200:203], v[44:47]
    v_mfma_f32_16x16x32_bf16 v[48:51], v[152:155], v[188:191], v[48:51]
    ds_read_b128 v[120:123], v216 offset:6144
    v_mfma_f32_16x16x32_bf16 v[52:55], v[152:155], v[196:199], v[52:55]
    v_mfma_f32_16x16x32_bf16 v[56:59], v[152:155], v[204:207], v[56:59]
    ds_read_b128 v[132:135], v213 offset:0
    v_mfma_f32_16x16x32_bf16 v[60:63], v[160:163], v[188:191], v[60:63]
    v_mfma_f32_16x16x32_bf16 v[64:67], v[160:163], v[196:199], v[64:67]
    ds_read_b128 v[140:143], v213 offset:2048
    v_mfma_f32_16x16x32_bf16 v[68:71], v[160:163], v[204:207], v[68:71]
    v_mfma_f32_16x16x32_bf16 v[72:75], v[168:171], v[188:191], v[72:75]
    ds_read_b128 v[148:151], v213 offset:4096
    v_mfma_f32_16x16x32_bf16 v[76:79], v[168:171], v[196:199], v[76:79]
    v_mfma_f32_16x16x32_bf16 v[80:83], v[168:171], v[204:207], v[80:83]
    ds_read_b128 v[100:103], v216 offset:1024
    v_mfma_f32_16x16x32_bf16 v[84:87], v[176:179], v[188:191], v[84:87]
    v_mfma_f32_16x16x32_bf16 v[88:91], v[176:179], v[196:199], v[88:91]
    ds_read_b128 v[108:111], v216 offset:3072
    v_mfma_f32_16x16x32_bf16 v[92:95], v[176:179], v[204:207], v[92:95]
    v_mfma_f32_16x16x32_bf16 v[48:51], v[156:159], v[184:187], v[48:51]
    ds_read_b128 v[116:119], v216 offset:5120
    v_xor_b32 v188, s34, v188
    v_xor_b32 v189, s34, v189
    v_mfma_f32_16x16x32_bf16 v[52:55], v[156:159], v[192:195], v[52:55]
    v_xor_b32 v190, s34, v190
    v_xor_b32 v191, s34, v191
    v_mfma_f32_16x16x32_bf16 v[56:59], v[156:159], v[200:203], v[56:59]
    ds_read_b128 v[124:127], v216 offset:7168
    v_xor_b32 v196, s34, v196
    v_xor_b32 v197, s34, v197
    v_mfma_f32_16x16x32_bf16 v[60:63], v[164:167], v[184:187], v[60:63]
    v_xor_b32 v198, s34, v198
    v_xor_b32 v199, s34, v199
    v_mfma_f32_16x16x32_bf16 v[64:67], v[164:167], v[192:195], v[64:67]
    v_xor_b32 v204, s34, v204
    v_xor_b32 v205, s34, v205
    v_mfma_f32_16x16x32_bf16 v[68:71], v[164:167], v[200:203], v[68:71]
    v_xor_b32 v206, s34, v206
    v_xor_b32 v207, s34, v207
    v_mfma_f32_16x16x32_bf16 v[72:75], v[172:175], v[184:187], v[72:75]
    v_mfma_f32_16x16x32_bf16 v[76:79], v[172:175], v[192:195], v[76:79]
    v_mfma_f32_16x16x32_bf16 v[80:83], v[172:175], v[200:203], v[80:83]
    v_mfma_f32_16x16x32_bf16 v[84:87], v[180:183], v[184:187], v[84:87]
    v_mfma_f32_16x16x32_bf16 v[88:91], v[180:183], v[192:195], v[88:91]
    v_mfma_f32_16x16x32_bf16 v[92:95], v[180:183], v[200:203], v[92:95]
    v_mfma_f32_16x16x32_bf16 v[0:3], v[156:159], v[188:191], v[0:3]
    v_mfma_f32_16x16x32_bf16 v[4:7], v[156:159], v[196:199], v[4:7]
    v_mfma_f32_16x16x32_bf16 v[8:11], v[156:159], v[204:207], v[8:11]
    v_mfma_f32_16x16x32_bf16 v[12:15], v[164:167], v[188:191], v[12:15]
    v_mfma_f32_16x16x32_bf16 v[16:19], v[164:167], v[196:199], v[16:19]
    s_waitcnt lgkmcnt(0)
    s_barrier
    v_mfma_f32_16x16x32_bf16 v[20:23], v[164:167], v[204:207], v[20:23]
    v_mfma_f32_16x16x32_bf16 v[24:27], v[172:175], v[188:191], v[24:27]
    v_mfma_f32_16x16x32_bf16 v[28:31], v[172:175], v[196:199], v[28:31]
    v_mfma_f32_16x16x32_bf16 v[32:35], v[172:175], v[204:207], v[32:35]
    v_mfma_f32_16x16x32_bf16 v[36:39], v[180:183], v[188:191], v[36:39]
    v_mfma_f32_16x16x32_bf16 v[40:43], v[180:183], v[196:199], v[40:43]
    v_mfma_f32_16x16x32_bf16 v[44:47], v[180:183], v[204:207], v[44:47]
    v_mfma_f32_16x16x32_bf16 v[0:3], v[96:99], v[128:131], v[0:3]
    ds_read_b128 v[152:155], v214 offset:0
    v_mfma_f32_16x16x32_bf16 v[4:7], v[96:99], v[136:139], v[4:7]
    v_mfma_f32_16x16x32_bf16 v[8:11], v[96:99], v[144:147], v[8:11]
    ds_read_b128 v[184:187], v208 offset:0
    v_mfma_f32_16x16x32_bf16 v[12:15], v[104:107], v[128:131], v[12:15]
    v_mfma_f32_16x16x32_bf16 v[16:19], v[104:107], v[136:139], v[16:19]
    ds_read_b128 v[192:195], v208 offset:2048
    v_mfma_f32_16x16x32_bf16 v[20:23], v[104:107], v[144:147], v[20:23]
    v_mfma_f32_16x16x32_bf16 v[24:27], v[112:115], v[128:131], v[24:27]
    ds_read_b128 v[200:203], v208 offset:4096
    v_mfma_f32_16x16x32_bf16 v[28:31], v[112:115], v[136:139], v[28:31]
    v_mfma_f32_16x16x32_bf16 v[32:35], v[112:115], v[144:147], v[32:35]
    ds_read_b128 v[160:163], v214 offset:2048
    v_mfma_f32_16x16x32_bf16 v[36:39], v[120:123], v[128:131], v[36:39]
    v_mfma_f32_16x16x32_bf16 v[40:43], v[120:123], v[136:139], v[40:43]
    ds_read_b128 v[168:171], v214 offset:4096
    v_mfma_f32_16x16x32_bf16 v[44:47], v[120:123], v[144:147], v[44:47]
    v_mfma_f32_16x16x32_bf16 v[48:51], v[96:99], v[132:135], v[48:51]
    ds_read_b128 v[176:179], v214 offset:6144
    v_mfma_f32_16x16x32_bf16 v[52:55], v[96:99], v[140:143], v[52:55]
    v_mfma_f32_16x16x32_bf16 v[56:59], v[96:99], v[148:151], v[56:59]
    ds_read_b128 v[188:191], v211 offset:0
    v_mfma_f32_16x16x32_bf16 v[60:63], v[104:107], v[132:135], v[60:63]
    v_mfma_f32_16x16x32_bf16 v[64:67], v[104:107], v[140:143], v[64:67]
    ds_read_b128 v[196:199], v211 offset:2048
    v_mfma_f32_16x16x32_bf16 v[68:71], v[104:107], v[148:151], v[68:71]
    v_mfma_f32_16x16x32_bf16 v[72:75], v[112:115], v[132:135], v[72:75]
    ds_read_b128 v[204:207], v211 offset:4096
    v_mfma_f32_16x16x32_bf16 v[76:79], v[112:115], v[140:143], v[76:79]
    v_mfma_f32_16x16x32_bf16 v[80:83], v[112:115], v[148:151], v[80:83]
    ds_read_b128 v[156:159], v214 offset:1024
    v_mfma_f32_16x16x32_bf16 v[84:87], v[120:123], v[132:135], v[84:87]
    v_mfma_f32_16x16x32_bf16 v[88:91], v[120:123], v[140:143], v[88:91]
    ds_read_b128 v[164:167], v214 offset:3072
    v_mfma_f32_16x16x32_bf16 v[92:95], v[120:123], v[148:151], v[92:95]
    v_mfma_f32_16x16x32_bf16 v[48:51], v[100:103], v[128:131], v[48:51]
    ds_read_b128 v[172:175], v214 offset:5120
    v_xor_b32 v132, s34, v132
    v_xor_b32 v133, s34, v133
    v_mfma_f32_16x16x32_bf16 v[52:55], v[100:103], v[136:139], v[52:55]
    v_xor_b32 v134, s34, v134
    v_xor_b32 v135, s34, v135
    v_mfma_f32_16x16x32_bf16 v[56:59], v[100:103], v[144:147], v[56:59]
    ds_read_b128 v[180:183], v214 offset:7168
    v_xor_b32 v140, s34, v140
    v_xor_b32 v141, s34, v141
    v_mfma_f32_16x16x32_bf16 v[60:63], v[108:111], v[128:131], v[60:63]
    v_xor_b32 v142, s34, v142
    v_xor_b32 v143, s34, v143
    v_mfma_f32_16x16x32_bf16 v[64:67], v[108:111], v[136:139], v[64:67]
    v_xor_b32 v148, s34, v148
    v_xor_b32 v149, s34, v149
    v_mfma_f32_16x16x32_bf16 v[68:71], v[108:111], v[144:147], v[68:71]
    v_xor_b32 v150, s34, v150
    v_xor_b32 v151, s34, v151
    v_mfma_f32_16x16x32_bf16 v[72:75], v[116:119], v[128:131], v[72:75]
    v_mfma_f32_16x16x32_bf16 v[76:79], v[116:119], v[136:139], v[76:79]
    v_mfma_f32_16x16x32_bf16 v[80:83], v[116:119], v[144:147], v[80:83]
    v_mfma_f32_16x16x32_bf16 v[84:87], v[124:127], v[128:131], v[84:87]
    v_mfma_f32_16x16x32_bf16 v[88:91], v[124:127], v[136:139], v[88:91]
    v_mfma_f32_16x16x32_bf16 v[92:95], v[124:127], v[144:147], v[92:95]
    v_mfma_f32_16x16x32_bf16 v[0:3], v[100:103], v[132:135], v[0:3]
    v_mfma_f32_16x16x32_bf16 v[4:7], v[100:103], v[140:143], v[4:7]
    v_mfma_f32_16x16x32_bf16 v[8:11], v[100:103], v[148:151], v[8:11]
    v_mfma_f32_16x16x32_bf16 v[12:15], v[108:111], v[132:135], v[12:15]
    v_mfma_f32_16x16x32_bf16 v[16:19], v[108:111], v[140:143], v[16:19]
    s_waitcnt lgkmcnt(0)
    s_barrier
    v_mfma_f32_16x16x32_bf16 v[20:23], v[108:111], v[148:151], v[20:23]
    v_mfma_f32_16x16x32_bf16 v[24:27], v[116:119], v[132:135], v[24:27]
    v_mfma_f32_16x16x32_bf16 v[28:31], v[116:119], v[140:143], v[28:31]
    v_mfma_f32_16x16x32_bf16 v[32:35], v[116:119], v[148:151], v[32:35]
    v_mfma_f32_16x16x32_bf16 v[36:39], v[124:127], v[132:135], v[36:39]
    v_mfma_f32_16x16x32_bf16 v[40:43], v[124:127], v[140:143], v[40:43]
    v_mfma_f32_16x16x32_bf16 v[44:47], v[124:127], v[148:151], v[44:47]
    v_mfma_f32_16x16x32_bf16 v[0:3], v[152:155], v[184:187], v[0:3]
    ds_read_b128 v[96:99], v214 offset:28672
    v_mfma_f32_16x16x32_bf16 v[4:7], v[152:155], v[192:195], v[4:7]
    v_mfma_f32_16x16x32_bf16 v[8:11], v[152:155], v[200:203], v[8:11]
    ds_read_b128 v[128:131], v208 offset:28672
    v_mfma_f32_16x16x32_bf16 v[12:15], v[160:163], v[184:187], v[12:15]
    v_mfma_f32_16x16x32_bf16 v[16:19], v[160:163], v[192:195], v[16:19]
    ds_read_b128 v[136:139], v208 offset:30720
    v_mfma_f32_16x16x32_bf16 v[20:23], v[160:163], v[200:203], v[20:23]
    v_mfma_f32_16x16x32_bf16 v[24:27], v[168:171], v[184:187], v[24:27]
    ds_read_b128 v[144:147], v208 offset:32768
    v_mfma_f32_16x16x32_bf16 v[28:31], v[168:171], v[192:195], v[28:31]
    v_mfma_f32_16x16x32_bf16 v[32:35], v[168:171], v[200:203], v[32:35]
    ds_read_b128 v[104:107], v214 offset:30720
    v_mfma_f32_16x16x32_bf16 v[36:39], v[176:179], v[184:187], v[36:39]
    v_mfma_f32_16x16x32_bf16 v[40:43], v[176:179], v[192:195], v[40:43]
    ds_read_b128 v[112:115], v214 offset:32768
    v_mfma_f32_16x16x32_bf16 v[44:47], v[176:179], v[200:203], v[44:47]
    v_mfma_f32_16x16x32_bf16 v[48:51], v[152:155], v[188:191], v[48:51]
    ds_read_b128 v[120:123], v214 offset:34816
    v_mfma_f32_16x16x32_bf16 v[52:55], v[152:155], v[196:199], v[52:55]
    v_mfma_f32_16x16x32_bf16 v[56:59], v[152:155], v[204:207], v[56:59]
    ds_read_b128 v[132:135], v211 offset:28672
    v_mfma_f32_16x16x32_bf16 v[60:63], v[160:163], v[188:191], v[60:63]
    v_mfma_f32_16x16x32_bf16 v[64:67], v[160:163], v[196:199], v[64:67]
    ds_read_b128 v[140:143], v211 offset:30720
    v_mfma_f32_16x16x32_bf16 v[68:71], v[160:163], v[204:207], v[68:71]
    v_mfma_f32_16x16x32_bf16 v[72:75], v[168:171], v[188:191], v[72:75]
    ds_read_b128 v[148:151], v211 offset:32768
    v_mfma_f32_16x16x32_bf16 v[76:79], v[168:171], v[196:199], v[76:79]
    v_mfma_f32_16x16x32_bf16 v[80:83], v[168:171], v[204:207], v[80:83]
    ds_read_b128 v[100:103], v214 offset:29696
    v_mfma_f32_16x16x32_bf16 v[84:87], v[176:179], v[188:191], v[84:87]
    v_mfma_f32_16x16x32_bf16 v[88:91], v[176:179], v[196:199], v[88:91]
    ds_read_b128 v[108:111], v214 offset:31744
    v_mfma_f32_16x16x32_bf16 v[92:95], v[176:179], v[204:207], v[92:95]
    v_mfma_f32_16x16x32_bf16 v[48:51], v[156:159], v[184:187], v[48:51]
    ds_read_b128 v[116:119], v214 offset:33792
    v_xor_b32 v188, s34, v188
    v_xor_b32 v189, s34, v189
    v_mfma_f32_16x16x32_bf16 v[52:55], v[156:159], v[192:195], v[52:55]
    v_xor_b32 v190, s34, v190
    v_xor_b32 v191, s34, v191
    v_mfma_f32_16x16x32_bf16 v[56:59], v[156:159], v[200:203], v[56:59]
    ds_read_b128 v[124:127], v214 offset:35840
    v_xor_b32 v196, s34, v196
    v_xor_b32 v197, s34, v197
    v_mfma_f32_16x16x32_bf16 v[60:63], v[164:167], v[184:187], v[60:63]
    v_xor_b32 v198, s34, v198
    v_xor_b32 v199, s34, v199
    v_mfma_f32_16x16x32_bf16 v[64:67], v[164:167], v[192:195], v[64:67]
    v_xor_b32 v204, s34, v204
    v_xor_b32 v205, s34, v205
    v_mfma_f32_16x16x32_bf16 v[68:71], v[164:167], v[200:203], v[68:71]
    v_xor_b32 v206, s34, v206
    v_xor_b32 v207, s34, v207
    v_mfma_f32_16x16x32_bf16 v[72:75], v[172:175], v[184:187], v[72:75]
    v_mfma_f32_16x16x32_bf16 v[76:79], v[172:175], v[192:195], v[76:79]
    v_mfma_f32_16x16x32_bf16 v[80:83], v[172:175], v[200:203], v[80:83]
    v_mfma_f32_16x16x32_bf16 v[84:87], v[180:183], v[184:187], v[84:87]
    v_mfma_f32_16x16x32_bf16 v[88:91], v[180:183], v[192:195], v[88:91]
    v_mfma_f32_16x16x32_bf16 v[92:95], v[180:183], v[200:203], v[92:95]
    v_mfma_f32_16x16x32_bf16 v[0:3], v[156:159], v[188:191], v[0:3]
    v_mfma_f32_16x16x32_bf16 v[4:7], v[156:159], v[196:199], v[4:7]
    v_mfma_f32_16x16x32_bf16 v[8:11], v[156:159], v[204:207], v[8:11]
    v_mfma_f32_16x16x32_bf16 v[12:15], v[164:167], v[188:191], v[12:15]
    v_mfma_f32_16x16x32_bf16 v[16:19], v[164:167], v[196:199], v[16:19]
    s_waitcnt lgkmcnt(0)
    s_barrier
    v_mfma_f32_16x16x32_bf16 v[20:23], v[164:167], v[204:207], v[20:23]
    v_mfma_f32_16x16x32_bf16 v[24:27], v[172:175], v[188:191], v[24:27]
    v_mfma_f32_16x16x32_bf16 v[28:31], v[172:175], v[196:199], v[28:31]
    v_mfma_f32_16x16x32_bf16 v[32:35], v[172:175], v[204:207], v[32:35]
    v_mfma_f32_16x16x32_bf16 v[36:39], v[180:183], v[188:191], v[36:39]
    v_mfma_f32_16x16x32_bf16 v[40:43], v[180:183], v[196:199], v[40:43]
    v_mfma_f32_16x16x32_bf16 v[44:47], v[180:183], v[204:207], v[44:47]
    v_mfma_f32_16x16x32_bf16 v[0:3], v[96:99], v[128:131], v[0:3]
    ds_read_b128 v[152:155], v215 offset:0
    v_mfma_f32_16x16x32_bf16 v[4:7], v[96:99], v[136:139], v[4:7]
    v_mfma_f32_16x16x32_bf16 v[8:11], v[96:99], v[144:147], v[8:11]
    ds_read_b128 v[184:187], v209 offset:0
    v_mfma_f32_16x16x32_bf16 v[12:15], v[104:107], v[128:131], v[12:15]
    v_mfma_f32_16x16x32_bf16 v[16:19], v[104:107], v[136:139], v[16:19]
    ds_read_b128 v[192:195], v209 offset:2048
    v_mfma_f32_16x16x32_bf16 v[20:23], v[104:107], v[144:147], v[20:23]
    v_mfma_f32_16x16x32_bf16 v[24:27], v[112:115], v[128:131], v[24:27]
    ds_read_b128 v[200:203], v209 offset:4096
    v_mfma_f32_16x16x32_bf16 v[28:31], v[112:115], v[136:139], v[28:31]
    v_mfma_f32_16x16x32_bf16 v[32:35], v[112:115], v[144:147], v[32:35]
    ds_read_b128 v[160:163], v215 offset:2048
    v_mfma_f32_16x16x32_bf16 v[36:39], v[120:123], v[128:131], v[36:39]
    v_mfma_f32_16x16x32_bf16 v[40:43], v[120:123], v[136:139], v[40:43]
    ds_read_b128 v[168:171], v215 offset:4096
    v_mfma_f32_16x16x32_bf16 v[44:47], v[120:123], v[144:147], v[44:47]
    v_mfma_f32_16x16x32_bf16 v[48:51], v[96:99], v[132:135], v[48:51]
    ds_read_b128 v[176:179], v215 offset:6144
    v_mfma_f32_16x16x32_bf16 v[52:55], v[96:99], v[140:143], v[52:55]
    v_mfma_f32_16x16x32_bf16 v[56:59], v[96:99], v[148:151], v[56:59]
    ds_read_b128 v[188:191], v212 offset:0
    v_mfma_f32_16x16x32_bf16 v[60:63], v[104:107], v[132:135], v[60:63]
    v_mfma_f32_16x16x32_bf16 v[64:67], v[104:107], v[140:143], v[64:67]
    ds_read_b128 v[196:199], v212 offset:2048
    v_mfma_f32_16x16x32_bf16 v[68:71], v[104:107], v[148:151], v[68:71]
    v_mfma_f32_16x16x32_bf16 v[72:75], v[112:115], v[132:135], v[72:75]
    ds_read_b128 v[204:207], v212 offset:4096
    v_mfma_f32_16x16x32_bf16 v[76:79], v[112:115], v[140:143], v[76:79]
    v_mfma_f32_16x16x32_bf16 v[80:83], v[112:115], v[148:151], v[80:83]
    ds_read_b128 v[156:159], v215 offset:1024
    v_mfma_f32_16x16x32_bf16 v[84:87], v[120:123], v[132:135], v[84:87]
    v_mfma_f32_16x16x32_bf16 v[88:91], v[120:123], v[140:143], v[88:91]
    ds_read_b128 v[164:167], v215 offset:3072
    v_mfma_f32_16x16x32_bf16 v[92:95], v[120:123], v[148:151], v[92:95]
    v_mfma_f32_16x16x32_bf16 v[48:51], v[100:103], v[128:131], v[48:51]
    ds_read_b128 v[172:175], v215 offset:5120
    v_xor_b32 v132, s34, v132
    v_xor_b32 v133, s34, v133
    v_mfma_f32_16x16x32_bf16 v[52:55], v[100:103], v[136:139], v[52:55]
    v_xor_b32 v134, s34, v134
    v_xor_b32 v135, s34, v135
    v_mfma_f32_16x16x32_bf16 v[56:59], v[100:103], v[144:147], v[56:59]
    ds_read_b128 v[180:183], v215 offset:7168
    v_xor_b32 v140, s34, v140
    v_xor_b32 v141, s34, v141
    v_mfma_f32_16x16x32_bf16 v[60:63], v[108:111], v[128:131], v[60:63]
    v_xor_b32 v142, s34, v142
    v_xor_b32 v143, s34, v143
    v_mfma_f32_16x16x32_bf16 v[64:67], v[108:111], v[136:139], v[64:67]
    v_xor_b32 v148, s34, v148
    v_xor_b32 v149, s34, v149
    v_mfma_f32_16x16x32_bf16 v[68:71], v[108:111], v[144:147], v[68:71]
    v_xor_b32 v150, s34, v150
    v_xor_b32 v151, s34, v151
    v_mfma_f32_16x16x32_bf16 v[72:75], v[116:119], v[128:131], v[72:75]
    v_mfma_f32_16x16x32_bf16 v[76:79], v[116:119], v[136:139], v[76:79]
    v_mfma_f32_16x16x32_bf16 v[80:83], v[116:119], v[144:147], v[80:83]
    v_mfma_f32_16x16x32_bf16 v[84:87], v[124:127], v[128:131], v[84:87]
    v_mfma_f32_16x16x32_bf16 v[88:91], v[124:127], v[136:139], v[88:91]
    v_mfma_f32_16x16x32_bf16 v[92:95], v[124:127], v[144:147], v[92:95]
    v_mfma_f32_16x16x32_bf16 v[0:3], v[100:103], v[132:135], v[0:3]
    v_mfma_f32_16x16x32_bf16 v[4:7], v[100:103], v[140:143], v[4:7]
    v_mfma_f32_16x16x32_bf16 v[8:11], v[100:103], v[148:151], v[8:11]
    v_mfma_f32_16x16x32_bf16 v[12:15], v[108:111], v[132:135], v[12:15]
    v_mfma_f32_16x16x32_bf16 v[16:19], v[108:111], v[140:143], v[16:19]
    s_waitcnt lgkmcnt(0)
    s_barrier
    v_mfma_f32_16x16x32_bf16 v[20:23], v[108:111], v[148:151], v[20:23]
    v_mfma_f32_16x16x32_bf16 v[24:27], v[116:119], v[132:135], v[24:27]
    v_mfma_f32_16x16x32_bf16 v[28:31], v[116:119], v[140:143], v[28:31]
    v_mfma_f32_16x16x32_bf16 v[32:35], v[116:119], v[148:151], v[32:35]
    v_mfma_f32_16x16x32_bf16 v[36:39], v[124:127], v[132:135], v[36:39]
    v_mfma_f32_16x16x32_bf16 v[40:43], v[124:127], v[140:143], v[40:43]
    v_mfma_f32_16x16x32_bf16 v[44:47], v[124:127], v[148:151], v[44:47]
    v_mfma_f32_16x16x32_bf16 v[0:3], v[152:155], v[184:187], v[0:3]
    ds_read_b128 v[96:99], v215 offset:28672
    v_mfma_f32_16x16x32_bf16 v[4:7], v[152:155], v[192:195], v[4:7]
    v_mfma_f32_16x16x32_bf16 v[8:11], v[152:155], v[200:203], v[8:11]
    ds_read_b128 v[128:131], v209 offset:28672
    v_mfma_f32_16x16x32_bf16 v[12:15], v[160:163], v[184:187], v[12:15]
    v_mfma_f32_16x16x32_bf16 v[16:19], v[160:163], v[192:195], v[16:19]
    ds_read_b128 v[136:139], v209 offset:30720
    v_mfma_f32_16x16x32_bf16 v[20:23], v[160:163], v[200:203], v[20:23]
    v_mfma_f32_16x16x32_bf16 v[24:27], v[168:171], v[184:187], v[24:27]
    ds_read_b128 v[144:147], v209 offset:32768
    v_mfma_f32_16x16x32_bf16 v[28:31], v[168:171], v[192:195], v[28:31]
    v_mfma_f32_16x16x32_bf16 v[32:35], v[168:171], v[200:203], v[32:35]
    ds_read_b128 v[104:107], v215 offset:30720
    v_mfma_f32_16x16x32_bf16 v[36:39], v[176:179], v[184:187], v[36:39]
    v_mfma_f32_16x16x32_bf16 v[40:43], v[176:179], v[192:195], v[40:43]
    ds_read_b128 v[112:115], v215 offset:32768
    v_mfma_f32_16x16x32_bf16 v[44:47], v[176:179], v[200:203], v[44:47]
    v_mfma_f32_16x16x32_bf16 v[48:51], v[152:155], v[188:191], v[48:51]
    ds_read_b128 v[120:123], v215 offset:34816
    v_mfma_f32_16x16x32_bf16 v[52:55], v[152:155], v[196:199], v[52:55]
    v_mfma_f32_16x16x32_bf16 v[56:59], v[152:155], v[204:207], v[56:59]
    ds_read_b128 v[132:135], v212 offset:28672
    v_mfma_f32_16x16x32_bf16 v[60:63], v[160:163], v[188:191], v[60:63]
    v_mfma_f32_16x16x32_bf16 v[64:67], v[160:163], v[196:199], v[64:67]
    ds_read_b128 v[140:143], v212 offset:30720
    v_mfma_f32_16x16x32_bf16 v[68:71], v[160:163], v[204:207], v[68:71]
    v_mfma_f32_16x16x32_bf16 v[72:75], v[168:171], v[188:191], v[72:75]
    ds_read_b128 v[148:151], v212 offset:32768
    v_mfma_f32_16x16x32_bf16 v[76:79], v[168:171], v[196:199], v[76:79]
    v_mfma_f32_16x16x32_bf16 v[80:83], v[168:171], v[204:207], v[80:83]
    ds_read_b128 v[100:103], v215 offset:29696
    v_mfma_f32_16x16x32_bf16 v[84:87], v[176:179], v[188:191], v[84:87]
    v_mfma_f32_16x16x32_bf16 v[88:91], v[176:179], v[196:199], v[88:91]
    ds_read_b128 v[108:111], v215 offset:31744
    v_mfma_f32_16x16x32_bf16 v[92:95], v[176:179], v[204:207], v[92:95]
    v_mfma_f32_16x16x32_bf16 v[48:51], v[156:159], v[184:187], v[48:51]
    ds_read_b128 v[116:119], v215 offset:33792
    v_xor_b32 v188, s34, v188
    v_xor_b32 v189, s34, v189
    v_mfma_f32_16x16x32_bf16 v[52:55], v[156:159], v[192:195], v[52:55]
    v_xor_b32 v190, s34, v190
    v_xor_b32 v191, s34, v191
    v_mfma_f32_16x16x32_bf16 v[56:59], v[156:159], v[200:203], v[56:59]
    ds_read_b128 v[124:127], v215 offset:35840
    v_xor_b32 v196, s34, v196
    v_xor_b32 v197, s34, v197
    v_mfma_f32_16x16x32_bf16 v[60:63], v[164:167], v[184:187], v[60:63]
    v_xor_b32 v198, s34, v198
    v_xor_b32 v199, s34, v199
    v_mfma_f32_16x16x32_bf16 v[64:67], v[164:167], v[192:195], v[64:67]
    v_xor_b32 v204, s34, v204
    v_xor_b32 v205, s34, v205
    v_mfma_f32_16x16x32_bf16 v[68:71], v[164:167], v[200:203], v[68:71]
    v_xor_b32 v206, s34, v206
    v_xor_b32 v207, s34, v207
    v_mfma_f32_16x16x32_bf16 v[72:75], v[172:175], v[184:187], v[72:75]
    v_mfma_f32_16x16x32_bf16 v[76:79], v[172:175], v[192:195], v[76:79]
    v_mfma_f32_16x16x32_bf16 v[80:83], v[172:175], v[200:203], v[80:83]
    v_mfma_f32_16x16x32_bf16 v[84:87], v[180:183], v[184:187], v[84:87]
    v_mfma_f32_16x16x32_bf16 v[88:91], v[180:183], v[192:195], v[88:91]
    v_mfma_f32_16x16x32_bf16 v[92:95], v[180:183], v[200:203], v[92:95]
    v_mfma_f32_16x16x32_bf16 v[0:3], v[156:159], v[188:191], v[0:3]
    v_mfma_f32_16x16x32_bf16 v[4:7], v[156:159], v[196:199], v[4:7]
    v_mfma_f32_16x16x32_bf16 v[8:11], v[156:159], v[204:207], v[8:11]
    v_mfma_f32_16x16x32_bf16 v[12:15], v[164:167], v[188:191], v[12:15]
    v_mfma_f32_16x16x32_bf16 v[16:19], v[164:167], v[196:199], v[16:19]
    s_waitcnt lgkmcnt(0)
    s_barrier
    v_mfma_f32_16x16x32_bf16 v[20:23], v[164:167], v[204:207], v[20:23]
    v_mfma_f32_16x16x32_bf16 v[24:27], v[172:175], v[188:191], v[24:27]
    v_mfma_f32_16x16x32_bf16 v[28:31], v[172:175], v[196:199], v[28:31]
    v_mfma_f32_16x16x32_bf16 v[32:35], v[172:175], v[204:207], v[32:35]
    v_mfma_f32_16x16x32_bf16 v[36:39], v[180:183], v[188:191], v[36:39]
    v_mfma_f32_16x16x32_bf16 v[40:43], v[180:183], v[196:199], v[40:43]
    v_mfma_f32_16x16x32_bf16 v[44:47], v[180:183], v[204:207], v[44:47]
    v_mfma_f32_16x16x32_bf16 v[0:3], v[96:99], v[128:131], v[0:3]
    ds_read_b128 v[152:155], v216 offset:0
    v_mfma_f32_16x16x32_bf16 v[4:7], v[96:99], v[136:139], v[4:7]
    v_mfma_f32_16x16x32_bf16 v[8:11], v[96:99], v[144:147], v[8:11]
    ds_read_b128 v[184:187], v210 offset:0
    v_mfma_f32_16x16x32_bf16 v[12:15], v[104:107], v[128:131], v[12:15]
    v_mfma_f32_16x16x32_bf16 v[16:19], v[104:107], v[136:139], v[16:19]
    ds_read_b128 v[192:195], v210 offset:2048
    v_mfma_f32_16x16x32_bf16 v[20:23], v[104:107], v[144:147], v[20:23]
    v_mfma_f32_16x16x32_bf16 v[24:27], v[112:115], v[128:131], v[24:27]
    ds_read_b128 v[200:203], v210 offset:4096
    v_mfma_f32_16x16x32_bf16 v[28:31], v[112:115], v[136:139], v[28:31]
    v_mfma_f32_16x16x32_bf16 v[32:35], v[112:115], v[144:147], v[32:35]
    ds_read_b128 v[160:163], v216 offset:2048
    v_mfma_f32_16x16x32_bf16 v[36:39], v[120:123], v[128:131], v[36:39]
    v_mfma_f32_16x16x32_bf16 v[40:43], v[120:123], v[136:139], v[40:43]
    ds_read_b128 v[168:171], v216 offset:4096
    v_mfma_f32_16x16x32_bf16 v[44:47], v[120:123], v[144:147], v[44:47]
    v_mfma_f32_16x16x32_bf16 v[48:51], v[96:99], v[132:135], v[48:51]
    ds_read_b128 v[176:179], v216 offset:6144
    v_mfma_f32_16x16x32_bf16 v[52:55], v[96:99], v[140:143], v[52:55]
    v_mfma_f32_16x16x32_bf16 v[56:59], v[96:99], v[148:151], v[56:59]
    ds_read_b128 v[188:191], v213 offset:0
    v_mfma_f32_16x16x32_bf16 v[60:63], v[104:107], v[132:135], v[60:63]
    v_mfma_f32_16x16x32_bf16 v[64:67], v[104:107], v[140:143], v[64:67]
    ds_read_b128 v[196:199], v213 offset:2048
    v_mfma_f32_16x16x32_bf16 v[68:71], v[104:107], v[148:151], v[68:71]
    v_mfma_f32_16x16x32_bf16 v[72:75], v[112:115], v[132:135], v[72:75]
    ds_read_b128 v[204:207], v213 offset:4096
    v_mfma_f32_16x16x32_bf16 v[76:79], v[112:115], v[140:143], v[76:79]
    v_mfma_f32_16x16x32_bf16 v[80:83], v[112:115], v[148:151], v[80:83]
    ds_read_b128 v[156:159], v216 offset:1024
    v_mfma_f32_16x16x32_bf16 v[84:87], v[120:123], v[132:135], v[84:87]
    v_mfma_f32_16x16x32_bf16 v[88:91], v[120:123], v[140:143], v[88:91]
    ds_read_b128 v[164:167], v216 offset:3072
    v_mfma_f32_16x16x32_bf16 v[92:95], v[120:123], v[148:151], v[92:95]
    v_mfma_f32_16x16x32_bf16 v[48:51], v[100:103], v[128:131], v[48:51]
    ds_read_b128 v[172:175], v216 offset:5120
    v_xor_b32 v132, s34, v132
    v_xor_b32 v133, s34, v133
    v_mfma_f32_16x16x32_bf16 v[52:55], v[100:103], v[136:139], v[52:55]
    v_xor_b32 v134, s34, v134
    v_xor_b32 v135, s34, v135
    v_mfma_f32_16x16x32_bf16 v[56:59], v[100:103], v[144:147], v[56:59]
    ds_read_b128 v[180:183], v216 offset:7168
    v_xor_b32 v140, s34, v140
    v_xor_b32 v141, s34, v141
    v_mfma_f32_16x16x32_bf16 v[60:63], v[108:111], v[128:131], v[60:63]
    v_xor_b32 v142, s34, v142
    v_xor_b32 v143, s34, v143
    v_mfma_f32_16x16x32_bf16 v[64:67], v[108:111], v[136:139], v[64:67]
    v_xor_b32 v148, s34, v148
    v_xor_b32 v149, s34, v149
    v_mfma_f32_16x16x32_bf16 v[68:71], v[108:111], v[144:147], v[68:71]
    v_xor_b32 v150, s34, v150
    v_xor_b32 v151, s34, v151
    v_mfma_f32_16x16x32_bf16 v[72:75], v[116:119], v[128:131], v[72:75]
    v_mfma_f32_16x16x32_bf16 v[76:79], v[116:119], v[136:139], v[76:79]
    v_mfma_f32_16x16x32_bf16 v[80:83], v[116:119], v[144:147], v[80:83]
    v_mfma_f32_16x16x32_bf16 v[84:87], v[124:127], v[128:131], v[84:87]
    v_mfma_f32_16x16x32_bf16 v[88:91], v[124:127], v[136:139], v[88:91]
    v_mfma_f32_16x16x32_bf16 v[92:95], v[124:127], v[144:147], v[92:95]
    v_mfma_f32_16x16x32_bf16 v[0:3], v[100:103], v[132:135], v[0:3]
    v_mfma_f32_16x16x32_bf16 v[4:7], v[100:103], v[140:143], v[4:7]
    v_mfma_f32_16x16x32_bf16 v[8:11], v[100:103], v[148:151], v[8:11]
    v_mfma_f32_16x16x32_bf16 v[12:15], v[108:111], v[132:135], v[12:15]
    v_mfma_f32_16x16x32_bf16 v[16:19], v[108:111], v[140:143], v[16:19]
    s_waitcnt lgkmcnt(0)
    s_barrier
    v_mfma_f32_16x16x32_bf16 v[20:23], v[108:111], v[148:151], v[20:23]
    v_mfma_f32_16x16x32_bf16 v[24:27], v[116:119], v[132:135], v[24:27]
    v_mfma_f32_16x16x32_bf16 v[28:31], v[116:119], v[140:143], v[28:31]
    v_mfma_f32_16x16x32_bf16 v[32:35], v[116:119], v[148:151], v[32:35]
    v_mfma_f32_16x16x32_bf16 v[36:39], v[124:127], v[132:135], v[36:39]
    v_mfma_f32_16x16x32_bf16 v[40:43], v[124:127], v[140:143], v[40:43]
    v_mfma_f32_16x16x32_bf16 v[44:47], v[124:127], v[148:151], v[44:47]
    v_mfma_f32_16x16x32_bf16 v[0:3], v[152:155], v[184:187], v[0:3]
    ds_read_b128 v[96:99], v214 offset:0
    v_mfma_f32_16x16x32_bf16 v[4:7], v[152:155], v[192:195], v[4:7]
    v_mfma_f32_16x16x32_bf16 v[8:11], v[152:155], v[200:203], v[8:11]
    ds_read_b128 v[128:131], v208 offset:0
    v_mfma_f32_16x16x32_bf16 v[12:15], v[160:163], v[184:187], v[12:15]
    v_mfma_f32_16x16x32_bf16 v[16:19], v[160:163], v[192:195], v[16:19]
    ds_read_b128 v[136:139], v208 offset:2048
    v_mfma_f32_16x16x32_bf16 v[20:23], v[160:163], v[200:203], v[20:23]
    v_mfma_f32_16x16x32_bf16 v[24:27], v[168:171], v[184:187], v[24:27]
    ds_read_b128 v[144:147], v208 offset:4096
    v_mfma_f32_16x16x32_bf16 v[28:31], v[168:171], v[192:195], v[28:31]
    v_mfma_f32_16x16x32_bf16 v[32:35], v[168:171], v[200:203], v[32:35]
    ds_read_b128 v[104:107], v214 offset:2048
    v_mfma_f32_16x16x32_bf16 v[36:39], v[176:179], v[184:187], v[36:39]
    v_mfma_f32_16x16x32_bf16 v[40:43], v[176:179], v[192:195], v[40:43]
    ds_read_b128 v[112:115], v214 offset:4096
    v_mfma_f32_16x16x32_bf16 v[44:47], v[176:179], v[200:203], v[44:47]
    v_mfma_f32_16x16x32_bf16 v[48:51], v[152:155], v[188:191], v[48:51]
    ds_read_b128 v[120:123], v214 offset:6144
    v_mfma_f32_16x16x32_bf16 v[52:55], v[152:155], v[196:199], v[52:55]
    v_mfma_f32_16x16x32_bf16 v[56:59], v[152:155], v[204:207], v[56:59]
    ds_read_b128 v[132:135], v211 offset:0
    v_mfma_f32_16x16x32_bf16 v[60:63], v[160:163], v[188:191], v[60:63]
    v_mfma_f32_16x16x32_bf16 v[64:67], v[160:163], v[196:199], v[64:67]
    ds_read_b128 v[140:143], v211 offset:2048
    v_mfma_f32_16x16x32_bf16 v[68:71], v[160:163], v[204:207], v[68:71]
    v_mfma_f32_16x16x32_bf16 v[72:75], v[168:171], v[188:191], v[72:75]
    ds_read_b128 v[148:151], v211 offset:4096
    v_mfma_f32_16x16x32_bf16 v[76:79], v[168:171], v[196:199], v[76:79]
    v_mfma_f32_16x16x32_bf16 v[80:83], v[168:171], v[204:207], v[80:83]
    ds_read_b128 v[100:103], v214 offset:1024
    v_mfma_f32_16x16x32_bf16 v[84:87], v[176:179], v[188:191], v[84:87]
    v_mfma_f32_16x16x32_bf16 v[88:91], v[176:179], v[196:199], v[88:91]
    ds_read_b128 v[108:111], v214 offset:3072
    v_mfma_f32_16x16x32_bf16 v[92:95], v[176:179], v[204:207], v[92:95]
    v_mfma_f32_16x16x32_bf16 v[48:51], v[156:159], v[184:187], v[48:51]
    ds_read_b128 v[116:119], v214 offset:5120
    v_xor_b32 v188, s34, v188
    v_xor_b32 v189, s34, v189
    v_mfma_f32_16x16x32_bf16 v[52:55], v[156:159], v[192:195], v[52:55]
    v_xor_b32 v190, s34, v190
    v_xor_b32 v191, s34, v191
    v_mfma_f32_16x16x32_bf16 v[56:59], v[156:159], v[200:203], v[56:59]
    ds_read_b128 v[124:127], v214 offset:7168
    v_xor_b32 v196, s34, v196
    v_xor_b32 v197, s34, v197
    v_mfma_f32_16x16x32_bf16 v[60:63], v[164:167], v[184:187], v[60:63]
    v_xor_b32 v198, s34, v198
    v_xor_b32 v199, s34, v199
    v_mfma_f32_16x16x32_bf16 v[64:67], v[164:167], v[192:195], v[64:67]
    v_xor_b32 v204, s34, v204
    v_xor_b32 v205, s34, v205
    v_mfma_f32_16x16x32_bf16 v[68:71], v[164:167], v[200:203], v[68:71]
    v_xor_b32 v206, s34, v206
    v_xor_b32 v207, s34, v207
    v_mfma_f32_16x16x32_bf16 v[72:75], v[172:175], v[184:187], v[72:75]
    v_mfma_f32_16x16x32_bf16 v[76:79], v[172:175], v[192:195], v[76:79]
    v_mfma_f32_16x16x32_bf16 v[80:83], v[172:175], v[200:203], v[80:83]
    v_mfma_f32_16x16x32_bf16 v[84:87], v[180:183], v[184:187], v[84:87]
    v_mfma_f32_16x16x32_bf16 v[88:91], v[180:183], v[192:195], v[88:91]
    v_mfma_f32_16x16x32_bf16 v[92:95], v[180:183], v[200:203], v[92:95]
    v_mfma_f32_16x16x32_bf16 v[0:3], v[156:159], v[188:191], v[0:3]
    v_mfma_f32_16x16x32_bf16 v[4:7], v[156:159], v[196:199], v[4:7]
    v_mfma_f32_16x16x32_bf16 v[8:11], v[156:159], v[204:207], v[8:11]
    v_mfma_f32_16x16x32_bf16 v[12:15], v[164:167], v[188:191], v[12:15]
    v_mfma_f32_16x16x32_bf16 v[16:19], v[164:167], v[196:199], v[16:19]
    s_waitcnt lgkmcnt(0)
    s_barrier
    v_mfma_f32_16x16x32_bf16 v[20:23], v[164:167], v[204:207], v[20:23]
    v_mfma_f32_16x16x32_bf16 v[24:27], v[172:175], v[188:191], v[24:27]
    v_mfma_f32_16x16x32_bf16 v[28:31], v[172:175], v[196:199], v[28:31]
    v_mfma_f32_16x16x32_bf16 v[32:35], v[172:175], v[204:207], v[32:35]
    v_mfma_f32_16x16x32_bf16 v[36:39], v[180:183], v[188:191], v[36:39]
    v_mfma_f32_16x16x32_bf16 v[40:43], v[180:183], v[196:199], v[40:43]
    v_mfma_f32_16x16x32_bf16 v[44:47], v[180:183], v[204:207], v[44:47]
    v_mfma_f32_16x16x32_bf16 v[0:3], v[96:99], v[128:131], v[0:3]
    ds_read_b128 v[152:155], v214 offset:28672
    v_mfma_f32_16x16x32_bf16 v[4:7], v[96:99], v[136:139], v[4:7]
    v_mfma_f32_16x16x32_bf16 v[8:11], v[96:99], v[144:147], v[8:11]
    ds_read_b128 v[184:187], v208 offset:28672
    v_mfma_f32_16x16x32_bf16 v[12:15], v[104:107], v[128:131], v[12:15]
    v_mfma_f32_16x16x32_bf16 v[16:19], v[104:107], v[136:139], v[16:19]
    ds_read_b128 v[192:195], v208 offset:30720
    v_mfma_f32_16x16x32_bf16 v[20:23], v[104:107], v[144:147], v[20:23]
    v_mfma_f32_16x16x32_bf16 v[24:27], v[112:115], v[128:131], v[24:27]
    ds_read_b128 v[200:203], v208 offset:32768
    v_mfma_f32_16x16x32_bf16 v[28:31], v[112:115], v[136:139], v[28:31]
    v_mfma_f32_16x16x32_bf16 v[32:35], v[112:115], v[144:147], v[32:35]
    ds_read_b128 v[160:163], v214 offset:30720
    v_mfma_f32_16x16x32_bf16 v[36:39], v[120:123], v[128:131], v[36:39]
    v_mfma_f32_16x16x32_bf16 v[40:43], v[120:123], v[136:139], v[40:43]
    ds_read_b128 v[168:171], v214 offset:32768
    v_mfma_f32_16x16x32_bf16 v[44:47], v[120:123], v[144:147], v[44:47]
    v_mfma_f32_16x16x32_bf16 v[48:51], v[96:99], v[132:135], v[48:51]
    ds_read_b128 v[176:179], v214 offset:34816
    v_mfma_f32_16x16x32_bf16 v[52:55], v[96:99], v[140:143], v[52:55]
    v_mfma_f32_16x16x32_bf16 v[56:59], v[96:99], v[148:151], v[56:59]
    ds_read_b128 v[188:191], v211 offset:28672
    v_mfma_f32_16x16x32_bf16 v[60:63], v[104:107], v[132:135], v[60:63]
    v_mfma_f32_16x16x32_bf16 v[64:67], v[104:107], v[140:143], v[64:67]
    ds_read_b128 v[196:199], v211 offset:30720
    v_mfma_f32_16x16x32_bf16 v[68:71], v[104:107], v[148:151], v[68:71]
    v_mfma_f32_16x16x32_bf16 v[72:75], v[112:115], v[132:135], v[72:75]
    ds_read_b128 v[204:207], v211 offset:32768
    v_mfma_f32_16x16x32_bf16 v[76:79], v[112:115], v[140:143], v[76:79]
    v_mfma_f32_16x16x32_bf16 v[80:83], v[112:115], v[148:151], v[80:83]
    ds_read_b128 v[156:159], v214 offset:29696
    v_mfma_f32_16x16x32_bf16 v[84:87], v[120:123], v[132:135], v[84:87]
    v_mfma_f32_16x16x32_bf16 v[88:91], v[120:123], v[140:143], v[88:91]
    ds_read_b128 v[164:167], v214 offset:31744
    v_mfma_f32_16x16x32_bf16 v[92:95], v[120:123], v[148:151], v[92:95]
    v_mfma_f32_16x16x32_bf16 v[48:51], v[100:103], v[128:131], v[48:51]
    ds_read_b128 v[172:175], v214 offset:33792
    v_xor_b32 v132, s34, v132
    v_xor_b32 v133, s34, v133
    v_mfma_f32_16x16x32_bf16 v[52:55], v[100:103], v[136:139], v[52:55]
    v_xor_b32 v134, s34, v134
    v_xor_b32 v135, s34, v135
    v_mfma_f32_16x16x32_bf16 v[56:59], v[100:103], v[144:147], v[56:59]
    ds_read_b128 v[180:183], v214 offset:35840
    v_xor_b32 v140, s34, v140
    v_xor_b32 v141, s34, v141
    v_mfma_f32_16x16x32_bf16 v[60:63], v[108:111], v[128:131], v[60:63]
    v_xor_b32 v142, s34, v142
    v_xor_b32 v143, s34, v143
    v_mfma_f32_16x16x32_bf16 v[64:67], v[108:111], v[136:139], v[64:67]
    v_xor_b32 v148, s34, v148
    v_xor_b32 v149, s34, v149
    v_mfma_f32_16x16x32_bf16 v[68:71], v[108:111], v[144:147], v[68:71]
    v_xor_b32 v150, s34, v150
    v_xor_b32 v151, s34, v151
    v_mfma_f32_16x16x32_bf16 v[72:75], v[116:119], v[128:131], v[72:75]
    v_mfma_f32_16x16x32_bf16 v[76:79], v[116:119], v[136:139], v[76:79]
    v_mfma_f32_16x16x32_bf16 v[80:83], v[116:119], v[144:147], v[80:83]
    v_mfma_f32_16x16x32_bf16 v[84:87], v[124:127], v[128:131], v[84:87]
    v_mfma_f32_16x16x32_bf16 v[88:91], v[124:127], v[136:139], v[88:91]
    v_mfma_f32_16x16x32_bf16 v[92:95], v[124:127], v[144:147], v[92:95]
    v_mfma_f32_16x16x32_bf16 v[0:3], v[100:103], v[132:135], v[0:3]
    v_mfma_f32_16x16x32_bf16 v[4:7], v[100:103], v[140:143], v[4:7]
    v_mfma_f32_16x16x32_bf16 v[8:11], v[100:103], v[148:151], v[8:11]
    v_mfma_f32_16x16x32_bf16 v[12:15], v[108:111], v[132:135], v[12:15]
    v_mfma_f32_16x16x32_bf16 v[16:19], v[108:111], v[140:143], v[16:19]
    s_waitcnt lgkmcnt(0)
    s_barrier
    v_mfma_f32_16x16x32_bf16 v[20:23], v[108:111], v[148:151], v[20:23]
    v_mfma_f32_16x16x32_bf16 v[24:27], v[116:119], v[132:135], v[24:27]
    v_mfma_f32_16x16x32_bf16 v[28:31], v[116:119], v[140:143], v[28:31]
    v_mfma_f32_16x16x32_bf16 v[32:35], v[116:119], v[148:151], v[32:35]
    v_mfma_f32_16x16x32_bf16 v[36:39], v[124:127], v[132:135], v[36:39]
    v_mfma_f32_16x16x32_bf16 v[40:43], v[124:127], v[140:143], v[40:43]
    v_mfma_f32_16x16x32_bf16 v[44:47], v[124:127], v[148:151], v[44:47]
    v_mfma_f32_16x16x32_bf16 v[0:3], v[152:155], v[184:187], v[0:3]
    ds_read_b128 v[96:99], v215 offset:0
    v_mfma_f32_16x16x32_bf16 v[4:7], v[152:155], v[192:195], v[4:7]
    v_mfma_f32_16x16x32_bf16 v[8:11], v[152:155], v[200:203], v[8:11]
    ds_read_b128 v[128:131], v209 offset:0
    v_mfma_f32_16x16x32_bf16 v[12:15], v[160:163], v[184:187], v[12:15]
    v_mfma_f32_16x16x32_bf16 v[16:19], v[160:163], v[192:195], v[16:19]
    ds_read_b128 v[136:139], v209 offset:2048
    v_mfma_f32_16x16x32_bf16 v[20:23], v[160:163], v[200:203], v[20:23]
    v_mfma_f32_16x16x32_bf16 v[24:27], v[168:171], v[184:187], v[24:27]
    ds_read_b128 v[144:147], v209 offset:4096
    v_mfma_f32_16x16x32_bf16 v[28:31], v[168:171], v[192:195], v[28:31]
    v_mfma_f32_16x16x32_bf16 v[32:35], v[168:171], v[200:203], v[32:35]
    ds_read_b128 v[104:107], v215 offset:2048
    v_mfma_f32_16x16x32_bf16 v[36:39], v[176:179], v[184:187], v[36:39]
    v_mfma_f32_16x16x32_bf16 v[40:43], v[176:179], v[192:195], v[40:43]
    ds_read_b128 v[112:115], v215 offset:4096
    v_mfma_f32_16x16x32_bf16 v[44:47], v[176:179], v[200:203], v[44:47]
    v_mfma_f32_16x16x32_bf16 v[48:51], v[152:155], v[188:191], v[48:51]
    ds_read_b128 v[120:123], v215 offset:6144
    v_mfma_f32_16x16x32_bf16 v[52:55], v[152:155], v[196:199], v[52:55]
    v_mfma_f32_16x16x32_bf16 v[56:59], v[152:155], v[204:207], v[56:59]
    ds_read_b128 v[132:135], v212 offset:0
    v_mfma_f32_16x16x32_bf16 v[60:63], v[160:163], v[188:191], v[60:63]
    v_mfma_f32_16x16x32_bf16 v[64:67], v[160:163], v[196:199], v[64:67]
    ds_read_b128 v[140:143], v212 offset:2048
    v_mfma_f32_16x16x32_bf16 v[68:71], v[160:163], v[204:207], v[68:71]
    v_mfma_f32_16x16x32_bf16 v[72:75], v[168:171], v[188:191], v[72:75]
    ds_read_b128 v[148:151], v212 offset:4096
    v_mfma_f32_16x16x32_bf16 v[76:79], v[168:171], v[196:199], v[76:79]
    v_mfma_f32_16x16x32_bf16 v[80:83], v[168:171], v[204:207], v[80:83]
    ds_read_b128 v[100:103], v215 offset:1024
    v_mfma_f32_16x16x32_bf16 v[84:87], v[176:179], v[188:191], v[84:87]
    v_mfma_f32_16x16x32_bf16 v[88:91], v[176:179], v[196:199], v[88:91]
    ds_read_b128 v[108:111], v215 offset:3072
    v_mfma_f32_16x16x32_bf16 v[92:95], v[176:179], v[204:207], v[92:95]
    v_mfma_f32_16x16x32_bf16 v[48:51], v[156:159], v[184:187], v[48:51]
    ds_read_b128 v[116:119], v215 offset:5120
    v_xor_b32 v188, s34, v188
    v_xor_b32 v189, s34, v189
    v_mfma_f32_16x16x32_bf16 v[52:55], v[156:159], v[192:195], v[52:55]
    v_xor_b32 v190, s34, v190
    v_xor_b32 v191, s34, v191
    v_mfma_f32_16x16x32_bf16 v[56:59], v[156:159], v[200:203], v[56:59]
    ds_read_b128 v[124:127], v215 offset:7168
    v_xor_b32 v196, s34, v196
    v_xor_b32 v197, s34, v197
    v_mfma_f32_16x16x32_bf16 v[60:63], v[164:167], v[184:187], v[60:63]
    v_xor_b32 v198, s34, v198
    v_xor_b32 v199, s34, v199
    v_mfma_f32_16x16x32_bf16 v[64:67], v[164:167], v[192:195], v[64:67]
    v_xor_b32 v204, s34, v204
    v_xor_b32 v205, s34, v205
    v_mfma_f32_16x16x32_bf16 v[68:71], v[164:167], v[200:203], v[68:71]
    v_xor_b32 v206, s34, v206
    v_xor_b32 v207, s34, v207
    v_mfma_f32_16x16x32_bf16 v[72:75], v[172:175], v[184:187], v[72:75]
    v_mfma_f32_16x16x32_bf16 v[76:79], v[172:175], v[192:195], v[76:79]
    v_mfma_f32_16x16x32_bf16 v[80:83], v[172:175], v[200:203], v[80:83]
    v_mfma_f32_16x16x32_bf16 v[84:87], v[180:183], v[184:187], v[84:87]
    v_mfma_f32_16x16x32_bf16 v[88:91], v[180:183], v[192:195], v[88:91]
    v_mfma_f32_16x16x32_bf16 v[92:95], v[180:183], v[200:203], v[92:95]
    v_mfma_f32_16x16x32_bf16 v[0:3], v[156:159], v[188:191], v[0:3]
    v_mfma_f32_16x16x32_bf16 v[4:7], v[156:159], v[196:199], v[4:7]
    v_mfma_f32_16x16x32_bf16 v[8:11], v[156:159], v[204:207], v[8:11]
    v_mfma_f32_16x16x32_bf16 v[12:15], v[164:167], v[188:191], v[12:15]
    v_mfma_f32_16x16x32_bf16 v[16:19], v[164:167], v[196:199], v[16:19]
    s_waitcnt lgkmcnt(0)
    s_barrier
    v_mfma_f32_16x16x32_bf16 v[20:23], v[164:167], v[204:207], v[20:23]
    v_mfma_f32_16x16x32_bf16 v[24:27], v[172:175], v[188:191], v[24:27]
    v_mfma_f32_16x16x32_bf16 v[28:31], v[172:175], v[196:199], v[28:31]
    v_mfma_f32_16x16x32_bf16 v[32:35], v[172:175], v[204:207], v[32:35]
    v_mfma_f32_16x16x32_bf16 v[36:39], v[180:183], v[188:191], v[36:39]
    v_mfma_f32_16x16x32_bf16 v[40:43], v[180:183], v[196:199], v[40:43]
    v_mfma_f32_16x16x32_bf16 v[44:47], v[180:183], v[204:207], v[44:47]
    v_mfma_f32_16x16x32_bf16 v[0:3], v[96:99], v[128:131], v[0:3]
    ds_read_b128 v[152:155], v215 offset:28672
    v_mfma_f32_16x16x32_bf16 v[4:7], v[96:99], v[136:139], v[4:7]
    v_mfma_f32_16x16x32_bf16 v[8:11], v[96:99], v[144:147], v[8:11]
    ds_read_b128 v[184:187], v209 offset:28672
    v_mfma_f32_16x16x32_bf16 v[12:15], v[104:107], v[128:131], v[12:15]
    v_mfma_f32_16x16x32_bf16 v[16:19], v[104:107], v[136:139], v[16:19]
    ds_read_b128 v[192:195], v209 offset:30720
    v_mfma_f32_16x16x32_bf16 v[20:23], v[104:107], v[144:147], v[20:23]
    v_mfma_f32_16x16x32_bf16 v[24:27], v[112:115], v[128:131], v[24:27]
    ds_read_b128 v[200:203], v209 offset:32768
    v_mfma_f32_16x16x32_bf16 v[28:31], v[112:115], v[136:139], v[28:31]
    v_mfma_f32_16x16x32_bf16 v[32:35], v[112:115], v[144:147], v[32:35]
    ds_read_b128 v[160:163], v215 offset:30720
    v_mfma_f32_16x16x32_bf16 v[36:39], v[120:123], v[128:131], v[36:39]
    v_mfma_f32_16x16x32_bf16 v[40:43], v[120:123], v[136:139], v[40:43]
    ds_read_b128 v[168:171], v215 offset:32768
    v_mfma_f32_16x16x32_bf16 v[44:47], v[120:123], v[144:147], v[44:47]
    v_mfma_f32_16x16x32_bf16 v[48:51], v[96:99], v[132:135], v[48:51]
    ds_read_b128 v[176:179], v215 offset:34816
    v_mfma_f32_16x16x32_bf16 v[52:55], v[96:99], v[140:143], v[52:55]
    v_mfma_f32_16x16x32_bf16 v[56:59], v[96:99], v[148:151], v[56:59]
    ds_read_b128 v[188:191], v212 offset:28672
    v_mfma_f32_16x16x32_bf16 v[60:63], v[104:107], v[132:135], v[60:63]
    v_mfma_f32_16x16x32_bf16 v[64:67], v[104:107], v[140:143], v[64:67]
    ds_read_b128 v[196:199], v212 offset:30720
    v_mfma_f32_16x16x32_bf16 v[68:71], v[104:107], v[148:151], v[68:71]
    v_mfma_f32_16x16x32_bf16 v[72:75], v[112:115], v[132:135], v[72:75]
    ds_read_b128 v[204:207], v212 offset:32768
    v_mfma_f32_16x16x32_bf16 v[76:79], v[112:115], v[140:143], v[76:79]
    v_mfma_f32_16x16x32_bf16 v[80:83], v[112:115], v[148:151], v[80:83]
    ds_read_b128 v[156:159], v215 offset:29696
    v_mfma_f32_16x16x32_bf16 v[84:87], v[120:123], v[132:135], v[84:87]
    v_mfma_f32_16x16x32_bf16 v[88:91], v[120:123], v[140:143], v[88:91]
    ds_read_b128 v[164:167], v215 offset:31744
    v_mfma_f32_16x16x32_bf16 v[92:95], v[120:123], v[148:151], v[92:95]
    v_mfma_f32_16x16x32_bf16 v[48:51], v[100:103], v[128:131], v[48:51]
    ds_read_b128 v[172:175], v215 offset:33792
    v_xor_b32 v132, s34, v132
    v_xor_b32 v133, s34, v133
    v_mfma_f32_16x16x32_bf16 v[52:55], v[100:103], v[136:139], v[52:55]
    v_xor_b32 v134, s34, v134
    v_xor_b32 v135, s34, v135
    v_mfma_f32_16x16x32_bf16 v[56:59], v[100:103], v[144:147], v[56:59]
    ds_read_b128 v[180:183], v215 offset:35840
    v_xor_b32 v140, s34, v140
    v_xor_b32 v141, s34, v141
    v_mfma_f32_16x16x32_bf16 v[60:63], v[108:111], v[128:131], v[60:63]
    v_xor_b32 v142, s34, v142
    v_xor_b32 v143, s34, v143
    v_mfma_f32_16x16x32_bf16 v[64:67], v[108:111], v[136:139], v[64:67]
    v_xor_b32 v148, s34, v148
    v_xor_b32 v149, s34, v149
    v_mfma_f32_16x16x32_bf16 v[68:71], v[108:111], v[144:147], v[68:71]
    v_xor_b32 v150, s34, v150
    v_xor_b32 v151, s34, v151
    v_mfma_f32_16x16x32_bf16 v[72:75], v[116:119], v[128:131], v[72:75]
    v_mfma_f32_16x16x32_bf16 v[76:79], v[116:119], v[136:139], v[76:79]
    v_mfma_f32_16x16x32_bf16 v[80:83], v[116:119], v[144:147], v[80:83]
    v_mfma_f32_16x16x32_bf16 v[84:87], v[124:127], v[128:131], v[84:87]
    v_mfma_f32_16x16x32_bf16 v[88:91], v[124:127], v[136:139], v[88:91]
    v_mfma_f32_16x16x32_bf16 v[92:95], v[124:127], v[144:147], v[92:95]
    v_mfma_f32_16x16x32_bf16 v[0:3], v[100:103], v[132:135], v[0:3]
    v_mfma_f32_16x16x32_bf16 v[4:7], v[100:103], v[140:143], v[4:7]
    v_mfma_f32_16x16x32_bf16 v[8:11], v[100:103], v[148:151], v[8:11]
    v_mfma_f32_16x16x32_bf16 v[12:15], v[108:111], v[132:135], v[12:15]
    v_mfma_f32_16x16x32_bf16 v[16:19], v[108:111], v[140:143], v[16:19]
    s_waitcnt lgkmcnt(0)
    s_barrier
    v_mfma_f32_16x16x32_bf16 v[20:23], v[108:111], v[148:151], v[20:23]
    v_mfma_f32_16x16x32_bf16 v[24:27], v[116:119], v[132:135], v[24:27]
    v_mfma_f32_16x16x32_bf16 v[28:31], v[116:119], v[140:143], v[28:31]
    v_mfma_f32_16x16x32_bf16 v[32:35], v[116:119], v[148:151], v[32:35]
    v_mfma_f32_16x16x32_bf16 v[36:39], v[124:127], v[132:135], v[36:39]
    v_mfma_f32_16x16x32_bf16 v[40:43], v[124:127], v[140:143], v[40:43]
    v_mfma_f32_16x16x32_bf16 v[44:47], v[124:127], v[148:151], v[44:47]
    v_mfma_f32_16x16x32_bf16 v[0:3], v[152:155], v[184:187], v[0:3]
    ds_read_b128 v[96:99], v216 offset:0
    v_mfma_f32_16x16x32_bf16 v[4:7], v[152:155], v[192:195], v[4:7]
    v_mfma_f32_16x16x32_bf16 v[8:11], v[152:155], v[200:203], v[8:11]
    ds_read_b128 v[128:131], v210 offset:0
    v_mfma_f32_16x16x32_bf16 v[12:15], v[160:163], v[184:187], v[12:15]
    v_mfma_f32_16x16x32_bf16 v[16:19], v[160:163], v[192:195], v[16:19]
    ds_read_b128 v[136:139], v210 offset:2048
    v_mfma_f32_16x16x32_bf16 v[20:23], v[160:163], v[200:203], v[20:23]
    v_mfma_f32_16x16x32_bf16 v[24:27], v[168:171], v[184:187], v[24:27]
    ds_read_b128 v[144:147], v210 offset:4096
    v_mfma_f32_16x16x32_bf16 v[28:31], v[168:171], v[192:195], v[28:31]
    v_mfma_f32_16x16x32_bf16 v[32:35], v[168:171], v[200:203], v[32:35]
    ds_read_b128 v[104:107], v216 offset:2048
    v_mfma_f32_16x16x32_bf16 v[36:39], v[176:179], v[184:187], v[36:39]
    v_mfma_f32_16x16x32_bf16 v[40:43], v[176:179], v[192:195], v[40:43]
    ds_read_b128 v[112:115], v216 offset:4096
    v_mfma_f32_16x16x32_bf16 v[44:47], v[176:179], v[200:203], v[44:47]
    v_mfma_f32_16x16x32_bf16 v[48:51], v[152:155], v[188:191], v[48:51]
    ds_read_b128 v[120:123], v216 offset:6144
    v_mfma_f32_16x16x32_bf16 v[52:55], v[152:155], v[196:199], v[52:55]
    v_mfma_f32_16x16x32_bf16 v[56:59], v[152:155], v[204:207], v[56:59]
    ds_read_b128 v[132:135], v213 offset:0
    v_mfma_f32_16x16x32_bf16 v[60:63], v[160:163], v[188:191], v[60:63]
    v_mfma_f32_16x16x32_bf16 v[64:67], v[160:163], v[196:199], v[64:67]
    ds_read_b128 v[140:143], v213 offset:2048
    v_mfma_f32_16x16x32_bf16 v[68:71], v[160:163], v[204:207], v[68:71]
    v_mfma_f32_16x16x32_bf16 v[72:75], v[168:171], v[188:191], v[72:75]
    ds_read_b128 v[148:151], v213 offset:4096
    v_mfma_f32_16x16x32_bf16 v[76:79], v[168:171], v[196:199], v[76:79]
    v_mfma_f32_16x16x32_bf16 v[80:83], v[168:171], v[204:207], v[80:83]
    ds_read_b128 v[100:103], v216 offset:1024
    v_mfma_f32_16x16x32_bf16 v[84:87], v[176:179], v[188:191], v[84:87]
    v_mfma_f32_16x16x32_bf16 v[88:91], v[176:179], v[196:199], v[88:91]
    ds_read_b128 v[108:111], v216 offset:3072
    v_mfma_f32_16x16x32_bf16 v[92:95], v[176:179], v[204:207], v[92:95]
    v_mfma_f32_16x16x32_bf16 v[48:51], v[156:159], v[184:187], v[48:51]
    ds_read_b128 v[116:119], v216 offset:5120
    v_xor_b32 v188, s34, v188
    v_xor_b32 v189, s34, v189
    v_mfma_f32_16x16x32_bf16 v[52:55], v[156:159], v[192:195], v[52:55]
    v_xor_b32 v190, s34, v190
    v_xor_b32 v191, s34, v191
    v_mfma_f32_16x16x32_bf16 v[56:59], v[156:159], v[200:203], v[56:59]
    ds_read_b128 v[124:127], v216 offset:7168
    v_xor_b32 v196, s34, v196
    v_xor_b32 v197, s34, v197
    v_mfma_f32_16x16x32_bf16 v[60:63], v[164:167], v[184:187], v[60:63]
    v_xor_b32 v198, s34, v198
    v_xor_b32 v199, s34, v199
    v_mfma_f32_16x16x32_bf16 v[64:67], v[164:167], v[192:195], v[64:67]
    v_xor_b32 v204, s34, v204
    v_xor_b32 v205, s34, v205
    v_mfma_f32_16x16x32_bf16 v[68:71], v[164:167], v[200:203], v[68:71]
    v_xor_b32 v206, s34, v206
    v_xor_b32 v207, s34, v207
    v_mfma_f32_16x16x32_bf16 v[72:75], v[172:175], v[184:187], v[72:75]
    v_mfma_f32_16x16x32_bf16 v[76:79], v[172:175], v[192:195], v[76:79]
    v_mfma_f32_16x16x32_bf16 v[80:83], v[172:175], v[200:203], v[80:83]
    v_mfma_f32_16x16x32_bf16 v[84:87], v[180:183], v[184:187], v[84:87]
    v_mfma_f32_16x16x32_bf16 v[88:91], v[180:183], v[192:195], v[88:91]
    v_mfma_f32_16x16x32_bf16 v[92:95], v[180:183], v[200:203], v[92:95]
    v_mfma_f32_16x16x32_bf16 v[0:3], v[156:159], v[188:191], v[0:3]
    v_mfma_f32_16x16x32_bf16 v[4:7], v[156:159], v[196:199], v[4:7]
    v_mfma_f32_16x16x32_bf16 v[8:11], v[156:159], v[204:207], v[8:11]
    v_mfma_f32_16x16x32_bf16 v[12:15], v[164:167], v[188:191], v[12:15]
    v_mfma_f32_16x16x32_bf16 v[16:19], v[164:167], v[196:199], v[16:19]
    s_waitcnt lgkmcnt(0)
    s_barrier
    v_mfma_f32_16x16x32_bf16 v[20:23], v[164:167], v[204:207], v[20:23]
    v_mfma_f32_16x16x32_bf16 v[24:27], v[172:175], v[188:191], v[24:27]
    v_mfma_f32_16x16x32_bf16 v[28:31], v[172:175], v[196:199], v[28:31]
    v_mfma_f32_16x16x32_bf16 v[32:35], v[172:175], v[204:207], v[32:35]
    v_mfma_f32_16x16x32_bf16 v[36:39], v[180:183], v[188:191], v[36:39]
    v_mfma_f32_16x16x32_bf16 v[40:43], v[180:183], v[196:199], v[40:43]
    v_mfma_f32_16x16x32_bf16 v[44:47], v[180:183], v[204:207], v[44:47]
    v_mfma_f32_16x16x32_bf16 v[0:3], v[96:99], v[128:131], v[0:3]
    ds_read_b128 v[152:155], v214 offset:0
    v_mfma_f32_16x16x32_bf16 v[4:7], v[96:99], v[136:139], v[4:7]
    v_mfma_f32_16x16x32_bf16 v[8:11], v[96:99], v[144:147], v[8:11]
    ds_read_b128 v[184:187], v208 offset:0
    v_mfma_f32_16x16x32_bf16 v[12:15], v[104:107], v[128:131], v[12:15]
    v_mfma_f32_16x16x32_bf16 v[16:19], v[104:107], v[136:139], v[16:19]
    ds_read_b128 v[192:195], v208 offset:2048
    v_mfma_f32_16x16x32_bf16 v[20:23], v[104:107], v[144:147], v[20:23]
    v_mfma_f32_16x16x32_bf16 v[24:27], v[112:115], v[128:131], v[24:27]
    ds_read_b128 v[200:203], v208 offset:4096
    v_mfma_f32_16x16x32_bf16 v[28:31], v[112:115], v[136:139], v[28:31]
    v_mfma_f32_16x16x32_bf16 v[32:35], v[112:115], v[144:147], v[32:35]
    ds_read_b128 v[160:163], v214 offset:2048
    v_mfma_f32_16x16x32_bf16 v[36:39], v[120:123], v[128:131], v[36:39]
    v_mfma_f32_16x16x32_bf16 v[40:43], v[120:123], v[136:139], v[40:43]
    ds_read_b128 v[168:171], v214 offset:4096
    v_mfma_f32_16x16x32_bf16 v[44:47], v[120:123], v[144:147], v[44:47]
    v_mfma_f32_16x16x32_bf16 v[48:51], v[96:99], v[132:135], v[48:51]
    ds_read_b128 v[176:179], v214 offset:6144
    v_mfma_f32_16x16x32_bf16 v[52:55], v[96:99], v[140:143], v[52:55]
    v_mfma_f32_16x16x32_bf16 v[56:59], v[96:99], v[148:151], v[56:59]
    ds_read_b128 v[188:191], v211 offset:0
    v_mfma_f32_16x16x32_bf16 v[60:63], v[104:107], v[132:135], v[60:63]
    v_mfma_f32_16x16x32_bf16 v[64:67], v[104:107], v[140:143], v[64:67]
    ds_read_b128 v[196:199], v211 offset:2048
    v_mfma_f32_16x16x32_bf16 v[68:71], v[104:107], v[148:151], v[68:71]
    v_mfma_f32_16x16x32_bf16 v[72:75], v[112:115], v[132:135], v[72:75]
    ds_read_b128 v[204:207], v211 offset:4096
    v_mfma_f32_16x16x32_bf16 v[76:79], v[112:115], v[140:143], v[76:79]
    v_mfma_f32_16x16x32_bf16 v[80:83], v[112:115], v[148:151], v[80:83]
    ds_read_b128 v[156:159], v214 offset:1024
    v_mfma_f32_16x16x32_bf16 v[84:87], v[120:123], v[132:135], v[84:87]
    v_mfma_f32_16x16x32_bf16 v[88:91], v[120:123], v[140:143], v[88:91]
    ds_read_b128 v[164:167], v214 offset:3072
    v_mfma_f32_16x16x32_bf16 v[92:95], v[120:123], v[148:151], v[92:95]
    v_mfma_f32_16x16x32_bf16 v[48:51], v[100:103], v[128:131], v[48:51]
    ds_read_b128 v[172:175], v214 offset:5120
    v_xor_b32 v132, s34, v132
    v_xor_b32 v133, s34, v133
    v_mfma_f32_16x16x32_bf16 v[52:55], v[100:103], v[136:139], v[52:55]
    v_xor_b32 v134, s34, v134
    v_xor_b32 v135, s34, v135
    v_mfma_f32_16x16x32_bf16 v[56:59], v[100:103], v[144:147], v[56:59]
    ds_read_b128 v[180:183], v214 offset:7168
    v_xor_b32 v140, s34, v140
    v_xor_b32 v141, s34, v141
    v_mfma_f32_16x16x32_bf16 v[60:63], v[108:111], v[128:131], v[60:63]
    v_xor_b32 v142, s34, v142
    v_xor_b32 v143, s34, v143
    v_mfma_f32_16x16x32_bf16 v[64:67], v[108:111], v[136:139], v[64:67]
    v_xor_b32 v148, s34, v148
    v_xor_b32 v149, s34, v149
    v_mfma_f32_16x16x32_bf16 v[68:71], v[108:111], v[144:147], v[68:71]
    v_xor_b32 v150, s34, v150
    v_xor_b32 v151, s34, v151
    v_mfma_f32_16x16x32_bf16 v[72:75], v[116:119], v[128:131], v[72:75]
    v_mfma_f32_16x16x32_bf16 v[76:79], v[116:119], v[136:139], v[76:79]
    v_mfma_f32_16x16x32_bf16 v[80:83], v[116:119], v[144:147], v[80:83]
    v_mfma_f32_16x16x32_bf16 v[84:87], v[124:127], v[128:131], v[84:87]
    v_mfma_f32_16x16x32_bf16 v[88:91], v[124:127], v[136:139], v[88:91]
    v_mfma_f32_16x16x32_bf16 v[92:95], v[124:127], v[144:147], v[92:95]
    v_mfma_f32_16x16x32_bf16 v[0:3], v[100:103], v[132:135], v[0:3]
    v_mfma_f32_16x16x32_bf16 v[4:7], v[100:103], v[140:143], v[4:7]
    v_mfma_f32_16x16x32_bf16 v[8:11], v[100:103], v[148:151], v[8:11]
    v_mfma_f32_16x16x32_bf16 v[12:15], v[108:111], v[132:135], v[12:15]
    v_mfma_f32_16x16x32_bf16 v[16:19], v[108:111], v[140:143], v[16:19]
    s_waitcnt lgkmcnt(0)
    v_mfma_f32_16x16x32_bf16 v[20:23], v[108:111], v[148:151], v[20:23]
    v_mfma_f32_16x16x32_bf16 v[24:27], v[116:119], v[132:135], v[24:27]
    v_mfma_f32_16x16x32_bf16 v[28:31], v[116:119], v[140:143], v[28:31]
    v_mfma_f32_16x16x32_bf16 v[32:35], v[116:119], v[148:151], v[32:35]
    v_mfma_f32_16x16x32_bf16 v[36:39], v[124:127], v[132:135], v[36:39]
    v_mfma_f32_16x16x32_bf16 v[40:43], v[124:127], v[140:143], v[40:43]
    v_mfma_f32_16x16x32_bf16 v[44:47], v[124:127], v[148:151], v[44:47]
    v_mfma_f32_16x16x32_bf16 v[0:3], v[152:155], v[184:187], v[0:3]
    v_mfma_f32_16x16x32_bf16 v[4:7], v[152:155], v[192:195], v[4:7]
    v_mfma_f32_16x16x32_bf16 v[8:11], v[152:155], v[200:203], v[8:11]
    v_mfma_f32_16x16x32_bf16 v[12:15], v[160:163], v[184:187], v[12:15]
    v_mfma_f32_16x16x32_bf16 v[16:19], v[160:163], v[192:195], v[16:19]
    v_mfma_f32_16x16x32_bf16 v[20:23], v[160:163], v[200:203], v[20:23]
    v_mfma_f32_16x16x32_bf16 v[24:27], v[168:171], v[184:187], v[24:27]
    v_mfma_f32_16x16x32_bf16 v[28:31], v[168:171], v[192:195], v[28:31]
    v_mfma_f32_16x16x32_bf16 v[32:35], v[168:171], v[200:203], v[32:35]
    v_mfma_f32_16x16x32_bf16 v[36:39], v[176:179], v[184:187], v[36:39]
    v_mfma_f32_16x16x32_bf16 v[40:43], v[176:179], v[192:195], v[40:43]
    v_mfma_f32_16x16x32_bf16 v[44:47], v[176:179], v[200:203], v[44:47]
    v_mfma_f32_16x16x32_bf16 v[48:51], v[152:155], v[188:191], v[48:51]
    v_mfma_f32_16x16x32_bf16 v[52:55], v[152:155], v[196:199], v[52:55]
    v_mfma_f32_16x16x32_bf16 v[56:59], v[152:155], v[204:207], v[56:59]
    v_mfma_f32_16x16x32_bf16 v[60:63], v[160:163], v[188:191], v[60:63]
    v_mfma_f32_16x16x32_bf16 v[64:67], v[160:163], v[196:199], v[64:67]
    v_mfma_f32_16x16x32_bf16 v[68:71], v[160:163], v[204:207], v[68:71]
    v_mfma_f32_16x16x32_bf16 v[72:75], v[168:171], v[188:191], v[72:75]
    v_mfma_f32_16x16x32_bf16 v[76:79], v[168:171], v[196:199], v[76:79]
    v_mfma_f32_16x16x32_bf16 v[80:83], v[168:171], v[204:207], v[80:83]
    v_mfma_f32_16x16x32_bf16 v[84:87], v[176:179], v[188:191], v[84:87]
    v_mfma_f32_16x16x32_bf16 v[88:91], v[176:179], v[196:199], v[88:91]
    v_mfma_f32_16x16x32_bf16 v[92:95], v[176:179], v[204:207], v[92:95]
    v_mfma_f32_16x16x32_bf16 v[48:51], v[156:159], v[184:187], v[48:51]
    v_xor_b32 v188, s34, v188
    v_xor_b32 v189, s34, v189
    v_mfma_f32_16x16x32_bf16 v[52:55], v[156:159], v[192:195], v[52:55]
    v_xor_b32 v190, s34, v190
    v_xor_b32 v191, s34, v191
    v_mfma_f32_16x16x32_bf16 v[56:59], v[156:159], v[200:203], v[56:59]
    v_xor_b32 v196, s34, v196
    v_xor_b32 v197, s34, v197
    v_mfma_f32_16x16x32_bf16 v[60:63], v[164:167], v[184:187], v[60:63]
    v_xor_b32 v198, s34, v198
    v_xor_b32 v199, s34, v199
    v_mfma_f32_16x16x32_bf16 v[64:67], v[164:167], v[192:195], v[64:67]
    v_xor_b32 v204, s34, v204
    v_xor_b32 v205, s34, v205
    v_mfma_f32_16x16x32_bf16 v[68:71], v[164:167], v[200:203], v[68:71]
    v_xor_b32 v206, s34, v206
    v_xor_b32 v207, s34, v207
    v_mfma_f32_16x16x32_bf16 v[72:75], v[172:175], v[184:187], v[72:75]
    v_mfma_f32_16x16x32_bf16 v[76:79], v[172:175], v[192:195], v[76:79]
    v_mfma_f32_16x16x32_bf16 v[80:83], v[172:175], v[200:203], v[80:83]
    v_mfma_f32_16x16x32_bf16 v[84:87], v[180:183], v[184:187], v[84:87]
    v_mfma_f32_16x16x32_bf16 v[88:91], v[180:183], v[192:195], v[88:91]
    v_mfma_f32_16x16x32_bf16 v[92:95], v[180:183], v[200:203], v[92:95]
    v_mfma_f32_16x16x32_bf16 v[0:3], v[156:159], v[188:191], v[0:3]
    v_mfma_f32_16x16x32_bf16 v[4:7], v[156:159], v[196:199], v[4:7]
    v_mfma_f32_16x16x32_bf16 v[8:11], v[156:159], v[204:207], v[8:11]
    v_mfma_f32_16x16x32_bf16 v[12:15], v[164:167], v[188:191], v[12:15]
    v_mfma_f32_16x16x32_bf16 v[16:19], v[164:167], v[196:199], v[16:19]
    v_mfma_f32_16x16x32_bf16 v[20:23], v[164:167], v[204:207], v[20:23]
    v_mfma_f32_16x16x32_bf16 v[24:27], v[172:175], v[188:191], v[24:27]
    v_mfma_f32_16x16x32_bf16 v[28:31], v[172:175], v[196:199], v[28:31]
    v_mfma_f32_16x16x32_bf16 v[32:35], v[172:175], v[204:207], v[32:35]
    v_mfma_f32_16x16x32_bf16 v[36:39], v[180:183], v[188:191], v[36:39]
    v_mfma_f32_16x16x32_bf16 v[40:43], v[180:183], v[196:199], v[40:43]
    v_mfma_f32_16x16x32_bf16 v[44:47], v[180:183], v[204:207], v[44:47]
    s_nop 7
    s_nop 7
    v_cvt_pk_bf16_f32 v96, v48, v49
    v_cvt_pk_bf16_f32 v97, v50, v51
    v_cvt_pk_bf16_f32 v98, v60, v61
    v_cvt_pk_bf16_f32 v99, v62, v63
    s_add_u32 s35, s33, 0
    buffer_store_dwordx4 v[96:99], v221, s[16:19], s35 offen offset:64 sc1
    v_cvt_pk_bf16_f32 v100, v52, v53
    v_cvt_pk_bf16_f32 v101, v54, v55
    v_cvt_pk_bf16_f32 v102, v64, v65
    v_cvt_pk_bf16_f32 v103, v66, v67
    s_add_u32 s35, s33, 524288
    buffer_store_dwordx4 v[100:103], v221, s[16:19], s35 offen offset:64 sc1
    v_cvt_pk_bf16_f32 v104, v56, v57
    v_cvt_pk_bf16_f32 v105, v58, v59
    v_cvt_pk_bf16_f32 v106, v68, v69
    v_cvt_pk_bf16_f32 v107, v70, v71
    s_add_u32 s35, s33, 1048576
    buffer_store_dwordx4 v[104:107], v221, s[16:19], s35 offen offset:64 sc1
    v_cvt_pk_bf16_f32 v108, v72, v73
    v_cvt_pk_bf16_f32 v109, v74, v75
    v_cvt_pk_bf16_f32 v110, v84, v85
    v_cvt_pk_bf16_f32 v111, v86, v87
    s_add_u32 s35, s33, 4096
    buffer_store_dwordx4 v[108:111], v221, s[16:19], s35 offen offset:64 sc1
    v_cvt_pk_bf16_f32 v112, v76, v77
    v_cvt_pk_bf16_f32 v113, v78, v79
    v_cvt_pk_bf16_f32 v114, v88, v89
    v_cvt_pk_bf16_f32 v115, v90, v91
    s_add_u32 s35, s33, 528384
    buffer_store_dwordx4 v[112:115], v221, s[16:19], s35 offen offset:64 sc1
    v_cvt_pk_bf16_f32 v116, v80, v81
    v_cvt_pk_bf16_f32 v117, v82, v83
    v_cvt_pk_bf16_f32 v118, v92, v93
    v_cvt_pk_bf16_f32 v119, v94, v95
    s_add_u32 s35, s33, 1052672
    buffer_store_dwordx4 v[116:119], v221, s[16:19], s35 offen offset:64 sc1
    v_cvt_pk_bf16_f32 v120, v0, v1
    v_cvt_pk_bf16_f32 v121, v2, v3
    v_cvt_pk_bf16_f32 v122, v12, v13
    v_cvt_pk_bf16_f32 v123, v14, v15
    s_add_u32 s35, s33, 0
    buffer_store_dwordx4 v[120:123], v221, s[16:19], s35 offen offset:0 sc1
    v_cvt_pk_bf16_f32 v124, v4, v5
    v_cvt_pk_bf16_f32 v125, v6, v7
    v_cvt_pk_bf16_f32 v126, v16, v17
    v_cvt_pk_bf16_f32 v127, v18, v19
    s_add_u32 s35, s33, 524288
    buffer_store_dwordx4 v[124:127], v221, s[16:19], s35 offen offset:0 sc1
    v_cvt_pk_bf16_f32 v96, v8, v9
    v_cvt_pk_bf16_f32 v97, v10, v11
    v_cvt_pk_bf16_f32 v98, v20, v21
    v_cvt_pk_bf16_f32 v99, v22, v23
    s_add_u32 s35, s33, 1048576
    buffer_store_dwordx4 v[96:99], v221, s[16:19], s35 offen offset:0 sc1
    v_cvt_pk_bf16_f32 v100, v24, v25
    v_cvt_pk_bf16_f32 v101, v26, v27
    v_cvt_pk_bf16_f32 v102, v36, v37
    v_cvt_pk_bf16_f32 v103, v38, v39
    s_add_u32 s35, s33, 4096
    buffer_store_dwordx4 v[100:103], v221, s[16:19], s35 offen offset:0 sc1
    v_cvt_pk_bf16_f32 v104, v28, v29
    v_cvt_pk_bf16_f32 v105, v30, v31
    v_cvt_pk_bf16_f32 v106, v40, v41
    v_cvt_pk_bf16_f32 v107, v42, v43
    s_add_u32 s35, s33, 528384
    buffer_store_dwordx4 v[104:107], v221, s[16:19], s35 offen offset:0 sc1
    v_cvt_pk_bf16_f32 v108, v32, v33
    v_cvt_pk_bf16_f32 v109, v34, v35
    v_cvt_pk_bf16_f32 v110, v44, v45
    v_cvt_pk_bf16_f32 v111, v46, v47
    s_add_u32 s35, s33, 1052672
    buffer_store_dwordx4 v[108:111], v221, s[16:19], s35 offen offset:0 sc1
    s_endpgm
L_gemm1_kernel_loader:
    s_sub_u32 s20, s20, 4
    v_and_b32 v3, 63, v0
    v_lshrrev_b32 v4, 3, v3
    v_and_b32 v5, 7, v3
    v_xor_b32 v5, v5, v4
    v_lshlrev_b32 v5, 4, v5
    v_lshl_add_u32 v1, v4, 11, v5
    v_lshlrev_b32 v2, 4, v3
    s_add_u32 s24, s20, 0
    s_lshl_b32 s40, s24, 10
    s_lshl_b32 s43, s24, 14
    s_add_u32 s24, s20, 4
    s_lshl_b32 s41, s24, 10
    s_lshl_b32 s44, s24, 14
    s_add_u32 s24, s20, 8
    s_lshl_b32 s42, s24, 10
    s_lshl_b32 s45, s24, 14
    s_mul_i32 s46, s20, 4096
    s_add_u32 s47, s46, 12288
    s_add_u32 m0, s40, 0
    s_add_u32 s24, s43, 0
    buffer_load_dwordx4 v1, s[8:11], s24 offen lds
    s_add_u32 m0, s41, 0
    s_add_u32 s24, s44, 0
    buffer_load_dwordx4 v1, s[8:11], s24 offen lds
    s_add_u32 m0, s42, 0
    s_add_u32 s24, s45, 0
    buffer_load_dwordx4 v1, s[8:11], s24 offen lds
    s_add_u32 m0, s47, 0
    s_add_u32 s24, s46, 0
    buffer_load_dwordx4 v2, s[12:15], s24 offen offset:0 lds
    buffer_load_dwordx4 v2, s[12:15], s24 offen offset:1024 lds
    buffer_load_dwordx4 v2, s[12:15], s24 offen offset:2048 lds
    buffer_load_dwordx4 v2, s[12:15], s24 offen offset:3072 lds
    s_add_u32 m0, s40, 28672
    s_add_u32 s24, s43, 128
    buffer_load_dwordx4 v1, s[8:11], s24 offen lds
    s_add_u32 m0, s41, 28672
    s_add_u32 s24, s44, 128
    buffer_load_dwordx4 v1, s[8:11], s24 offen lds
    s_add_u32 m0, s42, 28672
    s_add_u32 s24, s45, 128
    buffer_load_dwordx4 v1, s[8:11], s24 offen lds
    s_add_u32 m0, s47, 28672
    s_add_u32 s24, s46, 32768
    buffer_load_dwordx4 v2, s[12:15], s24 offen offset:0 lds
    buffer_load_dwordx4 v2, s[12:15], s24 offen offset:1024 lds
    buffer_load_dwordx4 v2, s[12:15], s24 offen offset:2048 lds
    buffer_load_dwordx4 v2, s[12:15], s24 offen offset:3072 lds
    s_waitcnt vmcnt(7)
    s_barrier
    s_add_u32 m0, s40, 57344
    s_add_u32 s24, s43, 256
    buffer_load_dwordx4 v1, s[8:11], s24 offen lds
    s_add_u32 m0, s41, 57344
    s_add_u32 s24, s44, 256
    buffer_load_dwordx4 v1, s[8:11], s24 offen lds
    s_add_u32 m0, s42, 57344
    s_add_u32 s24, s45, 256
    buffer_load_dwordx4 v1, s[8:11], s24 offen lds
    s_add_u32 m0, s47, 57344
    s_add_u32 s24, s46, 65536
    buffer_load_dwordx4 v2, s[12:15], s24 offen offset:0 lds
    buffer_load_dwordx4 v2, s[12:15], s24 offen offset:1024 lds
    buffer_load_dwordx4 v2, s[12:15], s24 offen offset:2048 lds
    buffer_load_dwordx4 v2, s[12:15], s24 offen offset:3072 lds
    s_waitcnt vmcnt(7)
    s_barrier
    s_add_u32 m0, s40, 86016
    s_add_u32 s24, s43, 384
    buffer_load_dwordx4 v1, s[8:11], s24 offen lds
    s_add_u32 m0, s41, 86016
    s_add_u32 s24, s44, 384
    buffer_load_dwordx4 v1, s[8:11], s24 offen lds
    s_add_u32 m0, s42, 86016
    s_add_u32 s24, s45, 384
    buffer_load_dwordx4 v1, s[8:11], s24 offen lds
    s_add_u32 m0, s47, 86016
    s_add_u32 s24, s46, 98304
    buffer_load_dwordx4 v2, s[12:15], s24 offen offset:0 lds
    buffer_load_dwordx4 v2, s[12:15], s24 offen offset:1024 lds
    buffer_load_dwordx4 v2, s[12:15], s24 offen offset:2048 lds
    buffer_load_dwordx4 v2, s[12:15], s24 offen offset:3072 lds
    s_add_u32 m0, s40, 114688
    s_add_u32 s24, s43, 512
    buffer_load_dwordx4 v1, s[8:11], s24 offen lds
    s_add_u32 m0, s41, 114688
    s_add_u32 s24, s44, 512
    buffer_load_dwordx4 v1, s[8:11], s24 offen lds
    s_add_u32 m0, s42, 114688
    s_add_u32 s24, s45, 512
    buffer_load_dwordx4 v1, s[8:11], s24 offen lds
    s_add_u32 m0, s47, 114688
    s_add_u32 s24, s46, 131072
    buffer_load_dwordx4 v2, s[12:15], s24 offen offset:0 lds
    buffer_load_dwordx4 v2, s[12:15], s24 offen offset:1024 lds
    buffer_load_dwordx4 v2, s[12:15], s24 offen offset:2048 lds
    buffer_load_dwordx4 v2, s[12:15], s24 offen offset:3072 lds
    s_waitcnt vmcnt(14)
    s_barrier
    s_add_u32 m0, s40, 0
    s_add_u32 s24, s43, 640
    buffer_load_dwordx4 v1, s[8:11], s24 offen lds
    s_add_u32 m0, s41, 0
    s_add_u32 s24, s44, 640
    buffer_load_dwordx4 v1, s[8:11], s24 offen lds
    s_add_u32 m0, s42, 0
    s_add_u32 s24, s45, 640
    buffer_load_dwordx4 v1, s[8:11], s24 offen lds
    s_add_u32 m0, s47, 0
    s_add_u32 s24, s46, 163840
    buffer_load_dwordx4 v2, s[12:15], s24 offen offset:0 lds
    buffer_load_dwordx4 v2, s[12:15], s24 offen offset:1024 lds
    buffer_load_dwordx4 v2, s[12:15], s24 offen offset:2048 lds
    buffer_load_dwordx4 v2, s[12:15], s24 offen offset:3072 lds
    s_add_u32 m0, s40, 28672
    s_add_u32 s24, s43, 768
    buffer_load_dwordx4 v1, s[8:11], s24 offen lds
    s_add_u32 m0, s41, 28672
    s_add_u32 s24, s44, 768
    buffer_load_dwordx4 v1, s[8:11], s24 offen lds
    s_add_u32 m0, s42, 28672
    s_add_u32 s24, s45, 768
    buffer_load_dwordx4 v1, s[8:11], s24 offen lds
    s_add_u32 m0, s47, 28672
    s_add_u32 s24, s46, 196608
    buffer_load_dwordx4 v2, s[12:15], s24 offen offset:0 lds
    buffer_load_dwordx4 v2, s[12:15], s24 offen offset:1024 lds
    buffer_load_dwordx4 v2, s[12:15], s24 offen offset:2048 lds
    buffer_load_dwordx4 v2, s[12:15], s24 offen offset:3072 lds
    s_waitcnt vmcnt(21)
    s_barrier
    s_add_u32 m0, s40, 57344
    s_add_u32 s24, s43, 896
    buffer_load_dwordx4 v1, s[8:11], s24 offen lds
    s_add_u32 m0, s41, 57344
    s_add_u32 s24, s44, 896
    buffer_load_dwordx4 v1, s[8:11], s24 offen lds
    s_add_u32 m0, s42, 57344
    s_add_u32 s24, s45, 896
    buffer_load_dwordx4 v1, s[8:11], s24 offen lds
    s_add_u32 m0, s47, 57344
    s_add_u32 s24, s46, 229376
    buffer_load_dwordx4 v2, s[12:15], s24 offen offset:0 lds
    buffer_load_dwordx4 v2, s[12:15], s24 offen offset:1024 lds
    buffer_load_dwordx4 v2, s[12:15], s24 offen offset:2048 lds
    buffer_load_dwordx4 v2, s[12:15], s24 offen offset:3072 lds
    s_waitcnt vmcnt(21)
    s_barrier
    s_add_u32 m0, s40, 86016
    s_add_u32 s24, s43, 1024
    buffer_load_dwordx4 v1, s[8:11], s24 offen lds
    s_add_u32 m0, s41, 86016
    s_add_u32 s24, s44, 1024
    buffer_load_dwordx4 v1, s[8:11], s24 offen lds
    s_add_u32 m0, s42, 86016
    s_add_u32 s24, s45, 1024
    buffer_load_dwordx4 v1, s[8:11], s24 offen lds
    s_add_u32 m0, s47, 86016
    s_add_u32 s24, s46, 262144
    buffer_load_dwordx4 v2, s[12:15], s24 offen offset:0 lds
    buffer_load_dwordx4 v2, s[12:15], s24 offen offset:1024 lds
    buffer_load_dwordx4 v2, s[12:15], s24 offen offset:2048 lds
    buffer_load_dwordx4 v2, s[12:15], s24 offen offset:3072 lds
    s_waitcnt vmcnt(21)
    s_barrier
    s_add_u32 m0, s40, 114688
    s_add_u32 s24, s43, 1152
    buffer_load_dwordx4 v1, s[8:11], s24 offen lds
    s_add_u32 m0, s41, 114688
    s_add_u32 s24, s44, 1152
    buffer_load_dwordx4 v1, s[8:11], s24 offen lds
    s_add_u32 m0, s42, 114688
    s_add_u32 s24, s45, 1152
    buffer_load_dwordx4 v1, s[8:11], s24 offen lds
    s_add_u32 m0, s47, 114688
    s_add_u32 s24, s46, 294912
    buffer_load_dwordx4 v2, s[12:15], s24 offen offset:0 lds
    buffer_load_dwordx4 v2, s[12:15], s24 offen offset:1024 lds
    buffer_load_dwordx4 v2, s[12:15], s24 offen offset:2048 lds
    buffer_load_dwordx4 v2, s[12:15], s24 offen offset:3072 lds
    s_waitcnt vmcnt(21)
    s_barrier
    s_add_u32 m0, s40, 0
    s_add_u32 s24, s43, 1280
    buffer_load_dwordx4 v1, s[8:11], s24 offen lds
    s_add_u32 m0, s41, 0
    s_add_u32 s24, s44, 1280
    buffer_load_dwordx4 v1, s[8:11], s24 offen lds
    s_add_u32 m0, s42, 0
    s_add_u32 s24, s45, 1280
    buffer_load_dwordx4 v1, s[8:11], s24 offen lds
    s_add_u32 m0, s47, 0
    s_add_u32 s24, s46, 327680
    buffer_load_dwordx4 v2, s[12:15], s24 offen offset:0 lds
    buffer_load_dwordx4 v2, s[12:15], s24 offen offset:1024 lds
    buffer_load_dwordx4 v2, s[12:15], s24 offen offset:2048 lds
    buffer_load_dwordx4 v2, s[12:15], s24 offen offset:3072 lds
    s_waitcnt vmcnt(21)
    s_barrier
    s_add_u32 m0, s40, 28672
    s_add_u32 s24, s43, 1408
    buffer_load_dwordx4 v1, s[8:11], s24 offen lds
    s_add_u32 m0, s41, 28672
    s_add_u32 s24, s44, 1408
    buffer_load_dwordx4 v1, s[8:11], s24 offen lds
    s_add_u32 m0, s42, 28672
    s_add_u32 s24, s45, 1408
    buffer_load_dwordx4 v1, s[8:11], s24 offen lds
    s_add_u32 m0, s47, 28672
    s_add_u32 s24, s46, 360448
    buffer_load_dwordx4 v2, s[12:15], s24 offen offset:0 lds
    buffer_load_dwordx4 v2, s[12:15], s24 offen offset:1024 lds
    buffer_load_dwordx4 v2, s[12:15], s24 offen offset:2048 lds
    buffer_load_dwordx4 v2, s[12:15], s24 offen offset:3072 lds
    s_waitcnt vmcnt(21)
    s_barrier
    s_add_u32 m0, s40, 57344
    s_add_u32 s24, s43, 1536
    buffer_load_dwordx4 v1, s[8:11], s24 offen lds
    s_add_u32 m0, s41, 57344
    s_add_u32 s24, s44, 1536
    buffer_load_dwordx4 v1, s[8:11], s24 offen lds
    s_add_u32 m0, s42, 57344
    s_add_u32 s24, s45, 1536
    buffer_load_dwordx4 v1, s[8:11], s24 offen lds
    s_add_u32 m0, s47, 57344
    s_add_u32 s24, s46, 393216
    buffer_load_dwordx4 v2, s[12:15], s24 offen offset:0 lds
    buffer_load_dwordx4 v2, s[12:15], s24 offen offset:1024 lds
    buffer_load_dwordx4 v2, s[12:15], s24 offen offset:2048 lds
    buffer_load_dwordx4 v2, s[12:15], s24 offen offset:3072 lds
    s_waitcnt vmcnt(21)
    s_barrier
    s_add_u32 m0, s40, 86016
    s_add_u32 s24, s43, 1664
    buffer_load_dwordx4 v1, s[8:11], s24 offen lds
    s_add_u32 m0, s41, 86016
    s_add_u32 s24, s44, 1664
    buffer_load_dwordx4 v1, s[8:11], s24 offen lds
    s_add_u32 m0, s42, 86016
    s_add_u32 s24, s45, 1664
    buffer_load_dwordx4 v1, s[8:11], s24 offen lds
    s_add_u32 m0, s47, 86016
    s_add_u32 s24, s46, 425984
    buffer_load_dwordx4 v2, s[12:15], s24 offen offset:0 lds
    buffer_load_dwordx4 v2, s[12:15], s24 offen offset:1024 lds
    buffer_load_dwordx4 v2, s[12:15], s24 offen offset:2048 lds
    buffer_load_dwordx4 v2, s[12:15], s24 offen offset:3072 lds
    s_waitcnt vmcnt(21)
    s_barrier
    s_add_u32 m0, s40, 114688
    s_add_u32 s24, s43, 1792
    buffer_load_dwordx4 v1, s[8:11], s24 offen lds
    s_add_u32 m0, s41, 114688
    s_add_u32 s24, s44, 1792
    buffer_load_dwordx4 v1, s[8:11], s24 offen lds
    s_add_u32 m0, s42, 114688
    s_add_u32 s24, s45, 1792
    buffer_load_dwordx4 v1, s[8:11], s24 offen lds
    s_add_u32 m0, s47, 114688
    s_add_u32 s24, s46, 458752
    buffer_load_dwordx4 v2, s[12:15], s24 offen offset:0 lds
    buffer_load_dwordx4 v2, s[12:15], s24 offen offset:1024 lds
    buffer_load_dwordx4 v2, s[12:15], s24 offen offset:2048 lds
    buffer_load_dwordx4 v2, s[12:15], s24 offen offset:3072 lds
    s_waitcnt vmcnt(21)
    s_barrier
    s_add_u32 m0, s40, 0
    s_add_u32 s24, s43, 1920
    buffer_load_dwordx4 v1, s[8:11], s24 offen lds
    s_add_u32 m0, s41, 0
    s_add_u32 s24, s44, 1920
    buffer_load_dwordx4 v1, s[8:11], s24 offen lds
    s_add_u32 m0, s42, 0
    s_add_u32 s24, s45, 1920
    buffer_load_dwordx4 v1, s[8:11], s24 offen lds
    s_add_u32 m0, s47, 0
    s_add_u32 s24, s46, 491520
    buffer_load_dwordx4 v2, s[12:15], s24 offen offset:0 lds
    buffer_load_dwordx4 v2, s[12:15], s24 offen offset:1024 lds
    buffer_load_dwordx4 v2, s[12:15], s24 offen offset:2048 lds
    buffer_load_dwordx4 v2, s[12:15], s24 offen offset:3072 lds
    s_waitcnt vmcnt(21)
    s_barrier
    s_waitcnt vmcnt(14)
    s_barrier
    s_waitcnt vmcnt(7)
    s_barrier
    s_waitcnt vmcnt(0)
    s_barrier
L_gemm1_kernel_done:
    s_endpgm
.globl mid_kernel
.p2align 8
.type mid_kernel,@function
mid_kernel:
    s_cmp_ge_u32 s2, 704
    s_cbranch_scc1 L_mid_kernel_done
    v_readfirstlane_b32 s20, v0
    s_lshr_b32 s20, s20, 6
    s_cmp_ge_u32 s2, 448
    s_cbranch_scc1 L_mid_kernel_g
    s_load_dwordx2 s[6:7], s[0:1], 72
    s_load_dwordx2 s[4:5], s[0:1], 72
    s_cmp_ge_u32 s2, 224
    s_cselect_b32 s24, 1, 0
    s_mul_i32 s25, s24, 224
    s_sub_u32 s25, s2, s25
    s_lshr_b32 s26, s25, 3
    s_and_b32 s27, s25, 7
    v_and_b32 v1, 63, v0
    v_lshrrev_b32 v2, 2, v1
    v_lshlrev_b32 v2, 6, v2
    v_lshrrev_b32 v3, 5, v1
    v_lshlrev_b32 v3, 1, v3
    v_and_b32 v4, 3, v1
    v_xor_b32 v3, v3, v4
    v_lshl_add_u32 v2, v3, 4, v2
    s_mul_i32 s28, s26, 6
    s_lshl_b32 s29, s20, 1
    s_add_u32 s28, s28, s29
    s_sub_u32 s28, s28, 1
    s_lshl_b32 s30, s27, 12
    s_add_u32 s31, s28, 0
    s_lshl_b32 s32, s31, 15
    s_add_u32 s32, s32, s30
    s_cmp_lt_i32 s31, 0
    s_cselect_b32 s32, 0x7f000000, s32
    v_add_u32 v3, s32, v2
    s_add_u32 s31, s28, 1
    s_lshl_b32 s32, s31, 15
    s_add_u32 s32, s32, s30
    s_cmp_lt_i32 s31, 0
    s_cselect_b32 s32, 0x7f000000, s32
    v_add_u32 v4, s32, v2
    s_waitcnt lgkmcnt(0)
    s_mul_i32 s33, s24, 5472256
    s_add_u32 s33, s33, 38871040
    s_add_u32 s8, s6, s33
    s_addc_u32 s9, s7, 0
    s_mov_b32 s10, 5472256
    s_mov_b32 s11, 0x00020000
    s_add_u32 s12, s6, 83312640
    s_addc_u32 s13, s7, 0
    s_mov_b32 s14, 16384
    s_mov_b32 s15, 0x00020000
    s_lshl_b32 s34, s20, 13
    s_add_u32 m0, s34, 0
    s_nop 0
    buffer_load_dwordx4 v3, s[8:11], 0 offen offset:0 lds
    buffer_load_dwordx4 v3, s[8:11], 0 offen offset:1024 lds
    buffer_load_dwordx4 v3, s[8:11], 0 offen offset:2048 lds
    buffer_load_dwordx4 v3, s[8:11], 0 offen offset:3072 lds
    s_add_u32 m0, s34, 4096
    s_nop 0
    buffer_load_dwordx4 v4, s[8:11], 0 offen offset:0 lds
    buffer_load_dwordx4 v4, s[8:11], 0 offen offset:1024 lds
    buffer_load_dwordx4 v4, s[8:11], 0 offen offset:2048 lds
    buffer_load_dwordx4 v4, s[8:11], 0 offen offset:3072 lds
    v_lshlrev_b32 v5, 4, v1
    s_mov_b32 s35, 8192
    buffer_load_dwordx4 v[8:11], v5, s[12:15], s35 offen
    s_mov_b32 s35, 9216
    buffer_load_dwordx4 v[12:15], v5, s[12:15], s35 offen
    s_mov_b32 s35, 10240
    buffer_load_dwordx4 v[16:19], v5, s[12:15], s35 offen
    s_mov_b32 s35, 11264
    buffer_load_dwordx4 v[20:23], v5, s[12:15], s35 offen
    s_mov_b32 s35, 12288
    buffer_load_dwordx4 v[24:27], v5, s[12:15], s35 offen
    s_mov_b32 s35, 13312
    buffer_load_dwordx4 v[28:31], v5, s[12:15], s35 offen
    s_lshl_b32 s35, s20, 11
    buffer_load_dwordx4 v[32:35], v5, s[12:15], s35 offen offset:0
    buffer_load_dwordx4 v[36:39], v5, s[12:15], s35 offen offset:1024
    v_bfe_u32 v40, v1, 2, 2
    v_lshrrev_b32 v41, 4, v1
    v_and_b32 v42, 3, v1
    v_lshl_add_u32 v43, v41, 3, v40
    v_lshlrev_b32 v46, 6, v43
    v_and_b32 v47, 1, v41
    v_lshlrev_b32 v47, 1, v47
    v_lshrrev_b32 v48, 1, v42
    v_xor_b32 v47, v47, v48
    v_lshl_add_u32 v46, v47, 4, v46
    v_and_b32 v48, 1, v42
    v_lshl_add_u32 v46, v48, 3, v46
    v_add_u32 v44, s34, v46
    v_xor_b32 v45, 32, v44
    v_add_u32 v49, 43008, v46
    v_xor_b32 v50, 32, v49
    v_add_u32 v47, 1, v43
    v_bfe_u32 v48, v47, 3, 1
    v_lshlrev_b32 v48, 1, v48
    v_lshrrev_b32 v55, 1, v42
    v_xor_b32 v48, v48, v55
    v_lshlrev_b32 v47, 6, v47
    v_lshl_add_u32 v47, v48, 4, v47
    v_and_b32 v48, 1, v42
    v_lshl_add_u32 v47, v48, 3, v47
    v_add_u32 v51, 32704, v47
    v_xor_b32 v52, 32, v51
    v_add_u32 v47, 5, v43
    v_bfe_u32 v48, v47, 3, 1
    v_lshlrev_b32 v48, 1, v48
    v_lshrrev_b32 v55, 1, v42
    v_xor_b32 v48, v48, v55
    v_lshlrev_b32 v47, 6, v47
    v_lshl_add_u32 v47, v48, 4, v47
    v_and_b32 v48, 1, v42
    v_lshl_add_u32 v47, v48, 3, v47
    v_add_u32 v53, 32704, v47
    v_xor_b32 v54, 32, v53
    v_and_b32 v47, 1, v1
    v_mul_u32_u24 v55, 10304, v47
    v_bfe_u32 v48, v1, 1, 3
    v_lshl_add_u32 v55, v48, 6, v55
    v_lshl_add_u32 v55, v41, 4, v55
    s_mul_i32 s35, s20, 3072
    s_add_u32 s35, s35, 31680
    v_add_u32 v56, s35, v55
    v_xor_b32 v57, 32, v56
    s_mul_i32 s35, s20, 48
    s_sub_u32 s35, s35, 17
    v_add_u32 v122, v48, v47
    v_add_u32 v122, s35, v122
    s_mov_b32 s35, 344064
    v_mul_lo_u32 v58, v48, s35
    v_and_b32 v47, 1, v1
    v_lshl_add_u32 v58, v47, 6, v58
    v_lshl_add_u32 v58, v41, 4, v58
    s_mov_b32 s36, 0xbdd2d3e8
    v_mov_b32 v59, 0xc0135761
    s_add_u32 s16, s4, 49815552
    s_addc_u32 s17, s5, 0
    s_mov_b32 s18, 11010048
    s_mov_b32 s19, 0x00020000
    s_mul_i32 s37, s20, 2752512
    s_mul_i32 s38, s24, 84
    s_mul_i32 s39, s26, 3
    s_add_u32 s38, s38, s39
    s_lshl_b32 s38, s38, 11
    s_add_u32 s37, s37, s38
    s_lshl_b32 s38, s27, 7
    s_add_u32 s37, s37, s38
    s_waitcnt vmcnt(2)
    ds_read_b64_tr_b16 v[60:61], v44 offset:0
    ds_read_b64_tr_b16 v[62:63], v44 offset:256
    ds_read_b64_tr_b16 v[64:65], v44 offset:2048
    ds_read_b64_tr_b16 v[66:67], v44 offset:2304
    ds_read_b64_tr_b16 v[68:69], v45 offset:0
    ds_read_b64_tr_b16 v[70:71], v45 offset:256
    ds_read_b64_tr_b16 v[72:73], v45 offset:2048
    ds_read_b64_tr_b16 v[74:75], v45 offset:2304
    s_waitcnt lgkmcnt(0)
    v_mfma_f32_16x16x32_bf16 v[76:79], v[60:63], v[8:11], 0
    v_mfma_f32_16x16x32_bf16 v[80:83], v[68:71], v[8:11], 0
    v_mfma_f32_16x16x32_bf16 v[84:87], v[60:63], v[16:19], 0
    v_mfma_f32_16x16x32_bf16 v[88:91], v[68:71], v[16:19], 0
    v_mfma_f32_16x16x32_bf16 v[92:95], v[60:63], v[24:27], 0
    v_mfma_f32_16x16x32_bf16 v[96:99], v[68:71], v[24:27], 0
    v_mfma_f32_16x16x32_bf16 v[76:79], v[64:67], v[12:15], v[76:79]
    v_mfma_f32_16x16x32_bf16 v[80:83], v[72:75], v[12:15], v[80:83]
    v_mfma_f32_16x16x32_bf16 v[84:87], v[64:67], v[20:23], v[84:87]
    v_mfma_f32_16x16x32_bf16 v[88:91], v[72:75], v[20:23], v[88:91]
    v_mfma_f32_16x16x32_bf16 v[92:95], v[64:67], v[28:31], v[92:95]
    v_mfma_f32_16x16x32_bf16 v[96:99], v[72:75], v[28:31], v[96:99]
    s_add_u32 s31, s28, 0
    s_cmp_eq_u32 s31, 166
    s_cselect_b32 s39, 0, -1
    s_nop 4
    v_mul_f32 v100, v76, v76
    v_mul_f32 v101, v77, v77
    v_mul_f32 v102, v78, v78
    v_mul_f32 v103, v79, v79
    v_mul_f32 v104, v80, v80
    v_mul_f32 v105, v81, v81
    v_mul_f32 v106, v82, v82
    v_mul_f32 v107, v83, v83
    v_fma_f32 v100, v100, s36, v59
    v_fma_f32 v101, v101, s36, v59
    v_fma_f32 v102, v102, s36, v59
    v_fma_f32 v103, v103, s36, v59
    v_fma_f32 v104, v104, s36, v59
    v_fma_f32 v105, v105, s36, v59
    v_fma_f32 v106, v106, s36, v59
    v_fma_f32 v107, v107, s36, v59
    v_mul_f32 v100, v100, v76
    v_mul_f32 v101, v101, v77
    v_mul_f32 v102, v102, v78
    v_mul_f32 v103, v103, v79
    v_mul_f32 v104, v104, v80
    v_mul_f32 v105, v105, v81
    v_mul_f32 v106, v106, v82
    v_mul_f32 v107, v107, v83
    v_exp_f32 v100, v100
    v_exp_f32 v101, v101
    v_exp_f32 v102, v102
    v_exp_f32 v103, v103
    v_exp_f32 v104, v104
    v_exp_f32 v105, v105
    v_exp_f32 v106, v106
    v_exp_f32 v107, v107
    v_add_f32 v100, 1.0, v100
    v_add_f32 v101, 1.0, v101
    v_add_f32 v102, 1.0, v102
    v_add_f32 v103, 1.0, v103
    v_add_f32 v104, 1.0, v104
    v_add_f32 v105, 1.0, v105
    v_add_f32 v106, 1.0, v106
    v_add_f32 v107, 1.0, v107
    v_rcp_f32 v100, v100
    v_rcp_f32 v101, v101
    v_rcp_f32 v102, v102
    v_rcp_f32 v103, v103
    v_rcp_f32 v104, v104
    v_rcp_f32 v105, v105
    v_rcp_f32 v106, v106
    v_rcp_f32 v107, v107
    v_mul_f32 v76, v76, v100
    v_mul_f32 v77, v77, v101
    v_mul_f32 v78, v78, v102
    v_mul_f32 v79, v79, v103
    v_mul_f32 v80, v80, v104
    v_mul_f32 v81, v81, v105
    v_mul_f32 v82, v82, v106
    v_mul_f32 v83, v83, v107
    v_cvt_pk_bf16_f32 v108, v76, v77
    v_cvt_pk_bf16_f32 v109, v78, v79
    v_cvt_pk_bf16_f32 v110, v80, v81
    v_cvt_pk_bf16_f32 v111, v82, v83
    v_add_u32 v123, 0, v122
    v_cmp_gt_u32 vcc, 160, v123
    s_nop 0
    s_and_saveexec_b64 s[40:41], vcc
    ds_write_b128 v56, v[108:111] offset:0
    s_mov_b64 exec, s[40:41]
    v_mul_f32 v100, v84, v84
    v_mul_f32 v101, v85, v85
    v_mul_f32 v102, v86, v86
    v_mul_f32 v103, v87, v87
    v_mul_f32 v104, v88, v88
    v_mul_f32 v105, v89, v89
    v_mul_f32 v106, v90, v90
    v_mul_f32 v107, v91, v91
    v_fma_f32 v100, v100, s36, v59
    v_fma_f32 v101, v101, s36, v59
    v_fma_f32 v102, v102, s36, v59
    v_fma_f32 v103, v103, s36, v59
    v_fma_f32 v104, v104, s36, v59
    v_fma_f32 v105, v105, s36, v59
    v_fma_f32 v106, v106, s36, v59
    v_fma_f32 v107, v107, s36, v59
    v_mul_f32 v100, v100, v84
    v_mul_f32 v101, v101, v85
    v_mul_f32 v102, v102, v86
    v_mul_f32 v103, v103, v87
    v_mul_f32 v104, v104, v88
    v_mul_f32 v105, v105, v89
    v_mul_f32 v106, v106, v90
    v_mul_f32 v107, v107, v91
    v_exp_f32 v100, v100
    v_exp_f32 v101, v101
    v_exp_f32 v102, v102
    v_exp_f32 v103, v103
    v_exp_f32 v104, v104
    v_exp_f32 v105, v105
    v_exp_f32 v106, v106
    v_exp_f32 v107, v107
    v_add_f32 v100, 1.0, v100
    v_add_f32 v101, 1.0, v101
    v_add_f32 v102, 1.0, v102
    v_add_f32 v103, 1.0, v103
    v_add_f32 v104, 1.0, v104
    v_add_f32 v105, 1.0, v105
    v_add_f32 v106, 1.0, v106
    v_add_f32 v107, 1.0, v107
    v_rcp_f32 v100, v100
    v_rcp_f32 v101, v101
    v_rcp_f32 v102, v102
    v_rcp_f32 v103, v103
    v_rcp_f32 v104, v104
    v_rcp_f32 v105, v105
    v_rcp_f32 v106, v106
    v_rcp_f32 v107, v107
    v_mul_f32 v84, v84, v100
    v_mul_f32 v85, v85, v101
    v_mul_f32 v86, v86, v102
    v_mul_f32 v87, v87, v103
    v_mul_f32 v88, v88, v104
    v_mul_f32 v89, v89, v105
    v_mul_f32 v90, v90, v106
    v_mul_f32 v91, v91, v107
    v_cvt_pk_bf16_f32 v112, v84, v85
    v_cvt_pk_bf16_f32 v113, v86, v87
    v_cvt_pk_bf16_f32 v114, v88, v89
    v_cvt_pk_bf16_f32 v115, v90, v91
    v_add_u32 v123, 8, v122
    v_cmp_gt_u32 vcc, 160, v123
    s_nop 0
    s_and_saveexec_b64 s[40:41], vcc
    ds_write_b128 v57, v[112:115] offset:512
    s_mov_b64 exec, s[40:41]
    v_mul_f32 v100, v92, v92
    v_mul_f32 v101, v93, v93
    v_mul_f32 v102, v94, v94
    v_mul_f32 v103, v95, v95
    v_mul_f32 v104, v96, v96
    v_mul_f32 v105, v97, v97
    v_mul_f32 v106, v98, v98
    v_mul_f32 v107, v99, v99
    v_fma_f32 v100, v100, s36, v59
    v_fma_f32 v101, v101, s36, v59
    v_fma_f32 v102, v102, s36, v59
    v_fma_f32 v103, v103, s36, v59
    v_fma_f32 v104, v104, s36, v59
    v_fma_f32 v105, v105, s36, v59
    v_fma_f32 v106, v106, s36, v59
    v_fma_f32 v107, v107, s36, v59
    v_mul_f32 v100, v100, v92
    v_mul_f32 v101, v101, v93
    v_mul_f32 v102, v102, v94
    v_mul_f32 v103, v103, v95
    v_mul_f32 v104, v104, v96
    v_mul_f32 v105, v105, v97
    v_mul_f32 v106, v106, v98
    v_mul_f32 v107, v107, v99
    v_exp_f32 v100, v100
    v_exp_f32 v101, v101
    v_exp_f32 v102, v102
    v_exp_f32 v103, v103
    v_exp_f32 v104, v104
    v_exp_f32 v105, v105
    v_exp_f32 v106, v106
    v_exp_f32 v107, v107
    v_add_f32 v100, 1.0, v100
    v_add_f32 v101, 1.0, v101
    v_add_f32 v102, 1.0, v102
    v_add_f32 v103, 1.0, v103
    v_add_f32 v104, 1.0, v104
    v_add_f32 v105, 1.0, v105
    v_add_f32 v106, 1.0, v106
    v_add_f32 v107, 1.0, v107
    v_rcp_f32 v100, v100
    v_rcp_f32 v101, v101
    v_rcp_f32 v102, v102
    v_rcp_f32 v103, v103
    v_rcp_f32 v104, v104
    v_rcp_f32 v105, v105
    v_rcp_f32 v106, v106
    v_rcp_f32 v107, v107
    v_mul_f32 v92, v92, v100
    v_mul_f32 v93, v93, v101
    v_mul_f32 v94, v94, v102
    v_mul_f32 v95, v95, v103
    v_mul_f32 v96, v96, v104
    v_mul_f32 v97, v97, v105
    v_mul_f32 v98, v98, v106
    v_mul_f32 v99, v99, v107
    v_cvt_pk_bf16_f32 v116, v92, v93
    v_cvt_pk_bf16_f32 v117, v94, v95
    v_cvt_pk_bf16_f32 v118, v96, v97
    v_cvt_pk_bf16_f32 v119, v98, v99
    v_and_b32 v116, s39, v116
    v_and_b32 v117, s39, v117
    v_and_b32 v118, s39, v118
    v_and_b32 v119, s39, v119
    v_add_u32 v123, 16, v122
    v_cmp_gt_u32 vcc, 160, v123
    s_nop 0
    s_and_saveexec_b64 s[40:41], vcc
    ds_write_b128 v56, v[116:119] offset:1024
    s_mov_b64 exec, s[40:41]
    ds_read_b64_tr_b16 v[60:61], v44 offset:4096
    ds_read_b64_tr_b16 v[62:63], v44 offset:4352
    ds_read_b64_tr_b16 v[64:65], v44 offset:6144
    ds_read_b64_tr_b16 v[66:67], v44 offset:6400
    ds_read_b64_tr_b16 v[68:69], v45 offset:4096
    ds_read_b64_tr_b16 v[70:71], v45 offset:4352
    ds_read_b64_tr_b16 v[72:73], v45 offset:6144
    ds_read_b64_tr_b16 v[74:75], v45 offset:6400
    s_waitcnt lgkmcnt(0)
    v_mfma_f32_16x16x32_bf16 v[76:79], v[60:63], v[8:11], 0
    v_mfma_f32_16x16x32_bf16 v[80:83], v[68:71], v[8:11], 0
    v_mfma_f32_16x16x32_bf16 v[84:87], v[60:63], v[16:19], 0
    v_mfma_f32_16x16x32_bf16 v[88:91], v[68:71], v[16:19], 0
    v_mfma_f32_16x16x32_bf16 v[92:95], v[60:63], v[24:27], 0
    v_mfma_f32_16x16x32_bf16 v[96:99], v[68:71], v[24:27], 0
    v_mfma_f32_16x16x32_bf16 v[76:79], v[64:67], v[12:15], v[76:79]
    v_mfma_f32_16x16x32_bf16 v[80:83], v[72:75], v[12:15], v[80:83]
    v_mfma_f32_16x16x32_bf16 v[84:87], v[64:67], v[20:23], v[84:87]
    v_mfma_f32_16x16x32_bf16 v[88:91], v[72:75], v[20:23], v[88:91]
    v_mfma_f32_16x16x32_bf16 v[92:95], v[64:67], v[28:31], v[92:95]
    v_mfma_f32_16x16x32_bf16 v[96:99], v[72:75], v[28:31], v[96:99]
    s_add_u32 s31, s28, 1
    s_cmp_eq_u32 s31, 166
    s_cselect_b32 s39, 0, -1
    s_nop 4
    v_mul_f32 v100, v76, v76
    v_mul_f32 v101, v77, v77
    v_mul_f32 v102, v78, v78
    v_mul_f32 v103, v79, v79
    v_mul_f32 v104, v80, v80
    v_mul_f32 v105, v81, v81
    v_mul_f32 v106, v82, v82
    v_mul_f32 v107, v83, v83
    v_fma_f32 v100, v100, s36, v59
    v_fma_f32 v101, v101, s36, v59
    v_fma_f32 v102, v102, s36, v59
    v_fma_f32 v103, v103, s36, v59
    v_fma_f32 v104, v104, s36, v59
    v_fma_f32 v105, v105, s36, v59
    v_fma_f32 v106, v106, s36, v59
    v_fma_f32 v107, v107, s36, v59
    v_mul_f32 v100, v100, v76
    v_mul_f32 v101, v101, v77
    v_mul_f32 v102, v102, v78
    v_mul_f32 v103, v103, v79
    v_mul_f32 v104, v104, v80
    v_mul_f32 v105, v105, v81
    v_mul_f32 v106, v106, v82
    v_mul_f32 v107, v107, v83
    v_exp_f32 v100, v100
    v_exp_f32 v101, v101
    v_exp_f32 v102, v102
    v_exp_f32 v103, v103
    v_exp_f32 v104, v104
    v_exp_f32 v105, v105
    v_exp_f32 v106, v106
    v_exp_f32 v107, v107
    v_add_f32 v100, 1.0, v100
    v_add_f32 v101, 1.0, v101
    v_add_f32 v102, 1.0, v102
    v_add_f32 v103, 1.0, v103
    v_add_f32 v104, 1.0, v104
    v_add_f32 v105, 1.0, v105
    v_add_f32 v106, 1.0, v106
    v_add_f32 v107, 1.0, v107
    v_rcp_f32 v100, v100
    v_rcp_f32 v101, v101
    v_rcp_f32 v102, v102
    v_rcp_f32 v103, v103
    v_rcp_f32 v104, v104
    v_rcp_f32 v105, v105
    v_rcp_f32 v106, v106
    v_rcp_f32 v107, v107
    v_mul_f32 v76, v76, v100
    v_mul_f32 v77, v77, v101
    v_mul_f32 v78, v78, v102
    v_mul_f32 v79, v79, v103
    v_mul_f32 v80, v80, v104
    v_mul_f32 v81, v81, v105
    v_mul_f32 v82, v82, v106
    v_mul_f32 v83, v83, v107
    v_cvt_pk_bf16_f32 v108, v76, v77
    v_cvt_pk_bf16_f32 v109, v78, v79
    v_cvt_pk_bf16_f32 v110, v80, v81
    v_cvt_pk_bf16_f32 v111, v82, v83
    v_add_u32 v123, 24, v122
    v_cmp_gt_u32 vcc, 160, v123
    s_nop 0
    s_and_saveexec_b64 s[40:41], vcc
    ds_write_b128 v57, v[108:111] offset:1536
    s_mov_b64 exec, s[40:41]
    v_mul_f32 v100, v84, v84
    v_mul_f32 v101, v85, v85
    v_mul_f32 v102, v86, v86
    v_mul_f32 v103, v87, v87
    v_mul_f32 v104, v88, v88
    v_mul_f32 v105, v89, v89
    v_mul_f32 v106, v90, v90
    v_mul_f32 v107, v91, v91
    v_fma_f32 v100, v100, s36, v59
    v_fma_f32 v101, v101, s36, v59
    v_fma_f32 v102, v102, s36, v59
    v_fma_f32 v103, v103, s36, v59
    v_fma_f32 v104, v104, s36, v59
    v_fma_f32 v105, v105, s36, v59
    v_fma_f32 v106, v106, s36, v59
    v_fma_f32 v107, v107, s36, v59
    v_mul_f32 v100, v100, v84
    v_mul_f32 v101, v101, v85
    v_mul_f32 v102, v102, v86
    v_mul_f32 v103, v103, v87
    v_mul_f32 v104, v104, v88
    v_mul_f32 v105, v105, v89
    v_mul_f32 v106, v106, v90
    v_mul_f32 v107, v107, v91
    v_exp_f32 v100, v100
    v_exp_f32 v101, v101
    v_exp_f32 v102, v102
    v_exp_f32 v103, v103
    v_exp_f32 v104, v104
    v_exp_f32 v105, v105
    v_exp_f32 v106, v106
    v_exp_f32 v107, v107
    v_add_f32 v100, 1.0, v100
    v_add_f32 v101, 1.0, v101
    v_add_f32 v102, 1.0, v102
    v_add_f32 v103, 1.0, v103
    v_add_f32 v104, 1.0, v104
    v_add_f32 v105, 1.0, v105
    v_add_f32 v106, 1.0, v106
    v_add_f32 v107, 1.0, v107
    v_rcp_f32 v100, v100
    v_rcp_f32 v101, v101
    v_rcp_f32 v102, v102
    v_rcp_f32 v103, v103
    v_rcp_f32 v104, v104
    v_rcp_f32 v105, v105
    v_rcp_f32 v106, v106
    v_rcp_f32 v107, v107
    v_mul_f32 v84, v84, v100
    v_mul_f32 v85, v85, v101
    v_mul_f32 v86, v86, v102
    v_mul_f32 v87, v87, v103
    v_mul_f32 v88, v88, v104
    v_mul_f32 v89, v89, v105
    v_mul_f32 v90, v90, v106
    v_mul_f32 v91, v91, v107
    v_cvt_pk_bf16_f32 v112, v84, v85
    v_cvt_pk_bf16_f32 v113, v86, v87
    v_cvt_pk_bf16_f32 v114, v88, v89
    v_cvt_pk_bf16_f32 v115, v90, v91
    v_add_u32 v123, 32, v122
    v_cmp_gt_u32 vcc, 160, v123
    s_nop 0
    s_and_saveexec_b64 s[40:41], vcc
    ds_write_b128 v56, v[112:115] offset:2048
    s_mov_b64 exec, s[40:41]
    v_mul_f32 v100, v92, v92
    v_mul_f32 v101, v93, v93
    v_mul_f32 v102, v94, v94
    v_mul_f32 v103, v95, v95
    v_mul_f32 v104, v96, v96
    v_mul_f32 v105, v97, v97
    v_mul_f32 v106, v98, v98
    v_mul_f32 v107, v99, v99
    v_fma_f32 v100, v100, s36, v59
    v_fma_f32 v101, v101, s36, v59
    v_fma_f32 v102, v102, s36, v59
    v_fma_f32 v103, v103, s36, v59
    v_fma_f32 v104, v104, s36, v59
    v_fma_f32 v105, v105, s36, v59
    v_fma_f32 v106, v106, s36, v59
    v_fma_f32 v107, v107, s36, v59
    v_mul_f32 v100, v100, v92
    v_mul_f32 v101, v101, v93
    v_mul_f32 v102, v102, v94
    v_mul_f32 v103, v103, v95
    v_mul_f32 v104, v104, v96
    v_mul_f32 v105, v105, v97
    v_mul_f32 v106, v106, v98
    v_mul_f32 v107, v107, v99
    v_exp_f32 v100, v100
    v_exp_f32 v101, v101
    v_exp_f32 v102, v102
    v_exp_f32 v103, v103
    v_exp_f32 v104, v104
    v_exp_f32 v105, v105
    v_exp_f32 v106, v106
    v_exp_f32 v107, v107
    v_add_f32 v100, 1.0, v100
    v_add_f32 v101, 1.0, v101
    v_add_f32 v102, 1.0, v102
    v_add_f32 v103, 1.0, v103
    v_add_f32 v104, 1.0, v104
    v_add_f32 v105, 1.0, v105
    v_add_f32 v106, 1.0, v106
    v_add_f32 v107, 1.0, v107
    v_rcp_f32 v100, v100
    v_rcp_f32 v101, v101
    v_rcp_f32 v102, v102
    v_rcp_f32 v103, v103
    v_rcp_f32 v104, v104
    v_rcp_f32 v105, v105
    v_rcp_f32 v106, v106
    v_rcp_f32 v107, v107
    v_mul_f32 v92, v92, v100
    v_mul_f32 v93, v93, v101
    v_mul_f32 v94, v94, v102
    v_mul_f32 v95, v95, v103
    v_mul_f32 v96, v96, v104
    v_mul_f32 v97, v97, v105
    v_mul_f32 v98, v98, v106
    v_mul_f32 v99, v99, v107
    v_cvt_pk_bf16_f32 v116, v92, v93
    v_cvt_pk_bf16_f32 v117, v94, v95
    v_cvt_pk_bf16_f32 v118, v96, v97
    v_cvt_pk_bf16_f32 v119, v98, v99
    v_and_b32 v116, s39, v116
    v_and_b32 v117, s39, v117
    v_and_b32 v118, s39, v118
    v_and_b32 v119, s39, v119
    v_add_u32 v123, 40, v122
    v_cmp_gt_u32 vcc, 160, v123
    s_nop 0
    s_and_saveexec_b64 s[40:41], vcc
    ds_write_b128 v57, v[116:119] offset:2560
    s_mov_b64 exec, s[40:41]
    s_waitcnt vmcnt(0)
    s_waitcnt lgkmcnt(0)
    s_barrier
    ds_read_b64_tr_b16 v[60:61], v49 offset:0
    ds_read_b64_tr_b16 v[62:63], v49 offset:256
    ds_read_b64_tr_b16 v[64:65], v49 offset:2048
    ds_read_b64_tr_b16 v[66:67], v49 offset:2304
    ds_read_b64_tr_b16 v[68:69], v50 offset:0
    ds_read_b64_tr_b16 v[70:71], v50 offset:256
    ds_read_b64_tr_b16 v[72:73], v50 offset:2048
    ds_read_b64_tr_b16 v[74:75], v50 offset:2304
    s_waitcnt lgkmcnt(0)
    v_mfma_f32_16x16x32_bf16 v[92:95], v[60:63], v[32:35], 0
    v_mfma_f32_16x16x32_bf16 v[96:99], v[68:71], v[32:35], 0
    v_mfma_f32_16x16x32_bf16 v[92:95], v[64:67], v[36:39], v[92:95]
    v_mfma_f32_16x16x32_bf16 v[96:99], v[72:75], v[36:39], v[96:99]
    ds_read_b64_tr_b16 v[76:77], v51 offset:0
    ds_read_b64_tr_b16 v[78:79], v53 offset:0
    ds_read_b64_tr_b16 v[80:81], v51 offset:2048
    ds_read_b64_tr_b16 v[82:83], v53 offset:2048
    ds_read_b64_tr_b16 v[84:85], v52 offset:0
    ds_read_b64_tr_b16 v[86:87], v54 offset:0
    ds_read_b64_tr_b16 v[88:89], v52 offset:2048
    ds_read_b64_tr_b16 v[90:91], v54 offset:2048
    v_cvt_pk_bf16_f32 v108, v92, v93
    v_cvt_pk_bf16_f32 v109, v94, v95
    v_cvt_pk_bf16_f32 v110, v96, v97
    v_cvt_pk_bf16_f32 v111, v98, v99
    s_add_u32 s38, s37, 0
    buffer_store_dwordx4 v[108:111], v58, s[16:19], s38 offen sc1
    s_waitcnt lgkmcnt(0)
    v_mfma_f32_16x16x32_bf16 v[100:103], v[76:79], v[32:35], 0
    v_mfma_f32_16x16x32_bf16 v[104:107], v[84:87], v[32:35], 0
    v_mfma_f32_16x16x32_bf16 v[100:103], v[80:83], v[36:39], v[100:103]
    v_mfma_f32_16x16x32_bf16 v[104:107], v[88:91], v[36:39], v[104:107]
    ds_read_b64_tr_b16 v[60:61], v49 offset:3072
    ds_read_b64_tr_b16 v[62:63], v49 offset:3328
    ds_read_b64_tr_b16 v[64:65], v49 offset:5120
    ds_read_b64_tr_b16 v[66:67], v49 offset:5376
    ds_read_b64_tr_b16 v[68:69], v50 offset:3072
    ds_read_b64_tr_b16 v[70:71], v50 offset:3328
    ds_read_b64_tr_b16 v[72:73], v50 offset:5120
    ds_read_b64_tr_b16 v[74:75], v50 offset:5376
    v_cvt_pk_bf16_f32 v112, v100, v101
    v_cvt_pk_bf16_f32 v113, v102, v103
    v_cvt_pk_bf16_f32 v114, v104, v105
    v_cvt_pk_bf16_f32 v115, v106, v107
    s_add_u32 s38, s37, 1024
    buffer_store_dwordx4 v[112:115], v58, s[16:19], s38 offen sc1
    s_waitcnt lgkmcnt(0)
    v_mfma_f32_16x16x32_bf16 v[92:95], v[60:63], v[32:35], 0
    v_mfma_f32_16x16x32_bf16 v[96:99], v[68:71], v[32:35], 0
    v_mfma_f32_16x16x32_bf16 v[92:95], v[64:67], v[36:39], v[92:95]
    v_mfma_f32_16x16x32_bf16 v[96:99], v[72:75], v[36:39], v[96:99]
    ds_read_b64_tr_b16 v[76:77], v51 offset:3072
    ds_read_b64_tr_b16 v[78:79], v53 offset:3072
    ds_read_b64_tr_b16 v[80:81], v51 offset:5120
    ds_read_b64_tr_b16 v[82:83], v53 offset:5120
    ds_read_b64_tr_b16 v[84:85], v52 offset:3072
    ds_read_b64_tr_b16 v[86:87], v54 offset:3072
    ds_read_b64_tr_b16 v[88:89], v52 offset:5120
    ds_read_b64_tr_b16 v[90:91], v54 offset:5120
    v_cvt_pk_bf16_f32 v108, v92, v93
    v_cvt_pk_bf16_f32 v109, v94, v95
    v_cvt_pk_bf16_f32 v110, v96, v97
    v_cvt_pk_bf16_f32 v111, v98, v99
    s_add_u32 s38, s37, 2048
    buffer_store_dwordx4 v[108:111], v58, s[16:19], s38 offen sc1
    s_waitcnt lgkmcnt(0)
    v_mfma_f32_16x16x32_bf16 v[100:103], v[76:79], v[32:35], 0
    v_mfma_f32_16x16x32_bf16 v[104:107], v[84:87], v[32:35], 0
    v_mfma_f32_16x16x32_bf16 v[100:103], v[80:83], v[36:39], v[100:103]
    v_mfma_f32_16x16x32_bf16 v[104:107], v[88:91], v[36:39], v[104:107]
    ds_read_b64_tr_b16 v[60:61], v49 offset:6144
    ds_read_b64_tr_b16 v[62:63], v49 offset:6400
    ds_read_b64_tr_b16 v[64:65], v49 offset:8192
    ds_read_b64_tr_b16 v[66:67], v49 offset:8448
    ds_read_b64_tr_b16 v[68:69], v50 offset:6144
    ds_read_b64_tr_b16 v[70:71], v50 offset:6400
    ds_read_b64_tr_b16 v[72:73], v50 offset:8192
    ds_read_b64_tr_b16 v[74:75], v50 offset:8448
    v_cvt_pk_bf16_f32 v112, v100, v101
    v_cvt_pk_bf16_f32 v113, v102, v103
    v_cvt_pk_bf16_f32 v114, v104, v105
    v_cvt_pk_bf16_f32 v115, v106, v107
    s_add_u32 s38, s37, 3072
    buffer_store_dwordx4 v[112:115], v58, s[16:19], s38 offen sc1
    s_waitcnt lgkmcnt(0)
    v_mfma_f32_16x16x32_bf16 v[92:95], v[60:63], v[32:35], 0
    v_mfma_f32_16x16x32_bf16 v[96:99], v[68:71], v[32:35], 0
    v_mfma_f32_16x16x32_bf16 v[92:95], v[64:67], v[36:39], v[92:95]
    v_mfma_f32_16x16x32_bf16 v[96:99], v[72:75], v[36:39], v[96:99]
    ds_read_b64_tr_b16 v[76:77], v51 offset:6144
    ds_read_b64_tr_b16 v[78:79], v53 offset:6144
    ds_read_b64_tr_b16 v[80:81], v51 offset:8192
    ds_read_b64_tr_b16 v[82:83], v53 offset:8192
    ds_read_b64_tr_b16 v[84:85], v52 offset:6144
    ds_read_b64_tr_b16 v[86:87], v54 offset:6144
    ds_read_b64_tr_b16 v[88:89], v52 offset:8192
    ds_read_b64_tr_b16 v[90:91], v54 offset:8192
    v_cvt_pk_bf16_f32 v108, v92, v93
    v_cvt_pk_bf16_f32 v109, v94, v95
    v_cvt_pk_bf16_f32 v110, v96, v97
    v_cvt_pk_bf16_f32 v111, v98, v99
    s_add_u32 s38, s37, 4096
    buffer_store_dwordx4 v[108:111], v58, s[16:19], s38 offen sc1
    s_waitcnt lgkmcnt(0)
    v_mfma_f32_16x16x32_bf16 v[100:103], v[76:79], v[32:35], 0
    v_mfma_f32_16x16x32_bf16 v[104:107], v[84:87], v[32:35], 0
    v_mfma_f32_16x16x32_bf16 v[100:103], v[80:83], v[36:39], v[100:103]
    v_mfma_f32_16x16x32_bf16 v[104:107], v[88:91], v[36:39], v[104:107]
    s_nop 7
    v_cvt_pk_bf16_f32 v112, v100, v101
    v_cvt_pk_bf16_f32 v113, v102, v103
    v_cvt_pk_bf16_f32 v114, v104, v105
    v_cvt_pk_bf16_f32 v115, v106, v107
    s_add_u32 s38, s37, 5120
    buffer_store_dwordx4 v[112:115], v58, s[16:19], s38 offen sc1
    s_endpgm
L_mid_kernel_g:
    s_sub_u32 s3, s2, 448
    s_load_dwordx2 s[4:5], s[0:1], 16
    s_load_dwordx2 s[6:7], s[0:1], 72
    s_lshr_b32 s24, s3, 4
    s_bfe_u32 s25, s3, 0x20002
    s_and_b32 s26, s3, 3
    s_lshr_b32 s27, s24, 3
    s_and_b32 s28, s24, 7
    v_and_b32 v1, 63, v0
    v_lshrrev_b32 v2, 3, v1
    v_mov_b32 v3, v2
    s_lshl_b32 s29, s25, 3
    s_lshl_b32 s30, s28, 5
    s_add_u32 s29, s29, s30
    v_add_u32 v3, s29, v3
    v_lshlrev_b32 v3, 9, v3
    v_and_b32 v4, 7, v1
    s_lshr_b32 s30, s20, 1
    s_lshl_b32 s30, s30, 2
    v_xor_b32 v4, s30, v4
    v_lshl_add_u32 v3, v4, 4, v3
    s_lshl_b32 s30, s26, 7
    v_add_u32 v3, s30, v3
    v_xor_b32 v4, 32, v3
    s_waitcnt lgkmcnt(0)
    s_mov_b32 s8, s4
    s_mov_b32 s9, s5
    s_mov_b32 s10, 4063232
    s_mov_b32 s11, 0x00020000
    s_add_u32 s12, s6, 60891136
    s_addc_u32 s13, s7, 0
    s_mov_b32 s14, 16916480
    s_mov_b32 s15, 0x00020000
    s_lshl_b32 s30, s20, 3
    s_add_u32 s30, s30, s27
    s_lshl_b32 s30, s30, 17
    s_mul_i32 s31, s20, 4608
    s_add_u32 m0, s31, 0
    s_add_u32 s32, s30, 0
    buffer_load_dwordx4 v3, s[8:11], s32 offen nt lds
    s_add_u32 m0, s31, 1152
    s_add_u32 s32, s30, 262144
    buffer_load_dwordx4 v3, s[8:11], s32 offen nt lds
    s_add_u32 m0, s31, 2304
    s_add_u32 s32, s30, 524288
    buffer_load_dwordx4 v4, s[8:11], s32 offen nt lds
    s_add_u32 m0, s31, 3456
    s_add_u32 s32, s30, 786432
    buffer_load_dwordx4 v4, s[8:11], s32 offen nt lds
    v_and_b32 v8, 15, v1
    v_or_b32 v9, 1, v8
    s_lshl_b32 s33, s20, 4
    v_add_u32 v9, s33, v9
    v_cvt_f32_u32 v9, v9
    v_mul_f32 v9, 0x3c000000, v9
    v_bfe_u32 v10, v1, 4, 1
    v_lshlrev_b32 v10, 3, v10
    v_cvt_f32_u32 v10, v10
    v_and_b32 v8, 1, v8
    v_cvt_f32_u32 v8, v8
    v_mul_f32 v8, 0x3f400000, v8
    v_fma_f32 v11, v9, v10, v8
    v_fract_f32 v12, v11
    v_add_f32 v11, v11, v9
    v_fract_f32 v13, v11
    v_add_f32 v11, v11, v9
    v_fract_f32 v14, v11
    v_add_f32 v11, v11, v9
    v_fract_f32 v15, v11
    v_add_f32 v11, v11, v9
    v_fract_f32 v16, v11
    v_add_f32 v11, v11, v9
    v_fract_f32 v17, v11
    v_add_f32 v11, v11, v9
    v_fract_f32 v18, v11
    v_add_f32 v11, v11, v9
    v_fract_f32 v19, v11
    v_cos_f32 v12, v12
    v_cos_f32 v13, v13
    v_cos_f32 v14, v14
    v_cos_f32 v15, v15
    v_cos_f32 v16, v16
    v_cos_f32 v17, v17
    v_cos_f32 v18, v18
    v_cos_f32 v19, v19
    s_nop 0
    v_mul_f32 v12, 0x3d000000, v12
    v_mul_f32 v13, 0x3d000000, v13
    v_mul_f32 v14, 0x3d000000, v14
    v_mul_f32 v15, 0x3d000000, v15
    v_mul_f32 v16, 0x3d000000, v16
    v_mul_f32 v17, 0x3d000000, v17
    v_mul_f32 v18, 0x3d000000, v18
    v_mul_f32 v19, 0x3d000000, v19
    v_cvt_pk_bf16_f32 v20, v12, v13
    v_cvt_pk_bf16_f32 v21, v14, v15
    v_cvt_pk_bf16_f32 v22, v16, v17
    v_cvt_pk_bf16_f32 v23, v18, v19
    v_lshlrev_b32 v28, 16, v20
    v_and_b32 v29, 0xffff0000, v20
    v_sub_f32 v28, v12, v28
    v_sub_f32 v29, v13, v29
    v_cvt_pk_bf16_f32 v24, v28, v29
    v_lshlrev_b32 v28, 16, v21
    v_and_b32 v29, 0xffff0000, v21
    v_sub_f32 v28, v14, v28
    v_sub_f32 v29, v15, v29
    v_cvt_pk_bf16_f32 v25, v28, v29
    v_lshlrev_b32 v28, 16, v22
    v_and_b32 v29, 0xffff0000, v22
    v_sub_f32 v28, v16, v28
    v_sub_f32 v29, v17, v29
    v_cvt_pk_bf16_f32 v26, v28, v29
    v_lshlrev_b32 v28, 16, v23
    v_and_b32 v29, 0xffff0000, v23
    v_sub_f32 v28, v18, v28
    v_sub_f32 v29, v19, v29
    v_cvt_pk_bf16_f32 v27, v28, v29
    v_cmp_gt_u32 vcc, 32, v1
    s_nop 1
    v_cndmask_b32 v20, v24, v20, vcc
    v_cndmask_b32 v21, v25, v21, vcc
    v_cndmask_b32 v22, v26, v22, vcc
    v_cndmask_b32 v23, v27, v23, vcc
    v_lshlrev_b32 v28, 4, v1
    s_lshl_b32 s33, s20, 10
    v_add_u32 v29, s33, v28
    ds_write_b128 v29, v[20:23] offset:18432
    v_bfe_u32 v30, v1, 2, 2
    v_bfe_u32 v31, v1, 4, 1
    v_lshl_add_u32 v32, v31, 3, v30
    v_mul_u32_u24 v32, 1152, v32
    v_lshrrev_b32 v30, 1, v30
    v_lshl_add_u32 v30, v31, 1, v30
    v_lshlrev_b32 v30, 1, v30
    v_bfe_u32 v31, v1, 1, 1
    s_lshl_b32 s33, s20, 1
    v_add_u32 v31, s33, v31
    v_xor_b32 v30, v30, v31
    v_lshl_add_u32 v32, v30, 4, v32
    v_and_b32 v30, 1, v1
    v_lshl_add_u32 v32, v30, 3, v32
    v_lshrrev_b32 v30, 4, v1
    s_mov_b32 s33, 1057280
    v_mul_lo_u32 v30, v30, s33
    v_and_b32 v31, 15, v1
    v_lshl_add_u32 v33, v31, 4, v30
    s_lshl_b32 s34, s24, 15
    s_lshl_b32 s35, s26, 2
    s_add_u32 s35, s35, s20
    s_lshl_b32 s35, s35, 11
    s_add_u32 s34, s34, s35
    s_lshl_b32 s35, s25, 8
    s_add_u32 s34, s34, s35
    s_waitcnt vmcnt(0) lgkmcnt(0)
    s_barrier
    ds_read_b128 v[36:39], v28 offset:18432
    ds_read_b128 v[40:43], v28 offset:19456
    ds_read_b128 v[44:47], v28 offset:20480
    ds_read_b128 v[48:51], v28 offset:21504
    ds_read_b64_tr_b16 v[52:53], v32 offset:0
    ds_read_b64_tr_b16 v[54:55], v32 offset:4608
    ds_read_b64_tr_b16 v[56:57], v32 offset:128
    ds_read_b64_tr_b16 v[58:59], v32 offset:4736
    ds_read_b64_tr_b16 v[60:61], v32 offset:256
    ds_read_b64_tr_b16 v[62:63], v32 offset:4864
    ds_read_b64_tr_b16 v[64:65], v32 offset:384
    ds_read_b64_tr_b16 v[66:67], v32 offset:4992
    ds_read_b64_tr_b16 v[68:69], v32 offset:512
    ds_read_b64_tr_b16 v[70:71], v32 offset:5120
    s_waitcnt lgkmcnt(8)
    ds_read_b64_tr_b16 v[72:73], v32 offset:640
    ds_read_b64_tr_b16 v[74:75], v32 offset:5248
    ds_read_b64_tr_b16 v[76:77], v32 offset:768
    ds_read_b64_tr_b16 v[78:79], v32 offset:5376
    ds_read_b64_tr_b16 v[80:81], v32 offset:896
    ds_read_b64_tr_b16 v[82:83], v32 offset:5504
    s_waitcnt lgkmcnt(0)
    v_mfma_f32_16x16x32_bf16 v[84:87], v[36:39], v[52:55], 0
    v_mfma_f32_16x16x32_bf16 v[88:91], v[36:39], v[56:59], 0
    v_mfma_f32_16x16x32_bf16 v[92:95], v[36:39], v[60:63], 0
    v_mfma_f32_16x16x32_bf16 v[96:99], v[36:39], v[64:67], 0
    v_mfma_f32_16x16x32_bf16 v[100:103], v[36:39], v[68:71], 0
    v_mfma_f32_16x16x32_bf16 v[104:107], v[36:39], v[72:75], 0
    v_mfma_f32_16x16x32_bf16 v[108:111], v[36:39], v[76:79], 0
    v_mfma_f32_16x16x32_bf16 v[112:115], v[36:39], v[80:83], 0
    s_nop 7
    v_cvt_pk_bf16_f32 v116, v84, v88
    v_cvt_pk_bf16_f32 v117, v92, v96
    v_cvt_pk_bf16_f32 v118, v100, v104
    v_cvt_pk_bf16_f32 v119, v108, v112
    s_add_u32 s35, s34, 0
    buffer_store_dwordx4 v[116:119], v33, s[12:15], s35 offen sc1
    s_nop 1
    v_cvt_pk_bf16_f32 v120, v85, v89
    v_cvt_pk_bf16_f32 v121, v93, v97
    v_cvt_pk_bf16_f32 v122, v101, v105
    v_cvt_pk_bf16_f32 v123, v109, v113
    s_add_u32 s35, s34, 1024
    buffer_store_dwordx4 v[120:123], v33, s[12:15], s35 offen sc1
    s_nop 1
    v_cvt_pk_bf16_f32 v116, v86, v90
    v_cvt_pk_bf16_f32 v117, v94, v98
    v_cvt_pk_bf16_f32 v118, v102, v106
    v_cvt_pk_bf16_f32 v119, v110, v114
    s_add_u32 s35, s34, 528640
    buffer_store_dwordx4 v[116:119], v33, s[12:15], s35 offen sc1
    s_nop 1
    v_cvt_pk_bf16_f32 v120, v87, v91
    v_cvt_pk_bf16_f32 v121, v95, v99
    v_cvt_pk_bf16_f32 v122, v103, v107
    v_cvt_pk_bf16_f32 v123, v111, v115
    s_add_u32 s35, s34, 529664
    buffer_store_dwordx4 v[120:123], v33, s[12:15], s35 offen sc1
    s_nop 1
    v_mfma_f32_16x16x32_bf16 v[84:87], v[40:43], v[52:55], 0
    v_mfma_f32_16x16x32_bf16 v[88:91], v[40:43], v[56:59], 0
    v_mfma_f32_16x16x32_bf16 v[92:95], v[40:43], v[60:63], 0
    v_mfma_f32_16x16x32_bf16 v[96:99], v[40:43], v[64:67], 0
    v_mfma_f32_16x16x32_bf16 v[100:103], v[40:43], v[68:71], 0
    v_mfma_f32_16x16x32_bf16 v[104:107], v[40:43], v[72:75], 0
    v_mfma_f32_16x16x32_bf16 v[108:111], v[40:43], v[76:79], 0
    v_mfma_f32_16x16x32_bf16 v[112:115], v[40:43], v[80:83], 0
    s_nop 7
    v_cvt_pk_bf16_f32 v116, v84, v88
    v_cvt_pk_bf16_f32 v117, v92, v96
    v_cvt_pk_bf16_f32 v118, v100, v104
    v_cvt_pk_bf16_f32 v119, v108, v112
    s_add_u32 s35, s34, 4229120
    buffer_store_dwordx4 v[116:119], v33, s[12:15], s35 offen sc1
    s_nop 1
    v_cvt_pk_bf16_f32 v120, v85, v89
    v_cvt_pk_bf16_f32 v121, v93, v97
    v_cvt_pk_bf16_f32 v122, v101, v105
    v_cvt_pk_bf16_f32 v123, v109, v113
    s_add_u32 s35, s34, 4230144
    buffer_store_dwordx4 v[120:123], v33, s[12:15], s35 offen sc1
    s_nop 1
    v_cvt_pk_bf16_f32 v116, v86, v90
    v_cvt_pk_bf16_f32 v117, v94, v98
    v_cvt_pk_bf16_f32 v118, v102, v106
    v_cvt_pk_bf16_f32 v119, v110, v114
    s_add_u32 s35, s34, 4757760
    buffer_store_dwordx4 v[116:119], v33, s[12:15], s35 offen sc1
    s_nop 1
    v_cvt_pk_bf16_f32 v120, v87, v91
    v_cvt_pk_bf16_f32 v121, v95, v99
    v_cvt_pk_bf16_f32 v122, v103, v107
    v_cvt_pk_bf16_f32 v123, v111, v115
    s_add_u32 s35, s34, 4758784
    buffer_store_dwordx4 v[120:123], v33, s[12:15], s35 offen sc1
    s_nop 1
    v_mfma_f32_16x16x32_bf16 v[84:87], v[44:47], v[52:55], 0
    v_mfma_f32_16x16x32_bf16 v[88:91], v[44:47], v[56:59], 0
    v_mfma_f32_16x16x32_bf16 v[92:95], v[44:47], v[60:63], 0
    v_mfma_f32_16x16x32_bf16 v[96:99], v[44:47], v[64:67], 0
    v_mfma_f32_16x16x32_bf16 v[100:103], v[44:47], v[68:71], 0
    v_mfma_f32_16x16x32_bf16 v[104:107], v[44:47], v[72:75], 0
    v_mfma_f32_16x16x32_bf16 v[108:111], v[44:47], v[76:79], 0
    v_mfma_f32_16x16x32_bf16 v[112:115], v[44:47], v[80:83], 0
    s_nop 7
    v_cvt_pk_bf16_f32 v116, v84, v88
    v_cvt_pk_bf16_f32 v117, v92, v96
    v_cvt_pk_bf16_f32 v118, v100, v104
    v_cvt_pk_bf16_f32 v119, v108, v112
    s_add_u32 s35, s34, 8458240
    buffer_store_dwordx4 v[116:119], v33, s[12:15], s35 offen sc1
    s_nop 1
    v_cvt_pk_bf16_f32 v120, v85, v89
    v_cvt_pk_bf16_f32 v121, v93, v97
    v_cvt_pk_bf16_f32 v122, v101, v105
    v_cvt_pk_bf16_f32 v123, v109, v113
    s_add_u32 s35, s34, 8459264
    buffer_store_dwordx4 v[120:123], v33, s[12:15], s35 offen sc1
    s_nop 1
    v_cvt_pk_bf16_f32 v116, v86, v90
    v_cvt_pk_bf16_f32 v117, v94, v98
    v_cvt_pk_bf16_f32 v118, v102, v106
    v_cvt_pk_bf16_f32 v119, v110, v114
    s_add_u32 s35, s34, 8986880
    buffer_store_dwordx4 v[116:119], v33, s[12:15], s35 offen sc1
    s_nop 1
    v_cvt_pk_bf16_f32 v120, v87, v91
    v_cvt_pk_bf16_f32 v121, v95, v99
    v_cvt_pk_bf16_f32 v122, v103, v107
    v_cvt_pk_bf16_f32 v123, v111, v115
    s_add_u32 s35, s34, 8987904
    buffer_store_dwordx4 v[120:123], v33, s[12:15], s35 offen sc1
    s_nop 1
    v_mfma_f32_16x16x32_bf16 v[84:87], v[48:51], v[52:55], 0
    v_mfma_f32_16x16x32_bf16 v[88:91], v[48:51], v[56:59], 0
    v_mfma_f32_16x16x32_bf16 v[92:95], v[48:51], v[60:63], 0
    v_mfma_f32_16x16x32_bf16 v[96:99], v[48:51], v[64:67], 0
    v_mfma_f32_16x16x32_bf16 v[100:103], v[48:51], v[68:71], 0
    v_mfma_f32_16x16x32_bf16 v[104:107], v[48:51], v[72:75], 0
    v_mfma_f32_16x16x32_bf16 v[108:111], v[48:51], v[76:79], 0
    v_mfma_f32_16x16x32_bf16 v[112:115], v[48:51], v[80:83], 0
    s_nop 7
    v_cvt_pk_bf16_f32 v116, v84, v88
    v_cvt_pk_bf16_f32 v117, v92, v96
    v_cvt_pk_bf16_f32 v118, v100, v104
    v_cvt_pk_bf16_f32 v119, v108, v112
    s_add_u32 s35, s34, 12687360
    buffer_store_dwordx4 v[116:119], v33, s[12:15], s35 offen sc1
    s_nop 1
    v_cvt_pk_bf16_f32 v120, v85, v89
    v_cvt_pk_bf16_f32 v121, v93, v97
    v_cvt_pk_bf16_f32 v122, v101, v105
    v_cvt_pk_bf16_f32 v123, v109, v113
    s_add_u32 s35, s34, 12688384
    buffer_store_dwordx4 v[120:123], v33, s[12:15], s35 offen sc1
    s_nop 1
    v_cvt_pk_bf16_f32 v116, v86, v90
    v_cvt_pk_bf16_f32 v117, v94, v98
    v_cvt_pk_bf16_f32 v118, v102, v106
    v_cvt_pk_bf16_f32 v119, v110, v114
    s_add_u32 s35, s34, 13216000
    buffer_store_dwordx4 v[116:119], v33, s[12:15], s35 offen sc1
    s_nop 1
    v_cvt_pk_bf16_f32 v120, v87, v91
    v_cvt_pk_bf16_f32 v121, v95, v99
    v_cvt_pk_bf16_f32 v122, v103, v107
    v_cvt_pk_bf16_f32 v123, v111, v115
    s_add_u32 s35, s34, 13217024
    buffer_store_dwordx4 v[120:123], v33, s[12:15], s35 offen sc1
    s_nop 1
    s_endpgm
L_mid_kernel_done:
    s_endpgm
.globl gemm2_kernel
.p2align 8
.type gemm2_kernel,@function
gemm2_kernel:
    s_cmp_ge_u32 s2, 256
    s_cbranch_scc1 L_gemm2_kernel_done
    s_load_dwordx2 s[4:5], s[0:1], 72
    s_load_dwordx2 s[6:7], s[0:1], 72
    v_readfirstlane_b32 s20, v0
    s_lshr_b32 s20, s20, 6
    s_and_b32 s24, s2, 7
    s_lshr_b32 s25, s2, 3
    s_lshr_b32 s26, s25, 3
    s_lshl_b32 s24, s24, 2
    s_add_u32 s21, s24, s26
    s_and_b32 s25, s25, 7
    s_lshr_b32 s26, s25, 2
    s_and_b32 s27, s25, 3
    s_mul_i32 s22, s26, 84
    s_sub_u32 s28, 168, s22
    s_min_u32 s28, s28, 84
    s_waitcnt lgkmcnt(0)
    s_mul_i32 s29, s21, 344064
    s_lshl_b32 s30, s22, 11
    s_add_u32 s29, s29, s30
    s_add_u32 s29, s29, 49815552
    s_add_u32 s8, s6, s29
    s_addc_u32 s9, s7, 0
    s_lshl_b32 s10, s28, 11
    s_mov_b32 s11, 0x00020000
    s_mul_i32 s29, s21, 528640
    s_mul_i32 s30, s27, 8192
    s_add_u32 s29, s29, s30
    s_add_u32 s29, s29, 60891136
    s_add_u32 s12, s4, s29
    s_addc_u32 s13, s5, 0
    s_mov_b32 s14, 499712
    s_mov_b32 s15, 0x00020000
    s_cmp_ge_u32 s20, 4
    s_cbranch_scc1 L_gemm2_kernel_loader
    s_lshl_b32 s29, s22, 15
    s_add_u32 s29, s29, 77807616
    s_add_u32 s16, s4, s29
    s_addc_u32 s17, s5, 0
    s_lshl_b32 s18, s28, 15
    s_mov_b32 s19, 0x00020000
    s_lshr_b32 s29, s20, 1
    s_and_b32 s30, s20, 1
    v_and_b32 v137, 15, v0
    v_bfe_u32 v138, v0, 4, 2
    v_and_b32 v139, 63, v0
    s_mul_i32 s31, s29, 6144
    v_and_b32 v140, 7, v137
    v_xor_b32 v140, v138, v140
    v_lshlrev_b32 v140, 4, v140
    v_lshl_add_u32 v140, v137, 7, v140
    v_add_u32 v140, s31, v140
    v_add_u32 v128, 0, v140
    v_xor_b32 v131, 64, v128
    v_add_u32 v129, 61440, v140
    v_xor_b32 v132, 64, v129
    v_add_u32 v130, 122880, v140
    v_xor_b32 v133, 64, v130
    s_mul_i32 s31, s30, 4096
    s_add_u32 s31, s31, 12288
    v_lshlrev_b32 v140, 4, v139
    v_add_u32 v140, s31, v140
    v_add_u32 v134, 0, v140
    v_add_u32 v135, 61440, v140
    v_add_u32 v136, 122880, v140
    s_mul_i32 s31, s29, 1572864
    v_lshlrev_b32 v141, 15, v137
    v_lshl_add_u32 v141, v138, 4, v141
    v_add_u32 v141, s31, v141
    s_mul_i32 s31, s27, 2
    s_mul_i32 s29, s30, 1
    s_add_u32 s31, s31, s29
    s_lshl_b32 s31, s31, 12
    s_lshl_b32 s29, s21, 7
    s_add_u32 s33, s31, s29
    s_mov_b32 s34, 0x80008000
    s_barrier
    ds_read_b128 v[48:51], v134 offset:0
    ds_read_b128 v[64:67], v128 offset:0
    ds_read_b128 v[72:75], v128 offset:2048
    ds_read_b128 v[80:83], v128 offset:4096
    ds_read_b128 v[56:59], v134 offset:2048
    ds_read_b128 v[68:71], v131 offset:0
    ds_read_b128 v[76:79], v131 offset:2048
    ds_read_b128 v[84:87], v131 offset:4096
    ds_read_b128 v[52:55], v134 offset:1024
    ds_read_b128 v[60:63], v134 offset:3072
    s_waitcnt lgkmcnt(0)
    s_barrier
    v_mfma_f32_16x16x32_bf16 v[0:3], v[48:51], v[64:67], 0
    ds_read_b128 v[88:91], v134 offset:20480
    v_mfma_f32_16x16x32_bf16 v[4:7], v[48:51], v[72:75], 0
    ds_read_b128 v[104:107], v128 offset:20480
    v_mfma_f32_16x16x32_bf16 v[8:11], v[48:51], v[80:83], 0
    ds_read_b128 v[112:115], v128 offset:22528
    v_mfma_f32_16x16x32_bf16 v[12:15], v[56:59], v[64:67], 0
    ds_read_b128 v[120:123], v128 offset:24576
    v_mfma_f32_16x16x32_bf16 v[16:19], v[56:59], v[72:75], 0
    ds_read_b128 v[96:99], v134 offset:22528
    v_mfma_f32_16x16x32_bf16 v[20:23], v[56:59], v[80:83], 0
    ds_read_b128 v[108:111], v131 offset:20480
    v_mfma_f32_16x16x32_bf16 v[24:27], v[48:51], v[68:71], 0
    ds_read_b128 v[116:119], v131 offset:22528
    v_mfma_f32_16x16x32_bf16 v[28:31], v[48:51], v[76:79], 0
    ds_read_b128 v[124:127], v131 offset:24576
    v_mfma_f32_16x16x32_bf16 v[32:35], v[48:51], v[84:87], 0
    ds_read_b128 v[92:95], v134 offset:21504
    v_mfma_f32_16x16x32_bf16 v[36:39], v[56:59], v[68:71], 0
    ds_read_b128 v[100:103], v134 offset:23552
    v_mfma_f32_16x16x32_bf16 v[40:43], v[56:59], v[76:79], 0
    v_mfma_f32_16x16x32_bf16 v[44:47], v[56:59], v[84:87], 0
    v_mfma_f32_16x16x32_bf16 v[24:27], v[52:55], v[64:67], v[24:27]
    v_xor_b32 v68, s34, v68
    v_xor_b32 v69, s34, v69
    v_mfma_f32_16x16x32_bf16 v[28:31], v[52:55], v[72:75], v[28:31]
    v_xor_b32 v70, s34, v70
    v_xor_b32 v71, s34, v71
    v_mfma_f32_16x16x32_bf16 v[32:35], v[52:55], v[80:83], v[32:35]
    v_xor_b32 v76, s34, v76
    v_xor_b32 v77, s34, v77
    v_mfma_f32_16x16x32_bf16 v[36:39], v[60:63], v[64:67], v[36:39]
    v_xor_b32 v78, s34, v78
    v_xor_b32 v79, s34, v79
    v_mfma_f32_16x16x32_bf16 v[40:43], v[60:63], v[72:75], v[40:43]
    v_xor_b32 v84, s34, v84
    v_xor_b32 v85, s34, v85
    v_mfma_f32_16x16x32_bf16 v[44:47], v[60:63], v[80:83], v[44:47]
    v_xor_b32 v86, s34, v86
    v_xor_b32 v87, s34, v87
    v_mfma_f32_16x16x32_bf16 v[0:3], v[52:55], v[68:71], v[0:3]
    v_mfma_f32_16x16x32_bf16 v[4:7], v[52:55], v[76:79], v[4:7]
    v_mfma_f32_16x16x32_bf16 v[8:11], v[52:55], v[84:87], v[8:11]
    s_waitcnt lgkmcnt(0)
    s_barrier
    v_mfma_f32_16x16x32_bf16 v[12:15], v[60:63], v[68:71], v[12:15]
    v_mfma_f32_16x16x32_bf16 v[16:19], v[60:63], v[76:79], v[16:19]
    v_mfma_f32_16x16x32_bf16 v[20:23], v[60:63], v[84:87], v[20:23]
    v_mfma_f32_16x16x32_bf16 v[0:3], v[88:91], v[104:107], v[0:3]
    ds_read_b128 v[48:51], v134 offset:40960
    v_mfma_f32_16x16x32_bf16 v[4:7], v[88:91], v[112:115], v[4:7]
    ds_read_b128 v[64:67], v128 offset:40960
    v_mfma_f32_16x16x32_bf16 v[8:11], v[88:91], v[120:123], v[8:11]
    ds_read_b128 v[72:75], v128 offset:43008
    v_mfma_f32_16x16x32_bf16 v[12:15], v[96:99], v[104:107], v[12:15]
    ds_read_b128 v[80:83], v128 offset:45056
    v_mfma_f32_16x16x32_bf16 v[16:19], v[96:99], v[112:115], v[16:19]
    ds_read_b128 v[56:59], v134 offset:43008
    v_mfma_f32_16x16x32_bf16 v[20:23], v[96:99], v[120:123], v[20:23]
    ds_read_b128 v[68:71], v131 offset:40960
    v_mfma_f32_16x16x32_bf16 v[24:27], v[88:91], v[108:111], v[24:27]
    ds_read_b128 v[76:79], v131 offset:43008
    v_mfma_f32_16x16x32_bf16 v[28:31], v[88:91], v[116:119], v[28:31]
    ds_read_b128 v[84:87], v131 offset:45056
    v_mfma_f32_16x16x32_bf16 v[32:35], v[88:91], v[124:127], v[32:35]
    ds_read_b128 v[52:55], v134 offset:41984
    v_mfma_f32_16x16x32_bf16 v[36:39], v[96:99], v[108:111], v[36:39]
    ds_read_b128 v[60:63], v134 offset:44032
    v_mfma_f32_16x16x32_bf16 v[40:43], v[96:99], v[116:119], v[40:43]
    v_mfma_f32_16x16x32_bf16 v[44:47], v[96:99], v[124:127], v[44:47]
    v_mfma_f32_16x16x32_bf16 v[24:27], v[92:95], v[104:107], v[24:27]
    v_xor_b32 v108, s34, v108
    v_xor_b32 v109, s34, v109
    v_mfma_f32_16x16x32_bf16 v[28:31], v[92:95], v[112:115], v[28:31]
    v_xor_b32 v110, s34, v110
    v_xor_b32 v111, s34, v111
    v_mfma_f32_16x16x32_bf16 v[32:35], v[92:95], v[120:123], v[32:35]
    v_xor_b32 v116, s34, v116
    v_xor_b32 v117, s34, v117
    v_mfma_f32_16x16x32_bf16 v[36:39], v[100:103], v[104:107], v[36:39]
    v_xor_b32 v118, s34, v118
    v_xor_b32 v119, s34, v119
    v_mfma_f32_16x16x32_bf16 v[40:43], v[100:103], v[112:115], v[40:43]
    v_xor_b32 v124, s34, v124
    v_xor_b32 v125, s34, v125
    v_mfma_f32_16x16x32_bf16 v[44:47], v[100:103], v[120:123], v[44:47]
    v_xor_b32 v126, s34, v126
    v_xor_b32 v127, s34, v127
    v_mfma_f32_16x16x32_bf16 v[0:3], v[92:95], v[108:111], v[0:3]
    v_mfma_f32_16x16x32_bf16 v[4:7], v[92:95], v[116:119], v[4:7]
    v_mfma_f32_16x16x32_bf16 v[8:11], v[92:95], v[124:127], v[8:11]
    s_waitcnt lgkmcnt(0)
    s_barrier
    v_mfma_f32_16x16x32_bf16 v[12:15], v[100:103], v[108:111], v[12:15]
    v_mfma_f32_16x16x32_bf16 v[16:19], v[100:103], v[116:119], v[16:19]
    v_mfma_f32_16x16x32_bf16 v[20:23], v[100:103], v[124:127], v[20:23]
    v_mfma_f32_16x16x32_bf16 v[0:3], v[48:51], v[64:67], v[0:3]
    ds_read_b128 v[88:91], v135 offset:0
    v_mfma_f32_16x16x32_bf16 v[4:7], v[48:51], v[72:75], v[4:7]
    ds_read_b128 v[104:107], v129 offset:0
    v_mfma_f32_16x16x32_bf16 v[8:11], v[48:51], v[80:83], v[8:11]
    ds_read_b128 v[112:115], v129 offset:2048
    v_mfma_f32_16x16x32_bf16 v[12:15], v[56:59], v[64:67], v[12:15]
    ds_read_b128 v[120:123], v129 offset:4096
    v_mfma_f32_16x16x32_bf16 v[16:19], v[56:59], v[72:75], v[16:19]
    ds_read_b128 v[96:99], v135 offset:2048
    v_mfma_f32_16x16x32_bf16 v[20:23], v[56:59], v[80:83], v[20:23]
    ds_read_b128 v[108:111], v132 offset:0
    v_mfma_f32_16x16x32_bf16 v[24:27], v[48:51], v[68:71], v[24:27]
    ds_read_b128 v[116:119], v132 offset:2048
    v_mfma_f32_16x16x32_bf16 v[28:31], v[48:51], v[76:79], v[28:31]
    ds_read_b128 v[124:127], v132 offset:4096
    v_mfma_f32_16x16x32_bf16 v[32:35], v[48:51], v[84:87], v[32:35]
    ds_read_b128 v[92:95], v135 offset:1024
    v_mfma_f32_16x16x32_bf16 v[36:39], v[56:59], v[68:71], v[36:39]
    ds_read_b128 v[100:103], v135 offset:3072
    v_mfma_f32_16x16x32_bf16 v[40:43], v[56:59], v[76:79], v[40:43]
    v_mfma_f32_16x16x32_bf16 v[44:47], v[56:59], v[84:87], v[44:47]
    v_mfma_f32_16x16x32_bf16 v[24:27], v[52:55], v[64:67], v[24:27]
    v_xor_b32 v68, s34, v68
    v_xor_b32 v69, s34, v69
    v_mfma_f32_16x16x32_bf16 v[28:31], v[52:55], v[72:75], v[28:31]
    v_xor_b32 v70, s34, v70
    v_xor_b32 v71, s34, v71
    v_mfma_f32_16x16x32_bf16 v[32:35], v[52:55], v[80:83], v[32:35]
    v_xor_b32 v76, s34, v76
    v_xor_b32 v77, s34, v77
    v_mfma_f32_16x16x32_bf16 v[36:39], v[60:63], v[64:67], v[36:39]
    v_xor_b32 v78, s34, v78
    v_xor_b32 v79, s34, v79
    v_mfma_f32_16x16x32_bf16 v[40:43], v[60:63], v[72:75], v[40:43]
    v_xor_b32 v84, s34, v84
    v_xor_b32 v85, s34, v85
    v_mfma_f32_16x16x32_bf16 v[44:47], v[60:63], v[80:83], v[44:47]
    v_xor_b32 v86, s34, v86
    v_xor_b32 v87, s34, v87
    v_mfma_f32_16x16x32_bf16 v[0:3], v[52:55], v[68:71], v[0:3]
    v_mfma_f32_16x16x32_bf16 v[4:7], v[52:55], v[76:79], v[4:7]
    v_mfma_f32_16x16x32_bf16 v[8:11], v[52:55], v[84:87], v[8:11]
    s_waitcnt lgkmcnt(0)
    s_barrier
    v_mfma_f32_16x16x32_bf16 v[12:15], v[60:63], v[68:71], v[12:15]
    v_mfma_f32_16x16x32_bf16 v[16:19], v[60:63], v[76:79], v[16:19]
    v_mfma_f32_16x16x32_bf16 v[20:23], v[60:63], v[84:87], v[20:23]
    v_mfma_f32_16x16x32_bf16 v[0:3], v[88:91], v[104:107], v[0:3]
    ds_read_b128 v[48:51], v135 offset:20480
    v_mfma_f32_16x16x32_bf16 v[4:7], v[88:91], v[112:115], v[4:7]
    ds_read_b128 v[64:67], v129 offset:20480
    v_mfma_f32_16x16x32_bf16 v[8:11], v[88:91], v[120:123], v[8:11]
    ds_read_b128 v[72:75], v129 offset:22528
    v_mfma_f32_16x16x32_bf16 v[12:15], v[96:99], v[104:107], v[12:15]
    ds_read_b128 v[80:83], v129 offset:24576
    v_mfma_f32_16x16x32_bf16 v[16:19], v[96:99], v[112:115], v[16:19]
    ds_read_b128 v[56:59], v135 offset:22528
    v_mfma_f32_16x16x32_bf16 v[20:23], v[96:99], v[120:123], v[20:23]
    ds_read_b128 v[68:71], v132 offset:20480
    v_mfma_f32_16x16x32_bf16 v[24:27], v[88:91], v[108:111], v[24:27]
    ds_read_b128 v[76:79], v132 offset:22528
    v_mfma_f32_16x16x32_bf16 v[28:31], v[88:91], v[116:119], v[28:31]
    ds_read_b128 v[84:87], v132 offset:24576
    v_mfma_f32_16x16x32_bf16 v[32:35], v[88:91], v[124:127], v[32:35]
    ds_read_b128 v[52:55], v135 offset:21504
    v_mfma_f32_16x16x32_bf16 v[36:39], v[96:99], v[108:111], v[36:39]
    ds_read_b128 v[60:63], v135 offset:23552
    v_mfma_f32_16x16x32_bf16 v[40:43], v[96:99], v[116:119], v[40:43]
    v_mfma_f32_16x16x32_bf16 v[44:47], v[96:99], v[124:127], v[44:47]
    v_mfma_f32_16x16x32_bf16 v[24:27], v[92:95], v[104:107], v[24:27]
    v_xor_b32 v108, s34, v108
    v_xor_b32 v109, s34, v109
    v_mfma_f32_16x16x32_bf16 v[28:31], v[92:95], v[112:115], v[28:31]
    v_xor_b32 v110, s34, v110
    v_xor_b32 v111, s34, v111
    v_mfma_f32_16x16x32_bf16 v[32:35], v[92:95], v[120:123], v[32:35]
    v_xor_b32 v116, s34, v116
    v_xor_b32 v117, s34, v117
    v_mfma_f32_16x16x32_bf16 v[36:39], v[100:103], v[104:107], v[36:39]
    v_xor_b32 v118, s34, v118
    v_xor_b32 v119, s34, v119
    v_mfma_f32_16x16x32_bf16 v[40:43], v[100:103], v[112:115], v[40:43]
    v_xor_b32 v124, s34, v124
    v_xor_b32 v125, s34, v125
    v_mfma_f32_16x16x32_bf16 v[44:47], v[100:103], v[120:123], v[44:47]
    v_xor_b32 v126, s34, v126
    v_xor_b32 v127, s34, v127
    v_mfma_f32_16x16x32_bf16 v[0:3], v[92:95], v[108:111], v[0:3]
    v_mfma_f32_16x16x32_bf16 v[4:7], v[92:95], v[116:119], v[4:7]
    v_mfma_f32_16x16x32_bf16 v[8:11], v[92:95], v[124:127], v[8:11]
    s_waitcnt lgkmcnt(0)
    s_barrier
    v_mfma_f32_16x16x32_bf16 v[12:15], v[100:103], v[108:111], v[12:15]
    v_mfma_f32_16x16x32_bf16 v[16:19], v[100:103], v[116:119], v[16:19]
    v_mfma_f32_16x16x32_bf16 v[20:23], v[100:103], v[124:127], v[20:23]
    v_mfma_f32_16x16x32_bf16 v[0:3], v[48:51], v[64:67], v[0:3]
    ds_read_b128 v[88:91], v135 offset:40960
    v_mfma_f32_16x16x32_bf16 v[4:7], v[48:51], v[72:75], v[4:7]
    ds_read_b128 v[104:107], v129 offset:40960
    v_mfma_f32_16x16x32_bf16 v[8:11], v[48:51], v[80:83], v[8:11]
    ds_read_b128 v[112:115], v129 offset:43008
    v_mfma_f32_16x16x32_bf16 v[12:15], v[56:59], v[64:67], v[12:15]
    ds_read_b128 v[120:123], v129 offset:45056
    v_mfma_f32_16x16x32_bf16 v[16:19], v[56:59], v[72:75], v[16:19]
    ds_read_b128 v[96:99], v135 offset:43008
    v_mfma_f32_16x16x32_bf16 v[20:23], v[56:59], v[80:83], v[20:23]
    ds_read_b128 v[108:111], v132 offset:40960
    v_mfma_f32_16x16x32_bf16 v[24:27], v[48:51], v[68:71], v[24:27]
    ds_read_b128 v[116:119], v132 offset:43008
    v_mfma_f32_16x16x32_bf16 v[28:31], v[48:51], v[76:79], v[28:31]
    ds_read_b128 v[124:127], v132 offset:45056
    v_mfma_f32_16x16x32_bf16 v[32:35], v[48:51], v[84:87], v[32:35]
    ds_read_b128 v[92:95], v135 offset:41984
    v_mfma_f32_16x16x32_bf16 v[36:39], v[56:59], v[68:71], v[36:39]
    ds_read_b128 v[100:103], v135 offset:44032
    v_mfma_f32_16x16x32_bf16 v[40:43], v[56:59], v[76:79], v[40:43]
    v_mfma_f32_16x16x32_bf16 v[44:47], v[56:59], v[84:87], v[44:47]
    v_mfma_f32_16x16x32_bf16 v[24:27], v[52:55], v[64:67], v[24:27]
    v_xor_b32 v68, s34, v68
    v_xor_b32 v69, s34, v69
    v_mfma_f32_16x16x32_bf16 v[28:31], v[52:55], v[72:75], v[28:31]
    v_xor_b32 v70, s34, v70
    v_xor_b32 v71, s34, v71
    v_mfma_f32_16x16x32_bf16 v[32:35], v[52:55], v[80:83], v[32:35]
    v_xor_b32 v76, s34, v76
    v_xor_b32 v77, s34, v77
    v_mfma_f32_16x16x32_bf16 v[36:39], v[60:63], v[64:67], v[36:39]
    v_xor_b32 v78, s34, v78
    v_xor_b32 v79, s34, v79
    v_mfma_f32_16x16x32_bf16 v[40:43], v[60:63], v[72:75], v[40:43]
    v_xor_b32 v84, s34, v84
    v_xor_b32 v85, s34, v85
    v_mfma_f32_16x16x32_bf16 v[44:47], v[60:63], v[80:83], v[44:47]
    v_xor_b32 v86, s34, v86
    v_xor_b32 v87, s34, v87
    v_mfma_f32_16x16x32_bf16 v[0:3], v[52:55], v[68:71], v[0:3]
    v_mfma_f32_16x16x32_bf16 v[4:7], v[52:55], v[76:79], v[4:7]
    v_mfma_f32_16x16x32_bf16 v[8:11], v[52:55], v[84:87], v[8:11]
    s_waitcnt lgkmcnt(0)
    s_barrier
    v_mfma_f32_16x16x32_bf16 v[12:15], v[60:63], v[68:71], v[12:15]
    v_mfma_f32_16x16x32_bf16 v[16:19], v[60:63], v[76:79], v[16:19]
    v_mfma_f32_16x16x32_bf16 v[20:23], v[60:63], v[84:87], v[20:23]
    v_mfma_f32_16x16x32_bf16 v[0:3], v[88:91], v[104:107], v[0:3]
    ds_read_b128 v[48:51], v136 offset:0
    v_mfma_f32_16x16x32_bf16 v[4:7], v[88:91], v[112:115], v[4:7]
    ds_read_b128 v[64:67], v130 offset:0
    v_mfma_f32_16x16x32_bf16 v[8:11], v[88:91], v[120:123], v[8:11]
    ds_read_b128 v[72:75], v130 offset:2048
    v_mfma_f32_16x16x32_bf16 v[12:15], v[96:99], v[104:107], v[12:15]
    ds_read_b128 v[80:83], v130 offset:4096
    v_mfma_f32_16x16x32_bf16 v[16:19], v[96:99], v[112:115], v[16:19]
    ds_read_b128 v[56:59], v136 offset:2048
    v_mfma_f32_16x16x32_bf16 v[20:23], v[96:99], v[120:123], v[20:23]
    ds_read_b128 v[68:71], v133 offset:0
    v_mfma_f32_16x16x32_bf16 v[24:27], v[88:91], v[108:111], v[24:27]
    ds_read_b128 v[76:79], v133 offset:2048
    v_mfma_f32_16x16x32_bf16 v[28:31], v[88:91], v[116:119], v[28:31]
    ds_read_b128 v[84:87], v133 offset:4096
    v_mfma_f32_16x16x32_bf16 v[32:35], v[88:91], v[124:127], v[32:35]
    ds_read_b128 v[52:55], v136 offset:1024
    v_mfma_f32_16x16x32_bf16 v[36:39], v[96:99], v[108:111], v[36:39]
    ds_read_b128 v[60:63], v136 offset:3072
    v_mfma_f32_16x16x32_bf16 v[40:43], v[96:99], v[116:119], v[40:43]
    v_mfma_f32_16x16x32_bf16 v[44:47], v[96:99], v[124:127], v[44:47]
    v_mfma_f32_16x16x32_bf16 v[24:27], v[92:95], v[104:107], v[24:27]
    v_xor_b32 v108, s34, v108
    v_xor_b32 v109, s34, v109
    v_mfma_f32_16x16x32_bf16 v[28:31], v[92:95], v[112:115], v[28:31]
    v_xor_b32 v110, s34, v110
    v_xor_b32 v111, s34, v111
    v_mfma_f32_16x16x32_bf16 v[32:35], v[92:95], v[120:123], v[32:35]
    v_xor_b32 v116, s34, v116
    v_xor_b32 v117, s34, v117
    v_mfma_f32_16x16x32_bf16 v[36:39], v[100:103], v[104:107], v[36:39]
    v_xor_b32 v118, s34, v118
    v_xor_b32 v119, s34, v119
    v_mfma_f32_16x16x32_bf16 v[40:43], v[100:103], v[112:115], v[40:43]
    v_xor_b32 v124, s34, v124
    v_xor_b32 v125, s34, v125
    v_mfma_f32_16x16x32_bf16 v[44:47], v[100:103], v[120:123], v[44:47]
    v_xor_b32 v126, s34, v126
    v_xor_b32 v127, s34, v127
    v_mfma_f32_16x16x32_bf16 v[0:3], v[92:95], v[108:111], v[0:3]
    v_mfma_f32_16x16x32_bf16 v[4:7], v[92:95], v[116:119], v[4:7]
    v_mfma_f32_16x16x32_bf16 v[8:11], v[92:95], v[124:127], v[8:11]
    s_waitcnt lgkmcnt(0)
    s_barrier
    v_mfma_f32_16x16x32_bf16 v[12:15], v[100:103], v[108:111], v[12:15]
    v_mfma_f32_16x16x32_bf16 v[16:19], v[100:103], v[116:119], v[16:19]
    v_mfma_f32_16x16x32_bf16 v[20:23], v[100:103], v[124:127], v[20:23]
    v_mfma_f32_16x16x32_bf16 v[0:3], v[48:51], v[64:67], v[0:3]
    ds_read_b128 v[88:91], v134 offset:0
    v_mfma_f32_16x16x32_bf16 v[4:7], v[48:51], v[72:75], v[4:7]
    ds_read_b128 v[104:107], v128 offset:0
    v_mfma_f32_16x16x32_bf16 v[8:11], v[48:51], v[80:83], v[8:11]
    ds_read_b128 v[112:115], v128 offset:2048
    v_mfma_f32_16x16x32_bf16 v[12:15], v[56:59], v[64:67], v[12:15]
    ds_read_b128 v[120:123], v128 offset:4096
    v_mfma_f32_16x16x32_bf16 v[16:19], v[56:59], v[72:75], v[16:19]
    ds_read_b128 v[96:99], v134 offset:2048
    v_mfma_f32_16x16x32_bf16 v[20:23], v[56:59], v[80:83], v[20:23]
    ds_read_b128 v[108:111], v131 offset:0
    v_mfma_f32_16x16x32_bf16 v[24:27], v[48:51], v[68:71], v[24:27]
    ds_read_b128 v[116:119], v131 offset:2048
    v_mfma_f32_16x16x32_bf16 v[28:31], v[48:51], v[76:79], v[28:31]
    ds_read_b128 v[124:127], v131 offset:4096
    v_mfma_f32_16x16x32_bf16 v[32:35], v[48:51], v[84:87], v[32:35]
    ds_read_b128 v[92:95], v134 offset:1024
    v_mfma_f32_16x16x32_bf16 v[36:39], v[56:59], v[68:71], v[36:39]
    ds_read_b128 v[100:103], v134 offset:3072
    v_mfma_f32_16x16x32_bf16 v[40:43], v[56:59], v[76:79], v[40:43]
    v_mfma_f32_16x16x32_bf16 v[44:47], v[56:59], v[84:87], v[44:47]
    v_mfma_f32_16x16x32_bf16 v[24:27], v[52:55], v[64:67], v[24:27]
    v_xor_b32 v68, s34, v68
    v_xor_b32 v69, s34, v69
    v_mfma_f32_16x16x32_bf16 v[28:31], v[52:55], v[72:75], v[28:31]
    v_xor_b32 v70, s34, v70
    v_xor_b32 v71, s34, v71
    v_mfma_f32_16x16x32_bf16 v[32:35], v[52:55], v[80:83], v[32:35]
    v_xor_b32 v76, s34, v76
    v_xor_b32 v77, s34, v77
    v_mfma_f32_16x16x32_bf16 v[36:39], v[60:63], v[64:67], v[36:39]
    v_xor_b32 v78, s34, v78
    v_xor_b32 v79, s34, v79
    v_mfma_f32_16x16x32_bf16 v[40:43], v[60:63], v[72:75], v[40:43]
    v_xor_b32 v84, s34, v84
    v_xor_b32 v85, s34, v85
    v_mfma_f32_16x16x32_bf16 v[44:47], v[60:63], v[80:83], v[44:47]
    v_xor_b32 v86, s34, v86
    v_xor_b32 v87, s34, v87
    v_mfma_f32_16x16x32_bf16 v[0:3], v[52:55], v[68:71], v[0:3]
    v_mfma_f32_16x16x32_bf16 v[4:7], v[52:55], v[76:79], v[4:7]
    v_mfma_f32_16x16x32_bf16 v[8:11], v[52:55], v[84:87], v[8:11]
    s_waitcnt lgkmcnt(0)
    s_barrier
    v_mfma_f32_16x16x32_bf16 v[12:15], v[60:63], v[68:71], v[12:15]
    v_mfma_f32_16x16x32_bf16 v[16:19], v[60:63], v[76:79], v[16:19]
    v_mfma_f32_16x16x32_bf16 v[20:23], v[60:63], v[84:87], v[20:23]
    v_mfma_f32_16x16x32_bf16 v[0:3], v[88:91], v[104:107], v[0:3]
    ds_read_b128 v[48:51], v134 offset:20480
    v_mfma_f32_16x16x32_bf16 v[4:7], v[88:91], v[112:115], v[4:7]
    ds_read_b128 v[64:67], v128 offset:20480
    v_mfma_f32_16x16x32_bf16 v[8:11], v[88:91], v[120:123], v[8:11]
    ds_read_b128 v[72:75], v128 offset:22528
    v_mfma_f32_16x16x32_bf16 v[12:15], v[96:99], v[104:107], v[12:15]
    ds_read_b128 v[80:83], v128 offset:24576
    v_mfma_f32_16x16x32_bf16 v[16:19], v[96:99], v[112:115], v[16:19]
    ds_read_b128 v[56:59], v134 offset:22528
    v_mfma_f32_16x16x32_bf16 v[20:23], v[96:99], v[120:123], v[20:23]
    ds_read_b128 v[68:71], v131 offset:20480
    v_mfma_f32_16x16x32_bf16 v[24:27], v[88:91], v[108:111], v[24:27]
    ds_read_b128 v[76:79], v131 offset:22528
    v_mfma_f32_16x16x32_bf16 v[28:31], v[88:91], v[116:119], v[28:31]
    ds_read_b128 v[84:87], v131 offset:24576
    v_mfma_f32_16x16x32_bf16 v[32:35], v[88:91], v[124:127], v[32:35]
    ds_read_b128 v[52:55], v134 offset:21504
    v_mfma_f32_16x16x32_bf16 v[36:39], v[96:99], v[108:111], v[36:39]
    ds_read_b128 v[60:63], v134 offset:23552
    v_mfma_f32_16x16x32_bf16 v[40:43], v[96:99], v[116:119], v[40:43]
    v_mfma_f32_16x16x32_bf16 v[44:47], v[96:99], v[124:127], v[44:47]
    v_mfma_f32_16x16x32_bf16 v[24:27], v[92:95], v[104:107], v[24:27]
    v_xor_b32 v108, s34, v108
    v_xor_b32 v109, s34, v109
    v_mfma_f32_16x16x32_bf16 v[28:31], v[92:95], v[112:115], v[28:31]
    v_xor_b32 v110, s34, v110
    v_xor_b32 v111, s34, v111
    v_mfma_f32_16x16x32_bf16 v[32:35], v[92:95], v[120:123], v[32:35]
    v_xor_b32 v116, s34, v116
    v_xor_b32 v117, s34, v117
    v_mfma_f32_16x16x32_bf16 v[36:39], v[100:103], v[104:107], v[36:39]
    v_xor_b32 v118, s34, v118
    v_xor_b32 v119, s34, v119
    v_mfma_f32_16x16x32_bf16 v[40:43], v[100:103], v[112:115], v[40:43]
    v_xor_b32 v124, s34, v124
    v_xor_b32 v125, s34, v125
    v_mfma_f32_16x16x32_bf16 v[44:47], v[100:103], v[120:123], v[44:47]
    v_xor_b32 v126, s34, v126
    v_xor_b32 v127, s34, v127
    v_mfma_f32_16x16x32_bf16 v[0:3], v[92:95], v[108:111], v[0:3]
    v_mfma_f32_16x16x32_bf16 v[4:7], v[92:95], v[116:119], v[4:7]
    v_mfma_f32_16x16x32_bf16 v[8:11], v[92:95], v[124:127], v[8:11]
    s_waitcnt lgkmcnt(0)
    s_barrier
    v_mfma_f32_16x16x32_bf16 v[12:15], v[100:103], v[108:111], v[12:15]
    v_mfma_f32_16x16x32_bf16 v[16:19], v[100:103], v[116:119], v[16:19]
    v_mfma_f32_16x16x32_bf16 v[20:23], v[100:103], v[124:127], v[20:23]
    v_mfma_f32_16x16x32_bf16 v[0:3], v[48:51], v[64:67], v[0:3]
    ds_read_b128 v[88:91], v134 offset:40960
    v_mfma_f32_16x16x32_bf16 v[4:7], v[48:51], v[72:75], v[4:7]
    ds_read_b128 v[104:107], v128 offset:40960
    v_mfma_f32_16x16x32_bf16 v[8:11], v[48:51], v[80:83], v[8:11]
    ds_read_b128 v[112:115], v128 offset:43008
    v_mfma_f32_16x16x32_bf16 v[12:15], v[56:59], v[64:67], v[12:15]
    ds_read_b128 v[120:123], v128 offset:45056
    v_mfma_f32_16x16x32_bf16 v[16:19], v[56:59], v[72:75], v[16:19]
    ds_read_b128 v[96:99], v134 offset:43008
    v_mfma_f32_16x16x32_bf16 v[20:23], v[56:59], v[80:83], v[20:23]
    ds_read_b128 v[108:111], v131 offset:40960
    v_mfma_f32_16x16x32_bf16 v[24:27], v[48:51], v[68:71], v[24:27]
    ds_read_b128 v[116:119], v131 offset:43008
    v_mfma_f32_16x16x32_bf16 v[28:31], v[48:51], v[76:79], v[28:31]
    ds_read_b128 v[124:127], v131 offset:45056
    v_mfma_f32_16x16x32_bf16 v[32:35], v[48:51], v[84:87], v[32:35]
    ds_read_b128 v[92:95], v134 offset:41984
    v_mfma_f32_16x16x32_bf16 v[36:39], v[56:59], v[68:71], v[36:39]
    ds_read_b128 v[100:103], v134 offset:44032
    v_mfma_f32_16x16x32_bf16 v[40:43], v[56:59], v[76:79], v[40:43]
    v_mfma_f32_16x16x32_bf16 v[44:47], v[56:59], v[84:87], v[44:47]
    v_mfma_f32_16x16x32_bf16 v[24:27], v[52:55], v[64:67], v[24:27]
    v_xor_b32 v68, s34, v68
    v_xor_b32 v69, s34, v69
    v_mfma_f32_16x16x32_bf16 v[28:31], v[52:55], v[72:75], v[28:31]
    v_xor_b32 v70, s34, v70
    v_xor_b32 v71, s34, v71
    v_mfma_f32_16x16x32_bf16 v[32:35], v[52:55], v[80:83], v[32:35]
    v_xor_b32 v76, s34, v76
    v_xor_b32 v77, s34, v77
    v_mfma_f32_16x16x32_bf16 v[36:39], v[60:63], v[64:67], v[36:39]
    v_xor_b32 v78, s34, v78
    v_xor_b32 v79, s34, v79
    v_mfma_f32_16x16x32_bf16 v[40:43], v[60:63], v[72:75], v[40:43]
    v_xor_b32 v84, s34, v84
    v_xor_b32 v85, s34, v85
    v_mfma_f32_16x16x32_bf16 v[44:47], v[60:63], v[80:83], v[44:47]
    v_xor_b32 v86, s34, v86
    v_xor_b32 v87, s34, v87
    v_mfma_f32_16x16x32_bf16 v[0:3], v[52:55], v[68:71], v[0:3]
    v_mfma_f32_16x16x32_bf16 v[4:7], v[52:55], v[76:79], v[4:7]
    v_mfma_f32_16x16x32_bf16 v[8:11], v[52:55], v[84:87], v[8:11]
    s_waitcnt lgkmcnt(0)
    s_barrier
    v_mfma_f32_16x16x32_bf16 v[12:15], v[60:63], v[68:71], v[12:15]
    v_mfma_f32_16x16x32_bf16 v[16:19], v[60:63], v[76:79], v[16:19]
    v_mfma_f32_16x16x32_bf16 v[20:23], v[60:63], v[84:87], v[20:23]
    v_mfma_f32_16x16x32_bf16 v[0:3], v[88:91], v[104:107], v[0:3]
    ds_read_b128 v[48:51], v135 offset:0
    v_mfma_f32_16x16x32_bf16 v[4:7], v[88:91], v[112:115], v[4:7]
    ds_read_b128 v[64:67], v129 offset:0
    v_mfma_f32_16x16x32_bf16 v[8:11], v[88:91], v[120:123], v[8:11]
    ds_read_b128 v[72:75], v129 offset:2048
    v_mfma_f32_16x16x32_bf16 v[12:15], v[96:99], v[104:107], v[12:15]
    ds_read_b128 v[80:83], v129 offset:4096
    v_mfma_f32_16x16x32_bf16 v[16:19], v[96:99], v[112:115], v[16:19]
    ds_read_b128 v[56:59], v135 offset:2048
    v_mfma_f32_16x16x32_bf16 v[20:23], v[96:99], v[120:123], v[20:23]
    ds_read_b128 v[68:71], v132 offset:0
    v_mfma_f32_16x16x32_bf16 v[24:27], v[88:91], v[108:111], v[24:27]
    ds_read_b128 v[76:79], v132 offset:2048
    v_mfma_f32_16x16x32_bf16 v[28:31], v[88:91], v[116:119], v[28:31]
    ds_read_b128 v[84:87], v132 offset:4096
    v_mfma_f32_16x16x32_bf16 v[32:35], v[88:91], v[124:127], v[32:35]
    ds_read_b128 v[52:55], v135 offset:1024
    v_mfma_f32_16x16x32_bf16 v[36:39], v[96:99], v[108:111], v[36:39]
    ds_read_b128 v[60:63], v135 offset:3072
    v_mfma_f32_16x16x32_bf16 v[40:43], v[96:99], v[116:119], v[40:43]
    v_mfma_f32_16x16x32_bf16 v[44:47], v[96:99], v[124:127], v[44:47]
    v_mfma_f32_16x16x32_bf16 v[24:27], v[92:95], v[104:107], v[24:27]
    v_xor_b32 v108, s34, v108
    v_xor_b32 v109, s34, v109
    v_mfma_f32_16x16x32_bf16 v[28:31], v[92:95], v[112:115], v[28:31]
    v_xor_b32 v110, s34, v110
    v_xor_b32 v111, s34, v111
    v_mfma_f32_16x16x32_bf16 v[32:35], v[92:95], v[120:123], v[32:35]
    v_xor_b32 v116, s34, v116
    v_xor_b32 v117, s34, v117
    v_mfma_f32_16x16x32_bf16 v[36:39], v[100:103], v[104:107], v[36:39]
    v_xor_b32 v118, s34, v118
    v_xor_b32 v119, s34, v119
    v_mfma_f32_16x16x32_bf16 v[40:43], v[100:103], v[112:115], v[40:43]
    v_xor_b32 v124, s34, v124
    v_xor_b32 v125, s34, v125
    v_mfma_f32_16x16x32_bf16 v[44:47], v[100:103], v[120:123], v[44:47]
    v_xor_b32 v126, s34, v126
    v_xor_b32 v127, s34, v127
    v_mfma_f32_16x16x32_bf16 v[0:3], v[92:95], v[108:111], v[0:3]
    v_mfma_f32_16x16x32_bf16 v[4:7], v[92:95], v[116:119], v[4:7]
    v_mfma_f32_16x16x32_bf16 v[8:11], v[92:95], v[124:127], v[8:11]
    s_waitcnt lgkmcnt(0)
    s_barrier
    v_mfma_f32_16x16x32_bf16 v[12:15], v[100:103], v[108:111], v[12:15]
    v_mfma_f32_16x16x32_bf16 v[16:19], v[100:103], v[116:119], v[16:19]
    v_mfma_f32_16x16x32_bf16 v[20:23], v[100:103], v[124:127], v[20:23]
    v_mfma_f32_16x16x32_bf16 v[0:3], v[48:51], v[64:67], v[0:3]
    ds_read_b128 v[88:91], v135 offset:20480
    v_mfma_f32_16x16x32_bf16 v[4:7], v[48:51], v[72:75], v[4:7]
    ds_read_b128 v[104:107], v129 offset:20480
    v_mfma_f32_16x16x32_bf16 v[8:11], v[48:51], v[80:83], v[8:11]
    ds_read_b128 v[112:115], v129 offset:22528
    v_mfma_f32_16x16x32_bf16 v[12:15], v[56:59], v[64:67], v[12:15]
    ds_read_b128 v[120:123], v129 offset:24576
    v_mfma_f32_16x16x32_bf16 v[16:19], v[56:59], v[72:75], v[16:19]
    ds_read_b128 v[96:99], v135 offset:22528
    v_mfma_f32_16x16x32_bf16 v[20:23], v[56:59], v[80:83], v[20:23]
    ds_read_b128 v[108:111], v132 offset:20480
    v_mfma_f32_16x16x32_bf16 v[24:27], v[48:51], v[68:71], v[24:27]
    ds_read_b128 v[116:119], v132 offset:22528
    v_mfma_f32_16x16x32_bf16 v[28:31], v[48:51], v[76:79], v[28:31]
    ds_read_b128 v[124:127], v132 offset:24576
    v_mfma_f32_16x16x32_bf16 v[32:35], v[48:51], v[84:87], v[32:35]
    ds_read_b128 v[92:95], v135 offset:21504
    v_mfma_f32_16x16x32_bf16 v[36:39], v[56:59], v[68:71], v[36:39]
    ds_read_b128 v[100:103], v135 offset:23552
    v_mfma_f32_16x16x32_bf16 v[40:43], v[56:59], v[76:79], v[40:43]
    v_mfma_f32_16x16x32_bf16 v[44:47], v[56:59], v[84:87], v[44:47]
    v_mfma_f32_16x16x32_bf16 v[24:27], v[52:55], v[64:67], v[24:27]
    v_xor_b32 v68, s34, v68
    v_xor_b32 v69, s34, v69
    v_mfma_f32_16x16x32_bf16 v[28:31], v[52:55], v[72:75], v[28:31]
    v_xor_b32 v70, s34, v70
    v_xor_b32 v71, s34, v71
    v_mfma_f32_16x16x32_bf16 v[32:35], v[52:55], v[80:83], v[32:35]
    v_xor_b32 v76, s34, v76
    v_xor_b32 v77, s34, v77
    v_mfma_f32_16x16x32_bf16 v[36:39], v[60:63], v[64:67], v[36:39]
    v_xor_b32 v78, s34, v78
    v_xor_b32 v79, s34, v79
    v_mfma_f32_16x16x32_bf16 v[40:43], v[60:63], v[72:75], v[40:43]
    v_xor_b32 v84, s34, v84
    v_xor_b32 v85, s34, v85
    v_mfma_f32_16x16x32_bf16 v[44:47], v[60:63], v[80:83], v[44:47]
    v_xor_b32 v86, s34, v86
    v_xor_b32 v87, s34, v87
    v_mfma_f32_16x16x32_bf16 v[0:3], v[52:55], v[68:71], v[0:3]
    v_mfma_f32_16x16x32_bf16 v[4:7], v[52:55], v[76:79], v[4:7]
    v_mfma_f32_16x16x32_bf16 v[8:11], v[52:55], v[84:87], v[8:11]
    s_waitcnt lgkmcnt(0)
    s_barrier
    v_mfma_f32_16x16x32_bf16 v[12:15], v[60:63], v[68:71], v[12:15]
    v_mfma_f32_16x16x32_bf16 v[16:19], v[60:63], v[76:79], v[16:19]
    v_mfma_f32_16x16x32_bf16 v[20:23], v[60:63], v[84:87], v[20:23]
    v_mfma_f32_16x16x32_bf16 v[0:3], v[88:91], v[104:107], v[0:3]
    ds_read_b128 v[48:51], v135 offset:40960
    v_mfma_f32_16x16x32_bf16 v[4:7], v[88:91], v[112:115], v[4:7]
    ds_read_b128 v[64:67], v129 offset:40960
    v_mfma_f32_16x16x32_bf16 v[8:11], v[88:91], v[120:123], v[8:11]
    ds_read_b128 v[72:75], v129 offset:43008
    v_mfma_f32_16x16x32_bf16 v[12:15], v[96:99], v[104:107], v[12:15]
    ds_read_b128 v[80:83], v129 offset:45056
    v_mfma_f32_16x16x32_bf16 v[16:19], v[96:99], v[112:115], v[16:19]
    ds_read_b128 v[56:59], v135 offset:43008
    v_mfma_f32_16x16x32_bf16 v[20:23], v[96:99], v[120:123], v[20:23]
    ds_read_b128 v[68:71], v132 offset:40960
    v_mfma_f32_16x16x32_bf16 v[24:27], v[88:91], v[108:111], v[24:27]
    ds_read_b128 v[76:79], v132 offset:43008
    v_mfma_f32_16x16x32_bf16 v[28:31], v[88:91], v[116:119], v[28:31]
    ds_read_b128 v[84:87], v132 offset:45056
    v_mfma_f32_16x16x32_bf16 v[32:35], v[88:91], v[124:127], v[32:35]
    ds_read_b128 v[52:55], v135 offset:41984
    v_mfma_f32_16x16x32_bf16 v[36:39], v[96:99], v[108:111], v[36:39]
    ds_read_b128 v[60:63], v135 offset:44032
    v_mfma_f32_16x16x32_bf16 v[40:43], v[96:99], v[116:119], v[40:43]
    v_mfma_f32_16x16x32_bf16 v[44:47], v[96:99], v[124:127], v[44:47]
    v_mfma_f32_16x16x32_bf16 v[24:27], v[92:95], v[104:107], v[24:27]
    v_xor_b32 v108, s34, v108
    v_xor_b32 v109, s34, v109
    v_mfma_f32_16x16x32_bf16 v[28:31], v[92:95], v[112:115], v[28:31]
    v_xor_b32 v110, s34, v110
    v_xor_b32 v111, s34, v111
    v_mfma_f32_16x16x32_bf16 v[32:35], v[92:95], v[120:123], v[32:35]
    v_xor_b32 v116, s34, v116
    v_xor_b32 v117, s34, v117
    v_mfma_f32_16x16x32_bf16 v[36:39], v[100:103], v[104:107], v[36:39]
    v_xor_b32 v118, s34, v118
    v_xor_b32 v119, s34, v119
    v_mfma_f32_16x16x32_bf16 v[40:43], v[100:103], v[112:115], v[40:43]
    v_xor_b32 v124, s34, v124
    v_xor_b32 v125, s34, v125
    v_mfma_f32_16x16x32_bf16 v[44:47], v[100:103], v[120:123], v[44:47]
    v_xor_b32 v126, s34, v126
    v_xor_b32 v127, s34, v127
    v_mfma_f32_16x16x32_bf16 v[0:3], v[92:95], v[108:111], v[0:3]
    v_mfma_f32_16x16x32_bf16 v[4:7], v[92:95], v[116:119], v[4:7]
    v_mfma_f32_16x16x32_bf16 v[8:11], v[92:95], v[124:127], v[8:11]
    s_waitcnt lgkmcnt(0)
    s_barrier
    v_mfma_f32_16x16x32_bf16 v[12:15], v[100:103], v[108:111], v[12:15]
    v_mfma_f32_16x16x32_bf16 v[16:19], v[100:103], v[116:119], v[16:19]
    v_mfma_f32_16x16x32_bf16 v[20:23], v[100:103], v[124:127], v[20:23]
    v_mfma_f32_16x16x32_bf16 v[0:3], v[48:51], v[64:67], v[0:3]
    ds_read_b128 v[88:91], v136 offset:0
    v_mfma_f32_16x16x32_bf16 v[4:7], v[48:51], v[72:75], v[4:7]
    ds_read_b128 v[104:107], v130 offset:0
    v_mfma_f32_16x16x32_bf16 v[8:11], v[48:51], v[80:83], v[8:11]
    ds_read_b128 v[112:115], v130 offset:2048
    v_mfma_f32_16x16x32_bf16 v[12:15], v[56:59], v[64:67], v[12:15]
    ds_read_b128 v[120:123], v130 offset:4096
    v_mfma_f32_16x16x32_bf16 v[16:19], v[56:59], v[72:75], v[16:19]
    ds_read_b128 v[96:99], v136 offset:2048
    v_mfma_f32_16x16x32_bf16 v[20:23], v[56:59], v[80:83], v[20:23]
    ds_read_b128 v[108:111], v133 offset:0
    v_mfma_f32_16x16x32_bf16 v[24:27], v[48:51], v[68:71], v[24:27]
    ds_read_b128 v[116:119], v133 offset:2048
    v_mfma_f32_16x16x32_bf16 v[28:31], v[48:51], v[76:79], v[28:31]
    ds_read_b128 v[124:127], v133 offset:4096
    v_mfma_f32_16x16x32_bf16 v[32:35], v[48:51], v[84:87], v[32:35]
    ds_read_b128 v[92:95], v136 offset:1024
    v_mfma_f32_16x16x32_bf16 v[36:39], v[56:59], v[68:71], v[36:39]
    ds_read_b128 v[100:103], v136 offset:3072
    v_mfma_f32_16x16x32_bf16 v[40:43], v[56:59], v[76:79], v[40:43]
    v_mfma_f32_16x16x32_bf16 v[44:47], v[56:59], v[84:87], v[44:47]
    v_mfma_f32_16x16x32_bf16 v[24:27], v[52:55], v[64:67], v[24:27]
    v_xor_b32 v68, s34, v68
    v_xor_b32 v69, s34, v69
    v_mfma_f32_16x16x32_bf16 v[28:31], v[52:55], v[72:75], v[28:31]
    v_xor_b32 v70, s34, v70
    v_xor_b32 v71, s34, v71
    v_mfma_f32_16x16x32_bf16 v[32:35], v[52:55], v[80:83], v[32:35]
    v_xor_b32 v76, s34, v76
    v_xor_b32 v77, s34, v77
    v_mfma_f32_16x16x32_bf16 v[36:39], v[60:63], v[64:67], v[36:39]
    v_xor_b32 v78, s34, v78
    v_xor_b32 v79, s34, v79
    v_mfma_f32_16x16x32_bf16 v[40:43], v[60:63], v[72:75], v[40:43]
    v_xor_b32 v84, s34, v84
    v_xor_b32 v85, s34, v85
    v_mfma_f32_16x16x32_bf16 v[44:47], v[60:63], v[80:83], v[44:47]
    v_xor_b32 v86, s34, v86
    v_xor_b32 v87, s34, v87
    v_mfma_f32_16x16x32_bf16 v[0:3], v[52:55], v[68:71], v[0:3]
    v_mfma_f32_16x16x32_bf16 v[4:7], v[52:55], v[76:79], v[4:7]
    v_mfma_f32_16x16x32_bf16 v[8:11], v[52:55], v[84:87], v[8:11]
    s_waitcnt lgkmcnt(0)
    s_barrier
    v_mfma_f32_16x16x32_bf16 v[12:15], v[60:63], v[68:71], v[12:15]
    v_mfma_f32_16x16x32_bf16 v[16:19], v[60:63], v[76:79], v[16:19]
    v_mfma_f32_16x16x32_bf16 v[20:23], v[60:63], v[84:87], v[20:23]
    v_mfma_f32_16x16x32_bf16 v[0:3], v[88:91], v[104:107], v[0:3]
    ds_read_b128 v[48:51], v134 offset:0
    v_mfma_f32_16x16x32_bf16 v[4:7], v[88:91], v[112:115], v[4:7]
    ds_read_b128 v[64:67], v128 offset:0
    v_mfma_f32_16x16x32_bf16 v[8:11], v[88:91], v[120:123], v[8:11]
    ds_read_b128 v[72:75], v128 offset:2048
    v_mfma_f32_16x16x32_bf16 v[12:15], v[96:99], v[104:107], v[12:15]
    ds_read_b128 v[80:83], v128 offset:4096
    v_mfma_f32_16x16x32_bf16 v[16:19], v[96:99], v[112:115], v[16:19]
    ds_read_b128 v[56:59], v134 offset:2048
    v_mfma_f32_16x16x32_bf16 v[20:23], v[96:99], v[120:123], v[20:23]
    ds_read_b128 v[68:71], v131 offset:0
    v_mfma_f32_16x16x32_bf16 v[24:27], v[88:91], v[108:111], v[24:27]
    ds_read_b128 v[76:79], v131 offset:2048
    v_mfma_f32_16x16x32_bf16 v[28:31], v[88:91], v[116:119], v[28:31]
    ds_read_b128 v[84:87], v131 offset:4096
    v_mfma_f32_16x16x32_bf16 v[32:35], v[88:91], v[124:127], v[32:35]
    ds_read_b128 v[52:55], v134 offset:1024
    v_mfma_f32_16x16x32_bf16 v[36:39], v[96:99], v[108:111], v[36:39]
    ds_read_b128 v[60:63], v134 offset:3072
    v_mfma_f32_16x16x32_bf16 v[40:43], v[96:99], v[116:119], v[40:43]
    v_mfma_f32_16x16x32_bf16 v[44:47], v[96:99], v[124:127], v[44:47]
    v_mfma_f32_16x16x32_bf16 v[24:27], v[92:95], v[104:107], v[24:27]
    v_xor_b32 v108, s34, v108
    v_xor_b32 v109, s34, v109
    v_mfma_f32_16x16x32_bf16 v[28:31], v[92:95], v[112:115], v[28:31]
    v_xor_b32 v110, s34, v110
    v_xor_b32 v111, s34, v111
    v_mfma_f32_16x16x32_bf16 v[32:35], v[92:95], v[120:123], v[32:35]
    v_xor_b32 v116, s34, v116
    v_xor_b32 v117, s34, v117
    v_mfma_f32_16x16x32_bf16 v[36:39], v[100:103], v[104:107], v[36:39]
    v_xor_b32 v118, s34, v118
    v_xor_b32 v119, s34, v119
    v_mfma_f32_16x16x32_bf16 v[40:43], v[100:103], v[112:115], v[40:43]
    v_xor_b32 v124, s34, v124
    v_xor_b32 v125, s34, v125
    v_mfma_f32_16x16x32_bf16 v[44:47], v[100:103], v[120:123], v[44:47]
    v_xor_b32 v126, s34, v126
    v_xor_b32 v127, s34, v127
    v_mfma_f32_16x16x32_bf16 v[0:3], v[92:95], v[108:111], v[0:3]
    v_mfma_f32_16x16x32_bf16 v[4:7], v[92:95], v[116:119], v[4:7]
    v_mfma_f32_16x16x32_bf16 v[8:11], v[92:95], v[124:127], v[8:11]
    s_waitcnt lgkmcnt(0)
    s_barrier
    v_mfma_f32_16x16x32_bf16 v[12:15], v[100:103], v[108:111], v[12:15]
    v_mfma_f32_16x16x32_bf16 v[16:19], v[100:103], v[116:119], v[16:19]
    v_mfma_f32_16x16x32_bf16 v[20:23], v[100:103], v[124:127], v[20:23]
    v_mfma_f32_16x16x32_bf16 v[0:3], v[48:51], v[64:67], v[0:3]
    ds_read_b128 v[88:91], v134 offset:20480
    v_mfma_f32_16x16x32_bf16 v[4:7], v[48:51], v[72:75], v[4:7]
    ds_read_b128 v[104:107], v128 offset:20480
    v_mfma_f32_16x16x32_bf16 v[8:11], v[48:51], v[80:83], v[8:11]
    ds_read_b128 v[112:115], v128 offset:22528
    v_mfma_f32_16x16x32_bf16 v[12:15], v[56:59], v[64:67], v[12:15]
    ds_read_b128 v[120:123], v128 offset:24576
    v_mfma_f32_16x16x32_bf16 v[16:19], v[56:59], v[72:75], v[16:19]
    ds_read_b128 v[96:99], v134 offset:22528
    v_mfma_f32_16x16x32_bf16 v[20:23], v[56:59], v[80:83], v[20:23]
    ds_read_b128 v[108:111], v131 offset:20480
    v_mfma_f32_16x16x32_bf16 v[24:27], v[48:51], v[68:71], v[24:27]
    ds_read_b128 v[116:119], v131 offset:22528
    v_mfma_f32_16x16x32_bf16 v[28:31], v[48:51], v[76:79], v[28:31]
    ds_read_b128 v[124:127], v131 offset:24576
    v_mfma_f32_16x16x32_bf16 v[32:35], v[48:51], v[84:87], v[32:35]
    ds_read_b128 v[92:95], v134 offset:21504
    v_mfma_f32_16x16x32_bf16 v[36:39], v[56:59], v[68:71], v[36:39]
    ds_read_b128 v[100:103], v134 offset:23552
    v_mfma_f32_16x16x32_bf16 v[40:43], v[56:59], v[76:79], v[40:43]
    v_mfma_f32_16x16x32_bf16 v[44:47], v[56:59], v[84:87], v[44:47]
    v_mfma_f32_16x16x32_bf16 v[24:27], v[52:55], v[64:67], v[24:27]
    v_xor_b32 v68, s34, v68
    v_xor_b32 v69, s34, v69
    v_mfma_f32_16x16x32_bf16 v[28:31], v[52:55], v[72:75], v[28:31]
    v_xor_b32 v70, s34, v70
    v_xor_b32 v71, s34, v71
    v_mfma_f32_16x16x32_bf16 v[32:35], v[52:55], v[80:83], v[32:35]
    v_xor_b32 v76, s34, v76
    v_xor_b32 v77, s34, v77
    v_mfma_f32_16x16x32_bf16 v[36:39], v[60:63], v[64:67], v[36:39]
    v_xor_b32 v78, s34, v78
    v_xor_b32 v79, s34, v79
    v_mfma_f32_16x16x32_bf16 v[40:43], v[60:63], v[72:75], v[40:43]
    v_xor_b32 v84, s34, v84
    v_xor_b32 v85, s34, v85
    v_mfma_f32_16x16x32_bf16 v[44:47], v[60:63], v[80:83], v[44:47]
    v_xor_b32 v86, s34, v86
    v_xor_b32 v87, s34, v87
    v_mfma_f32_16x16x32_bf16 v[0:3], v[52:55], v[68:71], v[0:3]
    v_mfma_f32_16x16x32_bf16 v[4:7], v[52:55], v[76:79], v[4:7]
    v_mfma_f32_16x16x32_bf16 v[8:11], v[52:55], v[84:87], v[8:11]
    s_waitcnt lgkmcnt(0)
    v_mfma_f32_16x16x32_bf16 v[12:15], v[60:63], v[68:71], v[12:15]
    v_mfma_f32_16x16x32_bf16 v[16:19], v[60:63], v[76:79], v[16:19]
    v_mfma_f32_16x16x32_bf16 v[20:23], v[60:63], v[84:87], v[20:23]
    v_mfma_f32_16x16x32_bf16 v[0:3], v[88:91], v[104:107], v[0:3]
    v_mfma_f32_16x16x32_bf16 v[4:7], v[88:91], v[112:115], v[4:7]
    v_mfma_f32_16x16x32_bf16 v[8:11], v[88:91], v[120:123], v[8:11]
    v_mfma_f32_16x16x32_bf16 v[12:15], v[96:99], v[104:107], v[12:15]
    v_mfma_f32_16x16x32_bf16 v[16:19], v[96:99], v[112:115], v[16:19]
    v_mfma_f32_16x16x32_bf16 v[20:23], v[96:99], v[120:123], v[20:23]
    v_mfma_f32_16x16x32_bf16 v[24:27], v[88:91], v[108:111], v[24:27]
    v_mfma_f32_16x16x32_bf16 v[28:31], v[88:91], v[116:119], v[28:31]
    v_mfma_f32_16x16x32_bf16 v[32:35], v[88:91], v[124:127], v[32:35]
    v_mfma_f32_16x16x32_bf16 v[36:39], v[96:99], v[108:111], v[36:39]
    v_mfma_f32_16x16x32_bf16 v[40:43], v[96:99], v[116:119], v[40:43]
    v_mfma_f32_16x16x32_bf16 v[44:47], v[96:99], v[124:127], v[44:47]
    v_mfma_f32_16x16x32_bf16 v[24:27], v[92:95], v[104:107], v[24:27]
    v_xor_b32 v108, s34, v108
    v_xor_b32 v109, s34, v109
    v_mfma_f32_16x16x32_bf16 v[28:31], v[92:95], v[112:115], v[28:31]
    v_xor_b32 v110, s34, v110
    v_xor_b32 v111, s34, v111
    v_mfma_f32_16x16x32_bf16 v[32:35], v[92:95], v[120:123], v[32:35]
    v_xor_b32 v116, s34, v116
    v_xor_b32 v117, s34, v117
    v_mfma_f32_16x16x32_bf16 v[36:39], v[100:103], v[104:107], v[36:39]
    v_xor_b32 v118, s34, v118
    v_xor_b32 v119, s34, v119
    v_mfma_f32_16x16x32_bf16 v[40:43], v[100:103], v[112:115], v[40:43]
    v_xor_b32 v124, s34, v124
    v_xor_b32 v125, s34, v125
    v_mfma_f32_16x16x32_bf16 v[44:47], v[100:103], v[120:123], v[44:47]
    v_xor_b32 v126, s34, v126
    v_xor_b32 v127, s34, v127
    v_mfma_f32_16x16x32_bf16 v[0:3], v[92:95], v[108:111], v[0:3]
    v_mfma_f32_16x16x32_bf16 v[4:7], v[92:95], v[116:119], v[4:7]
    v_mfma_f32_16x16x32_bf16 v[8:11], v[92:95], v[124:127], v[8:11]
    v_mfma_f32_16x16x32_bf16 v[12:15], v[100:103], v[108:111], v[12:15]
    v_mfma_f32_16x16x32_bf16 v[16:19], v[100:103], v[116:119], v[16:19]
    v_mfma_f32_16x16x32_bf16 v[20:23], v[100:103], v[124:127], v[20:23]
    s_nop 7
    s_nop 7
    v_cvt_pk_bf16_f32 v48, v24, v25
    v_cvt_pk_bf16_f32 v49, v26, v27
    v_cvt_pk_bf16_f32 v50, v36, v37
    v_cvt_pk_bf16_f32 v51, v38, v39
    s_add_u32 s35, s33, 0
    buffer_store_dwordx4 v[48:51], v141, s[16:19], s35 offen offset:64 sc1
    v_cvt_pk_bf16_f32 v52, v28, v29
    v_cvt_pk_bf16_f32 v53, v30, v31
    v_cvt_pk_bf16_f32 v54, v40, v41
    v_cvt_pk_bf16_f32 v55, v42, v43
    s_add_u32 s35, s33, 524288
    buffer_store_dwordx4 v[52:55], v141, s[16:19], s35 offen offset:64 sc1
    v_cvt_pk_bf16_f32 v56, v32, v33
    v_cvt_pk_bf16_f32 v57, v34, v35
    v_cvt_pk_bf16_f32 v58, v44, v45
    v_cvt_pk_bf16_f32 v59, v46, v47
    s_add_u32 s35, s33, 1048576
    buffer_store_dwordx4 v[56:59], v141, s[16:19], s35 offen offset:64 sc1
    v_cvt_pk_bf16_f32 v60, v0, v1
    v_cvt_pk_bf16_f32 v61, v2, v3
    v_cvt_pk_bf16_f32 v62, v12, v13
    v_cvt_pk_bf16_f32 v63, v14, v15
    s_add_u32 s35, s33, 0
    buffer_store_dwordx4 v[60:63], v141, s[16:19], s35 offen offset:0 sc1
    v_cvt_pk_bf16_f32 v64, v4, v5
    v_cvt_pk_bf16_f32 v65, v6, v7
    v_cvt_pk_bf16_f32 v66, v16, v17
    v_cvt_pk_bf16_f32 v67, v18, v19
    s_add_u32 s35, s33, 524288
    buffer_store_dwordx4 v[64:67], v141, s[16:19], s35 offen offset:0 sc1
    v_cvt_pk_bf16_f32 v68, v8, v9
    v_cvt_pk_bf16_f32 v69, v10, v11
    v_cvt_pk_bf16_f32 v70, v20, v21
    v_cvt_pk_bf16_f32 v71, v22, v23
    s_add_u32 s35, s33, 1048576
    buffer_store_dwordx4 v[68:71], v141, s[16:19], s35 offen offset:0 sc1
    s_endpgm
L_gemm2_kernel_loader:
    s_sub_u32 s20, s20, 4
    v_and_b32 v3, 63, v0
    v_lshrrev_b32 v4, 3, v3
    v_and_b32 v5, 7, v3
    v_xor_b32 v5, v5, v4
    v_lshlrev_b32 v5, 4, v5
    v_lshl_add_u32 v1, v4, 11, v5
    v_lshlrev_b32 v2, 4, v3
    s_add_u32 s24, s20, 0
    s_lshl_b32 s40, s24, 10
    s_lshl_b32 s43, s24, 14
    s_add_u32 s24, s20, 4
    s_lshl_b32 s41, s24, 10
    s_lshl_b32 s44, s24, 14
    s_add_u32 s24, s20, 8
    s_lshl_b32 s42, s24, 10
    s_lshl_b32 s45, s24, 14
    s_mul_i32 s46, s20, 2048
    s_add_u32 s47, s46, 12288
    s_add_u32 m0, s40, 0
    s_add_u32 s24, s43, 0
    buffer_load_dwordx4 v1, s[8:11], s24 offen lds
    s_add_u32 m0, s41, 0
    s_add_u32 s24, s44, 0
    buffer_load_dwordx4 v1, s[8:11], s24 offen lds
    s_add_u32 m0, s42, 0
    s_add_u32 s24, s45, 0
    buffer_load_dwordx4 v1, s[8:11], s24 offen lds
    s_add_u32 m0, s47, 0
    s_add_u32 s24, s46, 0
    buffer_load_dwordx4 v2, s[12:15], s24 offen offset:0 lds
    buffer_load_dwordx4 v2, s[12:15], s24 offen offset:1024 lds
    s_add_u32 m0, s40, 20480
    s_add_u32 s24, s43, 128
    buffer_load_dwordx4 v1, s[8:11], s24 offen lds
    s_add_u32 m0, s41, 20480
    s_add_u32 s24, s44, 128
    buffer_load_dwordx4 v1, s[8:11], s24 offen lds
    s_add_u32 m0, s42, 20480
    s_add_u32 s24, s45, 128
    buffer_load_dwordx4 v1, s[8:11], s24 offen lds
    s_add_u32 m0, s47, 20480
    s_add_u32 s24, s46, 32768
    buffer_load_dwordx4 v2, s[12:15], s24 offen offset:0 lds
    buffer_load_dwordx4 v2, s[12:15], s24 offen offset:1024 lds
    s_waitcnt vmcnt(5)
    s_barrier
    s_add_u32 m0, s40, 40960
    s_add_u32 s24, s43, 256
    buffer_load_dwordx4 v1, s[8:11], s24 offen lds
    s_add_u32 m0, s41, 40960
    s_add_u32 s24, s44, 256
    buffer_load_dwordx4 v1, s[8:11], s24 offen lds
    s_add_u32 m0, s42, 40960
    s_add_u32 s24, s45, 256
    buffer_load_dwordx4 v1, s[8:11], s24 offen lds
    s_add_u32 m0, s47, 40960
    s_add_u32 s24, s46, 65536
    buffer_load_dwordx4 v2, s[12:15], s24 offen offset:0 lds
    buffer_load_dwordx4 v2, s[12:15], s24 offen offset:1024 lds
    s_waitcnt vmcnt(5)
    s_barrier
    s_add_u32 m0, s40, 61440
    s_add_u32 s24, s43, 384
    buffer_load_dwordx4 v1, s[8:11], s24 offen lds
    s_add_u32 m0, s41, 61440
    s_add_u32 s24, s44, 384
    buffer_load_dwordx4 v1, s[8:11], s24 offen lds
    s_add_u32 m0, s42, 61440
    s_add_u32 s24, s45, 384
    buffer_load_dwordx4 v1, s[8:11], s24 offen lds
    s_add_u32 m0, s47, 61440
    s_add_u32 s24, s46, 98304
    buffer_load_dwordx4 v2, s[12:15], s24 offen offset:0 lds
    buffer_load_dwordx4 v2, s[12:15], s24 offen offset:1024 lds
    s_add_u32 m0, s40, 81920
    s_add_u32 s24, s43, 512
    buffer_load_dwordx4 v1, s[8:11], s24 offen lds
    s_add_u32 m0, s41, 81920
    s_add_u32 s24, s44, 512
    buffer_load_dwordx4 v1, s[8:11], s24 offen lds
    s_add_u32 m0, s42, 81920
    s_add_u32 s24, s45, 512
    buffer_load_dwordx4 v1, s[8:11], s24 offen lds
    s_add_u32 m0, s47, 81920
    s_add_u32 s24, s46, 131072
    buffer_load_dwordx4 v2, s[12:15], s24 offen offset:0 lds
    buffer_load_dwordx4 v2, s[12:15], s24 offen offset:1024 lds
    s_waitcnt vmcnt(10)
    s_barrier
    s_add_u32 m0, s40, 102400
    s_add_u32 s24, s43, 640
    buffer_load_dwordx4 v1, s[8:11], s24 offen lds
    s_add_u32 m0, s41, 102400
    s_add_u32 s24, s44, 640
    buffer_load_dwordx4 v1, s[8:11], s24 offen lds
    s_add_u32 m0, s42, 102400
    s_add_u32 s24, s45, 640
    buffer_load_dwordx4 v1, s[8:11], s24 offen lds
    s_add_u32 m0, s47, 102400
    s_add_u32 s24, s46, 163840
    buffer_load_dwordx4 v2, s[12:15], s24 offen offset:0 lds
    buffer_load_dwordx4 v2, s[12:15], s24 offen offset:1024 lds
    s_add_u32 m0, s40, 122880
    s_add_u32 s24, s43, 768
    buffer_load_dwordx4 v1, s[8:11], s24 offen lds
    s_add_u32 m0, s41, 122880
    s_add_u32 s24, s44, 768
    buffer_load_dwordx4 v1, s[8:11], s24 offen lds
    s_add_u32 m0, s42, 122880
    s_add_u32 s24, s45, 768
    buffer_load_dwordx4 v1, s[8:11], s24 offen lds
    s_add_u32 m0, s47, 122880
    s_add_u32 s24, s46, 196608
    buffer_load_dwordx4 v2, s[12:15], s24 offen offset:0 lds
    buffer_load_dwordx4 v2, s[12:15], s24 offen offset:1024 lds
    s_waitcnt vmcnt(15)
    s_barrier
    s_add_u32 m0, s40, 0
    s_add_u32 s24, s43, 896
    buffer_load_dwordx4 v1, s[8:11], s24 offen lds
    s_add_u32 m0, s41, 0
    s_add_u32 s24, s44, 896
    buffer_load_dwordx4 v1, s[8:11], s24 offen lds
    s_add_u32 m0, s42, 0
    s_add_u32 s24, s45, 896
    buffer_load_dwordx4 v1, s[8:11], s24 offen lds
    s_add_u32 m0, s47, 0
    s_add_u32 s24, s46, 229376
    buffer_load_dwordx4 v2, s[12:15], s24 offen offset:0 lds
    buffer_load_dwordx4 v2, s[12:15], s24 offen offset:1024 lds
    s_add_u32 m0, s40, 20480
    s_add_u32 s24, s43, 1024
    buffer_load_dwordx4 v1, s[8:11], s24 offen lds
    s_add_u32 m0, s41, 20480
    s_add_u32 s24, s44, 1024
    buffer_load_dwordx4 v1, s[8:11], s24 offen lds
    s_add_u32 m0, s42, 20480
    s_add_u32 s24, s45, 1024
    buffer_load_dwordx4 v1, s[8:11], s24 offen lds
    s_add_u32 m0, s47, 20480
    s_add_u32 s24, s46, 262144
    buffer_load_dwordx4 v2, s[12:15], s24 offen offset:0 lds
    buffer_load_dwordx4 v2, s[12:15], s24 offen offset:1024 lds
    s_waitcnt vmcnt(20)
    s_barrier
    s_add_u32 m0, s40, 40960
    s_add_u32 s24, s43, 1152
    buffer_load_dwordx4 v1, s[8:11], s24 offen lds
    s_add_u32 m0, s41, 40960
    s_add_u32 s24, s44, 1152
    buffer_load_dwordx4 v1, s[8:11], s24 offen lds
    s_add_u32 m0, s42, 40960
    s_add_u32 s24, s45, 1152
    buffer_load_dwordx4 v1, s[8:11], s24 offen lds
    s_add_u32 m0, s47, 40960
    s_add_u32 s24, s46, 294912
    buffer_load_dwordx4 v2, s[12:15], s24 offen offset:0 lds
    buffer_load_dwordx4 v2, s[12:15], s24 offen offset:1024 lds
    s_add_u32 m0, s40, 61440
    s_add_u32 s24, s43, 1280
    buffer_load_dwordx4 v1, s[8:11], s24 offen lds
    s_add_u32 m0, s41, 61440
    s_add_u32 s24, s44, 1280
    buffer_load_dwordx4 v1, s[8:11], s24 offen lds
    s_add_u32 m0, s42, 61440
    s_add_u32 s24, s45, 1280
    buffer_load_dwordx4 v1, s[8:11], s24 offen lds
    s_add_u32 m0, s47, 61440
    s_add_u32 s24, s46, 327680
    buffer_load_dwordx4 v2, s[12:15], s24 offen offset:0 lds
    buffer_load_dwordx4 v2, s[12:15], s24 offen offset:1024 lds
    s_waitcnt vmcnt(25)
    s_barrier
    s_add_u32 m0, s40, 81920
    s_add_u32 s24, s43, 1408
    buffer_load_dwordx4 v1, s[8:11], s24 offen lds
    s_add_u32 m0, s41, 81920
    s_add_u32 s24, s44, 1408
    buffer_load_dwordx4 v1, s[8:11], s24 offen lds
    s_add_u32 m0, s42, 81920
    s_add_u32 s24, s45, 1408
    buffer_load_dwordx4 v1, s[8:11], s24 offen lds
    s_add_u32 m0, s47, 81920
    s_add_u32 s24, s46, 360448
    buffer_load_dwordx4 v2, s[12:15], s24 offen offset:0 lds
    buffer_load_dwordx4 v2, s[12:15], s24 offen offset:1024 lds
    s_waitcnt vmcnt(25)
    s_barrier
    s_add_u32 m0, s40, 102400
    s_add_u32 s24, s43, 1536
    buffer_load_dwordx4 v1, s[8:11], s24 offen lds
    s_add_u32 m0, s41, 102400
    s_add_u32 s24, s44, 1536
    buffer_load_dwordx4 v1, s[8:11], s24 offen lds
    s_add_u32 m0, s42, 102400
    s_add_u32 s24, s45, 1536
    buffer_load_dwordx4 v1, s[8:11], s24 offen lds
    s_add_u32 m0, s47, 102400
    s_add_u32 s24, s46, 393216
    buffer_load_dwordx4 v2, s[12:15], s24 offen offset:0 lds
    buffer_load_dwordx4 v2, s[12:15], s24 offen offset:1024 lds
    s_waitcnt vmcnt(25)
    s_barrier
    s_add_u32 m0, s40, 122880
    s_add_u32 s24, s43, 1664
    buffer_load_dwordx4 v1, s[8:11], s24 offen lds
    s_add_u32 m0, s41, 122880
    s_add_u32 s24, s44, 1664
    buffer_load_dwordx4 v1, s[8:11], s24 offen lds
    s_add_u32 m0, s42, 122880
    s_add_u32 s24, s45, 1664
    buffer_load_dwordx4 v1, s[8:11], s24 offen lds
    s_add_u32 m0, s47, 122880
    s_add_u32 s24, s46, 425984
    buffer_load_dwordx4 v2, s[12:15], s24 offen offset:0 lds
    buffer_load_dwordx4 v2, s[12:15], s24 offen offset:1024 lds
    s_waitcnt vmcnt(25)
    s_barrier
    s_add_u32 m0, s40, 0
    s_add_u32 s24, s43, 1792
    buffer_load_dwordx4 v1, s[8:11], s24 offen lds
    s_add_u32 m0, s41, 0
    s_add_u32 s24, s44, 1792
    buffer_load_dwordx4 v1, s[8:11], s24 offen lds
    s_add_u32 m0, s42, 0
    s_add_u32 s24, s45, 1792
    buffer_load_dwordx4 v1, s[8:11], s24 offen lds
    s_add_u32 m0, s47, 0
    s_add_u32 s24, s46, 458752
    buffer_load_dwordx4 v2, s[12:15], s24 offen offset:0 lds
    buffer_load_dwordx4 v2, s[12:15], s24 offen offset:1024 lds
    s_waitcnt vmcnt(25)
    s_barrier
    s_add_u32 m0, s40, 20480
    s_add_u32 s24, s43, 1920
    buffer_load_dwordx4 v1, s[8:11], s24 offen lds
    s_add_u32 m0, s41, 20480
    s_add_u32 s24, s44, 1920
    buffer_load_dwordx4 v1, s[8:11], s24 offen lds
    s_add_u32 m0, s42, 20480
    s_add_u32 s24, s45, 1920
    buffer_load_dwordx4 v1, s[8:11], s24 offen lds
    s_add_u32 m0, s47, 20480
    s_add_u32 s24, s46, 491520
    buffer_load_dwordx4 v2, s[12:15], s24 offen offset:0 lds
    buffer_load_dwordx4 v2, s[12:15], s24 offen offset:1024 lds
    s_waitcnt vmcnt(25)
    s_barrier
    s_waitcnt vmcnt(20)
    s_barrier
    s_waitcnt vmcnt(15)
    s_barrier
    s_waitcnt vmcnt(10)
    s_barrier
    s_waitcnt vmcnt(5)
    s_barrier
    s_waitcnt vmcnt(0)
    s_barrier
L_gemm2_kernel_done:
    s_endpgm
.globl joint_kernel
.p2align 8
.type joint_kernel,@function
joint_kernel:
    s_cmp_ge_u32 s2, 250
    s_cbranch_scc1 L_joint_kernel_done
    s_load_dwordx2 s[6:7], s[0:1], 72
    s_load_dwordx2 s[4:5], s[0:1], 56
    v_readfirstlane_b32 s20, v0
    s_lshr_b32 s20, s20, 6
    s_and_b32 s21, s20, 3
    s_cmp_ge_u32 s2, 125
    s_cselect_b32 s24, 1, 0
    s_mul_i32 s25, s24, 125
    s_sub_u32 s25, s2, s25
    s_lshl_b32 s26, s25, 1
    s_add_u32 s26, s26, 0
    s_mul_i32 s27, s26, 171
    s_lshr_b32 s28, s27, 9
    s_mul_i32 s27, s28, 3
    s_sub_u32 s30, s26, s27
    s_lshl_b32 s26, s25, 1
    s_add_u32 s26, s26, 1
    s_mul_i32 s27, s26, 171
    s_lshr_b32 s29, s27, 9
    s_mul_i32 s27, s29, 3
    s_sub_u32 s31, s26, s27
    v_and_b32 v1, 63, v0
    v_lshlrev_b32 v5, 4, v1
    s_waitcnt lgkmcnt(0)
    s_add_u32 s12, s6, 83312640
    s_addc_u32 s13, s7, 0
    s_mov_b32 s14, 294912
    s_mov_b32 s15, 0x00020000
    s_mul_i32 s36, s24, 4000
    s_lshl_b32 s37, s25, 5
    s_add_u32 s36, s36, s37
    s_lshl_b32 s36, s36, 12
    s_add_u32 s16, s4, s36
    s_addc_u32 s17, s5, 0
    s_mov_b32 s18, 131072
    s_mov_b32 s19, 0x00020000
    s_lshl_b32 s38, s21, 15
    s_cmp_ge_u32 s20, 4
    s_cbranch_scc1 L_joint_kernel_helper
    v_lshrrev_b32 v2, 2, v1
    v_lshlrev_b32 v2, 6, v2
    v_lshrrev_b32 v3, 5, v1
    v_lshlrev_b32 v3, 1, v3
    v_and_b32 v4, 3, v1
    v_xor_b32 v3, v3, v4
    v_lshl_add_u32 v2, v3, 4, v2
    s_lshl_b32 s34, s21, 14
    s_lshl_b32 s35, s21, 13
    s_mul_i32 s33, s24, 2752512
    s_add_u32 s33, s33, 77807616
    s_add_u32 s8, s6, s33
    s_addc_u32 s9, s7, 0
    s_mov_b32 s10, 2752512
    s_mov_b32 s11, 0x00020000
    s_mov_b32 s46, 0
    s_cmp_eq_u32 s28, s29
    s_cbranch_scc1 L_joint_kernel_same
    s_lshl_b32 s36, s29, 15
    s_add_u32 s36, s36, s35
    s_add_u32 m0, s34, 8192
    s_add_u32 s37, s36, 0
    buffer_load_dwordx4 v2, s[8:11], s37 offen offset:0 lds
    buffer_load_dwordx4 v2, s[8:11], s37 offen offset:1024 lds
    buffer_load_dwordx4 v2, s[8:11], s37 offen offset:2048 lds
    buffer_load_dwordx4 v2, s[8:11], s37 offen offset:3072 lds
    s_add_u32 m0, s34, 12288
    s_add_u32 s37, s36, 4096
    buffer_load_dwordx4 v2, s[8:11], s37 offen offset:0 lds
    buffer_load_dwordx4 v2, s[8:11], s37 offen offset:1024 lds
    buffer_load_dwordx4 v2, s[8:11], s37 offen offset:2048 lds
    buffer_load_dwordx4 v2, s[8:11], s37 offen offset:3072 lds
    s_mov_b32 s46, 8192
L_joint_kernel_same:
    s_lshl_b32 s36, s30, 11
    s_add_u32 s36, s36, 8192
    buffer_load_dwordx4 v[8:11], v5, s[12:15], s36 offen offset:0
    buffer_load_dwordx4 v[12:15], v5, s[12:15], s36 offen offset:1024
    s_lshl_b32 s36, s31, 11
    s_add_u32 s36, s36, 8192
    buffer_load_dwordx4 v[16:19], v5, s[12:15], s36 offen offset:0
    buffer_load_dwordx4 v[20:23], v5, s[12:15], s36 offen offset:1024
    s_lshl_b32 s36, s28, 15
    s_add_u32 s36, s36, s35
    s_add_u32 m0, s34, 0
    s_add_u32 s37, s36, 0
    buffer_load_dwordx4 v2, s[8:11], s37 offen offset:0 lds
    buffer_load_dwordx4 v2, s[8:11], s37 offen offset:1024 lds
    buffer_load_dwordx4 v2, s[8:11], s37 offen offset:2048 lds
    buffer_load_dwordx4 v2, s[8:11], s37 offen offset:3072 lds
    s_add_u32 m0, s34, 4096
    s_add_u32 s37, s36, 4096
    buffer_load_dwordx4 v2, s[8:11], s37 offen offset:0 lds
    buffer_load_dwordx4 v2, s[8:11], s37 offen offset:1024 lds
    buffer_load_dwordx4 v2, s[8:11], s37 offen offset:2048 lds
    buffer_load_dwordx4 v2, s[8:11], s37 offen offset:3072 lds
    v_bfe_u32 v32, v1, 2, 2
    v_lshrrev_b32 v33, 4, v1
    v_and_b32 v34, 3, v1
    v_lshl_add_u32 v35, v33, 3, v32
    v_lshlrev_b32 v40, 6, v35
    v_and_b32 v41, 1, v33
    v_lshlrev_b32 v41, 1, v41
    v_lshrrev_b32 v42, 1, v34
    v_xor_b32 v41, v41, v42
    v_lshl_add_u32 v40, v41, 4, v40
    v_and_b32 v42, 1, v34
    v_lshl_add_u32 v40, v42, 3, v40
    v_add_u32 v36, s34, v40
    v_xor_b32 v37, 32, v36
    v_add_u32 v38, s46, v36
    v_add_u32 v39, s46, v37
    v_lshrrev_b32 v41, 1, v33
    v_lshlrev_b32 v41, 10, v41
    v_and_b32 v42, 1, v33
    v_lshl_add_u32 v41, v42, 9, v41
    v_and_b32 v42, 15, v1
    v_lshl_add_u32 v41, v42, 4, v41
    s_lshl_b32 s36, s21, 12
    s_add_u32 s36, s36, 65536
    v_add_u32 v43, s36, v41
    s_mov_b32 s40, 0xbdd2d3e8
    v_mov_b32 v44, 0xc0135761
    s_waitcnt vmcnt(4)
    ds_read_b64_tr_b16 v[48:49], v36 offset:0
    ds_read_b64_tr_b16 v[50:51], v36 offset:256
    ds_read_b64_tr_b16 v[52:53], v36 offset:2048
    ds_read_b64_tr_b16 v[54:55], v36 offset:2304
    ds_read_b64_tr_b16 v[56:57], v37 offset:0
    ds_read_b64_tr_b16 v[58:59], v37 offset:256
    ds_read_b64_tr_b16 v[60:61], v37 offset:2048
    ds_read_b64_tr_b16 v[62:63], v37 offset:2304
    s_waitcnt lgkmcnt(0)
    v_mfma_f32_16x16x32_bf16 v[64:67], v[48:51], v[8:11], 0
    v_mfma_f32_16x16x32_bf16 v[68:71], v[56:59], v[8:11], 0
    v_mfma_f32_16x16x32_bf16 v[64:67], v[52:55], v[12:15], v[64:67]
    v_mfma_f32_16x16x32_bf16 v[68:71], v[60:63], v[12:15], v[68:71]
    ds_read_b64_tr_b16 v[84:85], v38 offset:0
    ds_read_b64_tr_b16 v[86:87], v38 offset:256
    ds_read_b64_tr_b16 v[88:89], v38 offset:2048
    ds_read_b64_tr_b16 v[90:91], v38 offset:2304
    ds_read_b64_tr_b16 v[92:93], v39 offset:0
    ds_read_b64_tr_b16 v[94:95], v39 offset:256
    ds_read_b64_tr_b16 v[96:97], v39 offset:2048
    ds_read_b64_tr_b16 v[98:99], v39 offset:2304
    v_mul_f32 v72, v64, v64
    v_mul_f32 v73, v65, v65
    v_mul_f32 v74, v66, v66
    v_mul_f32 v75, v67, v67
    v_mul_f32 v76, v68, v68
    v_mul_f32 v77, v69, v69
    v_mul_f32 v78, v70, v70
    v_mul_f32 v79, v71, v71
    v_fma_f32 v72, v72, s40, v44
    v_fma_f32 v73, v73, s40, v44
    v_fma_f32 v74, v74, s40, v44
    v_fma_f32 v75, v75, s40, v44
    v_fma_f32 v76, v76, s40, v44
    v_fma_f32 v77, v77, s40, v44
    v_fma_f32 v78, v78, s40, v44
    v_fma_f32 v79, v79, s40, v44
    v_mul_f32 v72, v72, v64
    v_mul_f32 v73, v73, v65
    v_mul_f32 v74, v74, v66
    v_mul_f32 v75, v75, v67
    v_mul_f32 v76, v76, v68
    v_mul_f32 v77, v77, v69
    v_mul_f32 v78, v78, v70
    v_mul_f32 v79, v79, v71
    v_exp_f32 v72, v72
    v_exp_f32 v73, v73
    v_exp_f32 v74, v74
    v_exp_f32 v75, v75
    v_exp_f32 v76, v76
    v_exp_f32 v77, v77
    v_exp_f32 v78, v78
    v_exp_f32 v79, v79
    v_add_f32 v72, 1.0, v72
    v_add_f32 v73, 1.0, v73
    v_add_f32 v74, 1.0, v74
    v_add_f32 v75, 1.0, v75
    v_add_f32 v76, 1.0, v76
    v_add_f32 v77, 1.0, v77
    v_add_f32 v78, 1.0, v78
    v_add_f32 v79, 1.0, v79
    v_rcp_f32 v72, v72
    v_rcp_f32 v73, v73
    v_rcp_f32 v74, v74
    v_rcp_f32 v75, v75
    v_rcp_f32 v76, v76
    v_rcp_f32 v77, v77
    v_rcp_f32 v78, v78
    v_rcp_f32 v79, v79
    v_mul_f32 v64, v64, v72
    v_mul_f32 v65, v65, v73
    v_mul_f32 v66, v66, v74
    v_mul_f32 v67, v67, v75
    v_mul_f32 v68, v68, v76
    v_mul_f32 v69, v69, v77
    v_mul_f32 v70, v70, v78
    v_mul_f32 v71, v71, v79
    v_cvt_pk_bf16_f32 v80, v64, v65
    v_cvt_pk_bf16_f32 v81, v66, v67
    v_cvt_pk_bf16_f32 v82, v68, v69
    v_cvt_pk_bf16_f32 v83, v70, v71
    ds_write_b128 v43, v[80:83] offset:0
    s_waitcnt vmcnt(0)
    s_waitcnt lgkmcnt(1)
    v_mfma_f32_16x16x32_bf16 v[100:103], v[84:87], v[16:19], 0
    v_mfma_f32_16x16x32_bf16 v[104:107], v[92:95], v[16:19], 0
    v_mfma_f32_16x16x32_bf16 v[100:103], v[88:91], v[20:23], v[100:103]
    v_mfma_f32_16x16x32_bf16 v[104:107], v[96:99], v[20:23], v[104:107]
    ds_read_b64_tr_b16 v[48:49], v36 offset:4096
    ds_read_b64_tr_b16 v[50:51], v36 offset:4352
    ds_read_b64_tr_b16 v[52:53], v36 offset:6144
    ds_read_b64_tr_b16 v[54:55], v36 offset:6400
    ds_read_b64_tr_b16 v[56:57], v37 offset:4096
    ds_read_b64_tr_b16 v[58:59], v37 offset:4352
    ds_read_b64_tr_b16 v[60:61], v37 offset:6144
    ds_read_b64_tr_b16 v[62:63], v37 offset:6400
    v_mul_f32 v72, v100, v100
    v_mul_f32 v73, v101, v101
    v_mul_f32 v74, v102, v102
    v_mul_f32 v75, v103, v103
    v_mul_f32 v76, v104, v104
    v_mul_f32 v77, v105, v105
    v_mul_f32 v78, v106, v106
    v_mul_f32 v79, v107, v107
    v_fma_f32 v72, v72, s40, v44
    v_fma_f32 v73, v73, s40, v44
    v_fma_f32 v74, v74, s40, v44
    v_fma_f32 v75, v75, s40, v44
    v_fma_f32 v76, v76, s40, v44
    v_fma_f32 v77, v77, s40, v44
    v_fma_f32 v78, v78, s40, v44
    v_fma_f32 v79, v79, s40, v44
    v_mul_f32 v72, v72, v100
    v_mul_f32 v73, v73, v101
    v_mul_f32 v74, v74, v102
    v_mul_f32 v75, v75, v103
    v_mul_f32 v76, v76, v104
    v_mul_f32 v77, v77, v105
    v_mul_f32 v78, v78, v106
    v_mul_f32 v79, v79, v107
    v_exp_f32 v72, v72
    v_exp_f32 v73, v73
    v_exp_f32 v74, v74
    v_exp_f32 v75, v75
    v_exp_f32 v76, v76
    v_exp_f32 v77, v77
    v_exp_f32 v78, v78
    v_exp_f32 v79, v79
    v_add_f32 v72, 1.0, v72
    v_add_f32 v73, 1.0, v73
    v_add_f32 v74, 1.0, v74
    v_add_f32 v75, 1.0, v75
    v_add_f32 v76, 1.0, v76
    v_add_f32 v77, 1.0, v77
    v_add_f32 v78, 1.0, v78
    v_add_f32 v79, 1.0, v79
    v_rcp_f32 v72, v72
    v_rcp_f32 v73, v73
    v_rcp_f32 v74, v74
    v_rcp_f32 v75, v75
    v_rcp_f32 v76, v76
    v_rcp_f32 v77, v77
    v_rcp_f32 v78, v78
    v_rcp_f32 v79, v79
    v_mul_f32 v100, v100, v72
    v_mul_f32 v101, v101, v73
    v_mul_f32 v102, v102, v74
    v_mul_f32 v103, v103, v75
    v_mul_f32 v104, v104, v76
    v_mul_f32 v105, v105, v77
    v_mul_f32 v106, v106, v78
    v_mul_f32 v107, v107, v79
    v_cvt_pk_bf16_f32 v108, v100, v101
    v_cvt_pk_bf16_f32 v109, v102, v103
    v_cvt_pk_bf16_f32 v110, v104, v105
    v_cvt_pk_bf16_f32 v111, v106, v107
    ds_write_b128 v43, v[108:111] offset:256
    s_waitcnt lgkmcnt(1)
    v_mfma_f32_16x16x32_bf16 v[64:67], v[48:51], v[8:11], 0
    v_mfma_f32_16x16x32_bf16 v[68:71], v[56:59], v[8:11], 0
    v_mfma_f32_16x16x32_bf16 v[64:67], v[52:55], v[12:15], v[64:67]
    v_mfma_f32_16x16x32_bf16 v[68:71], v[60:63], v[12:15], v[68:71]
    ds_read_b64_tr_b16 v[84:85], v38 offset:4096
    ds_read_b64_tr_b16 v[86:87], v38 offset:4352
    ds_read_b64_tr_b16 v[88:89], v38 offset:6144
    ds_read_b64_tr_b16 v[90:91], v38 offset:6400
    ds_read_b64_tr_b16 v[92:93], v39 offset:4096
    ds_read_b64_tr_b16 v[94:95], v39 offset:4352
    ds_read_b64_tr_b16 v[96:97], v39 offset:6144
    ds_read_b64_tr_b16 v[98:99], v39 offset:6400
    v_mul_f32 v72, v64, v64
    v_mul_f32 v73, v65, v65
    v_mul_f32 v74, v66, v66
    v_mul_f32 v75, v67, v67
    v_mul_f32 v76, v68, v68
    v_mul_f32 v77, v69, v69
    v_mul_f32 v78, v70, v70
    v_mul_f32 v79, v71, v71
    v_fma_f32 v72, v72, s40, v44
    v_fma_f32 v73, v73, s40, v44
    v_fma_f32 v74, v74, s40, v44
    v_fma_f32 v75, v75, s40, v44
    v_fma_f32 v76, v76, s40, v44
    v_fma_f32 v77, v77, s40, v44
    v_fma_f32 v78, v78, s40, v44
    v_fma_f32 v79, v79, s40, v44
    v_mul_f32 v72, v72, v64
    v_mul_f32 v73, v73, v65
    v_mul_f32 v74, v74, v66
    v_mul_f32 v75, v75, v67
    v_mul_f32 v76, v76, v68
    v_mul_f32 v77, v77, v69
    v_mul_f32 v78, v78, v70
    v_mul_f32 v79, v79, v71
    v_exp_f32 v72, v72
    v_exp_f32 v73, v73
    v_exp_f32 v74, v74
    v_exp_f32 v75, v75
    v_exp_f32 v76, v76
    v_exp_f32 v77, v77
    v_exp_f32 v78, v78
    v_exp_f32 v79, v79
    v_add_f32 v72, 1.0, v72
    v_add_f32 v73, 1.0, v73
    v_add_f32 v74, 1.0, v74
    v_add_f32 v75, 1.0, v75
    v_add_f32 v76, 1.0, v76
    v_add_f32 v77, 1.0, v77
    v_add_f32 v78, 1.0, v78
    v_add_f32 v79, 1.0, v79
    v_rcp_f32 v72, v72
    v_rcp_f32 v73, v73
    v_rcp_f32 v74, v74
    v_rcp_f32 v75, v75
    v_rcp_f32 v76, v76
    v_rcp_f32 v77, v77
    v_rcp_f32 v78, v78
    v_rcp_f32 v79, v79
    v_mul_f32 v64, v64, v72
    v_mul_f32 v65, v65, v73
    v_mul_f32 v66, v66, v74
    v_mul_f32 v67, v67, v75
    v_mul_f32 v68, v68, v76
    v_mul_f32 v69, v69, v77
    v_mul_f32 v70, v70, v78
    v_mul_f32 v71, v71, v79
    v_cvt_pk_bf16_f32 v80, v64, v65
    v_cvt_pk_bf16_f32 v81, v66, v67
    v_cvt_pk_bf16_f32 v82, v68, v69
    v_cvt_pk_bf16_f32 v83, v70, v71
    ds_write_b128 v43, v[80:83] offset:2048
    s_waitcnt lgkmcnt(1)
    v_mfma_f32_16x16x32_bf16 v[100:103], v[84:87], v[16:19], 0
    v_mfma_f32_16x16x32_bf16 v[104:107], v[92:95], v[16:19], 0
    v_mfma_f32_16x16x32_bf16 v[100:103], v[88:91], v[20:23], v[100:103]
    v_mfma_f32_16x16x32_bf16 v[104:107], v[96:99], v[20:23], v[104:107]
    s_nop 7
    v_mul_f32 v72, v100, v100
    v_mul_f32 v73, v101, v101
    v_mul_f32 v74, v102, v102
    v_mul_f32 v75, v103, v103
    v_mul_f32 v76, v104, v104
    v_mul_f32 v77, v105, v105
    v_mul_f32 v78, v106, v106
    v_mul_f32 v79, v107, v107
    v_fma_f32 v72, v72, s40, v44
    v_fma_f32 v73, v73, s40, v44
    v_fma_f32 v74, v74, s40, v44
    v_fma_f32 v75, v75, s40, v44
    v_fma_f32 v76, v76, s40, v44
    v_fma_f32 v77, v77, s40, v44
    v_fma_f32 v78, v78, s40, v44
    v_fma_f32 v79, v79, s40, v44
    v_mul_f32 v72, v72, v100
    v_mul_f32 v73, v73, v101
    v_mul_f32 v74, v74, v102
    v_mul_f32 v75, v75, v103
    v_mul_f32 v76, v76, v104
    v_mul_f32 v77, v77, v105
    v_mul_f32 v78, v78, v106
    v_mul_f32 v79, v79, v107
    v_exp_f32 v72, v72
    v_exp_f32 v73, v73
    v_exp_f32 v74, v74
    v_exp_f32 v75, v75
    v_exp_f32 v76, v76
    v_exp_f32 v77, v77
    v_exp_f32 v78, v78
    v_exp_f32 v79, v79
    v_add_f32 v72, 1.0, v72
    v_add_f32 v73, 1.0, v73
    v_add_f32 v74, 1.0, v74
    v_add_f32 v75, 1.0, v75
    v_add_f32 v76, 1.0, v76
    v_add_f32 v77, 1.0, v77
    v_add_f32 v78, 1.0, v78
    v_add_f32 v79, 1.0, v79
    v_rcp_f32 v72, v72
    v_rcp_f32 v73, v73
    v_rcp_f32 v74, v74
    v_rcp_f32 v75, v75
    v_rcp_f32 v76, v76
    v_rcp_f32 v77, v77
    v_rcp_f32 v78, v78
    v_rcp_f32 v79, v79
    v_mul_f32 v100, v100, v72
    v_mul_f32 v101, v101, v73
    v_mul_f32 v102, v102, v74
    v_mul_f32 v103, v103, v75
    v_mul_f32 v104, v104, v76
    v_mul_f32 v105, v105, v77
    v_mul_f32 v106, v106, v78
    v_mul_f32 v107, v107, v79
    v_cvt_pk_bf16_f32 v108, v100, v101
    v_cvt_pk_bf16_f32 v109, v102, v103
    v_cvt_pk_bf16_f32 v110, v104, v105
    v_cvt_pk_bf16_f32 v111, v106, v107
    ds_write_b128 v43, v[108:111] offset:2304
    s_waitcnt lgkmcnt(0)
    s_barrier
    s_add_u32 s36, s38, 163840
    buffer_load_dwordx4 a[0:3], v5, s[12:15], s36 offen
    s_add_u32 s36, s38, 180224
    buffer_load_dwordx4 a[64:67], v5, s[12:15], s36 offen
    s_add_u32 s36, s38, 164864
    buffer_load_dwordx4 a[4:7], v5, s[12:15], s36 offen
    s_add_u32 s36, s38, 181248
    buffer_load_dwordx4 a[68:71], v5, s[12:15], s36 offen
    s_add_u32 s36, s38, 165888
    buffer_load_dwordx4 a[8:11], v5, s[12:15], s36 offen
    s_add_u32 s36, s38, 182272
    buffer_load_dwordx4 a[72:75], v5, s[12:15], s36 offen
    s_add_u32 s36, s38, 166912
    buffer_load_dwordx4 a[12:15], v5, s[12:15], s36 offen
    s_add_u32 s36, s38, 183296
    buffer_load_dwordx4 a[76:79], v5, s[12:15], s36 offen
    s_add_u32 s36, s38, 167936
    buffer_load_dwordx4 a[16:19], v5, s[12:15], s36 offen
    s_add_u32 s36, s38, 184320
    buffer_load_dwordx4 a[80:83], v5, s[12:15], s36 offen
    s_add_u32 s36, s38, 168960
    buffer_load_dwordx4 a[20:23], v5, s[12:15], s36 offen
    s_add_u32 s36, s38, 185344
    buffer_load_dwordx4 a[84:87], v5, s[12:15], s36 offen
    s_add_u32 s36, s38, 169984
    buffer_load_dwordx4 a[24:27], v5, s[12:15], s36 offen
    s_add_u32 s36, s38, 186368
    buffer_load_dwordx4 a[88:91], v5, s[12:15], s36 offen
    s_add_u32 s36, s38, 171008
    buffer_load_dwordx4 a[28:31], v5, s[12:15], s36 offen
    s_add_u32 s36, s38, 187392
    buffer_load_dwordx4 a[92:95], v5, s[12:15], s36 offen
    s_add_u32 s36, s38, 172032
    buffer_load_dwordx4 a[32:35], v5, s[12:15], s36 offen
    s_add_u32 s36, s38, 188416
    buffer_load_dwordx4 a[96:99], v5, s[12:15], s36 offen
    s_add_u32 s36, s38, 173056
    buffer_load_dwordx4 a[36:39], v5, s[12:15], s36 offen
    s_add_u32 s36, s38, 189440
    buffer_load_dwordx4 a[100:103], v5, s[12:15], s36 offen
    s_add_u32 s36, s38, 174080
    buffer_load_dwordx4 a[40:43], v5, s[12:15], s36 offen
    s_add_u32 s36, s38, 190464
    buffer_load_dwordx4 a[104:107], v5, s[12:15], s36 offen
    s_add_u32 s36, s38, 175104
    buffer_load_dwordx4 a[44:47], v5, s[12:15], s36 offen
    s_add_u32 s36, s38, 191488
    buffer_load_dwordx4 a[108:111], v5, s[12:15], s36 offen
    s_add_u32 s36, s38, 176128
    buffer_load_dwordx4 a[48:51], v5, s[12:15], s36 offen
    s_add_u32 s36, s38, 192512
    buffer_load_dwordx4 a[112:115], v5, s[12:15], s36 offen
    s_add_u32 s36, s38, 177152
    buffer_load_dwordx4 a[52:55], v5, s[12:15], s36 offen
    s_add_u32 s36, s38, 193536
    buffer_load_dwordx4 a[116:119], v5, s[12:15], s36 offen
    s_add_u32 s36, s38, 178176
    buffer_load_dwordx4 a[56:59], v5, s[12:15], s36 offen
    s_add_u32 s36, s38, 194560
    buffer_load_dwordx4 a[120:123], v5, s[12:15], s36 offen
    s_add_u32 s36, s38, 179200
    buffer_load_dwordx4 a[60:63], v5, s[12:15], s36 offen
    s_add_u32 s36, s38, 195584
    buffer_load_dwordx4 a[124:127], v5, s[12:15], s36 offen
    v_and_b32 v46, 31, v1
    v_mul_u32_u24 v47, 528, v46
    v_lshrrev_b32 v45, 5, v1
    v_lshl_add_u32 v47, v45, 4, v47
    s_lshl_b32 s36, s21, 7
    s_add_u32 s36, s36, 115712
    v_add_u32 v6, s36, v47
    v_lshlrev_b32 v7, 6, v45
    s_lshl_b32 s36, s21, 8
    s_add_u32 s36, s36, 14336
    buffer_load_dwordx4 v[72:75], v7, s[12:15], s36 offen offset:0
    buffer_load_dwordx4 v[76:79], v7, s[12:15], s36 offen offset:16
    buffer_load_dwordx4 v[80:83], v7, s[12:15], s36 offen offset:32
    buffer_load_dwordx4 v[84:87], v7, s[12:15], s36 offen offset:48
    buffer_load_dwordx4 v[88:91], v7, s[12:15], s36 offen offset:128
    buffer_load_dwordx4 v[92:95], v7, s[12:15], s36 offen offset:144
    buffer_load_dwordx4 v[96:99], v7, s[12:15], s36 offen offset:160
    buffer_load_dwordx4 v[100:103], v7, s[12:15], s36 offen offset:176
    s_setprio 1
    s_waitcnt vmcnt(0)
    s_barrier
    ds_read_b128 v[104:107], v5 offset:0
    ds_read_b128 v[108:111], v5 offset:1024
    ds_read_b128 v[112:115], v5 offset:2048
    s_waitcnt lgkmcnt(2)
    v_mfma_f32_32x32x16_bf16 v[8:23], a[0:3], v[104:107], v[72:87]
    ds_read_b128 v[116:119], v5 offset:3072
    v_mfma_f32_32x32x16_bf16 v[24:39], a[64:67], v[104:107], v[88:103]
    s_waitcnt lgkmcnt(2)
    v_mfma_f32_32x32x16_bf16 v[8:23], a[4:7], v[108:111], v[8:23]
    ds_read_b128 v[104:107], v5 offset:4096
    v_mfma_f32_32x32x16_bf16 v[24:39], a[68:71], v[108:111], v[24:39]
    s_waitcnt lgkmcnt(2)
    v_mfma_f32_32x32x16_bf16 v[8:23], a[8:11], v[112:115], v[8:23]
    ds_read_b128 v[108:111], v5 offset:5120
    v_mfma_f32_32x32x16_bf16 v[24:39], a[72:75], v[112:115], v[24:39]
    s_waitcnt lgkmcnt(2)
    v_mfma_f32_32x32x16_bf16 v[8:23], a[12:15], v[116:119], v[8:23]
    ds_read_b128 v[112:115], v5 offset:6144
    v_mfma_f32_32x32x16_bf16 v[24:39], a[76:79], v[116:119], v[24:39]
    s_waitcnt lgkmcnt(2)
    v_mfma_f32_32x32x16_bf16 v[8:23], a[16:19], v[104:107], v[8:23]
    ds_read_b128 v[116:119], v5 offset:7168
    v_mfma_f32_32x32x16_bf16 v[24:39], a[80:83], v[104:107], v[24:39]
    s_waitcnt lgkmcnt(2)
    v_mfma_f32_32x32x16_bf16 v[8:23], a[20:23], v[108:111], v[8:23]
    ds_read_b128 v[104:107], v5 offset:8192
    v_mfma_f32_32x32x16_bf16 v[24:39], a[84:87], v[108:111], v[24:39]
    s_waitcnt lgkmcnt(2)
    v_mfma_f32_32x32x16_bf16 v[8:23], a[24:27], v[112:115], v[8:23]
    ds_read_b128 v[108:111], v5 offset:9216
    v_mfma_f32_32x32x16_bf16 v[24:39], a[88:91], v[112:115], v[24:39]
    s_waitcnt lgkmcnt(2)
    v_mfma_f32_32x32x16_bf16 v[8:23], a[28:31], v[116:119], v[8:23]
    ds_read_b128 v[112:115], v5 offset:10240
    v_mfma_f32_32x32x16_bf16 v[24:39], a[92:95], v[116:119], v[24:39]
    s_waitcnt lgkmcnt(2)
    v_mfma_f32_32x32x16_bf16 v[8:23], a[32:35], v[104:107], v[8:23]
    ds_read_b128 v[116:119], v5 offset:11264
    v_mfma_f32_32x32x16_bf16 v[24:39], a[96:99], v[104:107], v[24:39]
    s_waitcnt lgkmcnt(2)
    v_mfma_f32_32x32x16_bf16 v[8:23], a[36:39], v[108:111], v[8:23]
    ds_read_b128 v[104:107], v5 offset:12288
    v_mfma_f32_32x32x16_bf16 v[24:39], a[100:103], v[108:111], v[24:39]
    s_waitcnt lgkmcnt(2)
    v_mfma_f32_32x32x16_bf16 v[8:23], a[40:43], v[112:115], v[8:23]
    ds_read_b128 v[108:111], v5 offset:13312
    v_mfma_f32_32x32x16_bf16 v[24:39], a[104:107], v[112:115], v[24:39]
    s_waitcnt lgkmcnt(2)
    v_mfma_f32_32x32x16_bf16 v[8:23], a[44:47], v[116:119], v[8:23]
    ds_read_b128 v[112:115], v5 offset:14336
    v_mfma_f32_32x32x16_bf16 v[24:39], a[108:111], v[116:119], v[24:39]
    s_waitcnt lgkmcnt(2)
    v_mfma_f32_32x32x16_bf16 v[8:23], a[48:51], v[104:107], v[8:23]
    ds_read_b128 v[116:119], v5 offset:15360
    v_mfma_f32_32x32x16_bf16 v[24:39], a[112:115], v[104:107], v[24:39]
    s_waitcnt lgkmcnt(2)
    v_mfma_f32_32x32x16_bf16 v[8:23], a[52:55], v[108:111], v[8:23]
    ds_read_b128 v[104:107], v5 offset:16384
    v_mfma_f32_32x32x16_bf16 v[24:39], a[116:119], v[108:111], v[24:39]
    s_waitcnt lgkmcnt(2)
    v_mfma_f32_32x32x16_bf16 v[8:23], a[56:59], v[112:115], v[8:23]
    ds_read_b128 v[108:111], v5 offset:17408
    v_mfma_f32_32x32x16_bf16 v[24:39], a[120:123], v[112:115], v[24:39]
    s_waitcnt lgkmcnt(2)
    v_mfma_f32_32x32x16_bf16 v[8:23], a[60:63], v[116:119], v[8:23]
    ds_read_b128 v[112:115], v5 offset:18432
    v_mfma_f32_32x32x16_bf16 v[24:39], a[124:127], v[116:119], v[24:39]
    s_barrier
    s_waitcnt lgkmcnt(2)
    v_mfma_f32_32x32x16_bf16 v[40:55], a[0:3], v[104:107], v[72:87]
    ds_read_b128 v[116:119], v5 offset:19456
    v_mfma_f32_32x32x16_bf16 v[56:71], a[64:67], v[104:107], v[88:103]
    s_waitcnt lgkmcnt(2)
    v_mfma_f32_32x32x16_bf16 v[40:55], a[4:7], v[108:111], v[40:55]
    ds_read_b128 v[104:107], v5 offset:20480
    v_cvt_pk_bf16_f32 v120, v8, v9
    v_mfma_f32_32x32x16_bf16 v[56:71], a[68:71], v[108:111], v[56:71]
    v_cvt_pk_bf16_f32 v121, v10, v11
    s_waitcnt lgkmcnt(2)
    v_mfma_f32_32x32x16_bf16 v[40:55], a[8:11], v[112:115], v[40:55]
    ds_read_b128 v[108:111], v5 offset:21504
    v_cvt_pk_bf16_f32 v122, v12, v13
    v_mfma_f32_32x32x16_bf16 v[56:71], a[72:75], v[112:115], v[56:71]
    v_cvt_pk_bf16_f32 v123, v14, v15
    s_waitcnt lgkmcnt(2)
    v_mfma_f32_32x32x16_bf16 v[40:55], a[12:15], v[116:119], v[40:55]
    ds_read_b128 v[112:115], v5 offset:22528
    ds_write_b128 v6, v[120:123] offset:0
    v_mfma_f32_32x32x16_bf16 v[56:71], a[76:79], v[116:119], v[56:71]
    v_cvt_pk_bf16_f32 v124, v16, v17
    s_waitcnt lgkmcnt(3)
    v_mfma_f32_32x32x16_bf16 v[40:55], a[16:19], v[104:107], v[40:55]
    ds_read_b128 v[116:119], v5 offset:23552
    v_cvt_pk_bf16_f32 v125, v18, v19
    v_mfma_f32_32x32x16_bf16 v[56:71], a[80:83], v[104:107], v[56:71]
    v_cvt_pk_bf16_f32 v126, v20, v21
    s_waitcnt lgkmcnt(3)
    v_mfma_f32_32x32x16_bf16 v[40:55], a[20:23], v[108:111], v[40:55]
    ds_read_b128 v[104:107], v5 offset:24576
    v_cvt_pk_bf16_f32 v127, v22, v23
    v_mfma_f32_32x32x16_bf16 v[56:71], a[84:87], v[108:111], v[56:71]
    ds_write_b128 v6, v[124:127] offset:32
    s_waitcnt lgkmcnt(4)
    v_mfma_f32_32x32x16_bf16 v[40:55], a[24:27], v[112:115], v[40:55]
    ds_read_b128 v[108:111], v5 offset:25600
    v_cvt_pk_bf16_f32 v120, v24, v25
    v_mfma_f32_32x32x16_bf16 v[56:71], a[88:91], v[112:115], v[56:71]
    v_cvt_pk_bf16_f32 v121, v26, v27
    s_waitcnt lgkmcnt(3)
    v_mfma_f32_32x32x16_bf16 v[40:55], a[28:31], v[116:119], v[40:55]
    ds_read_b128 v[112:115], v5 offset:26624
    v_cvt_pk_bf16_f32 v122, v28, v29
    v_mfma_f32_32x32x16_bf16 v[56:71], a[92:95], v[116:119], v[56:71]
    v_cvt_pk_bf16_f32 v123, v30, v31
    s_waitcnt lgkmcnt(3)
    v_mfma_f32_32x32x16_bf16 v[40:55], a[32:35], v[104:107], v[40:55]
    ds_read_b128 v[116:119], v5 offset:27648
    ds_write_b128 v6, v[120:123] offset:64
    v_mfma_f32_32x32x16_bf16 v[56:71], a[96:99], v[104:107], v[56:71]
    v_cvt_pk_bf16_f32 v124, v32, v33
    s_waitcnt lgkmcnt(3)
    v_mfma_f32_32x32x16_bf16 v[40:55], a[36:39], v[108:111], v[40:55]
    ds_read_b128 v[104:107], v5 offset:28672
    v_cvt_pk_bf16_f32 v125, v34, v35
    v_mfma_f32_32x32x16_bf16 v[56:71], a[100:103], v[108:111], v[56:71]
    v_cvt_pk_bf16_f32 v126, v36, v37
    s_waitcnt lgkmcnt(3)
    v_mfma_f32_32x32x16_bf16 v[40:55], a[40:43], v[112:115], v[40:55]
    ds_read_b128 v[108:111], v5 offset:29696
    v_cvt_pk_bf16_f32 v127, v38, v39
    v_mfma_f32_32x32x16_bf16 v[56:71], a[104:107], v[112:115], v[56:71]
    ds_write_b128 v6, v[124:127] offset:96
    s_waitcnt lgkmcnt(4)
    v_mfma_f32_32x32x16_bf16 v[40:55], a[44:47], v[116:119], v[40:55]
    ds_read_b128 v[112:115], v5 offset:30720
    v_mfma_f32_32x32x16_bf16 v[56:71], a[108:111], v[116:119], v[56:71]
    s_waitcnt lgkmcnt(3)
    v_mfma_f32_32x32x16_bf16 v[40:55], a[48:51], v[104:107], v[40:55]
    ds_read_b128 v[116:119], v5 offset:31744
    v_mfma_f32_32x32x16_bf16 v[56:71], a[112:115], v[104:107], v[56:71]
    s_waitcnt lgkmcnt(3)
    v_mfma_f32_32x32x16_bf16 v[40:55], a[52:55], v[108:111], v[40:55]
    ds_read_b128 v[104:107], v5 offset:32768
    v_mfma_f32_32x32x16_bf16 v[56:71], a[116:119], v[108:111], v[56:71]
    s_waitcnt lgkmcnt(2)
    v_mfma_f32_32x32x16_bf16 v[40:55], a[56:59], v[112:115], v[40:55]
    ds_read_b128 v[108:111], v5 offset:33792
    v_mfma_f32_32x32x16_bf16 v[56:71], a[120:123], v[112:115], v[56:71]
    s_waitcnt lgkmcnt(2)
    v_mfma_f32_32x32x16_bf16 v[40:55], a[60:63], v[116:119], v[40:55]
    ds_read_b128 v[112:115], v5 offset:34816
    v_mfma_f32_32x32x16_bf16 v[56:71], a[124:127], v[116:119], v[56:71]
    s_barrier
    s_waitcnt lgkmcnt(2)
    v_mfma_f32_32x32x16_bf16 v[8:23], a[0:3], v[104:107], v[72:87]
    ds_read_b128 v[116:119], v5 offset:35840
    v_mfma_f32_32x32x16_bf16 v[24:39], a[64:67], v[104:107], v[88:103]
    s_waitcnt lgkmcnt(2)
    v_mfma_f32_32x32x16_bf16 v[8:23], a[4:7], v[108:111], v[8:23]
    ds_read_b128 v[104:107], v5 offset:36864
    v_cvt_pk_bf16_f32 v120, v40, v41
    v_mfma_f32_32x32x16_bf16 v[24:39], a[68:71], v[108:111], v[24:39]
    v_cvt_pk_bf16_f32 v121, v42, v43
    s_waitcnt lgkmcnt(2)
    v_mfma_f32_32x32x16_bf16 v[8:23], a[8:11], v[112:115], v[8:23]
    ds_read_b128 v[108:111], v5 offset:37888
    v_cvt_pk_bf16_f32 v122, v44, v45
    v_mfma_f32_32x32x16_bf16 v[24:39], a[72:75], v[112:115], v[24:39]
    v_cvt_pk_bf16_f32 v123, v46, v47
    s_waitcnt lgkmcnt(2)
    v_mfma_f32_32x32x16_bf16 v[8:23], a[12:15], v[116:119], v[8:23]
    ds_read_b128 v[112:115], v5 offset:38912
    ds_write_b128 v6, v[120:123] offset:16896
    v_mfma_f32_32x32x16_bf16 v[24:39], a[76:79], v[116:119], v[24:39]
    v_cvt_pk_bf16_f32 v124, v48, v49
    s_waitcnt lgkmcnt(3)
    v_mfma_f32_32x32x16_bf16 v[8:23], a[16:19], v[104:107], v[8:23]
    ds_read_b128 v[116:119], v5 offset:39936
    v_cvt_pk_bf16_f32 v125, v50, v51
    v_mfma_f32_32x32x16_bf16 v[24:39], a[80:83], v[104:107], v[24:39]
    v_cvt_pk_bf16_f32 v126, v52, v53
    s_waitcnt lgkmcnt(3)
    v_mfma_f32_32x32x16_bf16 v[8:23], a[20:23], v[108:111], v[8:23]
    ds_read_b128 v[104:107], v5 offset:40960
    v_cvt_pk_bf16_f32 v127, v54, v55
    v_mfma_f32_32x32x16_bf16 v[24:39], a[84:87], v[108:111], v[24:39]
    ds_write_b128 v6, v[124:127] offset:16928
    s_waitcnt lgkmcnt(4)
    v_mfma_f32_32x32x16_bf16 v[8:23], a[24:27], v[112:115], v[8:23]
    ds_read_b128 v[108:111], v5 offset:41984
    v_cvt_pk_bf16_f32 v120, v56, v57
    v_mfma_f32_32x32x16_bf16 v[24:39], a[88:91], v[112:115], v[24:39]
    v_cvt_pk_bf16_f32 v121, v58, v59
    s_waitcnt lgkmcnt(3)
    v_mfma_f32_32x32x16_bf16 v[8:23], a[28:31], v[116:119], v[8:23]
    ds_read_b128 v[112:115], v5 offset:43008
    v_cvt_pk_bf16_f32 v122, v60, v61
    v_mfma_f32_32x32x16_bf16 v[24:39], a[92:95], v[116:119], v[24:39]
    v_cvt_pk_bf16_f32 v123, v62, v63
    s_waitcnt lgkmcnt(3)
    v_mfma_f32_32x32x16_bf16 v[8:23], a[32:35], v[104:107], v[8:23]
    ds_read_b128 v[116:119], v5 offset:44032
    ds_write_b128 v6, v[120:123] offset:16960
    v_mfma_f32_32x32x16_bf16 v[24:39], a[96:99], v[104:107], v[24:39]
    v_cvt_pk_bf16_f32 v124, v64, v65
    s_waitcnt lgkmcnt(3)
    v_mfma_f32_32x32x16_bf16 v[8:23], a[36:39], v[108:111], v[8:23]
    ds_read_b128 v[104:107], v5 offset:45056
    v_cvt_pk_bf16_f32 v125, v66, v67
    v_mfma_f32_32x32x16_bf16 v[24:39], a[100:103], v[108:111], v[24:39]
    v_cvt_pk_bf16_f32 v126, v68, v69
    s_waitcnt lgkmcnt(3)
    v_mfma_f32_32x32x16_bf16 v[8:23], a[40:43], v[112:115], v[8:23]
    ds_read_b128 v[108:111], v5 offset:46080
    v_cvt_pk_bf16_f32 v127, v70, v71
    v_mfma_f32_32x32x16_bf16 v[24:39], a[104:107], v[112:115], v[24:39]
    ds_write_b128 v6, v[124:127] offset:16992
    s_waitcnt lgkmcnt(4)
    v_mfma_f32_32x32x16_bf16 v[8:23], a[44:47], v[116:119], v[8:23]
    ds_read_b128 v[112:115], v5 offset:47104
    v_mfma_f32_32x32x16_bf16 v[24:39], a[108:111], v[116:119], v[24:39]
    s_waitcnt lgkmcnt(3)
    v_mfma_f32_32x32x16_bf16 v[8:23], a[48:51], v[104:107], v[8:23]
    ds_read_b128 v[116:119], v5 offset:48128
    v_mfma_f32_32x32x16_bf16 v[24:39], a[112:115], v[104:107], v[24:39]
    s_waitcnt lgkmcnt(3)
    v_mfma_f32_32x32x16_bf16 v[8:23], a[52:55], v[108:111], v[8:23]
    ds_read_b128 v[104:107], v5 offset:0
    v_mfma_f32_32x32x16_bf16 v[24:39], a[116:119], v[108:111], v[24:39]
    s_waitcnt lgkmcnt(2)
    v_mfma_f32_32x32x16_bf16 v[8:23], a[56:59], v[112:115], v[8:23]
    ds_read_b128 v[108:111], v5 offset:1024
    v_mfma_f32_32x32x16_bf16 v[24:39], a[120:123], v[112:115], v[24:39]
    s_waitcnt lgkmcnt(2)
    v_mfma_f32_32x32x16_bf16 v[8:23], a[60:63], v[116:119], v[8:23]
    ds_read_b128 v[112:115], v5 offset:2048
    v_mfma_f32_32x32x16_bf16 v[24:39], a[124:127], v[116:119], v[24:39]
    s_barrier
    s_waitcnt lgkmcnt(2)
    v_mfma_f32_32x32x16_bf16 v[40:55], a[0:3], v[104:107], v[72:87]
    ds_read_b128 v[116:119], v5 offset:3072
    v_mfma_f32_32x32x16_bf16 v[56:71], a[64:67], v[104:107], v[88:103]
    s_waitcnt lgkmcnt(2)
    v_mfma_f32_32x32x16_bf16 v[40:55], a[4:7], v[108:111], v[40:55]
    ds_read_b128 v[104:107], v5 offset:4096
    v_cvt_pk_bf16_f32 v120, v8, v9
    v_mfma_f32_32x32x16_bf16 v[56:71], a[68:71], v[108:111], v[56:71]
    v_cvt_pk_bf16_f32 v121, v10, v11
    s_waitcnt lgkmcnt(2)
    v_mfma_f32_32x32x16_bf16 v[40:55], a[8:11], v[112:115], v[40:55]
    ds_read_b128 v[108:111], v5 offset:5120
    v_cvt_pk_bf16_f32 v122, v12, v13
    v_mfma_f32_32x32x16_bf16 v[56:71], a[72:75], v[112:115], v[56:71]
    v_cvt_pk_bf16_f32 v123, v14, v15
    s_waitcnt lgkmcnt(2)
    v_mfma_f32_32x32x16_bf16 v[40:55], a[12:15], v[116:119], v[40:55]
    ds_read_b128 v[112:115], v5 offset:6144
    ds_write_b128 v6, v[120:123] offset:0
    v_mfma_f32_32x32x16_bf16 v[56:71], a[76:79], v[116:119], v[56:71]
    v_cvt_pk_bf16_f32 v124, v16, v17
    s_waitcnt lgkmcnt(3)
    v_mfma_f32_32x32x16_bf16 v[40:55], a[16:19], v[104:107], v[40:55]
    ds_read_b128 v[116:119], v5 offset:7168
    v_cvt_pk_bf16_f32 v125, v18, v19
    v_mfma_f32_32x32x16_bf16 v[56:71], a[80:83], v[104:107], v[56:71]
    v_cvt_pk_bf16_f32 v126, v20, v21
    s_waitcnt lgkmcnt(3)
    v_mfma_f32_32x32x16_bf16 v[40:55], a[20:23], v[108:111], v[40:55]
    ds_read_b128 v[104:107], v5 offset:8192
    v_cvt_pk_bf16_f32 v127, v22, v23
    v_mfma_f32_32x32x16_bf16 v[56:71], a[84:87], v[108:111], v[56:71]
    ds_write_b128 v6, v[124:127] offset:32
    s_waitcnt lgkmcnt(4)
    v_mfma_f32_32x32x16_bf16 v[40:55], a[24:27], v[112:115], v[40:55]
    ds_read_b128 v[108:111], v5 offset:9216
    v_cvt_pk_bf16_f32 v120, v24, v25
    v_mfma_f32_32x32x16_bf16 v[56:71], a[88:91], v[112:115], v[56:71]
    v_cvt_pk_bf16_f32 v121, v26, v27
    s_waitcnt lgkmcnt(3)
    v_mfma_f32_32x32x16_bf16 v[40:55], a[28:31], v[116:119], v[40:55]
    ds_read_b128 v[112:115], v5 offset:10240
    v_cvt_pk_bf16_f32 v122, v28, v29
    v_mfma_f32_32x32x16_bf16 v[56:71], a[92:95], v[116:119], v[56:71]
    v_cvt_pk_bf16_f32 v123, v30, v31
    s_waitcnt lgkmcnt(3)
    v_mfma_f32_32x32x16_bf16 v[40:55], a[32:35], v[104:107], v[40:55]
    ds_read_b128 v[116:119], v5 offset:11264
    ds_write_b128 v6, v[120:123] offset:64
    v_mfma_f32_32x32x16_bf16 v[56:71], a[96:99], v[104:107], v[56:71]
    v_cvt_pk_bf16_f32 v124, v32, v33
    s_waitcnt lgkmcnt(3)
    v_mfma_f32_32x32x16_bf16 v[40:55], a[36:39], v[108:111], v[40:55]
    ds_read_b128 v[104:107], v5 offset:12288
    v_cvt_pk_bf16_f32 v125, v34, v35
    v_mfma_f32_32x32x16_bf16 v[56:71], a[100:103], v[108:111], v[56:71]
    v_cvt_pk_bf16_f32 v126, v36, v37
    s_waitcnt lgkmcnt(3)
    v_mfma_f32_32x32x16_bf16 v[40:55], a[40:43], v[112:115], v[40:55]
    ds_read_b128 v[108:111], v5 offset:13312
    v_cvt_pk_bf16_f32 v127, v38, v39
    v_mfma_f32_32x32x16_bf16 v[56:71], a[104:107], v[112:115], v[56:71]
    ds_write_b128 v6, v[124:127] offset:96
    s_waitcnt lgkmcnt(4)
    v_mfma_f32_32x32x16_bf16 v[40:55], a[44:47], v[116:119], v[40:55]
    ds_read_b128 v[112:115], v5 offset:14336
    v_mfma_f32_32x32x16_bf16 v[56:71], a[108:111], v[116:119], v[56:71]
    s_waitcnt lgkmcnt(3)
    v_mfma_f32_32x32x16_bf16 v[40:55], a[48:51], v[104:107], v[40:55]
    ds_read_b128 v[116:119], v5 offset:15360
    v_mfma_f32_32x32x16_bf16 v[56:71], a[112:115], v[104:107], v[56:71]
    s_waitcnt lgkmcnt(3)
    v_mfma_f32_32x32x16_bf16 v[40:55], a[52:55], v[108:111], v[40:55]
    ds_read_b128 v[104:107], v5 offset:16384
    v_mfma_f32_32x32x16_bf16 v[56:71], a[116:119], v[108:111], v[56:71]
    s_waitcnt lgkmcnt(2)
    v_mfma_f32_32x32x16_bf16 v[40:55], a[56:59], v[112:115], v[40:55]
    ds_read_b128 v[108:111], v5 offset:17408
    v_mfma_f32_32x32x16_bf16 v[56:71], a[120:123], v[112:115], v[56:71]
    s_waitcnt lgkmcnt(2)
    v_mfma_f32_32x32x16_bf16 v[40:55], a[60:63], v[116:119], v[40:55]
    ds_read_b128 v[112:115], v5 offset:18432
    v_mfma_f32_32x32x16_bf16 v[56:71], a[124:127], v[116:119], v[56:71]
    s_barrier
    s_waitcnt lgkmcnt(2)
    v_mfma_f32_32x32x16_bf16 v[8:23], a[0:3], v[104:107], v[72:87]
    ds_read_b128 v[116:119], v5 offset:19456
    v_mfma_f32_32x32x16_bf16 v[24:39], a[64:67], v[104:107], v[88:103]
    s_waitcnt lgkmcnt(2)
    v_mfma_f32_32x32x16_bf16 v[8:23], a[4:7], v[108:111], v[8:23]
    ds_read_b128 v[104:107], v5 offset:20480
    v_cvt_pk_bf16_f32 v120, v40, v41
    v_mfma_f32_32x32x16_bf16 v[24:39], a[68:71], v[108:111], v[24:39]
    v_cvt_pk_bf16_f32 v121, v42, v43
    s_waitcnt lgkmcnt(2)
    v_mfma_f32_32x32x16_bf16 v[8:23], a[8:11], v[112:115], v[8:23]
    ds_read_b128 v[108:111], v5 offset:21504
    v_cvt_pk_bf16_f32 v122, v44, v45
    v_mfma_f32_32x32x16_bf16 v[24:39], a[72:75], v[112:115], v[24:39]
    v_cvt_pk_bf16_f32 v123, v46, v47
    s_waitcnt lgkmcnt(2)
    v_mfma_f32_32x32x16_bf16 v[8:23], a[12:15], v[116:119], v[8:23]
    ds_read_b128 v[112:115], v5 offset:22528
    ds_write_b128 v6, v[120:123] offset:16896
    v_mfma_f32_32x32x16_bf16 v[24:39], a[76:79], v[116:119], v[24:39]
    v_cvt_pk_bf16_f32 v124, v48, v49
    s_waitcnt lgkmcnt(3)
    v_mfma_f32_32x32x16_bf16 v[8:23], a[16:19], v[104:107], v[8:23]
    ds_read_b128 v[116:119], v5 offset:23552
    v_cvt_pk_bf16_f32 v125, v50, v51
    v_mfma_f32_32x32x16_bf16 v[24:39], a[80:83], v[104:107], v[24:39]
    v_cvt_pk_bf16_f32 v126, v52, v53
    s_waitcnt lgkmcnt(3)
    v_mfma_f32_32x32x16_bf16 v[8:23], a[20:23], v[108:111], v[8:23]
    ds_read_b128 v[104:107], v5 offset:24576
    v_cvt_pk_bf16_f32 v127, v54, v55
    v_mfma_f32_32x32x16_bf16 v[24:39], a[84:87], v[108:111], v[24:39]
    ds_write_b128 v6, v[124:127] offset:16928
    s_waitcnt lgkmcnt(4)
    v_mfma_f32_32x32x16_bf16 v[8:23], a[24:27], v[112:115], v[8:23]
    ds_read_b128 v[108:111], v5 offset:25600
    v_cvt_pk_bf16_f32 v120, v56, v57
    v_mfma_f32_32x32x16_bf16 v[24:39], a[88:91], v[112:115], v[24:39]
    v_cvt_pk_bf16_f32 v121, v58, v59
    s_waitcnt lgkmcnt(3)
    v_mfma_f32_32x32x16_bf16 v[8:23], a[28:31], v[116:119], v[8:23]
    ds_read_b128 v[112:115], v5 offset:26624
    v_cvt_pk_bf16_f32 v122, v60, v61
    v_mfma_f32_32x32x16_bf16 v[24:39], a[92:95], v[116:119], v[24:39]
    v_cvt_pk_bf16_f32 v123, v62, v63
    s_waitcnt lgkmcnt(3)
    v_mfma_f32_32x32x16_bf16 v[8:23], a[32:35], v[104:107], v[8:23]
    ds_read_b128 v[116:119], v5 offset:27648
    ds_write_b128 v6, v[120:123] offset:16960
    v_mfma_f32_32x32x16_bf16 v[24:39], a[96:99], v[104:107], v[24:39]
    v_cvt_pk_bf16_f32 v124, v64, v65
    s_waitcnt lgkmcnt(3)
    v_mfma_f32_32x32x16_bf16 v[8:23], a[36:39], v[108:111], v[8:23]
    ds_read_b128 v[104:107], v5 offset:28672
    v_cvt_pk_bf16_f32 v125, v66, v67
    v_mfma_f32_32x32x16_bf16 v[24:39], a[100:103], v[108:111], v[24:39]
    v_cvt_pk_bf16_f32 v126, v68, v69
    s_waitcnt lgkmcnt(3)
    v_mfma_f32_32x32x16_bf16 v[8:23], a[40:43], v[112:115], v[8:23]
    ds_read_b128 v[108:111], v5 offset:29696
    v_cvt_pk_bf16_f32 v127, v70, v71
    v_mfma_f32_32x32x16_bf16 v[24:39], a[104:107], v[112:115], v[24:39]
    ds_write_b128 v6, v[124:127] offset:16992
    s_waitcnt lgkmcnt(4)
    v_mfma_f32_32x32x16_bf16 v[8:23], a[44:47], v[116:119], v[8:23]
    ds_read_b128 v[112:115], v5 offset:30720
    v_mfma_f32_32x32x16_bf16 v[24:39], a[108:111], v[116:119], v[24:39]
    s_waitcnt lgkmcnt(3)
    v_mfma_f32_32x32x16_bf16 v[8:23], a[48:51], v[104:107], v[8:23]
    ds_read_b128 v[116:119], v5 offset:31744
    v_mfma_f32_32x32x16_bf16 v[24:39], a[112:115], v[104:107], v[24:39]
    s_waitcnt lgkmcnt(3)
    v_mfma_f32_32x32x16_bf16 v[8:23], a[52:55], v[108:111], v[8:23]
    ds_read_b128 v[104:107], v5 offset:32768
    v_mfma_f32_32x32x16_bf16 v[24:39], a[116:119], v[108:111], v[24:39]
    s_waitcnt lgkmcnt(2)
    v_mfma_f32_32x32x16_bf16 v[8:23], a[56:59], v[112:115], v[8:23]
    ds_read_b128 v[108:111], v5 offset:33792
    v_mfma_f32_32x32x16_bf16 v[24:39], a[120:123], v[112:115], v[24:39]
    s_waitcnt lgkmcnt(2)
    v_mfma_f32_32x32x16_bf16 v[8:23], a[60:63], v[116:119], v[8:23]
    ds_read_b128 v[112:115], v5 offset:34816
    v_mfma_f32_32x32x16_bf16 v[24:39], a[124:127], v[116:119], v[24:39]
    s_barrier
    s_waitcnt lgkmcnt(2)
    v_mfma_f32_32x32x16_bf16 v[40:55], a[0:3], v[104:107], v[72:87]
    ds_read_b128 v[116:119], v5 offset:35840
    v_mfma_f32_32x32x16_bf16 v[56:71], a[64:67], v[104:107], v[88:103]
    s_waitcnt lgkmcnt(2)
    v_mfma_f32_32x32x16_bf16 v[40:55], a[4:7], v[108:111], v[40:55]
    ds_read_b128 v[104:107], v5 offset:36864
    v_cvt_pk_bf16_f32 v120, v8, v9
    v_mfma_f32_32x32x16_bf16 v[56:71], a[68:71], v[108:111], v[56:71]
    v_cvt_pk_bf16_f32 v121, v10, v11
    s_waitcnt lgkmcnt(2)
    v_mfma_f32_32x32x16_bf16 v[40:55], a[8:11], v[112:115], v[40:55]
    ds_read_b128 v[108:111], v5 offset:37888
    v_cvt_pk_bf16_f32 v122, v12, v13
    v_mfma_f32_32x32x16_bf16 v[56:71], a[72:75], v[112:115], v[56:71]
    v_cvt_pk_bf16_f32 v123, v14, v15
    s_waitcnt lgkmcnt(2)
    v_mfma_f32_32x32x16_bf16 v[40:55], a[12:15], v[116:119], v[40:55]
    ds_read_b128 v[112:115], v5 offset:38912
    ds_write_b128 v6, v[120:123] offset:0
    v_mfma_f32_32x32x16_bf16 v[56:71], a[76:79], v[116:119], v[56:71]
    v_cvt_pk_bf16_f32 v124, v16, v17
    s_waitcnt lgkmcnt(3)
    v_mfma_f32_32x32x16_bf16 v[40:55], a[16:19], v[104:107], v[40:55]
    ds_read_b128 v[116:119], v5 offset:39936
    v_cvt_pk_bf16_f32 v125, v18, v19
    v_mfma_f32_32x32x16_bf16 v[56:71], a[80:83], v[104:107], v[56:71]
    v_cvt_pk_bf16_f32 v126, v20, v21
    s_waitcnt lgkmcnt(3)
    v_mfma_f32_32x32x16_bf16 v[40:55], a[20:23], v[108:111], v[40:55]
    ds_read_b128 v[104:107], v5 offset:40960
    v_cvt_pk_bf16_f32 v127, v22, v23
    v_mfma_f32_32x32x16_bf16 v[56:71], a[84:87], v[108:111], v[56:71]
    ds_write_b128 v6, v[124:127] offset:32
    s_waitcnt lgkmcnt(4)
    v_mfma_f32_32x32x16_bf16 v[40:55], a[24:27], v[112:115], v[40:55]
    ds_read_b128 v[108:111], v5 offset:41984
    v_cvt_pk_bf16_f32 v120, v24, v25
    v_mfma_f32_32x32x16_bf16 v[56:71], a[88:91], v[112:115], v[56:71]
    v_cvt_pk_bf16_f32 v121, v26, v27
    s_waitcnt lgkmcnt(3)
    v_mfma_f32_32x32x16_bf16 v[40:55], a[28:31], v[116:119], v[40:55]
    ds_read_b128 v[112:115], v5 offset:43008
    v_cvt_pk_bf16_f32 v122, v28, v29
    v_mfma_f32_32x32x16_bf16 v[56:71], a[92:95], v[116:119], v[56:71]
    v_cvt_pk_bf16_f32 v123, v30, v31
    s_waitcnt lgkmcnt(3)
    v_mfma_f32_32x32x16_bf16 v[40:55], a[32:35], v[104:107], v[40:55]
    ds_read_b128 v[116:119], v5 offset:44032
    ds_write_b128 v6, v[120:123] offset:64
    v_mfma_f32_32x32x16_bf16 v[56:71], a[96:99], v[104:107], v[56:71]
    v_cvt_pk_bf16_f32 v124, v32, v33
    s_waitcnt lgkmcnt(3)
    v_mfma_f32_32x32x16_bf16 v[40:55], a[36:39], v[108:111], v[40:55]
    ds_read_b128 v[104:107], v5 offset:45056
    v_cvt_pk_bf16_f32 v125, v34, v35
    v_mfma_f32_32x32x16_bf16 v[56:71], a[100:103], v[108:111], v[56:71]
    v_cvt_pk_bf16_f32 v126, v36, v37
    s_waitcnt lgkmcnt(3)
    v_mfma_f32_32x32x16_bf16 v[40:55], a[40:43], v[112:115], v[40:55]
    ds_read_b128 v[108:111], v5 offset:46080
    v_cvt_pk_bf16_f32 v127, v38, v39
    v_mfma_f32_32x32x16_bf16 v[56:71], a[104:107], v[112:115], v[56:71]
    ds_write_b128 v6, v[124:127] offset:96
    s_waitcnt lgkmcnt(4)
    v_mfma_f32_32x32x16_bf16 v[40:55], a[44:47], v[116:119], v[40:55]
    ds_read_b128 v[112:115], v5 offset:47104
    v_mfma_f32_32x32x16_bf16 v[56:71], a[108:111], v[116:119], v[56:71]
    s_waitcnt lgkmcnt(3)
    v_mfma_f32_32x32x16_bf16 v[40:55], a[48:51], v[104:107], v[40:55]
    ds_read_b128 v[116:119], v5 offset:48128
    v_mfma_f32_32x32x16_bf16 v[56:71], a[112:115], v[104:107], v[56:71]
    s_waitcnt lgkmcnt(3)
    v_mfma_f32_32x32x16_bf16 v[40:55], a[52:55], v[108:111], v[40:55]
    ds_read_b128 v[104:107], v5 offset:0
    v_mfma_f32_32x32x16_bf16 v[56:71], a[116:119], v[108:111], v[56:71]
    s_waitcnt lgkmcnt(2)
    v_mfma_f32_32x32x16_bf16 v[40:55], a[56:59], v[112:115], v[40:55]
    ds_read_b128 v[108:111], v5 offset:1024
    v_mfma_f32_32x32x16_bf16 v[56:71], a[120:123], v[112:115], v[56:71]
    s_waitcnt lgkmcnt(2)
    v_mfma_f32_32x32x16_bf16 v[40:55], a[60:63], v[116:119], v[40:55]
    ds_read_b128 v[112:115], v5 offset:2048
    v_mfma_f32_32x32x16_bf16 v[56:71], a[124:127], v[116:119], v[56:71]
    s_barrier
    s_waitcnt lgkmcnt(2)
    v_mfma_f32_32x32x16_bf16 v[8:23], a[0:3], v[104:107], v[72:87]
    ds_read_b128 v[116:119], v5 offset:3072
    v_mfma_f32_32x32x16_bf16 v[24:39], a[64:67], v[104:107], v[88:103]
    s_waitcnt lgkmcnt(2)
    v_mfma_f32_32x32x16_bf16 v[8:23], a[4:7], v[108:111], v[8:23]
    ds_read_b128 v[104:107], v5 offset:4096
    v_cvt_pk_bf16_f32 v120, v40, v41
    v_mfma_f32_32x32x16_bf16 v[24:39], a[68:71], v[108:111], v[24:39]
    v_cvt_pk_bf16_f32 v121, v42, v43
    s_waitcnt lgkmcnt(2)
    v_mfma_f32_32x32x16_bf16 v[8:23], a[8:11], v[112:115], v[8:23]
    ds_read_b128 v[108:111], v5 offset:5120
    v_cvt_pk_bf16_f32 v122, v44, v45
    v_mfma_f32_32x32x16_bf16 v[24:39], a[72:75], v[112:115], v[24:39]
    v_cvt_pk_bf16_f32 v123, v46, v47
    s_waitcnt lgkmcnt(2)
    v_mfma_f32_32x32x16_bf16 v[8:23], a[12:15], v[116:119], v[8:23]
    ds_read_b128 v[112:115], v5 offset:6144
    ds_write_b128 v6, v[120:123] offset:16896
    v_mfma_f32_32x32x16_bf16 v[24:39], a[76:79], v[116:119], v[24:39]
    v_cvt_pk_bf16_f32 v124, v48, v49
    s_waitcnt lgkmcnt(3)
    v_mfma_f32_32x32x16_bf16 v[8:23], a[16:19], v[104:107], v[8:23]
    ds_read_b128 v[116:119], v5 offset:7168
    v_cvt_pk_bf16_f32 v125, v50, v51
    v_mfma_f32_32x32x16_bf16 v[24:39], a[80:83], v[104:107], v[24:39]
    v_cvt_pk_bf16_f32 v126, v52, v53
    s_waitcnt lgkmcnt(3)
    v_mfma_f32_32x32x16_bf16 v[8:23], a[20:23], v[108:111], v[8:23]
    ds_read_b128 v[104:107], v5 offset:8192
    v_cvt_pk_bf16_f32 v127, v54, v55
    v_mfma_f32_32x32x16_bf16 v[24:39], a[84:87], v[108:111], v[24:39]
    ds_write_b128 v6, v[124:127] offset:16928
    s_waitcnt lgkmcnt(4)
    v_mfma_f32_32x32x16_bf16 v[8:23], a[24:27], v[112:115], v[8:23]
    ds_read_b128 v[108:111], v5 offset:9216
    v_cvt_pk_bf16_f32 v120, v56, v57
    v_mfma_f32_32x32x16_bf16 v[24:39], a[88:91], v[112:115], v[24:39]
    v_cvt_pk_bf16_f32 v121, v58, v59
    s_waitcnt lgkmcnt(3)
    v_mfma_f32_32x32x16_bf16 v[8:23], a[28:31], v[116:119], v[8:23]
    ds_read_b128 v[112:115], v5 offset:10240
    v_cvt_pk_bf16_f32 v122, v60, v61
    v_mfma_f32_32x32x16_bf16 v[24:39], a[92:95], v[116:119], v[24:39]
    v_cvt_pk_bf16_f32 v123, v62, v63
    s_waitcnt lgkmcnt(3)
    v_mfma_f32_32x32x16_bf16 v[8:23], a[32:35], v[104:107], v[8:23]
    ds_read_b128 v[116:119], v5 offset:11264
    ds_write_b128 v6, v[120:123] offset:16960
    v_mfma_f32_32x32x16_bf16 v[24:39], a[96:99], v[104:107], v[24:39]
    v_cvt_pk_bf16_f32 v124, v64, v65
    s_waitcnt lgkmcnt(3)
    v_mfma_f32_32x32x16_bf16 v[8:23], a[36:39], v[108:111], v[8:23]
    ds_read_b128 v[104:107], v5 offset:12288
    v_cvt_pk_bf16_f32 v125, v66, v67
    v_mfma_f32_32x32x16_bf16 v[24:39], a[100:103], v[108:111], v[24:39]
    v_cvt_pk_bf16_f32 v126, v68, v69
    s_waitcnt lgkmcnt(3)
    v_mfma_f32_32x32x16_bf16 v[8:23], a[40:43], v[112:115], v[8:23]
    ds_read_b128 v[108:111], v5 offset:13312
    v_cvt_pk_bf16_f32 v127, v70, v71
    v_mfma_f32_32x32x16_bf16 v[24:39], a[104:107], v[112:115], v[24:39]
    ds_write_b128 v6, v[124:127] offset:16992
    s_waitcnt lgkmcnt(4)
    v_mfma_f32_32x32x16_bf16 v[8:23], a[44:47], v[116:119], v[8:23]
    ds_read_b128 v[112:115], v5 offset:14336
    v_mfma_f32_32x32x16_bf16 v[24:39], a[108:111], v[116:119], v[24:39]
    s_waitcnt lgkmcnt(3)
    v_mfma_f32_32x32x16_bf16 v[8:23], a[48:51], v[104:107], v[8:23]
    ds_read_b128 v[116:119], v5 offset:15360
    v_mfma_f32_32x32x16_bf16 v[24:39], a[112:115], v[104:107], v[24:39]
    s_waitcnt lgkmcnt(3)
    v_mfma_f32_32x32x16_bf16 v[8:23], a[52:55], v[108:111], v[8:23]
    ds_read_b128 v[104:107], v5 offset:16384
    v_mfma_f32_32x32x16_bf16 v[24:39], a[116:119], v[108:111], v[24:39]
    s_waitcnt lgkmcnt(2)
    v_mfma_f32_32x32x16_bf16 v[8:23], a[56:59], v[112:115], v[8:23]
    ds_read_b128 v[108:111], v5 offset:17408
    v_mfma_f32_32x32x16_bf16 v[24:39], a[120:123], v[112:115], v[24:39]
    s_waitcnt lgkmcnt(2)
    v_mfma_f32_32x32x16_bf16 v[8:23], a[60:63], v[116:119], v[8:23]
    ds_read_b128 v[112:115], v5 offset:18432
    v_mfma_f32_32x32x16_bf16 v[24:39], a[124:127], v[116:119], v[24:39]
    s_barrier
    s_waitcnt lgkmcnt(2)
    v_mfma_f32_32x32x16_bf16 v[40:55], a[0:3], v[104:107], v[72:87]
    ds_read_b128 v[116:119], v5 offset:19456
    v_mfma_f32_32x32x16_bf16 v[56:71], a[64:67], v[104:107], v[88:103]
    s_waitcnt lgkmcnt(2)
    v_mfma_f32_32x32x16_bf16 v[40:55], a[4:7], v[108:111], v[40:55]
    ds_read_b128 v[104:107], v5 offset:20480
    v_cvt_pk_bf16_f32 v120, v8, v9
    v_mfma_f32_32x32x16_bf16 v[56:71], a[68:71], v[108:111], v[56:71]
    v_cvt_pk_bf16_f32 v121, v10, v11
    s_waitcnt lgkmcnt(2)
    v_mfma_f32_32x32x16_bf16 v[40:55], a[8:11], v[112:115], v[40:55]
    ds_read_b128 v[108:111], v5 offset:21504
    v_cvt_pk_bf16_f32 v122, v12, v13
    v_mfma_f32_32x32x16_bf16 v[56:71], a[72:75], v[112:115], v[56:71]
    v_cvt_pk_bf16_f32 v123, v14, v15
    s_waitcnt lgkmcnt(2)
    v_mfma_f32_32x32x16_bf16 v[40:55], a[12:15], v[116:119], v[40:55]
    ds_read_b128 v[112:115], v5 offset:22528
    ds_write_b128 v6, v[120:123] offset:0
    v_mfma_f32_32x32x16_bf16 v[56:71], a[76:79], v[116:119], v[56:71]
    v_cvt_pk_bf16_f32 v124, v16, v17
    s_waitcnt lgkmcnt(3)
    v_mfma_f32_32x32x16_bf16 v[40:55], a[16:19], v[104:107], v[40:55]
    ds_read_b128 v[116:119], v5 offset:23552
    v_cvt_pk_bf16_f32 v125, v18, v19
    v_mfma_f32_32x32x16_bf16 v[56:71], a[80:83], v[104:107], v[56:71]
    v_cvt_pk_bf16_f32 v126, v20, v21
    s_waitcnt lgkmcnt(3)
    v_mfma_f32_32x32x16_bf16 v[40:55], a[20:23], v[108:111], v[40:55]
    ds_read_b128 v[104:107], v5 offset:24576
    v_cvt_pk_bf16_f32 v127, v22, v23
    v_mfma_f32_32x32x16_bf16 v[56:71], a[84:87], v[108:111], v[56:71]
    ds_write_b128 v6, v[124:127] offset:32
    s_waitcnt lgkmcnt(4)
    v_mfma_f32_32x32x16_bf16 v[40:55], a[24:27], v[112:115], v[40:55]
    ds_read_b128 v[108:111], v5 offset:25600
    v_cvt_pk_bf16_f32 v120, v24, v25
    v_mfma_f32_32x32x16_bf16 v[56:71], a[88:91], v[112:115], v[56:71]
    v_cvt_pk_bf16_f32 v121, v26, v27
    s_waitcnt lgkmcnt(3)
    v_mfma_f32_32x32x16_bf16 v[40:55], a[28:31], v[116:119], v[40:55]
    ds_read_b128 v[112:115], v5 offset:26624
    v_cvt_pk_bf16_f32 v122, v28, v29
    v_mfma_f32_32x32x16_bf16 v[56:71], a[92:95], v[116:119], v[56:71]
    v_cvt_pk_bf16_f32 v123, v30, v31
    s_waitcnt lgkmcnt(3)
    v_mfma_f32_32x32x16_bf16 v[40:55], a[32:35], v[104:107], v[40:55]
    ds_read_b128 v[116:119], v5 offset:27648
    ds_write_b128 v6, v[120:123] offset:64
    v_mfma_f32_32x32x16_bf16 v[56:71], a[96:99], v[104:107], v[56:71]
    v_cvt_pk_bf16_f32 v124, v32, v33
    s_waitcnt lgkmcnt(3)
    v_mfma_f32_32x32x16_bf16 v[40:55], a[36:39], v[108:111], v[40:55]
    ds_read_b128 v[104:107], v5 offset:28672
    v_cvt_pk_bf16_f32 v125, v34, v35
    v_mfma_f32_32x32x16_bf16 v[56:71], a[100:103], v[108:111], v[56:71]
    v_cvt_pk_bf16_f32 v126, v36, v37
    s_waitcnt lgkmcnt(3)
    v_mfma_f32_32x32x16_bf16 v[40:55], a[40:43], v[112:115], v[40:55]
    ds_read_b128 v[108:111], v5 offset:29696
    v_cvt_pk_bf16_f32 v127, v38, v39
    v_mfma_f32_32x32x16_bf16 v[56:71], a[104:107], v[112:115], v[56:71]
    ds_write_b128 v6, v[124:127] offset:96
    s_waitcnt lgkmcnt(4)
    v_mfma_f32_32x32x16_bf16 v[40:55], a[44:47], v[116:119], v[40:55]
    ds_read_b128 v[112:115], v5 offset:30720
    v_mfma_f32_32x32x16_bf16 v[56:71], a[108:111], v[116:119], v[56:71]
    s_waitcnt lgkmcnt(3)
    v_mfma_f32_32x32x16_bf16 v[40:55], a[48:51], v[104:107], v[40:55]
    ds_read_b128 v[116:119], v5 offset:31744
    v_mfma_f32_32x32x16_bf16 v[56:71], a[112:115], v[104:107], v[56:71]
    s_waitcnt lgkmcnt(3)
    v_mfma_f32_32x32x16_bf16 v[40:55], a[52:55], v[108:111], v[40:55]
    v_mfma_f32_32x32x16_bf16 v[56:71], a[116:119], v[108:111], v[56:71]
    s_waitcnt lgkmcnt(1)
    v_mfma_f32_32x32x16_bf16 v[40:55], a[56:59], v[112:115], v[40:55]
    v_mfma_f32_32x32x16_bf16 v[56:71], a[120:123], v[112:115], v[56:71]
    s_waitcnt lgkmcnt(0)
    v_mfma_f32_32x32x16_bf16 v[40:55], a[60:63], v[116:119], v[40:55]
    v_mfma_f32_32x32x16_bf16 v[56:71], a[124:127], v[116:119], v[56:71]
    s_barrier
    s_nop 7
    s_nop 7
    v_cvt_pk_bf16_f32 v120, v40, v41
    v_cvt_pk_bf16_f32 v121, v42, v43
    v_cvt_pk_bf16_f32 v122, v44, v45
    v_cvt_pk_bf16_f32 v123, v46, v47
    ds_write_b128 v6, v[120:123] offset:16896
    v_cvt_pk_bf16_f32 v124, v48, v49
    v_cvt_pk_bf16_f32 v125, v50, v51
    v_cvt_pk_bf16_f32 v126, v52, v53
    v_cvt_pk_bf16_f32 v127, v54, v55
    ds_write_b128 v6, v[124:127] offset:16928
    v_cvt_pk_bf16_f32 v120, v56, v57
    v_cvt_pk_bf16_f32 v121, v58, v59
    v_cvt_pk_bf16_f32 v122, v60, v61
    v_cvt_pk_bf16_f32 v123, v62, v63
    ds_write_b128 v6, v[120:123] offset:16960
    v_cvt_pk_bf16_f32 v124, v64, v65
    v_cvt_pk_bf16_f32 v125, v66, v67
    v_cvt_pk_bf16_f32 v126, v68, v69
    v_cvt_pk_bf16_f32 v127, v70, v71
    ds_write_b128 v6, v[124:127] offset:16992
    s_waitcnt lgkmcnt(0)
    s_barrier
    s_endpgm
L_joint_kernel_helper:
    s_add_u32 s36, s38, 32768
    buffer_load_dwordx4 a[0:3], v5, s[12:15], s36 offen
    s_add_u32 s36, s38, 49152
    buffer_load_dwordx4 a[64:67], v5, s[12:15], s36 offen
    s_add_u32 s36, s38, 33792
    buffer_load_dwordx4 a[4:7], v5, s[12:15], s36 offen
    s_add_u32 s36, s38, 50176
    buffer_load_dwordx4 a[68:71], v5, s[12:15], s36 offen
    s_add_u32 s36, s38, 34816
    buffer_load_dwordx4 a[8:11], v5, s[12:15], s36 offen
    s_add_u32 s36, s38, 51200
    buffer_load_dwordx4 a[72:75], v5, s[12:15], s36 offen
    s_add_u32 s36, s38, 35840
    buffer_load_dwordx4 a[12:15], v5, s[12:15], s36 offen
    s_add_u32 s36, s38, 52224
    buffer_load_dwordx4 a[76:79], v5, s[12:15], s36 offen
    s_add_u32 s36, s38, 36864
    buffer_load_dwordx4 a[16:19], v5, s[12:15], s36 offen
    s_add_u32 s36, s38, 53248
    buffer_load_dwordx4 a[80:83], v5, s[12:15], s36 offen
    s_add_u32 s36, s38, 37888
    buffer_load_dwordx4 a[20:23], v5, s[12:15], s36 offen
    s_add_u32 s36, s38, 54272
    buffer_load_dwordx4 a[84:87], v5, s[12:15], s36 offen
    s_add_u32 s36, s38, 38912
    buffer_load_dwordx4 a[24:27], v5, s[12:15], s36 offen
    s_add_u32 s36, s38, 55296
    buffer_load_dwordx4 a[88:91], v5, s[12:15], s36 offen
    s_add_u32 s36, s38, 39936
    buffer_load_dwordx4 a[28:31], v5, s[12:15], s36 offen
    s_add_u32 s36, s38, 56320
    buffer_load_dwordx4 a[92:95], v5, s[12:15], s36 offen
    s_add_u32 s36, s38, 40960
    buffer_load_dwordx4 a[32:35], v5, s[12:15], s36 offen
    s_add_u32 s36, s38, 57344
    buffer_load_dwordx4 a[96:99], v5, s[12:15], s36 offen
    s_add_u32 s36, s38, 41984
    buffer_load_dwordx4 a[36:39], v5, s[12:15], s36 offen
    s_add_u32 s36, s38, 58368
    buffer_load_dwordx4 a[100:103], v5, s[12:15], s36 offen
    s_add_u32 s36, s38, 43008
    buffer_load_dwordx4 a[40:43], v5, s[12:15], s36 offen
    s_add_u32 s36, s38, 59392
    buffer_load_dwordx4 a[104:107], v5, s[12:15], s36 offen
    s_add_u32 s36, s38, 44032
    buffer_load_dwordx4 a[44:47], v5, s[12:15], s36 offen
    s_add_u32 s36, s38, 60416
    buffer_load_dwordx4 a[108:111], v5, s[12:15], s36 offen
    s_add_u32 s36, s38, 45056
    buffer_load_dwordx4 a[48:51], v5, s[12:15], s36 offen
    s_add_u32 s36, s38, 61440
    buffer_load_dwordx4 a[112:115], v5, s[12:15], s36 offen
    s_add_u32 s36, s38, 46080
    buffer_load_dwordx4 a[52:55], v5, s[12:15], s36 offen
    s_add_u32 s36, s38, 62464
    buffer_load_dwordx4 a[116:119], v5, s[12:15], s36 offen
    s_add_u32 s36, s38, 47104
    buffer_load_dwordx4 a[56:59], v5, s[12:15], s36 offen
    s_add_u32 s36, s38, 63488
    buffer_load_dwordx4 a[120:123], v5, s[12:15], s36 offen
    s_add_u32 s36, s38, 48128
    buffer_load_dwordx4 a[60:63], v5, s[12:15], s36 offen
    s_add_u32 s36, s38, 64512
    buffer_load_dwordx4 a[124:127], v5, s[12:15], s36 offen
    v_and_b32 v45, 7, v1
    v_lshlrev_b32 v45, 10, v45
    v_lshrrev_b32 v46, 5, v1
    v_lshl_add_u32 v45, v46, 4, v45
    s_lshl_b32 s36, s24, 13
    s_lshl_b32 s37, s21, 8
    s_add_u32 s36, s36, s37
    s_add_u32 s37, s36, 16384
    buffer_load_dwordx4 v[96:99], v45, s[12:15], s37 offen offset:0
    buffer_load_dwordx4 v[100:103], v45, s[12:15], s37 offen offset:32
    buffer_load_dwordx4 v[104:107], v45, s[12:15], s37 offen offset:64
    buffer_load_dwordx4 v[108:111], v45, s[12:15], s37 offen offset:96
    buffer_load_dwordx4 v[112:115], v45, s[12:15], s37 offen offset:128
    buffer_load_dwordx4 v[116:119], v45, s[12:15], s37 offen offset:160
    buffer_load_dwordx4 v[120:123], v45, s[12:15], s37 offen offset:192
    buffer_load_dwordx4 v[124:127], v45, s[12:15], s37 offen offset:224
    s_barrier
    v_add_u32 v7, 65536, v5
    ds_read_b128 v[64:67], v7 offset:0
    ds_read_b128 v[68:71], v7 offset:1024
    ds_read_b128 v[72:75], v7 offset:2048
    ds_read_b128 v[76:79], v7 offset:3072
    ds_read_b128 v[80:83], v7 offset:4096
    ds_read_b128 v[84:87], v7 offset:5120
    ds_read_b128 v[88:91], v7 offset:6144
    ds_read_b128 v[92:95], v7 offset:7168
    s_waitcnt lgkmcnt(0)
    s_waitcnt vmcnt(38)
    v_mfma_f32_32x32x16_bf16 v[32:47], a[0:3], v[64:67], 0
    v_mfma_f32_32x32x16_bf16 v[48:63], a[64:67], v[64:67], 0
    s_waitcnt vmcnt(36)
    v_mfma_f32_32x32x16_bf16 v[32:47], a[4:7], v[68:71], v[32:47]
    v_mfma_f32_32x32x16_bf16 v[48:63], a[68:71], v[68:71], v[48:63]
    s_waitcnt vmcnt(34)
    v_mfma_f32_32x32x16_bf16 v[32:47], a[8:11], v[72:75], v[32:47]
    v_mfma_f32_32x32x16_bf16 v[48:63], a[72:75], v[72:75], v[48:63]
    s_waitcnt vmcnt(32)
    v_mfma_f32_32x32x16_bf16 v[32:47], a[12:15], v[76:79], v[32:47]
    v_mfma_f32_32x32x16_bf16 v[48:63], a[76:79], v[76:79], v[48:63]
    s_waitcnt vmcnt(30)
    v_mfma_f32_32x32x16_bf16 v[32:47], a[16:19], v[80:83], v[32:47]
    v_mfma_f32_32x32x16_bf16 v[48:63], a[80:83], v[80:83], v[48:63]
    s_waitcnt vmcnt(28)
    v_mfma_f32_32x32x16_bf16 v[32:47], a[20:23], v[84:87], v[32:47]
    v_mfma_f32_32x32x16_bf16 v[48:63], a[84:87], v[84:87], v[48:63]
    s_waitcnt vmcnt(26)
    v_mfma_f32_32x32x16_bf16 v[32:47], a[24:27], v[88:91], v[32:47]
    v_mfma_f32_32x32x16_bf16 v[48:63], a[88:91], v[88:91], v[48:63]
    s_waitcnt vmcnt(24)
    v_mfma_f32_32x32x16_bf16 v[32:47], a[28:31], v[92:95], v[32:47]
    v_mfma_f32_32x32x16_bf16 v[48:63], a[92:95], v[92:95], v[48:63]
    ds_read_b128 v[64:67], v7 offset:8192
    ds_read_b128 v[68:71], v7 offset:9216
    ds_read_b128 v[72:75], v7 offset:10240
    ds_read_b128 v[76:79], v7 offset:11264
    ds_read_b128 v[80:83], v7 offset:12288
    ds_read_b128 v[84:87], v7 offset:13312
    ds_read_b128 v[88:91], v7 offset:14336
    ds_read_b128 v[92:95], v7 offset:15360
    s_waitcnt lgkmcnt(0)
    s_waitcnt vmcnt(22)
    v_mfma_f32_32x32x16_bf16 v[32:47], a[32:35], v[64:67], v[32:47]
    v_mfma_f32_32x32x16_bf16 v[48:63], a[96:99], v[64:67], v[48:63]
    s_waitcnt vmcnt(20)
    v_mfma_f32_32x32x16_bf16 v[32:47], a[36:39], v[68:71], v[32:47]
    v_mfma_f32_32x32x16_bf16 v[48:63], a[100:103], v[68:71], v[48:63]
    s_waitcnt vmcnt(18)
    v_mfma_f32_32x32x16_bf16 v[32:47], a[40:43], v[72:75], v[32:47]
    v_mfma_f32_32x32x16_bf16 v[48:63], a[104:107], v[72:75], v[48:63]
    s_waitcnt vmcnt(16)
    v_mfma_f32_32x32x16_bf16 v[32:47], a[44:47], v[76:79], v[32:47]
    v_mfma_f32_32x32x16_bf16 v[48:63], a[108:111], v[76:79], v[48:63]
    s_waitcnt vmcnt(14)
    v_mfma_f32_32x32x16_bf16 v[32:47], a[48:51], v[80:83], v[32:47]
    v_mfma_f32_32x32x16_bf16 v[48:63], a[112:115], v[80:83], v[48:63]
    s_waitcnt vmcnt(12)
    v_mfma_f32_32x32x16_bf16 v[32:47], a[52:55], v[84:87], v[32:47]
    v_mfma_f32_32x32x16_bf16 v[48:63], a[116:119], v[84:87], v[48:63]
    s_waitcnt vmcnt(10)
    v_mfma_f32_32x32x16_bf16 v[32:47], a[56:59], v[88:91], v[32:47]
    v_mfma_f32_32x32x16_bf16 v[48:63], a[120:123], v[88:91], v[48:63]
    s_waitcnt vmcnt(8)
    v_mfma_f32_32x32x16_bf16 v[32:47], a[60:63], v[92:95], v[32:47]
    v_mfma_f32_32x32x16_bf16 v[48:63], a[124:127], v[92:95], v[48:63]
    s_waitcnt vmcnt(0)
    v_max3_f32 v8, |v96|, |v97|, |v98|
    v_max3_f32 v8, v8, |v99|, |v100|
    v_max3_f32 v8, v8, |v101|, |v102|
    v_max3_f32 v8, v8, |v103|, |v104|
    v_max3_f32 v8, v8, |v105|, |v106|
    v_max3_f32 v8, v8, |v107|, |v108|
    v_max3_f32 v8, v8, |v109|, |v110|
    v_max3_f32 v8, v8, |v111|, |v112|
    v_max3_f32 v8, v8, |v113|, |v114|
    v_max3_f32 v8, v8, |v115|, |v116|
    v_max3_f32 v8, v8, |v117|, |v118|
    v_max3_f32 v8, v8, |v119|, |v120|
    v_max3_f32 v8, v8, |v121|, |v122|
    v_max3_f32 v8, v8, |v123|, |v124|
    v_max3_f32 v8, v8, |v125|, |v126|
    v_max_f32 v8, v8, |v127|
    s_mov_b32 s41, 0x42a80000
    v_cmp_lt_f32 s[42:43], s41, v8
    s_lshl_b32 s36, s21, 12
    v_add_u32 v2, s36, v5
    v_lshrrev_b32 v10, 5, v1
    v_lshlrev_b32 v11, 4, v10
    s_lshl_b32 s36, s21, 8
    s_add_u32 s36, s36, 81920
    v_add_u32 v11, s36, v11
    v_and_b32 v12, 31, v1
    v_mul_u32_u24 v13, 1056, v12
    v_add_u32 v9, v11, v13
    v_lshrrev_b32 v13, 3, v12
    v_mul_u32_u24 v13, 1056, v13
    v_add_u32 v4, v11, v13
    s_lshl_b32 s36, s21, 3
    v_add_u32 v10, s36, v10
    v_mul_u32_u24 v13, 528, v10
    v_lshl_add_u32 v13, v12, 4, v13
    v_add_u32 v6, 115712, v13
    v_lshlrev_b32 v13, 9, v10
    v_lshl_add_u32 v7, v12, 4, v13
    s_mov_b32 s41, 0x4038aa3b
    v_mul_f32 v64, s41, v32
    v_mul_f32 v65, s41, v33
    v_mul_f32 v66, s41, v34
    v_mul_f32 v67, s41, v35
    v_mul_f32 v68, s41, v36
    v_mul_f32 v69, s41, v37
    v_mul_f32 v70, s41, v38
    v_mul_f32 v71, s41, v39
    v_mul_f32 v72, s41, v40
    v_mul_f32 v73, s41, v41
    v_mul_f32 v74, s41, v42
    v_mul_f32 v75, s41, v43
    v_mul_f32 v76, s41, v44
    v_mul_f32 v77, s41, v45
    v_mul_f32 v78, s41, v46
    v_mul_f32 v79, s41, v47
    v_mul_f32 v80, s41, v48
    v_mul_f32 v81, s41, v49
    v_mul_f32 v82, s41, v50
    v_mul_f32 v83, s41, v51
    v_mul_f32 v84, s41, v52
    v_mul_f32 v85, s41, v53
    v_mul_f32 v86, s41, v54
    v_mul_f32 v87, s41, v55
    v_mul_f32 v88, s41, v56
    v_mul_f32 v89, s41, v57
    v_mul_f32 v90, s41, v58
    v_mul_f32 v91, s41, v59
    v_mul_f32 v92, s41, v60
    v_mul_f32 v93, s41, v61
    v_mul_f32 v94, s41, v62
    v_mul_f32 v95, s41, v63
    v_max3_f32 v8, |v64|, |v65|, |v66|
    v_max3_f32 v8, v8, |v67|, |v68|
    v_max3_f32 v8, v8, |v69|, |v70|
    v_max3_f32 v8, v8, |v71|, |v72|
    v_max3_f32 v8, v8, |v73|, |v74|
    v_max3_f32 v8, v8, |v75|, |v76|
    v_max3_f32 v8, v8, |v77|, |v78|
    v_max3_f32 v8, v8, |v79|, |v80|
    v_max3_f32 v8, v8, |v81|, |v82|
    v_max3_f32 v8, v8, |v83|, |v84|
    v_max3_f32 v8, v8, |v85|, |v86|
    v_max3_f32 v8, v8, |v87|, |v88|
    v_max3_f32 v8, v8, |v89|, |v90|
    v_max3_f32 v8, v8, |v91|, |v92|
    v_max3_f32 v8, v8, |v93|, |v94|
    v_max_f32 v8, v8, |v95|
    s_mov_b32 s41, 0x42200000
    v_cmp_lt_f32 vcc, s41, v8
    s_nop 3
    s_or_b64 s[42:43], s[42:43], vcc
    s_cmp_lg_u64 s[42:43], 0
    s_cselect_b32 s44, 1, 0
    s_cmp_lg_u32 s44, 0
    s_cbranch_scc1 L_joint_kernel_slow
    v_exp_f32 v32, v64
    v_exp_f32 v33, v65
    v_exp_f32 v34, v66
    v_exp_f32 v35, v67
    v_exp_f32 v36, v68
    v_exp_f32 v37, v69
    v_exp_f32 v38, v70
    v_exp_f32 v39, v71
    v_exp_f32 v40, v72
    v_exp_f32 v41, v73
    v_exp_f32 v42, v74
    v_exp_f32 v43, v75
    v_exp_f32 v44, v76
    v_exp_f32 v45, v77
    v_exp_f32 v46, v78
    v_exp_f32 v47, v79
    v_exp_f32 v48, v80
    v_exp_f32 v49, v81
    v_exp_f32 v50, v82
    v_exp_f32 v51, v83
    v_exp_f32 v52, v84
    v_exp_f32 v53, v85
    v_exp_f32 v54, v86
    v_exp_f32 v55, v87
    v_exp_f32 v56, v88
    v_exp_f32 v57, v89
    v_exp_f32 v58, v90
    v_exp_f32 v59, v91
    v_exp_f32 v60, v92
    v_exp_f32 v61, v93
    v_exp_f32 v62, v94
    v_exp_f32 v63, v95
    v_exp_f32 v96, v96
    v_exp_f32 v97, v97
    v_exp_f32 v98, v98
    v_exp_f32 v99, v99
    v_exp_f32 v100, v100
    v_exp_f32 v101, v101
    v_exp_f32 v102, v102
    v_exp_f32 v103, v103
    v_exp_f32 v104, v104
    v_exp_f32 v105, v105
    v_exp_f32 v106, v106
    v_exp_f32 v107, v107
    v_exp_f32 v108, v108
    v_exp_f32 v109, v109
    v_exp_f32 v110, v110
    v_exp_f32 v111, v111
    v_exp_f32 v112, v112
    v_exp_f32 v113, v113
    v_exp_f32 v114, v114
    v_exp_f32 v115, v115
    v_exp_f32 v116, v116
    v_exp_f32 v117, v117
    v_exp_f32 v118, v118
    v_exp_f32 v119, v119
    v_exp_f32 v120, v120
    v_exp_f32 v121, v121
    v_exp_f32 v122, v122
    v_exp_f32 v123, v123
    v_exp_f32 v124, v124
    v_exp_f32 v125, v125
    v_exp_f32 v126, v126
    v_exp_f32 v127, v127
    ds_write_b128 v9, v[32:35] offset:0
    ds_write_b128 v9, v[36:39] offset:32
    ds_write_b128 v9, v[40:43] offset:64
    ds_write_b128 v9, v[44:47] offset:96
    ds_write_b128 v9, v[48:51] offset:128
    ds_write_b128 v9, v[52:55] offset:160
    ds_write_b128 v9, v[56:59] offset:192
    ds_write_b128 v9, v[60:63] offset:224
    s_waitcnt lgkmcnt(0)
    ds_read_b128 v[32:35], v4 offset:0
    ds_read_b128 v[36:39], v4 offset:32
    ds_read_b128 v[40:43], v4 offset:64
    ds_read_b128 v[44:47], v4 offset:96
    ds_read_b128 v[48:51], v4 offset:128
    ds_read_b128 v[52:55], v4 offset:160
    ds_read_b128 v[56:59], v4 offset:192
    ds_read_b128 v[60:63], v4 offset:224
    s_waitcnt lgkmcnt(6)
    v_fma_f32 v64, v32, v96, 1.0
    v_fma_f32 v65, v33, v97, 1.0
    v_fma_f32 v66, v34, v98, 1.0
    v_fma_f32 v67, v35, v99, 1.0
    v_fma_f32 v68, v36, v100, 1.0
    v_fma_f32 v69, v37, v101, 1.0
    v_fma_f32 v70, v38, v102, 1.0
    v_fma_f32 v71, v39, v103, 1.0
    ds_read_b128 v[32:35], v4 offset:4224
    ds_read_b128 v[36:39], v4 offset:4256
    v_rcp_f32 v64, v64
    v_rcp_f32 v65, v65
    v_rcp_f32 v66, v66
    v_rcp_f32 v67, v67
    v_rcp_f32 v68, v68
    v_rcp_f32 v69, v69
    v_rcp_f32 v70, v70
    v_rcp_f32 v71, v71
    s_nop 0
    v_cvt_pk_bf16_f32 v80, v64, v65
    v_cvt_pk_bf16_f32 v81, v66, v67
    v_cvt_pk_bf16_f32 v82, v68, v69
    v_cvt_pk_bf16_f32 v83, v70, v71
    ds_write_b128 v2, v[80:83] offset:0
    s_waitcnt lgkmcnt(7)
    v_fma_f32 v72, v40, v104, 1.0
    v_fma_f32 v73, v41, v105, 1.0
    v_fma_f32 v74, v42, v106, 1.0
    v_fma_f32 v75, v43, v107, 1.0
    v_fma_f32 v76, v44, v108, 1.0
    v_fma_f32 v77, v45, v109, 1.0
    v_fma_f32 v78, v46, v110, 1.0
    v_fma_f32 v79, v47, v111, 1.0
    ds_read_b128 v[40:43], v4 offset:4288
    ds_read_b128 v[44:47], v4 offset:4320
    v_rcp_f32 v72, v72
    v_rcp_f32 v73, v73
    v_rcp_f32 v74, v74
    v_rcp_f32 v75, v75
    v_rcp_f32 v76, v76
    v_rcp_f32 v77, v77
    v_rcp_f32 v78, v78
    v_rcp_f32 v79, v79
    s_nop 0
    v_cvt_pk_bf16_f32 v84, v72, v73
    v_cvt_pk_bf16_f32 v85, v74, v75
    v_cvt_pk_bf16_f32 v86, v76, v77
    v_cvt_pk_bf16_f32 v87, v78, v79
    ds_write_b128 v2, v[84:87] offset:1024
    s_waitcnt lgkmcnt(8)
    v_fma_f32 v64, v48, v112, 1.0
    v_fma_f32 v65, v49, v113, 1.0
    v_fma_f32 v66, v50, v114, 1.0
    v_fma_f32 v67, v51, v115, 1.0
    v_fma_f32 v68, v52, v116, 1.0
    v_fma_f32 v69, v53, v117, 1.0
    v_fma_f32 v70, v54, v118, 1.0
    v_fma_f32 v71, v55, v119, 1.0
    ds_read_b128 v[48:51], v4 offset:4352
    ds_read_b128 v[52:55], v4 offset:4384
    v_rcp_f32 v64, v64
    v_rcp_f32 v65, v65
    v_rcp_f32 v66, v66
    v_rcp_f32 v67, v67
    v_rcp_f32 v68, v68
    v_rcp_f32 v69, v69
    v_rcp_f32 v70, v70
    v_rcp_f32 v71, v71
    s_nop 0
    v_cvt_pk_bf16_f32 v80, v64, v65
    v_cvt_pk_bf16_f32 v81, v66, v67
    v_cvt_pk_bf16_f32 v82, v68, v69
    v_cvt_pk_bf16_f32 v83, v70, v71
    ds_write_b128 v2, v[80:83] offset:2048
    s_waitcnt lgkmcnt(9)
    v_fma_f32 v72, v56, v120, 1.0
    v_fma_f32 v73, v57, v121, 1.0
    v_fma_f32 v74, v58, v122, 1.0
    v_fma_f32 v75, v59, v123, 1.0
    v_fma_f32 v76, v60, v124, 1.0
    v_fma_f32 v77, v61, v125, 1.0
    v_fma_f32 v78, v62, v126, 1.0
    v_fma_f32 v79, v63, v127, 1.0
    ds_read_b128 v[56:59], v4 offset:4416
    ds_read_b128 v[60:63], v4 offset:4448
    v_rcp_f32 v72, v72
    v_rcp_f32 v73, v73
    v_rcp_f32 v74, v74
    v_rcp_f32 v75, v75
    v_rcp_f32 v76, v76
    v_rcp_f32 v77, v77
    v_rcp_f32 v78, v78
    v_rcp_f32 v79, v79
    s_nop 0
    v_cvt_pk_bf16_f32 v84, v72, v73
    v_cvt_pk_bf16_f32 v85, v74, v75
    v_cvt_pk_bf16_f32 v86, v76, v77
    v_cvt_pk_bf16_f32 v87, v78, v79
    ds_write_b128 v2, v[84:87] offset:3072
    s_waitcnt lgkmcnt(10)
    v_fma_f32 v64, v32, v96, 1.0
    v_fma_f32 v65, v33, v97, 1.0
    v_fma_f32 v66, v34, v98, 1.0
    v_fma_f32 v67, v35, v99, 1.0
    v_fma_f32 v68, v36, v100, 1.0
    v_fma_f32 v69, v37, v101, 1.0
    v_fma_f32 v70, v38, v102, 1.0
    v_fma_f32 v71, v39, v103, 1.0
    ds_read_b128 v[32:35], v4 offset:8448
    ds_read_b128 v[36:39], v4 offset:8480
    v_rcp_f32 v64, v64
    v_rcp_f32 v65, v65
    v_rcp_f32 v66, v66
    v_rcp_f32 v67, v67
    v_rcp_f32 v68, v68
    v_rcp_f32 v69, v69
    v_rcp_f32 v70, v70
    v_rcp_f32 v71, v71
    s_nop 0
    v_cvt_pk_bf16_f32 v80, v64, v65
    v_cvt_pk_bf16_f32 v81, v66, v67
    v_cvt_pk_bf16_f32 v82, v68, v69
    v_cvt_pk_bf16_f32 v83, v70, v71
    ds_write_b128 v2, v[80:83] offset:16384
    s_waitcnt lgkmcnt(10)
    v_fma_f32 v72, v40, v104, 1.0
    v_fma_f32 v73, v41, v105, 1.0
    v_fma_f32 v74, v42, v106, 1.0
    v_fma_f32 v75, v43, v107, 1.0
    v_fma_f32 v76, v44, v108, 1.0
    v_fma_f32 v77, v45, v109, 1.0
    v_fma_f32 v78, v46, v110, 1.0
    v_fma_f32 v79, v47, v111, 1.0
    ds_read_b128 v[40:43], v4 offset:8512
    ds_read_b128 v[44:47], v4 offset:8544
    v_rcp_f32 v72, v72
    v_rcp_f32 v73, v73
    v_rcp_f32 v74, v74
    v_rcp_f32 v75, v75
    v_rcp_f32 v76, v76
    v_rcp_f32 v77, v77
    v_rcp_f32 v78, v78
    v_rcp_f32 v79, v79
    s_nop 0
    v_cvt_pk_bf16_f32 v84, v72, v73
    v_cvt_pk_bf16_f32 v85, v74, v75
    v_cvt_pk_bf16_f32 v86, v76, v77
    v_cvt_pk_bf16_f32 v87, v78, v79
    ds_write_b128 v2, v[84:87] offset:17408
    s_waitcnt lgkmcnt(10)
    v_fma_f32 v64, v48, v112, 1.0
    v_fma_f32 v65, v49, v113, 1.0
    v_fma_f32 v66, v50, v114, 1.0
    v_fma_f32 v67, v51, v115, 1.0
    v_fma_f32 v68, v52, v116, 1.0
    v_fma_f32 v69, v53, v117, 1.0
    v_fma_f32 v70, v54, v118, 1.0
    v_fma_f32 v71, v55, v119, 1.0
    ds_read_b128 v[48:51], v4 offset:8576
    ds_read_b128 v[52:55], v4 offset:8608
    v_rcp_f32 v64, v64
    v_rcp_f32 v65, v65
    v_rcp_f32 v66, v66
    v_rcp_f32 v67, v67
    v_rcp_f32 v68, v68
    v_rcp_f32 v69, v69
    v_rcp_f32 v70, v70
    v_rcp_f32 v71, v71
    s_nop 0
    v_cvt_pk_bf16_f32 v80, v64, v65
    v_cvt_pk_bf16_f32 v81, v66, v67
    v_cvt_pk_bf16_f32 v82, v68, v69
    v_cvt_pk_bf16_f32 v83, v70, v71
    ds_write_b128 v2, v[80:83] offset:18432
    s_waitcnt lgkmcnt(10)
    v_fma_f32 v72, v56, v120, 1.0
    v_fma_f32 v73, v57, v121, 1.0
    v_fma_f32 v74, v58, v122, 1.0
    v_fma_f32 v75, v59, v123, 1.0
    v_fma_f32 v76, v60, v124, 1.0
    v_fma_f32 v77, v61, v125, 1.0
    v_fma_f32 v78, v62, v126, 1.0
    v_fma_f32 v79, v63, v127, 1.0
    ds_read_b128 v[56:59], v4 offset:8640
    ds_read_b128 v[60:63], v4 offset:8672
    v_rcp_f32 v72, v72
    v_rcp_f32 v73, v73
    v_rcp_f32 v74, v74
    v_rcp_f32 v75, v75
    v_rcp_f32 v76, v76
    v_rcp_f32 v77, v77
    v_rcp_f32 v78, v78
    v_rcp_f32 v79, v79
    s_nop 0
    v_cvt_pk_bf16_f32 v84, v72, v73
    v_cvt_pk_bf16_f32 v85, v74, v75
    v_cvt_pk_bf16_f32 v86, v76, v77
    v_cvt_pk_bf16_f32 v87, v78, v79
    ds_write_b128 v2, v[84:87] offset:19456
    s_waitcnt lgkmcnt(0)
    s_barrier
    v_fma_f32 v64, v32, v96, 1.0
    v_fma_f32 v65, v33, v97, 1.0
    v_fma_f32 v66, v34, v98, 1.0
    v_fma_f32 v67, v35, v99, 1.0
    v_fma_f32 v68, v36, v100, 1.0
    v_fma_f32 v69, v37, v101, 1.0
    v_fma_f32 v70, v38, v102, 1.0
    v_fma_f32 v71, v39, v103, 1.0
    ds_read_b128 v[32:35], v4 offset:12672
    ds_read_b128 v[36:39], v4 offset:12704
    v_rcp_f32 v64, v64
    v_rcp_f32 v65, v65
    v_rcp_f32 v66, v66
    v_rcp_f32 v67, v67
    v_rcp_f32 v68, v68
    v_rcp_f32 v69, v69
    v_rcp_f32 v70, v70
    v_rcp_f32 v71, v71
    s_nop 0
    v_cvt_pk_bf16_f32 v80, v64, v65
    v_cvt_pk_bf16_f32 v81, v66, v67
    v_cvt_pk_bf16_f32 v82, v68, v69
    v_cvt_pk_bf16_f32 v83, v70, v71
    ds_write_b128 v2, v[80:83] offset:32768
    v_fma_f32 v72, v40, v104, 1.0
    v_fma_f32 v73, v41, v105, 1.0
    v_fma_f32 v74, v42, v106, 1.0
    v_fma_f32 v75, v43, v107, 1.0
    v_fma_f32 v76, v44, v108, 1.0
    v_fma_f32 v77, v45, v109, 1.0
    v_fma_f32 v78, v46, v110, 1.0
    v_fma_f32 v79, v47, v111, 1.0
    ds_read_b128 v[40:43], v4 offset:12736
    ds_read_b128 v[44:47], v4 offset:12768
    v_rcp_f32 v72, v72
    v_rcp_f32 v73, v73
    v_rcp_f32 v74, v74
    v_rcp_f32 v75, v75
    v_rcp_f32 v76, v76
    v_rcp_f32 v77, v77
    v_rcp_f32 v78, v78
    v_rcp_f32 v79, v79
    s_nop 0
    v_cvt_pk_bf16_f32 v84, v72, v73
    v_cvt_pk_bf16_f32 v85, v74, v75
    v_cvt_pk_bf16_f32 v86, v76, v77
    v_cvt_pk_bf16_f32 v87, v78, v79
    ds_write_b128 v2, v[84:87] offset:33792
    v_fma_f32 v64, v48, v112, 1.0
    v_fma_f32 v65, v49, v113, 1.0
    v_fma_f32 v66, v50, v114, 1.0
    v_fma_f32 v67, v51, v115, 1.0
    v_fma_f32 v68, v52, v116, 1.0
    v_fma_f32 v69, v53, v117, 1.0
    v_fma_f32 v70, v54, v118, 1.0
    v_fma_f32 v71, v55, v119, 1.0
    ds_read_b128 v[48:51], v4 offset:12800
    ds_read_b128 v[52:55], v4 offset:12832
    v_rcp_f32 v64, v64
    v_rcp_f32 v65, v65
    v_rcp_f32 v66, v66
    v_rcp_f32 v67, v67
    v_rcp_f32 v68, v68
    v_rcp_f32 v69, v69
    v_rcp_f32 v70, v70
    v_rcp_f32 v71, v71
    s_nop 0
    v_cvt_pk_bf16_f32 v80, v64, v65
    v_cvt_pk_bf16_f32 v81, v66, v67
    v_cvt_pk_bf16_f32 v82, v68, v69
    v_cvt_pk_bf16_f32 v83, v70, v71
    ds_write_b128 v2, v[80:83] offset:34816
    v_fma_f32 v72, v56, v120, 1.0
    v_fma_f32 v73, v57, v121, 1.0
    v_fma_f32 v74, v58, v122, 1.0
    v_fma_f32 v75, v59, v123, 1.0
    v_fma_f32 v76, v60, v124, 1.0
    v_fma_f32 v77, v61, v125, 1.0
    v_fma_f32 v78, v62, v126, 1.0
    v_fma_f32 v79, v63, v127, 1.0
    ds_read_b128 v[56:59], v4 offset:12864
    ds_read_b128 v[60:63], v4 offset:12896
    v_rcp_f32 v72, v72
    v_rcp_f32 v73, v73
    v_rcp_f32 v74, v74
    v_rcp_f32 v75, v75
    v_rcp_f32 v76, v76
    v_rcp_f32 v77, v77
    v_rcp_f32 v78, v78
    v_rcp_f32 v79, v79
    s_nop 0
    v_cvt_pk_bf16_f32 v84, v72, v73
    v_cvt_pk_bf16_f32 v85, v74, v75
    v_cvt_pk_bf16_f32 v86, v76, v77
    v_cvt_pk_bf16_f32 v87, v78, v79
    ds_write_b128 v2, v[84:87] offset:35840
    s_waitcnt lgkmcnt(0)
    s_barrier
    v_fma_f32 v64, v32, v96, 1.0
    v_fma_f32 v65, v33, v97, 1.0
    v_fma_f32 v66, v34, v98, 1.0
    v_fma_f32 v67, v35, v99, 1.0
    v_fma_f32 v68, v36, v100, 1.0
    v_fma_f32 v69, v37, v101, 1.0
    v_fma_f32 v70, v38, v102, 1.0
    v_fma_f32 v71, v39, v103, 1.0
    ds_read_b128 v[32:35], v4 offset:16896
    ds_read_b128 v[36:39], v4 offset:16928
    v_rcp_f32 v64, v64
    v_rcp_f32 v65, v65
    v_rcp_f32 v66, v66
    v_rcp_f32 v67, v67
    v_rcp_f32 v68, v68
    v_rcp_f32 v69, v69
    v_rcp_f32 v70, v70
    v_rcp_f32 v71, v71
    s_nop 0
    v_cvt_pk_bf16_f32 v80, v64, v65
    v_cvt_pk_bf16_f32 v81, v66, v67
    v_cvt_pk_bf16_f32 v82, v68, v69
    v_cvt_pk_bf16_f32 v83, v70, v71
    ds_write_b128 v2, v[80:83] offset:0
    v_fma_f32 v72, v40, v104, 1.0
    v_fma_f32 v73, v41, v105, 1.0
    v_fma_f32 v74, v42, v106, 1.0
    v_fma_f32 v75, v43, v107, 1.0
    v_fma_f32 v76, v44, v108, 1.0
    v_fma_f32 v77, v45, v109, 1.0
    v_fma_f32 v78, v46, v110, 1.0
    v_fma_f32 v79, v47, v111, 1.0
    ds_read_b128 v[40:43], v4 offset:16960
    ds_read_b128 v[44:47], v4 offset:16992
    v_rcp_f32 v72, v72
    v_rcp_f32 v73, v73
    v_rcp_f32 v74, v74
    v_rcp_f32 v75, v75
    v_rcp_f32 v76, v76
    v_rcp_f32 v77, v77
    v_rcp_f32 v78, v78
    v_rcp_f32 v79, v79
    s_nop 0
    v_cvt_pk_bf16_f32 v84, v72, v73
    v_cvt_pk_bf16_f32 v85, v74, v75
    v_cvt_pk_bf16_f32 v86, v76, v77
    v_cvt_pk_bf16_f32 v87, v78, v79
    ds_write_b128 v2, v[84:87] offset:1024
    v_fma_f32 v64, v48, v112, 1.0
    v_fma_f32 v65, v49, v113, 1.0
    v_fma_f32 v66, v50, v114, 1.0
    v_fma_f32 v67, v51, v115, 1.0
    v_fma_f32 v68, v52, v116, 1.0
    v_fma_f32 v69, v53, v117, 1.0
    v_fma_f32 v70, v54, v118, 1.0
    v_fma_f32 v71, v55, v119, 1.0
    ds_read_b128 v[48:51], v4 offset:17024
    ds_read_b128 v[52:55], v4 offset:17056
    v_rcp_f32 v64, v64
    v_rcp_f32 v65, v65
    v_rcp_f32 v66, v66
    v_rcp_f32 v67, v67
    v_rcp_f32 v68, v68
    v_rcp_f32 v69, v69
    v_rcp_f32 v70, v70
    v_rcp_f32 v71, v71
    s_nop 0
    v_cvt_pk_bf16_f32 v80, v64, v65
    v_cvt_pk_bf16_f32 v81, v66, v67
    v_cvt_pk_bf16_f32 v82, v68, v69
    v_cvt_pk_bf16_f32 v83, v70, v71
    ds_write_b128 v2, v[80:83] offset:2048
    v_fma_f32 v72, v56, v120, 1.0
    v_fma_f32 v73, v57, v121, 1.0
    v_fma_f32 v74, v58, v122, 1.0
    v_fma_f32 v75, v59, v123, 1.0
    v_fma_f32 v76, v60, v124, 1.0
    v_fma_f32 v77, v61, v125, 1.0
    v_fma_f32 v78, v62, v126, 1.0
    v_fma_f32 v79, v63, v127, 1.0
    ds_read_b128 v[56:59], v4 offset:17088
    ds_read_b128 v[60:63], v4 offset:17120
    v_rcp_f32 v72, v72
    v_rcp_f32 v73, v73
    v_rcp_f32 v74, v74
    v_rcp_f32 v75, v75
    v_rcp_f32 v76, v76
    v_rcp_f32 v77, v77
    v_rcp_f32 v78, v78
    v_rcp_f32 v79, v79
    s_nop 0
    v_cvt_pk_bf16_f32 v84, v72, v73
    v_cvt_pk_bf16_f32 v85, v74, v75
    v_cvt_pk_bf16_f32 v86, v76, v77
    v_cvt_pk_bf16_f32 v87, v78, v79
    ds_write_b128 v2, v[84:87] offset:3072
    s_waitcnt lgkmcnt(0)
    s_barrier
    ds_read_b128 a[0:3], v6 offset:0
    ds_read_b128 a[4:7], v6 offset:1056
    ds_read_b128 a[8:11], v6 offset:2112
    ds_read_b128 a[12:15], v6 offset:3168
    v_fma_f32 v64, v32, v96, 1.0
    v_fma_f32 v65, v33, v97, 1.0
    v_fma_f32 v66, v34, v98, 1.0
    v_fma_f32 v67, v35, v99, 1.0
    v_fma_f32 v68, v36, v100, 1.0
    v_fma_f32 v69, v37, v101, 1.0
    v_fma_f32 v70, v38, v102, 1.0
    v_fma_f32 v71, v39, v103, 1.0
    ds_read_b128 v[32:35], v4 offset:21120
    ds_read_b128 v[36:39], v4 offset:21152
    v_rcp_f32 v64, v64
    v_rcp_f32 v65, v65
    v_rcp_f32 v66, v66
    v_rcp_f32 v67, v67
    v_rcp_f32 v68, v68
    v_rcp_f32 v69, v69
    v_rcp_f32 v70, v70
    v_rcp_f32 v71, v71
    s_waitcnt lgkmcnt(5)
    s_mov_b32 s36, 0
    buffer_store_dwordx4 a[0:3], v7, s[16:19], s36 offen sc1
    s_waitcnt lgkmcnt(4)
    s_mov_b32 s36, 1024
    buffer_store_dwordx4 a[4:7], v7, s[16:19], s36 offen sc1
    v_cvt_pk_bf16_f32 v80, v64, v65
    v_cvt_pk_bf16_f32 v81, v66, v67
    v_cvt_pk_bf16_f32 v82, v68, v69
    v_cvt_pk_bf16_f32 v83, v70, v71
    ds_write_b128 v2, v[80:83] offset:16384
    v_fma_f32 v72, v40, v104, 1.0
    v_fma_f32 v73, v41, v105, 1.0
    v_fma_f32 v74, v42, v106, 1.0
    v_fma_f32 v75, v43, v107, 1.0
    v_fma_f32 v76, v44, v108, 1.0
    v_fma_f32 v77, v45, v109, 1.0
    v_fma_f32 v78, v46, v110, 1.0
    v_fma_f32 v79, v47, v111, 1.0
    ds_read_b128 v[40:43], v4 offset:21184
    ds_read_b128 v[44:47], v4 offset:21216
    v_rcp_f32 v72, v72
    v_rcp_f32 v73, v73
    v_rcp_f32 v74, v74
    v_rcp_f32 v75, v75
    v_rcp_f32 v76, v76
    v_rcp_f32 v77, v77
    v_rcp_f32 v78, v78
    v_rcp_f32 v79, v79
    s_waitcnt lgkmcnt(6)
    s_mov_b32 s36, 2048
    buffer_store_dwordx4 a[8:11], v7, s[16:19], s36 offen sc1
    s_waitcnt lgkmcnt(5)
    s_mov_b32 s36, 3072
    buffer_store_dwordx4 a[12:15], v7, s[16:19], s36 offen sc1
    v_cvt_pk_bf16_f32 v84, v72, v73
    v_cvt_pk_bf16_f32 v85, v74, v75
    v_cvt_pk_bf16_f32 v86, v76, v77
    v_cvt_pk_bf16_f32 v87, v78, v79
    ds_write_b128 v2, v[84:87] offset:17408
    v_fma_f32 v64, v48, v112, 1.0
    v_fma_f32 v65, v49, v113, 1.0
    v_fma_f32 v66, v50, v114, 1.0
    v_fma_f32 v67, v51, v115, 1.0
    v_fma_f32 v68, v52, v116, 1.0
    v_fma_f32 v69, v53, v117, 1.0
    v_fma_f32 v70, v54, v118, 1.0
    v_fma_f32 v71, v55, v119, 1.0
    ds_read_b128 v[48:51], v4 offset:21248
    ds_read_b128 v[52:55], v4 offset:21280
    v_rcp_f32 v64, v64
    v_rcp_f32 v65, v65
    v_rcp_f32 v66, v66
    v_rcp_f32 v67, v67
    v_rcp_f32 v68, v68
    v_rcp_f32 v69, v69
    v_rcp_f32 v70, v70
    v_rcp_f32 v71, v71
    s_nop 0
    v_cvt_pk_bf16_f32 v80, v64, v65
    v_cvt_pk_bf16_f32 v81, v66, v67
    v_cvt_pk_bf16_f32 v82, v68, v69
    v_cvt_pk_bf16_f32 v83, v70, v71
    ds_write_b128 v2, v[80:83] offset:18432
    v_fma_f32 v72, v56, v120, 1.0
    v_fma_f32 v73, v57, v121, 1.0
    v_fma_f32 v74, v58, v122, 1.0
    v_fma_f32 v75, v59, v123, 1.0
    v_fma_f32 v76, v60, v124, 1.0
    v_fma_f32 v77, v61, v125, 1.0
    v_fma_f32 v78, v62, v126, 1.0
    v_fma_f32 v79, v63, v127, 1.0
    ds_read_b128 v[56:59], v4 offset:21312
    ds_read_b128 v[60:63], v4 offset:21344
    v_rcp_f32 v72, v72
    v_rcp_f32 v73, v73
    v_rcp_f32 v74, v74
    v_rcp_f32 v75, v75
    v_rcp_f32 v76, v76
    v_rcp_f32 v77, v77
    v_rcp_f32 v78, v78
    v_rcp_f32 v79, v79
    s_nop 0
    v_cvt_pk_bf16_f32 v84, v72, v73
    v_cvt_pk_bf16_f32 v85, v74, v75
    v_cvt_pk_bf16_f32 v86, v76, v77
    v_cvt_pk_bf16_f32 v87, v78, v79
    ds_write_b128 v2, v[84:87] offset:19456
    s_waitcnt lgkmcnt(0)
    s_barrier
    ds_read_b128 a[0:3], v6 offset:16896
    ds_read_b128 a[4:7], v6 offset:17952
    ds_read_b128 a[8:11], v6 offset:19008
    ds_read_b128 a[12:15], v6 offset:20064
    v_fma_f32 v64, v32, v96, 1.0
    v_fma_f32 v65, v33, v97, 1.0
    v_fma_f32 v66, v34, v98, 1.0
    v_fma_f32 v67, v35, v99, 1.0
    v_fma_f32 v68, v36, v100, 1.0
    v_fma_f32 v69, v37, v101, 1.0
    v_fma_f32 v70, v38, v102, 1.0
    v_fma_f32 v71, v39, v103, 1.0
    ds_read_b128 v[32:35], v4 offset:25344
    ds_read_b128 v[36:39], v4 offset:25376
    v_rcp_f32 v64, v64
    v_rcp_f32 v65, v65
    v_rcp_f32 v66, v66
    v_rcp_f32 v67, v67
    v_rcp_f32 v68, v68
    v_rcp_f32 v69, v69
    v_rcp_f32 v70, v70
    v_rcp_f32 v71, v71
    s_waitcnt lgkmcnt(5)
    s_mov_b32 s36, 16384
    buffer_store_dwordx4 a[0:3], v7, s[16:19], s36 offen sc1
    s_waitcnt lgkmcnt(4)
    s_mov_b32 s36, 17408
    buffer_store_dwordx4 a[4:7], v7, s[16:19], s36 offen sc1
    v_cvt_pk_bf16_f32 v80, v64, v65
    v_cvt_pk_bf16_f32 v81, v66, v67
    v_cvt_pk_bf16_f32 v82, v68, v69
    v_cvt_pk_bf16_f32 v83, v70, v71
    ds_write_b128 v2, v[80:83] offset:32768
    v_fma_f32 v72, v40, v104, 1.0
    v_fma_f32 v73, v41, v105, 1.0
    v_fma_f32 v74, v42, v106, 1.0
    v_fma_f32 v75, v43, v107, 1.0
    v_fma_f32 v76, v44, v108, 1.0
    v_fma_f32 v77, v45, v109, 1.0
    v_fma_f32 v78, v46, v110, 1.0
    v_fma_f32 v79, v47, v111, 1.0
    ds_read_b128 v[40:43], v4 offset:25408
    ds_read_b128 v[44:47], v4 offset:25440
    v_rcp_f32 v72, v72
    v_rcp_f32 v73, v73
    v_rcp_f32 v74, v74
    v_rcp_f32 v75, v75
    v_rcp_f32 v76, v76
    v_rcp_f32 v77, v77
    v_rcp_f32 v78, v78
    v_rcp_f32 v79, v79
    s_waitcnt lgkmcnt(6)
    s_mov_b32 s36, 18432
    buffer_store_dwordx4 a[8:11], v7, s[16:19], s36 offen sc1
    s_waitcnt lgkmcnt(5)
    s_mov_b32 s36, 19456
    buffer_store_dwordx4 a[12:15], v7, s[16:19], s36 offen sc1
    v_cvt_pk_bf16_f32 v84, v72, v73
    v_cvt_pk_bf16_f32 v85, v74, v75
    v_cvt_pk_bf16_f32 v86, v76, v77
    v_cvt_pk_bf16_f32 v87, v78, v79
    ds_write_b128 v2, v[84:87] offset:33792
    v_fma_f32 v64, v48, v112, 1.0
    v_fma_f32 v65, v49, v113, 1.0
    v_fma_f32 v66, v50, v114, 1.0
    v_fma_f32 v67, v51, v115, 1.0
    v_fma_f32 v68, v52, v116, 1.0
    v_fma_f32 v69, v53, v117, 1.0
    v_fma_f32 v70, v54, v118, 1.0
    v_fma_f32 v71, v55, v119, 1.0
    ds_read_b128 v[48:51], v4 offset:25472
    ds_read_b128 v[52:55], v4 offset:25504
    v_rcp_f32 v64, v64
    v_rcp_f32 v65, v65
    v_rcp_f32 v66, v66
    v_rcp_f32 v67, v67
    v_rcp_f32 v68, v68
    v_rcp_f32 v69, v69
    v_rcp_f32 v70, v70
    v_rcp_f32 v71, v71
    s_nop 0
    v_cvt_pk_bf16_f32 v80, v64, v65
    v_cvt_pk_bf16_f32 v81, v66, v67
    v_cvt_pk_bf16_f32 v82, v68, v69
    v_cvt_pk_bf16_f32 v83, v70, v71
    ds_write_b128 v2, v[80:83] offset:34816
    v_fma_f32 v72, v56, v120, 1.0
    v_fma_f32 v73, v57, v121, 1.0
    v_fma_f32 v74, v58, v122, 1.0
    v_fma_f32 v75, v59, v123, 1.0
    v_fma_f32 v76, v60, v124, 1.0
    v_fma_f32 v77, v61, v125, 1.0
    v_fma_f32 v78, v62, v126, 1.0
    v_fma_f32 v79, v63, v127, 1.0
    ds_read_b128 v[56:59], v4 offset:25536
    ds_read_b128 v[60:63], v4 offset:25568
    v_rcp_f32 v72, v72
    v_rcp_f32 v73, v73
    v_rcp_f32 v74, v74
    v_rcp_f32 v75, v75
    v_rcp_f32 v76, v76
    v_rcp_f32 v77, v77
    v_rcp_f32 v78, v78
    v_rcp_f32 v79, v79
    s_nop 0
    v_cvt_pk_bf16_f32 v84, v72, v73
    v_cvt_pk_bf16_f32 v85, v74, v75
    v_cvt_pk_bf16_f32 v86, v76, v77
    v_cvt_pk_bf16_f32 v87, v78, v79
    ds_write_b128 v2, v[84:87] offset:35840
    s_waitcnt lgkmcnt(0)
    s_barrier
    ds_read_b128 a[0:3], v6 offset:0
    ds_read_b128 a[4:7], v6 offset:1056
    ds_read_b128 a[8:11], v6 offset:2112
    ds_read_b128 a[12:15], v6 offset:3168
    v_fma_f32 v64, v32, v96, 1.0
    v_fma_f32 v65, v33, v97, 1.0
    v_fma_f32 v66, v34, v98, 1.0
    v_fma_f32 v67, v35, v99, 1.0
    v_fma_f32 v68, v36, v100, 1.0
    v_fma_f32 v69, v37, v101, 1.0
    v_fma_f32 v70, v38, v102, 1.0
    v_fma_f32 v71, v39, v103, 1.0
    ds_read_b128 v[32:35], v4 offset:29568
    ds_read_b128 v[36:39], v4 offset:29600
    v_rcp_f32 v64, v64
    v_rcp_f32 v65, v65
    v_rcp_f32 v66, v66
    v_rcp_f32 v67, v67
    v_rcp_f32 v68, v68
    v_rcp_f32 v69, v69
    v_rcp_f32 v70, v70
    v_rcp_f32 v71, v71
    s_waitcnt lgkmcnt(5)
    s_mov_b32 s36, 32768
    buffer_store_dwordx4 a[0:3], v7, s[16:19], s36 offen sc1
    s_waitcnt lgkmcnt(4)
    s_mov_b32 s36, 33792
    buffer_store_dwordx4 a[4:7], v7, s[16:19], s36 offen sc1
    v_cvt_pk_bf16_f32 v80, v64, v65
    v_cvt_pk_bf16_f32 v81, v66, v67
    v_cvt_pk_bf16_f32 v82, v68, v69
    v_cvt_pk_bf16_f32 v83, v70, v71
    ds_write_b128 v2, v[80:83] offset:0
    v_fma_f32 v72, v40, v104, 1.0
    v_fma_f32 v73, v41, v105, 1.0
    v_fma_f32 v74, v42, v106, 1.0
    v_fma_f32 v75, v43, v107, 1.0
    v_fma_f32 v76, v44, v108, 1.0
    v_fma_f32 v77, v45, v109, 1.0
    v_fma_f32 v78, v46, v110, 1.0
    v_fma_f32 v79, v47, v111, 1.0
    ds_read_b128 v[40:43], v4 offset:29632
    ds_read_b128 v[44:47], v4 offset:29664
    v_rcp_f32 v72, v72
    v_rcp_f32 v73, v73
    v_rcp_f32 v74, v74
    v_rcp_f32 v75, v75
    v_rcp_f32 v76, v76
    v_rcp_f32 v77, v77
    v_rcp_f32 v78, v78
    v_rcp_f32 v79, v79
    s_waitcnt lgkmcnt(6)
    s_mov_b32 s36, 34816
    buffer_store_dwordx4 a[8:11], v7, s[16:19], s36 offen sc1
    s_waitcnt lgkmcnt(5)
    s_mov_b32 s36, 35840
    buffer_store_dwordx4 a[12:15], v7, s[16:19], s36 offen sc1
    v_cvt_pk_bf16_f32 v84, v72, v73
    v_cvt_pk_bf16_f32 v85, v74, v75
    v_cvt_pk_bf16_f32 v86, v76, v77
    v_cvt_pk_bf16_f32 v87, v78, v79
    ds_write_b128 v2, v[84:87] offset:1024
    v_fma_f32 v64, v48, v112, 1.0
    v_fma_f32 v65, v49, v113, 1.0
    v_fma_f32 v66, v50, v114, 1.0
    v_fma_f32 v67, v51, v115, 1.0
    v_fma_f32 v68, v52, v116, 1.0
    v_fma_f32 v69, v53, v117, 1.0
    v_fma_f32 v70, v54, v118, 1.0
    v_fma_f32 v71, v55, v119, 1.0
    ds_read_b128 v[48:51], v4 offset:29696
    ds_read_b128 v[52:55], v4 offset:29728
    v_rcp_f32 v64, v64
    v_rcp_f32 v65, v65
    v_rcp_f32 v66, v66
    v_rcp_f32 v67, v67
    v_rcp_f32 v68, v68
    v_rcp_f32 v69, v69
    v_rcp_f32 v70, v70
    v_rcp_f32 v71, v71
    s_nop 0
    v_cvt_pk_bf16_f32 v80, v64, v65
    v_cvt_pk_bf16_f32 v81, v66, v67
    v_cvt_pk_bf16_f32 v82, v68, v69
    v_cvt_pk_bf16_f32 v83, v70, v71
    ds_write_b128 v2, v[80:83] offset:2048
    v_fma_f32 v72, v56, v120, 1.0
    v_fma_f32 v73, v57, v121, 1.0
    v_fma_f32 v74, v58, v122, 1.0
    v_fma_f32 v75, v59, v123, 1.0
    v_fma_f32 v76, v60, v124, 1.0
    v_fma_f32 v77, v61, v125, 1.0
    v_fma_f32 v78, v62, v126, 1.0
    v_fma_f32 v79, v63, v127, 1.0
    ds_read_b128 v[56:59], v4 offset:29760
    ds_read_b128 v[60:63], v4 offset:29792
    v_rcp_f32 v72, v72
    v_rcp_f32 v73, v73
    v_rcp_f32 v74, v74
    v_rcp_f32 v75, v75
    v_rcp_f32 v76, v76
    v_rcp_f32 v77, v77
    v_rcp_f32 v78, v78
    v_rcp_f32 v79, v79
    s_nop 0
    v_cvt_pk_bf16_f32 v84, v72, v73
    v_cvt_pk_bf16_f32 v85, v74, v75
    v_cvt_pk_bf16_f32 v86, v76, v77
    v_cvt_pk_bf16_f32 v87, v78, v79
    ds_write_b128 v2, v[84:87] offset:3072
    s_waitcnt lgkmcnt(0)
    s_barrier
    ds_read_b128 a[0:3], v6 offset:16896
    ds_read_b128 a[4:7], v6 offset:17952
    ds_read_b128 a[8:11], v6 offset:19008
    ds_read_b128 a[12:15], v6 offset:20064
    v_fma_f32 v64, v32, v96, 1.0
    v_fma_f32 v65, v33, v97, 1.0
    v_fma_f32 v66, v34, v98, 1.0
    v_fma_f32 v67, v35, v99, 1.0
    v_fma_f32 v68, v36, v100, 1.0
    v_fma_f32 v69, v37, v101, 1.0
    v_fma_f32 v70, v38, v102, 1.0
    v_fma_f32 v71, v39, v103, 1.0
    v_rcp_f32 v64, v64
    v_rcp_f32 v65, v65
    v_rcp_f32 v66, v66
    v_rcp_f32 v67, v67
    v_rcp_f32 v68, v68
    v_rcp_f32 v69, v69
    v_rcp_f32 v70, v70
    v_rcp_f32 v71, v71
    s_waitcnt lgkmcnt(3)
    s_mov_b32 s36, 49152
    buffer_store_dwordx4 a[0:3], v7, s[16:19], s36 offen sc1
    s_waitcnt lgkmcnt(2)
    s_mov_b32 s36, 50176
    buffer_store_dwordx4 a[4:7], v7, s[16:19], s36 offen sc1
    v_cvt_pk_bf16_f32 v80, v64, v65
    v_cvt_pk_bf16_f32 v81, v66, v67
    v_cvt_pk_bf16_f32 v82, v68, v69
    v_cvt_pk_bf16_f32 v83, v70, v71
    ds_write_b128 v2, v[80:83] offset:16384
    v_fma_f32 v72, v40, v104, 1.0
    v_fma_f32 v73, v41, v105, 1.0
    v_fma_f32 v74, v42, v106, 1.0
    v_fma_f32 v75, v43, v107, 1.0
    v_fma_f32 v76, v44, v108, 1.0
    v_fma_f32 v77, v45, v109, 1.0
    v_fma_f32 v78, v46, v110, 1.0
    v_fma_f32 v79, v47, v111, 1.0
    v_rcp_f32 v72, v72
    v_rcp_f32 v73, v73
    v_rcp_f32 v74, v74
    v_rcp_f32 v75, v75
    v_rcp_f32 v76, v76
    v_rcp_f32 v77, v77
    v_rcp_f32 v78, v78
    v_rcp_f32 v79, v79
    s_waitcnt lgkmcnt(2)
    s_mov_b32 s36, 51200
    buffer_store_dwordx4 a[8:11], v7, s[16:19], s36 offen sc1
    s_waitcnt lgkmcnt(1)
    s_mov_b32 s36, 52224
    buffer_store_dwordx4 a[12:15], v7, s[16:19], s36 offen sc1
    v_cvt_pk_bf16_f32 v84, v72, v73
    v_cvt_pk_bf16_f32 v85, v74, v75
    v_cvt_pk_bf16_f32 v86, v76, v77
    v_cvt_pk_bf16_f32 v87, v78, v79
    ds_write_b128 v2, v[84:87] offset:17408
    v_fma_f32 v64, v48, v112, 1.0
    v_fma_f32 v65, v49, v113, 1.0
    v_fma_f32 v66, v50, v114, 1.0
    v_fma_f32 v67, v51, v115, 1.0
    v_fma_f32 v68, v52, v116, 1.0
    v_fma_f32 v69, v53, v117, 1.0
    v_fma_f32 v70, v54, v118, 1.0
    v_fma_f32 v71, v55, v119, 1.0
    v_rcp_f32 v64, v64
    v_rcp_f32 v65, v65
    v_rcp_f32 v66, v66
    v_rcp_f32 v67, v67
    v_rcp_f32 v68, v68
    v_rcp_f32 v69, v69
    v_rcp_f32 v70, v70
    v_rcp_f32 v71, v71
    s_nop 0
    v_cvt_pk_bf16_f32 v80, v64, v65
    v_cvt_pk_bf16_f32 v81, v66, v67
    v_cvt_pk_bf16_f32 v82, v68, v69
    v_cvt_pk_bf16_f32 v83, v70, v71
    ds_write_b128 v2, v[80:83] offset:18432
    v_fma_f32 v72, v56, v120, 1.0
    v_fma_f32 v73, v57, v121, 1.0
    v_fma_f32 v74, v58, v122, 1.0
    v_fma_f32 v75, v59, v123, 1.0
    v_fma_f32 v76, v60, v124, 1.0
    v_fma_f32 v77, v61, v125, 1.0
    v_fma_f32 v78, v62, v126, 1.0
    v_fma_f32 v79, v63, v127, 1.0
    v_rcp_f32 v72, v72
    v_rcp_f32 v73, v73
    v_rcp_f32 v74, v74
    v_rcp_f32 v75, v75
    v_rcp_f32 v76, v76
    v_rcp_f32 v77, v77
    v_rcp_f32 v78, v78
    v_rcp_f32 v79, v79
    s_nop 0
    v_cvt_pk_bf16_f32 v84, v72, v73
    v_cvt_pk_bf16_f32 v85, v74, v75
    v_cvt_pk_bf16_f32 v86, v76, v77
    v_cvt_pk_bf16_f32 v87, v78, v79
    ds_write_b128 v2, v[84:87] offset:19456
    s_waitcnt lgkmcnt(0)
    s_barrier
    ds_read_b128 a[0:3], v6 offset:0
    ds_read_b128 a[4:7], v6 offset:1056
    ds_read_b128 a[8:11], v6 offset:2112
    ds_read_b128 a[12:15], v6 offset:3168
    s_waitcnt lgkmcnt(3)
    s_mov_b32 s36, 65536
    buffer_store_dwordx4 a[0:3], v7, s[16:19], s36 offen sc1
    s_waitcnt lgkmcnt(2)
    s_mov_b32 s36, 66560
    buffer_store_dwordx4 a[4:7], v7, s[16:19], s36 offen sc1
    s_waitcnt lgkmcnt(1)
    s_mov_b32 s36, 67584
    buffer_store_dwordx4 a[8:11], v7, s[16:19], s36 offen sc1
    s_waitcnt lgkmcnt(0)
    s_mov_b32 s36, 68608
    buffer_store_dwordx4 a[12:15], v7, s[16:19], s36 offen sc1
    s_barrier
    ds_read_b128 a[0:3], v6 offset:16896
    ds_read_b128 a[4:7], v6 offset:17952
    ds_read_b128 a[8:11], v6 offset:19008
    ds_read_b128 a[12:15], v6 offset:20064
    s_waitcnt lgkmcnt(3)
    s_mov_b32 s36, 81920
    buffer_store_dwordx4 a[0:3], v7, s[16:19], s36 offen sc1
    s_waitcnt lgkmcnt(2)
    s_mov_b32 s36, 82944
    buffer_store_dwordx4 a[4:7], v7, s[16:19], s36 offen sc1
    s_waitcnt lgkmcnt(1)
    s_mov_b32 s36, 83968
    buffer_store_dwordx4 a[8:11], v7, s[16:19], s36 offen sc1
    s_waitcnt lgkmcnt(0)
    s_mov_b32 s36, 84992
    buffer_store_dwordx4 a[12:15], v7, s[16:19], s36 offen sc1
    s_barrier
    ds_read_b128 a[0:3], v6 offset:0
    ds_read_b128 a[4:7], v6 offset:1056
    ds_read_b128 a[8:11], v6 offset:2112
    ds_read_b128 a[12:15], v6 offset:3168
    s_waitcnt lgkmcnt(3)
    s_mov_b32 s36, 98304
    buffer_store_dwordx4 a[0:3], v7, s[16:19], s36 offen sc1
    s_waitcnt lgkmcnt(2)
    s_mov_b32 s36, 99328
    buffer_store_dwordx4 a[4:7], v7, s[16:19], s36 offen sc1
    s_waitcnt lgkmcnt(1)
    s_mov_b32 s36, 100352
    buffer_store_dwordx4 a[8:11], v7, s[16:19], s36 offen sc1
    s_waitcnt lgkmcnt(0)
    s_mov_b32 s36, 101376
    buffer_store_dwordx4 a[12:15], v7, s[16:19], s36 offen sc1
    s_barrier
    ds_read_b128 a[0:3], v6 offset:16896
    ds_read_b128 a[4:7], v6 offset:17952
    ds_read_b128 a[8:11], v6 offset:19008
    ds_read_b128 a[12:15], v6 offset:20064
    s_waitcnt lgkmcnt(3)
    s_mov_b32 s36, 114688
    buffer_store_dwordx4 a[0:3], v7, s[16:19], s36 offen sc1
    s_waitcnt lgkmcnt(2)
    s_mov_b32 s36, 115712
    buffer_store_dwordx4 a[4:7], v7, s[16:19], s36 offen sc1
    s_waitcnt lgkmcnt(1)
    s_mov_b32 s36, 116736
    buffer_store_dwordx4 a[8:11], v7, s[16:19], s36 offen sc1
    s_waitcnt lgkmcnt(0)
    s_mov_b32 s36, 117760
    buffer_store_dwordx4 a[12:15], v7, s[16:19], s36 offen sc1
    s_endpgm
L_joint_kernel_slow:
    ds_write_b128 v9, v[64:67] offset:0
    ds_write_b128 v9, v[68:71] offset:32
    ds_write_b128 v9, v[72:75] offset:64
    ds_write_b128 v9, v[76:79] offset:96
    ds_write_b128 v9, v[80:83] offset:128
    ds_write_b128 v9, v[84:87] offset:160
    ds_write_b128 v9, v[88:91] offset:192
    ds_write_b128 v9, v[92:95] offset:224
    s_waitcnt lgkmcnt(0)
    ds_read_b128 v[32:35], v4 offset:0
    ds_read_b128 v[36:39], v4 offset:32
    ds_read_b128 v[40:43], v4 offset:64
    ds_read_b128 v[44:47], v4 offset:96
    ds_read_b128 v[48:51], v4 offset:128
    ds_read_b128 v[52:55], v4 offset:160
    ds_read_b128 v[56:59], v4 offset:192
    ds_read_b128 v[60:63], v4 offset:224
    s_waitcnt lgkmcnt(6)
    v_add_f32 v64, v32, v96
    v_add_f32 v65, v33, v97
    v_add_f32 v66, v34, v98
    v_add_f32 v67, v35, v99
    v_add_f32 v68, v36, v100
    v_add_f32 v69, v37, v101
    v_add_f32 v70, v38, v102
    v_add_f32 v71, v39, v103
    ds_read_b128 v[32:35], v4 offset:4224
    ds_read_b128 v[36:39], v4 offset:4256
    v_exp_f32 v64, v64
    v_exp_f32 v65, v65
    v_exp_f32 v66, v66
    v_exp_f32 v67, v67
    v_exp_f32 v68, v68
    v_exp_f32 v69, v69
    v_exp_f32 v70, v70
    v_exp_f32 v71, v71
    v_add_f32 v64, 1.0, v64
    v_add_f32 v65, 1.0, v65
    v_add_f32 v66, 1.0, v66
    v_add_f32 v67, 1.0, v67
    v_add_f32 v68, 1.0, v68
    v_add_f32 v69, 1.0, v69
    v_add_f32 v70, 1.0, v70
    v_add_f32 v71, 1.0, v71
    v_rcp_f32 v64, v64
    v_rcp_f32 v65, v65
    v_rcp_f32 v66, v66
    v_rcp_f32 v67, v67
    v_rcp_f32 v68, v68
    v_rcp_f32 v69, v69
    v_rcp_f32 v70, v70
    v_rcp_f32 v71, v71
    s_nop 0
    v_cvt_pk_bf16_f32 v80, v64, v65
    v_cvt_pk_bf16_f32 v81, v66, v67
    v_cvt_pk_bf16_f32 v82, v68, v69
    v_cvt_pk_bf16_f32 v83, v70, v71
    ds_write_b128 v2, v[80:83] offset:0
    s_waitcnt lgkmcnt(7)
    v_add_f32 v72, v40, v104
    v_add_f32 v73, v41, v105
    v_add_f32 v74, v42, v106
    v_add_f32 v75, v43, v107
    v_add_f32 v76, v44, v108
    v_add_f32 v77, v45, v109
    v_add_f32 v78, v46, v110
    v_add_f32 v79, v47, v111
    ds_read_b128 v[40:43], v4 offset:4288
    ds_read_b128 v[44:47], v4 offset:4320
    v_exp_f32 v72, v72
    v_exp_f32 v73, v73
    v_exp_f32 v74, v74
    v_exp_f32 v75, v75
    v_exp_f32 v76, v76
    v_exp_f32 v77, v77
    v_exp_f32 v78, v78
    v_exp_f32 v79, v79
    v_add_f32 v72, 1.0, v72
    v_add_f32 v73, 1.0, v73
    v_add_f32 v74, 1.0, v74
    v_add_f32 v75, 1.0, v75
    v_add_f32 v76, 1.0, v76
    v_add_f32 v77, 1.0, v77
    v_add_f32 v78, 1.0, v78
    v_add_f32 v79, 1.0, v79
    v_rcp_f32 v72, v72
    v_rcp_f32 v73, v73
    v_rcp_f32 v74, v74
    v_rcp_f32 v75, v75
    v_rcp_f32 v76, v76
    v_rcp_f32 v77, v77
    v_rcp_f32 v78, v78
    v_rcp_f32 v79, v79
    s_nop 0
    v_cvt_pk_bf16_f32 v84, v72, v73
    v_cvt_pk_bf16_f32 v85, v74, v75
    v_cvt_pk_bf16_f32 v86, v76, v77
    v_cvt_pk_bf16_f32 v87, v78, v79
    ds_write_b128 v2, v[84:87] offset:1024
    s_waitcnt lgkmcnt(8)
    v_add_f32 v64, v48, v112
    v_add_f32 v65, v49, v113
    v_add_f32 v66, v50, v114
    v_add_f32 v67, v51, v115
    v_add_f32 v68, v52, v116
    v_add_f32 v69, v53, v117
    v_add_f32 v70, v54, v118
    v_add_f32 v71, v55, v119
    ds_read_b128 v[48:51], v4 offset:4352
    ds_read_b128 v[52:55], v4 offset:4384
    v_exp_f32 v64, v64
    v_exp_f32 v65, v65
    v_exp_f32 v66, v66
    v_exp_f32 v67, v67
    v_exp_f32 v68, v68
    v_exp_f32 v69, v69
    v_exp_f32 v70, v70
    v_exp_f32 v71, v71
    v_add_f32 v64, 1.0, v64
    v_add_f32 v65, 1.0, v65
    v_add_f32 v66, 1.0, v66
    v_add_f32 v67, 1.0, v67
    v_add_f32 v68, 1.0, v68
    v_add_f32 v69, 1.0, v69
    v_add_f32 v70, 1.0, v70
    v_add_f32 v71, 1.0, v71
    v_rcp_f32 v64, v64
    v_rcp_f32 v65, v65
    v_rcp_f32 v66, v66
    v_rcp_f32 v67, v67
    v_rcp_f32 v68, v68
    v_rcp_f32 v69, v69
    v_rcp_f32 v70, v70
    v_rcp_f32 v71, v71
    s_nop 0
    v_cvt_pk_bf16_f32 v80, v64, v65
    v_cvt_pk_bf16_f32 v81, v66, v67
    v_cvt_pk_bf16_f32 v82, v68, v69
    v_cvt_pk_bf16_f32 v83, v70, v71
    ds_write_b128 v2, v[80:83] offset:2048
    s_waitcnt lgkmcnt(9)
    v_add_f32 v72, v56, v120
    v_add_f32 v73, v57, v121
    v_add_f32 v74, v58, v122
    v_add_f32 v75, v59, v123
    v_add_f32 v76, v60, v124
    v_add_f32 v77, v61, v125
    v_add_f32 v78, v62, v126
    v_add_f32 v79, v63, v127
    ds_read_b128 v[56:59], v4 offset:4416
    ds_read_b128 v[60:63], v4 offset:4448
    v_exp_f32 v72, v72
    v_exp_f32 v73, v73
    v_exp_f32 v74, v74
    v_exp_f32 v75, v75
    v_exp_f32 v76, v76
    v_exp_f32 v77, v77
    v_exp_f32 v78, v78
    v_exp_f32 v79, v79
    v_add_f32 v72, 1.0, v72
    v_add_f32 v73, 1.0, v73
    v_add_f32 v74, 1.0, v74
    v_add_f32 v75, 1.0, v75
    v_add_f32 v76, 1.0, v76
    v_add_f32 v77, 1.0, v77
    v_add_f32 v78, 1.0, v78
    v_add_f32 v79, 1.0, v79
    v_rcp_f32 v72, v72
    v_rcp_f32 v73, v73
    v_rcp_f32 v74, v74
    v_rcp_f32 v75, v75
    v_rcp_f32 v76, v76
    v_rcp_f32 v77, v77
    v_rcp_f32 v78, v78
    v_rcp_f32 v79, v79
    s_nop 0
    v_cvt_pk_bf16_f32 v84, v72, v73
    v_cvt_pk_bf16_f32 v85, v74, v75
    v_cvt_pk_bf16_f32 v86, v76, v77
    v_cvt_pk_bf16_f32 v87, v78, v79
    ds_write_b128 v2, v[84:87] offset:3072
    s_waitcnt lgkmcnt(10)
    v_add_f32 v64, v32, v96
    v_add_f32 v65, v33, v97
    v_add_f32 v66, v34, v98
    v_add_f32 v67, v35, v99
    v_add_f32 v68, v36, v100
    v_add_f32 v69, v37, v101
    v_add_f32 v70, v38, v102
    v_add_f32 v71, v39, v103
    ds_read_b128 v[32:35], v4 offset:8448
    ds_read_b128 v[36:39], v4 offset:8480
    v_exp_f32 v64, v64
    v_exp_f32 v65, v65
    v_exp_f32 v66, v66
    v_exp_f32 v67, v67
    v_exp_f32 v68, v68
    v_exp_f32 v69, v69
    v_exp_f32 v70, v70
    v_exp_f32 v71, v71
    v_add_f32 v64, 1.0, v64
    v_add_f32 v65, 1.0, v65
    v_add_f32 v66, 1.0, v66
    v_add_f32 v67, 1.0, v67
    v_add_f32 v68, 1.0, v68
    v_add_f32 v69, 1.0, v69
    v_add_f32 v70, 1.0, v70
    v_add_f32 v71, 1.0, v71
    v_rcp_f32 v64, v64
    v_rcp_f32 v65, v65
    v_rcp_f32 v66, v66
    v_rcp_f32 v67, v67
    v_rcp_f32 v68, v68
    v_rcp_f32 v69, v69
    v_rcp_f32 v70, v70
    v_rcp_f32 v71, v71
    s_nop 0
    v_cvt_pk_bf16_f32 v80, v64, v65
    v_cvt_pk_bf16_f32 v81, v66, v67
    v_cvt_pk_bf16_f32 v82, v68, v69
    v_cvt_pk_bf16_f32 v83, v70, v71
    ds_write_b128 v2, v[80:83] offset:16384
    s_waitcnt lgkmcnt(10)
    v_add_f32 v72, v40, v104
    v_add_f32 v73, v41, v105
    v_add_f32 v74, v42, v106
    v_add_f32 v75, v43, v107
    v_add_f32 v76, v44, v108
    v_add_f32 v77, v45, v109
    v_add_f32 v78, v46, v110
    v_add_f32 v79, v47, v111
    ds_read_b128 v[40:43], v4 offset:8512
    ds_read_b128 v[44:47], v4 offset:8544
    v_exp_f32 v72, v72
    v_exp_f32 v73, v73
    v_exp_f32 v74, v74
    v_exp_f32 v75, v75
    v_exp_f32 v76, v76
    v_exp_f32 v77, v77
    v_exp_f32 v78, v78
    v_exp_f32 v79, v79
    v_add_f32 v72, 1.0, v72
    v_add_f32 v73, 1.0, v73
    v_add_f32 v74, 1.0, v74
    v_add_f32 v75, 1.0, v75
    v_add_f32 v76, 1.0, v76
    v_add_f32 v77, 1.0, v77
    v_add_f32 v78, 1.0, v78
    v_add_f32 v79, 1.0, v79
    v_rcp_f32 v72, v72
    v_rcp_f32 v73, v73
    v_rcp_f32 v74, v74
    v_rcp_f32 v75, v75
    v_rcp_f32 v76, v76
    v_rcp_f32 v77, v77
    v_rcp_f32 v78, v78
    v_rcp_f32 v79, v79
    s_nop 0
    v_cvt_pk_bf16_f32 v84, v72, v73
    v_cvt_pk_bf16_f32 v85, v74, v75
    v_cvt_pk_bf16_f32 v86, v76, v77
    v_cvt_pk_bf16_f32 v87, v78, v79
    ds_write_b128 v2, v[84:87] offset:17408
    s_waitcnt lgkmcnt(10)
    v_add_f32 v64, v48, v112
    v_add_f32 v65, v49, v113
    v_add_f32 v66, v50, v114
    v_add_f32 v67, v51, v115
    v_add_f32 v68, v52, v116
    v_add_f32 v69, v53, v117
    v_add_f32 v70, v54, v118
    v_add_f32 v71, v55, v119
    ds_read_b128 v[48:51], v4 offset:8576
    ds_read_b128 v[52:55], v4 offset:8608
    v_exp_f32 v64, v64
    v_exp_f32 v65, v65
    v_exp_f32 v66, v66
    v_exp_f32 v67, v67
    v_exp_f32 v68, v68
    v_exp_f32 v69, v69
    v_exp_f32 v70, v70
    v_exp_f32 v71, v71
    v_add_f32 v64, 1.0, v64
    v_add_f32 v65, 1.0, v65
    v_add_f32 v66, 1.0, v66
    v_add_f32 v67, 1.0, v67
    v_add_f32 v68, 1.0, v68
    v_add_f32 v69, 1.0, v69
    v_add_f32 v70, 1.0, v70
    v_add_f32 v71, 1.0, v71
    v_rcp_f32 v64, v64
    v_rcp_f32 v65, v65
    v_rcp_f32 v66, v66
    v_rcp_f32 v67, v67
    v_rcp_f32 v68, v68
    v_rcp_f32 v69, v69
    v_rcp_f32 v70, v70
    v_rcp_f32 v71, v71
    s_nop 0
    v_cvt_pk_bf16_f32 v80, v64, v65
    v_cvt_pk_bf16_f32 v81, v66, v67
    v_cvt_pk_bf16_f32 v82, v68, v69
    v_cvt_pk_bf16_f32 v83, v70, v71
    ds_write_b128 v2, v[80:83] offset:18432
    s_waitcnt lgkmcnt(10)
    v_add_f32 v72, v56, v120
    v_add_f32 v73, v57, v121
    v_add_f32 v74, v58, v122
    v_add_f32 v75, v59, v123
    v_add_f32 v76, v60, v124
    v_add_f32 v77, v61, v125
    v_add_f32 v78, v62, v126
    v_add_f32 v79, v63, v127
    ds_read_b128 v[56:59], v4 offset:8640
    ds_read_b128 v[60:63], v4 offset:8672
    v_exp_f32 v72, v72
    v_exp_f32 v73, v73
    v_exp_f32 v74, v74
    v_exp_f32 v75, v75
    v_exp_f32 v76, v76
    v_exp_f32 v77, v77
    v_exp_f32 v78, v78
    v_exp_f32 v79, v79
    v_add_f32 v72, 1.0, v72
    v_add_f32 v73, 1.0, v73
    v_add_f32 v74, 1.0, v74
    v_add_f32 v75, 1.0, v75
    v_add_f32 v76, 1.0, v76
    v_add_f32 v77, 1.0, v77
    v_add_f32 v78, 1.0, v78
    v_add_f32 v79, 1.0, v79
    v_rcp_f32 v72, v72
    v_rcp_f32 v73, v73
    v_rcp_f32 v74, v74
    v_rcp_f32 v75, v75
    v_rcp_f32 v76, v76
    v_rcp_f32 v77, v77
    v_rcp_f32 v78, v78
    v_rcp_f32 v79, v79
    s_nop 0
    v_cvt_pk_bf16_f32 v84, v72, v73
    v_cvt_pk_bf16_f32 v85, v74, v75
    v_cvt_pk_bf16_f32 v86, v76, v77
    v_cvt_pk_bf16_f32 v87, v78, v79
    ds_write_b128 v2, v[84:87] offset:19456
    s_waitcnt lgkmcnt(0)
    s_barrier
    v_add_f32 v64, v32, v96
    v_add_f32 v65, v33, v97
    v_add_f32 v66, v34, v98
    v_add_f32 v67, v35, v99
    v_add_f32 v68, v36, v100
    v_add_f32 v69, v37, v101
    v_add_f32 v70, v38, v102
    v_add_f32 v71, v39, v103
    ds_read_b128 v[32:35], v4 offset:12672
    ds_read_b128 v[36:39], v4 offset:12704
    v_exp_f32 v64, v64
    v_exp_f32 v65, v65
    v_exp_f32 v66, v66
    v_exp_f32 v67, v67
    v_exp_f32 v68, v68
    v_exp_f32 v69, v69
    v_exp_f32 v70, v70
    v_exp_f32 v71, v71
    v_add_f32 v64, 1.0, v64
    v_add_f32 v65, 1.0, v65
    v_add_f32 v66, 1.0, v66
    v_add_f32 v67, 1.0, v67
    v_add_f32 v68, 1.0, v68
    v_add_f32 v69, 1.0, v69
    v_add_f32 v70, 1.0, v70
    v_add_f32 v71, 1.0, v71
    v_rcp_f32 v64, v64
    v_rcp_f32 v65, v65
    v_rcp_f32 v66, v66
    v_rcp_f32 v67, v67
    v_rcp_f32 v68, v68
    v_rcp_f32 v69, v69
    v_rcp_f32 v70, v70
    v_rcp_f32 v71, v71
    s_nop 0
    v_cvt_pk_bf16_f32 v80, v64, v65
    v_cvt_pk_bf16_f32 v81, v66, v67
    v_cvt_pk_bf16_f32 v82, v68, v69
    v_cvt_pk_bf16_f32 v83, v70, v71
    ds_write_b128 v2, v[80:83] offset:32768
    v_add_f32 v72, v40, v104
    v_add_f32 v73, v41, v105
    v_add_f32 v74, v42, v106
    v_add_f32 v75, v43, v107
    v_add_f32 v76, v44, v108
    v_add_f32 v77, v45, v109
    v_add_f32 v78, v46, v110
    v_add_f32 v79, v47, v111
    ds_read_b128 v[40:43], v4 offset:12736
    ds_read_b128 v[44:47], v4 offset:12768
    v_exp_f32 v72, v72
    v_exp_f32 v73, v73
    v_exp_f32 v74, v74
    v_exp_f32 v75, v75
    v_exp_f32 v76, v76
    v_exp_f32 v77, v77
    v_exp_f32 v78, v78
    v_exp_f32 v79, v79
    v_add_f32 v72, 1.0, v72
    v_add_f32 v73, 1.0, v73
    v_add_f32 v74, 1.0, v74
    v_add_f32 v75, 1.0, v75
    v_add_f32 v76, 1.0, v76
    v_add_f32 v77, 1.0, v77
    v_add_f32 v78, 1.0, v78
    v_add_f32 v79, 1.0, v79
    v_rcp_f32 v72, v72
    v_rcp_f32 v73, v73
    v_rcp_f32 v74, v74
    v_rcp_f32 v75, v75
    v_rcp_f32 v76, v76
    v_rcp_f32 v77, v77
    v_rcp_f32 v78, v78
    v_rcp_f32 v79, v79
    s_nop 0
    v_cvt_pk_bf16_f32 v84, v72, v73
    v_cvt_pk_bf16_f32 v85, v74, v75
    v_cvt_pk_bf16_f32 v86, v76, v77
    v_cvt_pk_bf16_f32 v87, v78, v79
    ds_write_b128 v2, v[84:87] offset:33792
    v_add_f32 v64, v48, v112
    v_add_f32 v65, v49, v113
    v_add_f32 v66, v50, v114
    v_add_f32 v67, v51, v115
    v_add_f32 v68, v52, v116
    v_add_f32 v69, v53, v117
    v_add_f32 v70, v54, v118
    v_add_f32 v71, v55, v119
    ds_read_b128 v[48:51], v4 offset:12800
    ds_read_b128 v[52:55], v4 offset:12832
    v_exp_f32 v64, v64
    v_exp_f32 v65, v65
    v_exp_f32 v66, v66
    v_exp_f32 v67, v67
    v_exp_f32 v68, v68
    v_exp_f32 v69, v69
    v_exp_f32 v70, v70
    v_exp_f32 v71, v71
    v_add_f32 v64, 1.0, v64
    v_add_f32 v65, 1.0, v65
    v_add_f32 v66, 1.0, v66
    v_add_f32 v67, 1.0, v67
    v_add_f32 v68, 1.0, v68
    v_add_f32 v69, 1.0, v69
    v_add_f32 v70, 1.0, v70
    v_add_f32 v71, 1.0, v71
    v_rcp_f32 v64, v64
    v_rcp_f32 v65, v65
    v_rcp_f32 v66, v66
    v_rcp_f32 v67, v67
    v_rcp_f32 v68, v68
    v_rcp_f32 v69, v69
    v_rcp_f32 v70, v70
    v_rcp_f32 v71, v71
    s_nop 0
    v_cvt_pk_bf16_f32 v80, v64, v65
    v_cvt_pk_bf16_f32 v81, v66, v67
    v_cvt_pk_bf16_f32 v82, v68, v69
    v_cvt_pk_bf16_f32 v83, v70, v71
    ds_write_b128 v2, v[80:83] offset:34816
    v_add_f32 v72, v56, v120
    v_add_f32 v73, v57, v121
    v_add_f32 v74, v58, v122
    v_add_f32 v75, v59, v123
    v_add_f32 v76, v60, v124
    v_add_f32 v77, v61, v125
    v_add_f32 v78, v62, v126
    v_add_f32 v79, v63, v127
    ds_read_b128 v[56:59], v4 offset:12864
    ds_read_b128 v[60:63], v4 offset:12896
    v_exp_f32 v72, v72
    v_exp_f32 v73, v73
    v_exp_f32 v74, v74
    v_exp_f32 v75, v75
    v_exp_f32 v76, v76
    v_exp_f32 v77, v77
    v_exp_f32 v78, v78
    v_exp_f32 v79, v79
    v_add_f32 v72, 1.0, v72
    v_add_f32 v73, 1.0, v73
    v_add_f32 v74, 1.0, v74
    v_add_f32 v75, 1.0, v75
    v_add_f32 v76, 1.0, v76
    v_add_f32 v77, 1.0, v77
    v_add_f32 v78, 1.0, v78
    v_add_f32 v79, 1.0, v79
    v_rcp_f32 v72, v72
    v_rcp_f32 v73, v73
    v_rcp_f32 v74, v74
    v_rcp_f32 v75, v75
    v_rcp_f32 v76, v76
    v_rcp_f32 v77, v77
    v_rcp_f32 v78, v78
    v_rcp_f32 v79, v79
    s_nop 0
    v_cvt_pk_bf16_f32 v84, v72, v73
    v_cvt_pk_bf16_f32 v85, v74, v75
    v_cvt_pk_bf16_f32 v86, v76, v77
    v_cvt_pk_bf16_f32 v87, v78, v79
    ds_write_b128 v2, v[84:87] offset:35840
    s_waitcnt lgkmcnt(0)
    s_barrier
    v_add_f32 v64, v32, v96
    v_add_f32 v65, v33, v97
    v_add_f32 v66, v34, v98
    v_add_f32 v67, v35, v99
    v_add_f32 v68, v36, v100
    v_add_f32 v69, v37, v101
    v_add_f32 v70, v38, v102
    v_add_f32 v71, v39, v103
    ds_read_b128 v[32:35], v4 offset:16896
    ds_read_b128 v[36:39], v4 offset:16928
    v_exp_f32 v64, v64
    v_exp_f32 v65, v65
    v_exp_f32 v66, v66
    v_exp_f32 v67, v67
    v_exp_f32 v68, v68
    v_exp_f32 v69, v69
    v_exp_f32 v70, v70
    v_exp_f32 v71, v71
    v_add_f32 v64, 1.0, v64
    v_add_f32 v65, 1.0, v65
    v_add_f32 v66, 1.0, v66
    v_add_f32 v67, 1.0, v67
    v_add_f32 v68, 1.0, v68
    v_add_f32 v69, 1.0, v69
    v_add_f32 v70, 1.0, v70
    v_add_f32 v71, 1.0, v71
    v_rcp_f32 v64, v64
    v_rcp_f32 v65, v65
    v_rcp_f32 v66, v66
    v_rcp_f32 v67, v67
    v_rcp_f32 v68, v68
    v_rcp_f32 v69, v69
    v_rcp_f32 v70, v70
    v_rcp_f32 v71, v71
    s_nop 0
    v_cvt_pk_bf16_f32 v80, v64, v65
    v_cvt_pk_bf16_f32 v81, v66, v67
    v_cvt_pk_bf16_f32 v82, v68, v69
    v_cvt_pk_bf16_f32 v83, v70, v71
    ds_write_b128 v2, v[80:83] offset:0
    v_add_f32 v72, v40, v104
    v_add_f32 v73, v41, v105
    v_add_f32 v74, v42, v106
    v_add_f32 v75, v43, v107
    v_add_f32 v76, v44, v108
    v_add_f32 v77, v45, v109
    v_add_f32 v78, v46, v110
    v_add_f32 v79, v47, v111
    ds_read_b128 v[40:43], v4 offset:16960
    ds_read_b128 v[44:47], v4 offset:16992
    v_exp_f32 v72, v72
    v_exp_f32 v73, v73
    v_exp_f32 v74, v74
    v_exp_f32 v75, v75
    v_exp_f32 v76, v76
    v_exp_f32 v77, v77
    v_exp_f32 v78, v78
    v_exp_f32 v79, v79
    v_add_f32 v72, 1.0, v72
    v_add_f32 v73, 1.0, v73
    v_add_f32 v74, 1.0, v74
    v_add_f32 v75, 1.0, v75
    v_add_f32 v76, 1.0, v76
    v_add_f32 v77, 1.0, v77
    v_add_f32 v78, 1.0, v78
    v_add_f32 v79, 1.0, v79
    v_rcp_f32 v72, v72
    v_rcp_f32 v73, v73
    v_rcp_f32 v74, v74
    v_rcp_f32 v75, v75
    v_rcp_f32 v76, v76
    v_rcp_f32 v77, v77
    v_rcp_f32 v78, v78
    v_rcp_f32 v79, v79
    s_nop 0
    v_cvt_pk_bf16_f32 v84, v72, v73
    v_cvt_pk_bf16_f32 v85, v74, v75
    v_cvt_pk_bf16_f32 v86, v76, v77
    v_cvt_pk_bf16_f32 v87, v78, v79
    ds_write_b128 v2, v[84:87] offset:1024
    v_add_f32 v64, v48, v112
    v_add_f32 v65, v49, v113
    v_add_f32 v66, v50, v114
    v_add_f32 v67, v51, v115
    v_add_f32 v68, v52, v116
    v_add_f32 v69, v53, v117
    v_add_f32 v70, v54, v118
    v_add_f32 v71, v55, v119
    ds_read_b128 v[48:51], v4 offset:17024
    ds_read_b128 v[52:55], v4 offset:17056
    v_exp_f32 v64, v64
    v_exp_f32 v65, v65
    v_exp_f32 v66, v66
    v_exp_f32 v67, v67
    v_exp_f32 v68, v68
    v_exp_f32 v69, v69
    v_exp_f32 v70, v70
    v_exp_f32 v71, v71
    v_add_f32 v64, 1.0, v64
    v_add_f32 v65, 1.0, v65
    v_add_f32 v66, 1.0, v66
    v_add_f32 v67, 1.0, v67
    v_add_f32 v68, 1.0, v68
    v_add_f32 v69, 1.0, v69
    v_add_f32 v70, 1.0, v70
    v_add_f32 v71, 1.0, v71
    v_rcp_f32 v64, v64
    v_rcp_f32 v65, v65
    v_rcp_f32 v66, v66
    v_rcp_f32 v67, v67
    v_rcp_f32 v68, v68
    v_rcp_f32 v69, v69
    v_rcp_f32 v70, v70
    v_rcp_f32 v71, v71
    s_nop 0
    v_cvt_pk_bf16_f32 v80, v64, v65
    v_cvt_pk_bf16_f32 v81, v66, v67
    v_cvt_pk_bf16_f32 v82, v68, v69
    v_cvt_pk_bf16_f32 v83, v70, v71
    ds_write_b128 v2, v[80:83] offset:2048
    v_add_f32 v72, v56, v120
    v_add_f32 v73, v57, v121
    v_add_f32 v74, v58, v122
    v_add_f32 v75, v59, v123
    v_add_f32 v76, v60, v124
    v_add_f32 v77, v61, v125
    v_add_f32 v78, v62, v126
    v_add_f32 v79, v63, v127
    ds_read_b128 v[56:59], v4 offset:17088
    ds_read_b128 v[60:63], v4 offset:17120
    v_exp_f32 v72, v72
    v_exp_f32 v73, v73
    v_exp_f32 v74, v74
    v_exp_f32 v75, v75
    v_exp_f32 v76, v76
    v_exp_f32 v77, v77
    v_exp_f32 v78, v78
    v_exp_f32 v79, v79
    v_add_f32 v72, 1.0, v72
    v_add_f32 v73, 1.0, v73
    v_add_f32 v74, 1.0, v74
    v_add_f32 v75, 1.0, v75
    v_add_f32 v76, 1.0, v76
    v_add_f32 v77, 1.0, v77
    v_add_f32 v78, 1.0, v78
    v_add_f32 v79, 1.0, v79
    v_rcp_f32 v72, v72
    v_rcp_f32 v73, v73
    v_rcp_f32 v74, v74
    v_rcp_f32 v75, v75
    v_rcp_f32 v76, v76
    v_rcp_f32 v77, v77
    v_rcp_f32 v78, v78
    v_rcp_f32 v79, v79
    s_nop 0
    v_cvt_pk_bf16_f32 v84, v72, v73
    v_cvt_pk_bf16_f32 v85, v74, v75
    v_cvt_pk_bf16_f32 v86, v76, v77
    v_cvt_pk_bf16_f32 v87, v78, v79
    ds_write_b128 v2, v[84:87] offset:3072
    s_waitcnt lgkmcnt(0)
    s_barrier
    ds_read_b128 a[0:3], v6 offset:0
    ds_read_b128 a[4:7], v6 offset:1056
    ds_read_b128 a[8:11], v6 offset:2112
    ds_read_b128 a[12:15], v6 offset:3168
    v_add_f32 v64, v32, v96
    v_add_f32 v65, v33, v97
    v_add_f32 v66, v34, v98
    v_add_f32 v67, v35, v99
    v_add_f32 v68, v36, v100
    v_add_f32 v69, v37, v101
    v_add_f32 v70, v38, v102
    v_add_f32 v71, v39, v103
    ds_read_b128 v[32:35], v4 offset:21120
    ds_read_b128 v[36:39], v4 offset:21152
    v_exp_f32 v64, v64
    v_exp_f32 v65, v65
    v_exp_f32 v66, v66
    v_exp_f32 v67, v67
    v_exp_f32 v68, v68
    v_exp_f32 v69, v69
    v_exp_f32 v70, v70
    v_exp_f32 v71, v71
    v_add_f32 v64, 1.0, v64
    v_add_f32 v65, 1.0, v65
    v_add_f32 v66, 1.0, v66
    v_add_f32 v67, 1.0, v67
    v_add_f32 v68, 1.0, v68
    v_add_f32 v69, 1.0, v69
    v_add_f32 v70, 1.0, v70
    v_add_f32 v71, 1.0, v71
    v_rcp_f32 v64, v64
    v_rcp_f32 v65, v65
    v_rcp_f32 v66, v66
    v_rcp_f32 v67, v67
    v_rcp_f32 v68, v68
    v_rcp_f32 v69, v69
    v_rcp_f32 v70, v70
    v_rcp_f32 v71, v71
    s_waitcnt lgkmcnt(5)
    s_mov_b32 s36, 0
    buffer_store_dwordx4 a[0:3], v7, s[16:19], s36 offen sc1
    s_waitcnt lgkmcnt(4)
    s_mov_b32 s36, 1024
    buffer_store_dwordx4 a[4:7], v7, s[16:19], s36 offen sc1
    v_cvt_pk_bf16_f32 v80, v64, v65
    v_cvt_pk_bf16_f32 v81, v66, v67
    v_cvt_pk_bf16_f32 v82, v68, v69
    v_cvt_pk_bf16_f32 v83, v70, v71
    ds_write_b128 v2, v[80:83] offset:16384
    v_add_f32 v72, v40, v104
    v_add_f32 v73, v41, v105
    v_add_f32 v74, v42, v106
    v_add_f32 v75, v43, v107
    v_add_f32 v76, v44, v108
    v_add_f32 v77, v45, v109
    v_add_f32 v78, v46, v110
    v_add_f32 v79, v47, v111
    ds_read_b128 v[40:43], v4 offset:21184
    ds_read_b128 v[44:47], v4 offset:21216
    v_exp_f32 v72, v72
    v_exp_f32 v73, v73
    v_exp_f32 v74, v74
    v_exp_f32 v75, v75
    v_exp_f32 v76, v76
    v_exp_f32 v77, v77
    v_exp_f32 v78, v78
    v_exp_f32 v79, v79
    v_add_f32 v72, 1.0, v72
    v_add_f32 v73, 1.0, v73
    v_add_f32 v74, 1.0, v74
    v_add_f32 v75, 1.0, v75
    v_add_f32 v76, 1.0, v76
    v_add_f32 v77, 1.0, v77
    v_add_f32 v78, 1.0, v78
    v_add_f32 v79, 1.0, v79
    v_rcp_f32 v72, v72
    v_rcp_f32 v73, v73
    v_rcp_f32 v74, v74
    v_rcp_f32 v75, v75
    v_rcp_f32 v76, v76
    v_rcp_f32 v77, v77
    v_rcp_f32 v78, v78
    v_rcp_f32 v79, v79
    s_waitcnt lgkmcnt(6)
    s_mov_b32 s36, 2048
    buffer_store_dwordx4 a[8:11], v7, s[16:19], s36 offen sc1
    s_waitcnt lgkmcnt(5)
    s_mov_b32 s36, 3072
    buffer_store_dwordx4 a[12:15], v7, s[16:19], s36 offen sc1
    v_cvt_pk_bf16_f32 v84, v72, v73
    v_cvt_pk_bf16_f32 v85, v74, v75
    v_cvt_pk_bf16_f32 v86, v76, v77
    v_cvt_pk_bf16_f32 v87, v78, v79
    ds_write_b128 v2, v[84:87] offset:17408
    v_add_f32 v64, v48, v112
    v_add_f32 v65, v49, v113
    v_add_f32 v66, v50, v114
    v_add_f32 v67, v51, v115
    v_add_f32 v68, v52, v116
    v_add_f32 v69, v53, v117
    v_add_f32 v70, v54, v118
    v_add_f32 v71, v55, v119
    ds_read_b128 v[48:51], v4 offset:21248
    ds_read_b128 v[52:55], v4 offset:21280
    v_exp_f32 v64, v64
    v_exp_f32 v65, v65
    v_exp_f32 v66, v66
    v_exp_f32 v67, v67
    v_exp_f32 v68, v68
    v_exp_f32 v69, v69
    v_exp_f32 v70, v70
    v_exp_f32 v71, v71
    v_add_f32 v64, 1.0, v64
    v_add_f32 v65, 1.0, v65
    v_add_f32 v66, 1.0, v66
    v_add_f32 v67, 1.0, v67
    v_add_f32 v68, 1.0, v68
    v_add_f32 v69, 1.0, v69
    v_add_f32 v70, 1.0, v70
    v_add_f32 v71, 1.0, v71
    v_rcp_f32 v64, v64
    v_rcp_f32 v65, v65
    v_rcp_f32 v66, v66
    v_rcp_f32 v67, v67
    v_rcp_f32 v68, v68
    v_rcp_f32 v69, v69
    v_rcp_f32 v70, v70
    v_rcp_f32 v71, v71
    s_nop 0
    v_cvt_pk_bf16_f32 v80, v64, v65
    v_cvt_pk_bf16_f32 v81, v66, v67
    v_cvt_pk_bf16_f32 v82, v68, v69
    v_cvt_pk_bf16_f32 v83, v70, v71
    ds_write_b128 v2, v[80:83] offset:18432
    v_add_f32 v72, v56, v120
    v_add_f32 v73, v57, v121
    v_add_f32 v74, v58, v122
    v_add_f32 v75, v59, v123
    v_add_f32 v76, v60, v124
    v_add_f32 v77, v61, v125
    v_add_f32 v78, v62, v126
    v_add_f32 v79, v63, v127
    ds_read_b128 v[56:59], v4 offset:21312
    ds_read_b128 v[60:63], v4 offset:21344
    v_exp_f32 v72, v72
    v_exp_f32 v73, v73
    v_exp_f32 v74, v74
    v_exp_f32 v75, v75
    v_exp_f32 v76, v76
    v_exp_f32 v77, v77
    v_exp_f32 v78, v78
    v_exp_f32 v79, v79
    v_add_f32 v72, 1.0, v72
    v_add_f32 v73, 1.0, v73
    v_add_f32 v74, 1.0, v74
    v_add_f32 v75, 1.0, v75
    v_add_f32 v76, 1.0, v76
    v_add_f32 v77, 1.0, v77
    v_add_f32 v78, 1.0, v78
    v_add_f32 v79, 1.0, v79
    v_rcp_f32 v72, v72
    v_rcp_f32 v73, v73
    v_rcp_f32 v74, v74
    v_rcp_f32 v75, v75
    v_rcp_f32 v76, v76
    v_rcp_f32 v77, v77
    v_rcp_f32 v78, v78
    v_rcp_f32 v79, v79
    s_nop 0
    v_cvt_pk_bf16_f32 v84, v72, v73
    v_cvt_pk_bf16_f32 v85, v74, v75
    v_cvt_pk_bf16_f32 v86, v76, v77
    v_cvt_pk_bf16_f32 v87, v78, v79
    ds_write_b128 v2, v[84:87] offset:19456
    s_waitcnt lgkmcnt(0)
    s_barrier
    ds_read_b128 a[0:3], v6 offset:16896
    ds_read_b128 a[4:7], v6 offset:17952
    ds_read_b128 a[8:11], v6 offset:19008
    ds_read_b128 a[12:15], v6 offset:20064
    v_add_f32 v64, v32, v96
    v_add_f32 v65, v33, v97
    v_add_f32 v66, v34, v98
    v_add_f32 v67, v35, v99
    v_add_f32 v68, v36, v100
    v_add_f32 v69, v37, v101
    v_add_f32 v70, v38, v102
    v_add_f32 v71, v39, v103
    ds_read_b128 v[32:35], v4 offset:25344
    ds_read_b128 v[36:39], v4 offset:25376
    v_exp_f32 v64, v64
    v_exp_f32 v65, v65
    v_exp_f32 v66, v66
    v_exp_f32 v67, v67
    v_exp_f32 v68, v68
    v_exp_f32 v69, v69
    v_exp_f32 v70, v70
    v_exp_f32 v71, v71
    v_add_f32 v64, 1.0, v64
    v_add_f32 v65, 1.0, v65
    v_add_f32 v66, 1.0, v66
    v_add_f32 v67, 1.0, v67
    v_add_f32 v68, 1.0, v68
    v_add_f32 v69, 1.0, v69
    v_add_f32 v70, 1.0, v70
    v_add_f32 v71, 1.0, v71
    v_rcp_f32 v64, v64
    v_rcp_f32 v65, v65
    v_rcp_f32 v66, v66
    v_rcp_f32 v67, v67
    v_rcp_f32 v68, v68
    v_rcp_f32 v69, v69
    v_rcp_f32 v70, v70
    v_rcp_f32 v71, v71
    s_waitcnt lgkmcnt(5)
    s_mov_b32 s36, 16384
    buffer_store_dwordx4 a[0:3], v7, s[16:19], s36 offen sc1
    s_waitcnt lgkmcnt(4)
    s_mov_b32 s36, 17408
    buffer_store_dwordx4 a[4:7], v7, s[16:19], s36 offen sc1
    v_cvt_pk_bf16_f32 v80, v64, v65
    v_cvt_pk_bf16_f32 v81, v66, v67
    v_cvt_pk_bf16_f32 v82, v68, v69
    v_cvt_pk_bf16_f32 v83, v70, v71
    ds_write_b128 v2, v[80:83] offset:32768
    v_add_f32 v72, v40, v104
    v_add_f32 v73, v41, v105
    v_add_f32 v74, v42, v106
    v_add_f32 v75, v43, v107
    v_add_f32 v76, v44, v108
    v_add_f32 v77, v45, v109
    v_add_f32 v78, v46, v110
    v_add_f32 v79, v47, v111
    ds_read_b128 v[40:43], v4 offset:25408
    ds_read_b128 v[44:47], v4 offset:25440
    v_exp_f32 v72, v72
    v_exp_f32 v73, v73
    v_exp_f32 v74, v74
    v_exp_f32 v75, v75
    v_exp_f32 v76, v76
    v_exp_f32 v77, v77
    v_exp_f32 v78, v78
    v_exp_f32 v79, v79
    v_add_f32 v72, 1.0, v72
    v_add_f32 v73, 1.0, v73
    v_add_f32 v74, 1.0, v74
    v_add_f32 v75, 1.0, v75
    v_add_f32 v76, 1.0, v76
    v_add_f32 v77, 1.0, v77
    v_add_f32 v78, 1.0, v78
    v_add_f32 v79, 1.0, v79
    v_rcp_f32 v72, v72
    v_rcp_f32 v73, v73
    v_rcp_f32 v74, v74
    v_rcp_f32 v75, v75
    v_rcp_f32 v76, v76
    v_rcp_f32 v77, v77
    v_rcp_f32 v78, v78
    v_rcp_f32 v79, v79
    s_waitcnt lgkmcnt(6)
    s_mov_b32 s36, 18432
    buffer_store_dwordx4 a[8:11], v7, s[16:19], s36 offen sc1
    s_waitcnt lgkmcnt(5)
    s_mov_b32 s36, 19456
    buffer_store_dwordx4 a[12:15], v7, s[16:19], s36 offen sc1
    v_cvt_pk_bf16_f32 v84, v72, v73
    v_cvt_pk_bf16_f32 v85, v74, v75
    v_cvt_pk_bf16_f32 v86, v76, v77
    v_cvt_pk_bf16_f32 v87, v78, v79
    ds_write_b128 v2, v[84:87] offset:33792
    v_add_f32 v64, v48, v112
    v_add_f32 v65, v49, v113
    v_add_f32 v66, v50, v114
    v_add_f32 v67, v51, v115
    v_add_f32 v68, v52, v116
    v_add_f32 v69, v53, v117
    v_add_f32 v70, v54, v118
    v_add_f32 v71, v55, v119
    ds_read_b128 v[48:51], v4 offset:25472
    ds_read_b128 v[52:55], v4 offset:25504
    v_exp_f32 v64, v64
    v_exp_f32 v65, v65
    v_exp_f32 v66, v66
    v_exp_f32 v67, v67
    v_exp_f32 v68, v68
    v_exp_f32 v69, v69
    v_exp_f32 v70, v70
    v_exp_f32 v71, v71
    v_add_f32 v64, 1.0, v64
    v_add_f32 v65, 1.0, v65
    v_add_f32 v66, 1.0, v66
    v_add_f32 v67, 1.0, v67
    v_add_f32 v68, 1.0, v68
    v_add_f32 v69, 1.0, v69
    v_add_f32 v70, 1.0, v70
    v_add_f32 v71, 1.0, v71
    v_rcp_f32 v64, v64
    v_rcp_f32 v65, v65
    v_rcp_f32 v66, v66
    v_rcp_f32 v67, v67
    v_rcp_f32 v68, v68
    v_rcp_f32 v69, v69
    v_rcp_f32 v70, v70
    v_rcp_f32 v71, v71
    s_nop 0
    v_cvt_pk_bf16_f32 v80, v64, v65
    v_cvt_pk_bf16_f32 v81, v66, v67
    v_cvt_pk_bf16_f32 v82, v68, v69
    v_cvt_pk_bf16_f32 v83, v70, v71
    ds_write_b128 v2, v[80:83] offset:34816
    v_add_f32 v72, v56, v120
    v_add_f32 v73, v57, v121
    v_add_f32 v74, v58, v122
    v_add_f32 v75, v59, v123
    v_add_f32 v76, v60, v124
    v_add_f32 v77, v61, v125
    v_add_f32 v78, v62, v126
    v_add_f32 v79, v63, v127
    ds_read_b128 v[56:59], v4 offset:25536
    ds_read_b128 v[60:63], v4 offset:25568
    v_exp_f32 v72, v72
    v_exp_f32 v73, v73
    v_exp_f32 v74, v74
    v_exp_f32 v75, v75
    v_exp_f32 v76, v76
    v_exp_f32 v77, v77
    v_exp_f32 v78, v78
    v_exp_f32 v79, v79
    v_add_f32 v72, 1.0, v72
    v_add_f32 v73, 1.0, v73
    v_add_f32 v74, 1.0, v74
    v_add_f32 v75, 1.0, v75
    v_add_f32 v76, 1.0, v76
    v_add_f32 v77, 1.0, v77
    v_add_f32 v78, 1.0, v78
    v_add_f32 v79, 1.0, v79
    v_rcp_f32 v72, v72
    v_rcp_f32 v73, v73
    v_rcp_f32 v74, v74
    v_rcp_f32 v75, v75
    v_rcp_f32 v76, v76
    v_rcp_f32 v77, v77
    v_rcp_f32 v78, v78
    v_rcp_f32 v79, v79
    s_nop 0
    v_cvt_pk_bf16_f32 v84, v72, v73
    v_cvt_pk_bf16_f32 v85, v74, v75
    v_cvt_pk_bf16_f32 v86, v76, v77
    v_cvt_pk_bf16_f32 v87, v78, v79
    ds_write_b128 v2, v[84:87] offset:35840
    s_waitcnt lgkmcnt(0)
    s_barrier
    ds_read_b128 a[0:3], v6 offset:0
    ds_read_b128 a[4:7], v6 offset:1056
    ds_read_b128 a[8:11], v6 offset:2112
    ds_read_b128 a[12:15], v6 offset:3168
    v_add_f32 v64, v32, v96
    v_add_f32 v65, v33, v97
    v_add_f32 v66, v34, v98
    v_add_f32 v67, v35, v99
    v_add_f32 v68, v36, v100
    v_add_f32 v69, v37, v101
    v_add_f32 v70, v38, v102
    v_add_f32 v71, v39, v103
    ds_read_b128 v[32:35], v4 offset:29568
    ds_read_b128 v[36:39], v4 offset:29600
    v_exp_f32 v64, v64
    v_exp_f32 v65, v65
    v_exp_f32 v66, v66
    v_exp_f32 v67, v67
    v_exp_f32 v68, v68
    v_exp_f32 v69, v69
    v_exp_f32 v70, v70
    v_exp_f32 v71, v71
    v_add_f32 v64, 1.0, v64
    v_add_f32 v65, 1.0, v65
    v_add_f32 v66, 1.0, v66
    v_add_f32 v67, 1.0, v67
    v_add_f32 v68, 1.0, v68
    v_add_f32 v69, 1.0, v69
    v_add_f32 v70, 1.0, v70
    v_add_f32 v71, 1.0, v71
    v_rcp_f32 v64, v64
    v_rcp_f32 v65, v65
    v_rcp_f32 v66, v66
    v_rcp_f32 v67, v67
    v_rcp_f32 v68, v68
    v_rcp_f32 v69, v69
    v_rcp_f32 v70, v70
    v_rcp_f32 v71, v71
    s_waitcnt lgkmcnt(5)
    s_mov_b32 s36, 32768
    buffer_store_dwordx4 a[0:3], v7, s[16:19], s36 offen sc1
    s_waitcnt lgkmcnt(4)
    s_mov_b32 s36, 33792
    buffer_store_dwordx4 a[4:7], v7, s[16:19], s36 offen sc1
    v_cvt_pk_bf16_f32 v80, v64, v65
    v_cvt_pk_bf16_f32 v81, v66, v67
    v_cvt_pk_bf16_f32 v82, v68, v69
    v_cvt_pk_bf16_f32 v83, v70, v71
    ds_write_b128 v2, v[80:83] offset:0
    v_add_f32 v72, v40, v104
    v_add_f32 v73, v41, v105
    v_add_f32 v74, v42, v106
    v_add_f32 v75, v43, v107
    v_add_f32 v76, v44, v108
    v_add_f32 v77, v45, v109
    v_add_f32 v78, v46, v110
    v_add_f32 v79, v47, v111
    ds_read_b128 v[40:43], v4 offset:29632
    ds_read_b128 v[44:47], v4 offset:29664
    v_exp_f32 v72, v72
    v_exp_f32 v73, v73
    v_exp_f32 v74, v74
    v_exp_f32 v75, v75
    v_exp_f32 v76, v76
    v_exp_f32 v77, v77
    v_exp_f32 v78, v78
    v_exp_f32 v79, v79
    v_add_f32 v72, 1.0, v72
    v_add_f32 v73, 1.0, v73
    v_add_f32 v74, 1.0, v74
    v_add_f32 v75, 1.0, v75
    v_add_f32 v76, 1.0, v76
    v_add_f32 v77, 1.0, v77
    v_add_f32 v78, 1.0, v78
    v_add_f32 v79, 1.0, v79
    v_rcp_f32 v72, v72
    v_rcp_f32 v73, v73
    v_rcp_f32 v74, v74
    v_rcp_f32 v75, v75
    v_rcp_f32 v76, v76
    v_rcp_f32 v77, v77
    v_rcp_f32 v78, v78
    v_rcp_f32 v79, v79
    s_waitcnt lgkmcnt(6)
    s_mov_b32 s36, 34816
    buffer_store_dwordx4 a[8:11], v7, s[16:19], s36 offen sc1
    s_waitcnt lgkmcnt(5)
    s_mov_b32 s36, 35840
    buffer_store_dwordx4 a[12:15], v7, s[16:19], s36 offen sc1
    v_cvt_pk_bf16_f32 v84, v72, v73
    v_cvt_pk_bf16_f32 v85, v74, v75
    v_cvt_pk_bf16_f32 v86, v76, v77
    v_cvt_pk_bf16_f32 v87, v78, v79
    ds_write_b128 v2, v[84:87] offset:1024
    v_add_f32 v64, v48, v112
    v_add_f32 v65, v49, v113
    v_add_f32 v66, v50, v114
    v_add_f32 v67, v51, v115
    v_add_f32 v68, v52, v116
    v_add_f32 v69, v53, v117
    v_add_f32 v70, v54, v118
    v_add_f32 v71, v55, v119
    ds_read_b128 v[48:51], v4 offset:29696
    ds_read_b128 v[52:55], v4 offset:29728
    v_exp_f32 v64, v64
    v_exp_f32 v65, v65
    v_exp_f32 v66, v66
    v_exp_f32 v67, v67
    v_exp_f32 v68, v68
    v_exp_f32 v69, v69
    v_exp_f32 v70, v70
    v_exp_f32 v71, v71
    v_add_f32 v64, 1.0, v64
    v_add_f32 v65, 1.0, v65
    v_add_f32 v66, 1.0, v66
    v_add_f32 v67, 1.0, v67
    v_add_f32 v68, 1.0, v68
    v_add_f32 v69, 1.0, v69
    v_add_f32 v70, 1.0, v70
    v_add_f32 v71, 1.0, v71
    v_rcp_f32 v64, v64
    v_rcp_f32 v65, v65
    v_rcp_f32 v66, v66
    v_rcp_f32 v67, v67
    v_rcp_f32 v68, v68
    v_rcp_f32 v69, v69
    v_rcp_f32 v70, v70
    v_rcp_f32 v71, v71
    s_nop 0
    v_cvt_pk_bf16_f32 v80, v64, v65
    v_cvt_pk_bf16_f32 v81, v66, v67
    v_cvt_pk_bf16_f32 v82, v68, v69
    v_cvt_pk_bf16_f32 v83, v70, v71
    ds_write_b128 v2, v[80:83] offset:2048
    v_add_f32 v72, v56, v120
    v_add_f32 v73, v57, v121
    v_add_f32 v74, v58, v122
    v_add_f32 v75, v59, v123
    v_add_f32 v76, v60, v124
    v_add_f32 v77, v61, v125
    v_add_f32 v78, v62, v126
    v_add_f32 v79, v63, v127
    ds_read_b128 v[56:59], v4 offset:29760
    ds_read_b128 v[60:63], v4 offset:29792
    v_exp_f32 v72, v72
    v_exp_f32 v73, v73
    v_exp_f32 v74, v74
    v_exp_f32 v75, v75
    v_exp_f32 v76, v76
    v_exp_f32 v77, v77
    v_exp_f32 v78, v78
    v_exp_f32 v79, v79
    v_add_f32 v72, 1.0, v72
    v_add_f32 v73, 1.0, v73
    v_add_f32 v74, 1.0, v74
    v_add_f32 v75, 1.0, v75
    v_add_f32 v76, 1.0, v76
    v_add_f32 v77, 1.0, v77
    v_add_f32 v78, 1.0, v78
    v_add_f32 v79, 1.0, v79
    v_rcp_f32 v72, v72
    v_rcp_f32 v73, v73
    v_rcp_f32 v74, v74
    v_rcp_f32 v75, v75
    v_rcp_f32 v76, v76
    v_rcp_f32 v77, v77
    v_rcp_f32 v78, v78
    v_rcp_f32 v79, v79
    s_nop 0
    v_cvt_pk_bf16_f32 v84, v72, v73
    v_cvt_pk_bf16_f32 v85, v74, v75
    v_cvt_pk_bf16_f32 v86, v76, v77
    v_cvt_pk_bf16_f32 v87, v78, v79
    ds_write_b128 v2, v[84:87] offset:3072
    s_waitcnt lgkmcnt(0)
    s_barrier
    ds_read_b128 a[0:3], v6 offset:16896
    ds_read_b128 a[4:7], v6 offset:17952
    ds_read_b128 a[8:11], v6 offset:19008
    ds_read_b128 a[12:15], v6 offset:20064
    v_add_f32 v64, v32, v96
    v_add_f32 v65, v33, v97
    v_add_f32 v66, v34, v98
    v_add_f32 v67, v35, v99
    v_add_f32 v68, v36, v100
    v_add_f32 v69, v37, v101
    v_add_f32 v70, v38, v102
    v_add_f32 v71, v39, v103
    v_exp_f32 v64, v64
    v_exp_f32 v65, v65
    v_exp_f32 v66, v66
    v_exp_f32 v67, v67
    v_exp_f32 v68, v68
    v_exp_f32 v69, v69
    v_exp_f32 v70, v70
    v_exp_f32 v71, v71
    v_add_f32 v64, 1.0, v64
    v_add_f32 v65, 1.0, v65
    v_add_f32 v66, 1.0, v66
    v_add_f32 v67, 1.0, v67
    v_add_f32 v68, 1.0, v68
    v_add_f32 v69, 1.0, v69
    v_add_f32 v70, 1.0, v70
    v_add_f32 v71, 1.0, v71
    v_rcp_f32 v64, v64
    v_rcp_f32 v65, v65
    v_rcp_f32 v66, v66
    v_rcp_f32 v67, v67
    v_rcp_f32 v68, v68
    v_rcp_f32 v69, v69
    v_rcp_f32 v70, v70
    v_rcp_f32 v71, v71
    s_waitcnt lgkmcnt(3)
    s_mov_b32 s36, 49152
    buffer_store_dwordx4 a[0:3], v7, s[16:19], s36 offen sc1
    s_waitcnt lgkmcnt(2)
    s_mov_b32 s36, 50176
    buffer_store_dwordx4 a[4:7], v7, s[16:19], s36 offen sc1
    v_cvt_pk_bf16_f32 v80, v64, v65
    v_cvt_pk_bf16_f32 v81, v66, v67
    v_cvt_pk_bf16_f32 v82, v68, v69
    v_cvt_pk_bf16_f32 v83, v70, v71
    ds_write_b128 v2, v[80:83] offset:16384
    v_add_f32 v72, v40, v104
    v_add_f32 v73, v41, v105
    v_add_f32 v74, v42, v106
    v_add_f32 v75, v43, v107
    v_add_f32 v76, v44, v108
    v_add_f32 v77, v45, v109
    v_add_f32 v78, v46, v110
    v_add_f32 v79, v47, v111
    v_exp_f32 v72, v72
    v_exp_f32 v73, v73
    v_exp_f32 v74, v74
    v_exp_f32 v75, v75
    v_exp_f32 v76, v76
    v_exp_f32 v77, v77
    v_exp_f32 v78, v78
    v_exp_f32 v79, v79
    v_add_f32 v72, 1.0, v72
    v_add_f32 v73, 1.0, v73
    v_add_f32 v74, 1.0, v74
    v_add_f32 v75, 1.0, v75
    v_add_f32 v76, 1.0, v76
    v_add_f32 v77, 1.0, v77
    v_add_f32 v78, 1.0, v78
    v_add_f32 v79, 1.0, v79
    v_rcp_f32 v72, v72
    v_rcp_f32 v73, v73
    v_rcp_f32 v74, v74
    v_rcp_f32 v75, v75
    v_rcp_f32 v76, v76
    v_rcp_f32 v77, v77
    v_rcp_f32 v78, v78
    v_rcp_f32 v79, v79
    s_waitcnt lgkmcnt(2)
    s_mov_b32 s36, 51200
    buffer_store_dwordx4 a[8:11], v7, s[16:19], s36 offen sc1
    s_waitcnt lgkmcnt(1)
    s_mov_b32 s36, 52224
    buffer_store_dwordx4 a[12:15], v7, s[16:19], s36 offen sc1
    v_cvt_pk_bf16_f32 v84, v72, v73
    v_cvt_pk_bf16_f32 v85, v74, v75
    v_cvt_pk_bf16_f32 v86, v76, v77
    v_cvt_pk_bf16_f32 v87, v78, v79
    ds_write_b128 v2, v[84:87] offset:17408
    v_add_f32 v64, v48, v112
    v_add_f32 v65, v49, v113
    v_add_f32 v66, v50, v114
    v_add_f32 v67, v51, v115
    v_add_f32 v68, v52, v116
    v_add_f32 v69, v53, v117
    v_add_f32 v70, v54, v118
    v_add_f32 v71, v55, v119
    v_exp_f32 v64, v64
    v_exp_f32 v65, v65
    v_exp_f32 v66, v66
    v_exp_f32 v67, v67
    v_exp_f32 v68, v68
    v_exp_f32 v69, v69
    v_exp_f32 v70, v70
    v_exp_f32 v71, v71
    v_add_f32 v64, 1.0, v64
    v_add_f32 v65, 1.0, v65
    v_add_f32 v66, 1.0, v66
    v_add_f32 v67, 1.0, v67
    v_add_f32 v68, 1.0, v68
    v_add_f32 v69, 1.0, v69
    v_add_f32 v70, 1.0, v70
    v_add_f32 v71, 1.0, v71
    v_rcp_f32 v64, v64
    v_rcp_f32 v65, v65
    v_rcp_f32 v66, v66
    v_rcp_f32 v67, v67
    v_rcp_f32 v68, v68
    v_rcp_f32 v69, v69
    v_rcp_f32 v70, v70
    v_rcp_f32 v71, v71
    s_nop 0
    v_cvt_pk_bf16_f32 v80, v64, v65
    v_cvt_pk_bf16_f32 v81, v66, v67
    v_cvt_pk_bf16_f32 v82, v68, v69
    v_cvt_pk_bf16_f32 v83, v70, v71
    ds_write_b128 v2, v[80:83] offset:18432
    v_add_f32 v72, v56, v120
    v_add_f32 v73, v57, v121
    v_add_f32 v74, v58, v122
    v_add_f32 v75, v59, v123
    v_add_f32 v76, v60, v124
    v_add_f32 v77, v61, v125
    v_add_f32 v78, v62, v126
    v_add_f32 v79, v63, v127
    v_exp_f32 v72, v72
    v_exp_f32 v73, v73
    v_exp_f32 v74, v74
    v_exp_f32 v75, v75
    v_exp_f32 v76, v76
    v_exp_f32 v77, v77
    v_exp_f32 v78, v78
    v_exp_f32 v79, v79
    v_add_f32 v72, 1.0, v72
    v_add_f32 v73, 1.0, v73
    v_add_f32 v74, 1.0, v74
    v_add_f32 v75, 1.0, v75
    v_add_f32 v76, 1.0, v76
    v_add_f32 v77, 1.0, v77
    v_add_f32 v78, 1.0, v78
    v_add_f32 v79, 1.0, v79
    v_rcp_f32 v72, v72
    v_rcp_f32 v73, v73
    v_rcp_f32 v74, v74
    v_rcp_f32 v75, v75
    v_rcp_f32 v76, v76
    v_rcp_f32 v77, v77
    v_rcp_f32 v78, v78
    v_rcp_f32 v79, v79
    s_nop 0
    v_cvt_pk_bf16_f32 v84, v72, v73
    v_cvt_pk_bf16_f32 v85, v74, v75
    v_cvt_pk_bf16_f32 v86, v76, v77
    v_cvt_pk_bf16_f32 v87, v78, v79
    ds_write_b128 v2, v[84:87] offset:19456
    s_waitcnt lgkmcnt(0)
    s_barrier
    ds_read_b128 a[0:3], v6 offset:0
    ds_read_b128 a[4:7], v6 offset:1056
    ds_read_b128 a[8:11], v6 offset:2112
    ds_read_b128 a[12:15], v6 offset:3168
    s_waitcnt lgkmcnt(3)
    s_mov_b32 s36, 65536
    buffer_store_dwordx4 a[0:3], v7, s[16:19], s36 offen sc1
    s_waitcnt lgkmcnt(2)
    s_mov_b32 s36, 66560
    buffer_store_dwordx4 a[4:7], v7, s[16:19], s36 offen sc1
    s_waitcnt lgkmcnt(1)
    s_mov_b32 s36, 67584
    buffer_store_dwordx4 a[8:11], v7, s[16:19], s36 offen sc1
    s_waitcnt lgkmcnt(0)
    s_mov_b32 s36, 68608
    buffer_store_dwordx4 a[12:15], v7, s[16:19], s36 offen sc1
    s_barrier
    ds_read_b128 a[0:3], v6 offset:16896
    ds_read_b128 a[4:7], v6 offset:17952
    ds_read_b128 a[8:11], v6 offset:19008
    ds_read_b128 a[12:15], v6 offset:20064
    s_waitcnt lgkmcnt(3)
    s_mov_b32 s36, 81920
    buffer_store_dwordx4 a[0:3], v7, s[16:19], s36 offen sc1
    s_waitcnt lgkmcnt(2)
    s_mov_b32 s36, 82944
    buffer_store_dwordx4 a[4:7], v7, s[16:19], s36 offen sc1
    s_waitcnt lgkmcnt(1)
    s_mov_b32 s36, 83968
    buffer_store_dwordx4 a[8:11], v7, s[16:19], s36 offen sc1
    s_waitcnt lgkmcnt(0)
    s_mov_b32 s36, 84992
    buffer_store_dwordx4 a[12:15], v7, s[16:19], s36 offen sc1
    s_barrier
    ds_read_b128 a[0:3], v6 offset:0
    ds_read_b128 a[4:7], v6 offset:1056
    ds_read_b128 a[8:11], v6 offset:2112
    ds_read_b128 a[12:15], v6 offset:3168
    s_waitcnt lgkmcnt(3)
    s_mov_b32 s36, 98304
    buffer_store_dwordx4 a[0:3], v7, s[16:19], s36 offen sc1
    s_waitcnt lgkmcnt(2)
    s_mov_b32 s36, 99328
    buffer_store_dwordx4 a[4:7], v7, s[16:19], s36 offen sc1
    s_waitcnt lgkmcnt(1)
    s_mov_b32 s36, 100352
    buffer_store_dwordx4 a[8:11], v7, s[16:19], s36 offen sc1
    s_waitcnt lgkmcnt(0)
    s_mov_b32 s36, 101376
    buffer_store_dwordx4 a[12:15], v7, s[16:19], s36 offen sc1
    s_barrier
    ds_read_b128 a[0:3], v6 offset:16896
    ds_read_b128 a[4:7], v6 offset:17952
    ds_read_b128 a[8:11], v6 offset:19008
    ds_read_b128 a[12:15], v6 offset:20064
    s_waitcnt lgkmcnt(3)
    s_mov_b32 s36, 114688
    buffer_store_dwordx4 a[0:3], v7, s[16:19], s36 offen sc1
    s_waitcnt lgkmcnt(2)
    s_mov_b32 s36, 115712
    buffer_store_dwordx4 a[4:7], v7, s[16:19], s36 offen sc1
    s_waitcnt lgkmcnt(1)
    s_mov_b32 s36, 116736
    buffer_store_dwordx4 a[8:11], v7, s[16:19], s36 offen sc1
    s_waitcnt lgkmcnt(0)
    s_mov_b32 s36, 117760
    buffer_store_dwordx4 a[12:15], v7, s[16:19], s36 offen sc1
    s_endpgm
L_joint_kernel_done:
    s_endpgm
.section .rodata,"a"
.p2align 6
.amdhsa_kernel prep_kernel
  .amdhsa_next_free_vgpr 128
  .amdhsa_next_free_sgpr 102
  .amdhsa_accum_offset 128
  .amdhsa_group_segment_fixed_size 0
  .amdhsa_kernarg_size 80
  .amdhsa_user_sgpr_count 2
  .amdhsa_user_sgpr_kernarg_segment_ptr 1
  .amdhsa_system_sgpr_workgroup_id_x 1
.end_amdhsa_kernel
.p2align 6
.amdhsa_kernel gemm1_kernel
  .amdhsa_next_free_vgpr 232
  .amdhsa_next_free_sgpr 102
  .amdhsa_accum_offset 232
  .amdhsa_group_segment_fixed_size 0
  .amdhsa_kernarg_size 80
  .amdhsa_user_sgpr_count 2
  .amdhsa_user_sgpr_kernarg_segment_ptr 1
  .amdhsa_system_sgpr_workgroup_id_x 1
.end_amdhsa_kernel
.p2align 6
.amdhsa_kernel mid_kernel
  .amdhsa_next_free_vgpr 128
  .amdhsa_next_free_sgpr 102
  .amdhsa_accum_offset 128
  .amdhsa_group_segment_fixed_size 0
  .amdhsa_kernarg_size 80
  .amdhsa_user_sgpr_count 2
  .amdhsa_user_sgpr_kernarg_segment_ptr 1
  .amdhsa_system_sgpr_workgroup_id_x 1
.end_amdhsa_kernel
.p2align 6
.amdhsa_kernel gemm2_kernel
  .amdhsa_next_free_vgpr 152
  .amdhsa_next_free_sgpr 102
  .amdhsa_accum_offset 152
  .amdhsa_group_segment_fixed_size 0
  .amdhsa_kernarg_size 80
  .amdhsa_user_sgpr_count 2
  .amdhsa_user_sgpr_kernarg_segment_ptr 1
  .amdhsa_system_sgpr_workgroup_id_x 1
.end_amdhsa_kernel
.p2align 6
.amdhsa_kernel joint_kernel
  .amdhsa_next_free_vgpr 256
  .amdhsa_next_free_sgpr 102
  .amdhsa_accum_offset 128
  .amdhsa_group_segment_fixed_size 0
  .amdhsa_kernarg_size 80
  .amdhsa_user_sgpr_count 2
  .amdhsa_user_sgpr_kernarg_segment_ptr 1
  .amdhsa_system_sgpr_workgroup_id_x 1
.end_amdhsa_kernel
```

```asm
; @launch kernel=prep_kernel grid=(941,1,1) block=(256,1,1) lds=40960
; @launch kernel=gemm1_kernel grid=(256,1,1) block=(512,1,1) lds=143360
; @launch kernel=mid_kernel grid=(704,1,1) block=(256,1,1) lds=53248
; @launch kernel=gemm2_kernel grid=(256,1,1) block=(512,1,1) lds=143360
; @launch kernel=joint_kernel grid=(250,1,1) block=(512,1,1) lds=149504
.amdgcn_target "amdgcn-amd-amdhsa--gfx950"
.text
.globl prep_kernel
.p2align 8
.type prep_kernel,@function
prep_kernel:
    s_cmp_ge_u32 s2, 941
    s_cbranch_scc1 L_prep_kernel_done
    v_readfirstlane_b32 s20, v0
    s_lshr_b32 s20, s20, 6
    s_cmp_lt_u32 s2, 13
    s_cbranch_scc1 L_prep_kernel_slab
    s_cmp_lt_u32 s2, 269
    s_cbranch_scc1 L_prep_kernel_g
    s_load_dwordx2 s[4:5], s[0:1], 0
    s_load_dwordx2 s[6:7], s[0:1], 72
    s_sub_u32 s24, s2, 269
    s_and_b32 s25, s24, 7
    s_mul_i32 s25, s25, 84
    s_lshr_b32 s24, s24, 3
    s_add_u32 s24, s24, s25
    s_cmp_ge_u32 s24, 668
    s_cbranch_scc1 L_prep_kernel_done
    s_mul_hi_u32 s25, s24, 25718368
    s_mul_i32 s26, s25, 167
    s_sub_u32 s26, s24, s26
    s_and_b32 s27, s25, 1
    s_lshr_b32 s25, s25, 1
    v_and_b32 v1, 63, v0
    v_lshrrev_b32 v2, 3, v1
    s_mul_i32 s28, s26, 96
    s_add_u32 s28, s28, s27
    s_sub_u32 s28, s28, 15
    v_lshlrev_b32 v3, 1, v2
    v_add_u32 v3, s28, v3
    v_lshlrev_b32 v3, 9, v3
    s_lshl_b32 s29, s20, 7
    v_add_u32 v3, s29, v3
    v_bfe_u32 v4, v2, 1, 1
    v_lshlrev_b32 v4, 1, v4
    v_and_b32 v5, 7, v1
    v_xor_b32 v4, v4, v5
    v_lshl_add_u32 v3, v4, 4, v3
    v_xor_b32 v4, 64, v3
    s_waitcnt lgkmcnt(0)
    s_mul_i32 s30, s25, 8192000
    s_add_u32 s8, s4, s30
    s_addc_u32 s9, s5, 0
    s_mov_b32 s10, 8192000
    s_mov_b32 s11, 0x00020000
    s_lshl_b32 s31, s20, 13
    s_add_u32 m0, s31, 0
    v_add_u32 v5, 0, v3
    buffer_load_dwordx4 v5, s[8:11], 0 offen nt lds
    s_add_u32 m0, s31, 1024
    v_add_u32 v5, 8192, v4
    buffer_load_dwordx4 v5, s[8:11], 0 offen nt lds
    s_add_u32 m0, s31, 2048
    v_add_u32 v5, 16384, v3
    buffer_load_dwordx4 v5, s[8:11], 0 offen nt lds
    s_add_u32 m0, s31, 3072
    v_add_u32 v5, 24576, v4
    buffer_load_dwordx4 v5, s[8:11], 0 offen nt lds
    s_add_u32 m0, s31, 4096
    v_add_u32 v5, 32768, v3
    buffer_load_dwordx4 v5, s[8:11], 0 offen nt lds
    s_add_u32 m0, s31, 5120
    v_add_u32 v5, 40960, v4
    buffer_load_dwordx4 v5, s[8:11], 0 offen nt lds
    s_add_u32 m0, s31, 6144
    v_add_u32 v5, 49152, v3
    buffer_load_dwordx4 v5, s[8:11], 0 offen nt lds
    s_add_u32 m0, s31, 7168
    v_add_u32 v5, 57344, v4
    buffer_load_dwordx4 v5, s[8:11], 0 offen nt lds
    s_add_u32 s12, s6, 0
    s_addc_u32 s13, s7, 0
    s_mov_b32 s14, 21889024
    s_mov_b32 s15, 0x00020000
    v_mov_b32 v8, v1
    s_lshl_b32 s32, s20, 4
    v_lshlrev_b32 v6, 4, v1
    s_lshl_b32 s33, s20, 11
    v_add_u32 v7, s33, v6
    v_and_b32 v9, 15, v8
    v_lshrrev_b32 v10, 4, v8
    v_or_b32 v11, 1, v9
    v_add_u32 v11, s32, v11
    v_cvt_f32_u32 v11, v11
    v_mul_f32 v11, 0x3c000000, v11
    v_lshlrev_b32 v10, 3, v10
    v_add_u32 v10, 0, v10
    v_cvt_f32_u32 v10, v10
    v_and_b32 v9, 1, v9
    v_cvt_f32_u32 v9, v9
    v_mul_f32 v9, 0x3e800000, v9
    v_fma_f32 v12, v11, v10, v9
    v_fract_f32 v13, v12
    v_add_f32 v12, v12, v11
    v_fract_f32 v14, v12
    v_add_f32 v12, v12, v11
    v_fract_f32 v15, v12
    v_add_f32 v12, v12, v11
    v_fract_f32 v16, v12
    v_add_f32 v12, v12, v11
    v_fract_f32 v17, v12
    v_add_f32 v12, v12, v11
    v_fract_f32 v18, v12
    v_add_f32 v12, v12, v11
    v_fract_f32 v19, v12
    v_add_f32 v12, v12, v11
    v_fract_f32 v20, v12
    v_cos_f32 v13, v13
    v_cos_f32 v14, v14
    v_cos_f32 v15, v15
    v_cos_f32 v16, v16
    v_cos_f32 v17, v17
    v_cos_f32 v18, v18
    v_cos_f32 v19, v19
    v_cos_f32 v20, v20
    s_nop 0
    v_cvt_pk_bf16_f32 v24, v13, v14
    v_cvt_pk_bf16_f32 v25, v15, v16
    v_cvt_pk_bf16_f32 v26, v17, v18
    v_cvt_pk_bf16_f32 v27, v19, v20
    ds_write_b128 v7, v[24:27] offset:32768
    v_and_b32 v9, 15, v8
    v_lshrrev_b32 v10, 4, v8
    v_or_b32 v11, 1, v9
    v_add_u32 v11, s32, v11
    v_cvt_f32_u32 v11, v11
    v_mul_f32 v11, 0x3c000000, v11
    v_lshlrev_b32 v10, 3, v10
    v_add_u32 v10, 32, v10
    v_cvt_f32_u32 v10, v10
    v_and_b32 v9, 1, v9
    v_cvt_f32_u32 v9, v9
    v_mul_f32 v9, 0x3e800000, v9
    v_fma_f32 v12, v11, v10, v9
    v_fract_f32 v13, v12
    v_add_f32 v12, v12, v11
    v_fract_f32 v14, v12
    v_add_f32 v12, v12, v11
    v_fract_f32 v15, v12
    v_add_f32 v12, v12, v11
    v_fract_f32 v16, v12
    v_add_f32 v12, v12, v11
    v_fract_f32 v17, v12
    v_add_f32 v12, v12, v11
    v_fract_f32 v18, v12
    v_add_f32 v12, v12, v11
    v_fract_f32 v19, v12
    v_add_f32 v12, v12, v11
    v_fract_f32 v20, v12
    v_cos_f32 v13, v13
    v_cos_f32 v14, v14
    v_cos_f32 v15, v15
    v_cos_f32 v16, v16
    v_cos_f32 v17, v17
    v_cos_f32 v18, v18
    v_cos_f32 v19, v19
    v_cos_f32 v20, v20
    s_nop 0
    v_cvt_pk_bf16_f32 v28, v13, v14
    v_cvt_pk_bf16_f32 v29, v15, v16
    v_cvt_pk_bf16_f32 v30, v17, v18
    v_cvt_pk_bf16_f32 v31, v19, v20
    ds_write_b128 v7, v[28:31] offset:33792
    v_bfe_u32 v8, v1, 2, 2
    v_lshrrev_b32 v9, 4, v1
    v_lshl_add_u32 v10, v9, 3, v8
    v_lshlrev_b32 v10, 7, v10
    v_lshrrev_b32 v8, 1, v8
    v_and_b32 v11, 1, v9
    v_lshl_add_u32 v8, v11, 1, v8
    v_lshlrev_b32 v8, 1, v8
    v_bfe_u32 v11, v1, 1, 1
    v_xor_b32 v8, v8, v11
    v_lshl_add_u32 v10, v8, 4, v10
    v_and_b32 v11, 1, v1
    v_lshl_add_u32 v10, v11, 3, v10
    v_add_u32 v10, s31, v10
    v_xor_b32 v12, 0, v10
    v_xor_b32 v13, 32, v10
    v_xor_b32 v14, 64, v10
    v_xor_b32 v15, 96, v10
    v_bfe_u32 v8, v1, 1, 3
    s_mov_b32 s33, 684032
    v_mul_lo_u32 v8, v8, s33
    v_and_b32 v11, 1, v1
    v_lshl_add_u32 v8, v11, 6, v8
    v_lshl_add_u32 v16, v9, 4, v8
    s_mul_i32 s34, s25, 167
    s_add_u32 s34, s34, s26
    s_lshl_b32 s34, s34, 11
    s_lshl_b32 s35, s27, 3
    s_lshl_b32 s36, s20, 1
    s_add_u32 s35, s35, s36
    s_lshl_b32 s35, s35, 7
    s_add_u32 s34, s34, s35
    s_waitcnt lgkmcnt(0)
    s_barrier
    ds_read_b128 v[24:27], v6 offset:32768
    ds_read_b128 v[28:31], v6 offset:33792
    ds_read_b128 v[32:35], v6 offset:34816
    ds_read_b128 v[36:39], v6 offset:35840
    ds_read_b128 v[40:43], v6 offset:36864
    ds_read_b128 v[44:47], v6 offset:37888
    ds_read_b128 v[48:51], v6 offset:38912
    ds_read_b128 v[52:55], v6 offset:39936
    s_waitcnt vmcnt(0)
    ds_read_b64_tr_b16 v[56:57], v12 offset:0
    ds_read_b64_tr_b16 v[58:59], v12 offset:512
    ds_read_b64_tr_b16 v[60:61], v12 offset:4096
    ds_read_b64_tr_b16 v[62:63], v12 offset:4608
    ds_read_b64_tr_b16 v[64:65], v13 offset:0
    ds_read_b64_tr_b16 v[66:67], v13 offset:512
    ds_read_b64_tr_b16 v[68:69], v13 offset:4096
    ds_read_b64_tr_b16 v[70:71], v13 offset:4608
    s_waitcnt lgkmcnt(0)
    v_mfma_f32_16x16x32_bf16 v[72:75], v[56:59], v[24:27], 0
    v_mfma_f32_16x16x32_bf16 v[76:79], v[56:59], v[32:35], 0
    v_mfma_f32_16x16x32_bf16 v[80:83], v[56:59], v[40:43], 0
    v_mfma_f32_16x16x32_bf16 v[84:87], v[56:59], v[48:51], 0
    v_mfma_f32_16x16x32_bf16 v[88:91], v[64:67], v[24:27], 0
    v_mfma_f32_16x16x32_bf16 v[92:95], v[64:67], v[32:35], 0
    v_mfma_f32_16x16x32_bf16 v[96:99], v[64:67], v[40:43], 0
    v_mfma_f32_16x16x32_bf16 v[100:103], v[64:67], v[48:51], 0
    v_mfma_f32_16x16x32_bf16 v[72:75], v[60:63], v[28:31], v[72:75]
    v_mfma_f32_16x16x32_bf16 v[76:79], v[60:63], v[36:39], v[76:79]
    v_mfma_f32_16x16x32_bf16 v[80:83], v[60:63], v[44:47], v[80:83]
    v_mfma_f32_16x16x32_bf16 v[84:87], v[60:63], v[52:55], v[84:87]
    v_mfma_f32_16x16x32_bf16 v[88:91], v[68:71], v[28:31], v[88:91]
    v_mfma_f32_16x16x32_bf16 v[92:95], v[68:71], v[36:39], v[92:95]
    v_mfma_f32_16x16x32_bf16 v[96:99], v[68:71], v[44:47], v[96:99]
    v_mfma_f32_16x16x32_bf16 v[100:103], v[68:71], v[52:55], v[100:103]
    s_nop 7
    v_cvt_pk_bf16_f32 v104, v72, v73
    v_cvt_pk_bf16_f32 v105, v74, v75
    v_cvt_pk_bf16_f32 v106, v88, v89
    v_cvt_pk_bf16_f32 v107, v90, v91
    s_add_u32 s35, s34, 0
    buffer_store_dwordx4 v[104:107], v16, s[12:15], s35 offen sc1
    s_nop 1
    v_cvt_pk_bf16_f32 v108, v76, v77
    v_cvt_pk_bf16_f32 v109, v78, v79
    v_cvt_pk_bf16_f32 v110, v92, v93
    v_cvt_pk_bf16_f32 v111, v94, v95
    s_add_u32 s35, s34, 5472256
    buffer_store_dwordx4 v[108:111], v16, s[12:15], s35 offen sc1
    s_nop 1
    v_cvt_pk_bf16_f32 v104, v80, v81
    v_cvt_pk_bf16_f32 v105, v82, v83
    v_cvt_pk_bf16_f32 v106, v96, v97
    v_cvt_pk_bf16_f32 v107, v98, v99
    s_add_u32 s35, s34, 10944512
    buffer_store_dwordx4 v[104:107], v16, s[12:15], s35 offen sc1
    s_nop 1
    v_cvt_pk_bf16_f32 v108, v84, v85
    v_cvt_pk_bf16_f32 v109, v86, v87
    v_cvt_pk_bf16_f32 v110, v100, v101
    v_cvt_pk_bf16_f32 v111, v102, v103
    s_add_u32 s35, s34, 16416768
    buffer_store_dwordx4 v[108:111], v16, s[12:15], s35 offen sc1
    s_nop 1
    ds_read_b64_tr_b16 v[56:57], v14 offset:0
    ds_read_b64_tr_b16 v[58:59], v14 offset:512
    ds_read_b64_tr_b16 v[60:61], v14 offset:4096
    ds_read_b64_tr_b16 v[62:63], v14 offset:4608
    ds_read_b64_tr_b16 v[64:65], v15 offset:0
    ds_read_b64_tr_b16 v[66:67], v15 offset:512
    ds_read_b64_tr_b16 v[68:69], v15 offset:4096
    ds_read_b64_tr_b16 v[70:71], v15 offset:4608
    s_waitcnt lgkmcnt(0)
    v_mfma_f32_16x16x32_bf16 v[72:75], v[56:59], v[24:27], 0
    v_mfma_f32_16x16x32_bf16 v[76:79], v[56:59], v[32:35], 0
    v_mfma_f32_16x16x32_bf16 v[80:83], v[56:59], v[40:43], 0
    v_mfma_f32_16x16x32_bf16 v[84:87], v[56:59], v[48:51], 0
    v_mfma_f32_16x16x32_bf16 v[88:91], v[64:67], v[24:27], 0
    v_mfma_f32_16x16x32_bf16 v[92:95], v[64:67], v[32:35], 0
    v_mfma_f32_16x16x32_bf16 v[96:99], v[64:67], v[40:43], 0
    v_mfma_f32_16x16x32_bf16 v[100:103], v[64:67], v[48:51], 0
    v_mfma_f32_16x16x32_bf16 v[72:75], v[60:63], v[28:31], v[72:75]
    v_mfma_f32_16x16x32_bf16 v[76:79], v[60:63], v[36:39], v[76:79]
    v_mfma_f32_16x16x32_bf16 v[80:83], v[60:63], v[44:47], v[80:83]
    v_mfma_f32_16x16x32_bf16 v[84:87], v[60:63], v[52:55], v[84:87]
    v_mfma_f32_16x16x32_bf16 v[88:91], v[68:71], v[28:31], v[88:91]
    v_mfma_f32_16x16x32_bf16 v[92:95], v[68:71], v[36:39], v[92:95]
    v_mfma_f32_16x16x32_bf16 v[96:99], v[68:71], v[44:47], v[96:99]
    v_mfma_f32_16x16x32_bf16 v[100:103], v[68:71], v[52:55], v[100:103]
    s_nop 7
    v_cvt_pk_bf16_f32 v104, v72, v73
    v_cvt_pk_bf16_f32 v105, v74, v75
    v_cvt_pk_bf16_f32 v106, v88, v89
    v_cvt_pk_bf16_f32 v107, v90, v91
    s_add_u32 s35, s34, 128
    buffer_store_dwordx4 v[104:107], v16, s[12:15], s35 offen sc1
    s_nop 1
    v_cvt_pk_bf16_f32 v108, v76, v77
    v_cvt_pk_bf16_f32 v109, v78, v79
    v_cvt_pk_bf16_f32 v110, v92, v93
    v_cvt_pk_bf16_f32 v111, v94, v95
    s_add_u32 s35, s34, 5472384
    buffer_store_dwordx4 v[108:111], v16, s[12:15], s35 offen sc1
    s_nop 1
    v_cvt_pk_bf16_f32 v104, v80, v81
    v_cvt_pk_bf16_f32 v105, v82, v83
    v_cvt_pk_bf16_f32 v106, v96, v97
    v_cvt_pk_bf16_f32 v107, v98, v99
    s_add_u32 s35, s34, 10944640
    buffer_store_dwordx4 v[104:107], v16, s[12:15], s35 offen sc1
    s_nop 1
    v_cvt_pk_bf16_f32 v108, v84, v85
    v_cvt_pk_bf16_f32 v109, v86, v87
    v_cvt_pk_bf16_f32 v110, v100, v101
    v_cvt_pk_bf16_f32 v111, v102, v103
    s_add_u32 s35, s34, 16416896
    buffer_store_dwordx4 v[108:111], v16, s[12:15], s35 offen sc1
    s_nop 1
    s_endpgm
L_prep_kernel_g:
    s_sub_u32 s3, s2, 13
    s_load_dwordx2 s[4:5], s[0:1], 8
    s_load_dwordx2 s[6:7], s[0:1], 72
    s_lshr_b32 s24, s3, 4
    s_bfe_u32 s25, s3, 0x20002
    s_and_b32 s26, s3, 3
    s_lshr_b32 s27, s24, 3
    s_and_b32 s28, s24, 7
    v_and_b32 v1, 63, v0
    v_lshrrev_b32 v2, 3, v1
    v_lshrrev_b32 v3, 2, v2
    v_lshlrev_b32 v3, 4, v3
    v_and_b32 v4, 3, v2
    v_add_u32 v3, v3, v4
    s_lshl_b32 s29, s25, 2
    s_lshl_b32 s30, s28, 5
    s_add_u32 s29, s29, s30
    v_add_u32 v3, s29, v3
    v_lshlrev_b32 v3, 9, v3
    v_and_b32 v4, 7, v1
    s_lshr_b32 s30, s20, 1
    s_lshl_b32 s30, s30, 2
    v_xor_b32 v4, s30, v4
    v_lshl_add_u32 v3, v4, 4, v3
    s_lshl_b32 s30, s26, 7
    v_add_u32 v3, s30, v3
    v_xor_b32 v4, 32, v3
    s_waitcnt lgkmcnt(0)
    s_mov_b32 s8, s4
    s_mov_b32 s9, s5
    s_mov_b32 s10, 4063232
    s_mov_b32 s11, 0x00020000
    s_add_u32 s12, s6, 21954560
    s_addc_u32 s13, s7, 0
    s_mov_b32 s14, 16916480
    s_mov_b32 s15, 0x00020000
    s_lshl_b32 s30, s20, 3
    s_add_u32 s30, s30, s27
    s_lshl_b32 s30, s30, 17
    s_mul_i32 s31, s20, 4608
    s_add_u32 m0, s31, 0
    s_add_u32 s32, s30, 0
    buffer_load_dwordx4 v3, s[8:11], s32 offen nt lds
    s_add_u32 m0, s31, 1152
    s_add_u32 s32, s30, 262144
    buffer_load_dwordx4 v3, s[8:11], s32 offen nt lds
    s_add_u32 m0, s31, 2304
    s_add_u32 s32, s30, 524288
    buffer_load_dwordx4 v4, s[8:11], s32 offen nt lds
    s_add_u32 m0, s31, 3456
    s_add_u32 s32, s30, 786432
    buffer_load_dwordx4 v4, s[8:11], s32 offen nt lds
    v_and_b32 v8, 15, v1
    v_or_b32 v9, 1, v8
    s_lshl_b32 s33, s20, 4
    v_add_u32 v9, s33, v9
    v_cvt_f32_u32 v9, v9
    v_mul_f32 v9, 0x3c000000, v9
    v_bfe_u32 v10, v1, 4, 1
    v_lshlrev_b32 v10, 3, v10
    v_cvt_f32_u32 v10, v10
    v_and_b32 v8, 1, v8
    v_cvt_f32_u32 v8, v8
    v_mul_f32 v8, 0x3f400000, v8
    v_fma_f32 v11, v9, v10, v8
    v_fract_f32 v12, v11
    v_add_f32 v11, v11, v9
    v_fract_f32 v13, v11
    v_add_f32 v11, v11, v9
    v_fract_f32 v14, v11
    v_add_f32 v11, v11, v9
    v_fract_f32 v15, v11
    v_add_f32 v11, v11, v9
    v_fract_f32 v16, v11
    v_add_f32 v11, v11, v9
    v_fract_f32 v17, v11
    v_add_f32 v11, v11, v9
    v_fract_f32 v18, v11
    v_add_f32 v11, v11, v9
    v_fract_f32 v19, v11
    v_cos_f32 v12, v12
    v_cos_f32 v13, v13
    v_cos_f32 v14, v14
    v_cos_f32 v15, v15
    v_cos_f32 v16, v16
    v_cos_f32 v17, v17
    v_cos_f32 v18, v18
    v_cos_f32 v19, v19
    s_nop 0
    v_mul_f32 v12, 0x3d000000, v12
    v_mul_f32 v13, 0x3d000000, v13
    v_mul_f32 v14, 0x3d000000, v14
    v_mul_f32 v15, 0x3d000000, v15
    v_mul_f32 v16, 0x3d000000, v16
    v_mul_f32 v17, 0x3d000000, v17
    v_mul_f32 v18, 0x3d000000, v18
    v_mul_f32 v19, 0x3d000000, v19
    v_cvt_pk_bf16_f32 v20, v12, v13
    v_cvt_pk_bf16_f32 v21, v14, v15
    v_cvt_pk_bf16_f32 v22, v16, v17
    v_cvt_pk_bf16_f32 v23, v18, v19
    v_lshlrev_b32 v28, 16, v20
    v_and_b32 v29, 0xffff0000, v20
    v_sub_f32 v28, v12, v28
    v_sub_f32 v29, v13, v29
    v_cvt_pk_bf16_f32 v24, v28, v29
    v_lshlrev_b32 v28, 16, v21
    v_and_b32 v29, 0xffff0000, v21
    v_sub_f32 v28, v14, v28
    v_sub_f32 v29, v15, v29
    v_cvt_pk_bf16_f32 v25, v28, v29
    v_lshlrev_b32 v28, 16, v22
    v_and_b32 v29, 0xffff0000, v22
    v_sub_f32 v28, v16, v28
    v_sub_f32 v29, v17, v29
    v_cvt_pk_bf16_f32 v26, v28, v29
    v_lshlrev_b32 v28, 16, v23
    v_and_b32 v29, 0xffff0000, v23
    v_sub_f32 v28, v18, v28
    v_sub_f32 v29, v19, v29
    v_cvt_pk_bf16_f32 v27, v28, v29
    v_cmp_gt_u32 vcc, 32, v1
    s_nop 1
    v_cndmask_b32 v20, v24, v20, vcc
    v_cndmask_b32 v21, v25, v21, vcc
    v_cndmask_b32 v22, v26, v22, vcc
    v_cndmask_b32 v23, v27, v23, vcc
    v_lshlrev_b32 v28, 4, v1
    s_lshl_b32 s33, s20, 10
    v_add_u32 v29, s33, v28
    ds_write_b128 v29, v[20:23] offset:18432
    v_bfe_u32 v30, v1, 2, 2
    v_bfe_u32 v31, v1, 4, 1
    v_lshl_add_u32 v32, v31, 3, v30
    v_mul_u32_u24 v32, 1152, v32
    v_lshrrev_b32 v30, 1, v30
    v_lshl_add_u32 v30, v31, 1, v30
    v_lshlrev_b32 v30, 1, v30
    v_bfe_u32 v31, v1, 1, 1
    s_lshl_b32 s33, s20, 1
    v_add_u32 v31, s33, v31
    v_xor_b32 v30, v30, v31
    v_lshl_add_u32 v32, v30, 4, v32
    v_and_b32 v30, 1, v1
    v_lshl_add_u32 v32, v30, 3, v32
    v_lshrrev_b32 v30, 4, v1
    s_mov_b32 s33, 1057280
    v_mul_lo_u32 v30, v30, s33
    v_and_b32 v31, 15, v1
    v_lshl_add_u32 v33, v31, 4, v30
    s_lshl_b32 s34, s24, 15
    s_lshl_b32 s35, s26, 2
    s_add_u32 s35, s35, s20
    s_lshl_b32 s35, s35, 11
    s_add_u32 s34, s34, s35
    s_lshl_b32 s35, s25, 8
    s_add_u32 s34, s34, s35
    s_waitcnt vmcnt(0) lgkmcnt(0)
    s_barrier
    ds_read_b128 v[36:39], v28 offset:18432
    ds_read_b128 v[40:43], v28 offset:19456
    ds_read_b128 v[44:47], v28 offset:20480
    ds_read_b128 v[48:51], v28 offset:21504
    ds_read_b64_tr_b16 v[52:53], v32 offset:0
    ds_read_b64_tr_b16 v[54:55], v32 offset:4608
    ds_read_b64_tr_b16 v[56:57], v32 offset:128
    ds_read_b64_tr_b16 v[58:59], v32 offset:4736
    ds_read_b64_tr_b16 v[60:61], v32 offset:256
    ds_read_b64_tr_b16 v[62:63], v32 offset:4864
    ds_read_b64_tr_b16 v[64:65], v32 offset:384
    ds_read_b64_tr_b16 v[66:67], v32 offset:4992
    ds_read_b64_tr_b16 v[68:69], v32 offset:512
    ds_read_b64_tr_b16 v[70:71], v32 offset:5120
    s_waitcnt lgkmcnt(8)
    ds_read_b64_tr_b16 v[72:73], v32 offset:640
    ds_read_b64_tr_b16 v[74:75], v32 offset:5248
    ds_read_b64_tr_b16 v[76:77], v32 offset:768
    ds_read_b64_tr_b16 v[78:79], v32 offset:5376
    ds_read_b64_tr_b16 v[80:81], v32 offset:896
    ds_read_b64_tr_b16 v[82:83], v32 offset:5504
    s_waitcnt lgkmcnt(0)
    v_mfma_f32_16x16x32_bf16 v[84:87], v[36:39], v[52:55], 0
    v_mfma_f32_16x16x32_bf16 v[88:91], v[36:39], v[56:59], 0
    v_mfma_f32_16x16x32_bf16 v[92:95], v[36:39], v[60:63], 0
    v_mfma_f32_16x16x32_bf16 v[96:99], v[36:39], v[64:67], 0
    v_mfma_f32_16x16x32_bf16 v[100:103], v[36:39], v[68:71], 0
    v_mfma_f32_16x16x32_bf16 v[104:107], v[36:39], v[72:75], 0
    v_mfma_f32_16x16x32_bf16 v[108:111], v[36:39], v[76:79], 0
    v_mfma_f32_16x16x32_bf16 v[112:115], v[36:39], v[80:83], 0
    s_nop 7
    v_cvt_pk_bf16_f32 v116, v84, v88
    v_cvt_pk_bf16_f32 v117, v92, v96
    v_cvt_pk_bf16_f32 v118, v100, v104
    v_cvt_pk_bf16_f32 v119, v108, v112
    s_add_u32 s35, s34, 0
    buffer_store_dwordx4 v[116:119], v33, s[12:15], s35 offen sc1
    s_nop 1
    v_cvt_pk_bf16_f32 v120, v85, v89
    v_cvt_pk_bf16_f32 v121, v93, v97
    v_cvt_pk_bf16_f32 v122, v101, v105
    v_cvt_pk_bf16_f32 v123, v109, v113
    s_add_u32 s35, s34, 1024
    buffer_store_dwordx4 v[120:123], v33, s[12:15], s35 offen sc1
    s_nop 1
    v_cvt_pk_bf16_f32 v116, v86, v90
    v_cvt_pk_bf16_f32 v117, v94, v98
    v_cvt_pk_bf16_f32 v118, v102, v106
    v_cvt_pk_bf16_f32 v119, v110, v114
    s_add_u32 s35, s34, 528640
    buffer_store_dwordx4 v[116:119], v33, s[12:15], s35 offen sc1
    s_nop 1
    v_cvt_pk_bf16_f32 v120, v87, v91
    v_cvt_pk_bf16_f32 v121, v95, v99
    v_cvt_pk_bf16_f32 v122, v103, v107
    v_cvt_pk_bf16_f32 v123, v111, v115
    s_add_u32 s35, s34, 529664
    buffer_store_dwordx4 v[120:123], v33, s[12:15], s35 offen sc1
    s_nop 1
    v_mfma_f32_16x16x32_bf16 v[84:87], v[40:43], v[52:55], 0
    v_mfma_f32_16x16x32_bf16 v[88:91], v[40:43], v[56:59], 0
    v_mfma_f32_16x16x32_bf16 v[92:95], v[40:43], v[60:63], 0
    v_mfma_f32_16x16x32_bf16 v[96:99], v[40:43], v[64:67], 0
    v_mfma_f32_16x16x32_bf16 v[100:103], v[40:43], v[68:71], 0
    v_mfma_f32_16x16x32_bf16 v[104:107], v[40:43], v[72:75], 0
    v_mfma_f32_16x16x32_bf16 v[108:111], v[40:43], v[76:79], 0
    v_mfma_f32_16x16x32_bf16 v[112:115], v[40:43], v[80:83], 0
    s_nop 7
    v_cvt_pk_bf16_f32 v116, v84, v88
    v_cvt_pk_bf16_f32 v117, v92, v96
    v_cvt_pk_bf16_f32 v118, v100, v104
    v_cvt_pk_bf16_f32 v119, v108, v112
    s_add_u32 s35, s34, 4229120
    buffer_store_dwordx4 v[116:119], v33, s[12:15], s35 offen sc1
    s_nop 1
    v_cvt_pk_bf16_f32 v120, v85, v89
    v_cvt_pk_bf16_f32 v121, v93, v97
    v_cvt_pk_bf16_f32 v122, v101, v105
    v_cvt_pk_bf16_f32 v123, v109, v113
    s_add_u32 s35, s34, 4230144
    buffer_store_dwordx4 v[120:123], v33, s[12:15], s35 offen sc1
    s_nop 1
    v_cvt_pk_bf16_f32 v116, v86, v90
    v_cvt_pk_bf16_f32 v117, v94, v98
    v_cvt_pk_bf16_f32 v118, v102, v106
    v_cvt_pk_bf16_f32 v119, v110, v114
    s_add_u32 s35, s34, 4757760
    buffer_store_dwordx4 v[116:119], v33, s[12:15], s35 offen sc1
    s_nop 1
    v_cvt_pk_bf16_f32 v120, v87, v91
    v_cvt_pk_bf16_f32 v121, v95, v99
    v_cvt_pk_bf16_f32 v122, v103, v107
    v_cvt_pk_bf16_f32 v123, v111, v115
    s_add_u32 s35, s34, 4758784
    buffer_store_dwordx4 v[120:123], v33, s[12:15], s35 offen sc1
    s_nop 1
    v_mfma_f32_16x16x32_bf16 v[84:87], v[44:47], v[52:55], 0
    v_mfma_f32_16x16x32_bf16 v[88:91], v[44:47], v[56:59], 0
    v_mfma_f32_16x16x32_bf16 v[92:95], v[44:47], v[60:63], 0
    v_mfma_f32_16x16x32_bf16 v[96:99], v[44:47], v[64:67], 0
    v_mfma_f32_16x16x32_bf16 v[100:103], v[44:47], v[68:71], 0
    v_mfma_f32_16x16x32_bf16 v[104:107], v[44:47], v[72:75], 0
    v_mfma_f32_16x16x32_bf16 v[108:111], v[44:47], v[76:79], 0
    v_mfma_f32_16x16x32_bf16 v[112:115], v[44:47], v[80:83], 0
    s_nop 7
    v_cvt_pk_bf16_f32 v116, v84, v88
    v_cvt_pk_bf16_f32 v117, v92, v96
    v_cvt_pk_bf16_f32 v118, v100, v104
    v_cvt_pk_bf16_f32 v119, v108, v112
    s_add_u32 s35, s34, 8458240
    buffer_store_dwordx4 v[116:119], v33, s[12:15], s35 offen sc1
    s_nop 1
    v_cvt_pk_bf16_f32 v120, v85, v89
    v_cvt_pk_bf16_f32 v121, v93, v97
    v_cvt_pk_bf16_f32 v122, v101, v105
    v_cvt_pk_bf16_f32 v123, v109, v113
    s_add_u32 s35, s34, 8459264
    buffer_store_dwordx4 v[120:123], v33, s[12:15], s35 offen sc1
    s_nop 1
    v_cvt_pk_bf16_f32 v116, v86, v90
    v_cvt_pk_bf16_f32 v117, v94, v98
    v_cvt_pk_bf16_f32 v118, v102, v106
    v_cvt_pk_bf16_f32 v119, v110, v114
    s_add_u32 s35, s34, 8986880
    buffer_store_dwordx4 v[116:119], v33, s[12:15], s35 offen sc1
    s_nop 1
    v_cvt_pk_bf16_f32 v120, v87, v91
    v_cvt_pk_bf16_f32 v121, v95, v99
    v_cvt_pk_bf16_f32 v122, v103, v107
    v_cvt_pk_bf16_f32 v123, v111, v115
    s_add_u32 s35, s34, 8987904
    buffer_store_dwordx4 v[120:123], v33, s[12:15], s35 offen sc1
    s_nop 1
    v_mfma_f32_16x16x32_bf16 v[84:87], v[48:51], v[52:55], 0
    v_mfma_f32_16x16x32_bf16 v[88:91], v[48:51], v[56:59], 0
    v_mfma_f32_16x16x32_bf16 v[92:95], v[48:51], v[60:63], 0
    v_mfma_f32_16x16x32_bf16 v[96:99], v[48:51], v[64:67], 0
    v_mfma_f32_16x16x32_bf16 v[100:103], v[48:51], v[68:71], 0
    v_mfma_f32_16x16x32_bf16 v[104:107], v[48:51], v[72:75], 0
    v_mfma_f32_16x16x32_bf16 v[108:111], v[48:51], v[76:79], 0
    v_mfma_f32_16x16x32_bf16 v[112:115], v[48:51], v[80:83], 0
    s_nop 7
    v_cvt_pk_bf16_f32 v116, v84, v88
    v_cvt_pk_bf16_f32 v117, v92, v96
    v_cvt_pk_bf16_f32 v118, v100, v104
    v_cvt_pk_bf16_f32 v119, v108, v112
    s_add_u32 s35, s34, 12687360
    buffer_store_dwordx4 v[116:119], v33, s[12:15], s35 offen sc1
    s_nop 1
    v_cvt_pk_bf16_f32 v120, v85, v89
    v_cvt_pk_bf16_f32 v121, v93, v97
    v_cvt_pk_bf16_f32 v122, v101, v105
    v_cvt_pk_bf16_f32 v123, v109, v113
    s_add_u32 s35, s34, 12688384
    buffer_store_dwordx4 v[120:123], v33, s[12:15], s35 offen sc1
    s_nop 1
    v_cvt_pk_bf16_f32 v116, v86, v90
    v_cvt_pk_bf16_f32 v117, v94, v98
    v_cvt_pk_bf16_f32 v118, v102, v106
    v_cvt_pk_bf16_f32 v119, v110, v114
    s_add_u32 s35, s34, 13216000
    buffer_store_dwordx4 v[116:119], v33, s[12:15], s35 offen sc1
    s_nop 1
    v_cvt_pk_bf16_f32 v120, v87, v91
    v_cvt_pk_bf16_f32 v121, v95, v99
    v_cvt_pk_bf16_f32 v122, v103, v107
    v_cvt_pk_bf16_f32 v123, v111, v115
    s_add_u32 s35, s34, 13217024
    buffer_store_dwordx4 v[120:123], v33, s[12:15], s35 offen sc1
    s_nop 1
    s_endpgm
L_prep_kernel_slab:
    s_load_dwordx2 s[6:7], s[0:1], 72
    s_cmp_eq_u32 s2, 12
    s_cbranch_scc1 L_prep_kernel_tab
    s_lshr_b32 s24, s2, 2
    s_and_b32 s26, s2, 3
    s_mov_b32 s25, 40
    s_cmp_eq_u32 s24, 1
    s_cselect_b32 s25, 32, s25
    s_cmp_eq_u32 s24, 2
    s_cselect_b32 s25, 48, s25
    s_load_dwordx2 s[4:5], s[0:1], s25
    s_load_dwordx2 s[28:29], s[0:1], 24
    v_and_b32 v1, 63, v0
    v_lshrrev_b32 v2, 3, v1
    s_lshl_b32 s27, s20, 6
    v_add_u32 v2, s27, v2
    v_lshlrev_b32 v2, 9, v2
    v_and_b32 v3, 7, v1
    v_lshl_add_u32 v2, v3, 4, v2
    s_lshl_b32 s27, s26, 7
    v_add_u32 v2, s27, v2
    s_waitcnt lgkmcnt(0)
    s_mov_b32 s8, s4
    s_mov_b32 s9, s5
    s_mov_b32 s10, 131072
    s_mov_b32 s11, 0x00020000
    s_add_u32 s12, s6, 85499904
    s_addc_u32 s13, s7, 0
    s_mov_b32 s14, 294912
    s_mov_b32 s15, 0x00020000
    s_lshl_b32 s31, s20, 13
    s_add_u32 m0, s31, 0
    s_mov_b32 s32, 0
    buffer_load_dwordx4 v2, s[8:11], s32 offen nt lds
    s_add_u32 m0, s31, 1024
    s_mov_b32 s32, 4096
    buffer_load_dwordx4 v2, s[8:11], s32 offen nt lds
    s_add_u32 m0, s31, 2048
    s_mov_b32 s32, 8192
    buffer_load_dwordx4 v2, s[8:11], s32 offen nt lds
    s_add_u32 m0, s31, 3072
    s_mov_b32 s32, 12288
    buffer_load_dwordx4 v2, s[8:11], s32 offen nt lds
    s_add_u32 m0, s31, 4096
    s_mov_b32 s32, 16384
    buffer_load_dwordx4 v2, s[8:11], s32 offen nt lds
    s_add_u32 m0, s31, 5120
    s_mov_b32 s32, 20480
    buffer_load_dwordx4 v2, s[8:11], s32 offen nt lds
    s_add_u32 m0, s31, 6144
    s_mov_b32 s32, 24576
    buffer_load_dwordx4 v2, s[8:11], s32 offen nt lds
    s_add_u32 m0, s31, 7168
    s_mov_b32 s32, 28672
    buffer_load_dwordx4 v2, s[8:11], s32 offen nt lds
    s_cmp_eq_u32 s24, 0
    s_cbranch_scc1 L_prep_kernel_ge
    v_bfe_u32 v4, v1, 2, 2
    v_lshrrev_b32 v5, 5, v1
    v_bfe_u32 v6, v1, 4, 1
    v_and_b32 v7, 3, v1
    s_cmp_eq_u32 s24, 1
    s_cbranch_scc0 L_prep_kernel_wo
    v_lshl_add_u32 v8, v5, 4, v4
    v_lshlrev_b32 v8, 7, v8
    v_lshl_add_u32 v8, v6, 5, v8
    v_lshl_add_u32 v8, v7, 3, v8
    s_lshl_b32 s33, s20, 13
    v_add_u32 v8, s33, v8
    s_mov_b32 s34, 32768
    s_lshl_b32 s35, s26, 15
    s_add_u32 s34, s34, s35
    s_lshl_b32 s35, s20, 12
    s_add_u32 s34, s34, s35
    v_lshlrev_b32 v9, 4, v1
    s_waitcnt vmcnt(0)
    s_barrier
    ds_read_b64_tr_b16 v[16:17], v8 offset:0
    ds_read_b64_tr_b16 v[18:19], v8 offset:1024
    ds_read_b64_tr_b16 v[20:21], v8 offset:512
    ds_read_b64_tr_b16 v[22:23], v8 offset:1536
    ds_read_b64_tr_b16 v[24:25], v8 offset:4096
    ds_read_b64_tr_b16 v[26:27], v8 offset:5120
    ds_read_b64_tr_b16 v[28:29], v8 offset:4608
    ds_read_b64_tr_b16 v[30:31], v8 offset:5632
    s_waitcnt lgkmcnt(0)
    s_add_u32 s35, s34, 0
    buffer_store_dwordx4 v[16:19], v9, s[12:15], s35 offen sc1
    s_add_u32 s35, s34, 1024
    buffer_store_dwordx4 v[20:23], v9, s[12:15], s35 offen sc1
    s_add_u32 s35, s34, 2048
    buffer_store_dwordx4 v[24:27], v9, s[12:15], s35 offen sc1
    s_add_u32 s35, s34, 3072
    buffer_store_dwordx4 v[28:31], v9, s[12:15], s35 offen sc1
    ds_read_b64_tr_b16 v[32:33], v8 offset:64
    ds_read_b64_tr_b16 v[34:35], v8 offset:1088
    ds_read_b64_tr_b16 v[36:37], v8 offset:576
    ds_read_b64_tr_b16 v[38:39], v8 offset:1600
    ds_read_b64_tr_b16 v[40:41], v8 offset:4160
    ds_read_b64_tr_b16 v[42:43], v8 offset:5184
    ds_read_b64_tr_b16 v[44:45], v8 offset:4672
    ds_read_b64_tr_b16 v[46:47], v8 offset:5696
    s_waitcnt lgkmcnt(0)
    s_add_u32 s35, s34, 16384
    buffer_store_dwordx4 v[32:35], v9, s[12:15], s35 offen sc1
    s_add_u32 s35, s34, 17408
    buffer_store_dwordx4 v[36:39], v9, s[12:15], s35 offen sc1
    s_add_u32 s35, s34, 18432
    buffer_store_dwordx4 v[40:43], v9, s[12:15], s35 offen sc1
    s_add_u32 s35, s34, 19456
    buffer_store_dwordx4 v[44:47], v9, s[12:15], s35 offen sc1
    s_endpgm
L_prep_kernel_wo:
    v_lshl_add_u32 v8, v5, 2, v4
    v_lshlrev_b32 v8, 7, v8
    v_lshl_add_u32 v8, v6, 5, v8
    v_and_b32 v10, 1, v7
    v_lshl_add_u32 v8, v10, 4, v8
    v_lshrrev_b32 v10, 1, v7
    v_lshl_add_u32 v8, v10, 3, v8
    s_lshl_b32 s33, s20, 13
    v_add_u32 v8, s33, v8
    s_mov_b32 s34, 163840
    s_lshl_b32 s35, s26, 15
    s_add_u32 s34, s34, s35
    s_lshl_b32 s35, s20, 12
    s_add_u32 s34, s34, s35
    v_lshlrev_b32 v9, 4, v1
    s_waitcnt vmcnt(0)
    s_barrier
    ds_read_b64_tr_b16 v[16:17], v8 offset:0
    ds_read_b64_tr_b16 v[18:19], v8 offset:1024
    ds_read_b64_tr_b16 v[20:21], v8 offset:2048
    ds_read_b64_tr_b16 v[22:23], v8 offset:3072
    ds_read_b64_tr_b16 v[24:25], v8 offset:4096
    ds_read_b64_tr_b16 v[26:27], v8 offset:5120
    ds_read_b64_tr_b16 v[28:29], v8 offset:6144
    ds_read_b64_tr_b16 v[30:31], v8 offset:7168
    s_waitcnt lgkmcnt(0)
    v_mov_b32 v48, 0x3f803f80
    v_mov_b32 v49, 0x3f803f80
    v_mov_b32 v50, 0x3f803f80
    v_mov_b32 v51, 0x3f803f80
    s_nop 1
    v_mfma_f32_32x32x16_bf16 v[64:79], v[16:19], v[48:51], 0
    v_mfma_f32_32x32x16_bf16 v[64:79], v[20:23], v[48:51], v[64:79]
    v_mfma_f32_32x32x16_bf16 v[64:79], v[24:27], v[48:51], v[64:79]
    v_mfma_f32_32x32x16_bf16 v[64:79], v[28:31], v[48:51], v[64:79]
    v_lshlrev_b32 v52, 16, v16
    v_and_b32 v53, 0xffff0000, v16
    v_mul_f32 v52, -2.0, v52
    v_mul_f32 v53, -2.0, v53
    v_cvt_pk_bf16_f32 v16, v52, v53
    v_lshlrev_b32 v52, 16, v17
    v_and_b32 v53, 0xffff0000, v17
    v_mul_f32 v52, -2.0, v52
    v_mul_f32 v53, -2.0, v53
    v_cvt_pk_bf16_f32 v17, v52, v53
    v_lshlrev_b32 v52, 16, v18
    v_and_b32 v53, 0xffff0000, v18
    v_mul_f32 v52, -2.0, v52
    v_mul_f32 v53, -2.0, v53
    v_cvt_pk_bf16_f32 v18, v52, v53
    v_lshlrev_b32 v52, 16, v19
    v_and_b32 v53, 0xffff0000, v19
    v_mul_f32 v52, -2.0, v52
    v_mul_f32 v53, -2.0, v53
    v_cvt_pk_bf16_f32 v19, v52, v53
    v_lshlrev_b32 v52, 16, v20
    v_and_b32 v53, 0xffff0000, v20
    v_mul_f32 v52, -2.0, v52
    v_mul_f32 v53, -2.0, v53
    v_cvt_pk_bf16_f32 v20, v52, v53
    v_lshlrev_b32 v52, 16, v21
    v_and_b32 v53, 0xffff0000, v21
    v_mul_f32 v52, -2.0, v52
    v_mul_f32 v53, -2.0, v53
    v_cvt_pk_bf16_f32 v21, v52, v53
    v_lshlrev_b32 v52, 16, v22
    v_and_b32 v53, 0xffff0000, v22
    v_mul_f32 v52, -2.0, v52
    v_mul_f32 v53, -2.0, v53
    v_cvt_pk_bf16_f32 v22, v52, v53
    v_lshlrev_b32 v52, 16, v23
    v_and_b32 v53, 0xffff0000, v23
    v_mul_f32 v52, -2.0, v52
    v_mul_f32 v53, -2.0, v53
    v_cvt_pk_bf16_f32 v23, v52, v53
    v_lshlrev_b32 v52, 16, v24
    v_and_b32 v53, 0xffff0000, v24
    v_mul_f32 v52, -2.0, v52
    v_mul_f32 v53, -2.0, v53
    v_cvt_pk_bf16_f32 v24, v52, v53
    v_lshlrev_b32 v52, 16, v25
    v_and_b32 v53, 0xffff0000, v25
    v_mul_f32 v52, -2.0, v52
    v_mul_f32 v53, -2.0, v53
    v_cvt_pk_bf16_f32 v25, v52, v53
    v_lshlrev_b32 v52, 16, v26
    v_and_b32 v53, 0xffff0000, v26
    v_mul_f32 v52, -2.0, v52
    v_mul_f32 v53, -2.0, v53
    v_cvt_pk_bf16_f32 v26, v52, v53
    v_lshlrev_b32 v52, 16, v27
    v_and_b32 v53, 0xffff0000, v27
    v_mul_f32 v52, -2.0, v52
    v_mul_f32 v53, -2.0, v53
    v_cvt_pk_bf16_f32 v27, v52, v53
    v_lshlrev_b32 v52, 16, v28
    v_and_b32 v53, 0xffff0000, v28
    v_mul_f32 v52, -2.0, v52
    v_mul_f32 v53, -2.0, v53
    v_cvt_pk_bf16_f32 v28, v52, v53
    v_lshlrev_b32 v52, 16, v29
    v_and_b32 v53, 0xffff0000, v29
    v_mul_f32 v52, -2.0, v52
    v_mul_f32 v53, -2.0, v53
    v_cvt_pk_bf16_f32 v29, v52, v53
    v_lshlrev_b32 v52, 16, v30
    v_and_b32 v53, 0xffff0000, v30
    v_mul_f32 v52, -2.0, v52
    v_mul_f32 v53, -2.0, v53
    v_cvt_pk_bf16_f32 v30, v52, v53
    v_lshlrev_b32 v52, 16, v31
    v_and_b32 v53, 0xffff0000, v31
    v_mul_f32 v52, -2.0, v52
    v_mul_f32 v53, -2.0, v53
    v_cvt_pk_bf16_f32 v31, v52, v53
    s_add_u32 s35, s34, 0
    buffer_store_dwordx4 v[16:19], v9, s[12:15], s35 offen sc1
    s_add_u32 s35, s34, 1024
    buffer_store_dwordx4 v[20:23], v9, s[12:15], s35 offen sc1
    s_add_u32 s35, s34, 2048
    buffer_store_dwordx4 v[24:27], v9, s[12:15], s35 offen sc1
    s_add_u32 s35, s34, 3072
    buffer_store_dwordx4 v[28:31], v9, s[12:15], s35 offen sc1
    ds_read_b64_tr_b16 v[32:33], v8 offset:64
    ds_read_b64_tr_b16 v[34:35], v8 offset:1088
    ds_read_b64_tr_b16 v[36:37], v8 offset:2112
    ds_read_b64_tr_b16 v[38:39], v8 offset:3136
    ds_read_b64_tr_b16 v[40:41], v8 offset:4160
    ds_read_b64_tr_b16 v[42:43], v8 offset:5184
    ds_read_b64_tr_b16 v[44:45], v8 offset:6208
    ds_read_b64_tr_b16 v[46:47], v8 offset:7232
    s_waitcnt lgkmcnt(0)
    v_mfma_f32_32x32x16_bf16 v[80:95], v[32:35], v[48:51], 0
    v_mfma_f32_32x32x16_bf16 v[80:95], v[36:39], v[48:51], v[80:95]
    v_mfma_f32_32x32x16_bf16 v[80:95], v[40:43], v[48:51], v[80:95]
    v_mfma_f32_32x32x16_bf16 v[80:95], v[44:47], v[48:51], v[80:95]
    v_lshlrev_b32 v52, 16, v32
    v_and_b32 v53, 0xffff0000, v32
    v_mul_f32 v52, -2.0, v52
    v_mul_f32 v53, -2.0, v53
    v_cvt_pk_bf16_f32 v32, v52, v53
    v_lshlrev_b32 v52, 16, v33
    v_and_b32 v53, 0xffff0000, v33
    v_mul_f32 v52, -2.0, v52
    v_mul_f32 v53, -2.0, v53
    v_cvt_pk_bf16_f32 v33, v52, v53
    v_lshlrev_b32 v52, 16, v34
    v_and_b32 v53, 0xffff0000, v34
    v_mul_f32 v52, -2.0, v52
    v_mul_f32 v53, -2.0, v53
    v_cvt_pk_bf16_f32 v34, v52, v53
    v_lshlrev_b32 v52, 16, v35
    v_and_b32 v53, 0xffff0000, v35
    v_mul_f32 v52, -2.0, v52
    v_mul_f32 v53, -2.0, v53
    v_cvt_pk_bf16_f32 v35, v52, v53
    v_lshlrev_b32 v52, 16, v36
    v_and_b32 v53, 0xffff0000, v36
    v_mul_f32 v52, -2.0, v52
    v_mul_f32 v53, -2.0, v53
    v_cvt_pk_bf16_f32 v36, v52, v53
    v_lshlrev_b32 v52, 16, v37
    v_and_b32 v53, 0xffff0000, v37
    v_mul_f32 v52, -2.0, v52
    v_mul_f32 v53, -2.0, v53
    v_cvt_pk_bf16_f32 v37, v52, v53
    v_lshlrev_b32 v52, 16, v38
    v_and_b32 v53, 0xffff0000, v38
    v_mul_f32 v52, -2.0, v52
    v_mul_f32 v53, -2.0, v53
    v_cvt_pk_bf16_f32 v38, v52, v53
    v_lshlrev_b32 v52, 16, v39
    v_and_b32 v53, 0xffff0000, v39
    v_mul_f32 v52, -2.0, v52
    v_mul_f32 v53, -2.0, v53
    v_cvt_pk_bf16_f32 v39, v52, v53
    v_lshlrev_b32 v52, 16, v40
    v_and_b32 v53, 0xffff0000, v40
    v_mul_f32 v52, -2.0, v52
    v_mul_f32 v53, -2.0, v53
    v_cvt_pk_bf16_f32 v40, v52, v53
    v_lshlrev_b32 v52, 16, v41
    v_and_b32 v53, 0xffff0000, v41
    v_mul_f32 v52, -2.0, v52
    v_mul_f32 v53, -2.0, v53
    v_cvt_pk_bf16_f32 v41, v52, v53
    v_lshlrev_b32 v52, 16, v42
    v_and_b32 v53, 0xffff0000, v42
    v_mul_f32 v52, -2.0, v52
    v_mul_f32 v53, -2.0, v53
    v_cvt_pk_bf16_f32 v42, v52, v53
    v_lshlrev_b32 v52, 16, v43
    v_and_b32 v53, 0xffff0000, v43
    v_mul_f32 v52, -2.0, v52
    v_mul_f32 v53, -2.0, v53
    v_cvt_pk_bf16_f32 v43, v52, v53
    v_lshlrev_b32 v52, 16, v44
    v_and_b32 v53, 0xffff0000, v44
    v_mul_f32 v52, -2.0, v52
    v_mul_f32 v53, -2.0, v53
    v_cvt_pk_bf16_f32 v44, v52, v53
    v_lshlrev_b32 v52, 16, v45
    v_and_b32 v53, 0xffff0000, v45
    v_mul_f32 v52, -2.0, v52
    v_mul_f32 v53, -2.0, v53
    v_cvt_pk_bf16_f32 v45, v52, v53
    v_lshlrev_b32 v52, 16, v46
    v_and_b32 v53, 0xffff0000, v46
    v_mul_f32 v52, -2.0, v52
    v_mul_f32 v53, -2.0, v53
    v_cvt_pk_bf16_f32 v46, v52, v53
    v_lshlrev_b32 v52, 16, v47
    v_and_b32 v53, 0xffff0000, v47
    v_mul_f32 v52, -2.0, v52
    v_mul_f32 v53, -2.0, v53
    v_cvt_pk_bf16_f32 v47, v52, v53
    s_add_u32 s35, s34, 16384
    buffer_store_dwordx4 v[32:35], v9, s[12:15], s35 offen sc1
    s_add_u32 s35, s34, 17408
    buffer_store_dwordx4 v[36:39], v9, s[12:15], s35 offen sc1
    s_add_u32 s35, s34, 18432
    buffer_store_dwordx4 v[40:43], v9, s[12:15], s35 offen sc1
    s_add_u32 s35, s34, 19456
    buffer_store_dwordx4 v[44:47], v9, s[12:15], s35 offen sc1
    s_nop 7
    s_barrier
    v_lshlrev_b32 v10, 6, v1
    s_lshl_b32 s35, s20, 13
    v_add_u32 v11, s35, v10
    ds_write_b128 v11, v[64:67] offset:0
    ds_write_b128 v11, v[68:71] offset:16
    ds_write_b128 v11, v[72:75] offset:32
    ds_write_b128 v11, v[76:79] offset:48
    ds_write_b128 v11, v[80:83] offset:4096
    ds_write_b128 v11, v[84:87] offset:4112
    ds_write_b128 v11, v[88:91] offset:4128
    ds_write_b128 v11, v[92:95] offset:4144
    s_waitcnt lgkmcnt(0)
    s_barrier
    s_cmp_ge_u32 s20, 2
    s_cbranch_scc1 L_prep_kernel_done
    s_lshl_b32 s35, s20, 12
    v_add_u32 v11, s35, v10
    ds_read_b128 v[16:19], v11 offset:0
    ds_read_b128 v[20:23], v11 offset:16
    ds_read_b128 v[24:27], v11 offset:32
    ds_read_b128 v[28:31], v11 offset:48
    ds_read_b128 v[32:35], v11 offset:8192
    ds_read_b128 v[36:39], v11 offset:8208
    ds_read_b128 v[40:43], v11 offset:8224
    ds_read_b128 v[44:47], v11 offset:8240
    s_waitcnt lgkmcnt(0)
    ds_read_b128 v[48:51], v11 offset:16384
    ds_read_b128 v[52:55], v11 offset:16400
    ds_read_b128 v[56:59], v11 offset:16416
    ds_read_b128 v[60:63], v11 offset:16432
    ds_read_b128 v[64:67], v11 offset:24576
    ds_read_b128 v[68:71], v11 offset:24592
    ds_read_b128 v[72:75], v11 offset:24608
    ds_read_b128 v[76:79], v11 offset:24624
    s_waitcnt lgkmcnt(0)
    v_add_f32 v16, v16, v32
    v_add_f32 v48, v48, v64
    v_add_f32 v17, v17, v33
    v_add_f32 v49, v49, v65
    v_add_f32 v18, v18, v34
    v_add_f32 v50, v50, v66
    v_add_f32 v19, v19, v35
    v_add_f32 v51, v51, v67
    v_add_f32 v20, v20, v36
    v_add_f32 v52, v52, v68
    v_add_f32 v21, v21, v37
    v_add_f32 v53, v53, v69
    v_add_f32 v22, v22, v38
    v_add_f32 v54, v54, v70
    v_add_f32 v23, v23, v39
    v_add_f32 v55, v55, v71
    v_add_f32 v24, v24, v40
    v_add_f32 v56, v56, v72
    v_add_f32 v25, v25, v41
    v_add_f32 v57, v57, v73
    v_add_f32 v26, v26, v42
    v_add_f32 v58, v58, v74
    v_add_f32 v27, v27, v43
    v_add_f32 v59, v59, v75
    v_add_f32 v28, v28, v44
    v_add_f32 v60, v60, v76
    v_add_f32 v29, v29, v45
    v_add_f32 v61, v61, v77
    v_add_f32 v30, v30, v46
    v_add_f32 v62, v62, v78
    v_add_f32 v31, v31, v47
    v_add_f32 v63, v63, v79
    v_add_f32 v16, v16, v48
    v_add_f32 v17, v17, v49
    v_add_f32 v18, v18, v50
    v_add_f32 v19, v19, v51
    v_add_f32 v20, v20, v52
    v_add_f32 v21, v21, v53
    v_add_f32 v22, v22, v54
    v_add_f32 v23, v23, v55
    v_add_f32 v24, v24, v56
    v_add_f32 v25, v25, v57
    v_add_f32 v26, v26, v58
    v_add_f32 v27, v27, v59
    v_add_f32 v28, v28, v60
    v_add_f32 v29, v29, v61
    v_add_f32 v30, v30, v62
    v_add_f32 v31, v31, v63
    v_and_b32 v10, 31, v1
    v_cmp_eq_u32 vcc, 0, v10
    v_lshrrev_b32 v10, 5, v1
    v_lshlrev_b32 v10, 6, v10
    s_lshl_b32 s35, s26, 8
    s_lshl_b32 s36, s20, 7
    s_add_u32 s35, s35, s36
    s_add_u32 s35, s35, 14336
    s_and_saveexec_b64 s[38:39], vcc
    buffer_store_dwordx4 v[16:19], v10, s[12:15], s35 offen offset:0 sc1
    buffer_store_dwordx4 v[20:23], v10, s[12:15], s35 offen offset:16 sc1
    buffer_store_dwordx4 v[24:27], v10, s[12:15], s35 offen offset:32 sc1
    buffer_store_dwordx4 v[28:31], v10, s[12:15], s35 offen offset:48 sc1
    s_endpgm
L_prep_kernel_ge:
    s_mov_b32 s36, s28
    s_mov_b32 s37, s29
    s_mov_b32 s38, 8192
    s_mov_b32 s39, 0x00020000
    v_and_b32 v4, 15, v1
    v_lshrrev_b32 v5, 4, v1
    v_lshlrev_b32 v6, 9, v4
    v_lshl_add_u32 v6, v5, 4, v6
    buffer_load_dwordx4 v[16:19], v6, s[36:39], 0 offen offset:0
    buffer_load_dwordx4 v[20:23], v6, s[36:39], 0 offen offset:64
    buffer_load_dwordx4 v[24:27], v6, s[36:39], 0 offen offset:128
    buffer_load_dwordx4 v[28:31], v6, s[36:39], 0 offen offset:192
    buffer_load_dwordx4 v[32:35], v6, s[36:39], 0 offen offset:256
    buffer_load_dwordx4 v[36:39], v6, s[36:39], 0 offen offset:320
    buffer_load_dwordx4 v[40:43], v6, s[36:39], 0 offen offset:384
    buffer_load_dwordx4 v[44:47], v6, s[36:39], 0 offen offset:448
    v_bfe_u32 v7, v1, 2, 2
    v_lshl_add_u32 v7, v5, 3, v7
    v_lshlrev_b32 v7, 7, v7
    v_and_b32 v8, 3, v1
    v_lshl_add_u32 v7, v8, 3, v7
    s_lshl_b32 s33, s20, 5
    v_add_u32 v7, s33, v7
    s_waitcnt vmcnt(0)
    s_barrier
    ds_read_b64_tr_b16 v[48:49], v7 offset:0
    ds_read_b64_tr_b16 v[50:51], v7 offset:512
    ds_read_b64_tr_b16 v[52:53], v7 offset:4096
    ds_read_b64_tr_b16 v[54:55], v7 offset:4608
    ds_read_b64_tr_b16 v[56:57], v7 offset:8192
    ds_read_b64_tr_b16 v[58:59], v7 offset:8704
    ds_read_b64_tr_b16 v[60:61], v7 offset:12288
    ds_read_b64_tr_b16 v[62:63], v7 offset:12800
    s_waitcnt lgkmcnt(0)
    ds_read_b64_tr_b16 v[64:65], v7 offset:16384
    ds_read_b64_tr_b16 v[66:67], v7 offset:16896
    ds_read_b64_tr_b16 v[68:69], v7 offset:20480
    ds_read_b64_tr_b16 v[70:71], v7 offset:20992
    ds_read_b64_tr_b16 v[72:73], v7 offset:24576
    ds_read_b64_tr_b16 v[74:75], v7 offset:25088
    ds_read_b64_tr_b16 v[76:77], v7 offset:28672
    ds_read_b64_tr_b16 v[78:79], v7 offset:29184
    s_waitcnt lgkmcnt(0)
    v_mfma_f32_16x16x32_bf16 v[80:83], v[48:51], v[16:19], 0
    v_mfma_f32_16x16x32_bf16 v[80:83], v[52:55], v[20:23], v[80:83]
    v_mfma_f32_16x16x32_bf16 v[80:83], v[56:59], v[24:27], v[80:83]
    v_mfma_f32_16x16x32_bf16 v[80:83], v[60:63], v[28:31], v[80:83]
    v_mfma_f32_16x16x32_bf16 v[80:83], v[64:67], v[32:35], v[80:83]
    v_mfma_f32_16x16x32_bf16 v[80:83], v[68:71], v[36:39], v[80:83]
    v_mfma_f32_16x16x32_bf16 v[80:83], v[72:75], v[40:43], v[80:83]
    v_mfma_f32_16x16x32_bf16 v[80:83], v[76:79], v[44:47], v[80:83]
    s_nop 7
    v_cvt_pk_bf16_f32 v84, v80, v81
    v_cvt_pk_bf16_f32 v85, v82, v83
    s_mov_b32 s33, 0x4038aa3b
    v_lshlrev_b32 v80, 16, v84
    v_and_b32 v81, 0xffff0000, v84
    v_lshlrev_b32 v82, 16, v85
    v_and_b32 v83, 0xffff0000, v85
    v_mul_f32 v80, s33, v80
    v_mul_f32 v81, s33, v81
    v_mul_f32 v82, s33, v82
    v_mul_f32 v83, s33, v83
    v_lshlrev_b32 v6, 10, v4
    v_lshl_add_u32 v6, v5, 4, v6
    s_lshl_b32 s33, s26, 8
    s_lshl_b32 s34, s20, 6
    s_add_u32 s33, s33, s34
    s_add_u32 s33, s33, 16384
    buffer_store_dwordx4 v[80:83], v6, s[12:15], s33 offen sc1
    s_endpgm
L_prep_kernel_tab:
    v_and_b32 v8, 63, v0
    v_lshlrev_b32 v6, 4, v8
    s_waitcnt lgkmcnt(0)
    s_add_u32 s12, s6, 85499904
    s_addc_u32 s13, s7, 0
    s_mov_b32 s14, 294912
    s_mov_b32 s15, 0x00020000
    s_lshl_b32 s32, s20, 4
    s_lshl_b32 s33, s20, 11
    v_and_b32 v9, 15, v8
    v_lshrrev_b32 v10, 4, v8
    v_or_b32 v11, 1, v9
    v_add_u32 v11, s32, v11
    v_cvt_f32_u32 v11, v11
    v_mul_f32 v11, 0x3c000000, v11
    v_lshlrev_b32 v10, 3, v10
    v_add_u32 v10, 0, v10
    v_cvt_f32_u32 v10, v10
    v_and_b32 v9, 1, v9
    v_cvt_f32_u32 v9, v9
    v_mul_f32 v9, 0x3e800000, v9
    v_fma_f32 v12, v11, v10, v9
    v_fract_f32 v13, v12
    v_add_f32 v12, v12, v11
    v_fract_f32 v14, v12
    v_add_f32 v12, v12, v11
    v_fract_f32 v15, v12
    v_add_f32 v12, v12, v11
    v_fract_f32 v16, v12
    v_add_f32 v12, v12, v11
    v_fract_f32 v17, v12
    v_add_f32 v12, v12, v11
    v_fract_f32 v18, v12
    v_add_f32 v12, v12, v11
    v_fract_f32 v19, v12
    v_add_f32 v12, v12, v11
    v_fract_f32 v20, v12
    v_cos_f32 v13, v13
    v_cos_f32 v14, v14
    v_cos_f32 v15, v15
    v_cos_f32 v16, v16
    v_cos_f32 v17, v17
    v_cos_f32 v18, v18
    v_cos_f32 v19, v19
    v_cos_f32 v20, v20
    s_nop 0
    v_cvt_pk_bf16_f32 v24, v13, v14
    v_cvt_pk_bf16_f32 v25, v15, v16
    v_cvt_pk_bf16_f32 v26, v17, v18
    v_cvt_pk_bf16_f32 v27, v19, v20
    s_add_u32 s34, s33, 0
    buffer_store_dwordx4 v[24:27], v6, s[12:15], s34 offen sc1
    v_and_b32 v9, 15, v8
    v_lshrrev_b32 v10, 4, v8
    v_or_b32 v11, 1, v9
    v_add_u32 v11, s32, v11
    v_cvt_f32_u32 v11, v11
    v_mul_f32 v11, 0x3c000000, v11
    v_lshlrev_b32 v10, 3, v10
    v_add_u32 v10, 32, v10
    v_cvt_f32_u32 v10, v10
    v_and_b32 v9, 1, v9
    v_cvt_f32_u32 v9, v9
    v_mul_f32 v9, 0x3e800000, v9
    v_fma_f32 v12, v11, v10, v9
    v_fract_f32 v13, v12
    v_add_f32 v12, v12, v11
    v_fract_f32 v14, v12
    v_add_f32 v12, v12, v11
    v_fract_f32 v15, v12
    v_add_f32 v12, v12, v11
    v_fract_f32 v16, v12
    v_add_f32 v12, v12, v11
    v_fract_f32 v17, v12
    v_add_f32 v12, v12, v11
    v_fract_f32 v18, v12
    v_add_f32 v12, v12, v11
    v_fract_f32 v19, v12
    v_add_f32 v12, v12, v11
    v_fract_f32 v20, v12
    v_cos_f32 v13, v13
    v_cos_f32 v14, v14
    v_cos_f32 v15, v15
    v_cos_f32 v16, v16
    v_cos_f32 v17, v17
    v_cos_f32 v18, v18
    v_cos_f32 v19, v19
    v_cos_f32 v20, v20
    s_nop 0
    v_cvt_pk_bf16_f32 v28, v13, v14
    v_cvt_pk_bf16_f32 v29, v15, v16
    v_cvt_pk_bf16_f32 v30, v17, v18
    v_cvt_pk_bf16_f32 v31, v19, v20
    s_add_u32 s34, s33, 1024
    buffer_store_dwordx4 v[28:31], v6, s[12:15], s34 offen sc1
    s_cmp_ge_u32 s20, 3
    s_cbranch_scc1 L_prep_kernel_done
    v_and_b32 v9, 15, v8
    v_add_u32 v9, s32, v9
    v_cvt_f32_u32 v9, v9
    v_mul_f32 v9, 0x3c000000, v9
    v_lshrrev_b32 v10, 4, v8
    v_lshlrev_b32 v10, 3, v10
    v_add_u32 v11, 1, v10
    v_cvt_f32_u32 v11, v11
    v_mul_f32 v11, v11, v9
    v_fract_f32 v12, v11
    v_add_u32 v11, 1, v10
    v_cvt_f32_u32 v11, v11
    v_mul_f32 v11, v11, v9
    v_add_f32 v11, 0x3e800000, v11
    v_fract_f32 v13, v11
    v_add_u32 v11, 3, v10
    v_cvt_f32_u32 v11, v11
    v_mul_f32 v11, v11, v9
    v_fract_f32 v14, v11
    v_add_u32 v11, 3, v10
    v_cvt_f32_u32 v11, v11
    v_mul_f32 v11, v11, v9
    v_add_f32 v11, 0x3e800000, v11
    v_fract_f32 v15, v11
    v_add_u32 v11, 5, v10
    v_cvt_f32_u32 v11, v11
    v_mul_f32 v11, v11, v9
    v_fract_f32 v16, v11
    v_add_u32 v11, 5, v10
    v_cvt_f32_u32 v11, v11
    v_mul_f32 v11, v11, v9
    v_add_f32 v11, 0x3e800000, v11
    v_fract_f32 v17, v11
    v_add_u32 v11, 7, v10
    v_cvt_f32_u32 v11, v11
    v_mul_f32 v11, v11, v9
    v_fract_f32 v18, v11
    v_add_u32 v11, 7, v10
    v_cvt_f32_u32 v11, v11
    v_mul_f32 v11, v11, v9
    v_add_f32 v11, 0x3e800000, v11
    v_fract_f32 v19, v11
    v_cos_f32 v12, v12
    v_cos_f32 v13, v13
    v_cos_f32 v14, v14
    v_cos_f32 v15, v15
    v_cos_f32 v16, v16
    v_cos_f32 v17, v17
    v_cos_f32 v18, v18
    v_cos_f32 v19, v19
    s_nop 0
    v_cvt_pk_bf16_f32 v24, v12, v13
    v_cvt_pk_bf16_f32 v25, v14, v15
    v_cvt_pk_bf16_f32 v26, v16, v17
    v_cvt_pk_bf16_f32 v27, v18, v19
    s_add_u32 s34, s33, 8192
    buffer_store_dwordx4 v[24:27], v6, s[12:15], s34 offen sc1
    s_nop 1
    v_add_u32 v11, 33, v10
    v_cvt_f32_u32 v11, v11
    v_mul_f32 v11, v11, v9
    v_fract_f32 v12, v11
    v_add_u32 v11, 33, v10
    v_cvt_f32_u32 v11, v11
    v_mul_f32 v11, v11, v9
    v_add_f32 v11, 0x3e800000, v11
    v_fract_f32 v13, v11
    v_add_u32 v11, 35, v10
    v_cvt_f32_u32 v11, v11
    v_mul_f32 v11, v11, v9
    v_fract_f32 v14, v11
    v_add_u32 v11, 35, v10
    v_cvt_f32_u32 v11, v11
    v_mul_f32 v11, v11, v9
    v_add_f32 v11, 0x3e800000, v11
    v_fract_f32 v15, v11
    v_add_u32 v11, 37, v10
    v_cvt_f32_u32 v11, v11
    v_mul_f32 v11, v11, v9
    v_fract_f32 v16, v11
    v_add_u32 v11, 37, v10
    v_cvt_f32_u32 v11, v11
    v_mul_f32 v11, v11, v9
    v_add_f32 v11, 0x3e800000, v11
    v_fract_f32 v17, v11
    v_add_u32 v11, 39, v10
    v_cvt_f32_u32 v11, v11
    v_mul_f32 v11, v11, v9
    v_fract_f32 v18, v11
    v_add_u32 v11, 39, v10
    v_cvt_f32_u32 v11, v11
    v_mul_f32 v11, v11, v9
    v_add_f32 v11, 0x3e800000, v11
    v_fract_f32 v19, v11
    v_cos_f32 v12, v12
    v_cos_f32 v13, v13
    v_cos_f32 v14, v14
    v_cos_f32 v15, v15
    v_cos_f32 v16, v16
    v_cos_f32 v17, v17
    v_cos_f32 v18, v18
    v_cos_f32 v19, v19
    s_nop 0
    v_cvt_pk_bf16_f32 v24, v12, v13
    v_cvt_pk_bf16_f32 v25, v14, v15
    v_cvt_pk_bf16_f32 v26, v16, v17
    v_cvt_pk_bf16_f32 v27, v18, v19
    s_add_u32 s34, s33, 9216
    buffer_store_dwordx4 v[24:27], v6, s[12:15], s34 offen sc1
    s_nop 1
L_prep_kernel_done:
    s_endpgm
.globl gemm1_kernel
.p2align 8
.type gemm1_kernel,@function
gemm1_kernel:
    s_cmp_ge_u32 s2, 256
    s_cbranch_scc1 L_gemm1_kernel_done
    s_load_dwordx2 s[4:5], s[0:1], 72
    s_load_dwordx2 s[6:7], s[0:1], 72
    v_readfirstlane_b32 s20, v0
    s_lshr_b32 s20, s20, 6
    s_and_b32 s24, s2, 7
    s_lshr_b32 s25, s2, 3
    s_lshr_b32 s26, s25, 3
    s_lshl_b32 s24, s24, 2
    s_add_u32 s21, s24, s26
    s_and_b32 s25, s25, 7
    s_lshr_b32 s26, s25, 1
    s_and_b32 s27, s25, 1
    s_mul_i32 s22, s26, 84
    s_sub_u32 s28, 334, s22
    s_min_u32 s28, s28, 84
    s_waitcnt lgkmcnt(0)
    s_mul_i32 s29, s21, 684032
    s_lshl_b32 s30, s22, 11
    s_add_u32 s29, s29, s30
    s_add_u32 s29, s29, 0
    s_add_u32 s8, s6, s29
    s_addc_u32 s9, s7, 0
    s_lshl_b32 s10, s28, 11
    s_mov_b32 s11, 0x00020000
    s_mul_i32 s29, s21, 528640
    s_mul_i32 s30, s27, 16384
    s_add_u32 s29, s29, s30
    s_add_u32 s29, s29, 21954560
    s_add_u32 s12, s4, s29
    s_addc_u32 s13, s5, 0
    s_mov_b32 s14, 507904
    s_mov_b32 s15, 0x00020000
    s_cmp_ge_u32 s20, 4
    s_cbranch_scc1 L_gemm1_kernel_loader
    s_mul_i32 s29, s22, 37120
    s_add_u32 s29, s29, 38871040
    s_add_u32 s16, s4, s29
    s_addc_u32 s17, s5, 0
    s_mul_i32 s18, s28, 37120
    s_mov_b32 s19, 0x00020000
    s_lshr_b32 s29, s20, 1
    s_and_b32 s30, s20, 1
    v_and_b32 v217, 15, v0
    v_bfe_u32 v218, v0, 4, 2
    v_and_b32 v219, 63, v0
    s_mul_i32 s31, s29, 6144
    v_and_b32 v220, 7, v217
    v_xor_b32 v220, v218, v220
    v_lshlrev_b32 v220, 4, v220
    v_lshl_add_u32 v220, v217, 7, v220
    v_add_u32 v220, s31, v220
    v_add_u32 v208, 0, v220
    v_xor_b32 v211, 64, v208
    v_add_u32 v209, 57344, v220
    v_xor_b32 v212, 64, v209
    v_add_u32 v210, 114688, v220
    v_xor_b32 v213, 64, v210
    s_mul_i32 s31, s30, 8192
    s_add_u32 s31, s31, 12288
    v_lshlrev_b32 v220, 4, v219
    v_add_u32 v220, s31, v220
    v_add_u32 v214, 0, v220
    v_add_u32 v215, 57344, v220
    v_add_u32 v216, 114688, v220
    v_and_b32 v224, 7, v217
    v_lshrrev_b32 v225, 3, v217
    v_mul_u32_u24 v222, 37120, v224
    v_lshl_add_u32 v222, v218, 4, v222
    s_mul_i32 s31, s29, 1781760
    v_add_u32 v222, s31, v222
    v_lshl_add_u32 v222, v225, 6, v222
    v_xor_b32 v225, 64, v222
    v_add_u32 v223, 296960, v225
    s_mul_i32 s31, s27, 4
    s_mul_i32 s29, s30, 2
    s_add_u32 s31, s31, s29
    s_lshl_b32 s31, s31, 12
    s_lshl_b32 s29, s21, 7
    s_add_u32 s33, s31, s29
    s_mov_b32 s34, 0x80008000
    s_barrier
    ds_read_b128 v[96:99], v214 offset:0
    ds_read_b128 v[128:131], v208 offset:0
    ds_read_b128 v[136:139], v208 offset:2048
    ds_read_b128 v[144:147], v208 offset:4096
    ds_read_b128 v[104:107], v214 offset:2048
    ds_read_b128 v[112:115], v214 offset:4096
    ds_read_b128 v[120:123], v214 offset:6144
    ds_read_b128 v[132:135], v211 offset:0
    ds_read_b128 v[140:143], v211 offset:2048
    ds_read_b128 v[148:151], v211 offset:4096
    ds_read_b128 v[100:103], v214 offset:1024
    ds_read_b128 v[108:111], v214 offset:3072
    ds_read_b128 v[116:119], v214 offset:5120
    ds_read_b128 v[124:127], v214 offset:7168
    s_waitcnt lgkmcnt(0)
    s_barrier
    v_mfma_f32_16x16x32_bf16 v[0:3], v[96:99], v[128:131], 0
    ds_read_b128 v[152:155], v214 offset:28672
    v_mfma_f32_16x16x32_bf16 v[4:7], v[96:99], v[136:139], 0
    v_mfma_f32_16x16x32_bf16 v[8:11], v[96:99], v[144:147], 0
    ds_read_b128 v[184:187], v208 offset:28672
    v_mfma_f32_16x16x32_bf16 v[12:15], v[104:107], v[128:131], 0
    v_mfma_f32_16x16x32_bf16 v[16:19], v[104:107], v[136:139], 0
    ds_read_b128 v[192:195], v208 offset:30720
    v_mfma_f32_16x16x32_bf16 v[20:23], v[104:107], v[144:147], 0
    v_mfma_f32_16x16x32_bf16 v[24:27], v[112:115], v[128:131], 0
    ds_read_b128 v[200:203], v208 offset:32768
    v_mfma_f32_16x16x32_bf16 v[28:31], v[112:115], v[136:139], 0
    v_mfma_f32_16x16x32_bf16 v[32:35], v[112:115], v[144:147], 0
    ds_read_b128 v[160:163], v214 offset:30720
    v_mfma_f32_16x16x32_bf16 v[36:39], v[120:123], v[128:131], 0
    v_mfma_f32_16x16x32_bf16 v[40:43], v[120:123], v[136:139], 0
    ds_read_b128 v[168:171], v214 offset:32768
    v_mfma_f32_16x16x32_bf16 v[44:47], v[120:123], v[144:147], 0
    v_mfma_f32_16x16x32_bf16 v[48:51], v[96:99], v[132:135], 0
    ds_read_b128 v[176:179], v214 offset:34816
    v_mfma_f32_16x16x32_bf16 v[52:55], v[96:99], v[140:143], 0
    v_mfma_f32_16x16x32_bf16 v[56:59], v[96:99], v[148:151], 0
    ds_read_b128 v[188:191], v211 offset:28672
    v_mfma_f32_16x16x32_bf16 v[60:63], v[104:107], v[132:135], 0
    v_mfma_f32_16x16x32_bf16 v[64:67], v[104:107], v[140:143], 0
    ds_read_b128 v[196:199], v211 offset:30720
    v_mfma_f32_16x16x32_bf16 v[68:71], v[104:107], v[148:151], 0
    v_mfma_f32_16x16x32_bf16 v[72:75], v[112:115], v[132:135], 0
    ds_read_b128 v[204:207], v211 offset:32768
    v_mfma_f32_16x16x32_bf16 v[76:79], v[112:115], v[140:143], 0
    v_mfma_f32_16x16x32_bf16 v[80:83], v[112:115], v[148:151], 0
    ds_read_b128 v[156:159], v214 offset:29696
    v_mfma_f32_16x16x32_bf16 v[84:87], v[120:123], v[132:135], 0
    v_mfma_f32_16x16x32_bf16 v[88:91], v[120:123], v[140:143], 0
    ds_read_b128 v[164:167], v214 offset:31744
    v_mfma_f32_16x16x32_bf16 v[92:95], v[120:123], v[148:151], 0
    v_mfma_f32_16x16x32_bf16 v[48:51], v[100:103], v[128:131], v[48:51]
    ds_read_b128 v[172:175], v214 offset:33792
    v_xor_b32 v132, s34, v132
    v_xor_b32 v133, s34, v133
    v_mfma_f32_16x16x32_bf16 v[52:55], v[100:103], v[136:139], v[52:55]
    v_xor_b32 v134, s34, v134
    v_xor_b32 v135, s34, v135
    v_mfma_f32_16x16x32_bf16 v[56:59], v[100:103], v[144:147], v[56:59]
    ds_read_b128 v[180:183], v214 offset:35840
    v_xor_b32 v140, s34, v140
    v_xor_b32 v141, s34, v141
    v_mfma_f32_16x16x32_bf16 v[60:63], v[108:111], v[128:131], v[60:63]
    v_xor_b32 v142, s34, v142
    v_xor_b32 v143, s34, v143
    v_mfma_f32_16x16x32_bf16 v[64:67], v[108:111], v[136:139], v[64:67]
    v_xor_b32 v148, s34, v148
    v_xor_b32 v149, s34, v149
    v_mfma_f32_16x16x32_bf16 v[68:71], v[108:111], v[144:147], v[68:71]
    v_xor_b32 v150, s34, v150
    v_xor_b32 v151, s34, v151
    v_mfma_f32_16x16x32_bf16 v[72:75], v[116:119], v[128:131], v[72:75]
    v_mfma_f32_16x16x32_bf16 v[76:79], v[116:119], v[136:139], v[76:79]
    v_mfma_f32_16x16x32_bf16 v[80:83], v[116:119], v[144:147], v[80:83]
    v_mfma_f32_16x16x32_bf16 v[84:87], v[124:127], v[128:131], v[84:87]
    v_mfma_f32_16x16x32_bf16 v[88:91], v[124:127], v[136:139], v[88:91]
    v_mfma_f32_16x16x32_bf16 v[92:95], v[124:127], v[144:147], v[92:95]
    v_mfma_f32_16x16x32_bf16 v[0:3], v[100:103], v[132:135], v[0:3]
    v_mfma_f32_16x16x32_bf16 v[4:7], v[100:103], v[140:143], v[4:7]
    v_mfma_f32_16x16x32_bf16 v[8:11], v[100:103], v[148:151], v[8:11]
    v_mfma_f32_16x16x32_bf16 v[12:15], v[108:111], v[132:135], v[12:15]
    v_mfma_f32_16x16x32_bf16 v[16:19], v[108:111], v[140:143], v[16:19]
    s_waitcnt lgkmcnt(0)
    s_barrier
    v_mfma_f32_16x16x32_bf16 v[20:23], v[108:111], v[148:151], v[20:23]
    v_mfma_f32_16x16x32_bf16 v[24:27], v[116:119], v[132:135], v[24:27]
    v_mfma_f32_16x16x32_bf16 v[28:31], v[116:119], v[140:143], v[28:31]
    v_mfma_f32_16x16x32_bf16 v[32:35], v[116:119], v[148:151], v[32:35]
    v_mfma_f32_16x16x32_bf16 v[36:39], v[124:127], v[132:135], v[36:39]
    v_mfma_f32_16x16x32_bf16 v[40:43], v[124:127], v[140:143], v[40:43]
    v_mfma_f32_16x16x32_bf16 v[44:47], v[124:127], v[148:151], v[44:47]
    v_mfma_f32_16x16x32_bf16 v[0:3], v[152:155], v[184:187], v[0:3]
    ds_read_b128 v[96:99], v215 offset:0
    v_mfma_f32_16x16x32_bf16 v[4:7], v[152:155], v[192:195], v[4:7]
    v_mfma_f32_16x16x32_bf16 v[8:11], v[152:155], v[200:203], v[8:11]
    ds_read_b128 v[128:131], v209 offset:0
    v_mfma_f32_16x16x32_bf16 v[12:15], v[160:163], v[184:187], v[12:15]
    v_mfma_f32_16x16x32_bf16 v[16:19], v[160:163], v[192:195], v[16:19]
    ds_read_b128 v[136:139], v209 offset:2048
    v_mfma_f32_16x16x32_bf16 v[20:23], v[160:163], v[200:203], v[20:23]
    v_mfma_f32_16x16x32_bf16 v[24:27], v[168:171], v[184:187], v[24:27]
    ds_read_b128 v[144:147], v209 offset:4096
    v_mfma_f32_16x16x32_bf16 v[28:31], v[168:171], v[192:195], v[28:31]
    v_mfma_f32_16x16x32_bf16 v[32:35], v[168:171], v[200:203], v[32:35]
    ds_read_b128 v[104:107], v215 offset:2048
    v_mfma_f32_16x16x32_bf16 v[36:39], v[176:179], v[184:187], v[36:39]
    v_mfma_f32_16x16x32_bf16 v[40:43], v[176:179], v[192:195], v[40:43]
    ds_read_b128 v[112:115], v215 offset:4096
    v_mfma_f32_16x16x32_bf16 v[44:47], v[176:179], v[200:203], v[44:47]
    v_mfma_f32_16x16x32_bf16 v[48:51], v[152:155], v[188:191], v[48:51]
    ds_read_b128 v[120:123], v215 offset:6144
    v_mfma_f32_16x16x32_bf16 v[52:55], v[152:155], v[196:199], v[52:55]
    v_mfma_f32_16x16x32_bf16 v[56:59], v[152:155], v[204:207], v[56:59]
    ds_read_b128 v[132:135], v212 offset:0
    v_mfma_f32_16x16x32_bf16 v[60:63], v[160:163], v[188:191], v[60:63]
    v_mfma_f32_16x16x32_bf16 v[64:67], v[160:163], v[196:199], v[64:67]
    ds_read_b128 v[140:143], v212 offset:2048
    v_mfma_f32_16x16x32_bf16 v[68:71], v[160:163], v[204:207], v[68:71]
    v_mfma_f32_16x16x32_bf16 v[72:75], v[168:171], v[188:191], v[72:75]
    ds_read_b128 v[148:151], v212 offset:4096
    v_mfma_f32_16x16x32_bf16 v[76:79], v[168:171], v[196:199], v[76:79]
    v_mfma_f32_16x16x32_bf16 v[80:83], v[168:171], v[204:207], v[80:83]
    ds_read_b128 v[100:103], v215 offset:1024
    v_mfma_f32_16x16x32_bf16 v[84:87], v[176:179], v[188:191], v[84:87]
    v_mfma_f32_16x16x32_bf16 v[88:91], v[176:179], v[196:199], v[88:91]
    ds_read_b128 v[108:111], v215 offset:3072
    v_mfma_f32_16x16x32_bf16 v[92:95], v[176:179], v[204:207], v[92:95]
    v_mfma_f32_16x16x32_bf16 v[48:51], v[156:159], v[184:187], v[48:51]
    ds_read_b128 v[116:119], v215 offset:5120
    v_xor_b32 v188, s34, v188
    v_xor_b32 v189, s34, v189
    v_mfma_f32_16x16x32_bf16 v[52:55], v[156:159], v[192:195], v[52:55]
    v_xor_b32 v190, s34, v190
    v_xor_b32 v191, s34, v191
    v_mfma_f32_16x16x32_bf16 v[56:59], v[156:159], v[200:203], v[56:59]
    ds_read_b128 v[124:127], v215 offset:7168
    v_xor_b32 v196, s34, v196
    v_xor_b32 v197, s34, v197
    v_mfma_f32_16x16x32_bf16 v[60:63], v[164:167], v[184:187], v[60:63]
    v_xor_b32 v198, s34, v198
    v_xor_b32 v199, s34, v199
    v_mfma_f32_16x16x32_bf16 v[64:67], v[164:167], v[192:195], v[64:67]
    v_xor_b32 v204, s34, v204
    v_xor_b32 v205, s34, v205
    v_mfma_f32_16x16x32_bf16 v[68:71], v[164:167], v[200:203], v[68:71]
    v_xor_b32 v206, s34, v206
    v_xor_b32 v207, s34, v207
    v_mfma_f32_16x16x32_bf16 v[72:75], v[172:175], v[184:187], v[72:75]
    v_mfma_f32_16x16x32_bf16 v[76:79], v[172:175], v[192:195], v[76:79]
    v_mfma_f32_16x16x32_bf16 v[80:83], v[172:175], v[200:203], v[80:83]
    v_mfma_f32_16x16x32_bf16 v[84:87], v[180:183], v[184:187], v[84:87]
    v_mfma_f32_16x16x32_bf16 v[88:91], v[180:183], v[192:195], v[88:91]
    v_mfma_f32_16x16x32_bf16 v[92:95], v[180:183], v[200:203], v[92:95]
    v_mfma_f32_16x16x32_bf16 v[0:3], v[156:159], v[188:191], v[0:3]
    v_mfma_f32_16x16x32_bf16 v[4:7], v[156:159], v[196:199], v[4:7]
    v_mfma_f32_16x16x32_bf16 v[8:11], v[156:159], v[204:207], v[8:11]
    v_mfma_f32_16x16x32_bf16 v[12:15], v[164:167], v[188:191], v[12:15]
    v_mfma_f32_16x16x32_bf16 v[16:19], v[164:167], v[196:199], v[16:19]
    s_waitcnt lgkmcnt(0)
    s_barrier
    v_mfma_f32_16x16x32_bf16 v[20:23], v[164:167], v[204:207], v[20:23]
    v_mfma_f32_16x16x32_bf16 v[24:27], v[172:175], v[188:191], v[24:27]
    v_mfma_f32_16x16x32_bf16 v[28:31], v[172:175], v[196:199], v[28:31]
    v_mfma_f32_16x16x32_bf16 v[32:35], v[172:175], v[204:207], v[32:35]
    v_mfma_f32_16x16x32_bf16 v[36:39], v[180:183], v[188:191], v[36:39]
    v_mfma_f32_16x16x32_bf16 v[40:43], v[180:183], v[196:199], v[40:43]
    v_mfma_f32_16x16x32_bf16 v[44:47], v[180:183], v[204:207], v[44:47]
    v_mfma_f32_16x16x32_bf16 v[0:3], v[96:99], v[128:131], v[0:3]
    ds_read_b128 v[152:155], v215 offset:28672
    v_mfma_f32_16x16x32_bf16 v[4:7], v[96:99], v[136:139], v[4:7]
    v_mfma_f32_16x16x32_bf16 v[8:11], v[96:99], v[144:147], v[8:11]
    ds_read_b128 v[184:187], v209 offset:28672
    v_mfma_f32_16x16x32_bf16 v[12:15], v[104:107], v[128:131], v[12:15]
    v_mfma_f32_16x16x32_bf16 v[16:19], v[104:107], v[136:139], v[16:19]
    ds_read_b128 v[192:195], v209 offset:30720
    v_mfma_f32_16x16x32_bf16 v[20:23], v[104:107], v[144:147], v[20:23]
    v_mfma_f32_16x16x32_bf16 v[24:27], v[112:115], v[128:131], v[24:27]
    ds_read_b128 v[200:203], v209 offset:32768
    v_mfma_f32_16x16x32_bf16 v[28:31], v[112:115], v[136:139], v[28:31]
    v_mfma_f32_16x16x32_bf16 v[32:35], v[112:115], v[144:147], v[32:35]
    ds_read_b128 v[160:163], v215 offset:30720
    v_mfma_f32_16x16x32_bf16 v[36:39], v[120:123], v[128:131], v[36:39]
    v_mfma_f32_16x16x32_bf16 v[40:43], v[120:123], v[136:139], v[40:43]
    ds_read_b128 v[168:171], v215 offset:32768
    v_mfma_f32_16x16x32_bf16 v[44:47], v[120:123], v[144:147], v[44:47]
    v_mfma_f32_16x16x32_bf16 v[48:51], v[96:99], v[132:135], v[48:51]
    ds_read_b128 v[176:179], v215 offset:34816
    v_mfma_f32_16x16x32_bf16 v[52:55], v[96:99], v[140:143], v[52:55]
    v_mfma_f32_16x16x32_bf16 v[56:59], v[96:99], v[148:151], v[56:59]
    ds_read_b128 v[188:191], v212 offset:28672
    v_mfma_f32_16x16x32_bf16 v[60:63], v[104:107], v[132:135], v[60:63]
    v_mfma_f32_16x16x32_bf16 v[64:67], v[104:107], v[140:143], v[64:67]
    ds_read_b128 v[196:199], v212 offset:30720
    v_mfma_f32_16x16x32_bf16 v[68:71], v[104:107], v[148:151], v[68:71]
    v_mfma_f32_16x16x32_bf16 v[72:75], v[112:115], v[132:135], v[72:75]
    ds_read_b128 v[204:207], v212 offset:32768
    v_mfma_f32_16x16x32_bf16 v[76:79], v[112:115], v[140:143], v[76:79]
    v_mfma_f32_16x16x32_bf16 v[80:83], v[112:115], v[148:151], v[80:83]
    ds_read_b128 v[156:159], v215 offset:29696
    v_mfma_f32_16x16x32_bf16 v[84:87], v[120:123], v[132:135], v[84:87]
    v_mfma_f32_16x16x32_bf16 v[88:91], v[120:123], v[140:143], v[88:91]
    ds_read_b128 v[164:167], v215 offset:31744
    v_mfma_f32_16x16x32_bf16 v[92:95], v[120:123], v[148:151], v[92:95]
    v_mfma_f32_16x16x32_bf16 v[48:51], v[100:103], v[128:131], v[48:51]
    ds_read_b128 v[172:175], v215 offset:33792
    v_xor_b32 v132, s34, v132
    v_xor_b32 v133, s34, v133
    v_mfma_f32_16x16x32_bf16 v[52:55], v[100:103], v[136:139], v[52:55]
    v_xor_b32 v134, s34, v134
    v_xor_b32 v135, s34, v135
    v_mfma_f32_16x16x32_bf16 v[56:59], v[100:103], v[144:147], v[56:59]
    ds_read_b128 v[180:183], v215 offset:35840
    v_xor_b32 v140, s34, v140
    v_xor_b32 v141, s34, v141
    v_mfma_f32_16x16x32_bf16 v[60:63], v[108:111], v[128:131], v[60:63]
    v_xor_b32 v142, s34, v142
    v_xor_b32 v143, s34, v143
    v_mfma_f32_16x16x32_bf16 v[64:67], v[108:111], v[136:139], v[64:67]
    v_xor_b32 v148, s34, v148
    v_xor_b32 v149, s34, v149
    v_mfma_f32_16x16x32_bf16 v[68:71], v[108:111], v[144:147], v[68:71]
    v_xor_b32 v150, s34, v150
    v_xor_b32 v151, s34, v151
    v_mfma_f32_16x16x32_bf16 v[72:75], v[116:119], v[128:131], v[72:75]
    v_mfma_f32_16x16x32_bf16 v[76:79], v[116:119], v[136:139], v[76:79]
    v_mfma_f32_16x16x32_bf16 v[80:83], v[116:119], v[144:147], v[80:83]
    v_mfma_f32_16x16x32_bf16 v[84:87], v[124:127], v[128:131], v[84:87]
    v_mfma_f32_16x16x32_bf16 v[88:91], v[124:127], v[136:139], v[88:91]
    v_mfma_f32_16x16x32_bf16 v[92:95], v[124:127], v[144:147], v[92:95]
    v_mfma_f32_16x16x32_bf16 v[0:3], v[100:103], v[132:135], v[0:3]
    v_mfma_f32_16x16x32_bf16 v[4:7], v[100:103], v[140:143], v[4:7]
    v_mfma_f32_16x16x32_bf16 v[8:11], v[100:103], v[148:151], v[8:11]
    v_mfma_f32_16x16x32_bf16 v[12:15], v[108:111], v[132:135], v[12:15]
    v_mfma_f32_16x16x32_bf16 v[16:19], v[108:111], v[140:143], v[16:19]
    s_waitcnt lgkmcnt(0)
    s_barrier
    v_mfma_f32_16x16x32_bf16 v[20:23], v[108:111], v[148:151], v[20:23]
    v_mfma_f32_16x16x32_bf16 v[24:27], v[116:119], v[132:135], v[24:27]
    v_mfma_f32_16x16x32_bf16 v[28:31], v[116:119], v[140:143], v[28:31]
    v_mfma_f32_16x16x32_bf16 v[32:35], v[116:119], v[148:151], v[32:35]
    v_mfma_f32_16x16x32_bf16 v[36:39], v[124:127], v[132:135], v[36:39]
    v_mfma_f32_16x16x32_bf16 v[40:43], v[124:127], v[140:143], v[40:43]
    v_mfma_f32_16x16x32_bf16 v[44:47], v[124:127], v[148:151], v[44:47]
    v_mfma_f32_16x16x32_bf16 v[0:3], v[152:155], v[184:187], v[0:3]
    ds_read_b128 v[96:99], v216 offset:0
    v_mfma_f32_16x16x32_bf16 v[4:7], v[152:155], v[192:195], v[4:7]
    v_mfma_f32_16x16x32_bf16 v[8:11], v[152:155], v[200:203], v[8:11]
    ds_read_b128 v[128:131], v210 offset:0
    v_mfma_f32_16x16x32_bf16 v[12:15], v[160:163], v[184:187], v[12:15]
    v_mfma_f32_16x16x32_bf16 v[16:19], v[160:163], v[192:195], v[16:19]
    ds_read_b128 v[136:139], v210 offset:2048
    v_mfma_f32_16x16x32_bf16 v[20:23], v[160:163], v[200:203], v[20:23]
    v_mfma_f32_16x16x32_bf16 v[24:27], v[168:171], v[184:187], v[24:27]
    ds_read_b128 v[144:147], v210 offset:4096
    v_mfma_f32_16x16x32_bf16 v[28:31], v[168:171], v[192:195], v[28:31]
    v_mfma_f32_16x16x32_bf16 v[32:35], v[168:171], v[200:203], v[32:35]
    ds_read_b128 v[104:107], v216 offset:2048
    v_mfma_f32_16x16x32_bf16 v[36:39], v[176:179], v[184:187], v[36:39]
    v_mfma_f32_16x16x32_bf16 v[40:43], v[176:179], v[192:195], v[40:43]
    ds_read_b128 v[112:115], v216 offset:4096
    v_mfma_f32_16x16x32_bf16 v[44:47], v[176:179], v[200:203], v[44:47]
    v_mfma_f32_16x16x32_bf16 v[48:51], v[152:155], v[188:191], v[48:51]
    ds_read_b128 v[120:123], v216 offset:6144
    v_mfma_f32_16x16x32_bf16 v[52:55], v[152:155], v[196:199], v[52:55]
    v_mfma_f32_16x16x32_bf16 v[56:59], v[152:155], v[204:207], v[56:59]
    ds_read_b128 v[132:135], v213 offset:0
    v_mfma_f32_16x16x32_bf16 v[60:63], v[160:163], v[188:191], v[60:63]
    v_mfma_f32_16x16x32_bf16 v[64:67], v[160:163], v[196:199], v[64:67]
    ds_read_b128 v[140:143], v213 offset:2048
    v_mfma_f32_16x16x32_bf16 v[68:71], v[160:163], v[204:207], v[68:71]
    v_mfma_f32_16x16x32_bf16 v[72:75], v[168:171], v[188:191], v[72:75]
    ds_read_b128 v[148:151], v213 offset:4096
    v_mfma_f32_16x16x32_bf16 v[76:79], v[168:171], v[196:199], v[76:79]
    v_mfma_f32_16x16x32_bf16 v[80:83], v[168:171], v[204:207], v[80:83]
    ds_read_b128 v[100:103], v216 offset:1024
    v_mfma_f32_16x16x32_bf16 v[84:87], v[176:179], v[188:191], v[84:87]
    v_mfma_f32_16x16x32_bf16 v[88:91], v[176:179], v[196:199], v[88:91]
    ds_read_b128 v[108:111], v216 offset:3072
    v_mfma_f32_16x16x32_bf16 v[92:95], v[176:179], v[204:207], v[92:95]
    v_mfma_f32_16x16x32_bf16 v[48:51], v[156:159], v[184:187], v[48:51]
    ds_read_b128 v[116:119], v216 offset:5120
    v_xor_b32 v188, s34, v188
    v_xor_b32 v189, s34, v189
    v_mfma_f32_16x16x32_bf16 v[52:55], v[156:159], v[192:195], v[52:55]
    v_xor_b32 v190, s34, v190
    v_xor_b32 v191, s34, v191
    v_mfma_f32_16x16x32_bf16 v[56:59], v[156:159], v[200:203], v[56:59]
    ds_read_b128 v[124:127], v216 offset:7168
    v_xor_b32 v196, s34, v196
    v_xor_b32 v197, s34, v197
    v_mfma_f32_16x16x32_bf16 v[60:63], v[164:167], v[184:187], v[60:63]
    v_xor_b32 v198, s34, v198
    v_xor_b32 v199, s34, v199
    v_mfma_f32_16x16x32_bf16 v[64:67], v[164:167], v[192:195], v[64:67]
    v_xor_b32 v204, s34, v204
    v_xor_b32 v205, s34, v205
    v_mfma_f32_16x16x32_bf16 v[68:71], v[164:167], v[200:203], v[68:71]
    v_xor_b32 v206, s34, v206
    v_xor_b32 v207, s34, v207
    v_mfma_f32_16x16x32_bf16 v[72:75], v[172:175], v[184:187], v[72:75]
    v_mfma_f32_16x16x32_bf16 v[76:79], v[172:175], v[192:195], v[76:79]
    v_mfma_f32_16x16x32_bf16 v[80:83], v[172:175], v[200:203], v[80:83]
    v_mfma_f32_16x16x32_bf16 v[84:87], v[180:183], v[184:187], v[84:87]
    v_mfma_f32_16x16x32_bf16 v[88:91], v[180:183], v[192:195], v[88:91]
    v_mfma_f32_16x16x32_bf16 v[92:95], v[180:183], v[200:203], v[92:95]
    v_mfma_f32_16x16x32_bf16 v[0:3], v[156:159], v[188:191], v[0:3]
    v_mfma_f32_16x16x32_bf16 v[4:7], v[156:159], v[196:199], v[4:7]
    v_mfma_f32_16x16x32_bf16 v[8:11], v[156:159], v[204:207], v[8:11]
    v_mfma_f32_16x16x32_bf16 v[12:15], v[164:167], v[188:191], v[12:15]
    v_mfma_f32_16x16x32_bf16 v[16:19], v[164:167], v[196:199], v[16:19]
    s_waitcnt lgkmcnt(0)
    s_barrier
    v_mfma_f32_16x16x32_bf16 v[20:23], v[164:167], v[204:207], v[20:23]
    v_mfma_f32_16x16x32_bf16 v[24:27], v[172:175], v[188:191], v[24:27]
    v_mfma_f32_16x16x32_bf16 v[28:31], v[172:175], v[196:199], v[28:31]
    v_mfma_f32_16x16x32_bf16 v[32:35], v[172:175], v[204:207], v[32:35]
    v_mfma_f32_16x16x32_bf16 v[36:39], v[180:183], v[188:191], v[36:39]
    v_mfma_f32_16x16x32_bf16 v[40:43], v[180:183], v[196:199], v[40:43]
    v_mfma_f32_16x16x32_bf16 v[44:47], v[180:183], v[204:207], v[44:47]
    v_mfma_f32_16x16x32_bf16 v[0:3], v[96:99], v[128:131], v[0:3]
    ds_read_b128 v[152:155], v214 offset:0
    v_mfma_f32_16x16x32_bf16 v[4:7], v[96:99], v[136:139], v[4:7]
    v_mfma_f32_16x16x32_bf16 v[8:11], v[96:99], v[144:147], v[8:11]
    ds_read_b128 v[184:187], v208 offset:0
    v_mfma_f32_16x16x32_bf16 v[12:15], v[104:107], v[128:131], v[12:15]
    v_mfma_f32_16x16x32_bf16 v[16:19], v[104:107], v[136:139], v[16:19]
    ds_read_b128 v[192:195], v208 offset:2048
    v_mfma_f32_16x16x32_bf16 v[20:23], v[104:107], v[144:147], v[20:23]
    v_mfma_f32_16x16x32_bf16 v[24:27], v[112:115], v[128:131], v[24:27]
    ds_read_b128 v[200:203], v208 offset:4096
    v_mfma_f32_16x16x32_bf16 v[28:31], v[112:115], v[136:139], v[28:31]
    v_mfma_f32_16x16x32_bf16 v[32:35], v[112:115], v[144:147], v[32:35]
    ds_read_b128 v[160:163], v214 offset:2048
    v_mfma_f32_16x16x32_bf16 v[36:39], v[120:123], v[128:131], v[36:39]
    v_mfma_f32_16x16x32_bf16 v[40:43], v[120:123], v[136:139], v[40:43]
    ds_read_b128 v[168:171], v214 offset:4096
    v_mfma_f32_16x16x32_bf16 v[44:47], v[120:123], v[144:147], v[44:47]
    v_mfma_f32_16x16x32_bf16 v[48:51], v[96:99], v[132:135], v[48:51]
    ds_read_b128 v[176:179], v214 offset:6144
    v_mfma_f32_16x16x32_bf16 v[52:55], v[96:99], v[140:143], v[52:55]
    v_mfma_f32_16x16x32_bf16 v[56:59], v[96:99], v[148:151], v[56:59]
    ds_read_b128 v[188:191], v211 offset:0
    v_mfma_f32_16x16x32_bf16 v[60:63], v[104:107], v[132:135], v[60:63]
    v_mfma_f32_16x16x32_bf16 v[64:67], v[104:107], v[140:143], v[64:67]
    ds_read_b128 v[196:199], v211 offset:2048
    v_mfma_f32_16x16x32_bf16 v[68:71], v[104:107], v[148:151], v[68:71]
    v_mfma_f32_16x16x32_bf16 v[72:75], v[112:115], v[132:135], v[72:75]
    ds_read_b128 v[204:207], v211 offset:4096
    v_mfma_f32_16x16x32_bf16 v[76:79], v[112:115], v[140:143], v[76:79]
    v_mfma_f32_16x16x32_bf16 v[80:83], v[112:115], v[148:151], v[80:83]
    ds_read_b128 v[156:159], v214 offset:1024
    v_mfma_f32_16x16x32_bf16 v[84:87], v[120:123], v[132:135], v[84:87]
    v_mfma_f32_16x16x32_bf16 v[88:91], v[120:123], v[140:143], v[88:91]
    ds_read_b128 v[164:167], v214 offset:3072
    v_mfma_f32_16x16x32_bf16 v[92:95], v[120:123], v[148:151], v[92:95]
    v_mfma_f32_16x16x32_bf16 v[48:51], v[100:103], v[128:131], v[48:51]
    ds_read_b128 v[172:175], v214 offset:5120
    v_xor_b32 v132, s34, v132
    v_xor_b32 v133, s34, v133
    v_mfma_f32_16x16x32_bf16 v[52:55], v[100:103], v[136:139], v[52:55]
    v_xor_b32 v134, s34, v134
    v_xor_b32 v135, s34, v135
    v_mfma_f32_16x16x32_bf16 v[56:59], v[100:103], v[144:147], v[56:59]
    ds_read_b128 v[180:183], v214 offset:7168
    v_xor_b32 v140, s34, v140
    v_xor_b32 v141, s34, v141
    v_mfma_f32_16x16x32_bf16 v[60:63], v[108:111], v[128:131], v[60:63]
    v_xor_b32 v142, s34, v142
    v_xor_b32 v143, s34, v143
    v_mfma_f32_16x16x32_bf16 v[64:67], v[108:111], v[136:139], v[64:67]
    v_xor_b32 v148, s34, v148
    v_xor_b32 v149, s34, v149
    v_mfma_f32_16x16x32_bf16 v[68:71], v[108:111], v[144:147], v[68:71]
    v_xor_b32 v150, s34, v150
    v_xor_b32 v151, s34, v151
    v_mfma_f32_16x16x32_bf16 v[72:75], v[116:119], v[128:131], v[72:75]
    v_mfma_f32_16x16x32_bf16 v[76:79], v[116:119], v[136:139], v[76:79]
    v_mfma_f32_16x16x32_bf16 v[80:83], v[116:119], v[144:147], v[80:83]
    v_mfma_f32_16x16x32_bf16 v[84:87], v[124:127], v[128:131], v[84:87]
    v_mfma_f32_16x16x32_bf16 v[88:91], v[124:127], v[136:139], v[88:91]
    v_mfma_f32_16x16x32_bf16 v[92:95], v[124:127], v[144:147], v[92:95]
    v_mfma_f32_16x16x32_bf16 v[0:3], v[100:103], v[132:135], v[0:3]
    v_mfma_f32_16x16x32_bf16 v[4:7], v[100:103], v[140:143], v[4:7]
    v_mfma_f32_16x16x32_bf16 v[8:11], v[100:103], v[148:151], v[8:11]
    v_mfma_f32_16x16x32_bf16 v[12:15], v[108:111], v[132:135], v[12:15]
    v_mfma_f32_16x16x32_bf16 v[16:19], v[108:111], v[140:143], v[16:19]
    s_waitcnt lgkmcnt(0)
    s_barrier
    v_mfma_f32_16x16x32_bf16 v[20:23], v[108:111], v[148:151], v[20:23]
    v_mfma_f32_16x16x32_bf16 v[24:27], v[116:119], v[132:135], v[24:27]
    v_mfma_f32_16x16x32_bf16 v[28:31], v[116:119], v[140:143], v[28:31]
    v_mfma_f32_16x16x32_bf16 v[32:35], v[116:119], v[148:151], v[32:35]
    v_mfma_f32_16x16x32_bf16 v[36:39], v[124:127], v[132:135], v[36:39]
    v_mfma_f32_16x16x32_bf16 v[40:43], v[124:127], v[140:143], v[40:43]
    v_mfma_f32_16x16x32_bf16 v[44:47], v[124:127], v[148:151], v[44:47]
    v_mfma_f32_16x16x32_bf16 v[0:3], v[152:155], v[184:187], v[0:3]
    ds_read_b128 v[96:99], v214 offset:28672
    v_mfma_f32_16x16x32_bf16 v[4:7], v[152:155], v[192:195], v[4:7]
    v_mfma_f32_16x16x32_bf16 v[8:11], v[152:155], v[200:203], v[8:11]
    ds_read_b128 v[128:131], v208 offset:28672
    v_mfma_f32_16x16x32_bf16 v[12:15], v[160:163], v[184:187], v[12:15]
    v_mfma_f32_16x16x32_bf16 v[16:19], v[160:163], v[192:195], v[16:19]
    ds_read_b128 v[136:139], v208 offset:30720
    v_mfma_f32_16x16x32_bf16 v[20:23], v[160:163], v[200:203], v[20:23]
    v_mfma_f32_16x16x32_bf16 v[24:27], v[168:171], v[184:187], v[24:27]
    ds_read_b128 v[144:147], v208 offset:32768
    v_mfma_f32_16x16x32_bf16 v[28:31], v[168:171], v[192:195], v[28:31]
    v_mfma_f32_16x16x32_bf16 v[32:35], v[168:171], v[200:203], v[32:35]
    ds_read_b128 v[104:107], v214 offset:30720
    v_mfma_f32_16x16x32_bf16 v[36:39], v[176:179], v[184:187], v[36:39]
    v_mfma_f32_16x16x32_bf16 v[40:43], v[176:179], v[192:195], v[40:43]
    ds_read_b128 v[112:115], v214 offset:32768
    v_mfma_f32_16x16x32_bf16 v[44:47], v[176:179], v[200:203], v[44:47]
    v_mfma_f32_16x16x32_bf16 v[48:51], v[152:155], v[188:191], v[48:51]
    ds_read_b128 v[120:123], v214 offset:34816
    v_mfma_f32_16x16x32_bf16 v[52:55], v[152:155], v[196:199], v[52:55]
    v_mfma_f32_16x16x32_bf16 v[56:59], v[152:155], v[204:207], v[56:59]
    ds_read_b128 v[132:135], v211 offset:28672
    v_mfma_f32_16x16x32_bf16 v[60:63], v[160:163], v[188:191], v[60:63]
    v_mfma_f32_16x16x32_bf16 v[64:67], v[160:163], v[196:199], v[64:67]
    ds_read_b128 v[140:143], v211 offset:30720
    v_mfma_f32_16x16x32_bf16 v[68:71], v[160:163], v[204:207], v[68:71]
    v_mfma_f32_16x16x32_bf16 v[72:75], v[168:171], v[188:191], v[72:75]
    ds_read_b128 v[148:151], v211 offset:32768
    v_mfma_f32_16x16x32_bf16 v[76:79], v[168:171], v[196:199], v[76:79]
    v_mfma_f32_16x16x32_bf16 v[80:83], v[168:171], v[204:207], v[80:83]
    ds_read_b128 v[100:103], v214 offset:29696
    v_mfma_f32_16x16x32_bf16 v[84:87], v[176:179], v[188:191], v[84:87]
    v_mfma_f32_16x16x32_bf16 v[88:91], v[176:179], v[196:199], v[88:91]
    ds_read_b128 v[108:111], v214 offset:31744
    v_mfma_f32_16x16x32_bf16 v[92:95], v[176:179], v[204:207], v[92:95]
    v_mfma_f32_16x16x32_bf16 v[48:51], v[156:159], v[184:187], v[48:51]
    ds_read_b128 v[116:119], v214 offset:33792
    v_xor_b32 v188, s34, v188
    v_xor_b32 v189, s34, v189
    v_mfma_f32_16x16x32_bf16 v[52:55], v[156:159], v[192:195], v[52:55]
    v_xor_b32 v190, s34, v190
    v_xor_b32 v191, s34, v191
    v_mfma_f32_16x16x32_bf16 v[56:59], v[156:159], v[200:203], v[56:59]
    ds_read_b128 v[124:127], v214 offset:35840
    v_xor_b32 v196, s34, v196
    v_xor_b32 v197, s34, v197
    v_mfma_f32_16x16x32_bf16 v[60:63], v[164:167], v[184:187], v[60:63]
    v_xor_b32 v198, s34, v198
    v_xor_b32 v199, s34, v199
    v_mfma_f32_16x16x32_bf16 v[64:67], v[164:167], v[192:195], v[64:67]
    v_xor_b32 v204, s34, v204
    v_xor_b32 v205, s34, v205
    v_mfma_f32_16x16x32_bf16 v[68:71], v[164:167], v[200:203], v[68:71]
    v_xor_b32 v206, s34, v206
    v_xor_b32 v207, s34, v207
    v_mfma_f32_16x16x32_bf16 v[72:75], v[172:175], v[184:187], v[72:75]
    v_mfma_f32_16x16x32_bf16 v[76:79], v[172:175], v[192:195], v[76:79]
    v_mfma_f32_16x16x32_bf16 v[80:83], v[172:175], v[200:203], v[80:83]
    v_mfma_f32_16x16x32_bf16 v[84:87], v[180:183], v[184:187], v[84:87]
    v_mfma_f32_16x16x32_bf16 v[88:91], v[180:183], v[192:195], v[88:91]
    v_mfma_f32_16x16x32_bf16 v[92:95], v[180:183], v[200:203], v[92:95]
    v_mfma_f32_16x16x32_bf16 v[0:3], v[156:159], v[188:191], v[0:3]
    v_mfma_f32_16x16x32_bf16 v[4:7], v[156:159], v[196:199], v[4:7]
    v_mfma_f32_16x16x32_bf16 v[8:11], v[156:159], v[204:207], v[8:11]
    v_mfma_f32_16x16x32_bf16 v[12:15], v[164:167], v[188:191], v[12:15]
    v_mfma_f32_16x16x32_bf16 v[16:19], v[164:167], v[196:199], v[16:19]
    s_waitcnt lgkmcnt(0)
    s_barrier
    v_mfma_f32_16x16x32_bf16 v[20:23], v[164:167], v[204:207], v[20:23]
    v_mfma_f32_16x16x32_bf16 v[24:27], v[172:175], v[188:191], v[24:27]
    v_mfma_f32_16x16x32_bf16 v[28:31], v[172:175], v[196:199], v[28:31]
    v_mfma_f32_16x16x32_bf16 v[32:35], v[172:175], v[204:207], v[32:35]
    v_mfma_f32_16x16x32_bf16 v[36:39], v[180:183], v[188:191], v[36:39]
    v_mfma_f32_16x16x32_bf16 v[40:43], v[180:183], v[196:199], v[40:43]
    v_mfma_f32_16x16x32_bf16 v[44:47], v[180:183], v[204:207], v[44:47]
    v_mfma_f32_16x16x32_bf16 v[0:3], v[96:99], v[128:131], v[0:3]
    ds_read_b128 v[152:155], v215 offset:0
    v_mfma_f32_16x16x32_bf16 v[4:7], v[96:99], v[136:139], v[4:7]
    v_mfma_f32_16x16x32_bf16 v[8:11], v[96:99], v[144:147], v[8:11]
    ds_read_b128 v[184:187], v209 offset:0
    v_mfma_f32_16x16x32_bf16 v[12:15], v[104:107], v[128:131], v[12:15]
    v_mfma_f32_16x16x32_bf16 v[16:19], v[104:107], v[136:139], v[16:19]
    ds_read_b128 v[192:195], v209 offset:2048
    v_mfma_f32_16x16x32_bf16 v[20:23], v[104:107], v[144:147], v[20:23]
    v_mfma_f32_16x16x32_bf16 v[24:27], v[112:115], v[128:131], v[24:27]
    ds_read_b128 v[200:203], v209 offset:4096
    v_mfma_f32_16x16x32_bf16 v[28:31], v[112:115], v[136:139], v[28:31]
    v_mfma_f32_16x16x32_bf16 v[32:35], v[112:115], v[144:147], v[32:35]
    ds_read_b128 v[160:163], v215 offset:2048
    v_mfma_f32_16x16x32_bf16 v[36:39], v[120:123], v[128:131], v[36:39]
    v_mfma_f32_16x16x32_bf16 v[40:43], v[120:123], v[136:139], v[40:43]
    ds_read_b128 v[168:171], v215 offset:4096
    v_mfma_f32_16x16x32_bf16 v[44:47], v[120:123], v[144:147], v[44:47]
    v_mfma_f32_16x16x32_bf16 v[48:51], v[96:99], v[132:135], v[48:51]
    ds_read_b128 v[176:179], v215 offset:6144
    v_mfma_f32_16x16x32_bf16 v[52:55], v[96:99], v[140:143], v[52:55]
    v_mfma_f32_16x16x32_bf16 v[56:59], v[96:99], v[148:151], v[56:59]
    ds_read_b128 v[188:191], v212 offset:0
    v_mfma_f32_16x16x32_bf16 v[60:63], v[104:107], v[132:135], v[60:63]
    v_mfma_f32_16x16x32_bf16 v[64:67], v[104:107], v[140:143], v[64:67]
    ds_read_b128 v[196:199], v212 offset:2048
    v_mfma_f32_16x16x32_bf16 v[68:71], v[104:107], v[148:151], v[68:71]
    v_mfma_f32_16x16x32_bf16 v[72:75], v[112:115], v[132:135], v[72:75]
    ds_read_b128 v[204:207], v212 offset:4096
    v_mfma_f32_16x16x32_bf16 v[76:79], v[112:115], v[140:143], v[76:79]
    v_mfma_f32_16x16x32_bf16 v[80:83], v[112:115], v[148:151], v[80:83]
    ds_read_b128 v[156:159], v215 offset:1024
    v_mfma_f32_16x16x32_bf16 v[84:87], v[120:123], v[132:135], v[84:87]
    v_mfma_f32_16x16x32_bf16 v[88:91], v[120:123], v[140:143], v[88:91]
    ds_read_b128 v[164:167], v215 offset:3072
    v_mfma_f32_16x16x32_bf16 v[92:95], v[120:123], v[148:151], v[92:95]
    v_mfma_f32_16x16x32_bf16 v[48:51], v[100:103], v[128:131], v[48:51]
    ds_read_b128 v[172:175], v215 offset:5120
    v_xor_b32 v132, s34, v132
    v_xor_b32 v133, s34, v133
    v_mfma_f32_16x16x32_bf16 v[52:55], v[100:103], v[136:139], v[52:55]
    v_xor_b32 v134, s34, v134
    v_xor_b32 v135, s34, v135
    v_mfma_f32_16x16x32_bf16 v[56:59], v[100:103], v[144:147], v[56:59]
    ds_read_b128 v[180:183], v215 offset:7168
    v_xor_b32 v140, s34, v140
    v_xor_b32 v141, s34, v141
    v_mfma_f32_16x16x32_bf16 v[60:63], v[108:111], v[128:131], v[60:63]
    v_xor_b32 v142, s34, v142
    v_xor_b32 v143, s34, v143
    v_mfma_f32_16x16x32_bf16 v[64:67], v[108:111], v[136:139], v[64:67]
    v_xor_b32 v148, s34, v148
    v_xor_b32 v149, s34, v149
    v_mfma_f32_16x16x32_bf16 v[68:71], v[108:111], v[144:147], v[68:71]
    v_xor_b32 v150, s34, v150
    v_xor_b32 v151, s34, v151
    v_mfma_f32_16x16x32_bf16 v[72:75], v[116:119], v[128:131], v[72:75]
    v_mfma_f32_16x16x32_bf16 v[76:79], v[116:119], v[136:139], v[76:79]
    v_mfma_f32_16x16x32_bf16 v[80:83], v[116:119], v[144:147], v[80:83]
    v_mfma_f32_16x16x32_bf16 v[84:87], v[124:127], v[128:131], v[84:87]
    v_mfma_f32_16x16x32_bf16 v[88:91], v[124:127], v[136:139], v[88:91]
    v_mfma_f32_16x16x32_bf16 v[92:95], v[124:127], v[144:147], v[92:95]
    v_mfma_f32_16x16x32_bf16 v[0:3], v[100:103], v[132:135], v[0:3]
    v_mfma_f32_16x16x32_bf16 v[4:7], v[100:103], v[140:143], v[4:7]
    v_mfma_f32_16x16x32_bf16 v[8:11], v[100:103], v[148:151], v[8:11]
    v_mfma_f32_16x16x32_bf16 v[12:15], v[108:111], v[132:135], v[12:15]
    v_mfma_f32_16x16x32_bf16 v[16:19], v[108:111], v[140:143], v[16:19]
    s_waitcnt lgkmcnt(0)
    s_barrier
    v_mfma_f32_16x16x32_bf16 v[20:23], v[108:111], v[148:151], v[20:23]
    v_mfma_f32_16x16x32_bf16 v[24:27], v[116:119], v[132:135], v[24:27]
    v_mfma_f32_16x16x32_bf16 v[28:31], v[116:119], v[140:143], v[28:31]
    v_mfma_f32_16x16x32_bf16 v[32:35], v[116:119], v[148:151], v[32:35]
    v_mfma_f32_16x16x32_bf16 v[36:39], v[124:127], v[132:135], v[36:39]
    v_mfma_f32_16x16x32_bf16 v[40:43], v[124:127], v[140:143], v[40:43]
    v_mfma_f32_16x16x32_bf16 v[44:47], v[124:127], v[148:151], v[44:47]
    v_mfma_f32_16x16x32_bf16 v[0:3], v[152:155], v[184:187], v[0:3]
    ds_read_b128 v[96:99], v215 offset:28672
    v_mfma_f32_16x16x32_bf16 v[4:7], v[152:155], v[192:195], v[4:7]
    v_mfma_f32_16x16x32_bf16 v[8:11], v[152:155], v[200:203], v[8:11]
    ds_read_b128 v[128:131], v209 offset:28672
    v_mfma_f32_16x16x32_bf16 v[12:15], v[160:163], v[184:187], v[12:15]
    v_mfma_f32_16x16x32_bf16 v[16:19], v[160:163], v[192:195], v[16:19]
    ds_read_b128 v[136:139], v209 offset:30720
    v_mfma_f32_16x16x32_bf16 v[20:23], v[160:163], v[200:203], v[20:23]
    v_mfma_f32_16x16x32_bf16 v[24:27], v[168:171], v[184:187], v[24:27]
    ds_read_b128 v[144:147], v209 offset:32768
    v_mfma_f32_16x16x32_bf16 v[28:31], v[168:171], v[192:195], v[28:31]
    v_mfma_f32_16x16x32_bf16 v[32:35], v[168:171], v[200:203], v[32:35]
    ds_read_b128 v[104:107], v215 offset:30720
    v_mfma_f32_16x16x32_bf16 v[36:39], v[176:179], v[184:187], v[36:39]
    v_mfma_f32_16x16x32_bf16 v[40:43], v[176:179], v[192:195], v[40:43]
    ds_read_b128 v[112:115], v215 offset:32768
    v_mfma_f32_16x16x32_bf16 v[44:47], v[176:179], v[200:203], v[44:47]
    v_mfma_f32_16x16x32_bf16 v[48:51], v[152:155], v[188:191], v[48:51]
    ds_read_b128 v[120:123], v215 offset:34816
    v_mfma_f32_16x16x32_bf16 v[52:55], v[152:155], v[196:199], v[52:55]
    v_mfma_f32_16x16x32_bf16 v[56:59], v[152:155], v[204:207], v[56:59]
    ds_read_b128 v[132:135], v212 offset:28672
    v_mfma_f32_16x16x32_bf16 v[60:63], v[160:163], v[188:191], v[60:63]
    v_mfma_f32_16x16x32_bf16 v[64:67], v[160:163], v[196:199], v[64:67]
    ds_read_b128 v[140:143], v212 offset:30720
    v_mfma_f32_16x16x32_bf16 v[68:71], v[160:163], v[204:207], v[68:71]
    v_mfma_f32_16x16x32_bf16 v[72:75], v[168:171], v[188:191], v[72:75]
    ds_read_b128 v[148:151], v212 offset:32768
    v_mfma_f32_16x16x32_bf16 v[76:79], v[168:171], v[196:199], v[76:79]
    v_mfma_f32_16x16x32_bf16 v[80:83], v[168:171], v[204:207], v[80:83]
    ds_read_b128 v[100:103], v215 offset:29696
    v_mfma_f32_16x16x32_bf16 v[84:87], v[176:179], v[188:191], v[84:87]
    v_mfma_f32_16x16x32_bf16 v[88:91], v[176:179], v[196:199], v[88:91]
    ds_read_b128 v[108:111], v215 offset:31744
    v_mfma_f32_16x16x32_bf16 v[92:95], v[176:179], v[204:207], v[92:95]
    v_mfma_f32_16x16x32_bf16 v[48:51], v[156:159], v[184:187], v[48:51]
    ds_read_b128 v[116:119], v215 offset:33792
    v_xor_b32 v188, s34, v188
    v_xor_b32 v189, s34, v189
    v_mfma_f32_16x16x32_bf16 v[52:55], v[156:159], v[192:195], v[52:55]
    v_xor_b32 v190, s34, v190
    v_xor_b32 v191, s34, v191
    v_mfma_f32_16x16x32_bf16 v[56:59], v[156:159], v[200:203], v[56:59]
    ds_read_b128 v[124:127], v215 offset:35840
    v_xor_b32 v196, s34, v196
    v_xor_b32 v197, s34, v197
    v_mfma_f32_16x16x32_bf16 v[60:63], v[164:167], v[184:187], v[60:63]
    v_xor_b32 v198, s34, v198
    v_xor_b32 v199, s34, v199
    v_mfma_f32_16x16x32_bf16 v[64:67], v[164:167], v[192:195], v[64:67]
    v_xor_b32 v204, s34, v204
    v_xor_b32 v205, s34, v205
    v_mfma_f32_16x16x32_bf16 v[68:71], v[164:167], v[200:203], v[68:71]
    v_xor_b32 v206, s34, v206
    v_xor_b32 v207, s34, v207
    v_mfma_f32_16x16x32_bf16 v[72:75], v[172:175], v[184:187], v[72:75]
    v_mfma_f32_16x16x32_bf16 v[76:79], v[172:175], v[192:195], v[76:79]
    v_mfma_f32_16x16x32_bf16 v[80:83], v[172:175], v[200:203], v[80:83]
    v_mfma_f32_16x16x32_bf16 v[84:87], v[180:183], v[184:187], v[84:87]
    v_mfma_f32_16x16x32_bf16 v[88:91], v[180:183], v[192:195], v[88:91]
    v_mfma_f32_16x16x32_bf16 v[92:95], v[180:183], v[200:203], v[92:95]
    v_mfma_f32_16x16x32_bf16 v[0:3], v[156:159], v[188:191], v[0:3]
    v_mfma_f32_16x16x32_bf16 v[4:7], v[156:159], v[196:199], v[4:7]
    v_mfma_f32_16x16x32_bf16 v[8:11], v[156:159], v[204:207], v[8:11]
    v_mfma_f32_16x16x32_bf16 v[12:15], v[164:167], v[188:191], v[12:15]
    v_mfma_f32_16x16x32_bf16 v[16:19], v[164:167], v[196:199], v[16:19]
    s_waitcnt lgkmcnt(0)
    s_barrier
    v_mfma_f32_16x16x32_bf16 v[20:23], v[164:167], v[204:207], v[20:23]
    v_mfma_f32_16x16x32_bf16 v[24:27], v[172:175], v[188:191], v[24:27]
    v_mfma_f32_16x16x32_bf16 v[28:31], v[172:175], v[196:199], v[28:31]
    v_mfma_f32_16x16x32_bf16 v[32:35], v[172:175], v[204:207], v[32:35]
    v_mfma_f32_16x16x32_bf16 v[36:39], v[180:183], v[188:191], v[36:39]
    v_mfma_f32_16x16x32_bf16 v[40:43], v[180:183], v[196:199], v[40:43]
    v_mfma_f32_16x16x32_bf16 v[44:47], v[180:183], v[204:207], v[44:47]
    v_mfma_f32_16x16x32_bf16 v[0:3], v[96:99], v[128:131], v[0:3]
    ds_read_b128 v[152:155], v216 offset:0
    v_mfma_f32_16x16x32_bf16 v[4:7], v[96:99], v[136:139], v[4:7]
    v_mfma_f32_16x16x32_bf16 v[8:11], v[96:99], v[144:147], v[8:11]
    ds_read_b128 v[184:187], v210 offset:0
    v_mfma_f32_16x16x32_bf16 v[12:15], v[104:107], v[128:131], v[12:15]
    v_mfma_f32_16x16x32_bf16 v[16:19], v[104:107], v[136:139], v[16:19]
    ds_read_b128 v[192:195], v210 offset:2048
    v_mfma_f32_16x16x32_bf16 v[20:23], v[104:107], v[144:147], v[20:23]
    v_mfma_f32_16x16x32_bf16 v[24:27], v[112:115], v[128:131], v[24:27]
    ds_read_b128 v[200:203], v210 offset:4096
    v_mfma_f32_16x16x32_bf16 v[28:31], v[112:115], v[136:139], v[28:31]
    v_mfma_f32_16x16x32_bf16 v[32:35], v[112:115], v[144:147], v[32:35]
    ds_read_b128 v[160:163], v216 offset:2048
    v_mfma_f32_16x16x32_bf16 v[36:39], v[120:123], v[128:131], v[36:39]
    v_mfma_f32_16x16x32_bf16 v[40:43], v[120:123], v[136:139], v[40:43]
    ds_read_b128 v[168:171], v216 offset:4096
    v_mfma_f32_16x16x32_bf16 v[44:47], v[120:123], v[144:147], v[44:47]
    v_mfma_f32_16x16x32_bf16 v[48:51], v[96:99], v[132:135], v[48:51]
    ds_read_b128 v[176:179], v216 offset:6144
    v_mfma_f32_16x16x32_bf16 v[52:55], v[96:99], v[140:143], v[52:55]
    v_mfma_f32_16x16x32_bf16 v[56:59], v[96:99], v[148:151], v[56:59]
    ds_read_b128 v[188:191], v213 offset:0
    v_mfma_f32_16x16x32_bf16 v[60:63], v[104:107], v[132:135], v[60:63]
    v_mfma_f32_16x16x32_bf16 v[64:67], v[104:107], v[140:143], v[64:67]
    ds_read_b128 v[196:199], v213 offset:2048
    v_mfma_f32_16x16x32_bf16 v[68:71], v[104:107], v[148:151], v[68:71]
    v_mfma_f32_16x16x32_bf16 v[72:75], v[112:115], v[132:135], v[72:75]
    ds_read_b128 v[204:207], v213 offset:4096
    v_mfma_f32_16x16x32_bf16 v[76:79], v[112:115], v[140:143], v[76:79]
    v_mfma_f32_16x16x32_bf16 v[80:83], v[112:115], v[148:151], v[80:83]
    ds_read_b128 v[156:159], v216 offset:1024
    v_mfma_f32_16x16x32_bf16 v[84:87], v[120:123], v[132:135], v[84:87]
    v_mfma_f32_16x16x32_bf16 v[88:91], v[120:123], v[140:143], v[88:91]
    ds_read_b128 v[164:167], v216 offset:3072
    v_mfma_f32_16x16x32_bf16 v[92:95], v[120:123], v[148:151], v[92:95]
    v_mfma_f32_16x16x32_bf16 v[48:51], v[100:103], v[128:131], v[48:51]
    ds_read_b128 v[172:175], v216 offset:5120
    v_xor_b32 v132, s34, v132
    v_xor_b32 v133, s34, v133
    v_mfma_f32_16x16x32_bf16 v[52:55], v[100:103], v[136:139], v[52:55]
    v_xor_b32 v134, s34, v134
    v_xor_b32 v135, s34, v135
    v_mfma_f32_16x16x32_bf16 v[56:59], v[100:103], v[144:147], v[56:59]
    ds_read_b128 v[180:183], v216 offset:7168
    v_xor_b32 v140, s34, v140
    v_xor_b32 v141, s34, v141
    v_mfma_f32_16x16x32_bf16 v[60:63], v[108:111], v[128:131], v[60:63]
    v_xor_b32 v142, s34, v142
    v_xor_b32 v143, s34, v143
    v_mfma_f32_16x16x32_bf16 v[64:67], v[108:111], v[136:139], v[64:67]
    v_xor_b32 v148, s34, v148
    v_xor_b32 v149, s34, v149
    v_mfma_f32_16x16x32_bf16 v[68:71], v[108:111], v[144:147], v[68:71]
    v_xor_b32 v150, s34, v150
    v_xor_b32 v151, s34, v151
    v_mfma_f32_16x16x32_bf16 v[72:75], v[116:119], v[128:131], v[72:75]
    v_mfma_f32_16x16x32_bf16 v[76:79], v[116:119], v[136:139], v[76:79]
    v_mfma_f32_16x16x32_bf16 v[80:83], v[116:119], v[144:147], v[80:83]
    v_mfma_f32_16x16x32_bf16 v[84:87], v[124:127], v[128:131], v[84:87]
    v_mfma_f32_16x16x32_bf16 v[88:91], v[124:127], v[136:139], v[88:91]
    v_mfma_f32_16x16x32_bf16 v[92:95], v[124:127], v[144:147], v[92:95]
    v_mfma_f32_16x16x32_bf16 v[0:3], v[100:103], v[132:135], v[0:3]
    v_mfma_f32_16x16x32_bf16 v[4:7], v[100:103], v[140:143], v[4:7]
    v_mfma_f32_16x16x32_bf16 v[8:11], v[100:103], v[148:151], v[8:11]
    v_mfma_f32_16x16x32_bf16 v[12:15], v[108:111], v[132:135], v[12:15]
    v_mfma_f32_16x16x32_bf16 v[16:19], v[108:111], v[140:143], v[16:19]
    s_waitcnt lgkmcnt(0)
    s_barrier
    v_mfma_f32_16x16x32_bf16 v[20:23], v[108:111], v[148:151], v[20:23]
    v_mfma_f32_16x16x32_bf16 v[24:27], v[116:119], v[132:135], v[24:27]
    v_mfma_f32_16x16x32_bf16 v[28:31], v[116:119], v[140:143], v[28:31]
    v_mfma_f32_16x16x32_bf16 v[32:35], v[116:119], v[148:151], v[32:35]
    v_mfma_f32_16x16x32_bf16 v[36:39], v[124:127], v[132:135], v[36:39]
    v_mfma_f32_16x16x32_bf16 v[40:43], v[124:127], v[140:143], v[40:43]
    v_mfma_f32_16x16x32_bf16 v[44:47], v[124:127], v[148:151], v[44:47]
    v_mfma_f32_16x16x32_bf16 v[0:3], v[152:155], v[184:187], v[0:3]
    ds_read_b128 v[96:99], v214 offset:0
    v_mfma_f32_16x16x32_bf16 v[4:7], v[152:155], v[192:195], v[4:7]
    v_mfma_f32_16x16x32_bf16 v[8:11], v[152:155], v[200:203], v[8:11]
    ds_read_b128 v[128:131], v208 offset:0
    v_mfma_f32_16x16x32_bf16 v[12:15], v[160:163], v[184:187], v[12:15]
    v_mfma_f32_16x16x32_bf16 v[16:19], v[160:163], v[192:195], v[16:19]
    ds_read_b128 v[136:139], v208 offset:2048
    v_mfma_f32_16x16x32_bf16 v[20:23], v[160:163], v[200:203], v[20:23]
    v_mfma_f32_16x16x32_bf16 v[24:27], v[168:171], v[184:187], v[24:27]
    ds_read_b128 v[144:147], v208 offset:4096
    v_mfma_f32_16x16x32_bf16 v[28:31], v[168:171], v[192:195], v[28:31]
    v_mfma_f32_16x16x32_bf16 v[32:35], v[168:171], v[200:203], v[32:35]
    ds_read_b128 v[104:107], v214 offset:2048
    v_mfma_f32_16x16x32_bf16 v[36:39], v[176:179], v[184:187], v[36:39]
    v_mfma_f32_16x16x32_bf16 v[40:43], v[176:179], v[192:195], v[40:43]
    ds_read_b128 v[112:115], v214 offset:4096
    v_mfma_f32_16x16x32_bf16 v[44:47], v[176:179], v[200:203], v[44:47]
    v_mfma_f32_16x16x32_bf16 v[48:51], v[152:155], v[188:191], v[48:51]
    ds_read_b128 v[120:123], v214 offset:6144
    v_mfma_f32_16x16x32_bf16 v[52:55], v[152:155], v[196:199], v[52:55]
    v_mfma_f32_16x16x32_bf16 v[56:59], v[152:155], v[204:207], v[56:59]
    ds_read_b128 v[132:135], v211 offset:0
    v_mfma_f32_16x16x32_bf16 v[60:63], v[160:163], v[188:191], v[60:63]
    v_mfma_f32_16x16x32_bf16 v[64:67], v[160:163], v[196:199], v[64:67]
    ds_read_b128 v[140:143], v211 offset:2048
    v_mfma_f32_16x16x32_bf16 v[68:71], v[160:163], v[204:207], v[68:71]
    v_mfma_f32_16x16x32_bf16 v[72:75], v[168:171], v[188:191], v[72:75]
    ds_read_b128 v[148:151], v211 offset:4096
    v_mfma_f32_16x16x32_bf16 v[76:79], v[168:171], v[196:199], v[76:79]
    v_mfma_f32_16x16x32_bf16 v[80:83], v[168:171], v[204:207], v[80:83]
    ds_read_b128 v[100:103], v214 offset:1024
    v_mfma_f32_16x16x32_bf16 v[84:87], v[176:179], v[188:191], v[84:87]
    v_mfma_f32_16x16x32_bf16 v[88:91], v[176:179], v[196:199], v[88:91]
    ds_read_b128 v[108:111], v214 offset:3072
    v_mfma_f32_16x16x32_bf16 v[92:95], v[176:179], v[204:207], v[92:95]
    v_mfma_f32_16x16x32_bf16 v[48:51], v[156:159], v[184:187], v[48:51]
    ds_read_b128 v[116:119], v214 offset:5120
    v_xor_b32 v188, s34, v188
    v_xor_b32 v189, s34, v189
    v_mfma_f32_16x16x32_bf16 v[52:55], v[156:159], v[192:195], v[52:55]
    v_xor_b32 v190, s34, v190
    v_xor_b32 v191, s34, v191
    v_mfma_f32_16x16x32_bf16 v[56:59], v[156:159], v[200:203], v[56:59]
    ds_read_b128 v[124:127], v214 offset:7168
    v_xor_b32 v196, s34, v196
    v_xor_b32 v197, s34, v197
    v_mfma_f32_16x16x32_bf16 v[60:63], v[164:167], v[184:187], v[60:63]
    v_xor_b32 v198, s34, v198
    v_xor_b32 v199, s34, v199
    v_mfma_f32_16x16x32_bf16 v[64:67], v[164:167], v[192:195], v[64:67]
    v_xor_b32 v204, s34, v204
    v_xor_b32 v205, s34, v205
    v_mfma_f32_16x16x32_bf16 v[68:71], v[164:167], v[200:203], v[68:71]
    v_xor_b32 v206, s34, v206
    v_xor_b32 v207, s34, v207
    v_mfma_f32_16x16x32_bf16 v[72:75], v[172:175], v[184:187], v[72:75]
    v_mfma_f32_16x16x32_bf16 v[76:79], v[172:175], v[192:195], v[76:79]
    v_mfma_f32_16x16x32_bf16 v[80:83], v[172:175], v[200:203], v[80:83]
    v_mfma_f32_16x16x32_bf16 v[84:87], v[180:183], v[184:187], v[84:87]
    v_mfma_f32_16x16x32_bf16 v[88:91], v[180:183], v[192:195], v[88:91]
    v_mfma_f32_16x16x32_bf16 v[92:95], v[180:183], v[200:203], v[92:95]
    v_mfma_f32_16x16x32_bf16 v[0:3], v[156:159], v[188:191], v[0:3]
    v_mfma_f32_16x16x32_bf16 v[4:7], v[156:159], v[196:199], v[4:7]
    v_mfma_f32_16x16x32_bf16 v[8:11], v[156:159], v[204:207], v[8:11]
    v_mfma_f32_16x16x32_bf16 v[12:15], v[164:167], v[188:191], v[12:15]
    v_mfma_f32_16x16x32_bf16 v[16:19], v[164:167], v[196:199], v[16:19]
    s_waitcnt lgkmcnt(0)
    s_barrier
    v_mfma_f32_16x16x32_bf16 v[20:23], v[164:167], v[204:207], v[20:23]
    v_mfma_f32_16x16x32_bf16 v[24:27], v[172:175], v[188:191], v[24:27]
    v_mfma_f32_16x16x32_bf16 v[28:31], v[172:175], v[196:199], v[28:31]
    v_mfma_f32_16x16x32_bf16 v[32:35], v[172:175], v[204:207], v[32:35]
    v_mfma_f32_16x16x32_bf16 v[36:39], v[180:183], v[188:191], v[36:39]
    v_mfma_f32_16x16x32_bf16 v[40:43], v[180:183], v[196:199], v[40:43]
    v_mfma_f32_16x16x32_bf16 v[44:47], v[180:183], v[204:207], v[44:47]
    v_mfma_f32_16x16x32_bf16 v[0:3], v[96:99], v[128:131], v[0:3]
    ds_read_b128 v[152:155], v214 offset:28672
    v_mfma_f32_16x16x32_bf16 v[4:7], v[96:99], v[136:139], v[4:7]
    v_mfma_f32_16x16x32_bf16 v[8:11], v[96:99], v[144:147], v[8:11]
    ds_read_b128 v[184:187], v208 offset:28672
    v_mfma_f32_16x16x32_bf16 v[12:15], v[104:107], v[128:131], v[12:15]
    v_mfma_f32_16x16x32_bf16 v[16:19], v[104:107], v[136:139], v[16:19]
    ds_read_b128 v[192:195], v208 offset:30720
    v_mfma_f32_16x16x32_bf16 v[20:23], v[104:107], v[144:147], v[20:23]
    v_mfma_f32_16x16x32_bf16 v[24:27], v[112:115], v[128:131], v[24:27]
    ds_read_b128 v[200:203], v208 offset:32768
    v_mfma_f32_16x16x32_bf16 v[28:31], v[112:115], v[136:139], v[28:31]
    v_mfma_f32_16x16x32_bf16 v[32:35], v[112:115], v[144:147], v[32:35]
    ds_read_b128 v[160:163], v214 offset:30720
    v_mfma_f32_16x16x32_bf16 v[36:39], v[120:123], v[128:131], v[36:39]
    v_mfma_f32_16x16x32_bf16 v[40:43], v[120:123], v[136:139], v[40:43]
    ds_read_b128 v[168:171], v214 offset:32768
    v_mfma_f32_16x16x32_bf16 v[44:47], v[120:123], v[144:147], v[44:47]
    v_mfma_f32_16x16x32_bf16 v[48:51], v[96:99], v[132:135], v[48:51]
    ds_read_b128 v[176:179], v214 offset:34816
    v_mfma_f32_16x16x32_bf16 v[52:55], v[96:99], v[140:143], v[52:55]
    v_mfma_f32_16x16x32_bf16 v[56:59], v[96:99], v[148:151], v[56:59]
    ds_read_b128 v[188:191], v211 offset:28672
    v_mfma_f32_16x16x32_bf16 v[60:63], v[104:107], v[132:135], v[60:63]
    v_mfma_f32_16x16x32_bf16 v[64:67], v[104:107], v[140:143], v[64:67]
    ds_read_b128 v[196:199], v211 offset:30720
    v_mfma_f32_16x16x32_bf16 v[68:71], v[104:107], v[148:151], v[68:71]
    v_mfma_f32_16x16x32_bf16 v[72:75], v[112:115], v[132:135], v[72:75]
    ds_read_b128 v[204:207], v211 offset:32768
    v_mfma_f32_16x16x32_bf16 v[76:79], v[112:115], v[140:143], v[76:79]
    v_mfma_f32_16x16x32_bf16 v[80:83], v[112:115], v[148:151], v[80:83]
    ds_read_b128 v[156:159], v214 offset:29696
    v_mfma_f32_16x16x32_bf16 v[84:87], v[120:123], v[132:135], v[84:87]
    v_mfma_f32_16x16x32_bf16 v[88:91], v[120:123], v[140:143], v[88:91]
    ds_read_b128 v[164:167], v214 offset:31744
    v_mfma_f32_16x16x32_bf16 v[92:95], v[120:123], v[148:151], v[92:95]
    v_mfma_f32_16x16x32_bf16 v[48:51], v[100:103], v[128:131], v[48:51]
    ds_read_b128 v[172:175], v214 offset:33792
    v_xor_b32 v132, s34, v132
    v_xor_b32 v133, s34, v133
    v_mfma_f32_16x16x32_bf16 v[52:55], v[100:103], v[136:139], v[52:55]
    v_xor_b32 v134, s34, v134
    v_xor_b32 v135, s34, v135
    v_mfma_f32_16x16x32_bf16 v[56:59], v[100:103], v[144:147], v[56:59]
    ds_read_b128 v[180:183], v214 offset:35840
    v_xor_b32 v140, s34, v140
    v_xor_b32 v141, s34, v141
    v_mfma_f32_16x16x32_bf16 v[60:63], v[108:111], v[128:131], v[60:63]
    v_xor_b32 v142, s34, v142
    v_xor_b32 v143, s34, v143
    v_mfma_f32_16x16x32_bf16 v[64:67], v[108:111], v[136:139], v[64:67]
    v_xor_b32 v148, s34, v148
    v_xor_b32 v149, s34, v149
    v_mfma_f32_16x16x32_bf16 v[68:71], v[108:111], v[144:147], v[68:71]
    v_xor_b32 v150, s34, v150
    v_xor_b32 v151, s34, v151
    v_mfma_f32_16x16x32_bf16 v[72:75], v[116:119], v[128:131], v[72:75]
    v_mfma_f32_16x16x32_bf16 v[76:79], v[116:119], v[136:139], v[76:79]
    v_mfma_f32_16x16x32_bf16 v[80:83], v[116:119], v[144:147], v[80:83]
    v_mfma_f32_16x16x32_bf16 v[84:87], v[124:127], v[128:131], v[84:87]
    v_mfma_f32_16x16x32_bf16 v[88:91], v[124:127], v[136:139], v[88:91]
    v_mfma_f32_16x16x32_bf16 v[92:95], v[124:127], v[144:147], v[92:95]
    v_mfma_f32_16x16x32_bf16 v[0:3], v[100:103], v[132:135], v[0:3]
    v_mfma_f32_16x16x32_bf16 v[4:7], v[100:103], v[140:143], v[4:7]
    v_mfma_f32_16x16x32_bf16 v[8:11], v[100:103], v[148:151], v[8:11]
    v_mfma_f32_16x16x32_bf16 v[12:15], v[108:111], v[132:135], v[12:15]
    v_mfma_f32_16x16x32_bf16 v[16:19], v[108:111], v[140:143], v[16:19]
    s_waitcnt lgkmcnt(0)
    s_barrier
    v_mfma_f32_16x16x32_bf16 v[20:23], v[108:111], v[148:151], v[20:23]
    v_mfma_f32_16x16x32_bf16 v[24:27], v[116:119], v[132:135], v[24:27]
    v_mfma_f32_16x16x32_bf16 v[28:31], v[116:119], v[140:143], v[28:31]
    v_mfma_f32_16x16x32_bf16 v[32:35], v[116:119], v[148:151], v[32:35]
    v_mfma_f32_16x16x32_bf16 v[36:39], v[124:127], v[132:135], v[36:39]
    v_mfma_f32_16x16x32_bf16 v[40:43], v[124:127], v[140:143], v[40:43]
    v_mfma_f32_16x16x32_bf16 v[44:47], v[124:127], v[148:151], v[44:47]
    v_mfma_f32_16x16x32_bf16 v[0:3], v[152:155], v[184:187], v[0:3]
    ds_read_b128 v[96:99], v215 offset:0
    v_mfma_f32_16x16x32_bf16 v[4:7], v[152:155], v[192:195], v[4:7]
    v_mfma_f32_16x16x32_bf16 v[8:11], v[152:155], v[200:203], v[8:11]
    ds_read_b128 v[128:131], v209 offset:0
    v_mfma_f32_16x16x32_bf16 v[12:15], v[160:163], v[184:187], v[12:15]
    v_mfma_f32_16x16x32_bf16 v[16:19], v[160:163], v[192:195], v[16:19]
    ds_read_b128 v[136:139], v209 offset:2048
    v_mfma_f32_16x16x32_bf16 v[20:23], v[160:163], v[200:203], v[20:23]
    v_mfma_f32_16x16x32_bf16 v[24:27], v[168:171], v[184:187], v[24:27]
    ds_read_b128 v[144:147], v209 offset:4096
    v_mfma_f32_16x16x32_bf16 v[28:31], v[168:171], v[192:195], v[28:31]
    v_mfma_f32_16x16x32_bf16 v[32:35], v[168:171], v[200:203], v[32:35]
    ds_read_b128 v[104:107], v215 offset:2048
    v_mfma_f32_16x16x32_bf16 v[36:39], v[176:179], v[184:187], v[36:39]
    v_mfma_f32_16x16x32_bf16 v[40:43], v[176:179], v[192:195], v[40:43]
    ds_read_b128 v[112:115], v215 offset:4096
    v_mfma_f32_16x16x32_bf16 v[44:47], v[176:179], v[200:203], v[44:47]
    v_mfma_f32_16x16x32_bf16 v[48:51], v[152:155], v[188:191], v[48:51]
    ds_read_b128 v[120:123], v215 offset:6144
    v_mfma_f32_16x16x32_bf16 v[52:55], v[152:155], v[196:199], v[52:55]
    v_mfma_f32_16x16x32_bf16 v[56:59], v[152:155], v[204:207], v[56:59]
    ds_read_b128 v[132:135], v212 offset:0
    v_mfma_f32_16x16x32_bf16 v[60:63], v[160:163], v[188:191], v[60:63]
    v_mfma_f32_16x16x32_bf16 v[64:67], v[160:163], v[196:199], v[64:67]
    ds_read_b128 v[140:143], v212 offset:2048
    v_mfma_f32_16x16x32_bf16 v[68:71], v[160:163], v[204:207], v[68:71]
    v_mfma_f32_16x16x32_bf16 v[72:75], v[168:171], v[188:191], v[72:75]
    ds_read_b128 v[148:151], v212 offset:4096
    v_mfma_f32_16x16x32_bf16 v[76:79], v[168:171], v[196:199], v[76:79]
    v_mfma_f32_16x16x32_bf16 v[80:83], v[168:171], v[204:207], v[80:83]
    ds_read_b128 v[100:103], v215 offset:1024
    v_mfma_f32_16x16x32_bf16 v[84:87], v[176:179], v[188:191], v[84:87]
    v_mfma_f32_16x16x32_bf16 v[88:91], v[176:179], v[196:199], v[88:91]
    ds_read_b128 v[108:111], v215 offset:3072
    v_mfma_f32_16x16x32_bf16 v[92:95], v[176:179], v[204:207], v[92:95]
    v_mfma_f32_16x16x32_bf16 v[48:51], v[156:159], v[184:187], v[48:51]
    ds_read_b128 v[116:119], v215 offset:5120
    v_xor_b32 v188, s34, v188
    v_xor_b32 v189, s34, v189
    v_mfma_f32_16x16x32_bf16 v[52:55], v[156:159], v[192:195], v[52:55]
    v_xor_b32 v190, s34, v190
    v_xor_b32 v191, s34, v191
    v_mfma_f32_16x16x32_bf16 v[56:59], v[156:159], v[200:203], v[56:59]
    ds_read_b128 v[124:127], v215 offset:7168
    v_xor_b32 v196, s34, v196
    v_xor_b32 v197, s34, v197
    v_mfma_f32_16x16x32_bf16 v[60:63], v[164:167], v[184:187], v[60:63]
    v_xor_b32 v198, s34, v198
    v_xor_b32 v199, s34, v199
    v_mfma_f32_16x16x32_bf16 v[64:67], v[164:167], v[192:195], v[64:67]
    v_xor_b32 v204, s34, v204
    v_xor_b32 v205, s34, v205
    v_mfma_f32_16x16x32_bf16 v[68:71], v[164:167], v[200:203], v[68:71]
    v_xor_b32 v206, s34, v206
    v_xor_b32 v207, s34, v207
    v_mfma_f32_16x16x32_bf16 v[72:75], v[172:175], v[184:187], v[72:75]
    v_mfma_f32_16x16x32_bf16 v[76:79], v[172:175], v[192:195], v[76:79]
    v_mfma_f32_16x16x32_bf16 v[80:83], v[172:175], v[200:203], v[80:83]
    v_mfma_f32_16x16x32_bf16 v[84:87], v[180:183], v[184:187], v[84:87]
    v_mfma_f32_16x16x32_bf16 v[88:91], v[180:183], v[192:195], v[88:91]
    v_mfma_f32_16x16x32_bf16 v[92:95], v[180:183], v[200:203], v[92:95]
    v_mfma_f32_16x16x32_bf16 v[0:3], v[156:159], v[188:191], v[0:3]
    v_mfma_f32_16x16x32_bf16 v[4:7], v[156:159], v[196:199], v[4:7]
    v_mfma_f32_16x16x32_bf16 v[8:11], v[156:159], v[204:207], v[8:11]
    v_mfma_f32_16x16x32_bf16 v[12:15], v[164:167], v[188:191], v[12:15]
    v_mfma_f32_16x16x32_bf16 v[16:19], v[164:167], v[196:199], v[16:19]
    s_waitcnt lgkmcnt(0)
    s_barrier
    v_mfma_f32_16x16x32_bf16 v[20:23], v[164:167], v[204:207], v[20:23]
    v_mfma_f32_16x16x32_bf16 v[24:27], v[172:175], v[188:191], v[24:27]
    v_mfma_f32_16x16x32_bf16 v[28:31], v[172:175], v[196:199], v[28:31]
    v_mfma_f32_16x16x32_bf16 v[32:35], v[172:175], v[204:207], v[32:35]
    v_mfma_f32_16x16x32_bf16 v[36:39], v[180:183], v[188:191], v[36:39]
    v_mfma_f32_16x16x32_bf16 v[40:43], v[180:183], v[196:199], v[40:43]
    v_mfma_f32_16x16x32_bf16 v[44:47], v[180:183], v[204:207], v[44:47]
    v_mfma_f32_16x16x32_bf16 v[0:3], v[96:99], v[128:131], v[0:3]
    ds_read_b128 v[152:155], v215 offset:28672
    v_mfma_f32_16x16x32_bf16 v[4:7], v[96:99], v[136:139], v[4:7]
    v_mfma_f32_16x16x32_bf16 v[8:11], v[96:99], v[144:147], v[8:11]
    ds_read_b128 v[184:187], v209 offset:28672
    v_mfma_f32_16x16x32_bf16 v[12:15], v[104:107], v[128:131], v[12:15]
    v_mfma_f32_16x16x32_bf16 v[16:19], v[104:107], v[136:139], v[16:19]
    ds_read_b128 v[192:195], v209 offset:30720
    v_mfma_f32_16x16x32_bf16 v[20:23], v[104:107], v[144:147], v[20:23]
    v_mfma_f32_16x16x32_bf16 v[24:27], v[112:115], v[128:131], v[24:27]
    ds_read_b128 v[200:203], v209 offset:32768
    v_mfma_f32_16x16x32_bf16 v[28:31], v[112:115], v[136:139], v[28:31]
    v_mfma_f32_16x16x32_bf16 v[32:35], v[112:115], v[144:147], v[32:35]
    ds_read_b128 v[160:163], v215 offset:30720
    v_mfma_f32_16x16x32_bf16 v[36:39], v[120:123], v[128:131], v[36:39]
    v_mfma_f32_16x16x32_bf16 v[40:43], v[120:123], v[136:139], v[40:43]
    ds_read_b128 v[168:171], v215 offset:32768
    v_mfma_f32_16x16x32_bf16 v[44:47], v[120:123], v[144:147], v[44:47]
    v_mfma_f32_16x16x32_bf16 v[48:51], v[96:99], v[132:135], v[48:51]
    ds_read_b128 v[176:179], v215 offset:34816
    v_mfma_f32_16x16x32_bf16 v[52:55], v[96:99], v[140:143], v[52:55]
    v_mfma_f32_16x16x32_bf16 v[56:59], v[96:99], v[148:151], v[56:59]
    ds_read_b128 v[188:191], v212 offset:28672
    v_mfma_f32_16x16x32_bf16 v[60:63], v[104:107], v[132:135], v[60:63]
    v_mfma_f32_16x16x32_bf16 v[64:67], v[104:107], v[140:143], v[64:67]
    ds_read_b128 v[196:199], v212 offset:30720
    v_mfma_f32_16x16x32_bf16 v[68:71], v[104:107], v[148:151], v[68:71]
    v_mfma_f32_16x16x32_bf16 v[72:75], v[112:115], v[132:135], v[72:75]
    ds_read_b128 v[204:207], v212 offset:32768
    v_mfma_f32_16x16x32_bf16 v[76:79], v[112:115], v[140:143], v[76:79]
    v_mfma_f32_16x16x32_bf16 v[80:83], v[112:115], v[148:151], v[80:83]
    ds_read_b128 v[156:159], v215 offset:29696
    v_mfma_f32_16x16x32_bf16 v[84:87], v[120:123], v[132:135], v[84:87]
    v_mfma_f32_16x16x32_bf16 v[88:91], v[120:123], v[140:143], v[88:91]
    ds_read_b128 v[164:167], v215 offset:31744
    v_mfma_f32_16x16x32_bf16 v[92:95], v[120:123], v[148:151], v[92:95]
    v_mfma_f32_16x16x32_bf16 v[48:51], v[100:103], v[128:131], v[48:51]
    ds_read_b128 v[172:175], v215 offset:33792
    v_xor_b32 v132, s34, v132
    v_xor_b32 v133, s34, v133
    v_mfma_f32_16x16x32_bf16 v[52:55], v[100:103], v[136:139], v[52:55]
    v_xor_b32 v134, s34, v134
    v_xor_b32 v135, s34, v135
    v_mfma_f32_16x16x32_bf16 v[56:59], v[100:103], v[144:147], v[56:59]
    ds_read_b128 v[180:183], v215 offset:35840
    v_xor_b32 v140, s34, v140
    v_xor_b32 v141, s34, v141
    v_mfma_f32_16x16x32_bf16 v[60:63], v[108:111], v[128:131], v[60:63]
    v_xor_b32 v142, s34, v142
    v_xor_b32 v143, s34, v143
    v_mfma_f32_16x16x32_bf16 v[64:67], v[108:111], v[136:139], v[64:67]
    v_xor_b32 v148, s34, v148
    v_xor_b32 v149, s34, v149
    v_mfma_f32_16x16x32_bf16 v[68:71], v[108:111], v[144:147], v[68:71]
    v_xor_b32 v150, s34, v150
    v_xor_b32 v151, s34, v151
    v_mfma_f32_16x16x32_bf16 v[72:75], v[116:119], v[128:131], v[72:75]
    v_mfma_f32_16x16x32_bf16 v[76:79], v[116:119], v[136:139], v[76:79]
    v_mfma_f32_16x16x32_bf16 v[80:83], v[116:119], v[144:147], v[80:83]
    v_mfma_f32_16x16x32_bf16 v[84:87], v[124:127], v[128:131], v[84:87]
    v_mfma_f32_16x16x32_bf16 v[88:91], v[124:127], v[136:139], v[88:91]
    v_mfma_f32_16x16x32_bf16 v[92:95], v[124:127], v[144:147], v[92:95]
    v_mfma_f32_16x16x32_bf16 v[0:3], v[100:103], v[132:135], v[0:3]
    v_mfma_f32_16x16x32_bf16 v[4:7], v[100:103], v[140:143], v[4:7]
    v_mfma_f32_16x16x32_bf16 v[8:11], v[100:103], v[148:151], v[8:11]
    v_mfma_f32_16x16x32_bf16 v[12:15], v[108:111], v[132:135], v[12:15]
    v_mfma_f32_16x16x32_bf16 v[16:19], v[108:111], v[140:143], v[16:19]
    s_waitcnt lgkmcnt(0)
    s_barrier
    v_mfma_f32_16x16x32_bf16 v[20:23], v[108:111], v[148:151], v[20:23]
    v_mfma_f32_16x16x32_bf16 v[24:27], v[116:119], v[132:135], v[24:27]
    v_mfma_f32_16x16x32_bf16 v[28:31], v[116:119], v[140:143], v[28:31]
    v_mfma_f32_16x16x32_bf16 v[32:35], v[116:119], v[148:151], v[32:35]
    v_mfma_f32_16x16x32_bf16 v[36:39], v[124:127], v[132:135], v[36:39]
    v_mfma_f32_16x16x32_bf16 v[40:43], v[124:127], v[140:143], v[40:43]
    v_mfma_f32_16x16x32_bf16 v[44:47], v[124:127], v[148:151], v[44:47]
    v_mfma_f32_16x16x32_bf16 v[0:3], v[152:155], v[184:187], v[0:3]
    ds_read_b128 v[96:99], v216 offset:0
    v_mfma_f32_16x16x32_bf16 v[4:7], v[152:155], v[192:195], v[4:7]
    v_mfma_f32_16x16x32_bf16 v[8:11], v[152:155], v[200:203], v[8:11]
    ds_read_b128 v[128:131], v210 offset:0
    v_mfma_f32_16x16x32_bf16 v[12:15], v[160:163], v[184:187], v[12:15]
    v_mfma_f32_16x16x32_bf16 v[16:19], v[160:163], v[192:195], v[16:19]
    ds_read_b128 v[136:139], v210 offset:2048
    v_mfma_f32_16x16x32_bf16 v[20:23], v[160:163], v[200:203], v[20:23]
    v_mfma_f32_16x16x32_bf16 v[24:27], v[168:171], v[184:187], v[24:27]
    ds_read_b128 v[144:147], v210 offset:4096
    v_mfma_f32_16x16x32_bf16 v[28:31], v[168:171], v[192:195], v[28:31]
    v_mfma_f32_16x16x32_bf16 v[32:35], v[168:171], v[200:203], v[32:35]
    ds_read_b128 v[104:107], v216 offset:2048
    v_mfma_f32_16x16x32_bf16 v[36:39], v[176:179], v[184:187], v[36:39]
    v_mfma_f32_16x16x32_bf16 v[40:43], v[176:179], v[192:195], v[40:43]
    ds_read_b128 v[112:115], v216 offset:4096
    v_mfma_f32_16x16x32_bf16 v[44:47], v[176:179], v[200:203], v[44:47]
    v_mfma_f32_16x16x32_bf16 v[48:51], v[152:155], v[188:191], v[48:51]
    ds_read_b128 v[120:123], v216 offset:6144
    v_mfma_f32_16x16x32_bf16 v[52:55], v[152:155], v[196:199], v[52:55]
    v_mfma_f32_16x16x32_bf16 v[56:59], v[152:155], v[204:207], v[56:59]
    ds_read_b128 v[132:135], v213 offset:0
    v_mfma_f32_16x16x32_bf16 v[60:63], v[160:163], v[188:191], v[60:63]
    v_mfma_f32_16x16x32_bf16 v[64:67], v[160:163], v[196:199], v[64:67]
    ds_read_b128 v[140:143], v213 offset:2048
    v_mfma_f32_16x16x32_bf16 v[68:71], v[160:163], v[204:207], v[68:71]
    v_mfma_f32_16x16x32_bf16 v[72:75], v[168:171], v[188:191], v[72:75]
    ds_read_b128 v[148:151], v213 offset:4096
    v_mfma_f32_16x16x32_bf16 v[76:79], v[168:171], v[196:199], v[76:79]
    v_mfma_f32_16x16x32_bf16 v[80:83], v[168:171], v[204:207], v[80:83]
    ds_read_b128 v[100:103], v216 offset:1024
    v_mfma_f32_16x16x32_bf16 v[84:87], v[176:179], v[188:191], v[84:87]
    v_mfma_f32_16x16x32_bf16 v[88:91], v[176:179], v[196:199], v[88:91]
    ds_read_b128 v[108:111], v216 offset:3072
    v_mfma_f32_16x16x32_bf16 v[92:95], v[176:179], v[204:207], v[92:95]
    v_mfma_f32_16x16x32_bf16 v[48:51], v[156:159], v[184:187], v[48:51]
    ds_read_b128 v[116:119], v216 offset:5120
    v_xor_b32 v188, s34, v188
    v_xor_b32 v189, s34, v189
    v_mfma_f32_16x16x32_bf16 v[52:55], v[156:159], v[192:195], v[52:55]
    v_xor_b32 v190, s34, v190
    v_xor_b32 v191, s34, v191
    v_mfma_f32_16x16x32_bf16 v[56:59], v[156:159], v[200:203], v[56:59]
    ds_read_b128 v[124:127], v216 offset:7168
    v_xor_b32 v196, s34, v196
    v_xor_b32 v197, s34, v197
    v_mfma_f32_16x16x32_bf16 v[60:63], v[164:167], v[184:187], v[60:63]
    v_xor_b32 v198, s34, v198
    v_xor_b32 v199, s34, v199
    v_mfma_f32_16x16x32_bf16 v[64:67], v[164:167], v[192:195], v[64:67]
    v_xor_b32 v204, s34, v204
    v_xor_b32 v205, s34, v205
    v_mfma_f32_16x16x32_bf16 v[68:71], v[164:167], v[200:203], v[68:71]
    v_xor_b32 v206, s34, v206
    v_xor_b32 v207, s34, v207
    v_mfma_f32_16x16x32_bf16 v[72:75], v[172:175], v[184:187], v[72:75]
    v_mfma_f32_16x16x32_bf16 v[76:79], v[172:175], v[192:195], v[76:79]
    v_mfma_f32_16x16x32_bf16 v[80:83], v[172:175], v[200:203], v[80:83]
    v_mfma_f32_16x16x32_bf16 v[84:87], v[180:183], v[184:187], v[84:87]
    v_mfma_f32_16x16x32_bf16 v[88:91], v[180:183], v[192:195], v[88:91]
    v_mfma_f32_16x16x32_bf16 v[92:95], v[180:183], v[200:203], v[92:95]
    v_mfma_f32_16x16x32_bf16 v[0:3], v[156:159], v[188:191], v[0:3]
    v_mfma_f32_16x16x32_bf16 v[4:7], v[156:159], v[196:199], v[4:7]
    v_mfma_f32_16x16x32_bf16 v[8:11], v[156:159], v[204:207], v[8:11]
    v_mfma_f32_16x16x32_bf16 v[12:15], v[164:167], v[188:191], v[12:15]
    v_mfma_f32_16x16x32_bf16 v[16:19], v[164:167], v[196:199], v[16:19]
    s_waitcnt lgkmcnt(0)
    s_barrier
    v_mfma_f32_16x16x32_bf16 v[20:23], v[164:167], v[204:207], v[20:23]
    v_mfma_f32_16x16x32_bf16 v[24:27], v[172:175], v[188:191], v[24:27]
    v_mfma_f32_16x16x32_bf16 v[28:31], v[172:175], v[196:199], v[28:31]
    v_mfma_f32_16x16x32_bf16 v[32:35], v[172:175], v[204:207], v[32:35]
    v_mfma_f32_16x16x32_bf16 v[36:39], v[180:183], v[188:191], v[36:39]
    v_mfma_f32_16x16x32_bf16 v[40:43], v[180:183], v[196:199], v[40:43]
    v_mfma_f32_16x16x32_bf16 v[44:47], v[180:183], v[204:207], v[44:47]
    v_mfma_f32_16x16x32_bf16 v[0:3], v[96:99], v[128:131], v[0:3]
    ds_read_b128 v[152:155], v214 offset:0
    v_mfma_f32_16x16x32_bf16 v[4:7], v[96:99], v[136:139], v[4:7]
    v_mfma_f32_16x16x32_bf16 v[8:11], v[96:99], v[144:147], v[8:11]
    ds_read_b128 v[184:187], v208 offset:0
    v_mfma_f32_16x16x32_bf16 v[12:15], v[104:107], v[128:131], v[12:15]
    v_mfma_f32_16x16x32_bf16 v[16:19], v[104:107], v[136:139], v[16:19]
    ds_read_b128 v[192:195], v208 offset:2048
    v_mfma_f32_16x16x32_bf16 v[20:23], v[104:107], v[144:147], v[20:23]
    v_mfma_f32_16x16x32_bf16 v[24:27], v[112:115], v[128:131], v[24:27]
    ds_read_b128 v[200:203], v208 offset:4096
    v_mfma_f32_16x16x32_bf16 v[28:31], v[112:115], v[136:139], v[28:31]
    v_mfma_f32_16x16x32_bf16 v[32:35], v[112:115], v[144:147], v[32:35]
    ds_read_b128 v[160:163], v214 offset:2048
    v_mfma_f32_16x16x32_bf16 v[36:39], v[120:123], v[128:131], v[36:39]
    v_mfma_f32_16x16x32_bf16 v[40:43], v[120:123], v[136:139], v[40:43]
    ds_read_b128 v[168:171], v214 offset:4096
    v_mfma_f32_16x16x32_bf16 v[44:47], v[120:123], v[144:147], v[44:47]
    v_mfma_f32_16x16x32_bf16 v[48:51], v[96:99], v[132:135], v[48:51]
    ds_read_b128 v[176:179], v214 offset:6144
    v_mfma_f32_16x16x32_bf16 v[52:55], v[96:99], v[140:143], v[52:55]
    v_mfma_f32_16x16x32_bf16 v[56:59], v[96:99], v[148:151], v[56:59]
    ds_read_b128 v[188:191], v211 offset:0
    v_mfma_f32_16x16x32_bf16 v[60:63], v[104:107], v[132:135], v[60:63]
    v_mfma_f32_16x16x32_bf16 v[64:67], v[104:107], v[140:143], v[64:67]
    ds_read_b128 v[196:199], v211 offset:2048
    v_mfma_f32_16x16x32_bf16 v[68:71], v[104:107], v[148:151], v[68:71]
    v_mfma_f32_16x16x32_bf16 v[72:75], v[112:115], v[132:135], v[72:75]
    ds_read_b128 v[204:207], v211 offset:4096
    v_mfma_f32_16x16x32_bf16 v[76:79], v[112:115], v[140:143], v[76:79]
    v_mfma_f32_16x16x32_bf16 v[80:83], v[112:115], v[148:151], v[80:83]
    ds_read_b128 v[156:159], v214 offset:1024
    v_mfma_f32_16x16x32_bf16 v[84:87], v[120:123], v[132:135], v[84:87]
    v_mfma_f32_16x16x32_bf16 v[88:91], v[120:123], v[140:143], v[88:91]
    ds_read_b128 v[164:167], v214 offset:3072
    v_mfma_f32_16x16x32_bf16 v[92:95], v[120:123], v[148:151], v[92:95]
    v_mfma_f32_16x16x32_bf16 v[48:51], v[100:103], v[128:131], v[48:51]
    ds_read_b128 v[172:175], v214 offset:5120
    v_xor_b32 v132, s34, v132
    v_xor_b32 v133, s34, v133
    v_mfma_f32_16x16x32_bf16 v[52:55], v[100:103], v[136:139], v[52:55]
    v_xor_b32 v134, s34, v134
    v_xor_b32 v135, s34, v135
    v_mfma_f32_16x16x32_bf16 v[56:59], v[100:103], v[144:147], v[56:59]
    ds_read_b128 v[180:183], v214 offset:7168
    v_xor_b32 v140, s34, v140
    v_xor_b32 v141, s34, v141
    v_mfma_f32_16x16x32_bf16 v[60:63], v[108:111], v[128:131], v[60:63]
    v_xor_b32 v142, s34, v142
    v_xor_b32 v143, s34, v143
    v_mfma_f32_16x16x32_bf16 v[64:67], v[108:111], v[136:139], v[64:67]
    v_xor_b32 v148, s34, v148
    v_xor_b32 v149, s34, v149
    v_mfma_f32_16x16x32_bf16 v[68:71], v[108:111], v[144:147], v[68:71]
    v_xor_b32 v150, s34, v150
    v_xor_b32 v151, s34, v151
    v_mfma_f32_16x16x32_bf16 v[72:75], v[116:119], v[128:131], v[72:75]
    v_mfma_f32_16x16x32_bf16 v[76:79], v[116:119], v[136:139], v[76:79]
    v_mfma_f32_16x16x32_bf16 v[80:83], v[116:119], v[144:147], v[80:83]
    v_mfma_f32_16x16x32_bf16 v[84:87], v[124:127], v[128:131], v[84:87]
    v_mfma_f32_16x16x32_bf16 v[88:91], v[124:127], v[136:139], v[88:91]
    v_mfma_f32_16x16x32_bf16 v[92:95], v[124:127], v[144:147], v[92:95]
    v_mfma_f32_16x16x32_bf16 v[0:3], v[100:103], v[132:135], v[0:3]
    v_mfma_f32_16x16x32_bf16 v[4:7], v[100:103], v[140:143], v[4:7]
    v_mfma_f32_16x16x32_bf16 v[8:11], v[100:103], v[148:151], v[8:11]
    v_mfma_f32_16x16x32_bf16 v[12:15], v[108:111], v[132:135], v[12:15]
    v_mfma_f32_16x16x32_bf16 v[16:19], v[108:111], v[140:143], v[16:19]
    s_waitcnt lgkmcnt(0)
    v_mfma_f32_16x16x32_bf16 v[20:23], v[108:111], v[148:151], v[20:23]
    v_mfma_f32_16x16x32_bf16 v[24:27], v[116:119], v[132:135], v[24:27]
    v_mfma_f32_16x16x32_bf16 v[28:31], v[116:119], v[140:143], v[28:31]
    v_mfma_f32_16x16x32_bf16 v[32:35], v[116:119], v[148:151], v[32:35]
    v_mfma_f32_16x16x32_bf16 v[36:39], v[124:127], v[132:135], v[36:39]
    v_mfma_f32_16x16x32_bf16 v[40:43], v[124:127], v[140:143], v[40:43]
    v_mfma_f32_16x16x32_bf16 v[44:47], v[124:127], v[148:151], v[44:47]
    v_mfma_f32_16x16x32_bf16 v[0:3], v[152:155], v[184:187], v[0:3]
    v_mfma_f32_16x16x32_bf16 v[4:7], v[152:155], v[192:195], v[4:7]
    v_mfma_f32_16x16x32_bf16 v[8:11], v[152:155], v[200:203], v[8:11]
    v_mfma_f32_16x16x32_bf16 v[12:15], v[160:163], v[184:187], v[12:15]
    v_mfma_f32_16x16x32_bf16 v[16:19], v[160:163], v[192:195], v[16:19]
    v_mfma_f32_16x16x32_bf16 v[20:23], v[160:163], v[200:203], v[20:23]
    v_mfma_f32_16x16x32_bf16 v[24:27], v[168:171], v[184:187], v[24:27]
    v_mfma_f32_16x16x32_bf16 v[28:31], v[168:171], v[192:195], v[28:31]
    v_mfma_f32_16x16x32_bf16 v[32:35], v[168:171], v[200:203], v[32:35]
    v_mfma_f32_16x16x32_bf16 v[36:39], v[176:179], v[184:187], v[36:39]
    v_mfma_f32_16x16x32_bf16 v[40:43], v[176:179], v[192:195], v[40:43]
    v_mfma_f32_16x16x32_bf16 v[44:47], v[176:179], v[200:203], v[44:47]
    v_mfma_f32_16x16x32_bf16 v[48:51], v[152:155], v[188:191], v[48:51]
    v_mfma_f32_16x16x32_bf16 v[52:55], v[152:155], v[196:199], v[52:55]
    v_mfma_f32_16x16x32_bf16 v[56:59], v[152:155], v[204:207], v[56:59]
    v_mfma_f32_16x16x32_bf16 v[60:63], v[160:163], v[188:191], v[60:63]
    v_mfma_f32_16x16x32_bf16 v[64:67], v[160:163], v[196:199], v[64:67]
    v_mfma_f32_16x16x32_bf16 v[68:71], v[160:163], v[204:207], v[68:71]
    v_mfma_f32_16x16x32_bf16 v[72:75], v[168:171], v[188:191], v[72:75]
    v_mfma_f32_16x16x32_bf16 v[76:79], v[168:171], v[196:199], v[76:79]
    v_mfma_f32_16x16x32_bf16 v[80:83], v[168:171], v[204:207], v[80:83]
    v_mfma_f32_16x16x32_bf16 v[84:87], v[176:179], v[188:191], v[84:87]
    v_mfma_f32_16x16x32_bf16 v[88:91], v[176:179], v[196:199], v[88:91]
    v_mfma_f32_16x16x32_bf16 v[92:95], v[176:179], v[204:207], v[92:95]
    v_mfma_f32_16x16x32_bf16 v[48:51], v[156:159], v[184:187], v[48:51]
    v_xor_b32 v188, s34, v188
    v_xor_b32 v189, s34, v189
    v_mfma_f32_16x16x32_bf16 v[52:55], v[156:159], v[192:195], v[52:55]
    v_xor_b32 v190, s34, v190
    v_xor_b32 v191, s34, v191
    v_mfma_f32_16x16x32_bf16 v[56:59], v[156:159], v[200:203], v[56:59]
    v_xor_b32 v196, s34, v196
    v_xor_b32 v197, s34, v197
    v_mfma_f32_16x16x32_bf16 v[60:63], v[164:167], v[184:187], v[60:63]
    v_xor_b32 v198, s34, v198
    v_xor_b32 v199, s34, v199
    v_mfma_f32_16x16x32_bf16 v[64:67], v[164:167], v[192:195], v[64:67]
    v_xor_b32 v204, s34, v204
    v_xor_b32 v205, s34, v205
    v_mfma_f32_16x16x32_bf16 v[68:71], v[164:167], v[200:203], v[68:71]
    v_xor_b32 v206, s34, v206
    v_xor_b32 v207, s34, v207
    v_mfma_f32_16x16x32_bf16 v[72:75], v[172:175], v[184:187], v[72:75]
    v_mfma_f32_16x16x32_bf16 v[76:79], v[172:175], v[192:195], v[76:79]
    v_mfma_f32_16x16x32_bf16 v[80:83], v[172:175], v[200:203], v[80:83]
    v_mfma_f32_16x16x32_bf16 v[84:87], v[180:183], v[184:187], v[84:87]
    v_mfma_f32_16x16x32_bf16 v[88:91], v[180:183], v[192:195], v[88:91]
    v_mfma_f32_16x16x32_bf16 v[92:95], v[180:183], v[200:203], v[92:95]
    v_mfma_f32_16x16x32_bf16 v[0:3], v[156:159], v[188:191], v[0:3]
    v_mfma_f32_16x16x32_bf16 v[4:7], v[156:159], v[196:199], v[4:7]
    v_mfma_f32_16x16x32_bf16 v[8:11], v[156:159], v[204:207], v[8:11]
    v_mfma_f32_16x16x32_bf16 v[12:15], v[164:167], v[188:191], v[12:15]
    v_mfma_f32_16x16x32_bf16 v[16:19], v[164:167], v[196:199], v[16:19]
    v_mfma_f32_16x16x32_bf16 v[20:23], v[164:167], v[204:207], v[20:23]
    v_mfma_f32_16x16x32_bf16 v[24:27], v[172:175], v[188:191], v[24:27]
    v_mfma_f32_16x16x32_bf16 v[28:31], v[172:175], v[196:199], v[28:31]
    v_mfma_f32_16x16x32_bf16 v[32:35], v[172:175], v[204:207], v[32:35]
    v_mfma_f32_16x16x32_bf16 v[36:39], v[180:183], v[188:191], v[36:39]
    v_mfma_f32_16x16x32_bf16 v[40:43], v[180:183], v[196:199], v[40:43]
    v_mfma_f32_16x16x32_bf16 v[44:47], v[180:183], v[204:207], v[44:47]
    s_nop 7
    s_nop 7
    v_cvt_pk_bf16_f32 v96, v0, v1
    v_cvt_pk_bf16_f32 v97, v2, v3
    v_cvt_pk_bf16_f32 v98, v12, v13
    v_cvt_pk_bf16_f32 v99, v14, v15
    v_cvt_pk_bf16_f32 v100, v48, v49
    v_cvt_pk_bf16_f32 v101, v50, v51
    v_cvt_pk_bf16_f32 v102, v60, v61
    v_cvt_pk_bf16_f32 v103, v62, v63
    v_mov_b32 v104, v96
    v_mov_b32 v105, v97
    v_mov_b32 v106, v98
    v_mov_b32 v107, v99
    s_add_u32 s35, s33, 0
    v_mov_b32_dpp v104, v100 row_ror:8 row_mask:0xf bank_mask:0x3
    v_mov_b32_dpp v105, v101 row_ror:8 row_mask:0xf bank_mask:0x3
    v_mov_b32_dpp v106, v102 row_ror:8 row_mask:0xf bank_mask:0x3
    v_mov_b32_dpp v107, v103 row_ror:8 row_mask:0xf bank_mask:0x3
    v_mov_b32_dpp v96, v100 row_ror:8 row_mask:0xf bank_mask:0xc
    v_mov_b32_dpp v97, v101 row_ror:8 row_mask:0xf bank_mask:0xc
    v_mov_b32_dpp v98, v102 row_ror:8 row_mask:0xf bank_mask:0xc
    v_mov_b32_dpp v99, v103 row_ror:8 row_mask:0xf bank_mask:0xc
    buffer_store_dwordx4 v[96:99], v222, s[16:19], s35 offen sc1
    buffer_store_dwordx4 v[104:107], v223, s[16:19], s35 offen sc1
    v_cvt_pk_bf16_f32 v108, v4, v5
    v_cvt_pk_bf16_f32 v109, v6, v7
    v_cvt_pk_bf16_f32 v110, v16, v17
    v_cvt_pk_bf16_f32 v111, v18, v19
    v_cvt_pk_bf16_f32 v112, v52, v53
    v_cvt_pk_bf16_f32 v113, v54, v55
    v_cvt_pk_bf16_f32 v114, v64, v65
    v_cvt_pk_bf16_f32 v115, v66, v67
    v_mov_b32 v116, v108
    v_mov_b32 v117, v109
    v_mov_b32 v118, v110
    v_mov_b32 v119, v111
    s_add_u32 s35, s33, 593920
    v_mov_b32_dpp v116, v112 row_ror:8 row_mask:0xf bank_mask:0x3
    v_mov_b32_dpp v117, v113 row_ror:8 row_mask:0xf bank_mask:0x3
    v_mov_b32_dpp v118, v114 row_ror:8 row_mask:0xf bank_mask:0x3
    v_mov_b32_dpp v119, v115 row_ror:8 row_mask:0xf bank_mask:0x3
    v_mov_b32_dpp v108, v112 row_ror:8 row_mask:0xf bank_mask:0xc
    v_mov_b32_dpp v109, v113 row_ror:8 row_mask:0xf bank_mask:0xc
    v_mov_b32_dpp v110, v114 row_ror:8 row_mask:0xf bank_mask:0xc
    v_mov_b32_dpp v111, v115 row_ror:8 row_mask:0xf bank_mask:0xc
    buffer_store_dwordx4 v[108:111], v222, s[16:19], s35 offen sc1
    buffer_store_dwordx4 v[116:119], v223, s[16:19], s35 offen sc1
    v_cvt_pk_bf16_f32 v120, v8, v9
    v_cvt_pk_bf16_f32 v121, v10, v11
    v_cvt_pk_bf16_f32 v122, v20, v21
    v_cvt_pk_bf16_f32 v123, v22, v23
    v_cvt_pk_bf16_f32 v124, v56, v57
    v_cvt_pk_bf16_f32 v125, v58, v59
    v_cvt_pk_bf16_f32 v126, v68, v69
    v_cvt_pk_bf16_f32 v127, v70, v71
    v_mov_b32 v128, v120
    v_mov_b32 v129, v121
    v_mov_b32 v130, v122
    v_mov_b32 v131, v123
    s_add_u32 s35, s33, 1187840
    v_mov_b32_dpp v128, v124 row_ror:8 row_mask:0xf bank_mask:0x3
    v_mov_b32_dpp v129, v125 row_ror:8 row_mask:0xf bank_mask:0x3
    v_mov_b32_dpp v130, v126 row_ror:8 row_mask:0xf bank_mask:0x3
    v_mov_b32_dpp v131, v127 row_ror:8 row_mask:0xf bank_mask:0x3
    v_mov_b32_dpp v120, v124 row_ror:8 row_mask:0xf bank_mask:0xc
    v_mov_b32_dpp v121, v125 row_ror:8 row_mask:0xf bank_mask:0xc
    v_mov_b32_dpp v122, v126 row_ror:8 row_mask:0xf bank_mask:0xc
    v_mov_b32_dpp v123, v127 row_ror:8 row_mask:0xf bank_mask:0xc
    buffer_store_dwordx4 v[120:123], v222, s[16:19], s35 offen sc1
    buffer_store_dwordx4 v[128:131], v223, s[16:19], s35 offen sc1
    v_cvt_pk_bf16_f32 v96, v24, v25
    v_cvt_pk_bf16_f32 v97, v26, v27
    v_cvt_pk_bf16_f32 v98, v36, v37
    v_cvt_pk_bf16_f32 v99, v38, v39
    v_cvt_pk_bf16_f32 v100, v72, v73
    v_cvt_pk_bf16_f32 v101, v74, v75
    v_cvt_pk_bf16_f32 v102, v84, v85
    v_cvt_pk_bf16_f32 v103, v86, v87
    v_mov_b32 v104, v96
    v_mov_b32 v105, v97
    v_mov_b32 v106, v98
    v_mov_b32 v107, v99
    s_add_u32 s35, s33, 4096
    v_mov_b32_dpp v104, v100 row_ror:8 row_mask:0xf bank_mask:0x3
    v_mov_b32_dpp v105, v101 row_ror:8 row_mask:0xf bank_mask:0x3
    v_mov_b32_dpp v106, v102 row_ror:8 row_mask:0xf bank_mask:0x3
    v_mov_b32_dpp v107, v103 row_ror:8 row_mask:0xf bank_mask:0x3
    v_mov_b32_dpp v96, v100 row_ror:8 row_mask:0xf bank_mask:0xc
    v_mov_b32_dpp v97, v101 row_ror:8 row_mask:0xf bank_mask:0xc
    v_mov_b32_dpp v98, v102 row_ror:8 row_mask:0xf bank_mask:0xc
    v_mov_b32_dpp v99, v103 row_ror:8 row_mask:0xf bank_mask:0xc
    buffer_store_dwordx4 v[96:99], v222, s[16:19], s35 offen sc1
    buffer_store_dwordx4 v[104:107], v223, s[16:19], s35 offen sc1
    v_cvt_pk_bf16_f32 v108, v28, v29
    v_cvt_pk_bf16_f32 v109, v30, v31
    v_cvt_pk_bf16_f32 v110, v40, v41
    v_cvt_pk_bf16_f32 v111, v42, v43
    v_cvt_pk_bf16_f32 v112, v76, v77
    v_cvt_pk_bf16_f32 v113, v78, v79
    v_cvt_pk_bf16_f32 v114, v88, v89
    v_cvt_pk_bf16_f32 v115, v90, v91
    v_mov_b32 v116, v108
    v_mov_b32 v117, v109
    v_mov_b32 v118, v110
    v_mov_b32 v119, v111
    s_add_u32 s35, s33, 598016
    v_mov_b32_dpp v116, v112 row_ror:8 row_mask:0xf bank_mask:0x3
    v_mov_b32_dpp v117, v113 row_ror:8 row_mask:0xf bank_mask:0x3
    v_mov_b32_dpp v118, v114 row_ror:8 row_mask:0xf bank_mask:0x3
    v_mov_b32_dpp v119, v115 row_ror:8 row_mask:0xf bank_mask:0x3
    v_mov_b32_dpp v108, v112 row_ror:8 row_mask:0xf bank_mask:0xc
    v_mov_b32_dpp v109, v113 row_ror:8 row_mask:0xf bank_mask:0xc
    v_mov_b32_dpp v110, v114 row_ror:8 row_mask:0xf bank_mask:0xc
    v_mov_b32_dpp v111, v115 row_ror:8 row_mask:0xf bank_mask:0xc
    buffer_store_dwordx4 v[108:111], v222, s[16:19], s35 offen sc1
    buffer_store_dwordx4 v[116:119], v223, s[16:19], s35 offen sc1
    v_cvt_pk_bf16_f32 v120, v32, v33
    v_cvt_pk_bf16_f32 v121, v34, v35
    v_cvt_pk_bf16_f32 v122, v44, v45
    v_cvt_pk_bf16_f32 v123, v46, v47
    v_cvt_pk_bf16_f32 v124, v80, v81
    v_cvt_pk_bf16_f32 v125, v82, v83
    v_cvt_pk_bf16_f32 v126, v92, v93
    v_cvt_pk_bf16_f32 v127, v94, v95
    v_mov_b32 v128, v120
    v_mov_b32 v129, v121
    v_mov_b32 v130, v122
    v_mov_b32 v131, v123
    s_add_u32 s35, s33, 1191936
    v_mov_b32_dpp v128, v124 row_ror:8 row_mask:0xf bank_mask:0x3
    v_mov_b32_dpp v129, v125 row_ror:8 row_mask:0xf bank_mask:0x3
    v_mov_b32_dpp v130, v126 row_ror:8 row_mask:0xf bank_mask:0x3
    v_mov_b32_dpp v131, v127 row_ror:8 row_mask:0xf bank_mask:0x3
    v_mov_b32_dpp v120, v124 row_ror:8 row_mask:0xf bank_mask:0xc
    v_mov_b32_dpp v121, v125 row_ror:8 row_mask:0xf bank_mask:0xc
    v_mov_b32_dpp v122, v126 row_ror:8 row_mask:0xf bank_mask:0xc
    v_mov_b32_dpp v123, v127 row_ror:8 row_mask:0xf bank_mask:0xc
    buffer_store_dwordx4 v[120:123], v222, s[16:19], s35 offen sc1
    buffer_store_dwordx4 v[128:131], v223, s[16:19], s35 offen sc1
    s_endpgm
L_gemm1_kernel_loader:
    s_sub_u32 s20, s20, 4
    v_and_b32 v3, 63, v0
    v_lshrrev_b32 v4, 3, v3
    v_and_b32 v5, 7, v3
    v_xor_b32 v5, v5, v4
    v_lshlrev_b32 v5, 4, v5
    v_lshl_add_u32 v1, v4, 11, v5
    v_lshlrev_b32 v2, 4, v3
    s_add_u32 s24, s20, 0
    s_lshl_b32 s40, s24, 10
    s_lshl_b32 s43, s24, 14
    s_add_u32 s24, s20, 4
    s_lshl_b32 s41, s24, 10
    s_lshl_b32 s44, s24, 14
    s_add_u32 s24, s20, 8
    s_lshl_b32 s42, s24, 10
    s_lshl_b32 s45, s24, 14
    s_mul_i32 s46, s20, 4096
    s_add_u32 s47, s46, 12288
    s_add_u32 m0, s40, 0
    s_add_u32 s24, s43, 0
    buffer_load_dwordx4 v1, s[8:11], s24 offen lds
    s_add_u32 m0, s41, 0
    s_add_u32 s24, s44, 0
    buffer_load_dwordx4 v1, s[8:11], s24 offen lds
    s_add_u32 m0, s42, 0
    s_add_u32 s24, s45, 0
    buffer_load_dwordx4 v1, s[8:11], s24 offen lds
    s_add_u32 m0, s47, 0
    s_add_u32 s24, s46, 0
    buffer_load_dwordx4 v2, s[12:15], s24 offen offset:0 lds
    buffer_load_dwordx4 v2, s[12:15], s24 offen offset:1024 lds
    buffer_load_dwordx4 v2, s[12:15], s24 offen offset:2048 lds
    buffer_load_dwordx4 v2, s[12:15], s24 offen offset:3072 lds
    s_add_u32 m0, s40, 28672
    s_add_u32 s24, s43, 128
    buffer_load_dwordx4 v1, s[8:11], s24 offen lds
    s_add_u32 m0, s41, 28672
    s_add_u32 s24, s44, 128
    buffer_load_dwordx4 v1, s[8:11], s24 offen lds
    s_add_u32 m0, s42, 28672
    s_add_u32 s24, s45, 128
    buffer_load_dwordx4 v1, s[8:11], s24 offen lds
    s_add_u32 m0, s47, 28672
    s_add_u32 s24, s46, 32768
    buffer_load_dwordx4 v2, s[12:15], s24 offen offset:0 lds
    buffer_load_dwordx4 v2, s[12:15], s24 offen offset:1024 lds
    buffer_load_dwordx4 v2, s[12:15], s24 offen offset:2048 lds
    buffer_load_dwordx4 v2, s[12:15], s24 offen offset:3072 lds
    s_waitcnt vmcnt(7)
    s_barrier
    s_add_u32 m0, s40, 57344
    s_add_u32 s24, s43, 256
    buffer_load_dwordx4 v1, s[8:11], s24 offen lds
    s_add_u32 m0, s41, 57344
    s_add_u32 s24, s44, 256
    buffer_load_dwordx4 v1, s[8:11], s24 offen lds
    s_add_u32 m0, s42, 57344
    s_add_u32 s24, s45, 256
    buffer_load_dwordx4 v1, s[8:11], s24 offen lds
    s_add_u32 m0, s47, 57344
    s_add_u32 s24, s46, 65536
    buffer_load_dwordx4 v2, s[12:15], s24 offen offset:0 lds
    buffer_load_dwordx4 v2, s[12:15], s24 offen offset:1024 lds
    buffer_load_dwordx4 v2, s[12:15], s24 offen offset:2048 lds
    buffer_load_dwordx4 v2, s[12:15], s24 offen offset:3072 lds
    s_waitcnt vmcnt(7)
    s_barrier
    s_add_u32 m0, s40, 86016
    s_add_u32 s24, s43, 384
    buffer_load_dwordx4 v1, s[8:11], s24 offen lds
    s_add_u32 m0, s41, 86016
    s_add_u32 s24, s44, 384
    buffer_load_dwordx4 v1, s[8:11], s24 offen lds
    s_add_u32 m0, s42, 86016
    s_add_u32 s24, s45, 384
    buffer_load_dwordx4 v1, s[8:11], s24 offen lds
    s_add_u32 m0, s47, 86016
    s_add_u32 s24, s46, 98304
    buffer_load_dwordx4 v2, s[12:15], s24 offen offset:0 lds
    buffer_load_dwordx4 v2, s[12:15], s24 offen offset:1024 lds
    buffer_load_dwordx4 v2, s[12:15], s24 offen offset:2048 lds
    buffer_load_dwordx4 v2, s[12:15], s24 offen offset:3072 lds
    s_add_u32 m0, s40, 114688
    s_add_u32 s24, s43, 512
    buffer_load_dwordx4 v1, s[8:11], s24 offen lds
    s_add_u32 m0, s41, 114688
    s_add_u32 s24, s44, 512
    buffer_load_dwordx4 v1, s[8:11], s24 offen lds
    s_add_u32 m0, s42, 114688
    s_add_u32 s24, s45, 512
    buffer_load_dwordx4 v1, s[8:11], s24 offen lds
    s_add_u32 m0, s47, 114688
    s_add_u32 s24, s46, 131072
    buffer_load_dwordx4 v2, s[12:15], s24 offen offset:0 lds
    buffer_load_dwordx4 v2, s[12:15], s24 offen offset:1024 lds
    buffer_load_dwordx4 v2, s[12:15], s24 offen offset:2048 lds
    buffer_load_dwordx4 v2, s[12:15], s24 offen offset:3072 lds
    s_waitcnt vmcnt(14)
    s_barrier
    s_add_u32 m0, s40, 0
    s_add_u32 s24, s43, 640
    buffer_load_dwordx4 v1, s[8:11], s24 offen lds
    s_add_u32 m0, s41, 0
    s_add_u32 s24, s44, 640
    buffer_load_dwordx4 v1, s[8:11], s24 offen lds
    s_add_u32 m0, s42, 0
    s_add_u32 s24, s45, 640
    buffer_load_dwordx4 v1, s[8:11], s24 offen lds
    s_add_u32 m0, s47, 0
    s_add_u32 s24, s46, 163840
    buffer_load_dwordx4 v2, s[12:15], s24 offen offset:0 lds
    buffer_load_dwordx4 v2, s[12:15], s24 offen offset:1024 lds
    buffer_load_dwordx4 v2, s[12:15], s24 offen offset:2048 lds
    buffer_load_dwordx4 v2, s[12:15], s24 offen offset:3072 lds
    s_add_u32 m0, s40, 28672
    s_add_u32 s24, s43, 768
    buffer_load_dwordx4 v1, s[8:11], s24 offen lds
    s_add_u32 m0, s41, 28672
    s_add_u32 s24, s44, 768
    buffer_load_dwordx4 v1, s[8:11], s24 offen lds
    s_add_u32 m0, s42, 28672
    s_add_u32 s24, s45, 768
    buffer_load_dwordx4 v1, s[8:11], s24 offen lds
    s_add_u32 m0, s47, 28672
    s_add_u32 s24, s46, 196608
    buffer_load_dwordx4 v2, s[12:15], s24 offen offset:0 lds
    buffer_load_dwordx4 v2, s[12:15], s24 offen offset:1024 lds
    buffer_load_dwordx4 v2, s[12:15], s24 offen offset:2048 lds
    buffer_load_dwordx4 v2, s[12:15], s24 offen offset:3072 lds
    s_waitcnt vmcnt(21)
    s_barrier
    s_add_u32 m0, s40, 57344
    s_add_u32 s24, s43, 896
    buffer_load_dwordx4 v1, s[8:11], s24 offen lds
    s_add_u32 m0, s41, 57344
    s_add_u32 s24, s44, 896
    buffer_load_dwordx4 v1, s[8:11], s24 offen lds
    s_add_u32 m0, s42, 57344
    s_add_u32 s24, s45, 896
    buffer_load_dwordx4 v1, s[8:11], s24 offen lds
    s_add_u32 m0, s47, 57344
    s_add_u32 s24, s46, 229376
    buffer_load_dwordx4 v2, s[12:15], s24 offen offset:0 lds
    buffer_load_dwordx4 v2, s[12:15], s24 offen offset:1024 lds
    buffer_load_dwordx4 v2, s[12:15], s24 offen offset:2048 lds
    buffer_load_dwordx4 v2, s[12:15], s24 offen offset:3072 lds
    s_waitcnt vmcnt(21)
    s_barrier
    s_add_u32 m0, s40, 86016
    s_add_u32 s24, s43, 1024
    buffer_load_dwordx4 v1, s[8:11], s24 offen lds
    s_add_u32 m0, s41, 86016
    s_add_u32 s24, s44, 1024
    buffer_load_dwordx4 v1, s[8:11], s24 offen lds
    s_add_u32 m0, s42, 86016
    s_add_u32 s24, s45, 1024
    buffer_load_dwordx4 v1, s[8:11], s24 offen lds
    s_add_u32 m0, s47, 86016
    s_add_u32 s24, s46, 262144
    buffer_load_dwordx4 v2, s[12:15], s24 offen offset:0 lds
    buffer_load_dwordx4 v2, s[12:15], s24 offen offset:1024 lds
    buffer_load_dwordx4 v2, s[12:15], s24 offen offset:2048 lds
    buffer_load_dwordx4 v2, s[12:15], s24 offen offset:3072 lds
    s_waitcnt vmcnt(21)
    s_barrier
    s_add_u32 m0, s40, 114688
    s_add_u32 s24, s43, 1152
    buffer_load_dwordx4 v1, s[8:11], s24 offen lds
    s_add_u32 m0, s41, 114688
    s_add_u32 s24, s44, 1152
    buffer_load_dwordx4 v1, s[8:11], s24 offen lds
    s_add_u32 m0, s42, 114688
    s_add_u32 s24, s45, 1152
    buffer_load_dwordx4 v1, s[8:11], s24 offen lds
    s_add_u32 m0, s47, 114688
    s_add_u32 s24, s46, 294912
    buffer_load_dwordx4 v2, s[12:15], s24 offen offset:0 lds
    buffer_load_dwordx4 v2, s[12:15], s24 offen offset:1024 lds
    buffer_load_dwordx4 v2, s[12:15], s24 offen offset:2048 lds
    buffer_load_dwordx4 v2, s[12:15], s24 offen offset:3072 lds
    s_waitcnt vmcnt(21)
    s_barrier
    s_add_u32 m0, s40, 0
    s_add_u32 s24, s43, 1280
    buffer_load_dwordx4 v1, s[8:11], s24 offen lds
    s_add_u32 m0, s41, 0
    s_add_u32 s24, s44, 1280
    buffer_load_dwordx4 v1, s[8:11], s24 offen lds
    s_add_u32 m0, s42, 0
    s_add_u32 s24, s45, 1280
    buffer_load_dwordx4 v1, s[8:11], s24 offen lds
    s_add_u32 m0, s47, 0
    s_add_u32 s24, s46, 327680
    buffer_load_dwordx4 v2, s[12:15], s24 offen offset:0 lds
    buffer_load_dwordx4 v2, s[12:15], s24 offen offset:1024 lds
    buffer_load_dwordx4 v2, s[12:15], s24 offen offset:2048 lds
    buffer_load_dwordx4 v2, s[12:15], s24 offen offset:3072 lds
    s_waitcnt vmcnt(21)
    s_barrier
    s_add_u32 m0, s40, 28672
    s_add_u32 s24, s43, 1408
    buffer_load_dwordx4 v1, s[8:11], s24 offen lds
    s_add_u32 m0, s41, 28672
    s_add_u32 s24, s44, 1408
    buffer_load_dwordx4 v1, s[8:11], s24 offen lds
    s_add_u32 m0, s42, 28672
    s_add_u32 s24, s45, 1408
    buffer_load_dwordx4 v1, s[8:11], s24 offen lds
    s_add_u32 m0, s47, 28672
    s_add_u32 s24, s46, 360448
    buffer_load_dwordx4 v2, s[12:15], s24 offen offset:0 lds
    buffer_load_dwordx4 v2, s[12:15], s24 offen offset:1024 lds
    buffer_load_dwordx4 v2, s[12:15], s24 offen offset:2048 lds
    buffer_load_dwordx4 v2, s[12:15], s24 offen offset:3072 lds
    s_waitcnt vmcnt(21)
    s_barrier
    s_add_u32 m0, s40, 57344
    s_add_u32 s24, s43, 1536
    buffer_load_dwordx4 v1, s[8:11], s24 offen lds
    s_add_u32 m0, s41, 57344
    s_add_u32 s24, s44, 1536
    buffer_load_dwordx4 v1, s[8:11], s24 offen lds
    s_add_u32 m0, s42, 57344
    s_add_u32 s24, s45, 1536
    buffer_load_dwordx4 v1, s[8:11], s24 offen lds
    s_add_u32 m0, s47, 57344
    s_add_u32 s24, s46, 393216
    buffer_load_dwordx4 v2, s[12:15], s24 offen offset:0 lds
    buffer_load_dwordx4 v2, s[12:15], s24 offen offset:1024 lds
    buffer_load_dwordx4 v2, s[12:15], s24 offen offset:2048 lds
    buffer_load_dwordx4 v2, s[12:15], s24 offen offset:3072 lds
    s_waitcnt vmcnt(21)
    s_barrier
    s_add_u32 m0, s40, 86016
    s_add_u32 s24, s43, 1664
    buffer_load_dwordx4 v1, s[8:11], s24 offen lds
    s_add_u32 m0, s41, 86016
    s_add_u32 s24, s44, 1664
    buffer_load_dwordx4 v1, s[8:11], s24 offen lds
    s_add_u32 m0, s42, 86016
    s_add_u32 s24, s45, 1664
    buffer_load_dwordx4 v1, s[8:11], s24 offen lds
    s_add_u32 m0, s47, 86016
    s_add_u32 s24, s46, 425984
    buffer_load_dwordx4 v2, s[12:15], s24 offen offset:0 lds
    buffer_load_dwordx4 v2, s[12:15], s24 offen offset:1024 lds
    buffer_load_dwordx4 v2, s[12:15], s24 offen offset:2048 lds
    buffer_load_dwordx4 v2, s[12:15], s24 offen offset:3072 lds
    s_waitcnt vmcnt(21)
    s_barrier
    s_add_u32 m0, s40, 114688
    s_add_u32 s24, s43, 1792
    buffer_load_dwordx4 v1, s[8:11], s24 offen lds
    s_add_u32 m0, s41, 114688
    s_add_u32 s24, s44, 1792
    buffer_load_dwordx4 v1, s[8:11], s24 offen lds
    s_add_u32 m0, s42, 114688
    s_add_u32 s24, s45, 1792
    buffer_load_dwordx4 v1, s[8:11], s24 offen lds
    s_add_u32 m0, s47, 114688
    s_add_u32 s24, s46, 458752
    buffer_load_dwordx4 v2, s[12:15], s24 offen offset:0 lds
    buffer_load_dwordx4 v2, s[12:15], s24 offen offset:1024 lds
    buffer_load_dwordx4 v2, s[12:15], s24 offen offset:2048 lds
    buffer_load_dwordx4 v2, s[12:15], s24 offen offset:3072 lds
    s_waitcnt vmcnt(21)
    s_barrier
    s_add_u32 m0, s40, 0
    s_add_u32 s24, s43, 1920
    buffer_load_dwordx4 v1, s[8:11], s24 offen lds
    s_add_u32 m0, s41, 0
    s_add_u32 s24, s44, 1920
    buffer_load_dwordx4 v1, s[8:11], s24 offen lds
    s_add_u32 m0, s42, 0
    s_add_u32 s24, s45, 1920
    buffer_load_dwordx4 v1, s[8:11], s24 offen lds
    s_add_u32 m0, s47, 0
    s_add_u32 s24, s46, 491520
    buffer_load_dwordx4 v2, s[12:15], s24 offen offset:0 lds
    buffer_load_dwordx4 v2, s[12:15], s24 offen offset:1024 lds
    buffer_load_dwordx4 v2, s[12:15], s24 offen offset:2048 lds
    buffer_load_dwordx4 v2, s[12:15], s24 offen offset:3072 lds
    s_waitcnt vmcnt(21)
    s_barrier
    s_waitcnt vmcnt(14)
    s_barrier
    s_waitcnt vmcnt(7)
    s_barrier
    s_waitcnt vmcnt(0)
    s_barrier
L_gemm1_kernel_done:
    s_endpgm
.globl mid_kernel
.p2align 8
.type mid_kernel,@function
mid_kernel:
    s_cmp_ge_u32 s2, 704
    s_cbranch_scc1 L_mid_kernel_done
    v_readfirstlane_b32 s20, v0
    s_lshr_b32 s20, s20, 6
    s_cmp_ge_u32 s2, 448
    s_cbranch_scc1 L_mid_kernel_g
    s_load_dwordx2 s[6:7], s[0:1], 72
    s_load_dwordx2 s[4:5], s[0:1], 72
    s_cmp_ge_u32 s2, 224
    s_cselect_b32 s24, 1, 0
    s_mul_i32 s25, s24, 224
    s_sub_u32 s25, s2, s25
    s_lshr_b32 s26, s25, 3
    s_and_b32 s27, s25, 7
    v_and_b32 v1, 63, v0
    v_lshrrev_b32 v2, 2, v1
    v_lshlrev_b32 v2, 6, v2
    v_lshrrev_b32 v3, 5, v1
    v_lshlrev_b32 v3, 1, v3
    v_and_b32 v4, 3, v1
    v_xor_b32 v3, v3, v4
    v_lshl_add_u32 v2, v3, 4, v2
    s_mul_i32 s28, s26, 6
    s_lshl_b32 s29, s20, 1
    s_add_u32 s28, s28, s29
    s_sub_u32 s28, s28, 1
    s_lshl_b32 s30, s27, 12
    s_add_u32 s31, s28, 0
    s_mul_i32 s32, s31, 37120
    s_add_u32 s32, s32, s30
    s_cmp_lt_i32 s31, 0
    s_cselect_b32 s32, 0x7f000000, s32
    v_add_u32 v3, s32, v2
    s_add_u32 s31, s28, 1
    s_mul_i32 s32, s31, 37120
    s_add_u32 s32, s32, s30
    s_cmp_lt_i32 s31, 0
    s_cselect_b32 s32, 0x7f000000, s32
    v_add_u32 v4, s32, v2
    s_waitcnt lgkmcnt(0)
    s_mul_i32 s33, s24, 6199040
    s_add_u32 s33, s33, 38871040
    s_add_u32 s8, s6, s33
    s_addc_u32 s9, s7, 0
    s_mov_b32 s10, 6199040
    s_mov_b32 s11, 0x00020000
    s_add_u32 s12, s6, 85499904
    s_addc_u32 s13, s7, 0
    s_mov_b32 s14, 16384
    s_mov_b32 s15, 0x00020000
    s_lshl_b32 s34, s20, 13
    s_add_u32 m0, s34, 0
    s_nop 0
    buffer_load_dwordx4 v3, s[8:11], 0 offen offset:0 lds
    buffer_load_dwordx4 v3, s[8:11], 0 offen offset:1024 lds
    buffer_load_dwordx4 v3, s[8:11], 0 offen offset:2048 lds
    buffer_load_dwordx4 v3, s[8:11], 0 offen offset:3072 lds
    s_add_u32 m0, s34, 4096
    s_nop 0
    buffer_load_dwordx4 v4, s[8:11], 0 offen offset:0 lds
    buffer_load_dwordx4 v4, s[8:11], 0 offen offset:1024 lds
    buffer_load_dwordx4 v4, s[8:11], 0 offen offset:2048 lds
    buffer_load_dwordx4 v4, s[8:11], 0 offen offset:3072 lds
    v_lshlrev_b32 v5, 4, v1
    s_mov_b32 s35, 8192
    buffer_load_dwordx4 v[8:11], v5, s[12:15], s35 offen
    s_mov_b32 s35, 9216
    buffer_load_dwordx4 v[12:15], v5, s[12:15], s35 offen
    s_mov_b32 s35, 10240
    buffer_load_dwordx4 v[16:19], v5, s[12:15], s35 offen
    s_mov_b32 s35, 11264
    buffer_load_dwordx4 v[20:23], v5, s[12:15], s35 offen
    s_mov_b32 s35, 12288
    buffer_load_dwordx4 v[24:27], v5, s[12:15], s35 offen
    s_mov_b32 s35, 13312
    buffer_load_dwordx4 v[28:31], v5, s[12:15], s35 offen
    s_lshl_b32 s35, s20, 11
    buffer_load_dwordx4 v[32:35], v5, s[12:15], s35 offen offset:0
    buffer_load_dwordx4 v[36:39], v5, s[12:15], s35 offen offset:1024
    v_bfe_u32 v40, v1, 2, 2
    v_lshrrev_b32 v41, 4, v1
    v_and_b32 v42, 3, v1
    v_lshl_add_u32 v43, v41, 3, v40
    v_lshlrev_b32 v46, 6, v43
    v_and_b32 v47, 1, v41
    v_lshlrev_b32 v47, 1, v47
    v_lshrrev_b32 v48, 1, v42
    v_xor_b32 v47, v47, v48
    v_lshl_add_u32 v46, v47, 4, v46
    v_and_b32 v48, 1, v42
    v_lshl_add_u32 v46, v48, 3, v46
    v_add_u32 v44, s34, v46
    v_xor_b32 v45, 32, v44
    v_add_u32 v49, 43008, v46
    v_xor_b32 v50, 32, v49
    v_add_u32 v47, 1, v43
    v_bfe_u32 v48, v47, 3, 1
    v_lshlrev_b32 v48, 1, v48
    v_lshrrev_b32 v55, 1, v42
    v_xor_b32 v48, v48, v55
    v_lshlrev_b32 v47, 6, v47
    v_lshl_add_u32 v47, v48, 4, v47
    v_and_b32 v48, 1, v42
    v_lshl_add_u32 v47, v48, 3, v47
    v_add_u32 v51, 32704, v47
    v_xor_b32 v52, 32, v51
    v_add_u32 v47, 5, v43
    v_bfe_u32 v48, v47, 3, 1
    v_lshlrev_b32 v48, 1, v48
    v_lshrrev_b32 v55, 1, v42
    v_xor_b32 v48, v48, v55
    v_lshlrev_b32 v47, 6, v47
    v_lshl_add_u32 v47, v48, 4, v47
    v_and_b32 v48, 1, v42
    v_lshl_add_u32 v47, v48, 3, v47
    v_add_u32 v53, 32704, v47
    v_xor_b32 v54, 32, v53
    v_and_b32 v47, 1, v1
    v_mul_u32_u24 v55, 10304, v47
    v_bfe_u32 v48, v1, 1, 3
    v_lshl_add_u32 v55, v48, 6, v55
    v_lshl_add_u32 v55, v41, 4, v55
    s_mul_i32 s35, s20, 3072
    s_add_u32 s35, s35, 31680
    v_add_u32 v56, s35, v55
    v_xor_b32 v57, 32, v56
    s_mul_i32 s35, s20, 48
    s_sub_u32 s35, s35, 17
    v_add_u32 v122, v48, v47
    v_add_u32 v122, s35, v122
    s_mov_b32 s35, 344064
    v_mul_lo_u32 v58, v48, s35
    v_and_b32 v47, 1, v1
    v_lshl_add_u32 v58, v47, 6, v58
    v_lshl_add_u32 v58, v41, 4, v58
    s_mov_b32 s36, 0xbdd2d3e8
    v_mov_b32 v59, 0xc0135761
    s_mov_b32 s42, 0xbdd2d3e8
    s_mov_b32 s43, 0xbdd2d3e8
    v_mov_b32 v120, 0xc0135761
    v_mov_b32 v121, 0xc0135761
    s_add_u32 s16, s4, 51269632
    s_addc_u32 s17, s5, 0
    s_mov_b32 s18, 11010048
    s_mov_b32 s19, 0x00020000
    s_mul_i32 s37, s20, 2752512
    s_mul_i32 s38, s24, 84
    s_mul_i32 s39, s26, 3
    s_add_u32 s38, s38, s39
    s_lshl_b32 s38, s38, 11
    s_add_u32 s37, s37, s38
    s_lshl_b32 s38, s27, 7
    s_add_u32 s37, s37, s38
    s_waitcnt vmcnt(2)
    ds_read_b64_tr_b16 v[60:61], v44 offset:0
    ds_read_b64_tr_b16 v[62:63], v44 offset:256
    ds_read_b64_tr_b16 v[64:65], v44 offset:2048
    ds_read_b64_tr_b16 v[66:67], v44 offset:2304
    ds_read_b64_tr_b16 v[68:69], v45 offset:0
    ds_read_b64_tr_b16 v[70:71], v45 offset:256
    ds_read_b64_tr_b16 v[72:73], v45 offset:2048
    ds_read_b64_tr_b16 v[74:75], v45 offset:2304
    s_waitcnt lgkmcnt(0)
    v_mfma_f32_16x16x32_bf16 v[76:79], v[60:63], v[8:11], 0
    v_mfma_f32_16x16x32_bf16 v[80:83], v[68:71], v[8:11], 0
    v_mfma_f32_16x16x32_bf16 v[84:87], v[60:63], v[16:19], 0
    v_mfma_f32_16x16x32_bf16 v[88:91], v[68:71], v[16:19], 0
    v_mfma_f32_16x16x32_bf16 v[92:95], v[60:63], v[24:27], 0
    v_mfma_f32_16x16x32_bf16 v[96:99], v[68:71], v[24:27], 0
    v_mfma_f32_16x16x32_bf16 v[76:79], v[64:67], v[12:15], v[76:79]
    v_mfma_f32_16x16x32_bf16 v[80:83], v[72:75], v[12:15], v[80:83]
    v_mfma_f32_16x16x32_bf16 v[84:87], v[64:67], v[20:23], v[84:87]
    v_mfma_f32_16x16x32_bf16 v[88:91], v[72:75], v[20:23], v[88:91]
    v_mfma_f32_16x16x32_bf16 v[92:95], v[64:67], v[28:31], v[92:95]
    v_mfma_f32_16x16x32_bf16 v[96:99], v[72:75], v[28:31], v[96:99]
    s_add_u32 s31, s28, 0
    s_cmp_eq_u32 s31, 166
    s_cselect_b32 s39, 0, -1
    s_nop 4
    v_mul_f32 v100, v76, v76
    v_mul_f32 v101, v77, v77
    v_mul_f32 v102, v78, v78
    v_mul_f32 v103, v79, v79
    v_mul_f32 v104, v80, v80
    v_mul_f32 v105, v81, v81
    v_mul_f32 v106, v82, v82
    v_mul_f32 v107, v83, v83
    v_fma_f32 v100, v100, s36, v59
    v_fma_f32 v101, v101, s36, v59
    v_fma_f32 v102, v102, s36, v59
    v_fma_f32 v103, v103, s36, v59
    v_fma_f32 v104, v104, s36, v59
    v_fma_f32 v105, v105, s36, v59
    v_fma_f32 v106, v106, s36, v59
    v_fma_f32 v107, v107, s36, v59
    v_mul_f32 v100, v100, v76
    v_mul_f32 v101, v101, v77
    v_mul_f32 v102, v102, v78
    v_mul_f32 v103, v103, v79
    v_mul_f32 v104, v104, v80
    v_mul_f32 v105, v105, v81
    v_mul_f32 v106, v106, v82
    v_mul_f32 v107, v107, v83
    v_exp_f32 v100, v100
    v_exp_f32 v101, v101
    v_exp_f32 v102, v102
    v_exp_f32 v103, v103
    v_exp_f32 v104, v104
    v_exp_f32 v105, v105
    v_exp_f32 v106, v106
    v_exp_f32 v107, v107
    v_add_f32 v100, 1.0, v100
    v_add_f32 v101, 1.0, v101
    v_add_f32 v102, 1.0, v102
    v_add_f32 v103, 1.0, v103
    v_add_f32 v104, 1.0, v104
    v_add_f32 v105, 1.0, v105
    v_add_f32 v106, 1.0, v106
    v_add_f32 v107, 1.0, v107
    v_rcp_f32 v100, v100
    v_rcp_f32 v101, v101
    v_rcp_f32 v102, v102
    v_rcp_f32 v103, v103
    v_rcp_f32 v104, v104
    v_rcp_f32 v105, v105
    v_rcp_f32 v106, v106
    v_rcp_f32 v107, v107
    v_mul_f32 v76, v76, v100
    v_mul_f32 v77, v77, v101
    v_mul_f32 v78, v78, v102
    v_mul_f32 v79, v79, v103
    v_mul_f32 v80, v80, v104
    v_mul_f32 v81, v81, v105
    v_mul_f32 v82, v82, v106
    v_mul_f32 v83, v83, v107
    v_cvt_pk_bf16_f32 v108, v76, v77
    v_cvt_pk_bf16_f32 v109, v78, v79
    v_cvt_pk_bf16_f32 v110, v80, v81
    v_cvt_pk_bf16_f32 v111, v82, v83
    v_add_u32 v123, 0, v122
    v_cmp_gt_u32 vcc, 160, v123
    s_nop 0
    s_and_saveexec_b64 s[40:41], vcc
    ds_write_b128 v56, v[108:111] offset:0
    s_mov_b64 exec, s[40:41]
    v_mul_f32 v100, v84, v84
    v_mul_f32 v101, v85, v85
    v_mul_f32 v102, v86, v86
    v_mul_f32 v103, v87, v87
    v_mul_f32 v104, v88, v88
    v_mul_f32 v105, v89, v89
    v_mul_f32 v106, v90, v90
    v_mul_f32 v107, v91, v91
    v_fma_f32 v100, v100, s36, v59
    v_fma_f32 v101, v101, s36, v59
    v_fma_f32 v102, v102, s36, v59
    v_fma_f32 v103, v103, s36, v59
    v_fma_f32 v104, v104, s36, v59
    v_fma_f32 v105, v105, s36, v59
    v_fma_f32 v106, v106, s36, v59
    v_fma_f32 v107, v107, s36, v59
    v_mul_f32 v100, v100, v84
    v_mul_f32 v101, v101, v85
    v_mul_f32 v102, v102, v86
    v_mul_f32 v103, v103, v87
    v_mul_f32 v104, v104, v88
    v_mul_f32 v105, v105, v89
    v_mul_f32 v106, v106, v90
    v_mul_f32 v107, v107, v91
    v_exp_f32 v100, v100
    v_exp_f32 v101, v101
    v_exp_f32 v102, v102
    v_exp_f32 v103, v103
    v_exp_f32 v104, v104
    v_exp_f32 v105, v105
    v_exp_f32 v106, v106
    v_exp_f32 v107, v107
    v_add_f32 v100, 1.0, v100
    v_add_f32 v101, 1.0, v101
    v_add_f32 v102, 1.0, v102
    v_add_f32 v103, 1.0, v103
    v_add_f32 v104, 1.0, v104
    v_add_f32 v105, 1.0, v105
    v_add_f32 v106, 1.0, v106
    v_add_f32 v107, 1.0, v107
    v_rcp_f32 v100, v100
    v_rcp_f32 v101, v101
    v_rcp_f32 v102, v102
    v_rcp_f32 v103, v103
    v_rcp_f32 v104, v104
    v_rcp_f32 v105, v105
    v_rcp_f32 v106, v106
    v_rcp_f32 v107, v107
    v_mul_f32 v84, v84, v100
    v_mul_f32 v85, v85, v101
    v_mul_f32 v86, v86, v102
    v_mul_f32 v87, v87, v103
    v_mul_f32 v88, v88, v104
    v_mul_f32 v89, v89, v105
    v_mul_f32 v90, v90, v106
    v_mul_f32 v91, v91, v107
    v_cvt_pk_bf16_f32 v112, v84, v85
    v_cvt_pk_bf16_f32 v113, v86, v87
    v_cvt_pk_bf16_f32 v114, v88, v89
    v_cvt_pk_bf16_f32 v115, v90, v91
    v_add_u32 v123, 8, v122
    v_cmp_gt_u32 vcc, 160, v123
    s_nop 0
    s_and_saveexec_b64 s[40:41], vcc
    ds_write_b128 v57, v[112:115] offset:512
    s_mov_b64 exec, s[40:41]
    v_mul_f32 v100, v92, v92
    v_mul_f32 v101, v93, v93
    v_mul_f32 v102, v94, v94
    v_mul_f32 v103, v95, v95
    v_mul_f32 v104, v96, v96
    v_mul_f32 v105, v97, v97
    v_mul_f32 v106, v98, v98
    v_mul_f32 v107, v99, v99
    v_fma_f32 v100, v100, s36, v59
    v_fma_f32 v101, v101, s36, v59
    v_fma_f32 v102, v102, s36, v59
    v_fma_f32 v103, v103, s36, v59
    v_fma_f32 v104, v104, s36, v59
    v_fma_f32 v105, v105, s36, v59
    v_fma_f32 v106, v106, s36, v59
    v_fma_f32 v107, v107, s36, v59
    v_mul_f32 v100, v100, v92
    v_mul_f32 v101, v101, v93
    v_mul_f32 v102, v102, v94
    v_mul_f32 v103, v103, v95
    v_mul_f32 v104, v104, v96
    v_mul_f32 v105, v105, v97
    v_mul_f32 v106, v106, v98
    v_mul_f32 v107, v107, v99
    v_exp_f32 v100, v100
    v_exp_f32 v101, v101
    v_exp_f32 v102, v102
    v_exp_f32 v103, v103
    v_exp_f32 v104, v104
    v_exp_f32 v105, v105
    v_exp_f32 v106, v106
    v_exp_f32 v107, v107
    v_add_f32 v100, 1.0, v100
    v_add_f32 v101, 1.0, v101
    v_add_f32 v102, 1.0, v102
    v_add_f32 v103, 1.0, v103
    v_add_f32 v104, 1.0, v104
    v_add_f32 v105, 1.0, v105
    v_add_f32 v106, 1.0, v106
    v_add_f32 v107, 1.0, v107
    v_rcp_f32 v100, v100
    v_rcp_f32 v101, v101
    v_rcp_f32 v102, v102
    v_rcp_f32 v103, v103
    v_rcp_f32 v104, v104
    v_rcp_f32 v105, v105
    v_rcp_f32 v106, v106
    v_rcp_f32 v107, v107
    v_mul_f32 v92, v92, v100
    v_mul_f32 v93, v93, v101
    v_mul_f32 v94, v94, v102
    v_mul_f32 v95, v95, v103
    v_mul_f32 v96, v96, v104
    v_mul_f32 v97, v97, v105
    v_mul_f32 v98, v98, v106
    v_mul_f32 v99, v99, v107
    v_cvt_pk_bf16_f32 v116, v92, v93
    v_cvt_pk_bf16_f32 v117, v94, v95
    v_cvt_pk_bf16_f32 v118, v96, v97
    v_cvt_pk_bf16_f32 v119, v98, v99
    v_and_b32 v116, s39, v116
    v_and_b32 v117, s39, v117
    v_and_b32 v118, s39, v118
    v_and_b32 v119, s39, v119
    v_add_u32 v123, 16, v122
    v_cmp_gt_u32 vcc, 160, v123
    s_nop 0
    s_and_saveexec_b64 s[40:41], vcc
    ds_write_b128 v56, v[116:119] offset:1024
    s_mov_b64 exec, s[40:41]
    ds_read_b64_tr_b16 v[60:61], v44 offset:4096
    ds_read_b64_tr_b16 v[62:63], v44 offset:4352
    ds_read_b64_tr_b16 v[64:65], v44 offset:6144
    ds_read_b64_tr_b16 v[66:67], v44 offset:6400
    ds_read_b64_tr_b16 v[68:69], v45 offset:4096
    ds_read_b64_tr_b16 v[70:71], v45 offset:4352
    ds_read_b64_tr_b16 v[72:73], v45 offset:6144
    ds_read_b64_tr_b16 v[74:75], v45 offset:6400
    s_waitcnt lgkmcnt(0)
    v_mfma_f32_16x16x32_bf16 v[76:79], v[60:63], v[8:11], 0
    v_mfma_f32_16x16x32_bf16 v[80:83], v[68:71], v[8:11], 0
    v_mfma_f32_16x16x32_bf16 v[84:87], v[60:63], v[16:19], 0
    v_mfma_f32_16x16x32_bf16 v[88:91], v[68:71], v[16:19], 0
    v_mfma_f32_16x16x32_bf16 v[92:95], v[60:63], v[24:27], 0
    v_mfma_f32_16x16x32_bf16 v[96:99], v[68:71], v[24:27], 0
    v_mfma_f32_16x16x32_bf16 v[76:79], v[64:67], v[12:15], v[76:79]
    v_mfma_f32_16x16x32_bf16 v[80:83], v[72:75], v[12:15], v[80:83]
    v_mfma_f32_16x16x32_bf16 v[84:87], v[64:67], v[20:23], v[84:87]
    v_mfma_f32_16x16x32_bf16 v[88:91], v[72:75], v[20:23], v[88:91]
    v_mfma_f32_16x16x32_bf16 v[92:95], v[64:67], v[28:31], v[92:95]
    v_mfma_f32_16x16x32_bf16 v[96:99], v[72:75], v[28:31], v[96:99]
    s_add_u32 s31, s28, 1
    s_cmp_eq_u32 s31, 166
    s_cselect_b32 s39, 0, -1
    s_nop 4
    v_mul_f32 v100, v76, v76
    v_mul_f32 v101, v77, v77
    v_mul_f32 v102, v78, v78
    v_mul_f32 v103, v79, v79
    v_mul_f32 v104, v80, v80
    v_mul_f32 v105, v81, v81
    v_mul_f32 v106, v82, v82
    v_mul_f32 v107, v83, v83
    v_fma_f32 v100, v100, s36, v59
    v_fma_f32 v101, v101, s36, v59
    v_fma_f32 v102, v102, s36, v59
    v_fma_f32 v103, v103, s36, v59
    v_fma_f32 v104, v104, s36, v59
    v_fma_f32 v105, v105, s36, v59
    v_fma_f32 v106, v106, s36, v59
    v_fma_f32 v107, v107, s36, v59
    v_mul_f32 v100, v100, v76
    v_mul_f32 v101, v101, v77
    v_mul_f32 v102, v102, v78
    v_mul_f32 v103, v103, v79
    v_mul_f32 v104, v104, v80
    v_mul_f32 v105, v105, v81
    v_mul_f32 v106, v106, v82
    v_mul_f32 v107, v107, v83
    v_exp_f32 v100, v100
    v_exp_f32 v101, v101
    v_exp_f32 v102, v102
    v_exp_f32 v103, v103
    v_exp_f32 v104, v104
    v_exp_f32 v105, v105
    v_exp_f32 v106, v106
    v_exp_f32 v107, v107
    v_add_f32 v100, 1.0, v100
    v_add_f32 v101, 1.0, v101
    v_add_f32 v102, 1.0, v102
    v_add_f32 v103, 1.0, v103
    v_add_f32 v104, 1.0, v104
    v_add_f32 v105, 1.0, v105
    v_add_f32 v106, 1.0, v106
    v_add_f32 v107, 1.0, v107
    v_rcp_f32 v100, v100
    v_rcp_f32 v101, v101
    v_rcp_f32 v102, v102
    v_rcp_f32 v103, v103
    v_rcp_f32 v104, v104
    v_rcp_f32 v105, v105
    v_rcp_f32 v106, v106
    v_rcp_f32 v107, v107
    v_mul_f32 v76, v76, v100
    v_mul_f32 v77, v77, v101
    v_mul_f32 v78, v78, v102
    v_mul_f32 v79, v79, v103
    v_mul_f32 v80, v80, v104
    v_mul_f32 v81, v81, v105
    v_mul_f32 v82, v82, v106
    v_mul_f32 v83, v83, v107
    v_cvt_pk_bf16_f32 v108, v76, v77
    v_cvt_pk_bf16_f32 v109, v78, v79
    v_cvt_pk_bf16_f32 v110, v80, v81
    v_cvt_pk_bf16_f32 v111, v82, v83
    v_add_u32 v123, 24, v122
    v_cmp_gt_u32 vcc, 160, v123
    s_nop 0
    s_and_saveexec_b64 s[40:41], vcc
    ds_write_b128 v57, v[108:111] offset:1536
    s_mov_b64 exec, s[40:41]
    v_mul_f32 v100, v84, v84
    v_mul_f32 v101, v85, v85
    v_mul_f32 v102, v86, v86
    v_mul_f32 v103, v87, v87
    v_mul_f32 v104, v88, v88
    v_mul_f32 v105, v89, v89
    v_mul_f32 v106, v90, v90
    v_mul_f32 v107, v91, v91
    v_fma_f32 v100, v100, s36, v59
    v_fma_f32 v101, v101, s36, v59
    v_fma_f32 v102, v102, s36, v59
    v_fma_f32 v103, v103, s36, v59
    v_fma_f32 v104, v104, s36, v59
    v_fma_f32 v105, v105, s36, v59
    v_fma_f32 v106, v106, s36, v59
    v_fma_f32 v107, v107, s36, v59
    v_mul_f32 v100, v100, v84
    v_mul_f32 v101, v101, v85
    v_mul_f32 v102, v102, v86
    v_mul_f32 v103, v103, v87
    v_mul_f32 v104, v104, v88
    v_mul_f32 v105, v105, v89
    v_mul_f32 v106, v106, v90
    v_mul_f32 v107, v107, v91
    v_exp_f32 v100, v100
    v_exp_f32 v101, v101
    v_exp_f32 v102, v102
    v_exp_f32 v103, v103
    v_exp_f32 v104, v104
    v_exp_f32 v105, v105
    v_exp_f32 v106, v106
    v_exp_f32 v107, v107
    v_add_f32 v100, 1.0, v100
    v_add_f32 v101, 1.0, v101
    v_add_f32 v102, 1.0, v102
    v_add_f32 v103, 1.0, v103
    v_add_f32 v104, 1.0, v104
    v_add_f32 v105, 1.0, v105
    v_add_f32 v106, 1.0, v106
    v_add_f32 v107, 1.0, v107
    v_rcp_f32 v100, v100
    v_rcp_f32 v101, v101
    v_rcp_f32 v102, v102
    v_rcp_f32 v103, v103
    v_rcp_f32 v104, v104
    v_rcp_f32 v105, v105
    v_rcp_f32 v106, v106
    v_rcp_f32 v107, v107
    v_mul_f32 v84, v84, v100
    v_mul_f32 v85, v85, v101
    v_mul_f32 v86, v86, v102
    v_mul_f32 v87, v87, v103
    v_mul_f32 v88, v88, v104
    v_mul_f32 v89, v89, v105
    v_mul_f32 v90, v90, v106
    v_mul_f32 v91, v91, v107
    v_cvt_pk_bf16_f32 v112, v84, v85
    v_cvt_pk_bf16_f32 v113, v86, v87
    v_cvt_pk_bf16_f32 v114, v88, v89
    v_cvt_pk_bf16_f32 v115, v90, v91
    v_add_u32 v123, 32, v122
    v_cmp_gt_u32 vcc, 160, v123
    s_nop 0
    s_and_saveexec_b64 s[40:41], vcc
    ds_write_b128 v56, v[112:115] offset:2048
    s_mov_b64 exec, s[40:41]
    v_mul_f32 v100, v92, v92
    v_mul_f32 v101, v93, v93
    v_mul_f32 v102, v94, v94
    v_mul_f32 v103, v95, v95
    v_mul_f32 v104, v96, v96
    v_mul_f32 v105, v97, v97
    v_mul_f32 v106, v98, v98
    v_mul_f32 v107, v99, v99
    v_fma_f32 v100, v100, s36, v59
    v_fma_f32 v101, v101, s36, v59
    v_fma_f32 v102, v102, s36, v59
    v_fma_f32 v103, v103, s36, v59
    v_fma_f32 v104, v104, s36, v59
    v_fma_f32 v105, v105, s36, v59
    v_fma_f32 v106, v106, s36, v59
    v_fma_f32 v107, v107, s36, v59
    v_mul_f32 v100, v100, v92
    v_mul_f32 v101, v101, v93
    v_mul_f32 v102, v102, v94
    v_mul_f32 v103, v103, v95
    v_mul_f32 v104, v104, v96
    v_mul_f32 v105, v105, v97
    v_mul_f32 v106, v106, v98
    v_mul_f32 v107, v107, v99
    v_exp_f32 v100, v100
    v_exp_f32 v101, v101
    v_exp_f32 v102, v102
    v_exp_f32 v103, v103
    v_exp_f32 v104, v104
    v_exp_f32 v105, v105
    v_exp_f32 v106, v106
    v_exp_f32 v107, v107
    v_add_f32 v100, 1.0, v100
    v_add_f32 v101, 1.0, v101
    v_add_f32 v102, 1.0, v102
    v_add_f32 v103, 1.0, v103
    v_add_f32 v104, 1.0, v104
    v_add_f32 v105, 1.0, v105
    v_add_f32 v106, 1.0, v106
    v_add_f32 v107, 1.0, v107
    v_rcp_f32 v100, v100
    v_rcp_f32 v101, v101
    v_rcp_f32 v102, v102
    v_rcp_f32 v103, v103
    v_rcp_f32 v104, v104
    v_rcp_f32 v105, v105
    v_rcp_f32 v106, v106
    v_rcp_f32 v107, v107
    v_mul_f32 v92, v92, v100
    v_mul_f32 v93, v93, v101
    v_mul_f32 v94, v94, v102
    v_mul_f32 v95, v95, v103
    v_mul_f32 v96, v96, v104
    v_mul_f32 v97, v97, v105
    v_mul_f32 v98, v98, v106
    v_mul_f32 v99, v99, v107
    v_cvt_pk_bf16_f32 v116, v92, v93
    v_cvt_pk_bf16_f32 v117, v94, v95
    v_cvt_pk_bf16_f32 v118, v96, v97
    v_cvt_pk_bf16_f32 v119, v98, v99
    v_and_b32 v116, s39, v116
    v_and_b32 v117, s39, v117
    v_and_b32 v118, s39, v118
    v_and_b32 v119, s39, v119
    v_add_u32 v123, 40, v122
    v_cmp_gt_u32 vcc, 160, v123
    s_nop 0
    s_and_saveexec_b64 s[40:41], vcc
    ds_write_b128 v57, v[116:119] offset:2560
    s_mov_b64 exec, s[40:41]
    s_waitcnt vmcnt(0)
    s_waitcnt lgkmcnt(0)
    s_barrier
    ds_read_b64_tr_b16 v[60:61], v49 offset:0
    ds_read_b64_tr_b16 v[62:63], v49 offset:256
    ds_read_b64_tr_b16 v[64:65], v49 offset:2048
    ds_read_b64_tr_b16 v[66:67], v49 offset:2304
    ds_read_b64_tr_b16 v[68:69], v50 offset:0
    ds_read_b64_tr_b16 v[70:71], v50 offset:256
    ds_read_b64_tr_b16 v[72:73], v50 offset:2048
    ds_read_b64_tr_b16 v[74:75], v50 offset:2304
    s_waitcnt lgkmcnt(0)
    v_mfma_f32_16x16x32_bf16 v[92:95], v[60:63], v[32:35], 0
    v_mfma_f32_16x16x32_bf16 v[96:99], v[68:71], v[32:35], 0
    v_mfma_f32_16x16x32_bf16 v[92:95], v[64:67], v[36:39], v[92:95]
    v_mfma_f32_16x16x32_bf16 v[96:99], v[72:75], v[36:39], v[96:99]
    ds_read_b64_tr_b16 v[76:77], v51 offset:0
    ds_read_b64_tr_b16 v[78:79], v53 offset:0
    ds_read_b64_tr_b16 v[80:81], v51 offset:2048
    ds_read_b64_tr_b16 v[82:83], v53 offset:2048
    ds_read_b64_tr_b16 v[84:85], v52 offset:0
    ds_read_b64_tr_b16 v[86:87], v54 offset:0
    ds_read_b64_tr_b16 v[88:89], v52 offset:2048
    ds_read_b64_tr_b16 v[90:91], v54 offset:2048
    v_cvt_pk_bf16_f32 v108, v92, v93
    v_cvt_pk_bf16_f32 v109, v94, v95
    v_cvt_pk_bf16_f32 v110, v96, v97
    v_cvt_pk_bf16_f32 v111, v98, v99
    s_add_u32 s38, s37, 0
    buffer_store_dwordx4 v[108:111], v58, s[16:19], s38 offen sc1
    s_waitcnt lgkmcnt(0)
    v_mfma_f32_16x16x32_bf16 v[100:103], v[76:79], v[32:35], 0
    v_mfma_f32_16x16x32_bf16 v[104:107], v[84:87], v[32:35], 0
    v_mfma_f32_16x16x32_bf16 v[100:103], v[80:83], v[36:39], v[100:103]
    v_mfma_f32_16x16x32_bf16 v[104:107], v[88:91], v[36:39], v[104:107]
    ds_read_b64_tr_b16 v[60:61], v49 offset:3072
    ds_read_b64_tr_b16 v[62:63], v49 offset:3328
    ds_read_b64_tr_b16 v[64:65], v49 offset:5120
    ds_read_b64_tr_b16 v[66:67], v49 offset:5376
    ds_read_b64_tr_b16 v[68:69], v50 offset:3072
    ds_read_b64_tr_b16 v[70:71], v50 offset:3328
    ds_read_b64_tr_b16 v[72:73], v50 offset:5120
    ds_read_b64_tr_b16 v[74:75], v50 offset:5376
    v_cvt_pk_bf16_f32 v112, v100, v101
    v_cvt_pk_bf16_f32 v113, v102, v103
    v_cvt_pk_bf16_f32 v114, v104, v105
    v_cvt_pk_bf16_f32 v115, v106, v107
    s_add_u32 s38, s37, 1024
    buffer_store_dwordx4 v[112:115], v58, s[16:19], s38 offen sc1
    s_waitcnt lgkmcnt(0)
    v_mfma_f32_16x16x32_bf16 v[92:95], v[60:63], v[32:35], 0
    v_mfma_f32_16x16x32_bf16 v[96:99], v[68:71], v[32:35], 0
    v_mfma_f32_16x16x32_bf16 v[92:95], v[64:67], v[36:39], v[92:95]
    v_mfma_f32_16x16x32_bf16 v[96:99], v[72:75], v[36:39], v[96:99]
    ds_read_b64_tr_b16 v[76:77], v51 offset:3072
    ds_read_b64_tr_b16 v[78:79], v53 offset:3072
    ds_read_b64_tr_b16 v[80:81], v51 offset:5120
    ds_read_b64_tr_b16 v[82:83], v53 offset:5120
    ds_read_b64_tr_b16 v[84:85], v52 offset:3072
    ds_read_b64_tr_b16 v[86:87], v54 offset:3072
    ds_read_b64_tr_b16 v[88:89], v52 offset:5120
    ds_read_b64_tr_b16 v[90:91], v54 offset:5120
    v_cvt_pk_bf16_f32 v108, v92, v93
    v_cvt_pk_bf16_f32 v109, v94, v95
    v_cvt_pk_bf16_f32 v110, v96, v97
    v_cvt_pk_bf16_f32 v111, v98, v99
    s_add_u32 s38, s37, 2048
    buffer_store_dwordx4 v[108:111], v58, s[16:19], s38 offen sc1
    s_waitcnt lgkmcnt(0)
    v_mfma_f32_16x16x32_bf16 v[100:103], v[76:79], v[32:35], 0
    v_mfma_f32_16x16x32_bf16 v[104:107], v[84:87], v[32:35], 0
    v_mfma_f32_16x16x32_bf16 v[100:103], v[80:83], v[36:39], v[100:103]
    v_mfma_f32_16x16x32_bf16 v[104:107], v[88:91], v[36:39], v[104:107]
    ds_read_b64_tr_b16 v[60:61], v49 offset:6144
    ds_read_b64_tr_b16 v[62:63], v49 offset:6400
    ds_read_b64_tr_b16 v[64:65], v49 offset:8192
    ds_read_b64_tr_b16 v[66:67], v49 offset:8448
    ds_read_b64_tr_b16 v[68:69], v50 offset:6144
    ds_read_b64_tr_b16 v[70:71], v50 offset:6400
    ds_read_b64_tr_b16 v[72:73], v50 offset:8192
    ds_read_b64_tr_b16 v[74:75], v50 offset:8448
    v_cvt_pk_bf16_f32 v112, v100, v101
    v_cvt_pk_bf16_f32 v113, v102, v103
    v_cvt_pk_bf16_f32 v114, v104, v105
    v_cvt_pk_bf16_f32 v115, v106, v107
    s_add_u32 s38, s37, 3072
    buffer_store_dwordx4 v[112:115], v58, s[16:19], s38 offen sc1
    s_waitcnt lgkmcnt(0)
    v_mfma_f32_16x16x32_bf16 v[92:95], v[60:63], v[32:35], 0
    v_mfma_f32_16x16x32_bf16 v[96:99], v[68:71], v[32:35], 0
    v_mfma_f32_16x16x32_bf16 v[92:95], v[64:67], v[36:39], v[92:95]
    v_mfma_f32_16x16x32_bf16 v[96:99], v[72:75], v[36:39], v[96:99]
    ds_read_b64_tr_b16 v[76:77], v51 offset:6144
    ds_read_b64_tr_b16 v[78:79], v53 offset:6144
    ds_read_b64_tr_b16 v[80:81], v51 offset:8192
    ds_read_b64_tr_b16 v[82:83], v53 offset:8192
    ds_read_b64_tr_b16 v[84:85], v52 offset:6144
    ds_read_b64_tr_b16 v[86:87], v54 offset:6144
    ds_read_b64_tr_b16 v[88:89], v52 offset:8192
    ds_read_b64_tr_b16 v[90:91], v54 offset:8192
    v_cvt_pk_bf16_f32 v108, v92, v93
    v_cvt_pk_bf16_f32 v109, v94, v95
    v_cvt_pk_bf16_f32 v110, v96, v97
    v_cvt_pk_bf16_f32 v111, v98, v99
    s_add_u32 s38, s37, 4096
    buffer_store_dwordx4 v[108:111], v58, s[16:19], s38 offen sc1
    s_waitcnt lgkmcnt(0)
    v_mfma_f32_16x16x32_bf16 v[100:103], v[76:79], v[32:35], 0
    v_mfma_f32_16x16x32_bf16 v[104:107], v[84:87], v[32:35], 0
    v_mfma_f32_16x16x32_bf16 v[100:103], v[80:83], v[36:39], v[100:103]
    v_mfma_f32_16x16x32_bf16 v[104:107], v[88:91], v[36:39], v[104:107]
    s_nop 7
    v_cvt_pk_bf16_f32 v112, v100, v101
    v_cvt_pk_bf16_f32 v113, v102, v103
    v_cvt_pk_bf16_f32 v114, v104, v105
    v_cvt_pk_bf16_f32 v115, v106, v107
    s_add_u32 s38, s37, 5120
    buffer_store_dwordx4 v[112:115], v58, s[16:19], s38 offen sc1
    s_endpgm
L_mid_kernel_g:
    s_sub_u32 s3, s2, 448
    s_load_dwordx2 s[4:5], s[0:1], 16
    s_load_dwordx2 s[6:7], s[0:1], 72
    s_lshr_b32 s24, s3, 4
    s_bfe_u32 s25, s3, 0x20002
    s_and_b32 s26, s3, 3
    s_lshr_b32 s27, s24, 3
    s_and_b32 s28, s24, 7
    v_and_b32 v1, 63, v0
    v_lshrrev_b32 v2, 3, v1
    v_mov_b32 v3, v2
    s_lshl_b32 s29, s25, 3
    s_lshl_b32 s30, s28, 5
    s_add_u32 s29, s29, s30
    v_add_u32 v3, s29, v3
    v_lshlrev_b32 v3, 9, v3
    v_and_b32 v4, 7, v1
    s_lshr_b32 s30, s20, 1
    s_lshl_b32 s30, s30, 2
    v_xor_b32 v4, s30, v4
    v_lshl_add_u32 v3, v4, 4, v3
    s_lshl_b32 s30, s26, 7
    v_add_u32 v3, s30, v3
    v_xor_b32 v4, 32, v3
    s_waitcnt lgkmcnt(0)
    s_mov_b32 s8, s4
    s_mov_b32 s9, s5
    s_mov_b32 s10, 4063232
    s_mov_b32 s11, 0x00020000
    s_add_u32 s12, s6, 62345216
    s_addc_u32 s13, s7, 0
    s_mov_b32 s14, 16916480
    s_mov_b32 s15, 0x00020000
    s_lshl_b32 s30, s20, 3
    s_add_u32 s30, s30, s27
    s_lshl_b32 s30, s30, 17
    s_mul_i32 s31, s20, 4608
    s_add_u32 m0, s31, 0
    s_add_u32 s32, s30, 0
    buffer_load_dwordx4 v3, s[8:11], s32 offen nt lds
    s_add_u32 m0, s31, 1152
    s_add_u32 s32, s30, 262144
    buffer_load_dwordx4 v3, s[8:11], s32 offen nt lds
    s_add_u32 m0, s31, 2304
    s_add_u32 s32, s30, 524288
    buffer_load_dwordx4 v4, s[8:11], s32 offen nt lds
    s_add_u32 m0, s31, 3456
    s_add_u32 s32, s30, 786432
    buffer_load_dwordx4 v4, s[8:11], s32 offen nt lds
    v_and_b32 v8, 15, v1
    v_or_b32 v9, 1, v8
    s_lshl_b32 s33, s20, 4
    v_add_u32 v9, s33, v9
    v_cvt_f32_u32 v9, v9
    v_mul_f32 v9, 0x3c000000, v9
    v_bfe_u32 v10, v1, 4, 1
    v_lshlrev_b32 v10, 3, v10
    v_cvt_f32_u32 v10, v10
    v_and_b32 v8, 1, v8
    v_cvt_f32_u32 v8, v8
    v_mul_f32 v8, 0x3f400000, v8
    v_fma_f32 v11, v9, v10, v8
    v_fract_f32 v12, v11
    v_add_f32 v11, v11, v9
    v_fract_f32 v13, v11
    v_add_f32 v11, v11, v9
    v_fract_f32 v14, v11
    v_add_f32 v11, v11, v9
    v_fract_f32 v15, v11
    v_add_f32 v11, v11, v9
    v_fract_f32 v16, v11
    v_add_f32 v11, v11, v9
    v_fract_f32 v17, v11
    v_add_f32 v11, v11, v9
    v_fract_f32 v18, v11
    v_add_f32 v11, v11, v9
    v_fract_f32 v19, v11
    v_cos_f32 v12, v12
    v_cos_f32 v13, v13
    v_cos_f32 v14, v14
    v_cos_f32 v15, v15
    v_cos_f32 v16, v16
    v_cos_f32 v17, v17
    v_cos_f32 v18, v18
    v_cos_f32 v19, v19
    s_nop 0
    v_mul_f32 v12, 0x3d000000, v12
    v_mul_f32 v13, 0x3d000000, v13
    v_mul_f32 v14, 0x3d000000, v14
    v_mul_f32 v15, 0x3d000000, v15
    v_mul_f32 v16, 0x3d000000, v16
    v_mul_f32 v17, 0x3d000000, v17
    v_mul_f32 v18, 0x3d000000, v18
    v_mul_f32 v19, 0x3d000000, v19
    v_cvt_pk_bf16_f32 v20, v12, v13
    v_cvt_pk_bf16_f32 v21, v14, v15
    v_cvt_pk_bf16_f32 v22, v16, v17
    v_cvt_pk_bf16_f32 v23, v18, v19
    v_lshlrev_b32 v28, 16, v20
    v_and_b32 v29, 0xffff0000, v20
    v_sub_f32 v28, v12, v28
    v_sub_f32 v29, v13, v29
    v_cvt_pk_bf16_f32 v24, v28, v29
    v_lshlrev_b32 v28, 16, v21
    v_and_b32 v29, 0xffff0000, v21
    v_sub_f32 v28, v14, v28
    v_sub_f32 v29, v15, v29
    v_cvt_pk_bf16_f32 v25, v28, v29
    v_lshlrev_b32 v28, 16, v22
    v_and_b32 v29, 0xffff0000, v22
    v_sub_f32 v28, v16, v28
    v_sub_f32 v29, v17, v29
    v_cvt_pk_bf16_f32 v26, v28, v29
    v_lshlrev_b32 v28, 16, v23
    v_and_b32 v29, 0xffff0000, v23
    v_sub_f32 v28, v18, v28
    v_sub_f32 v29, v19, v29
    v_cvt_pk_bf16_f32 v27, v28, v29
    v_cmp_gt_u32 vcc, 32, v1
    s_nop 1
    v_cndmask_b32 v20, v24, v20, vcc
    v_cndmask_b32 v21, v25, v21, vcc
    v_cndmask_b32 v22, v26, v22, vcc
    v_cndmask_b32 v23, v27, v23, vcc
    v_lshlrev_b32 v28, 4, v1
    s_lshl_b32 s33, s20, 10
    v_add_u32 v29, s33, v28
    ds_write_b128 v29, v[20:23] offset:18432
    v_bfe_u32 v30, v1, 2, 2
    v_bfe_u32 v31, v1, 4, 1
    v_lshl_add_u32 v32, v31, 3, v30
    v_mul_u32_u24 v32, 1152, v32
    v_lshrrev_b32 v30, 1, v30
    v_lshl_add_u32 v30, v31, 1, v30
    v_lshlrev_b32 v30, 1, v30
    v_bfe_u32 v31, v1, 1, 1
    s_lshl_b32 s33, s20, 1
    v_add_u32 v31, s33, v31
    v_xor_b32 v30, v30, v31
    v_lshl_add_u32 v32, v30, 4, v32
    v_and_b32 v30, 1, v1
    v_lshl_add_u32 v32, v30, 3, v32
    v_lshrrev_b32 v30, 4, v1
    s_mov_b32 s33, 1057280
    v_mul_lo_u32 v30, v30, s33
    v_and_b32 v31, 15, v1
    v_lshl_add_u32 v33, v31, 4, v30
    s_lshl_b32 s34, s24, 15
    s_lshl_b32 s35, s26, 2
    s_add_u32 s35, s35, s20
    s_lshl_b32 s35, s35, 11
    s_add_u32 s34, s34, s35
    s_lshl_b32 s35, s25, 8
    s_add_u32 s34, s34, s35
    s_waitcnt vmcnt(0) lgkmcnt(0)
    s_barrier
    ds_read_b128 v[36:39], v28 offset:18432
    ds_read_b128 v[40:43], v28 offset:19456
    ds_read_b128 v[44:47], v28 offset:20480
    ds_read_b128 v[48:51], v28 offset:21504
    ds_read_b64_tr_b16 v[52:53], v32 offset:0
    ds_read_b64_tr_b16 v[54:55], v32 offset:4608
    ds_read_b64_tr_b16 v[56:57], v32 offset:128
    ds_read_b64_tr_b16 v[58:59], v32 offset:4736
    ds_read_b64_tr_b16 v[60:61], v32 offset:256
    ds_read_b64_tr_b16 v[62:63], v32 offset:4864
    ds_read_b64_tr_b16 v[64:65], v32 offset:384
    ds_read_b64_tr_b16 v[66:67], v32 offset:4992
    ds_read_b64_tr_b16 v[68:69], v32 offset:512
    ds_read_b64_tr_b16 v[70:71], v32 offset:5120
    s_waitcnt lgkmcnt(8)
    ds_read_b64_tr_b16 v[72:73], v32 offset:640
    ds_read_b64_tr_b16 v[74:75], v32 offset:5248
    ds_read_b64_tr_b16 v[76:77], v32 offset:768
    ds_read_b64_tr_b16 v[78:79], v32 offset:5376
    ds_read_b64_tr_b16 v[80:81], v32 offset:896
    ds_read_b64_tr_b16 v[82:83], v32 offset:5504
    s_waitcnt lgkmcnt(0)
    v_mfma_f32_16x16x32_bf16 v[84:87], v[36:39], v[52:55], 0
    v_mfma_f32_16x16x32_bf16 v[88:91], v[36:39], v[56:59], 0
    v_mfma_f32_16x16x32_bf16 v[92:95], v[36:39], v[60:63], 0
    v_mfma_f32_16x16x32_bf16 v[96:99], v[36:39], v[64:67], 0
    v_mfma_f32_16x16x32_bf16 v[100:103], v[36:39], v[68:71], 0
    v_mfma_f32_16x16x32_bf16 v[104:107], v[36:39], v[72:75], 0
    v_mfma_f32_16x16x32_bf16 v[108:111], v[36:39], v[76:79], 0
    v_mfma_f32_16x16x32_bf16 v[112:115], v[36:39], v[80:83], 0
    s_nop 7
    v_cvt_pk_bf16_f32 v116, v84, v88
    v_cvt_pk_bf16_f32 v117, v92, v96
    v_cvt_pk_bf16_f32 v118, v100, v104
    v_cvt_pk_bf16_f32 v119, v108, v112
    s_add_u32 s35, s34, 0
    buffer_store_dwordx4 v[116:119], v33, s[12:15], s35 offen sc1
    s_nop 1
    v_cvt_pk_bf16_f32 v120, v85, v89
    v_cvt_pk_bf16_f32 v121, v93, v97
    v_cvt_pk_bf16_f32 v122, v101, v105
    v_cvt_pk_bf16_f32 v123, v109, v113
    s_add_u32 s35, s34, 1024
    buffer_store_dwordx4 v[120:123], v33, s[12:15], s35 offen sc1
    s_nop 1
    v_cvt_pk_bf16_f32 v116, v86, v90
    v_cvt_pk_bf16_f32 v117, v94, v98
    v_cvt_pk_bf16_f32 v118, v102, v106
    v_cvt_pk_bf16_f32 v119, v110, v114
    s_add_u32 s35, s34, 528640
    buffer_store_dwordx4 v[116:119], v33, s[12:15], s35 offen sc1
    s_nop 1
    v_cvt_pk_bf16_f32 v120, v87, v91
    v_cvt_pk_bf16_f32 v121, v95, v99
    v_cvt_pk_bf16_f32 v122, v103, v107
    v_cvt_pk_bf16_f32 v123, v111, v115
    s_add_u32 s35, s34, 529664
    buffer_store_dwordx4 v[120:123], v33, s[12:15], s35 offen sc1
    s_nop 1
    v_mfma_f32_16x16x32_bf16 v[84:87], v[40:43], v[52:55], 0
    v_mfma_f32_16x16x32_bf16 v[88:91], v[40:43], v[56:59], 0
    v_mfma_f32_16x16x32_bf16 v[92:95], v[40:43], v[60:63], 0
    v_mfma_f32_16x16x32_bf16 v[96:99], v[40:43], v[64:67], 0
    v_mfma_f32_16x16x32_bf16 v[100:103], v[40:43], v[68:71], 0
    v_mfma_f32_16x16x32_bf16 v[104:107], v[40:43], v[72:75], 0
    v_mfma_f32_16x16x32_bf16 v[108:111], v[40:43], v[76:79], 0
    v_mfma_f32_16x16x32_bf16 v[112:115], v[40:43], v[80:83], 0
    s_nop 7
    v_cvt_pk_bf16_f32 v116, v84, v88
    v_cvt_pk_bf16_f32 v117, v92, v96
    v_cvt_pk_bf16_f32 v118, v100, v104
    v_cvt_pk_bf16_f32 v119, v108, v112
    s_add_u32 s35, s34, 4229120
    buffer_store_dwordx4 v[116:119], v33, s[12:15], s35 offen sc1
    s_nop 1
    v_cvt_pk_bf16_f32 v120, v85, v89
    v_cvt_pk_bf16_f32 v121, v93, v97
    v_cvt_pk_bf16_f32 v122, v101, v105
    v_cvt_pk_bf16_f32 v123, v109, v113
    s_add_u32 s35, s34, 4230144
    buffer_store_dwordx4 v[120:123], v33, s[12:15], s35 offen sc1
    s_nop 1
    v_cvt_pk_bf16_f32 v116, v86, v90
    v_cvt_pk_bf16_f32 v117, v94, v98
    v_cvt_pk_bf16_f32 v118, v102, v106
    v_cvt_pk_bf16_f32 v119, v110, v114
    s_add_u32 s35, s34, 4757760
    buffer_store_dwordx4 v[116:119], v33, s[12:15], s35 offen sc1
    s_nop 1
    v_cvt_pk_bf16_f32 v120, v87, v91
    v_cvt_pk_bf16_f32 v121, v95, v99
    v_cvt_pk_bf16_f32 v122, v103, v107
    v_cvt_pk_bf16_f32 v123, v111, v115
    s_add_u32 s35, s34, 4758784
    buffer_store_dwordx4 v[120:123], v33, s[12:15], s35 offen sc1
    s_nop 1
    v_mfma_f32_16x16x32_bf16 v[84:87], v[44:47], v[52:55], 0
    v_mfma_f32_16x16x32_bf16 v[88:91], v[44:47], v[56:59], 0
    v_mfma_f32_16x16x32_bf16 v[92:95], v[44:47], v[60:63], 0
    v_mfma_f32_16x16x32_bf16 v[96:99], v[44:47], v[64:67], 0
    v_mfma_f32_16x16x32_bf16 v[100:103], v[44:47], v[68:71], 0
    v_mfma_f32_16x16x32_bf16 v[104:107], v[44:47], v[72:75], 0
    v_mfma_f32_16x16x32_bf16 v[108:111], v[44:47], v[76:79], 0
    v_mfma_f32_16x16x32_bf16 v[112:115], v[44:47], v[80:83], 0
    s_nop 7
    v_cvt_pk_bf16_f32 v116, v84, v88
    v_cvt_pk_bf16_f32 v117, v92, v96
    v_cvt_pk_bf16_f32 v118, v100, v104
    v_cvt_pk_bf16_f32 v119, v108, v112
    s_add_u32 s35, s34, 8458240
    buffer_store_dwordx4 v[116:119], v33, s[12:15], s35 offen sc1
    s_nop 1
    v_cvt_pk_bf16_f32 v120, v85, v89
    v_cvt_pk_bf16_f32 v121, v93, v97
    v_cvt_pk_bf16_f32 v122, v101, v105
    v_cvt_pk_bf16_f32 v123, v109, v113
    s_add_u32 s35, s34, 8459264
    buffer_store_dwordx4 v[120:123], v33, s[12:15], s35 offen sc1
    s_nop 1
    v_cvt_pk_bf16_f32 v116, v86, v90
    v_cvt_pk_bf16_f32 v117, v94, v98
    v_cvt_pk_bf16_f32 v118, v102, v106
    v_cvt_pk_bf16_f32 v119, v110, v114
    s_add_u32 s35, s34, 8986880
    buffer_store_dwordx4 v[116:119], v33, s[12:15], s35 offen sc1
    s_nop 1
    v_cvt_pk_bf16_f32 v120, v87, v91
    v_cvt_pk_bf16_f32 v121, v95, v99
    v_cvt_pk_bf16_f32 v122, v103, v107
    v_cvt_pk_bf16_f32 v123, v111, v115
    s_add_u32 s35, s34, 8987904
    buffer_store_dwordx4 v[120:123], v33, s[12:15], s35 offen sc1
    s_nop 1
    v_mfma_f32_16x16x32_bf16 v[84:87], v[48:51], v[52:55], 0
    v_mfma_f32_16x16x32_bf16 v[88:91], v[48:51], v[56:59], 0
    v_mfma_f32_16x16x32_bf16 v[92:95], v[48:51], v[60:63], 0
    v_mfma_f32_16x16x32_bf16 v[96:99], v[48:51], v[64:67], 0
    v_mfma_f32_16x16x32_bf16 v[100:103], v[48:51], v[68:71], 0
    v_mfma_f32_16x16x32_bf16 v[104:107], v[48:51], v[72:75], 0
    v_mfma_f32_16x16x32_bf16 v[108:111], v[48:51], v[76:79], 0
    v_mfma_f32_16x16x32_bf16 v[112:115], v[48:51], v[80:83], 0
    s_nop 7
    v_cvt_pk_bf16_f32 v116, v84, v88
    v_cvt_pk_bf16_f32 v117, v92, v96
    v_cvt_pk_bf16_f32 v118, v100, v104
    v_cvt_pk_bf16_f32 v119, v108, v112
    s_add_u32 s35, s34, 12687360
    buffer_store_dwordx4 v[116:119], v33, s[12:15], s35 offen sc1
    s_nop 1
    v_cvt_pk_bf16_f32 v120, v85, v89
    v_cvt_pk_bf16_f32 v121, v93, v97
    v_cvt_pk_bf16_f32 v122, v101, v105
    v_cvt_pk_bf16_f32 v123, v109, v113
    s_add_u32 s35, s34, 12688384
    buffer_store_dwordx4 v[120:123], v33, s[12:15], s35 offen sc1
    s_nop 1
    v_cvt_pk_bf16_f32 v116, v86, v90
    v_cvt_pk_bf16_f32 v117, v94, v98
    v_cvt_pk_bf16_f32 v118, v102, v106
    v_cvt_pk_bf16_f32 v119, v110, v114
    s_add_u32 s35, s34, 13216000
    buffer_store_dwordx4 v[116:119], v33, s[12:15], s35 offen sc1
    s_nop 1
    v_cvt_pk_bf16_f32 v120, v87, v91
    v_cvt_pk_bf16_f32 v121, v95, v99
    v_cvt_pk_bf16_f32 v122, v103, v107
    v_cvt_pk_bf16_f32 v123, v111, v115
    s_add_u32 s35, s34, 13217024
    buffer_store_dwordx4 v[120:123], v33, s[12:15], s35 offen sc1
    s_nop 1
    s_endpgm
L_mid_kernel_done:
    s_endpgm
.globl gemm2_kernel
.p2align 8
.type gemm2_kernel,@function
gemm2_kernel:
    s_cmp_ge_u32 s2, 256
    s_cbranch_scc1 L_gemm2_kernel_done
    s_load_dwordx2 s[4:5], s[0:1], 72
    s_load_dwordx2 s[6:7], s[0:1], 72
    v_readfirstlane_b32 s20, v0
    s_lshr_b32 s20, s20, 6
    s_and_b32 s24, s2, 7
    s_lshr_b32 s25, s2, 3
    s_lshr_b32 s26, s25, 3
    s_lshl_b32 s24, s24, 2
    s_add_u32 s21, s24, s26
    s_and_b32 s25, s25, 7
    s_lshr_b32 s26, s25, 2
    s_and_b32 s27, s25, 3
    s_mul_i32 s22, s26, 84
    s_sub_u32 s28, 168, s22
    s_min_u32 s28, s28, 84
    s_waitcnt lgkmcnt(0)
    s_mul_i32 s29, s21, 344064
    s_lshl_b32 s30, s22, 11
    s_add_u32 s29, s29, s30
    s_add_u32 s29, s29, 51269632
    s_add_u32 s8, s6, s29
    s_addc_u32 s9, s7, 0
    s_lshl_b32 s10, s28, 11
    s_mov_b32 s11, 0x00020000
    s_mul_i32 s29, s21, 528640
    s_mul_i32 s30, s27, 8192
    s_add_u32 s29, s29, s30
    s_add_u32 s29, s29, 62345216
    s_add_u32 s12, s4, s29
    s_addc_u32 s13, s5, 0
    s_mov_b32 s14, 499712
    s_mov_b32 s15, 0x00020000
    s_cmp_ge_u32 s20, 4
    s_cbranch_scc1 L_gemm2_kernel_loader
    s_mul_i32 s29, s22, 37120
    s_add_u32 s29, s29, 79261696
    s_add_u32 s16, s4, s29
    s_addc_u32 s17, s5, 0
    s_mul_i32 s18, s28, 37120
    s_mov_b32 s19, 0x00020000
    s_lshr_b32 s29, s20, 1
    s_and_b32 s30, s20, 1
    v_and_b32 v137, 15, v0
    v_bfe_u32 v138, v0, 4, 2
    v_and_b32 v139, 63, v0
    s_mul_i32 s31, s29, 6144
    v_and_b32 v140, 7, v137
    v_xor_b32 v140, v138, v140
    v_lshlrev_b32 v140, 4, v140
    v_lshl_add_u32 v140, v137, 7, v140
    v_add_u32 v140, s31, v140
    v_add_u32 v128, 0, v140
    v_xor_b32 v131, 64, v128
    v_add_u32 v129, 61440, v140
    v_xor_b32 v132, 64, v129
    v_add_u32 v130, 122880, v140
    v_xor_b32 v133, 64, v130
    s_mul_i32 s31, s30, 4096
    s_add_u32 s31, s31, 12288
    v_lshlrev_b32 v140, 4, v139
    v_add_u32 v140, s31, v140
    v_add_u32 v134, 0, v140
    v_add_u32 v135, 61440, v140
    v_add_u32 v136, 122880, v140
    v_and_b32 v144, 7, v137
    v_lshrrev_b32 v145, 3, v137
    v_mul_u32_u24 v142, 37120, v144
    v_lshl_add_u32 v142, v138, 4, v142
    s_mul_i32 s31, s29, 1781760
    v_add_u32 v142, s31, v142
    v_lshl_add_u32 v142, v145, 6, v142
    v_xor_b32 v145, 64, v142
    v_add_u32 v143, 296960, v145
    s_mul_i32 s31, s27, 2
    s_mul_i32 s29, s30, 1
    s_add_u32 s31, s31, s29
    s_lshl_b32 s31, s31, 12
    s_lshl_b32 s29, s21, 7
    s_add_u32 s33, s31, s29
    s_mov_b32 s34, 0x80008000
    s_barrier
    ds_read_b128 v[48:51], v134 offset:0
    ds_read_b128 v[64:67], v128 offset:0
    ds_read_b128 v[72:75], v128 offset:2048
    ds_read_b128 v[80:83], v128 offset:4096
    ds_read_b128 v[56:59], v134 offset:2048
    ds_read_b128 v[68:71], v131 offset:0
    ds_read_b128 v[76:79], v131 offset:2048
    ds_read_b128 v[84:87], v131 offset:4096
    ds_read_b128 v[52:55], v134 offset:1024
    ds_read_b128 v[60:63], v134 offset:3072
    s_waitcnt lgkmcnt(0)
    s_barrier
    v_mfma_f32_16x16x32_bf16 v[0:3], v[48:51], v[64:67], 0
    ds_read_b128 v[88:91], v134 offset:20480
    v_mfma_f32_16x16x32_bf16 v[4:7], v[48:51], v[72:75], 0
    ds_read_b128 v[104:107], v128 offset:20480
    v_mfma_f32_16x16x32_bf16 v[8:11], v[48:51], v[80:83], 0
    ds_read_b128 v[112:115], v128 offset:22528
    v_mfma_f32_16x16x32_bf16 v[12:15], v[56:59], v[64:67], 0
    ds_read_b128 v[120:123], v128 offset:24576
    v_mfma_f32_16x16x32_bf16 v[16:19], v[56:59], v[72:75], 0
    ds_read_b128 v[96:99], v134 offset:22528
    v_mfma_f32_16x16x32_bf16 v[20:23], v[56:59], v[80:83], 0
    ds_read_b128 v[108:111], v131 offset:20480
    v_mfma_f32_16x16x32_bf16 v[24:27], v[48:51], v[68:71], 0
    ds_read_b128 v[116:119], v131 offset:22528
    v_mfma_f32_16x16x32_bf16 v[28:31], v[48:51], v[76:79], 0
    ds_read_b128 v[124:127], v131 offset:24576
    v_mfma_f32_16x16x32_bf16 v[32:35], v[48:51], v[84:87], 0
    ds_read_b128 v[92:95], v134 offset:21504
    v_mfma_f32_16x16x32_bf16 v[36:39], v[56:59], v[68:71], 0
    ds_read_b128 v[100:103], v134 offset:23552
    v_mfma_f32_16x16x32_bf16 v[40:43], v[56:59], v[76:79], 0
    v_mfma_f32_16x16x32_bf16 v[44:47], v[56:59], v[84:87], 0
    v_mfma_f32_16x16x32_bf16 v[24:27], v[52:55], v[64:67], v[24:27]
    v_xor_b32 v68, s34, v68
    v_xor_b32 v69, s34, v69
    v_mfma_f32_16x16x32_bf16 v[28:31], v[52:55], v[72:75], v[28:31]
    v_xor_b32 v70, s34, v70
    v_xor_b32 v71, s34, v71
    v_mfma_f32_16x16x32_bf16 v[32:35], v[52:55], v[80:83], v[32:35]
    v_xor_b32 v76, s34, v76
    v_xor_b32 v77, s34, v77
    v_mfma_f32_16x16x32_bf16 v[36:39], v[60:63], v[64:67], v[36:39]
    v_xor_b32 v78, s34, v78
    v_xor_b32 v79, s34, v79
    v_mfma_f32_16x16x32_bf16 v[40:43], v[60:63], v[72:75], v[40:43]
    v_xor_b32 v84, s34, v84
    v_xor_b32 v85, s34, v85
    v_mfma_f32_16x16x32_bf16 v[44:47], v[60:63], v[80:83], v[44:47]
    v_xor_b32 v86, s34, v86
    v_xor_b32 v87, s34, v87
    v_mfma_f32_16x16x32_bf16 v[0:3], v[52:55], v[68:71], v[0:3]
    v_mfma_f32_16x16x32_bf16 v[4:7], v[52:55], v[76:79], v[4:7]
    v_mfma_f32_16x16x32_bf16 v[8:11], v[52:55], v[84:87], v[8:11]
    s_waitcnt lgkmcnt(0)
    s_barrier
    v_mfma_f32_16x16x32_bf16 v[12:15], v[60:63], v[68:71], v[12:15]
    v_mfma_f32_16x16x32_bf16 v[16:19], v[60:63], v[76:79], v[16:19]
    v_mfma_f32_16x16x32_bf16 v[20:23], v[60:63], v[84:87], v[20:23]
    v_mfma_f32_16x16x32_bf16 v[0:3], v[88:91], v[104:107], v[0:3]
    ds_read_b128 v[48:51], v134 offset:40960
    v_mfma_f32_16x16x32_bf16 v[4:7], v[88:91], v[112:115], v[4:7]
    ds_read_b128 v[64:67], v128 offset:40960
    v_mfma_f32_16x16x32_bf16 v[8:11], v[88:91], v[120:123], v[8:11]
    ds_read_b128 v[72:75], v128 offset:43008
    v_mfma_f32_16x16x32_bf16 v[12:15], v[96:99], v[104:107], v[12:15]
    ds_read_b128 v[80:83], v128 offset:45056
    v_mfma_f32_16x16x32_bf16 v[16:19], v[96:99], v[112:115], v[16:19]
    ds_read_b128 v[56:59], v134 offset:43008
    v_mfma_f32_16x16x32_bf16 v[20:23], v[96:99], v[120:123], v[20:23]
    ds_read_b128 v[68:71], v131 offset:40960
    v_mfma_f32_16x16x32_bf16 v[24:27], v[88:91], v[108:111], v[24:27]
    ds_read_b128 v[76:79], v131 offset:43008
    v_mfma_f32_16x16x32_bf16 v[28:31], v[88:91], v[116:119], v[28:31]
    ds_read_b128 v[84:87], v131 offset:45056
    v_mfma_f32_16x16x32_bf16 v[32:35], v[88:91], v[124:127], v[32:35]
    ds_read_b128 v[52:55], v134 offset:41984
    v_mfma_f32_16x16x32_bf16 v[36:39], v[96:99], v[108:111], v[36:39]
    ds_read_b128 v[60:63], v134 offset:44032
    v_mfma_f32_16x16x32_bf16 v[40:43], v[96:99], v[116:119], v[40:43]
    v_mfma_f32_16x16x32_bf16 v[44:47], v[96:99], v[124:127], v[44:47]
    v_mfma_f32_16x16x32_bf16 v[24:27], v[92:95], v[104:107], v[24:27]
    v_xor_b32 v108, s34, v108
    v_xor_b32 v109, s34, v109
    v_mfma_f32_16x16x32_bf16 v[28:31], v[92:95], v[112:115], v[28:31]
    v_xor_b32 v110, s34, v110
    v_xor_b32 v111, s34, v111
    v_mfma_f32_16x16x32_bf16 v[32:35], v[92:95], v[120:123], v[32:35]
    v_xor_b32 v116, s34, v116
    v_xor_b32 v117, s34, v117
    v_mfma_f32_16x16x32_bf16 v[36:39], v[100:103], v[104:107], v[36:39]
    v_xor_b32 v118, s34, v118
    v_xor_b32 v119, s34, v119
    v_mfma_f32_16x16x32_bf16 v[40:43], v[100:103], v[112:115], v[40:43]
    v_xor_b32 v124, s34, v124
    v_xor_b32 v125, s34, v125
    v_mfma_f32_16x16x32_bf16 v[44:47], v[100:103], v[120:123], v[44:47]
    v_xor_b32 v126, s34, v126
    v_xor_b32 v127, s34, v127
    v_mfma_f32_16x16x32_bf16 v[0:3], v[92:95], v[108:111], v[0:3]
    v_mfma_f32_16x16x32_bf16 v[4:7], v[92:95], v[116:119], v[4:7]
    v_mfma_f32_16x16x32_bf16 v[8:11], v[92:95], v[124:127], v[8:11]
    s_waitcnt lgkmcnt(0)
    s_barrier
    v_mfma_f32_16x16x32_bf16 v[12:15], v[100:103], v[108:111], v[12:15]
    v_mfma_f32_16x16x32_bf16 v[16:19], v[100:103], v[116:119], v[16:19]
    v_mfma_f32_16x16x32_bf16 v[20:23], v[100:103], v[124:127], v[20:23]
    v_mfma_f32_16x16x32_bf16 v[0:3], v[48:51], v[64:67], v[0:3]
    ds_read_b128 v[88:91], v135 offset:0
    v_mfma_f32_16x16x32_bf16 v[4:7], v[48:51], v[72:75], v[4:7]
    ds_read_b128 v[104:107], v129 offset:0
    v_mfma_f32_16x16x32_bf16 v[8:11], v[48:51], v[80:83], v[8:11]
    ds_read_b128 v[112:115], v129 offset:2048
    v_mfma_f32_16x16x32_bf16 v[12:15], v[56:59], v[64:67], v[12:15]
    ds_read_b128 v[120:123], v129 offset:4096
    v_mfma_f32_16x16x32_bf16 v[16:19], v[56:59], v[72:75], v[16:19]
    ds_read_b128 v[96:99], v135 offset:2048
    v_mfma_f32_16x16x32_bf16 v[20:23], v[56:59], v[80:83], v[20:23]
    ds_read_b128 v[108:111], v132 offset:0
    v_mfma_f32_16x16x32_bf16 v[24:27], v[48:51], v[68:71], v[24:27]
    ds_read_b128 v[116:119], v132 offset:2048
    v_mfma_f32_16x16x32_bf16 v[28:31], v[48:51], v[76:79], v[28:31]
    ds_read_b128 v[124:127], v132 offset:4096
    v_mfma_f32_16x16x32_bf16 v[32:35], v[48:51], v[84:87], v[32:35]
    ds_read_b128 v[92:95], v135 offset:1024
    v_mfma_f32_16x16x32_bf16 v[36:39], v[56:59], v[68:71], v[36:39]
    ds_read_b128 v[100:103], v135 offset:3072
    v_mfma_f32_16x16x32_bf16 v[40:43], v[56:59], v[76:79], v[40:43]
    v_mfma_f32_16x16x32_bf16 v[44:47], v[56:59], v[84:87], v[44:47]
    v_mfma_f32_16x16x32_bf16 v[24:27], v[52:55], v[64:67], v[24:27]
    v_xor_b32 v68, s34, v68
    v_xor_b32 v69, s34, v69
    v_mfma_f32_16x16x32_bf16 v[28:31], v[52:55], v[72:75], v[28:31]
    v_xor_b32 v70, s34, v70
    v_xor_b32 v71, s34, v71
    v_mfma_f32_16x16x32_bf16 v[32:35], v[52:55], v[80:83], v[32:35]
    v_xor_b32 v76, s34, v76
    v_xor_b32 v77, s34, v77
    v_mfma_f32_16x16x32_bf16 v[36:39], v[60:63], v[64:67], v[36:39]
    v_xor_b32 v78, s34, v78
    v_xor_b32 v79, s34, v79
    v_mfma_f32_16x16x32_bf16 v[40:43], v[60:63], v[72:75], v[40:43]
    v_xor_b32 v84, s34, v84
    v_xor_b32 v85, s34, v85
    v_mfma_f32_16x16x32_bf16 v[44:47], v[60:63], v[80:83], v[44:47]
    v_xor_b32 v86, s34, v86
    v_xor_b32 v87, s34, v87
    v_mfma_f32_16x16x32_bf16 v[0:3], v[52:55], v[68:71], v[0:3]
    v_mfma_f32_16x16x32_bf16 v[4:7], v[52:55], v[76:79], v[4:7]
    v_mfma_f32_16x16x32_bf16 v[8:11], v[52:55], v[84:87], v[8:11]
    s_waitcnt lgkmcnt(0)
    s_barrier
    v_mfma_f32_16x16x32_bf16 v[12:15], v[60:63], v[68:71], v[12:15]
    v_mfma_f32_16x16x32_bf16 v[16:19], v[60:63], v[76:79], v[16:19]
    v_mfma_f32_16x16x32_bf16 v[20:23], v[60:63], v[84:87], v[20:23]
    v_mfma_f32_16x16x32_bf16 v[0:3], v[88:91], v[104:107], v[0:3]
    ds_read_b128 v[48:51], v135 offset:20480
    v_mfma_f32_16x16x32_bf16 v[4:7], v[88:91], v[112:115], v[4:7]
    ds_read_b128 v[64:67], v129 offset:20480
    v_mfma_f32_16x16x32_bf16 v[8:11], v[88:91], v[120:123], v[8:11]
    ds_read_b128 v[72:75], v129 offset:22528
    v_mfma_f32_16x16x32_bf16 v[12:15], v[96:99], v[104:107], v[12:15]
    ds_read_b128 v[80:83], v129 offset:24576
    v_mfma_f32_16x16x32_bf16 v[16:19], v[96:99], v[112:115], v[16:19]
    ds_read_b128 v[56:59], v135 offset:22528
    v_mfma_f32_16x16x32_bf16 v[20:23], v[96:99], v[120:123], v[20:23]
    ds_read_b128 v[68:71], v132 offset:20480
    v_mfma_f32_16x16x32_bf16 v[24:27], v[88:91], v[108:111], v[24:27]
    ds_read_b128 v[76:79], v132 offset:22528
    v_mfma_f32_16x16x32_bf16 v[28:31], v[88:91], v[116:119], v[28:31]
    ds_read_b128 v[84:87], v132 offset:24576
    v_mfma_f32_16x16x32_bf16 v[32:35], v[88:91], v[124:127], v[32:35]
    ds_read_b128 v[52:55], v135 offset:21504
    v_mfma_f32_16x16x32_bf16 v[36:39], v[96:99], v[108:111], v[36:39]
    ds_read_b128 v[60:63], v135 offset:23552
    v_mfma_f32_16x16x32_bf16 v[40:43], v[96:99], v[116:119], v[40:43]
    v_mfma_f32_16x16x32_bf16 v[44:47], v[96:99], v[124:127], v[44:47]
    v_mfma_f32_16x16x32_bf16 v[24:27], v[92:95], v[104:107], v[24:27]
    v_xor_b32 v108, s34, v108
    v_xor_b32 v109, s34, v109
    v_mfma_f32_16x16x32_bf16 v[28:31], v[92:95], v[112:115], v[28:31]
    v_xor_b32 v110, s34, v110
    v_xor_b32 v111, s34, v111
    v_mfma_f32_16x16x32_bf16 v[32:35], v[92:95], v[120:123], v[32:35]
    v_xor_b32 v116, s34, v116
    v_xor_b32 v117, s34, v117
    v_mfma_f32_16x16x32_bf16 v[36:39], v[100:103], v[104:107], v[36:39]
    v_xor_b32 v118, s34, v118
    v_xor_b32 v119, s34, v119
    v_mfma_f32_16x16x32_bf16 v[40:43], v[100:103], v[112:115], v[40:43]
    v_xor_b32 v124, s34, v124
    v_xor_b32 v125, s34, v125
    v_mfma_f32_16x16x32_bf16 v[44:47], v[100:103], v[120:123], v[44:47]
    v_xor_b32 v126, s34, v126
    v_xor_b32 v127, s34, v127
    v_mfma_f32_16x16x32_bf16 v[0:3], v[92:95], v[108:111], v[0:3]
    v_mfma_f32_16x16x32_bf16 v[4:7], v[92:95], v[116:119], v[4:7]
    v_mfma_f32_16x16x32_bf16 v[8:11], v[92:95], v[124:127], v[8:11]
    s_waitcnt lgkmcnt(0)
    s_barrier
    v_mfma_f32_16x16x32_bf16 v[12:15], v[100:103], v[108:111], v[12:15]
    v_mfma_f32_16x16x32_bf16 v[16:19], v[100:103], v[116:119], v[16:19]
    v_mfma_f32_16x16x32_bf16 v[20:23], v[100:103], v[124:127], v[20:23]
    v_mfma_f32_16x16x32_bf16 v[0:3], v[48:51], v[64:67], v[0:3]
    ds_read_b128 v[88:91], v135 offset:40960
    v_mfma_f32_16x16x32_bf16 v[4:7], v[48:51], v[72:75], v[4:7]
    ds_read_b128 v[104:107], v129 offset:40960
    v_mfma_f32_16x16x32_bf16 v[8:11], v[48:51], v[80:83], v[8:11]
    ds_read_b128 v[112:115], v129 offset:43008
    v_mfma_f32_16x16x32_bf16 v[12:15], v[56:59], v[64:67], v[12:15]
    ds_read_b128 v[120:123], v129 offset:45056
    v_mfma_f32_16x16x32_bf16 v[16:19], v[56:59], v[72:75], v[16:19]
    ds_read_b128 v[96:99], v135 offset:43008
    v_mfma_f32_16x16x32_bf16 v[20:23], v[56:59], v[80:83], v[20:23]
    ds_read_b128 v[108:111], v132 offset:40960
    v_mfma_f32_16x16x32_bf16 v[24:27], v[48:51], v[68:71], v[24:27]
    ds_read_b128 v[116:119], v132 offset:43008
    v_mfma_f32_16x16x32_bf16 v[28:31], v[48:51], v[76:79], v[28:31]
    ds_read_b128 v[124:127], v132 offset:45056
    v_mfma_f32_16x16x32_bf16 v[32:35], v[48:51], v[84:87], v[32:35]
    ds_read_b128 v[92:95], v135 offset:41984
    v_mfma_f32_16x16x32_bf16 v[36:39], v[56:59], v[68:71], v[36:39]
    ds_read_b128 v[100:103], v135 offset:44032
    v_mfma_f32_16x16x32_bf16 v[40:43], v[56:59], v[76:79], v[40:43]
    v_mfma_f32_16x16x32_bf16 v[44:47], v[56:59], v[84:87], v[44:47]
    v_mfma_f32_16x16x32_bf16 v[24:27], v[52:55], v[64:67], v[24:27]
    v_xor_b32 v68, s34, v68
    v_xor_b32 v69, s34, v69
    v_mfma_f32_16x16x32_bf16 v[28:31], v[52:55], v[72:75], v[28:31]
    v_xor_b32 v70, s34, v70
    v_xor_b32 v71, s34, v71
    v_mfma_f32_16x16x32_bf16 v[32:35], v[52:55], v[80:83], v[32:35]
    v_xor_b32 v76, s34, v76
    v_xor_b32 v77, s34, v77
    v_mfma_f32_16x16x32_bf16 v[36:39], v[60:63], v[64:67], v[36:39]
    v_xor_b32 v78, s34, v78
    v_xor_b32 v79, s34, v79
    v_mfma_f32_16x16x32_bf16 v[40:43], v[60:63], v[72:75], v[40:43]
    v_xor_b32 v84, s34, v84
    v_xor_b32 v85, s34, v85
    v_mfma_f32_16x16x32_bf16 v[44:47], v[60:63], v[80:83], v[44:47]
    v_xor_b32 v86, s34, v86
    v_xor_b32 v87, s34, v87
    v_mfma_f32_16x16x32_bf16 v[0:3], v[52:55], v[68:71], v[0:3]
    v_mfma_f32_16x16x32_bf16 v[4:7], v[52:55], v[76:79], v[4:7]
    v_mfma_f32_16x16x32_bf16 v[8:11], v[52:55], v[84:87], v[8:11]
    s_waitcnt lgkmcnt(0)
    s_barrier
    v_mfma_f32_16x16x32_bf16 v[12:15], v[60:63], v[68:71], v[12:15]
    v_mfma_f32_16x16x32_bf16 v[16:19], v[60:63], v[76:79], v[16:19]
    v_mfma_f32_16x16x32_bf16 v[20:23], v[60:63], v[84:87], v[20:23]
    v_mfma_f32_16x16x32_bf16 v[0:3], v[88:91], v[104:107], v[0:3]
    ds_read_b128 v[48:51], v136 offset:0
    v_mfma_f32_16x16x32_bf16 v[4:7], v[88:91], v[112:115], v[4:7]
    ds_read_b128 v[64:67], v130 offset:0
    v_mfma_f32_16x16x32_bf16 v[8:11], v[88:91], v[120:123], v[8:11]
    ds_read_b128 v[72:75], v130 offset:2048
    v_mfma_f32_16x16x32_bf16 v[12:15], v[96:99], v[104:107], v[12:15]
    ds_read_b128 v[80:83], v130 offset:4096
    v_mfma_f32_16x16x32_bf16 v[16:19], v[96:99], v[112:115], v[16:19]
    ds_read_b128 v[56:59], v136 offset:2048
    v_mfma_f32_16x16x32_bf16 v[20:23], v[96:99], v[120:123], v[20:23]
    ds_read_b128 v[68:71], v133 offset:0
    v_mfma_f32_16x16x32_bf16 v[24:27], v[88:91], v[108:111], v[24:27]
    ds_read_b128 v[76:79], v133 offset:2048
    v_mfma_f32_16x16x32_bf16 v[28:31], v[88:91], v[116:119], v[28:31]
    ds_read_b128 v[84:87], v133 offset:4096
    v_mfma_f32_16x16x32_bf16 v[32:35], v[88:91], v[124:127], v[32:35]
    ds_read_b128 v[52:55], v136 offset:1024
    v_mfma_f32_16x16x32_bf16 v[36:39], v[96:99], v[108:111], v[36:39]
    ds_read_b128 v[60:63], v136 offset:3072
    v_mfma_f32_16x16x32_bf16 v[40:43], v[96:99], v[116:119], v[40:43]
    v_mfma_f32_16x16x32_bf16 v[44:47], v[96:99], v[124:127], v[44:47]
    v_mfma_f32_16x16x32_bf16 v[24:27], v[92:95], v[104:107], v[24:27]
    v_xor_b32 v108, s34, v108
    v_xor_b32 v109, s34, v109
    v_mfma_f32_16x16x32_bf16 v[28:31], v[92:95], v[112:115], v[28:31]
    v_xor_b32 v110, s34, v110
    v_xor_b32 v111, s34, v111
    v_mfma_f32_16x16x32_bf16 v[32:35], v[92:95], v[120:123], v[32:35]
    v_xor_b32 v116, s34, v116
    v_xor_b32 v117, s34, v117
    v_mfma_f32_16x16x32_bf16 v[36:39], v[100:103], v[104:107], v[36:39]
    v_xor_b32 v118, s34, v118
    v_xor_b32 v119, s34, v119
    v_mfma_f32_16x16x32_bf16 v[40:43], v[100:103], v[112:115], v[40:43]
    v_xor_b32 v124, s34, v124
    v_xor_b32 v125, s34, v125
    v_mfma_f32_16x16x32_bf16 v[44:47], v[100:103], v[120:123], v[44:47]
    v_xor_b32 v126, s34, v126
    v_xor_b32 v127, s34, v127
    v_mfma_f32_16x16x32_bf16 v[0:3], v[92:95], v[108:111], v[0:3]
    v_mfma_f32_16x16x32_bf16 v[4:7], v[92:95], v[116:119], v[4:7]
    v_mfma_f32_16x16x32_bf16 v[8:11], v[92:95], v[124:127], v[8:11]
    s_waitcnt lgkmcnt(0)
    s_barrier
    v_mfma_f32_16x16x32_bf16 v[12:15], v[100:103], v[108:111], v[12:15]
    v_mfma_f32_16x16x32_bf16 v[16:19], v[100:103], v[116:119], v[16:19]
    v_mfma_f32_16x16x32_bf16 v[20:23], v[100:103], v[124:127], v[20:23]
    v_mfma_f32_16x16x32_bf16 v[0:3], v[48:51], v[64:67], v[0:3]
    ds_read_b128 v[88:91], v134 offset:0
    v_mfma_f32_16x16x32_bf16 v[4:7], v[48:51], v[72:75], v[4:7]
    ds_read_b128 v[104:107], v128 offset:0
    v_mfma_f32_16x16x32_bf16 v[8:11], v[48:51], v[80:83], v[8:11]
    ds_read_b128 v[112:115], v128 offset:2048
    v_mfma_f32_16x16x32_bf16 v[12:15], v[56:59], v[64:67], v[12:15]
    ds_read_b128 v[120:123], v128 offset:4096
    v_mfma_f32_16x16x32_bf16 v[16:19], v[56:59], v[72:75], v[16:19]
    ds_read_b128 v[96:99], v134 offset:2048
    v_mfma_f32_16x16x32_bf16 v[20:23], v[56:59], v[80:83], v[20:23]
    ds_read_b128 v[108:111], v131 offset:0
    v_mfma_f32_16x16x32_bf16 v[24:27], v[48:51], v[68:71], v[24:27]
    ds_read_b128 v[116:119], v131 offset:2048
    v_mfma_f32_16x16x32_bf16 v[28:31], v[48:51], v[76:79], v[28:31]
    ds_read_b128 v[124:127], v131 offset:4096
    v_mfma_f32_16x16x32_bf16 v[32:35], v[48:51], v[84:87], v[32:35]
    ds_read_b128 v[92:95], v134 offset:1024
    v_mfma_f32_16x16x32_bf16 v[36:39], v[56:59], v[68:71], v[36:39]
    ds_read_b128 v[100:103], v134 offset:3072
    v_mfma_f32_16x16x32_bf16 v[40:43], v[56:59], v[76:79], v[40:43]
    v_mfma_f32_16x16x32_bf16 v[44:47], v[56:59], v[84:87], v[44:47]
    v_mfma_f32_16x16x32_bf16 v[24:27], v[52:55], v[64:67], v[24:27]
    v_xor_b32 v68, s34, v68
    v_xor_b32 v69, s34, v69
    v_mfma_f32_16x16x32_bf16 v[28:31], v[52:55], v[72:75], v[28:31]
    v_xor_b32 v70, s34, v70
    v_xor_b32 v71, s34, v71
    v_mfma_f32_16x16x32_bf16 v[32:35], v[52:55], v[80:83], v[32:35]
    v_xor_b32 v76, s34, v76
    v_xor_b32 v77, s34, v77
    v_mfma_f32_16x16x32_bf16 v[36:39], v[60:63], v[64:67], v[36:39]
    v_xor_b32 v78, s34, v78
    v_xor_b32 v79, s34, v79
    v_mfma_f32_16x16x32_bf16 v[40:43], v[60:63], v[72:75], v[40:43]
    v_xor_b32 v84, s34, v84
    v_xor_b32 v85, s34, v85
    v_mfma_f32_16x16x32_bf16 v[44:47], v[60:63], v[80:83], v[44:47]
    v_xor_b32 v86, s34, v86
    v_xor_b32 v87, s34, v87
    v_mfma_f32_16x16x32_bf16 v[0:3], v[52:55], v[68:71], v[0:3]
    v_mfma_f32_16x16x32_bf16 v[4:7], v[52:55], v[76:79], v[4:7]
    v_mfma_f32_16x16x32_bf16 v[8:11], v[52:55], v[84:87], v[8:11]
    s_waitcnt lgkmcnt(0)
    s_barrier
    v_mfma_f32_16x16x32_bf16 v[12:15], v[60:63], v[68:71], v[12:15]
    v_mfma_f32_16x16x32_bf16 v[16:19], v[60:63], v[76:79], v[16:19]
    v_mfma_f32_16x16x32_bf16 v[20:23], v[60:63], v[84:87], v[20:23]
    v_mfma_f32_16x16x32_bf16 v[0:3], v[88:91], v[104:107], v[0:3]
    ds_read_b128 v[48:51], v134 offset:20480
    v_mfma_f32_16x16x32_bf16 v[4:7], v[88:91], v[112:115], v[4:7]
    ds_read_b128 v[64:67], v128 offset:20480
    v_mfma_f32_16x16x32_bf16 v[8:11], v[88:91], v[120:123], v[8:11]
    ds_read_b128 v[72:75], v128 offset:22528
    v_mfma_f32_16x16x32_bf16 v[12:15], v[96:99], v[104:107], v[12:15]
    ds_read_b128 v[80:83], v128 offset:24576
    v_mfma_f32_16x16x32_bf16 v[16:19], v[96:99], v[112:115], v[16:19]
    ds_read_b128 v[56:59], v134 offset:22528
    v_mfma_f32_16x16x32_bf16 v[20:23], v[96:99], v[120:123], v[20:23]
    ds_read_b128 v[68:71], v131 offset:20480
    v_mfma_f32_16x16x32_bf16 v[24:27], v[88:91], v[108:111], v[24:27]
    ds_read_b128 v[76:79], v131 offset:22528
    v_mfma_f32_16x16x32_bf16 v[28:31], v[88:91], v[116:119], v[28:31]
    ds_read_b128 v[84:87], v131 offset:24576
    v_mfma_f32_16x16x32_bf16 v[32:35], v[88:91], v[124:127], v[32:35]
    ds_read_b128 v[52:55], v134 offset:21504
    v_mfma_f32_16x16x32_bf16 v[36:39], v[96:99], v[108:111], v[36:39]
    ds_read_b128 v[60:63], v134 offset:23552
    v_mfma_f32_16x16x32_bf16 v[40:43], v[96:99], v[116:119], v[40:43]
    v_mfma_f32_16x16x32_bf16 v[44:47], v[96:99], v[124:127], v[44:47]
    v_mfma_f32_16x16x32_bf16 v[24:27], v[92:95], v[104:107], v[24:27]
    v_xor_b32 v108, s34, v108
    v_xor_b32 v109, s34, v109
    v_mfma_f32_16x16x32_bf16 v[28:31], v[92:95], v[112:115], v[28:31]
    v_xor_b32 v110, s34, v110
    v_xor_b32 v111, s34, v111
    v_mfma_f32_16x16x32_bf16 v[32:35], v[92:95], v[120:123], v[32:35]
    v_xor_b32 v116, s34, v116
    v_xor_b32 v117, s34, v117
    v_mfma_f32_16x16x32_bf16 v[36:39], v[100:103], v[104:107], v[36:39]
    v_xor_b32 v118, s34, v118
    v_xor_b32 v119, s34, v119
    v_mfma_f32_16x16x32_bf16 v[40:43], v[100:103], v[112:115], v[40:43]
    v_xor_b32 v124, s34, v124
    v_xor_b32 v125, s34, v125
    v_mfma_f32_16x16x32_bf16 v[44:47], v[100:103], v[120:123], v[44:47]
    v_xor_b32 v126, s34, v126
    v_xor_b32 v127, s34, v127
    v_mfma_f32_16x16x32_bf16 v[0:3], v[92:95], v[108:111], v[0:3]
    v_mfma_f32_16x16x32_bf16 v[4:7], v[92:95], v[116:119], v[4:7]
    v_mfma_f32_16x16x32_bf16 v[8:11], v[92:95], v[124:127], v[8:11]
    s_waitcnt lgkmcnt(0)
    s_barrier
    v_mfma_f32_16x16x32_bf16 v[12:15], v[100:103], v[108:111], v[12:15]
    v_mfma_f32_16x16x32_bf16 v[16:19], v[100:103], v[116:119], v[16:19]
    v_mfma_f32_16x16x32_bf16 v[20:23], v[100:103], v[124:127], v[20:23]
    v_mfma_f32_16x16x32_bf16 v[0:3], v[48:51], v[64:67], v[0:3]
    ds_read_b128 v[88:91], v134 offset:40960
    v_mfma_f32_16x16x32_bf16 v[4:7], v[48:51], v[72:75], v[4:7]
    ds_read_b128 v[104:107], v128 offset:40960
    v_mfma_f32_16x16x32_bf16 v[8:11], v[48:51], v[80:83], v[8:11]
    ds_read_b128 v[112:115], v128 offset:43008
    v_mfma_f32_16x16x32_bf16 v[12:15], v[56:59], v[64:67], v[12:15]
    ds_read_b128 v[120:123], v128 offset:45056
    v_mfma_f32_16x16x32_bf16 v[16:19], v[56:59], v[72:75], v[16:19]
    ds_read_b128 v[96:99], v134 offset:43008
    v_mfma_f32_16x16x32_bf16 v[20:23], v[56:59], v[80:83], v[20:23]
    ds_read_b128 v[108:111], v131 offset:40960
    v_mfma_f32_16x16x32_bf16 v[24:27], v[48:51], v[68:71], v[24:27]
    ds_read_b128 v[116:119], v131 offset:43008
    v_mfma_f32_16x16x32_bf16 v[28:31], v[48:51], v[76:79], v[28:31]
    ds_read_b128 v[124:127], v131 offset:45056
    v_mfma_f32_16x16x32_bf16 v[32:35], v[48:51], v[84:87], v[32:35]
    ds_read_b128 v[92:95], v134 offset:41984
    v_mfma_f32_16x16x32_bf16 v[36:39], v[56:59], v[68:71], v[36:39]
    ds_read_b128 v[100:103], v134 offset:44032
    v_mfma_f32_16x16x32_bf16 v[40:43], v[56:59], v[76:79], v[40:43]
    v_mfma_f32_16x16x32_bf16 v[44:47], v[56:59], v[84:87], v[44:47]
    v_mfma_f32_16x16x32_bf16 v[24:27], v[52:55], v[64:67], v[24:27]
    v_xor_b32 v68, s34, v68
    v_xor_b32 v69, s34, v69
    v_mfma_f32_16x16x32_bf16 v[28:31], v[52:55], v[72:75], v[28:31]
    v_xor_b32 v70, s34, v70
    v_xor_b32 v71, s34, v71
    v_mfma_f32_16x16x32_bf16 v[32:35], v[52:55], v[80:83], v[32:35]
    v_xor_b32 v76, s34, v76
    v_xor_b32 v77, s34, v77
    v_mfma_f32_16x16x32_bf16 v[36:39], v[60:63], v[64:67], v[36:39]
    v_xor_b32 v78, s34, v78
    v_xor_b32 v79, s34, v79
    v_mfma_f32_16x16x32_bf16 v[40:43], v[60:63], v[72:75], v[40:43]
    v_xor_b32 v84, s34, v84
    v_xor_b32 v85, s34, v85
    v_mfma_f32_16x16x32_bf16 v[44:47], v[60:63], v[80:83], v[44:47]
    v_xor_b32 v86, s34, v86
    v_xor_b32 v87, s34, v87
    v_mfma_f32_16x16x32_bf16 v[0:3], v[52:55], v[68:71], v[0:3]
    v_mfma_f32_16x16x32_bf16 v[4:7], v[52:55], v[76:79], v[4:7]
    v_mfma_f32_16x16x32_bf16 v[8:11], v[52:55], v[84:87], v[8:11]
    s_waitcnt lgkmcnt(0)
    s_barrier
    v_mfma_f32_16x16x32_bf16 v[12:15], v[60:63], v[68:71], v[12:15]
    v_mfma_f32_16x16x32_bf16 v[16:19], v[60:63], v[76:79], v[16:19]
    v_mfma_f32_16x16x32_bf16 v[20:23], v[60:63], v[84:87], v[20:23]
    v_mfma_f32_16x16x32_bf16 v[0:3], v[88:91], v[104:107], v[0:3]
    ds_read_b128 v[48:51], v135 offset:0
    v_mfma_f32_16x16x32_bf16 v[4:7], v[88:91], v[112:115], v[4:7]
    ds_read_b128 v[64:67], v129 offset:0
    v_mfma_f32_16x16x32_bf16 v[8:11], v[88:91], v[120:123], v[8:11]
    ds_read_b128 v[72:75], v129 offset:2048
    v_mfma_f32_16x16x32_bf16 v[12:15], v[96:99], v[104:107], v[12:15]
    ds_read_b128 v[80:83], v129 offset:4096
    v_mfma_f32_16x16x32_bf16 v[16:19], v[96:99], v[112:115], v[16:19]
    ds_read_b128 v[56:59], v135 offset:2048
    v_mfma_f32_16x16x32_bf16 v[20:23], v[96:99], v[120:123], v[20:23]
    ds_read_b128 v[68:71], v132 offset:0
    v_mfma_f32_16x16x32_bf16 v[24:27], v[88:91], v[108:111], v[24:27]
    ds_read_b128 v[76:79], v132 offset:2048
    v_mfma_f32_16x16x32_bf16 v[28:31], v[88:91], v[116:119], v[28:31]
    ds_read_b128 v[84:87], v132 offset:4096
    v_mfma_f32_16x16x32_bf16 v[32:35], v[88:91], v[124:127], v[32:35]
    ds_read_b128 v[52:55], v135 offset:1024
    v_mfma_f32_16x16x32_bf16 v[36:39], v[96:99], v[108:111], v[36:39]
    ds_read_b128 v[60:63], v135 offset:3072
    v_mfma_f32_16x16x32_bf16 v[40:43], v[96:99], v[116:119], v[40:43]
    v_mfma_f32_16x16x32_bf16 v[44:47], v[96:99], v[124:127], v[44:47]
    v_mfma_f32_16x16x32_bf16 v[24:27], v[92:95], v[104:107], v[24:27]
    v_xor_b32 v108, s34, v108
    v_xor_b32 v109, s34, v109
    v_mfma_f32_16x16x32_bf16 v[28:31], v[92:95], v[112:115], v[28:31]
    v_xor_b32 v110, s34, v110
    v_xor_b32 v111, s34, v111
    v_mfma_f32_16x16x32_bf16 v[32:35], v[92:95], v[120:123], v[32:35]
    v_xor_b32 v116, s34, v116
    v_xor_b32 v117, s34, v117
    v_mfma_f32_16x16x32_bf16 v[36:39], v[100:103], v[104:107], v[36:39]
    v_xor_b32 v118, s34, v118
    v_xor_b32 v119, s34, v119
    v_mfma_f32_16x16x32_bf16 v[40:43], v[100:103], v[112:115], v[40:43]
    v_xor_b32 v124, s34, v124
    v_xor_b32 v125, s34, v125
    v_mfma_f32_16x16x32_bf16 v[44:47], v[100:103], v[120:123], v[44:47]
    v_xor_b32 v126, s34, v126
    v_xor_b32 v127, s34, v127
    v_mfma_f32_16x16x32_bf16 v[0:3], v[92:95], v[108:111], v[0:3]
    v_mfma_f32_16x16x32_bf16 v[4:7], v[92:95], v[116:119], v[4:7]
    v_mfma_f32_16x16x32_bf16 v[8:11], v[92:95], v[124:127], v[8:11]
    s_waitcnt lgkmcnt(0)
    s_barrier
    v_mfma_f32_16x16x32_bf16 v[12:15], v[100:103], v[108:111], v[12:15]
    v_mfma_f32_16x16x32_bf16 v[16:19], v[100:103], v[116:119], v[16:19]
    v_mfma_f32_16x16x32_bf16 v[20:23], v[100:103], v[124:127], v[20:23]
    v_mfma_f32_16x16x32_bf16 v[0:3], v[48:51], v[64:67], v[0:3]
    ds_read_b128 v[88:91], v135 offset:20480
    v_mfma_f32_16x16x32_bf16 v[4:7], v[48:51], v[72:75], v[4:7]
    ds_read_b128 v[104:107], v129 offset:20480
    v_mfma_f32_16x16x32_bf16 v[8:11], v[48:51], v[80:83], v[8:11]
    ds_read_b128 v[112:115], v129 offset:22528
    v_mfma_f32_16x16x32_bf16 v[12:15], v[56:59], v[64:67], v[12:15]
    ds_read_b128 v[120:123], v129 offset:24576
    v_mfma_f32_16x16x32_bf16 v[16:19], v[56:59], v[72:75], v[16:19]
    ds_read_b128 v[96:99], v135 offset:22528
    v_mfma_f32_16x16x32_bf16 v[20:23], v[56:59], v[80:83], v[20:23]
    ds_read_b128 v[108:111], v132 offset:20480
    v_mfma_f32_16x16x32_bf16 v[24:27], v[48:51], v[68:71], v[24:27]
    ds_read_b128 v[116:119], v132 offset:22528
    v_mfma_f32_16x16x32_bf16 v[28:31], v[48:51], v[76:79], v[28:31]
    ds_read_b128 v[124:127], v132 offset:24576
    v_mfma_f32_16x16x32_bf16 v[32:35], v[48:51], v[84:87], v[32:35]
    ds_read_b128 v[92:95], v135 offset:21504
    v_mfma_f32_16x16x32_bf16 v[36:39], v[56:59], v[68:71], v[36:39]
    ds_read_b128 v[100:103], v135 offset:23552
    v_mfma_f32_16x16x32_bf16 v[40:43], v[56:59], v[76:79], v[40:43]
    v_mfma_f32_16x16x32_bf16 v[44:47], v[56:59], v[84:87], v[44:47]
    v_mfma_f32_16x16x32_bf16 v[24:27], v[52:55], v[64:67], v[24:27]
    v_xor_b32 v68, s34, v68
    v_xor_b32 v69, s34, v69
    v_mfma_f32_16x16x32_bf16 v[28:31], v[52:55], v[72:75], v[28:31]
    v_xor_b32 v70, s34, v70
    v_xor_b32 v71, s34, v71
    v_mfma_f32_16x16x32_bf16 v[32:35], v[52:55], v[80:83], v[32:35]
    v_xor_b32 v76, s34, v76
    v_xor_b32 v77, s34, v77
    v_mfma_f32_16x16x32_bf16 v[36:39], v[60:63], v[64:67], v[36:39]
    v_xor_b32 v78, s34, v78
    v_xor_b32 v79, s34, v79
    v_mfma_f32_16x16x32_bf16 v[40:43], v[60:63], v[72:75], v[40:43]
    v_xor_b32 v84, s34, v84
    v_xor_b32 v85, s34, v85
    v_mfma_f32_16x16x32_bf16 v[44:47], v[60:63], v[80:83], v[44:47]
    v_xor_b32 v86, s34, v86
    v_xor_b32 v87, s34, v87
    v_mfma_f32_16x16x32_bf16 v[0:3], v[52:55], v[68:71], v[0:3]
    v_mfma_f32_16x16x32_bf16 v[4:7], v[52:55], v[76:79], v[4:7]
    v_mfma_f32_16x16x32_bf16 v[8:11], v[52:55], v[84:87], v[8:11]
    s_waitcnt lgkmcnt(0)
    s_barrier
    v_mfma_f32_16x16x32_bf16 v[12:15], v[60:63], v[68:71], v[12:15]
    v_mfma_f32_16x16x32_bf16 v[16:19], v[60:63], v[76:79], v[16:19]
    v_mfma_f32_16x16x32_bf16 v[20:23], v[60:63], v[84:87], v[20:23]
    v_mfma_f32_16x16x32_bf16 v[0:3], v[88:91], v[104:107], v[0:3]
    ds_read_b128 v[48:51], v135 offset:40960
    v_mfma_f32_16x16x32_bf16 v[4:7], v[88:91], v[112:115], v[4:7]
    ds_read_b128 v[64:67], v129 offset:40960
    v_mfma_f32_16x16x32_bf16 v[8:11], v[88:91], v[120:123], v[8:11]
    ds_read_b128 v[72:75], v129 offset:43008
    v_mfma_f32_16x16x32_bf16 v[12:15], v[96:99], v[104:107], v[12:15]
    ds_read_b128 v[80:83], v129 offset:45056
    v_mfma_f32_16x16x32_bf16 v[16:19], v[96:99], v[112:115], v[16:19]
    ds_read_b128 v[56:59], v135 offset:43008
    v_mfma_f32_16x16x32_bf16 v[20:23], v[96:99], v[120:123], v[20:23]
    ds_read_b128 v[68:71], v132 offset:40960
    v_mfma_f32_16x16x32_bf16 v[24:27], v[88:91], v[108:111], v[24:27]
    ds_read_b128 v[76:79], v132 offset:43008
    v_mfma_f32_16x16x32_bf16 v[28:31], v[88:91], v[116:119], v[28:31]
    ds_read_b128 v[84:87], v132 offset:45056
    v_mfma_f32_16x16x32_bf16 v[32:35], v[88:91], v[124:127], v[32:35]
    ds_read_b128 v[52:55], v135 offset:41984
    v_mfma_f32_16x16x32_bf16 v[36:39], v[96:99], v[108:111], v[36:39]
    ds_read_b128 v[60:63], v135 offset:44032
    v_mfma_f32_16x16x32_bf16 v[40:43], v[96:99], v[116:119], v[40:43]
    v_mfma_f32_16x16x32_bf16 v[44:47], v[96:99], v[124:127], v[44:47]
    v_mfma_f32_16x16x32_bf16 v[24:27], v[92:95], v[104:107], v[24:27]
    v_xor_b32 v108, s34, v108
    v_xor_b32 v109, s34, v109
    v_mfma_f32_16x16x32_bf16 v[28:31], v[92:95], v[112:115], v[28:31]
    v_xor_b32 v110, s34, v110
    v_xor_b32 v111, s34, v111
    v_mfma_f32_16x16x32_bf16 v[32:35], v[92:95], v[120:123], v[32:35]
    v_xor_b32 v116, s34, v116
    v_xor_b32 v117, s34, v117
    v_mfma_f32_16x16x32_bf16 v[36:39], v[100:103], v[104:107], v[36:39]
    v_xor_b32 v118, s34, v118
    v_xor_b32 v119, s34, v119
    v_mfma_f32_16x16x32_bf16 v[40:43], v[100:103], v[112:115], v[40:43]
    v_xor_b32 v124, s34, v124
    v_xor_b32 v125, s34, v125
    v_mfma_f32_16x16x32_bf16 v[44:47], v[100:103], v[120:123], v[44:47]
    v_xor_b32 v126, s34, v126
    v_xor_b32 v127, s34, v127
    v_mfma_f32_16x16x32_bf16 v[0:3], v[92:95], v[108:111], v[0:3]
    v_mfma_f32_16x16x32_bf16 v[4:7], v[92:95], v[116:119], v[4:7]
    v_mfma_f32_16x16x32_bf16 v[8:11], v[92:95], v[124:127], v[8:11]
    s_waitcnt lgkmcnt(0)
    s_barrier
    v_mfma_f32_16x16x32_bf16 v[12:15], v[100:103], v[108:111], v[12:15]
    v_mfma_f32_16x16x32_bf16 v[16:19], v[100:103], v[116:119], v[16:19]
    v_mfma_f32_16x16x32_bf16 v[20:23], v[100:103], v[124:127], v[20:23]
    v_mfma_f32_16x16x32_bf16 v[0:3], v[48:51], v[64:67], v[0:3]
    ds_read_b128 v[88:91], v136 offset:0
    v_mfma_f32_16x16x32_bf16 v[4:7], v[48:51], v[72:75], v[4:7]
    ds_read_b128 v[104:107], v130 offset:0
    v_mfma_f32_16x16x32_bf16 v[8:11], v[48:51], v[80:83], v[8:11]
    ds_read_b128 v[112:115], v130 offset:2048
    v_mfma_f32_16x16x32_bf16 v[12:15], v[56:59], v[64:67], v[12:15]
    ds_read_b128 v[120:123], v130 offset:4096
    v_mfma_f32_16x16x32_bf16 v[16:19], v[56:59], v[72:75], v[16:19]
    ds_read_b128 v[96:99], v136 offset:2048
    v_mfma_f32_16x16x32_bf16 v[20:23], v[56:59], v[80:83], v[20:23]
    ds_read_b128 v[108:111], v133 offset:0
    v_mfma_f32_16x16x32_bf16 v[24:27], v[48:51], v[68:71], v[24:27]
    ds_read_b128 v[116:119], v133 offset:2048
    v_mfma_f32_16x16x32_bf16 v[28:31], v[48:51], v[76:79], v[28:31]
    ds_read_b128 v[124:127], v133 offset:4096
    v_mfma_f32_16x16x32_bf16 v[32:35], v[48:51], v[84:87], v[32:35]
    ds_read_b128 v[92:95], v136 offset:1024
    v_mfma_f32_16x16x32_bf16 v[36:39], v[56:59], v[68:71], v[36:39]
    ds_read_b128 v[100:103], v136 offset:3072
    v_mfma_f32_16x16x32_bf16 v[40:43], v[56:59], v[76:79], v[40:43]
    v_mfma_f32_16x16x32_bf16 v[44:47], v[56:59], v[84:87], v[44:47]
    v_mfma_f32_16x16x32_bf16 v[24:27], v[52:55], v[64:67], v[24:27]
    v_xor_b32 v68, s34, v68
    v_xor_b32 v69, s34, v69
    v_mfma_f32_16x16x32_bf16 v[28:31], v[52:55], v[72:75], v[28:31]
    v_xor_b32 v70, s34, v70
    v_xor_b32 v71, s34, v71
    v_mfma_f32_16x16x32_bf16 v[32:35], v[52:55], v[80:83], v[32:35]
    v_xor_b32 v76, s34, v76
    v_xor_b32 v77, s34, v77
    v_mfma_f32_16x16x32_bf16 v[36:39], v[60:63], v[64:67], v[36:39]
    v_xor_b32 v78, s34, v78
    v_xor_b32 v79, s34, v79
    v_mfma_f32_16x16x32_bf16 v[40:43], v[60:63], v[72:75], v[40:43]
    v_xor_b32 v84, s34, v84
    v_xor_b32 v85, s34, v85
    v_mfma_f32_16x16x32_bf16 v[44:47], v[60:63], v[80:83], v[44:47]
    v_xor_b32 v86, s34, v86
    v_xor_b32 v87, s34, v87
    v_mfma_f32_16x16x32_bf16 v[0:3], v[52:55], v[68:71], v[0:3]
    v_mfma_f32_16x16x32_bf16 v[4:7], v[52:55], v[76:79], v[4:7]
    v_mfma_f32_16x16x32_bf16 v[8:11], v[52:55], v[84:87], v[8:11]
    s_waitcnt lgkmcnt(0)
    s_barrier
    v_mfma_f32_16x16x32_bf16 v[12:15], v[60:63], v[68:71], v[12:15]
    v_mfma_f32_16x16x32_bf16 v[16:19], v[60:63], v[76:79], v[16:19]
    v_mfma_f32_16x16x32_bf16 v[20:23], v[60:63], v[84:87], v[20:23]
    v_mfma_f32_16x16x32_bf16 v[0:3], v[88:91], v[104:107], v[0:3]
    ds_read_b128 v[48:51], v134 offset:0
    v_mfma_f32_16x16x32_bf16 v[4:7], v[88:91], v[112:115], v[4:7]
    ds_read_b128 v[64:67], v128 offset:0
    v_mfma_f32_16x16x32_bf16 v[8:11], v[88:91], v[120:123], v[8:11]
    ds_read_b128 v[72:75], v128 offset:2048
    v_mfma_f32_16x16x32_bf16 v[12:15], v[96:99], v[104:107], v[12:15]
    ds_read_b128 v[80:83], v128 offset:4096
    v_mfma_f32_16x16x32_bf16 v[16:19], v[96:99], v[112:115], v[16:19]
    ds_read_b128 v[56:59], v134 offset:2048
    v_mfma_f32_16x16x32_bf16 v[20:23], v[96:99], v[120:123], v[20:23]
    ds_read_b128 v[68:71], v131 offset:0
    v_mfma_f32_16x16x32_bf16 v[24:27], v[88:91], v[108:111], v[24:27]
    ds_read_b128 v[76:79], v131 offset:2048
    v_mfma_f32_16x16x32_bf16 v[28:31], v[88:91], v[116:119], v[28:31]
    ds_read_b128 v[84:87], v131 offset:4096
    v_mfma_f32_16x16x32_bf16 v[32:35], v[88:91], v[124:127], v[32:35]
    ds_read_b128 v[52:55], v134 offset:1024
    v_mfma_f32_16x16x32_bf16 v[36:39], v[96:99], v[108:111], v[36:39]
    ds_read_b128 v[60:63], v134 offset:3072
    v_mfma_f32_16x16x32_bf16 v[40:43], v[96:99], v[116:119], v[40:43]
    v_mfma_f32_16x16x32_bf16 v[44:47], v[96:99], v[124:127], v[44:47]
    v_mfma_f32_16x16x32_bf16 v[24:27], v[92:95], v[104:107], v[24:27]
    v_xor_b32 v108, s34, v108
    v_xor_b32 v109, s34, v109
    v_mfma_f32_16x16x32_bf16 v[28:31], v[92:95], v[112:115], v[28:31]
    v_xor_b32 v110, s34, v110
    v_xor_b32 v111, s34, v111
    v_mfma_f32_16x16x32_bf16 v[32:35], v[92:95], v[120:123], v[32:35]
    v_xor_b32 v116, s34, v116
    v_xor_b32 v117, s34, v117
    v_mfma_f32_16x16x32_bf16 v[36:39], v[100:103], v[104:107], v[36:39]
    v_xor_b32 v118, s34, v118
    v_xor_b32 v119, s34, v119
    v_mfma_f32_16x16x32_bf16 v[40:43], v[100:103], v[112:115], v[40:43]
    v_xor_b32 v124, s34, v124
    v_xor_b32 v125, s34, v125
    v_mfma_f32_16x16x32_bf16 v[44:47], v[100:103], v[120:123], v[44:47]
    v_xor_b32 v126, s34, v126
    v_xor_b32 v127, s34, v127
    v_mfma_f32_16x16x32_bf16 v[0:3], v[92:95], v[108:111], v[0:3]
    v_mfma_f32_16x16x32_bf16 v[4:7], v[92:95], v[116:119], v[4:7]
    v_mfma_f32_16x16x32_bf16 v[8:11], v[92:95], v[124:127], v[8:11]
    s_waitcnt lgkmcnt(0)
    s_barrier
    v_mfma_f32_16x16x32_bf16 v[12:15], v[100:103], v[108:111], v[12:15]
    v_mfma_f32_16x16x32_bf16 v[16:19], v[100:103], v[116:119], v[16:19]
    v_mfma_f32_16x16x32_bf16 v[20:23], v[100:103], v[124:127], v[20:23]
    v_mfma_f32_16x16x32_bf16 v[0:3], v[48:51], v[64:67], v[0:3]
    ds_read_b128 v[88:91], v134 offset:20480
    v_mfma_f32_16x16x32_bf16 v[4:7], v[48:51], v[72:75], v[4:7]
    ds_read_b128 v[104:107], v128 offset:20480
    v_mfma_f32_16x16x32_bf16 v[8:11], v[48:51], v[80:83], v[8:11]
    ds_read_b128 v[112:115], v128 offset:22528
    v_mfma_f32_16x16x32_bf16 v[12:15], v[56:59], v[64:67], v[12:15]
    ds_read_b128 v[120:123], v128 offset:24576
    v_mfma_f32_16x16x32_bf16 v[16:19], v[56:59], v[72:75], v[16:19]
    ds_read_b128 v[96:99], v134 offset:22528
    v_mfma_f32_16x16x32_bf16 v[20:23], v[56:59], v[80:83], v[20:23]
    ds_read_b128 v[108:111], v131 offset:20480
    v_mfma_f32_16x16x32_bf16 v[24:27], v[48:51], v[68:71], v[24:27]
    ds_read_b128 v[116:119], v131 offset:22528
    v_mfma_f32_16x16x32_bf16 v[28:31], v[48:51], v[76:79], v[28:31]
    ds_read_b128 v[124:127], v131 offset:24576
    v_mfma_f32_16x16x32_bf16 v[32:35], v[48:51], v[84:87], v[32:35]
    ds_read_b128 v[92:95], v134 offset:21504
    v_mfma_f32_16x16x32_bf16 v[36:39], v[56:59], v[68:71], v[36:39]
    ds_read_b128 v[100:103], v134 offset:23552
    v_mfma_f32_16x16x32_bf16 v[40:43], v[56:59], v[76:79], v[40:43]
    v_mfma_f32_16x16x32_bf16 v[44:47], v[56:59], v[84:87], v[44:47]
    v_mfma_f32_16x16x32_bf16 v[24:27], v[52:55], v[64:67], v[24:27]
    v_xor_b32 v68, s34, v68
    v_xor_b32 v69, s34, v69
    v_mfma_f32_16x16x32_bf16 v[28:31], v[52:55], v[72:75], v[28:31]
    v_xor_b32 v70, s34, v70
    v_xor_b32 v71, s34, v71
    v_mfma_f32_16x16x32_bf16 v[32:35], v[52:55], v[80:83], v[32:35]
    v_xor_b32 v76, s34, v76
    v_xor_b32 v77, s34, v77
    v_mfma_f32_16x16x32_bf16 v[36:39], v[60:63], v[64:67], v[36:39]
    v_xor_b32 v78, s34, v78
    v_xor_b32 v79, s34, v79
    v_mfma_f32_16x16x32_bf16 v[40:43], v[60:63], v[72:75], v[40:43]
    v_xor_b32 v84, s34, v84
    v_xor_b32 v85, s34, v85
    v_mfma_f32_16x16x32_bf16 v[44:47], v[60:63], v[80:83], v[44:47]
    v_xor_b32 v86, s34, v86
    v_xor_b32 v87, s34, v87
    v_mfma_f32_16x16x32_bf16 v[0:3], v[52:55], v[68:71], v[0:3]
    v_mfma_f32_16x16x32_bf16 v[4:7], v[52:55], v[76:79], v[4:7]
    v_mfma_f32_16x16x32_bf16 v[8:11], v[52:55], v[84:87], v[8:11]
    s_waitcnt lgkmcnt(0)
    v_mfma_f32_16x16x32_bf16 v[12:15], v[60:63], v[68:71], v[12:15]
    v_mfma_f32_16x16x32_bf16 v[16:19], v[60:63], v[76:79], v[16:19]
    v_mfma_f32_16x16x32_bf16 v[20:23], v[60:63], v[84:87], v[20:23]
    v_mfma_f32_16x16x32_bf16 v[0:3], v[88:91], v[104:107], v[0:3]
    v_mfma_f32_16x16x32_bf16 v[4:7], v[88:91], v[112:115], v[4:7]
    v_mfma_f32_16x16x32_bf16 v[8:11], v[88:91], v[120:123], v[8:11]
    v_mfma_f32_16x16x32_bf16 v[12:15], v[96:99], v[104:107], v[12:15]
    v_mfma_f32_16x16x32_bf16 v[16:19], v[96:99], v[112:115], v[16:19]
    v_mfma_f32_16x16x32_bf16 v[20:23], v[96:99], v[120:123], v[20:23]
    v_mfma_f32_16x16x32_bf16 v[24:27], v[88:91], v[108:111], v[24:27]
    v_mfma_f32_16x16x32_bf16 v[28:31], v[88:91], v[116:119], v[28:31]
    v_mfma_f32_16x16x32_bf16 v[32:35], v[88:91], v[124:127], v[32:35]
    v_mfma_f32_16x16x32_bf16 v[36:39], v[96:99], v[108:111], v[36:39]
    v_mfma_f32_16x16x32_bf16 v[40:43], v[96:99], v[116:119], v[40:43]
    v_mfma_f32_16x16x32_bf16 v[44:47], v[96:99], v[124:127], v[44:47]
    v_mfma_f32_16x16x32_bf16 v[24:27], v[92:95], v[104:107], v[24:27]
    v_xor_b32 v108, s34, v108
    v_xor_b32 v109, s34, v109
    v_mfma_f32_16x16x32_bf16 v[28:31], v[92:95], v[112:115], v[28:31]
    v_xor_b32 v110, s34, v110
    v_xor_b32 v111, s34, v111
    v_mfma_f32_16x16x32_bf16 v[32:35], v[92:95], v[120:123], v[32:35]
    v_xor_b32 v116, s34, v116
    v_xor_b32 v117, s34, v117
    v_mfma_f32_16x16x32_bf16 v[36:39], v[100:103], v[104:107], v[36:39]
    v_xor_b32 v118, s34, v118
    v_xor_b32 v119, s34, v119
    v_mfma_f32_16x16x32_bf16 v[40:43], v[100:103], v[112:115], v[40:43]
    v_xor_b32 v124, s34, v124
    v_xor_b32 v125, s34, v125
    v_mfma_f32_16x16x32_bf16 v[44:47], v[100:103], v[120:123], v[44:47]
    v_xor_b32 v126, s34, v126
    v_xor_b32 v127, s34, v127
    v_mfma_f32_16x16x32_bf16 v[0:3], v[92:95], v[108:111], v[0:3]
    v_mfma_f32_16x16x32_bf16 v[4:7], v[92:95], v[116:119], v[4:7]
    v_mfma_f32_16x16x32_bf16 v[8:11], v[92:95], v[124:127], v[8:11]
    v_mfma_f32_16x16x32_bf16 v[12:15], v[100:103], v[108:111], v[12:15]
    v_mfma_f32_16x16x32_bf16 v[16:19], v[100:103], v[116:119], v[16:19]
    v_mfma_f32_16x16x32_bf16 v[20:23], v[100:103], v[124:127], v[20:23]
    s_nop 7
    s_nop 7
    v_cvt_pk_bf16_f32 v48, v0, v1
    v_cvt_pk_bf16_f32 v49, v2, v3
    v_cvt_pk_bf16_f32 v50, v12, v13
    v_cvt_pk_bf16_f32 v51, v14, v15
    v_cvt_pk_bf16_f32 v52, v24, v25
    v_cvt_pk_bf16_f32 v53, v26, v27
    v_cvt_pk_bf16_f32 v54, v36, v37
    v_cvt_pk_bf16_f32 v55, v38, v39
    v_mov_b32 v56, v48
    v_mov_b32 v57, v49
    v_mov_b32 v58, v50
    v_mov_b32 v59, v51
    s_add_u32 s35, s33, 0
    v_mov_b32_dpp v56, v52 row_ror:8 row_mask:0xf bank_mask:0x3
    v_mov_b32_dpp v57, v53 row_ror:8 row_mask:0xf bank_mask:0x3
    v_mov_b32_dpp v58, v54 row_ror:8 row_mask:0xf bank_mask:0x3
    v_mov_b32_dpp v59, v55 row_ror:8 row_mask:0xf bank_mask:0x3
    v_mov_b32_dpp v48, v52 row_ror:8 row_mask:0xf bank_mask:0xc
    v_mov_b32_dpp v49, v53 row_ror:8 row_mask:0xf bank_mask:0xc
    v_mov_b32_dpp v50, v54 row_ror:8 row_mask:0xf bank_mask:0xc
    v_mov_b32_dpp v51, v55 row_ror:8 row_mask:0xf bank_mask:0xc
    buffer_store_dwordx4 v[48:51], v142, s[16:19], s35 offen sc1
    buffer_store_dwordx4 v[56:59], v143, s[16:19], s35 offen sc1
    v_cvt_pk_bf16_f32 v60, v4, v5
    v_cvt_pk_bf16_f32 v61, v6, v7
    v_cvt_pk_bf16_f32 v62, v16, v17
    v_cvt_pk_bf16_f32 v63, v18, v19
    v_cvt_pk_bf16_f32 v64, v28, v29
    v_cvt_pk_bf16_f32 v65, v30, v31
    v_cvt_pk_bf16_f32 v66, v40, v41
    v_cvt_pk_bf16_f32 v67, v42, v43
    v_mov_b32 v68, v60
    v_mov_b32 v69, v61
    v_mov_b32 v70, v62
    v_mov_b32 v71, v63
    s_add_u32 s35, s33, 593920
    v_mov_b32_dpp v68, v64 row_ror:8 row_mask:0xf bank_mask:0x3
    v_mov_b32_dpp v69, v65 row_ror:8 row_mask:0xf bank_mask:0x3
    v_mov_b32_dpp v70, v66 row_ror:8 row_mask:0xf bank_mask:0x3
    v_mov_b32_dpp v71, v67 row_ror:8 row_mask:0xf bank_mask:0x3
    v_mov_b32_dpp v60, v64 row_ror:8 row_mask:0xf bank_mask:0xc
    v_mov_b32_dpp v61, v65 row_ror:8 row_mask:0xf bank_mask:0xc
    v_mov_b32_dpp v62, v66 row_ror:8 row_mask:0xf bank_mask:0xc
    v_mov_b32_dpp v63, v67 row_ror:8 row_mask:0xf bank_mask:0xc
    buffer_store_dwordx4 v[60:63], v142, s[16:19], s35 offen sc1
    buffer_store_dwordx4 v[68:71], v143, s[16:19], s35 offen sc1
    v_cvt_pk_bf16_f32 v72, v8, v9
    v_cvt_pk_bf16_f32 v73, v10, v11
    v_cvt_pk_bf16_f32 v74, v20, v21
    v_cvt_pk_bf16_f32 v75, v22, v23
    v_cvt_pk_bf16_f32 v76, v32, v33
    v_cvt_pk_bf16_f32 v77, v34, v35
    v_cvt_pk_bf16_f32 v78, v44, v45
    v_cvt_pk_bf16_f32 v79, v46, v47
    v_mov_b32 v80, v72
    v_mov_b32 v81, v73
    v_mov_b32 v82, v74
    v_mov_b32 v83, v75
    s_add_u32 s35, s33, 1187840
    v_mov_b32_dpp v80, v76 row_ror:8 row_mask:0xf bank_mask:0x3
    v_mov_b32_dpp v81, v77 row_ror:8 row_mask:0xf bank_mask:0x3
    v_mov_b32_dpp v82, v78 row_ror:8 row_mask:0xf bank_mask:0x3
    v_mov_b32_dpp v83, v79 row_ror:8 row_mask:0xf bank_mask:0x3
    v_mov_b32_dpp v72, v76 row_ror:8 row_mask:0xf bank_mask:0xc
    v_mov_b32_dpp v73, v77 row_ror:8 row_mask:0xf bank_mask:0xc
    v_mov_b32_dpp v74, v78 row_ror:8 row_mask:0xf bank_mask:0xc
    v_mov_b32_dpp v75, v79 row_ror:8 row_mask:0xf bank_mask:0xc
    buffer_store_dwordx4 v[72:75], v142, s[16:19], s35 offen sc1
    buffer_store_dwordx4 v[80:83], v143, s[16:19], s35 offen sc1
    s_endpgm
L_gemm2_kernel_loader:
    s_sub_u32 s20, s20, 4
    v_and_b32 v3, 63, v0
    v_lshrrev_b32 v4, 3, v3
    v_and_b32 v5, 7, v3
    v_xor_b32 v5, v5, v4
    v_lshlrev_b32 v5, 4, v5
    v_lshl_add_u32 v1, v4, 11, v5
    v_lshlrev_b32 v2, 4, v3
    s_add_u32 s24, s20, 0
    s_lshl_b32 s40, s24, 10
    s_lshl_b32 s43, s24, 14
    s_add_u32 s24, s20, 4
    s_lshl_b32 s41, s24, 10
    s_lshl_b32 s44, s24, 14
    s_add_u32 s24, s20, 8
    s_lshl_b32 s42, s24, 10
    s_lshl_b32 s45, s24, 14
    s_mul_i32 s46, s20, 2048
    s_add_u32 s47, s46, 12288
    s_add_u32 m0, s40, 0
    s_add_u32 s24, s43, 0
    buffer_load_dwordx4 v1, s[8:11], s24 offen lds
    s_add_u32 m0, s41, 0
    s_add_u32 s24, s44, 0
    buffer_load_dwordx4 v1, s[8:11], s24 offen lds
    s_add_u32 m0, s42, 0
    s_add_u32 s24, s45, 0
    buffer_load_dwordx4 v1, s[8:11], s24 offen lds
    s_add_u32 m0, s47, 0
    s_add_u32 s24, s46, 0
    buffer_load_dwordx4 v2, s[12:15], s24 offen offset:0 lds
    buffer_load_dwordx4 v2, s[12:15], s24 offen offset:1024 lds
    s_add_u32 m0, s40, 20480
    s_add_u32 s24, s43, 128
    buffer_load_dwordx4 v1, s[8:11], s24 offen lds
    s_add_u32 m0, s41, 20480
    s_add_u32 s24, s44, 128
    buffer_load_dwordx4 v1, s[8:11], s24 offen lds
    s_add_u32 m0, s42, 20480
    s_add_u32 s24, s45, 128
    buffer_load_dwordx4 v1, s[8:11], s24 offen lds
    s_add_u32 m0, s47, 20480
    s_add_u32 s24, s46, 32768
    buffer_load_dwordx4 v2, s[12:15], s24 offen offset:0 lds
    buffer_load_dwordx4 v2, s[12:15], s24 offen offset:1024 lds
    s_waitcnt vmcnt(5)
    s_barrier
    s_add_u32 m0, s40, 40960
    s_add_u32 s24, s43, 256
    buffer_load_dwordx4 v1, s[8:11], s24 offen lds
    s_add_u32 m0, s41, 40960
    s_add_u32 s24, s44, 256
    buffer_load_dwordx4 v1, s[8:11], s24 offen lds
    s_add_u32 m0, s42, 40960
    s_add_u32 s24, s45, 256
    buffer_load_dwordx4 v1, s[8:11], s24 offen lds
    s_add_u32 m0, s47, 40960
    s_add_u32 s24, s46, 65536
    buffer_load_dwordx4 v2, s[12:15], s24 offen offset:0 lds
    buffer_load_dwordx4 v2, s[12:15], s24 offen offset:1024 lds
    s_waitcnt vmcnt(5)
    s_barrier
    s_add_u32 m0, s40, 61440
    s_add_u32 s24, s43, 384
    buffer_load_dwordx4 v1, s[8:11], s24 offen lds
    s_add_u32 m0, s41, 61440
    s_add_u32 s24, s44, 384
    buffer_load_dwordx4 v1, s[8:11], s24 offen lds
    s_add_u32 m0, s42, 61440
    s_add_u32 s24, s45, 384
    buffer_load_dwordx4 v1, s[8:11], s24 offen lds
    s_add_u32 m0, s47, 61440
    s_add_u32 s24, s46, 98304
    buffer_load_dwordx4 v2, s[12:15], s24 offen offset:0 lds
    buffer_load_dwordx4 v2, s[12:15], s24 offen offset:1024 lds
    s_add_u32 m0, s40, 81920
    s_add_u32 s24, s43, 512
    buffer_load_dwordx4 v1, s[8:11], s24 offen lds
    s_add_u32 m0, s41, 81920
    s_add_u32 s24, s44, 512
    buffer_load_dwordx4 v1, s[8:11], s24 offen lds
    s_add_u32 m0, s42, 81920
    s_add_u32 s24, s45, 512
    buffer_load_dwordx4 v1, s[8:11], s24 offen lds
    s_add_u32 m0, s47, 81920
    s_add_u32 s24, s46, 131072
    buffer_load_dwordx4 v2, s[12:15], s24 offen offset:0 lds
    buffer_load_dwordx4 v2, s[12:15], s24 offen offset:1024 lds
    s_waitcnt vmcnt(10)
    s_barrier
    s_add_u32 m0, s40, 102400
    s_add_u32 s24, s43, 640
    buffer_load_dwordx4 v1, s[8:11], s24 offen lds
    s_add_u32 m0, s41, 102400
    s_add_u32 s24, s44, 640
    buffer_load_dwordx4 v1, s[8:11], s24 offen lds
    s_add_u32 m0, s42, 102400
    s_add_u32 s24, s45, 640
    buffer_load_dwordx4 v1, s[8:11], s24 offen lds
    s_add_u32 m0, s47, 102400
    s_add_u32 s24, s46, 163840
    buffer_load_dwordx4 v2, s[12:15], s24 offen offset:0 lds
    buffer_load_dwordx4 v2, s[12:15], s24 offen offset:1024 lds
    s_add_u32 m0, s40, 122880
    s_add_u32 s24, s43, 768
    buffer_load_dwordx4 v1, s[8:11], s24 offen lds
    s_add_u32 m0, s41, 122880
    s_add_u32 s24, s44, 768
    buffer_load_dwordx4 v1, s[8:11], s24 offen lds
    s_add_u32 m0, s42, 122880
    s_add_u32 s24, s45, 768
    buffer_load_dwordx4 v1, s[8:11], s24 offen lds
    s_add_u32 m0, s47, 122880
    s_add_u32 s24, s46, 196608
    buffer_load_dwordx4 v2, s[12:15], s24 offen offset:0 lds
    buffer_load_dwordx4 v2, s[12:15], s24 offen offset:1024 lds
    s_waitcnt vmcnt(15)
    s_barrier
    s_add_u32 m0, s40, 0
    s_add_u32 s24, s43, 896
    buffer_load_dwordx4 v1, s[8:11], s24 offen lds
    s_add_u32 m0, s41, 0
    s_add_u32 s24, s44, 896
    buffer_load_dwordx4 v1, s[8:11], s24 offen lds
    s_add_u32 m0, s42, 0
    s_add_u32 s24, s45, 896
    buffer_load_dwordx4 v1, s[8:11], s24 offen lds
    s_add_u32 m0, s47, 0
    s_add_u32 s24, s46, 229376
    buffer_load_dwordx4 v2, s[12:15], s24 offen offset:0 lds
    buffer_load_dwordx4 v2, s[12:15], s24 offen offset:1024 lds
    s_add_u32 m0, s40, 20480
    s_add_u32 s24, s43, 1024
    buffer_load_dwordx4 v1, s[8:11], s24 offen lds
    s_add_u32 m0, s41, 20480
    s_add_u32 s24, s44, 1024
    buffer_load_dwordx4 v1, s[8:11], s24 offen lds
    s_add_u32 m0, s42, 20480
    s_add_u32 s24, s45, 1024
    buffer_load_dwordx4 v1, s[8:11], s24 offen lds
    s_add_u32 m0, s47, 20480
    s_add_u32 s24, s46, 262144
    buffer_load_dwordx4 v2, s[12:15], s24 offen offset:0 lds
    buffer_load_dwordx4 v2, s[12:15], s24 offen offset:1024 lds
    s_waitcnt vmcnt(20)
    s_barrier
    s_add_u32 m0, s40, 40960
    s_add_u32 s24, s43, 1152
    buffer_load_dwordx4 v1, s[8:11], s24 offen lds
    s_add_u32 m0, s41, 40960
    s_add_u32 s24, s44, 1152
    buffer_load_dwordx4 v1, s[8:11], s24 offen lds
    s_add_u32 m0, s42, 40960
    s_add_u32 s24, s45, 1152
    buffer_load_dwordx4 v1, s[8:11], s24 offen lds
    s_add_u32 m0, s47, 40960
    s_add_u32 s24, s46, 294912
    buffer_load_dwordx4 v2, s[12:15], s24 offen offset:0 lds
    buffer_load_dwordx4 v2, s[12:15], s24 offen offset:1024 lds
    s_add_u32 m0, s40, 61440
    s_add_u32 s24, s43, 1280
    buffer_load_dwordx4 v1, s[8:11], s24 offen lds
    s_add_u32 m0, s41, 61440
    s_add_u32 s24, s44, 1280
    buffer_load_dwordx4 v1, s[8:11], s24 offen lds
    s_add_u32 m0, s42, 61440
    s_add_u32 s24, s45, 1280
    buffer_load_dwordx4 v1, s[8:11], s24 offen lds
    s_add_u32 m0, s47, 61440
    s_add_u32 s24, s46, 327680
    buffer_load_dwordx4 v2, s[12:15], s24 offen offset:0 lds
    buffer_load_dwordx4 v2, s[12:15], s24 offen offset:1024 lds
    s_waitcnt vmcnt(25)
    s_barrier
    s_add_u32 m0, s40, 81920
    s_add_u32 s24, s43, 1408
    buffer_load_dwordx4 v1, s[8:11], s24 offen lds
    s_add_u32 m0, s41, 81920
    s_add_u32 s24, s44, 1408
    buffer_load_dwordx4 v1, s[8:11], s24 offen lds
    s_add_u32 m0, s42, 81920
    s_add_u32 s24, s45, 1408
    buffer_load_dwordx4 v1, s[8:11], s24 offen lds
    s_add_u32 m0, s47, 81920
    s_add_u32 s24, s46, 360448
    buffer_load_dwordx4 v2, s[12:15], s24 offen offset:0 lds
    buffer_load_dwordx4 v2, s[12:15], s24 offen offset:1024 lds
    s_waitcnt vmcnt(25)
    s_barrier
    s_add_u32 m0, s40, 102400
    s_add_u32 s24, s43, 1536
    buffer_load_dwordx4 v1, s[8:11], s24 offen lds
    s_add_u32 m0, s41, 102400
    s_add_u32 s24, s44, 1536
    buffer_load_dwordx4 v1, s[8:11], s24 offen lds
    s_add_u32 m0, s42, 102400
    s_add_u32 s24, s45, 1536
    buffer_load_dwordx4 v1, s[8:11], s24 offen lds
    s_add_u32 m0, s47, 102400
    s_add_u32 s24, s46, 393216
    buffer_load_dwordx4 v2, s[12:15], s24 offen offset:0 lds
    buffer_load_dwordx4 v2, s[12:15], s24 offen offset:1024 lds
    s_waitcnt vmcnt(25)
    s_barrier
    s_add_u32 m0, s40, 122880
    s_add_u32 s24, s43, 1664
    buffer_load_dwordx4 v1, s[8:11], s24 offen lds
    s_add_u32 m0, s41, 122880
    s_add_u32 s24, s44, 1664
    buffer_load_dwordx4 v1, s[8:11], s24 offen lds
    s_add_u32 m0, s42, 122880
    s_add_u32 s24, s45, 1664
    buffer_load_dwordx4 v1, s[8:11], s24 offen lds
    s_add_u32 m0, s47, 122880
    s_add_u32 s24, s46, 425984
    buffer_load_dwordx4 v2, s[12:15], s24 offen offset:0 lds
    buffer_load_dwordx4 v2, s[12:15], s24 offen offset:1024 lds
    s_waitcnt vmcnt(25)
    s_barrier
    s_add_u32 m0, s40, 0
    s_add_u32 s24, s43, 1792
    buffer_load_dwordx4 v1, s[8:11], s24 offen lds
    s_add_u32 m0, s41, 0
    s_add_u32 s24, s44, 1792
    buffer_load_dwordx4 v1, s[8:11], s24 offen lds
    s_add_u32 m0, s42, 0
    s_add_u32 s24, s45, 1792
    buffer_load_dwordx4 v1, s[8:11], s24 offen lds
    s_add_u32 m0, s47, 0
    s_add_u32 s24, s46, 458752
    buffer_load_dwordx4 v2, s[12:15], s24 offen offset:0 lds
    buffer_load_dwordx4 v2, s[12:15], s24 offen offset:1024 lds
    s_waitcnt vmcnt(25)
    s_barrier
    s_add_u32 m0, s40, 20480
    s_add_u32 s24, s43, 1920
    buffer_load_dwordx4 v1, s[8:11], s24 offen lds
    s_add_u32 m0, s41, 20480
    s_add_u32 s24, s44, 1920
    buffer_load_dwordx4 v1, s[8:11], s24 offen lds
    s_add_u32 m0, s42, 20480
    s_add_u32 s24, s45, 1920
    buffer_load_dwordx4 v1, s[8:11], s24 offen lds
    s_add_u32 m0, s47, 20480
    s_add_u32 s24, s46, 491520
    buffer_load_dwordx4 v2, s[12:15], s24 offen offset:0 lds
    buffer_load_dwordx4 v2, s[12:15], s24 offen offset:1024 lds
    s_waitcnt vmcnt(25)
    s_barrier
    s_waitcnt vmcnt(20)
    s_barrier
    s_waitcnt vmcnt(15)
    s_barrier
    s_waitcnt vmcnt(10)
    s_barrier
    s_waitcnt vmcnt(5)
    s_barrier
    s_waitcnt vmcnt(0)
    s_barrier
L_gemm2_kernel_done:
    s_endpgm
.globl joint_kernel
.p2align 8
.type joint_kernel,@function
joint_kernel:
    s_cmp_ge_u32 s2, 250
    s_cbranch_scc1 L_joint_kernel_done
    s_load_dwordx2 s[6:7], s[0:1], 72
    s_load_dwordx2 s[4:5], s[0:1], 56
    v_readfirstlane_b32 s20, v0
    s_lshr_b32 s20, s20, 6
    s_and_b32 s21, s20, 3
    s_cmp_ge_u32 s2, 125
    s_cselect_b32 s24, 1, 0
    s_mul_i32 s25, s24, 125
    s_sub_u32 s25, s2, s25
    s_lshl_b32 s26, s25, 1
    s_add_u32 s26, s26, 0
    s_mul_i32 s27, s26, 171
    s_lshr_b32 s28, s27, 9
    s_mul_i32 s27, s28, 3
    s_sub_u32 s30, s26, s27
    s_lshl_b32 s26, s25, 1
    s_add_u32 s26, s26, 1
    s_mul_i32 s27, s26, 171
    s_lshr_b32 s29, s27, 9
    s_mul_i32 s27, s29, 3
    s_sub_u32 s31, s26, s27
    v_and_b32 v1, 63, v0
    v_lshlrev_b32 v5, 4, v1
    s_waitcnt lgkmcnt(0)
    s_add_u32 s12, s6, 85499904
    s_addc_u32 s13, s7, 0
    s_mov_b32 s14, 294912
    s_mov_b32 s15, 0x00020000
    s_mul_i32 s36, s24, 4000
    s_lshl_b32 s37, s25, 5
    s_add_u32 s36, s36, s37
    s_lshl_b32 s36, s36, 12
    s_add_u32 s16, s4, s36
    s_addc_u32 s17, s5, 0
    s_mov_b32 s18, 131072
    s_mov_b32 s19, 0x00020000
    s_lshl_b32 s38, s21, 15
    s_cmp_ge_u32 s20, 4
    s_cbranch_scc1 L_joint_kernel_helper
    s_lshr_b32 s36, s2, 3
    s_and_b32 s36, s36, 31
    s_lshl_b32 s36, s36, 13
    s_add_u32 s36, s36, 32768
    v_lshlrev_b32 v6, 7, v1
    s_cmp_lg_u32 s20, 0
    s_cbranch_scc1 L_joint_kernel_nopf
    buffer_load_dword v7, v6, s[12:15], s36 offen
L_joint_kernel_nopf:
    v_lshrrev_b32 v2, 2, v1
    v_lshlrev_b32 v2, 6, v2
    v_lshrrev_b32 v3, 5, v1
    v_lshlrev_b32 v3, 1, v3
    v_and_b32 v4, 3, v1
    v_xor_b32 v3, v3, v4
    v_lshl_add_u32 v2, v3, 4, v2
    s_lshl_b32 s34, s21, 14
    s_lshl_b32 s35, s21, 13
    s_mul_i32 s33, s24, 3118080
    s_add_u32 s33, s33, 79261696
    s_add_u32 s8, s6, s33
    s_addc_u32 s9, s7, 0
    s_mov_b32 s10, 3118080
    s_mov_b32 s11, 0x00020000
    s_mov_b32 s46, 0
    s_cmp_eq_u32 s28, s29
    s_cbranch_scc1 L_joint_kernel_same
    s_mul_i32 s36, s29, 37120
    s_add_u32 s36, s36, s35
    s_add_u32 m0, s34, 8192
    s_add_u32 s37, s36, 0
    buffer_load_dwordx4 v2, s[8:11], s37 offen offset:0 lds
    buffer_load_dwordx4 v2, s[8:11], s37 offen offset:1024 lds
    buffer_load_dwordx4 v2, s[8:11], s37 offen offset:2048 lds
    buffer_load_dwordx4 v2, s[8:11], s37 offen offset:3072 lds
    s_add_u32 m0, s34, 12288
    s_add_u32 s37, s36, 4096
    buffer_load_dwordx4 v2, s[8:11], s37 offen offset:0 lds
    buffer_load_dwordx4 v2, s[8:11], s37 offen offset:1024 lds
    buffer_load_dwordx4 v2, s[8:11], s37 offen offset:2048 lds
    buffer_load_dwordx4 v2, s[8:11], s37 offen offset:3072 lds
    s_mov_b32 s46, 8192
L_joint_kernel_same:
    s_lshl_b32 s36, s30, 11
    s_add_u32 s36, s36, 8192
    buffer_load_dwordx4 v[8:11], v5, s[12:15], s36 offen offset:0
    buffer_load_dwordx4 v[12:15], v5, s[12:15], s36 offen offset:1024
    s_lshl_b32 s36, s31, 11
    s_add_u32 s36, s36, 8192
    buffer_load_dwordx4 v[16:19], v5, s[12:15], s36 offen offset:0
    buffer_load_dwordx4 v[20:23], v5, s[12:15], s36 offen offset:1024
    s_mul_i32 s36, s28, 37120
    s_add_u32 s36, s36, s35
    s_add_u32 m0, s34, 0
    s_add_u32 s37, s36, 0
    buffer_load_dwordx4 v2, s[8:11], s37 offen offset:0 lds
    buffer_load_dwordx4 v2, s[8:11], s37 offen offset:1024 lds
    buffer_load_dwordx4 v2, s[8:11], s37 offen offset:2048 lds
    buffer_load_dwordx4 v2, s[8:11], s37 offen offset:3072 lds
    s_add_u32 m0, s34, 4096
    s_add_u32 s37, s36, 4096
    buffer_load_dwordx4 v2, s[8:11], s37 offen offset:0 lds
    buffer_load_dwordx4 v2, s[8:11], s37 offen offset:1024 lds
    buffer_load_dwordx4 v2, s[8:11], s37 offen offset:2048 lds
    buffer_load_dwordx4 v2, s[8:11], s37 offen offset:3072 lds
    v_bfe_u32 v32, v1, 2, 2
    v_lshrrev_b32 v33, 4, v1
    v_and_b32 v34, 3, v1
    v_lshl_add_u32 v35, v33, 3, v32
    v_lshlrev_b32 v40, 6, v35
    v_and_b32 v41, 1, v33
    v_lshlrev_b32 v41, 1, v41
    v_lshrrev_b32 v42, 1, v34
    v_xor_b32 v41, v41, v42
    v_lshl_add_u32 v40, v41, 4, v40
    v_and_b32 v42, 1, v34
    v_lshl_add_u32 v40, v42, 3, v40
    v_add_u32 v36, s34, v40
    v_xor_b32 v37, 32, v36
    v_add_u32 v38, s46, v36
    v_add_u32 v39, s46, v37
    v_lshrrev_b32 v41, 1, v33
    v_lshlrev_b32 v41, 10, v41
    v_and_b32 v42, 1, v33
    v_lshl_add_u32 v41, v42, 9, v41
    v_and_b32 v42, 15, v1
    v_lshl_add_u32 v41, v42, 4, v41
    s_lshl_b32 s36, s21, 12
    s_add_u32 s36, s36, 65536
    v_add_u32 v43, s36, v41
    s_mov_b32 s40, 0xbdd2d3e8
    v_mov_b32 v44, 0xc0135761
    s_mov_b32 s41, 0xbdd2d3e8
    v_mov_b32 v45, 0xc0135761
    s_waitcnt vmcnt(4)
    ds_read_b64_tr_b16 v[48:49], v36 offset:0
    ds_read_b64_tr_b16 v[50:51], v36 offset:256
    ds_read_b64_tr_b16 v[52:53], v36 offset:2048
    ds_read_b64_tr_b16 v[54:55], v36 offset:2304
    ds_read_b64_tr_b16 v[56:57], v37 offset:0
    ds_read_b64_tr_b16 v[58:59], v37 offset:256
    ds_read_b64_tr_b16 v[60:61], v37 offset:2048
    ds_read_b64_tr_b16 v[62:63], v37 offset:2304
    s_waitcnt lgkmcnt(0)
    v_mfma_f32_16x16x32_bf16 v[64:67], v[48:51], v[8:11], 0
    v_mfma_f32_16x16x32_bf16 v[68:71], v[56:59], v[8:11], 0
    v_mfma_f32_16x16x32_bf16 v[64:67], v[52:55], v[12:15], v[64:67]
    v_mfma_f32_16x16x32_bf16 v[68:71], v[60:63], v[12:15], v[68:71]
    ds_read_b64_tr_b16 v[84:85], v38 offset:0
    ds_read_b64_tr_b16 v[86:87], v38 offset:256
    ds_read_b64_tr_b16 v[88:89], v38 offset:2048
    ds_read_b64_tr_b16 v[90:91], v38 offset:2304
    ds_read_b64_tr_b16 v[92:93], v39 offset:0
    ds_read_b64_tr_b16 v[94:95], v39 offset:256
    ds_read_b64_tr_b16 v[96:97], v39 offset:2048
    ds_read_b64_tr_b16 v[98:99], v39 offset:2304
    v_mul_f32 v72, v64, v64
    v_mul_f32 v73, v65, v65
    v_mul_f32 v74, v66, v66
    v_mul_f32 v75, v67, v67
    v_mul_f32 v76, v68, v68
    v_mul_f32 v77, v69, v69
    v_mul_f32 v78, v70, v70
    v_mul_f32 v79, v71, v71
    v_fma_f32 v72, v72, s40, v44
    v_fma_f32 v73, v73, s40, v44
    v_fma_f32 v74, v74, s40, v44
    v_fma_f32 v75, v75, s40, v44
    v_fma_f32 v76, v76, s40, v44
    v_fma_f32 v77, v77, s40, v44
    v_fma_f32 v78, v78, s40, v44
    v_fma_f32 v79, v79, s40, v44
    v_mul_f32 v72, v72, v64
    v_mul_f32 v73, v73, v65
    v_mul_f32 v74, v74, v66
    v_mul_f32 v75, v75, v67
    v_mul_f32 v76, v76, v68
    v_mul_f32 v77, v77, v69
    v_mul_f32 v78, v78, v70
    v_mul_f32 v79, v79, v71
    v_exp_f32 v72, v72
    v_exp_f32 v73, v73
    v_exp_f32 v74, v74
    v_exp_f32 v75, v75
    v_exp_f32 v76, v76
    v_exp_f32 v77, v77
    v_exp_f32 v78, v78
    v_exp_f32 v79, v79
    v_add_f32 v72, 1.0, v72
    v_add_f32 v73, 1.0, v73
    v_add_f32 v74, 1.0, v74
    v_add_f32 v75, 1.0, v75
    v_add_f32 v76, 1.0, v76
    v_add_f32 v77, 1.0, v77
    v_add_f32 v78, 1.0, v78
    v_add_f32 v79, 1.0, v79
    v_rcp_f32 v72, v72
    v_rcp_f32 v73, v73
    v_rcp_f32 v74, v74
    v_rcp_f32 v75, v75
    v_rcp_f32 v76, v76
    v_rcp_f32 v77, v77
    v_rcp_f32 v78, v78
    v_rcp_f32 v79, v79
    v_mul_f32 v64, v64, v72
    v_mul_f32 v65, v65, v73
    v_mul_f32 v66, v66, v74
    v_mul_f32 v67, v67, v75
    v_mul_f32 v68, v68, v76
    v_mul_f32 v69, v69, v77
    v_mul_f32 v70, v70, v78
    v_mul_f32 v71, v71, v79
    v_cvt_pk_bf16_f32 v80, v64, v65
    v_cvt_pk_bf16_f32 v81, v66, v67
    v_cvt_pk_bf16_f32 v82, v68, v69
    v_cvt_pk_bf16_f32 v83, v70, v71
    ds_write_b128 v43, v[80:83] offset:0
    s_waitcnt vmcnt(0)
    s_waitcnt lgkmcnt(1)
    v_mfma_f32_16x16x32_bf16 v[100:103], v[84:87], v[16:19], 0
    v_mfma_f32_16x16x32_bf16 v[104:107], v[92:95], v[16:19], 0
    v_mfma_f32_16x16x32_bf16 v[100:103], v[88:91], v[20:23], v[100:103]
    v_mfma_f32_16x16x32_bf16 v[104:107], v[96:99], v[20:23], v[104:107]
    ds_read_b64_tr_b16 v[48:49], v36 offset:4096
    ds_read_b64_tr_b16 v[50:51], v36 offset:4352
    ds_read_b64_tr_b16 v[52:53], v36 offset:6144
    ds_read_b64_tr_b16 v[54:55], v36 offset:6400
    ds_read_b64_tr_b16 v[56:57], v37 offset:4096
    ds_read_b64_tr_b16 v[58:59], v37 offset:4352
    ds_read_b64_tr_b16 v[60:61], v37 offset:6144
    ds_read_b64_tr_b16 v[62:63], v37 offset:6400
    v_mul_f32 v72, v100, v100
    v_mul_f32 v73, v101, v101
    v_mul_f32 v74, v102, v102
    v_mul_f32 v75, v103, v103
    v_mul_f32 v76, v104, v104
    v_mul_f32 v77, v105, v105
    v_mul_f32 v78, v106, v106
    v_mul_f32 v79, v107, v107
    v_fma_f32 v72, v72, s40, v44
    v_fma_f32 v73, v73, s40, v44
    v_fma_f32 v74, v74, s40, v44
    v_fma_f32 v75, v75, s40, v44
    v_fma_f32 v76, v76, s40, v44
    v_fma_f32 v77, v77, s40, v44
    v_fma_f32 v78, v78, s40, v44
    v_fma_f32 v79, v79, s40, v44
    v_mul_f32 v72, v72, v100
    v_mul_f32 v73, v73, v101
    v_mul_f32 v74, v74, v102
    v_mul_f32 v75, v75, v103
    v_mul_f32 v76, v76, v104
    v_mul_f32 v77, v77, v105
    v_mul_f32 v78, v78, v106
    v_mul_f32 v79, v79, v107
    v_exp_f32 v72, v72
    v_exp_f32 v73, v73
    v_exp_f32 v74, v74
    v_exp_f32 v75, v75
    v_exp_f32 v76, v76
    v_exp_f32 v77, v77
    v_exp_f32 v78, v78
    v_exp_f32 v79, v79
    v_add_f32 v72, 1.0, v72
    v_add_f32 v73, 1.0, v73
    v_add_f32 v74, 1.0, v74
    v_add_f32 v75, 1.0, v75
    v_add_f32 v76, 1.0, v76
    v_add_f32 v77, 1.0, v77
    v_add_f32 v78, 1.0, v78
    v_add_f32 v79, 1.0, v79
    v_rcp_f32 v72, v72
    v_rcp_f32 v73, v73
    v_rcp_f32 v74, v74
    v_rcp_f32 v75, v75
    v_rcp_f32 v76, v76
    v_rcp_f32 v77, v77
    v_rcp_f32 v78, v78
    v_rcp_f32 v79, v79
    v_mul_f32 v100, v100, v72
    v_mul_f32 v101, v101, v73
    v_mul_f32 v102, v102, v74
    v_mul_f32 v103, v103, v75
    v_mul_f32 v104, v104, v76
    v_mul_f32 v105, v105, v77
    v_mul_f32 v106, v106, v78
    v_mul_f32 v107, v107, v79
    v_cvt_pk_bf16_f32 v108, v100, v101
    v_cvt_pk_bf16_f32 v109, v102, v103
    v_cvt_pk_bf16_f32 v110, v104, v105
    v_cvt_pk_bf16_f32 v111, v106, v107
    ds_write_b128 v43, v[108:111] offset:256
    s_waitcnt lgkmcnt(1)
    v_mfma_f32_16x16x32_bf16 v[64:67], v[48:51], v[8:11], 0
    v_mfma_f32_16x16x32_bf16 v[68:71], v[56:59], v[8:11], 0
    v_mfma_f32_16x16x32_bf16 v[64:67], v[52:55], v[12:15], v[64:67]
    v_mfma_f32_16x16x32_bf16 v[68:71], v[60:63], v[12:15], v[68:71]
    ds_read_b64_tr_b16 v[84:85], v38 offset:4096
    ds_read_b64_tr_b16 v[86:87], v38 offset:4352
    ds_read_b64_tr_b16 v[88:89], v38 offset:6144
    ds_read_b64_tr_b16 v[90:91], v38 offset:6400
    ds_read_b64_tr_b16 v[92:93], v39 offset:4096
    ds_read_b64_tr_b16 v[94:95], v39 offset:4352
    ds_read_b64_tr_b16 v[96:97], v39 offset:6144
    ds_read_b64_tr_b16 v[98:99], v39 offset:6400
    v_mul_f32 v72, v64, v64
    v_mul_f32 v73, v65, v65
    v_mul_f32 v74, v66, v66
    v_mul_f32 v75, v67, v67
    v_mul_f32 v76, v68, v68
    v_mul_f32 v77, v69, v69
    v_mul_f32 v78, v70, v70
    v_mul_f32 v79, v71, v71
    v_fma_f32 v72, v72, s40, v44
    v_fma_f32 v73, v73, s40, v44
    v_fma_f32 v74, v74, s40, v44
    v_fma_f32 v75, v75, s40, v44
    v_fma_f32 v76, v76, s40, v44
    v_fma_f32 v77, v77, s40, v44
    v_fma_f32 v78, v78, s40, v44
    v_fma_f32 v79, v79, s40, v44
    v_mul_f32 v72, v72, v64
    v_mul_f32 v73, v73, v65
    v_mul_f32 v74, v74, v66
    v_mul_f32 v75, v75, v67
    v_mul_f32 v76, v76, v68
    v_mul_f32 v77, v77, v69
    v_mul_f32 v78, v78, v70
    v_mul_f32 v79, v79, v71
    v_exp_f32 v72, v72
    v_exp_f32 v73, v73
    v_exp_f32 v74, v74
    v_exp_f32 v75, v75
    v_exp_f32 v76, v76
    v_exp_f32 v77, v77
    v_exp_f32 v78, v78
    v_exp_f32 v79, v79
    v_add_f32 v72, 1.0, v72
    v_add_f32 v73, 1.0, v73
    v_add_f32 v74, 1.0, v74
    v_add_f32 v75, 1.0, v75
    v_add_f32 v76, 1.0, v76
    v_add_f32 v77, 1.0, v77
    v_add_f32 v78, 1.0, v78
    v_add_f32 v79, 1.0, v79
    v_rcp_f32 v72, v72
    v_rcp_f32 v73, v73
    v_rcp_f32 v74, v74
    v_rcp_f32 v75, v75
    v_rcp_f32 v76, v76
    v_rcp_f32 v77, v77
    v_rcp_f32 v78, v78
    v_rcp_f32 v79, v79
    v_mul_f32 v64, v64, v72
    v_mul_f32 v65, v65, v73
    v_mul_f32 v66, v66, v74
    v_mul_f32 v67, v67, v75
    v_mul_f32 v68, v68, v76
    v_mul_f32 v69, v69, v77
    v_mul_f32 v70, v70, v78
    v_mul_f32 v71, v71, v79
    v_cvt_pk_bf16_f32 v80, v64, v65
    v_cvt_pk_bf16_f32 v81, v66, v67
    v_cvt_pk_bf16_f32 v82, v68, v69
    v_cvt_pk_bf16_f32 v83, v70, v71
    ds_write_b128 v43, v[80:83] offset:2048
    s_waitcnt lgkmcnt(1)
    v_mfma_f32_16x16x32_bf16 v[100:103], v[84:87], v[16:19], 0
    v_mfma_f32_16x16x32_bf16 v[104:107], v[92:95], v[16:19], 0
    v_mfma_f32_16x16x32_bf16 v[100:103], v[88:91], v[20:23], v[100:103]
    v_mfma_f32_16x16x32_bf16 v[104:107], v[96:99], v[20:23], v[104:107]
    s_nop 7
    v_mul_f32 v72, v100, v100
    v_mul_f32 v73, v101, v101
    v_mul_f32 v74, v102, v102
    v_mul_f32 v75, v103, v103
    v_mul_f32 v76, v104, v104
    v_mul_f32 v77, v105, v105
    v_mul_f32 v78, v106, v106
    v_mul_f32 v79, v107, v107
    v_fma_f32 v72, v72, s40, v44
    v_fma_f32 v73, v73, s40, v44
    v_fma_f32 v74, v74, s40, v44
    v_fma_f32 v75, v75, s40, v44
    v_fma_f32 v76, v76, s40, v44
    v_fma_f32 v77, v77, s40, v44
    v_fma_f32 v78, v78, s40, v44
    v_fma_f32 v79, v79, s40, v44
    v_mul_f32 v72, v72, v100
    v_mul_f32 v73, v73, v101
    v_mul_f32 v74, v74, v102
    v_mul_f32 v75, v75, v103
    v_mul_f32 v76, v76, v104
    v_mul_f32 v77, v77, v105
    v_mul_f32 v78, v78, v106
    v_mul_f32 v79, v79, v107
    v_exp_f32 v72, v72
    v_exp_f32 v73, v73
    v_exp_f32 v74, v74
    v_exp_f32 v75, v75
    v_exp_f32 v76, v76
    v_exp_f32 v77, v77
    v_exp_f32 v78, v78
    v_exp_f32 v79, v79
    v_add_f32 v72, 1.0, v72
    v_add_f32 v73, 1.0, v73
    v_add_f32 v74, 1.0, v74
    v_add_f32 v75, 1.0, v75
    v_add_f32 v76, 1.0, v76
    v_add_f32 v77, 1.0, v77
    v_add_f32 v78, 1.0, v78
    v_add_f32 v79, 1.0, v79
    v_rcp_f32 v72, v72
    v_rcp_f32 v73, v73
    v_rcp_f32 v74, v74
    v_rcp_f32 v75, v75
    v_rcp_f32 v76, v76
    v_rcp_f32 v77, v77
    v_rcp_f32 v78, v78
    v_rcp_f32 v79, v79
    v_mul_f32 v100, v100, v72
    v_mul_f32 v101, v101, v73
    v_mul_f32 v102, v102, v74
    v_mul_f32 v103, v103, v75
    v_mul_f32 v104, v104, v76
    v_mul_f32 v105, v105, v77
    v_mul_f32 v106, v106, v78
    v_mul_f32 v107, v107, v79
    v_cvt_pk_bf16_f32 v108, v100, v101
    v_cvt_pk_bf16_f32 v109, v102, v103
    v_cvt_pk_bf16_f32 v110, v104, v105
    v_cvt_pk_bf16_f32 v111, v106, v107
    ds_write_b128 v43, v[108:111] offset:2304
    s_waitcnt lgkmcnt(0)
    s_barrier
    s_add_u32 s36, s38, 163840
    buffer_load_dwordx4 a[0:3], v5, s[12:15], s36 offen
    s_add_u32 s36, s38, 180224
    buffer_load_dwordx4 a[64:67], v5, s[12:15], s36 offen
    s_add_u32 s36, s38, 164864
    buffer_load_dwordx4 a[4:7], v5, s[12:15], s36 offen
    s_add_u32 s36, s38, 181248
    buffer_load_dwordx4 a[68:71], v5, s[12:15], s36 offen
    s_add_u32 s36, s38, 165888
    buffer_load_dwordx4 a[8:11], v5, s[12:15], s36 offen
    s_add_u32 s36, s38, 182272
    buffer_load_dwordx4 a[72:75], v5, s[12:15], s36 offen
    s_add_u32 s36, s38, 166912
    buffer_load_dwordx4 a[12:15], v5, s[12:15], s36 offen
    s_add_u32 s36, s38, 183296
    buffer_load_dwordx4 a[76:79], v5, s[12:15], s36 offen
    s_add_u32 s36, s38, 167936
    buffer_load_dwordx4 a[16:19], v5, s[12:15], s36 offen
    s_add_u32 s36, s38, 184320
    buffer_load_dwordx4 a[80:83], v5, s[12:15], s36 offen
    s_add_u32 s36, s38, 168960
    buffer_load_dwordx4 a[20:23], v5, s[12:15], s36 offen
    s_add_u32 s36, s38, 185344
    buffer_load_dwordx4 a[84:87], v5, s[12:15], s36 offen
    s_add_u32 s36, s38, 169984
    buffer_load_dwordx4 a[24:27], v5, s[12:15], s36 offen
    s_add_u32 s36, s38, 186368
    buffer_load_dwordx4 a[88:91], v5, s[12:15], s36 offen
    s_add_u32 s36, s38, 171008
    buffer_load_dwordx4 a[28:31], v5, s[12:15], s36 offen
    s_add_u32 s36, s38, 187392
    buffer_load_dwordx4 a[92:95], v5, s[12:15], s36 offen
    s_add_u32 s36, s38, 172032
    buffer_load_dwordx4 a[32:35], v5, s[12:15], s36 offen
    s_add_u32 s36, s38, 188416
    buffer_load_dwordx4 a[96:99], v5, s[12:15], s36 offen
    s_add_u32 s36, s38, 173056
    buffer_load_dwordx4 a[36:39], v5, s[12:15], s36 offen
    s_add_u32 s36, s38, 189440
    buffer_load_dwordx4 a[100:103], v5, s[12:15], s36 offen
    s_add_u32 s36, s38, 174080
    buffer_load_dwordx4 a[40:43], v5, s[12:15], s36 offen
    s_add_u32 s36, s38, 190464
    buffer_load_dwordx4 a[104:107], v5, s[12:15], s36 offen
    s_add_u32 s36, s38, 175104
    buffer_load_dwordx4 a[44:47], v5, s[12:15], s36 offen
    s_add_u32 s36, s38, 191488
    buffer_load_dwordx4 a[108:111], v5, s[12:15], s36 offen
    s_add_u32 s36, s38, 176128
    buffer_load_dwordx4 a[48:51], v5, s[12:15], s36 offen
    s_add_u32 s36, s38, 192512
    buffer_load_dwordx4 a[112:115], v5, s[12:15], s36 offen
    s_add_u32 s36, s38, 177152
    buffer_load_dwordx4 a[52:55], v5, s[12:15], s36 offen
    s_add_u32 s36, s38, 193536
    buffer_load_dwordx4 a[116:119], v5, s[12:15], s36 offen
    s_add_u32 s36, s38, 178176
    buffer_load_dwordx4 a[56:59], v5, s[12:15], s36 offen
    s_add_u32 s36, s38, 194560
    buffer_load_dwordx4 a[120:123], v5, s[12:15], s36 offen
    s_add_u32 s36, s38, 179200
    buffer_load_dwordx4 a[60:63], v5, s[12:15], s36 offen
    s_add_u32 s36, s38, 195584
    buffer_load_dwordx4 a[124:127], v5, s[12:15], s36 offen
    v_and_b32 v46, 31, v1
    v_mul_u32_u24 v47, 528, v46
    v_lshrrev_b32 v45, 5, v1
    v_lshl_add_u32 v47, v45, 4, v47
    s_lshl_b32 s36, s21, 7
    s_add_u32 s36, s36, 115712
    v_add_u32 v6, s36, v47
    v_lshlrev_b32 v7, 6, v45
    s_lshl_b32 s36, s21, 8
    s_add_u32 s36, s36, 14336
    buffer_load_dwordx4 v[72:75], v7, s[12:15], s36 offen offset:0
    buffer_load_dwordx4 v[76:79], v7, s[12:15], s36 offen offset:16
    buffer_load_dwordx4 v[80:83], v7, s[12:15], s36 offen offset:32
    buffer_load_dwordx4 v[84:87], v7, s[12:15], s36 offen offset:48
    buffer_load_dwordx4 v[88:91], v7, s[12:15], s36 offen offset:128
    buffer_load_dwordx4 v[92:95], v7, s[12:15], s36 offen offset:144
    buffer_load_dwordx4 v[96:99], v7, s[12:15], s36 offen offset:160
    buffer_load_dwordx4 v[100:103], v7, s[12:15], s36 offen offset:176
    s_setprio 1
    s_waitcnt vmcnt(0)
    s_barrier
    ds_read_b128 v[104:107], v5 offset:0
    ds_read_b128 v[108:111], v5 offset:1024
    ds_read_b128 v[112:115], v5 offset:2048
    s_waitcnt lgkmcnt(2)
    v_mfma_f32_32x32x16_bf16 v[8:23], a[0:3], v[104:107], v[72:87]
    ds_read_b128 v[116:119], v5 offset:3072
    v_mfma_f32_32x32x16_bf16 v[24:39], a[64:67], v[104:107], v[88:103]
    s_waitcnt lgkmcnt(2)
    v_mfma_f32_32x32x16_bf16 v[8:23], a[4:7], v[108:111], v[8:23]
    ds_read_b128 v[104:107], v5 offset:4096
    v_mfma_f32_32x32x16_bf16 v[24:39], a[68:71], v[108:111], v[24:39]
    s_waitcnt lgkmcnt(2)
    v_mfma_f32_32x32x16_bf16 v[8:23], a[8:11], v[112:115], v[8:23]
    ds_read_b128 v[108:111], v5 offset:5120
    v_mfma_f32_32x32x16_bf16 v[24:39], a[72:75], v[112:115], v[24:39]
    s_waitcnt lgkmcnt(2)
    v_mfma_f32_32x32x16_bf16 v[8:23], a[12:15], v[116:119], v[8:23]
    ds_read_b128 v[112:115], v5 offset:6144
    v_mfma_f32_32x32x16_bf16 v[24:39], a[76:79], v[116:119], v[24:39]
    s_waitcnt lgkmcnt(2)
    v_mfma_f32_32x32x16_bf16 v[8:23], a[16:19], v[104:107], v[8:23]
    ds_read_b128 v[116:119], v5 offset:7168
    v_mfma_f32_32x32x16_bf16 v[24:39], a[80:83], v[104:107], v[24:39]
    s_waitcnt lgkmcnt(2)
    v_mfma_f32_32x32x16_bf16 v[8:23], a[20:23], v[108:111], v[8:23]
    ds_read_b128 v[104:107], v5 offset:8192
    v_mfma_f32_32x32x16_bf16 v[24:39], a[84:87], v[108:111], v[24:39]
    s_waitcnt lgkmcnt(2)
    v_mfma_f32_32x32x16_bf16 v[8:23], a[24:27], v[112:115], v[8:23]
    ds_read_b128 v[108:111], v5 offset:9216
    v_mfma_f32_32x32x16_bf16 v[24:39], a[88:91], v[112:115], v[24:39]
    s_waitcnt lgkmcnt(2)
    v_mfma_f32_32x32x16_bf16 v[8:23], a[28:31], v[116:119], v[8:23]
    ds_read_b128 v[112:115], v5 offset:10240
    v_mfma_f32_32x32x16_bf16 v[24:39], a[92:95], v[116:119], v[24:39]
    s_waitcnt lgkmcnt(2)
    v_mfma_f32_32x32x16_bf16 v[8:23], a[32:35], v[104:107], v[8:23]
    ds_read_b128 v[116:119], v5 offset:11264
    v_mfma_f32_32x32x16_bf16 v[24:39], a[96:99], v[104:107], v[24:39]
    s_waitcnt lgkmcnt(2)
    v_mfma_f32_32x32x16_bf16 v[8:23], a[36:39], v[108:111], v[8:23]
    ds_read_b128 v[104:107], v5 offset:12288
    v_mfma_f32_32x32x16_bf16 v[24:39], a[100:103], v[108:111], v[24:39]
    s_waitcnt lgkmcnt(2)
    v_mfma_f32_32x32x16_bf16 v[8:23], a[40:43], v[112:115], v[8:23]
    ds_read_b128 v[108:111], v5 offset:13312
    v_mfma_f32_32x32x16_bf16 v[24:39], a[104:107], v[112:115], v[24:39]
    s_waitcnt lgkmcnt(2)
    v_mfma_f32_32x32x16_bf16 v[8:23], a[44:47], v[116:119], v[8:23]
    ds_read_b128 v[112:115], v5 offset:14336
    v_mfma_f32_32x32x16_bf16 v[24:39], a[108:111], v[116:119], v[24:39]
    s_waitcnt lgkmcnt(2)
    v_mfma_f32_32x32x16_bf16 v[8:23], a[48:51], v[104:107], v[8:23]
    ds_read_b128 v[116:119], v5 offset:15360
    v_mfma_f32_32x32x16_bf16 v[24:39], a[112:115], v[104:107], v[24:39]
    s_waitcnt lgkmcnt(2)
    v_mfma_f32_32x32x16_bf16 v[8:23], a[52:55], v[108:111], v[8:23]
    ds_read_b128 v[104:107], v5 offset:16384
    v_mfma_f32_32x32x16_bf16 v[24:39], a[116:119], v[108:111], v[24:39]
    s_waitcnt lgkmcnt(2)
    v_mfma_f32_32x32x16_bf16 v[8:23], a[56:59], v[112:115], v[8:23]
    ds_read_b128 v[108:111], v5 offset:17408
    v_mfma_f32_32x32x16_bf16 v[24:39], a[120:123], v[112:115], v[24:39]
    s_waitcnt lgkmcnt(2)
    v_mfma_f32_32x32x16_bf16 v[8:23], a[60:63], v[116:119], v[8:23]
    ds_read_b128 v[112:115], v5 offset:18432
    v_mfma_f32_32x32x16_bf16 v[24:39], a[124:127], v[116:119], v[24:39]
    s_barrier
    s_waitcnt lgkmcnt(2)
    v_mfma_f32_32x32x16_bf16 v[40:55], a[0:3], v[104:107], v[72:87]
    ds_read_b128 v[116:119], v5 offset:19456
    v_mfma_f32_32x32x16_bf16 v[56:71], a[64:67], v[104:107], v[88:103]
    s_waitcnt lgkmcnt(2)
    v_mfma_f32_32x32x16_bf16 v[40:55], a[4:7], v[108:111], v[40:55]
    ds_read_b128 v[104:107], v5 offset:20480
    v_cvt_pk_bf16_f32 v120, v8, v9
    v_mfma_f32_32x32x16_bf16 v[56:71], a[68:71], v[108:111], v[56:71]
    v_cvt_pk_bf16_f32 v121, v10, v11
    s_waitcnt lgkmcnt(2)
    v_mfma_f32_32x32x16_bf16 v[40:55], a[8:11], v[112:115], v[40:55]
    ds_read_b128 v[108:111], v5 offset:21504
    v_cvt_pk_bf16_f32 v122, v12, v13
    v_mfma_f32_32x32x16_bf16 v[56:71], a[72:75], v[112:115], v[56:71]
    v_cvt_pk_bf16_f32 v123, v14, v15
    s_waitcnt lgkmcnt(2)
    v_mfma_f32_32x32x16_bf16 v[40:55], a[12:15], v[116:119], v[40:55]
    ds_read_b128 v[112:115], v5 offset:22528
    ds_write_b128 v6, v[120:123] offset:0
    v_mfma_f32_32x32x16_bf16 v[56:71], a[76:79], v[116:119], v[56:71]
    v_cvt_pk_bf16_f32 v124, v16, v17
    s_waitcnt lgkmcnt(3)
    v_mfma_f32_32x32x16_bf16 v[40:55], a[16:19], v[104:107], v[40:55]
    ds_read_b128 v[116:119], v5 offset:23552
    v_cvt_pk_bf16_f32 v125, v18, v19
    v_mfma_f32_32x32x16_bf16 v[56:71], a[80:83], v[104:107], v[56:71]
    v_cvt_pk_bf16_f32 v126, v20, v21
    s_waitcnt lgkmcnt(3)
    v_mfma_f32_32x32x16_bf16 v[40:55], a[20:23], v[108:111], v[40:55]
    ds_read_b128 v[104:107], v5 offset:24576
    v_cvt_pk_bf16_f32 v127, v22, v23
    v_mfma_f32_32x32x16_bf16 v[56:71], a[84:87], v[108:111], v[56:71]
    ds_write_b128 v6, v[124:127] offset:32
    s_waitcnt lgkmcnt(4)
    v_mfma_f32_32x32x16_bf16 v[40:55], a[24:27], v[112:115], v[40:55]
    ds_read_b128 v[108:111], v5 offset:25600
    v_cvt_pk_bf16_f32 v120, v24, v25
    v_mfma_f32_32x32x16_bf16 v[56:71], a[88:91], v[112:115], v[56:71]
    v_cvt_pk_bf16_f32 v121, v26, v27
    s_waitcnt lgkmcnt(3)
    v_mfma_f32_32x32x16_bf16 v[40:55], a[28:31], v[116:119], v[40:55]
    ds_read_b128 v[112:115], v5 offset:26624
    v_cvt_pk_bf16_f32 v122, v28, v29
    v_mfma_f32_32x32x16_bf16 v[56:71], a[92:95], v[116:119], v[56:71]
    v_cvt_pk_bf16_f32 v123, v30, v31
    s_waitcnt lgkmcnt(3)
    v_mfma_f32_32x32x16_bf16 v[40:55], a[32:35], v[104:107], v[40:55]
    ds_read_b128 v[116:119], v5 offset:27648
    ds_write_b128 v6, v[120:123] offset:64
    v_mfma_f32_32x32x16_bf16 v[56:71], a[96:99], v[104:107], v[56:71]
    v_cvt_pk_bf16_f32 v124, v32, v33
    s_waitcnt lgkmcnt(3)
    v_mfma_f32_32x32x16_bf16 v[40:55], a[36:39], v[108:111], v[40:55]
    ds_read_b128 v[104:107], v5 offset:28672
    v_cvt_pk_bf16_f32 v125, v34, v35
    v_mfma_f32_32x32x16_bf16 v[56:71], a[100:103], v[108:111], v[56:71]
    v_cvt_pk_bf16_f32 v126, v36, v37
    s_waitcnt lgkmcnt(3)
    v_mfma_f32_32x32x16_bf16 v[40:55], a[40:43], v[112:115], v[40:55]
    ds_read_b128 v[108:111], v5 offset:29696
    v_cvt_pk_bf16_f32 v127, v38, v39
    v_mfma_f32_32x32x16_bf16 v[56:71], a[104:107], v[112:115], v[56:71]
    ds_write_b128 v6, v[124:127] offset:96
    s_waitcnt lgkmcnt(4)
    v_mfma_f32_32x32x16_bf16 v[40:55], a[44:47], v[116:119], v[40:55]
    ds_read_b128 v[112:115], v5 offset:30720
    v_mfma_f32_32x32x16_bf16 v[56:71], a[108:111], v[116:119], v[56:71]
    s_waitcnt lgkmcnt(3)
    v_mfma_f32_32x32x16_bf16 v[40:55], a[48:51], v[104:107], v[40:55]
    ds_read_b128 v[116:119], v5 offset:31744
    v_mfma_f32_32x32x16_bf16 v[56:71], a[112:115], v[104:107], v[56:71]
    s_waitcnt lgkmcnt(3)
    v_mfma_f32_32x32x16_bf16 v[40:55], a[52:55], v[108:111], v[40:55]
    ds_read_b128 v[104:107], v5 offset:32768
    v_mfma_f32_32x32x16_bf16 v[56:71], a[116:119], v[108:111], v[56:71]
    s_waitcnt lgkmcnt(2)
    v_mfma_f32_32x32x16_bf16 v[40:55], a[56:59], v[112:115], v[40:55]
    ds_read_b128 v[108:111], v5 offset:33792
    v_mfma_f32_32x32x16_bf16 v[56:71], a[120:123], v[112:115], v[56:71]
    s_waitcnt lgkmcnt(2)
    v_mfma_f32_32x32x16_bf16 v[40:55], a[60:63], v[116:119], v[40:55]
    ds_read_b128 v[112:115], v5 offset:34816
    v_mfma_f32_32x32x16_bf16 v[56:71], a[124:127], v[116:119], v[56:71]
    s_barrier
    s_waitcnt lgkmcnt(2)
    v_mfma_f32_32x32x16_bf16 v[8:23], a[0:3], v[104:107], v[72:87]
    ds_read_b128 v[116:119], v5 offset:35840
    v_mfma_f32_32x32x16_bf16 v[24:39], a[64:67], v[104:107], v[88:103]
    s_waitcnt lgkmcnt(2)
    v_mfma_f32_32x32x16_bf16 v[8:23], a[4:7], v[108:111], v[8:23]
    ds_read_b128 v[104:107], v5 offset:36864
    v_cvt_pk_bf16_f32 v120, v40, v41
    v_mfma_f32_32x32x16_bf16 v[24:39], a[68:71], v[108:111], v[24:39]
    v_cvt_pk_bf16_f32 v121, v42, v43
    s_waitcnt lgkmcnt(2)
    v_mfma_f32_32x32x16_bf16 v[8:23], a[8:11], v[112:115], v[8:23]
    ds_read_b128 v[108:111], v5 offset:37888
    v_cvt_pk_bf16_f32 v122, v44, v45
    v_mfma_f32_32x32x16_bf16 v[24:39], a[72:75], v[112:115], v[24:39]
    v_cvt_pk_bf16_f32 v123, v46, v47
    s_waitcnt lgkmcnt(2)
    v_mfma_f32_32x32x16_bf16 v[8:23], a[12:15], v[116:119], v[8:23]
    ds_read_b128 v[112:115], v5 offset:38912
    ds_write_b128 v6, v[120:123] offset:16896
    v_mfma_f32_32x32x16_bf16 v[24:39], a[76:79], v[116:119], v[24:39]
    v_cvt_pk_bf16_f32 v124, v48, v49
    s_waitcnt lgkmcnt(3)
    v_mfma_f32_32x32x16_bf16 v[8:23], a[16:19], v[104:107], v[8:23]
    ds_read_b128 v[116:119], v5 offset:39936
    v_cvt_pk_bf16_f32 v125, v50, v51
    v_mfma_f32_32x32x16_bf16 v[24:39], a[80:83], v[104:107], v[24:39]
    v_cvt_pk_bf16_f32 v126, v52, v53
    s_waitcnt lgkmcnt(3)
    v_mfma_f32_32x32x16_bf16 v[8:23], a[20:23], v[108:111], v[8:23]
    ds_read_b128 v[104:107], v5 offset:40960
    v_cvt_pk_bf16_f32 v127, v54, v55
    v_mfma_f32_32x32x16_bf16 v[24:39], a[84:87], v[108:111], v[24:39]
    ds_write_b128 v6, v[124:127] offset:16928
    s_waitcnt lgkmcnt(4)
    v_mfma_f32_32x32x16_bf16 v[8:23], a[24:27], v[112:115], v[8:23]
    ds_read_b128 v[108:111], v5 offset:41984
    v_cvt_pk_bf16_f32 v120, v56, v57
    v_mfma_f32_32x32x16_bf16 v[24:39], a[88:91], v[112:115], v[24:39]
    v_cvt_pk_bf16_f32 v121, v58, v59
    s_waitcnt lgkmcnt(3)
    v_mfma_f32_32x32x16_bf16 v[8:23], a[28:31], v[116:119], v[8:23]
    ds_read_b128 v[112:115], v5 offset:43008
    v_cvt_pk_bf16_f32 v122, v60, v61
    v_mfma_f32_32x32x16_bf16 v[24:39], a[92:95], v[116:119], v[24:39]
    v_cvt_pk_bf16_f32 v123, v62, v63
    s_waitcnt lgkmcnt(3)
    v_mfma_f32_32x32x16_bf16 v[8:23], a[32:35], v[104:107], v[8:23]
    ds_read_b128 v[116:119], v5 offset:44032
    ds_write_b128 v6, v[120:123] offset:16960
    v_mfma_f32_32x32x16_bf16 v[24:39], a[96:99], v[104:107], v[24:39]
    v_cvt_pk_bf16_f32 v124, v64, v65
    s_waitcnt lgkmcnt(3)
    v_mfma_f32_32x32x16_bf16 v[8:23], a[36:39], v[108:111], v[8:23]
    ds_read_b128 v[104:107], v5 offset:45056
    v_cvt_pk_bf16_f32 v125, v66, v67
    v_mfma_f32_32x32x16_bf16 v[24:39], a[100:103], v[108:111], v[24:39]
    v_cvt_pk_bf16_f32 v126, v68, v69
    s_waitcnt lgkmcnt(3)
    v_mfma_f32_32x32x16_bf16 v[8:23], a[40:43], v[112:115], v[8:23]
    ds_read_b128 v[108:111], v5 offset:46080
    v_cvt_pk_bf16_f32 v127, v70, v71
    v_mfma_f32_32x32x16_bf16 v[24:39], a[104:107], v[112:115], v[24:39]
    ds_write_b128 v6, v[124:127] offset:16992
    s_waitcnt lgkmcnt(4)
    v_mfma_f32_32x32x16_bf16 v[8:23], a[44:47], v[116:119], v[8:23]
    ds_read_b128 v[112:115], v5 offset:47104
    v_mfma_f32_32x32x16_bf16 v[24:39], a[108:111], v[116:119], v[24:39]
    s_waitcnt lgkmcnt(3)
    v_mfma_f32_32x32x16_bf16 v[8:23], a[48:51], v[104:107], v[8:23]
    ds_read_b128 v[116:119], v5 offset:48128
    v_mfma_f32_32x32x16_bf16 v[24:39], a[112:115], v[104:107], v[24:39]
    s_waitcnt lgkmcnt(3)
    v_mfma_f32_32x32x16_bf16 v[8:23], a[52:55], v[108:111], v[8:23]
    ds_read_b128 v[104:107], v5 offset:0
    v_mfma_f32_32x32x16_bf16 v[24:39], a[116:119], v[108:111], v[24:39]
    s_waitcnt lgkmcnt(2)
    v_mfma_f32_32x32x16_bf16 v[8:23], a[56:59], v[112:115], v[8:23]
    ds_read_b128 v[108:111], v5 offset:1024
    v_mfma_f32_32x32x16_bf16 v[24:39], a[120:123], v[112:115], v[24:39]
    s_waitcnt lgkmcnt(2)
    v_mfma_f32_32x32x16_bf16 v[8:23], a[60:63], v[116:119], v[8:23]
    ds_read_b128 v[112:115], v5 offset:2048
    v_mfma_f32_32x32x16_bf16 v[24:39], a[124:127], v[116:119], v[24:39]
    s_barrier
    s_waitcnt lgkmcnt(2)
    v_mfma_f32_32x32x16_bf16 v[40:55], a[0:3], v[104:107], v[72:87]
    ds_read_b128 v[116:119], v5 offset:3072
    v_mfma_f32_32x32x16_bf16 v[56:71], a[64:67], v[104:107], v[88:103]
    s_waitcnt lgkmcnt(2)
    v_mfma_f32_32x32x16_bf16 v[40:55], a[4:7], v[108:111], v[40:55]
    ds_read_b128 v[104:107], v5 offset:4096
    v_cvt_pk_bf16_f32 v120, v8, v9
    v_mfma_f32_32x32x16_bf16 v[56:71], a[68:71], v[108:111], v[56:71]
    v_cvt_pk_bf16_f32 v121, v10, v11
    s_waitcnt lgkmcnt(2)
    v_mfma_f32_32x32x16_bf16 v[40:55], a[8:11], v[112:115], v[40:55]
    ds_read_b128 v[108:111], v5 offset:5120
    v_cvt_pk_bf16_f32 v122, v12, v13
    v_mfma_f32_32x32x16_bf16 v[56:71], a[72:75], v[112:115], v[56:71]
    v_cvt_pk_bf16_f32 v123, v14, v15
    s_waitcnt lgkmcnt(2)
    v_mfma_f32_32x32x16_bf16 v[40:55], a[12:15], v[116:119], v[40:55]
    ds_read_b128 v[112:115], v5 offset:6144
    ds_write_b128 v6, v[120:123] offset:0
    v_mfma_f32_32x32x16_bf16 v[56:71], a[76:79], v[116:119], v[56:71]
    v_cvt_pk_bf16_f32 v124, v16, v17
    s_waitcnt lgkmcnt(3)
    v_mfma_f32_32x32x16_bf16 v[40:55], a[16:19], v[104:107], v[40:55]
    ds_read_b128 v[116:119], v5 offset:7168
    v_cvt_pk_bf16_f32 v125, v18, v19
    v_mfma_f32_32x32x16_bf16 v[56:71], a[80:83], v[104:107], v[56:71]
    v_cvt_pk_bf16_f32 v126, v20, v21
    s_waitcnt lgkmcnt(3)
    v_mfma_f32_32x32x16_bf16 v[40:55], a[20:23], v[108:111], v[40:55]
    ds_read_b128 v[104:107], v5 offset:8192
    v_cvt_pk_bf16_f32 v127, v22, v23
    v_mfma_f32_32x32x16_bf16 v[56:71], a[84:87], v[108:111], v[56:71]
    ds_write_b128 v6, v[124:127] offset:32
    s_waitcnt lgkmcnt(4)
    v_mfma_f32_32x32x16_bf16 v[40:55], a[24:27], v[112:115], v[40:55]
    ds_read_b128 v[108:111], v5 offset:9216
    v_cvt_pk_bf16_f32 v120, v24, v25
    v_mfma_f32_32x32x16_bf16 v[56:71], a[88:91], v[112:115], v[56:71]
    v_cvt_pk_bf16_f32 v121, v26, v27
    s_waitcnt lgkmcnt(3)
    v_mfma_f32_32x32x16_bf16 v[40:55], a[28:31], v[116:119], v[40:55]
    ds_read_b128 v[112:115], v5 offset:10240
    v_cvt_pk_bf16_f32 v122, v28, v29
    v_mfma_f32_32x32x16_bf16 v[56:71], a[92:95], v[116:119], v[56:71]
    v_cvt_pk_bf16_f32 v123, v30, v31
    s_waitcnt lgkmcnt(3)
    v_mfma_f32_32x32x16_bf16 v[40:55], a[32:35], v[104:107], v[40:55]
    ds_read_b128 v[116:119], v5 offset:11264
    ds_write_b128 v6, v[120:123] offset:64
    v_mfma_f32_32x32x16_bf16 v[56:71], a[96:99], v[104:107], v[56:71]
    v_cvt_pk_bf16_f32 v124, v32, v33
    s_waitcnt lgkmcnt(3)
    v_mfma_f32_32x32x16_bf16 v[40:55], a[36:39], v[108:111], v[40:55]
    ds_read_b128 v[104:107], v5 offset:12288
    v_cvt_pk_bf16_f32 v125, v34, v35
    v_mfma_f32_32x32x16_bf16 v[56:71], a[100:103], v[108:111], v[56:71]
    v_cvt_pk_bf16_f32 v126, v36, v37
    s_waitcnt lgkmcnt(3)
    v_mfma_f32_32x32x16_bf16 v[40:55], a[40:43], v[112:115], v[40:55]
    ds_read_b128 v[108:111], v5 offset:13312
    v_cvt_pk_bf16_f32 v127, v38, v39
    v_mfma_f32_32x32x16_bf16 v[56:71], a[104:107], v[112:115], v[56:71]
    ds_write_b128 v6, v[124:127] offset:96
    s_waitcnt lgkmcnt(4)
    v_mfma_f32_32x32x16_bf16 v[40:55], a[44:47], v[116:119], v[40:55]
    ds_read_b128 v[112:115], v5 offset:14336
    v_mfma_f32_32x32x16_bf16 v[56:71], a[108:111], v[116:119], v[56:71]
    s_waitcnt lgkmcnt(3)
    v_mfma_f32_32x32x16_bf16 v[40:55], a[48:51], v[104:107], v[40:55]
    ds_read_b128 v[116:119], v5 offset:15360
    v_mfma_f32_32x32x16_bf16 v[56:71], a[112:115], v[104:107], v[56:71]
    s_waitcnt lgkmcnt(3)
    v_mfma_f32_32x32x16_bf16 v[40:55], a[52:55], v[108:111], v[40:55]
    ds_read_b128 v[104:107], v5 offset:16384
    v_mfma_f32_32x32x16_bf16 v[56:71], a[116:119], v[108:111], v[56:71]
    s_waitcnt lgkmcnt(2)
    v_mfma_f32_32x32x16_bf16 v[40:55], a[56:59], v[112:115], v[40:55]
    ds_read_b128 v[108:111], v5 offset:17408
    v_mfma_f32_32x32x16_bf16 v[56:71], a[120:123], v[112:115], v[56:71]
    s_waitcnt lgkmcnt(2)
    v_mfma_f32_32x32x16_bf16 v[40:55], a[60:63], v[116:119], v[40:55]
    ds_read_b128 v[112:115], v5 offset:18432
    v_mfma_f32_32x32x16_bf16 v[56:71], a[124:127], v[116:119], v[56:71]
    s_barrier
    s_waitcnt lgkmcnt(2)
    v_mfma_f32_32x32x16_bf16 v[8:23], a[0:3], v[104:107], v[72:87]
    ds_read_b128 v[116:119], v5 offset:19456
    v_mfma_f32_32x32x16_bf16 v[24:39], a[64:67], v[104:107], v[88:103]
    s_waitcnt lgkmcnt(2)
    v_mfma_f32_32x32x16_bf16 v[8:23], a[4:7], v[108:111], v[8:23]
    ds_read_b128 v[104:107], v5 offset:20480
    v_cvt_pk_bf16_f32 v120, v40, v41
    v_mfma_f32_32x32x16_bf16 v[24:39], a[68:71], v[108:111], v[24:39]
    v_cvt_pk_bf16_f32 v121, v42, v43
    s_waitcnt lgkmcnt(2)
    v_mfma_f32_32x32x16_bf16 v[8:23], a[8:11], v[112:115], v[8:23]
    ds_read_b128 v[108:111], v5 offset:21504
    v_cvt_pk_bf16_f32 v122, v44, v45
    v_mfma_f32_32x32x16_bf16 v[24:39], a[72:75], v[112:115], v[24:39]
    v_cvt_pk_bf16_f32 v123, v46, v47
    s_waitcnt lgkmcnt(2)
    v_mfma_f32_32x32x16_bf16 v[8:23], a[12:15], v[116:119], v[8:23]
    ds_read_b128 v[112:115], v5 offset:22528
    ds_write_b128 v6, v[120:123] offset:16896
    v_mfma_f32_32x32x16_bf16 v[24:39], a[76:79], v[116:119], v[24:39]
    v_cvt_pk_bf16_f32 v124, v48, v49
    s_waitcnt lgkmcnt(3)
    v_mfma_f32_32x32x16_bf16 v[8:23], a[16:19], v[104:107], v[8:23]
    ds_read_b128 v[116:119], v5 offset:23552
    v_cvt_pk_bf16_f32 v125, v50, v51
    v_mfma_f32_32x32x16_bf16 v[24:39], a[80:83], v[104:107], v[24:39]
    v_cvt_pk_bf16_f32 v126, v52, v53
    s_waitcnt lgkmcnt(3)
    v_mfma_f32_32x32x16_bf16 v[8:23], a[20:23], v[108:111], v[8:23]
    ds_read_b128 v[104:107], v5 offset:24576
    v_cvt_pk_bf16_f32 v127, v54, v55
    v_mfma_f32_32x32x16_bf16 v[24:39], a[84:87], v[108:111], v[24:39]
    ds_write_b128 v6, v[124:127] offset:16928
    s_waitcnt lgkmcnt(4)
    v_mfma_f32_32x32x16_bf16 v[8:23], a[24:27], v[112:115], v[8:23]
    ds_read_b128 v[108:111], v5 offset:25600
    v_cvt_pk_bf16_f32 v120, v56, v57
    v_mfma_f32_32x32x16_bf16 v[24:39], a[88:91], v[112:115], v[24:39]
    v_cvt_pk_bf16_f32 v121, v58, v59
    s_waitcnt lgkmcnt(3)
    v_mfma_f32_32x32x16_bf16 v[8:23], a[28:31], v[116:119], v[8:23]
    ds_read_b128 v[112:115], v5 offset:26624
    v_cvt_pk_bf16_f32 v122, v60, v61
    v_mfma_f32_32x32x16_bf16 v[24:39], a[92:95], v[116:119], v[24:39]
    v_cvt_pk_bf16_f32 v123, v62, v63
    s_waitcnt lgkmcnt(3)
    v_mfma_f32_32x32x16_bf16 v[8:23], a[32:35], v[104:107], v[8:23]
    ds_read_b128 v[116:119], v5 offset:27648
    ds_write_b128 v6, v[120:123] offset:16960
    v_mfma_f32_32x32x16_bf16 v[24:39], a[96:99], v[104:107], v[24:39]
    v_cvt_pk_bf16_f32 v124, v64, v65
    s_waitcnt lgkmcnt(3)
    v_mfma_f32_32x32x16_bf16 v[8:23], a[36:39], v[108:111], v[8:23]
    ds_read_b128 v[104:107], v5 offset:28672
    v_cvt_pk_bf16_f32 v125, v66, v67
    v_mfma_f32_32x32x16_bf16 v[24:39], a[100:103], v[108:111], v[24:39]
    v_cvt_pk_bf16_f32 v126, v68, v69
    s_waitcnt lgkmcnt(3)
    v_mfma_f32_32x32x16_bf16 v[8:23], a[40:43], v[112:115], v[8:23]
    ds_read_b128 v[108:111], v5 offset:29696
    v_cvt_pk_bf16_f32 v127, v70, v71
    v_mfma_f32_32x32x16_bf16 v[24:39], a[104:107], v[112:115], v[24:39]
    ds_write_b128 v6, v[124:127] offset:16992
    s_waitcnt lgkmcnt(4)
    v_mfma_f32_32x32x16_bf16 v[8:23], a[44:47], v[116:119], v[8:23]
    ds_read_b128 v[112:115], v5 offset:30720
    v_mfma_f32_32x32x16_bf16 v[24:39], a[108:111], v[116:119], v[24:39]
    s_waitcnt lgkmcnt(3)
    v_mfma_f32_32x32x16_bf16 v[8:23], a[48:51], v[104:107], v[8:23]
    ds_read_b128 v[116:119], v5 offset:31744
    v_mfma_f32_32x32x16_bf16 v[24:39], a[112:115], v[104:107], v[24:39]
    s_waitcnt lgkmcnt(3)
    v_mfma_f32_32x32x16_bf16 v[8:23], a[52:55], v[108:111], v[8:23]
    ds_read_b128 v[104:107], v5 offset:32768
    v_mfma_f32_32x32x16_bf16 v[24:39], a[116:119], v[108:111], v[24:39]
    s_waitcnt lgkmcnt(2)
    v_mfma_f32_32x32x16_bf16 v[8:23], a[56:59], v[112:115], v[8:23]
    ds_read_b128 v[108:111], v5 offset:33792
    v_mfma_f32_32x32x16_bf16 v[24:39], a[120:123], v[112:115], v[24:39]
    s_waitcnt lgkmcnt(2)
    v_mfma_f32_32x32x16_bf16 v[8:23], a[60:63], v[116:119], v[8:23]
    ds_read_b128 v[112:115], v5 offset:34816
    v_mfma_f32_32x32x16_bf16 v[24:39], a[124:127], v[116:119], v[24:39]
    s_barrier
    s_waitcnt lgkmcnt(2)
    v_mfma_f32_32x32x16_bf16 v[40:55], a[0:3], v[104:107], v[72:87]
    ds_read_b128 v[116:119], v5 offset:35840
    v_mfma_f32_32x32x16_bf16 v[56:71], a[64:67], v[104:107], v[88:103]
    s_waitcnt lgkmcnt(2)
    v_mfma_f32_32x32x16_bf16 v[40:55], a[4:7], v[108:111], v[40:55]
    ds_read_b128 v[104:107], v5 offset:36864
    v_cvt_pk_bf16_f32 v120, v8, v9
    v_mfma_f32_32x32x16_bf16 v[56:71], a[68:71], v[108:111], v[56:71]
    v_cvt_pk_bf16_f32 v121, v10, v11
    s_waitcnt lgkmcnt(2)
    v_mfma_f32_32x32x16_bf16 v[40:55], a[8:11], v[112:115], v[40:55]
    ds_read_b128 v[108:111], v5 offset:37888
    v_cvt_pk_bf16_f32 v122, v12, v13
    v_mfma_f32_32x32x16_bf16 v[56:71], a[72:75], v[112:115], v[56:71]
    v_cvt_pk_bf16_f32 v123, v14, v15
    s_waitcnt lgkmcnt(2)
    v_mfma_f32_32x32x16_bf16 v[40:55], a[12:15], v[116:119], v[40:55]
    ds_read_b128 v[112:115], v5 offset:38912
    ds_write_b128 v6, v[120:123] offset:0
    v_mfma_f32_32x32x16_bf16 v[56:71], a[76:79], v[116:119], v[56:71]
    v_cvt_pk_bf16_f32 v124, v16, v17
    s_waitcnt lgkmcnt(3)
    v_mfma_f32_32x32x16_bf16 v[40:55], a[16:19], v[104:107], v[40:55]
    ds_read_b128 v[116:119], v5 offset:39936
    v_cvt_pk_bf16_f32 v125, v18, v19
    v_mfma_f32_32x32x16_bf16 v[56:71], a[80:83], v[104:107], v[56:71]
    v_cvt_pk_bf16_f32 v126, v20, v21
    s_waitcnt lgkmcnt(3)
    v_mfma_f32_32x32x16_bf16 v[40:55], a[20:23], v[108:111], v[40:55]
    ds_read_b128 v[104:107], v5 offset:40960
    v_cvt_pk_bf16_f32 v127, v22, v23
    v_mfma_f32_32x32x16_bf16 v[56:71], a[84:87], v[108:111], v[56:71]
    ds_write_b128 v6, v[124:127] offset:32
    s_waitcnt lgkmcnt(4)
    v_mfma_f32_32x32x16_bf16 v[40:55], a[24:27], v[112:115], v[40:55]
    ds_read_b128 v[108:111], v5 offset:41984
    v_cvt_pk_bf16_f32 v120, v24, v25
    v_mfma_f32_32x32x16_bf16 v[56:71], a[88:91], v[112:115], v[56:71]
    v_cvt_pk_bf16_f32 v121, v26, v27
    s_waitcnt lgkmcnt(3)
    v_mfma_f32_32x32x16_bf16 v[40:55], a[28:31], v[116:119], v[40:55]
    ds_read_b128 v[112:115], v5 offset:43008
    v_cvt_pk_bf16_f32 v122, v28, v29
    v_mfma_f32_32x32x16_bf16 v[56:71], a[92:95], v[116:119], v[56:71]
    v_cvt_pk_bf16_f32 v123, v30, v31
    s_waitcnt lgkmcnt(3)
    v_mfma_f32_32x32x16_bf16 v[40:55], a[32:35], v[104:107], v[40:55]
    ds_read_b128 v[116:119], v5 offset:44032
    ds_write_b128 v6, v[120:123] offset:64
    v_mfma_f32_32x32x16_bf16 v[56:71], a[96:99], v[104:107], v[56:71]
    v_cvt_pk_bf16_f32 v124, v32, v33
    s_waitcnt lgkmcnt(3)
    v_mfma_f32_32x32x16_bf16 v[40:55], a[36:39], v[108:111], v[40:55]
    ds_read_b128 v[104:107], v5 offset:45056
    v_cvt_pk_bf16_f32 v125, v34, v35
    v_mfma_f32_32x32x16_bf16 v[56:71], a[100:103], v[108:111], v[56:71]
    v_cvt_pk_bf16_f32 v126, v36, v37
    s_waitcnt lgkmcnt(3)
    v_mfma_f32_32x32x16_bf16 v[40:55], a[40:43], v[112:115], v[40:55]
    ds_read_b128 v[108:111], v5 offset:46080
    v_cvt_pk_bf16_f32 v127, v38, v39
    v_mfma_f32_32x32x16_bf16 v[56:71], a[104:107], v[112:115], v[56:71]
    ds_write_b128 v6, v[124:127] offset:96
    s_waitcnt lgkmcnt(4)
    v_mfma_f32_32x32x16_bf16 v[40:55], a[44:47], v[116:119], v[40:55]
    ds_read_b128 v[112:115], v5 offset:47104
    v_mfma_f32_32x32x16_bf16 v[56:71], a[108:111], v[116:119], v[56:71]
    s_waitcnt lgkmcnt(3)
    v_mfma_f32_32x32x16_bf16 v[40:55], a[48:51], v[104:107], v[40:55]
    ds_read_b128 v[116:119], v5 offset:48128
    v_mfma_f32_32x32x16_bf16 v[56:71], a[112:115], v[104:107], v[56:71]
    s_waitcnt lgkmcnt(3)
    v_mfma_f32_32x32x16_bf16 v[40:55], a[52:55], v[108:111], v[40:55]
    ds_read_b128 v[104:107], v5 offset:0
    v_mfma_f32_32x32x16_bf16 v[56:71], a[116:119], v[108:111], v[56:71]
    s_waitcnt lgkmcnt(2)
    v_mfma_f32_32x32x16_bf16 v[40:55], a[56:59], v[112:115], v[40:55]
    ds_read_b128 v[108:111], v5 offset:1024
    v_mfma_f32_32x32x16_bf16 v[56:71], a[120:123], v[112:115], v[56:71]
    s_waitcnt lgkmcnt(2)
    v_mfma_f32_32x32x16_bf16 v[40:55], a[60:63], v[116:119], v[40:55]
    ds_read_b128 v[112:115], v5 offset:2048
    v_mfma_f32_32x32x16_bf16 v[56:71], a[124:127], v[116:119], v[56:71]
    s_barrier
    s_waitcnt lgkmcnt(2)
    v_mfma_f32_32x32x16_bf16 v[8:23], a[0:3], v[104:107], v[72:87]
    ds_read_b128 v[116:119], v5 offset:3072
    v_mfma_f32_32x32x16_bf16 v[24:39], a[64:67], v[104:107], v[88:103]
    s_waitcnt lgkmcnt(2)
    v_mfma_f32_32x32x16_bf16 v[8:23], a[4:7], v[108:111], v[8:23]
    ds_read_b128 v[104:107], v5 offset:4096
    v_cvt_pk_bf16_f32 v120, v40, v41
    v_mfma_f32_32x32x16_bf16 v[24:39], a[68:71], v[108:111], v[24:39]
    v_cvt_pk_bf16_f32 v121, v42, v43
    s_waitcnt lgkmcnt(2)
    v_mfma_f32_32x32x16_bf16 v[8:23], a[8:11], v[112:115], v[8:23]
    ds_read_b128 v[108:111], v5 offset:5120
    v_cvt_pk_bf16_f32 v122, v44, v45
    v_mfma_f32_32x32x16_bf16 v[24:39], a[72:75], v[112:115], v[24:39]
    v_cvt_pk_bf16_f32 v123, v46, v47
    s_waitcnt lgkmcnt(2)
    v_mfma_f32_32x32x16_bf16 v[8:23], a[12:15], v[116:119], v[8:23]
    ds_read_b128 v[112:115], v5 offset:6144
    ds_write_b128 v6, v[120:123] offset:16896
    v_mfma_f32_32x32x16_bf16 v[24:39], a[76:79], v[116:119], v[24:39]
    v_cvt_pk_bf16_f32 v124, v48, v49
    s_waitcnt lgkmcnt(3)
    v_mfma_f32_32x32x16_bf16 v[8:23], a[16:19], v[104:107], v[8:23]
    ds_read_b128 v[116:119], v5 offset:7168
    v_cvt_pk_bf16_f32 v125, v50, v51
    v_mfma_f32_32x32x16_bf16 v[24:39], a[80:83], v[104:107], v[24:39]
    v_cvt_pk_bf16_f32 v126, v52, v53
    s_waitcnt lgkmcnt(3)
    v_mfma_f32_32x32x16_bf16 v[8:23], a[20:23], v[108:111], v[8:23]
    ds_read_b128 v[104:107], v5 offset:8192
    v_cvt_pk_bf16_f32 v127, v54, v55
    v_mfma_f32_32x32x16_bf16 v[24:39], a[84:87], v[108:111], v[24:39]
    ds_write_b128 v6, v[124:127] offset:16928
    s_waitcnt lgkmcnt(4)
    v_mfma_f32_32x32x16_bf16 v[8:23], a[24:27], v[112:115], v[8:23]
    ds_read_b128 v[108:111], v5 offset:9216
    v_cvt_pk_bf16_f32 v120, v56, v57
    v_mfma_f32_32x32x16_bf16 v[24:39], a[88:91], v[112:115], v[24:39]
    v_cvt_pk_bf16_f32 v121, v58, v59
    s_waitcnt lgkmcnt(3)
    v_mfma_f32_32x32x16_bf16 v[8:23], a[28:31], v[116:119], v[8:23]
    ds_read_b128 v[112:115], v5 offset:10240
    v_cvt_pk_bf16_f32 v122, v60, v61
    v_mfma_f32_32x32x16_bf16 v[24:39], a[92:95], v[116:119], v[24:39]
    v_cvt_pk_bf16_f32 v123, v62, v63
    s_waitcnt lgkmcnt(3)
    v_mfma_f32_32x32x16_bf16 v[8:23], a[32:35], v[104:107], v[8:23]
    ds_read_b128 v[116:119], v5 offset:11264
    ds_write_b128 v6, v[120:123] offset:16960
    v_mfma_f32_32x32x16_bf16 v[24:39], a[96:99], v[104:107], v[24:39]
    v_cvt_pk_bf16_f32 v124, v64, v65
    s_waitcnt lgkmcnt(3)
    v_mfma_f32_32x32x16_bf16 v[8:23], a[36:39], v[108:111], v[8:23]
    ds_read_b128 v[104:107], v5 offset:12288
    v_cvt_pk_bf16_f32 v125, v66, v67
    v_mfma_f32_32x32x16_bf16 v[24:39], a[100:103], v[108:111], v[24:39]
    v_cvt_pk_bf16_f32 v126, v68, v69
    s_waitcnt lgkmcnt(3)
    v_mfma_f32_32x32x16_bf16 v[8:23], a[40:43], v[112:115], v[8:23]
    ds_read_b128 v[108:111], v5 offset:13312
    v_cvt_pk_bf16_f32 v127, v70, v71
    v_mfma_f32_32x32x16_bf16 v[24:39], a[104:107], v[112:115], v[24:39]
    ds_write_b128 v6, v[124:127] offset:16992
    s_waitcnt lgkmcnt(4)
    v_mfma_f32_32x32x16_bf16 v[8:23], a[44:47], v[116:119], v[8:23]
    ds_read_b128 v[112:115], v5 offset:14336
    v_mfma_f32_32x32x16_bf16 v[24:39], a[108:111], v[116:119], v[24:39]
    s_waitcnt lgkmcnt(3)
    v_mfma_f32_32x32x16_bf16 v[8:23], a[48:51], v[104:107], v[8:23]
    ds_read_b128 v[116:119], v5 offset:15360
    v_mfma_f32_32x32x16_bf16 v[24:39], a[112:115], v[104:107], v[24:39]
    s_waitcnt lgkmcnt(3)
    v_mfma_f32_32x32x16_bf16 v[8:23], a[52:55], v[108:111], v[8:23]
    ds_read_b128 v[104:107], v5 offset:16384
    v_mfma_f32_32x32x16_bf16 v[24:39], a[116:119], v[108:111], v[24:39]
    s_waitcnt lgkmcnt(2)
    v_mfma_f32_32x32x16_bf16 v[8:23], a[56:59], v[112:115], v[8:23]
    ds_read_b128 v[108:111], v5 offset:17408
    v_mfma_f32_32x32x16_bf16 v[24:39], a[120:123], v[112:115], v[24:39]
    s_waitcnt lgkmcnt(2)
    v_mfma_f32_32x32x16_bf16 v[8:23], a[60:63], v[116:119], v[8:23]
    ds_read_b128 v[112:115], v5 offset:18432
    v_mfma_f32_32x32x16_bf16 v[24:39], a[124:127], v[116:119], v[24:39]
    s_barrier
    s_waitcnt lgkmcnt(2)
    v_mfma_f32_32x32x16_bf16 v[40:55], a[0:3], v[104:107], v[72:87]
    ds_read_b128 v[116:119], v5 offset:19456
    v_mfma_f32_32x32x16_bf16 v[56:71], a[64:67], v[104:107], v[88:103]
    s_waitcnt lgkmcnt(2)
    v_mfma_f32_32x32x16_bf16 v[40:55], a[4:7], v[108:111], v[40:55]
    ds_read_b128 v[104:107], v5 offset:20480
    v_cvt_pk_bf16_f32 v120, v8, v9
    v_mfma_f32_32x32x16_bf16 v[56:71], a[68:71], v[108:111], v[56:71]
    v_cvt_pk_bf16_f32 v121, v10, v11
    s_waitcnt lgkmcnt(2)
    v_mfma_f32_32x32x16_bf16 v[40:55], a[8:11], v[112:115], v[40:55]
    ds_read_b128 v[108:111], v5 offset:21504
    v_cvt_pk_bf16_f32 v122, v12, v13
    v_mfma_f32_32x32x16_bf16 v[56:71], a[72:75], v[112:115], v[56:71]
    v_cvt_pk_bf16_f32 v123, v14, v15
    s_waitcnt lgkmcnt(2)
    v_mfma_f32_32x32x16_bf16 v[40:55], a[12:15], v[116:119], v[40:55]
    ds_read_b128 v[112:115], v5 offset:22528
    ds_write_b128 v6, v[120:123] offset:0
    v_mfma_f32_32x32x16_bf16 v[56:71], a[76:79], v[116:119], v[56:71]
    v_cvt_pk_bf16_f32 v124, v16, v17
    s_waitcnt lgkmcnt(3)
    v_mfma_f32_32x32x16_bf16 v[40:55], a[16:19], v[104:107], v[40:55]
    ds_read_b128 v[116:119], v5 offset:23552
    v_cvt_pk_bf16_f32 v125, v18, v19
    v_mfma_f32_32x32x16_bf16 v[56:71], a[80:83], v[104:107], v[56:71]
    v_cvt_pk_bf16_f32 v126, v20, v21
    s_waitcnt lgkmcnt(3)
    v_mfma_f32_32x32x16_bf16 v[40:55], a[20:23], v[108:111], v[40:55]
    ds_read_b128 v[104:107], v5 offset:24576
    v_cvt_pk_bf16_f32 v127, v22, v23
    v_mfma_f32_32x32x16_bf16 v[56:71], a[84:87], v[108:111], v[56:71]
    ds_write_b128 v6, v[124:127] offset:32
    s_waitcnt lgkmcnt(4)
    v_mfma_f32_32x32x16_bf16 v[40:55], a[24:27], v[112:115], v[40:55]
    ds_read_b128 v[108:111], v5 offset:25600
    v_cvt_pk_bf16_f32 v120, v24, v25
    v_mfma_f32_32x32x16_bf16 v[56:71], a[88:91], v[112:115], v[56:71]
    v_cvt_pk_bf16_f32 v121, v26, v27
    s_waitcnt lgkmcnt(3)
    v_mfma_f32_32x32x16_bf16 v[40:55], a[28:31], v[116:119], v[40:55]
    ds_read_b128 v[112:115], v5 offset:26624
    v_cvt_pk_bf16_f32 v122, v28, v29
    v_mfma_f32_32x32x16_bf16 v[56:71], a[92:95], v[116:119], v[56:71]
    v_cvt_pk_bf16_f32 v123, v30, v31
    s_waitcnt lgkmcnt(3)
    v_mfma_f32_32x32x16_bf16 v[40:55], a[32:35], v[104:107], v[40:55]
    ds_read_b128 v[116:119], v5 offset:27648
    ds_write_b128 v6, v[120:123] offset:64
    v_mfma_f32_32x32x16_bf16 v[56:71], a[96:99], v[104:107], v[56:71]
    v_cvt_pk_bf16_f32 v124, v32, v33
    s_waitcnt lgkmcnt(3)
    v_mfma_f32_32x32x16_bf16 v[40:55], a[36:39], v[108:111], v[40:55]
    ds_read_b128 v[104:107], v5 offset:28672
    v_cvt_pk_bf16_f32 v125, v34, v35
    v_mfma_f32_32x32x16_bf16 v[56:71], a[100:103], v[108:111], v[56:71]
    v_cvt_pk_bf16_f32 v126, v36, v37
    s_waitcnt lgkmcnt(3)
    v_mfma_f32_32x32x16_bf16 v[40:55], a[40:43], v[112:115], v[40:55]
    ds_read_b128 v[108:111], v5 offset:29696
    v_cvt_pk_bf16_f32 v127, v38, v39
    v_mfma_f32_32x32x16_bf16 v[56:71], a[104:107], v[112:115], v[56:71]
    ds_write_b128 v6, v[124:127] offset:96
    s_waitcnt lgkmcnt(4)
    v_mfma_f32_32x32x16_bf16 v[40:55], a[44:47], v[116:119], v[40:55]
    ds_read_b128 v[112:115], v5 offset:30720
    v_mfma_f32_32x32x16_bf16 v[56:71], a[108:111], v[116:119], v[56:71]
    s_waitcnt lgkmcnt(3)
    v_mfma_f32_32x32x16_bf16 v[40:55], a[48:51], v[104:107], v[40:55]
    ds_read_b128 v[116:119], v5 offset:31744
    v_mfma_f32_32x32x16_bf16 v[56:71], a[112:115], v[104:107], v[56:71]
    s_waitcnt lgkmcnt(3)
    v_mfma_f32_32x32x16_bf16 v[40:55], a[52:55], v[108:111], v[40:55]
    v_mfma_f32_32x32x16_bf16 v[56:71], a[116:119], v[108:111], v[56:71]
    s_waitcnt lgkmcnt(1)
    v_mfma_f32_32x32x16_bf16 v[40:55], a[56:59], v[112:115], v[40:55]
    v_mfma_f32_32x32x16_bf16 v[56:71], a[120:123], v[112:115], v[56:71]
    s_waitcnt lgkmcnt(0)
    v_mfma_f32_32x32x16_bf16 v[40:55], a[60:63], v[116:119], v[40:55]
    v_mfma_f32_32x32x16_bf16 v[56:71], a[124:127], v[116:119], v[56:71]
    s_barrier
    s_nop 7
    s_nop 7
    v_cvt_pk_bf16_f32 v120, v40, v41
    v_cvt_pk_bf16_f32 v121, v42, v43
    v_cvt_pk_bf16_f32 v122, v44, v45
    v_cvt_pk_bf16_f32 v123, v46, v47
    ds_write_b128 v6, v[120:123] offset:16896
    v_cvt_pk_bf16_f32 v124, v48, v49
    v_cvt_pk_bf16_f32 v125, v50, v51
    v_cvt_pk_bf16_f32 v126, v52, v53
    v_cvt_pk_bf16_f32 v127, v54, v55
    ds_write_b128 v6, v[124:127] offset:16928
    v_cvt_pk_bf16_f32 v120, v56, v57
    v_cvt_pk_bf16_f32 v121, v58, v59
    v_cvt_pk_bf16_f32 v122, v60, v61
    v_cvt_pk_bf16_f32 v123, v62, v63
    ds_write_b128 v6, v[120:123] offset:16960
    v_cvt_pk_bf16_f32 v124, v64, v65
    v_cvt_pk_bf16_f32 v125, v66, v67
    v_cvt_pk_bf16_f32 v126, v68, v69
    v_cvt_pk_bf16_f32 v127, v70, v71
    ds_write_b128 v6, v[124:127] offset:16992
    s_waitcnt lgkmcnt(0)
    s_barrier
    s_endpgm
L_joint_kernel_helper:
    v_and_b32 v14, 7, v1
    v_lshlrev_b32 v14, 10, v14
    v_lshrrev_b32 v15, 5, v1
    v_lshl_add_u32 v14, v15, 4, v14
    s_lshl_b32 s36, s24, 13
    s_lshl_b32 s37, s21, 8
    s_add_u32 s36, s36, s37
    s_add_u32 s37, s36, 16384
    buffer_load_dwordx4 v[96:99], v14, s[12:15], s37 offen offset:0
    buffer_load_dwordx4 v[100:103], v14, s[12:15], s37 offen offset:32
    buffer_load_dwordx4 v[104:107], v14, s[12:15], s37 offen offset:64
    buffer_load_dwordx4 v[108:111], v14, s[12:15], s37 offen offset:96
    buffer_load_dwordx4 v[112:115], v14, s[12:15], s37 offen offset:128
    buffer_load_dwordx4 v[116:119], v14, s[12:15], s37 offen offset:160
    buffer_load_dwordx4 v[120:123], v14, s[12:15], s37 offen offset:192
    buffer_load_dwordx4 v[124:127], v14, s[12:15], s37 offen offset:224
    s_add_u32 s36, s38, 32768
    buffer_load_dwordx4 a[0:3], v5, s[12:15], s36 offen
    s_add_u32 s36, s38, 49152
    buffer_load_dwordx4 a[64:67], v5, s[12:15], s36 offen
    s_add_u32 s36, s38, 33792
    buffer_load_dwordx4 a[4:7], v5, s[12:15], s36 offen
    s_add_u32 s36, s38, 50176
    buffer_load_dwordx4 a[68:71], v5, s[12:15], s36 offen
    s_add_u32 s36, s38, 34816
    buffer_load_dwordx4 a[8:11], v5, s[12:15], s36 offen
    s_add_u32 s36, s38, 51200
    buffer_load_dwordx4 a[72:75], v5, s[12:15], s36 offen
    s_add_u32 s36, s38, 35840
    buffer_load_dwordx4 a[12:15], v5, s[12:15], s36 offen
    s_add_u32 s36, s38, 52224
    buffer_load_dwordx4 a[76:79], v5, s[12:15], s36 offen
    s_add_u32 s36, s38, 36864
    buffer_load_dwordx4 a[16:19], v5, s[12:15], s36 offen
    s_add_u32 s36, s38, 53248
    buffer_load_dwordx4 a[80:83], v5, s[12:15], s36 offen
    s_add_u32 s36, s38, 37888
    buffer_load_dwordx4 a[20:23], v5, s[12:15], s36 offen
    s_add_u32 s36, s38, 54272
    buffer_load_dwordx4 a[84:87], v5, s[12:15], s36 offen
    s_add_u32 s36, s38, 38912
    buffer_load_dwordx4 a[24:27], v5, s[12:15], s36 offen
    s_add_u32 s36, s38, 55296
    buffer_load_dwordx4 a[88:91], v5, s[12:15], s36 offen
    s_add_u32 s36, s38, 39936
    buffer_load_dwordx4 a[28:31], v5, s[12:15], s36 offen
    s_add_u32 s36, s38, 56320
    buffer_load_dwordx4 a[92:95], v5, s[12:15], s36 offen
    s_add_u32 s36, s38, 40960
    buffer_load_dwordx4 a[32:35], v5, s[12:15], s36 offen
    s_add_u32 s36, s38, 57344
    buffer_load_dwordx4 a[96:99], v5, s[12:15], s36 offen
    s_add_u32 s36, s38, 41984
    buffer_load_dwordx4 a[36:39], v5, s[12:15], s36 offen
    s_add_u32 s36, s38, 58368
    buffer_load_dwordx4 a[100:103], v5, s[12:15], s36 offen
    s_add_u32 s36, s38, 43008
    buffer_load_dwordx4 a[40:43], v5, s[12:15], s36 offen
    s_add_u32 s36, s38, 59392
    buffer_load_dwordx4 a[104:107], v5, s[12:15], s36 offen
    s_add_u32 s36, s38, 44032
    buffer_load_dwordx4 a[44:47], v5, s[12:15], s36 offen
    s_add_u32 s36, s38, 60416
    buffer_load_dwordx4 a[108:111], v5, s[12:15], s36 offen
    s_add_u32 s36, s38, 45056
    buffer_load_dwordx4 a[48:51], v5, s[12:15], s36 offen
    s_add_u32 s36, s38, 61440
    buffer_load_dwordx4 a[112:115], v5, s[12:15], s36 offen
    s_add_u32 s36, s38, 46080
    buffer_load_dwordx4 a[52:55], v5, s[12:15], s36 offen
    s_add_u32 s36, s38, 62464
    buffer_load_dwordx4 a[116:119], v5, s[12:15], s36 offen
    s_add_u32 s36, s38, 47104
    buffer_load_dwordx4 a[56:59], v5, s[12:15], s36 offen
    s_add_u32 s36, s38, 63488
    buffer_load_dwordx4 a[120:123], v5, s[12:15], s36 offen
    s_add_u32 s36, s38, 48128
    buffer_load_dwordx4 a[60:63], v5, s[12:15], s36 offen
    s_add_u32 s36, s38, 64512
    buffer_load_dwordx4 a[124:127], v5, s[12:15], s36 offen
    s_waitcnt vmcnt(32)
    v_max3_f32 v8, |v96|, |v97|, |v98|
    v_max3_f32 v8, v8, |v99|, |v100|
    v_max3_f32 v8, v8, |v101|, |v102|
    v_max3_f32 v8, v8, |v103|, |v104|
    v_max3_f32 v8, v8, |v105|, |v106|
    v_max3_f32 v8, v8, |v107|, |v108|
    v_max3_f32 v8, v8, |v109|, |v110|
    v_max3_f32 v8, v8, |v111|, |v112|
    v_max3_f32 v8, v8, |v113|, |v114|
    v_max3_f32 v8, v8, |v115|, |v116|
    v_max3_f32 v8, v8, |v117|, |v118|
    v_max3_f32 v8, v8, |v119|, |v120|
    v_max3_f32 v8, v8, |v121|, |v122|
    v_max3_f32 v8, v8, |v123|, |v124|
    v_max3_f32 v8, v8, |v125|, |v126|
    v_max_f32 v8, v8, |v127|
    s_mov_b32 s41, 0x42a80000
    v_cmp_lt_f32 s[42:43], s41, v8
    v_exp_f32 v96, v96
    v_exp_f32 v97, v97
    v_exp_f32 v98, v98
    v_exp_f32 v99, v99
    v_exp_f32 v100, v100
    v_exp_f32 v101, v101
    v_exp_f32 v102, v102
    v_exp_f32 v103, v103
    v_exp_f32 v104, v104
    v_exp_f32 v105, v105
    v_exp_f32 v106, v106
    v_exp_f32 v107, v107
    v_exp_f32 v108, v108
    v_exp_f32 v109, v109
    v_exp_f32 v110, v110
    v_exp_f32 v111, v111
    v_exp_f32 v112, v112
    v_exp_f32 v113, v113
    v_exp_f32 v114, v114
    v_exp_f32 v115, v115
    v_exp_f32 v116, v116
    v_exp_f32 v117, v117
    v_exp_f32 v118, v118
    v_exp_f32 v119, v119
    v_exp_f32 v120, v120
    v_exp_f32 v121, v121
    v_exp_f32 v122, v122
    v_exp_f32 v123, v123
    v_exp_f32 v124, v124
    v_exp_f32 v125, v125
    v_exp_f32 v126, v126
    v_exp_f32 v127, v127
    s_barrier
    v_add_u32 v7, 65536, v5
    ds_read_b128 v[64:67], v7 offset:0
    ds_read_b128 v[68:71], v7 offset:1024
    ds_read_b128 v[72:75], v7 offset:2048
    ds_read_b128 v[76:79], v7 offset:3072
    ds_read_b128 v[80:83], v7 offset:4096
    ds_read_b128 v[84:87], v7 offset:5120
    ds_read_b128 v[88:91], v7 offset:6144
    ds_read_b128 v[92:95], v7 offset:7168
    s_waitcnt vmcnt(30) lgkmcnt(7)
    v_mfma_f32_32x32x16_bf16 v[32:47], a[0:3], v[64:67], 0
    v_mfma_f32_32x32x16_bf16 v[48:63], a[64:67], v[64:67], 0
    s_waitcnt vmcnt(28) lgkmcnt(6)
    v_mfma_f32_32x32x16_bf16 v[32:47], a[4:7], v[68:71], v[32:47]
    v_mfma_f32_32x32x16_bf16 v[48:63], a[68:71], v[68:71], v[48:63]
    ds_read_b128 v[64:67], v7 offset:8192
    s_waitcnt vmcnt(26) lgkmcnt(6)
    v_mfma_f32_32x32x16_bf16 v[32:47], a[8:11], v[72:75], v[32:47]
    v_mfma_f32_32x32x16_bf16 v[48:63], a[72:75], v[72:75], v[48:63]
    ds_read_b128 v[68:71], v7 offset:9216
    s_waitcnt vmcnt(24) lgkmcnt(6)
    v_mfma_f32_32x32x16_bf16 v[32:47], a[12:15], v[76:79], v[32:47]
    v_mfma_f32_32x32x16_bf16 v[48:63], a[76:79], v[76:79], v[48:63]
    ds_read_b128 v[72:75], v7 offset:10240
    s_waitcnt vmcnt(22) lgkmcnt(6)
    v_mfma_f32_32x32x16_bf16 v[32:47], a[16:19], v[80:83], v[32:47]
    v_mfma_f32_32x32x16_bf16 v[48:63], a[80:83], v[80:83], v[48:63]
    ds_read_b128 v[76:79], v7 offset:11264
    s_waitcnt vmcnt(20) lgkmcnt(6)
    v_mfma_f32_32x32x16_bf16 v[32:47], a[20:23], v[84:87], v[32:47]
    v_mfma_f32_32x32x16_bf16 v[48:63], a[84:87], v[84:87], v[48:63]
    ds_read_b128 v[80:83], v7 offset:12288
    s_waitcnt vmcnt(18) lgkmcnt(6)
    v_mfma_f32_32x32x16_bf16 v[32:47], a[24:27], v[88:91], v[32:47]
    v_mfma_f32_32x32x16_bf16 v[48:63], a[88:91], v[88:91], v[48:63]
    ds_read_b128 v[84:87], v7 offset:13312
    s_waitcnt vmcnt(16) lgkmcnt(6)
    v_mfma_f32_32x32x16_bf16 v[32:47], a[28:31], v[92:95], v[32:47]
    v_mfma_f32_32x32x16_bf16 v[48:63], a[92:95], v[92:95], v[48:63]
    ds_read_b128 v[88:91], v7 offset:14336
    s_waitcnt vmcnt(14) lgkmcnt(6)
    v_mfma_f32_32x32x16_bf16 v[32:47], a[32:35], v[64:67], v[32:47]
    v_mfma_f32_32x32x16_bf16 v[48:63], a[96:99], v[64:67], v[48:63]
    ds_read_b128 v[92:95], v7 offset:15360
    s_waitcnt vmcnt(12) lgkmcnt(6)
    v_mfma_f32_32x32x16_bf16 v[32:47], a[36:39], v[68:71], v[32:47]
    v_mfma_f32_32x32x16_bf16 v[48:63], a[100:103], v[68:71], v[48:63]
    s_waitcnt vmcnt(10) lgkmcnt(5)
    v_mfma_f32_32x32x16_bf16 v[32:47], a[40:43], v[72:75], v[32:47]
    v_mfma_f32_32x32x16_bf16 v[48:63], a[104:107], v[72:75], v[48:63]
    s_waitcnt vmcnt(8) lgkmcnt(4)
    v_mfma_f32_32x32x16_bf16 v[32:47], a[44:47], v[76:79], v[32:47]
    v_mfma_f32_32x32x16_bf16 v[48:63], a[108:111], v[76:79], v[48:63]
    s_waitcnt vmcnt(6) lgkmcnt(3)
    v_mfma_f32_32x32x16_bf16 v[32:47], a[48:51], v[80:83], v[32:47]
    v_mfma_f32_32x32x16_bf16 v[48:63], a[112:115], v[80:83], v[48:63]
    s_waitcnt vmcnt(4) lgkmcnt(2)
    v_mfma_f32_32x32x16_bf16 v[32:47], a[52:55], v[84:87], v[32:47]
    v_mfma_f32_32x32x16_bf16 v[48:63], a[116:119], v[84:87], v[48:63]
    s_waitcnt vmcnt(2) lgkmcnt(1)
    v_mfma_f32_32x32x16_bf16 v[32:47], a[56:59], v[88:91], v[32:47]
    v_mfma_f32_32x32x16_bf16 v[48:63], a[120:123], v[88:91], v[48:63]
    s_waitcnt vmcnt(0) lgkmcnt(0)
    v_mfma_f32_32x32x16_bf16 v[32:47], a[60:63], v[92:95], v[32:47]
    v_mfma_f32_32x32x16_bf16 v[48:63], a[124:127], v[92:95], v[48:63]
    s_lshl_b32 s36, s21, 12
    v_add_u32 v2, s36, v5
    v_lshrrev_b32 v10, 5, v1
    v_lshlrev_b32 v11, 4, v10
    s_lshl_b32 s36, s21, 8
    s_add_u32 s36, s36, 81920
    v_add_u32 v11, s36, v11
    v_and_b32 v12, 31, v1
    v_mul_u32_u24 v13, 1056, v12
    v_add_u32 v9, v11, v13
    v_lshrrev_b32 v13, 3, v12
    v_mul_u32_u24 v13, 1056, v13
    v_add_u32 v4, v11, v13
    s_lshl_b32 s36, s21, 3
    v_add_u32 v10, s36, v10
    v_mul_u32_u24 v13, 528, v10
    v_lshl_add_u32 v13, v12, 4, v13
    v_add_u32 v6, 115712, v13
    v_lshlrev_b32 v13, 9, v10
    v_lshl_add_u32 v7, v12, 4, v13
    s_mov_b32 s41, 0x4038aa3b
    v_mul_f32 v64, s41, v32
    v_mul_f32 v65, s41, v33
    v_mul_f32 v66, s41, v34
    v_mul_f32 v67, s41, v35
    v_mul_f32 v68, s41, v36
    v_mul_f32 v69, s41, v37
    v_mul_f32 v70, s41, v38
    v_mul_f32 v71, s41, v39
    v_mul_f32 v72, s41, v40
    v_mul_f32 v73, s41, v41
    v_mul_f32 v74, s41, v42
    v_mul_f32 v75, s41, v43
    v_mul_f32 v76, s41, v44
    v_mul_f32 v77, s41, v45
    v_mul_f32 v78, s41, v46
    v_mul_f32 v79, s41, v47
    v_mul_f32 v80, s41, v48
    v_mul_f32 v81, s41, v49
    v_mul_f32 v82, s41, v50
    v_mul_f32 v83, s41, v51
    v_mul_f32 v84, s41, v52
    v_mul_f32 v85, s41, v53
    v_mul_f32 v86, s41, v54
    v_mul_f32 v87, s41, v55
    v_mul_f32 v88, s41, v56
    v_mul_f32 v89, s41, v57
    v_mul_f32 v90, s41, v58
    v_mul_f32 v91, s41, v59
    v_mul_f32 v92, s41, v60
    v_mul_f32 v93, s41, v61
    v_mul_f32 v94, s41, v62
    v_mul_f32 v95, s41, v63
    v_max3_f32 v8, |v64|, |v65|, |v66|
    v_max3_f32 v8, v8, |v67|, |v68|
    v_max3_f32 v8, v8, |v69|, |v70|
    v_max3_f32 v8, v8, |v71|, |v72|
    v_max3_f32 v8, v8, |v73|, |v74|
    v_max3_f32 v8, v8, |v75|, |v76|
    v_max3_f32 v8, v8, |v77|, |v78|
    v_max3_f32 v8, v8, |v79|, |v80|
    v_max3_f32 v8, v8, |v81|, |v82|
    v_max3_f32 v8, v8, |v83|, |v84|
    v_max3_f32 v8, v8, |v85|, |v86|
    v_max3_f32 v8, v8, |v87|, |v88|
    v_max3_f32 v8, v8, |v89|, |v90|
    v_max3_f32 v8, v8, |v91|, |v92|
    v_max3_f32 v8, v8, |v93|, |v94|
    v_max_f32 v8, v8, |v95|
    s_mov_b32 s41, 0x42200000
    v_cmp_lt_f32 vcc, s41, v8
    s_nop 3
    s_or_b64 s[42:43], s[42:43], vcc
    s_cmp_lg_u64 s[42:43], 0
    s_cselect_b32 s44, 1, 0
    s_cmp_lg_u32 s44, 0
    s_cbranch_scc1 L_joint_kernel_slow
    v_exp_f32 v32, v64
    v_exp_f32 v33, v65
    v_exp_f32 v34, v66
    v_exp_f32 v35, v67
    v_exp_f32 v36, v68
    v_exp_f32 v37, v69
    v_exp_f32 v38, v70
    v_exp_f32 v39, v71
    v_exp_f32 v40, v72
    v_exp_f32 v41, v73
    v_exp_f32 v42, v74
    v_exp_f32 v43, v75
    v_exp_f32 v44, v76
    v_exp_f32 v45, v77
    v_exp_f32 v46, v78
    v_exp_f32 v47, v79
    v_exp_f32 v48, v80
    v_exp_f32 v49, v81
    v_exp_f32 v50, v82
    v_exp_f32 v51, v83
    v_exp_f32 v52, v84
    v_exp_f32 v53, v85
    v_exp_f32 v54, v86
    v_exp_f32 v55, v87
    v_exp_f32 v56, v88
    v_exp_f32 v57, v89
    v_exp_f32 v58, v90
    v_exp_f32 v59, v91
    v_exp_f32 v60, v92
    v_exp_f32 v61, v93
    v_exp_f32 v62, v94
    v_exp_f32 v63, v95
    ds_write_b128 v9, v[32:35] offset:0
    ds_write_b128 v9, v[36:39] offset:32
    ds_write_b128 v9, v[40:43] offset:64
    ds_write_b128 v9, v[44:47] offset:96
    ds_write_b128 v9, v[48:51] offset:128
    ds_write_b128 v9, v[52:55] offset:160
    ds_write_b128 v9, v[56:59] offset:192
    ds_write_b128 v9, v[60:63] offset:224
    s_waitcnt lgkmcnt(0)
    ds_read_b128 v[32:35], v4 offset:0
    ds_read_b128 v[36:39], v4 offset:32
    ds_read_b128 v[40:43], v4 offset:64
    ds_read_b128 v[44:47], v4 offset:96
    ds_read_b128 v[48:51], v4 offset:128
    ds_read_b128 v[52:55], v4 offset:160
    ds_read_b128 v[56:59], v4 offset:192
    ds_read_b128 v[60:63], v4 offset:224
    s_waitcnt lgkmcnt(6)
    v_fma_f32 v64, v32, v96, 1.0
    v_fma_f32 v65, v33, v97, 1.0
    v_fma_f32 v66, v34, v98, 1.0
    v_fma_f32 v67, v35, v99, 1.0
    v_fma_f32 v68, v36, v100, 1.0
    v_fma_f32 v69, v37, v101, 1.0
    v_fma_f32 v70, v38, v102, 1.0
    v_fma_f32 v71, v39, v103, 1.0
    ds_read_b128 v[32:35], v4 offset:4224
    ds_read_b128 v[36:39], v4 offset:4256
    v_rcp_f32 v64, v64
    v_rcp_f32 v65, v65
    v_rcp_f32 v66, v66
    v_rcp_f32 v67, v67
    v_rcp_f32 v68, v68
    v_rcp_f32 v69, v69
    v_rcp_f32 v70, v70
    v_rcp_f32 v71, v71
    s_nop 0
    v_cvt_pk_bf16_f32 v80, v64, v65
    v_cvt_pk_bf16_f32 v81, v66, v67
    v_cvt_pk_bf16_f32 v82, v68, v69
    v_cvt_pk_bf16_f32 v83, v70, v71
    ds_write_b128 v2, v[80:83] offset:0
    s_waitcnt lgkmcnt(7)
    v_fma_f32 v72, v40, v104, 1.0
    v_fma_f32 v73, v41, v105, 1.0
    v_fma_f32 v74, v42, v106, 1.0
    v_fma_f32 v75, v43, v107, 1.0
    v_fma_f32 v76, v44, v108, 1.0
    v_fma_f32 v77, v45, v109, 1.0
    v_fma_f32 v78, v46, v110, 1.0
    v_fma_f32 v79, v47, v111, 1.0
    ds_read_b128 v[40:43], v4 offset:4288
    ds_read_b128 v[44:47], v4 offset:4320
    v_rcp_f32 v72, v72
    v_rcp_f32 v73, v73
    v_rcp_f32 v74, v74
    v_rcp_f32 v75, v75
    v_rcp_f32 v76, v76
    v_rcp_f32 v77, v77
    v_rcp_f32 v78, v78
    v_rcp_f32 v79, v79
    s_nop 0
    v_cvt_pk_bf16_f32 v84, v72, v73
    v_cvt_pk_bf16_f32 v85, v74, v75
    v_cvt_pk_bf16_f32 v86, v76, v77
    v_cvt_pk_bf16_f32 v87, v78, v79
    ds_write_b128 v2, v[84:87] offset:1024
    s_waitcnt lgkmcnt(8)
    v_fma_f32 v64, v48, v112, 1.0
    v_fma_f32 v65, v49, v113, 1.0
    v_fma_f32 v66, v50, v114, 1.0
    v_fma_f32 v67, v51, v115, 1.0
    v_fma_f32 v68, v52, v116, 1.0
    v_fma_f32 v69, v53, v117, 1.0
    v_fma_f32 v70, v54, v118, 1.0
    v_fma_f32 v71, v55, v119, 1.0
    ds_read_b128 v[48:51], v4 offset:4352
    ds_read_b128 v[52:55], v4 offset:4384
    v_rcp_f32 v64, v64
    v_rcp_f32 v65, v65
    v_rcp_f32 v66, v66
    v_rcp_f32 v67, v67
    v_rcp_f32 v68, v68
    v_rcp_f32 v69, v69
    v_rcp_f32 v70, v70
    v_rcp_f32 v71, v71
    s_nop 0
    v_cvt_pk_bf16_f32 v80, v64, v65
    v_cvt_pk_bf16_f32 v81, v66, v67
    v_cvt_pk_bf16_f32 v82, v68, v69
    v_cvt_pk_bf16_f32 v83, v70, v71
    ds_write_b128 v2, v[80:83] offset:2048
    s_waitcnt lgkmcnt(9)
    v_fma_f32 v72, v56, v120, 1.0
    v_fma_f32 v73, v57, v121, 1.0
    v_fma_f32 v74, v58, v122, 1.0
    v_fma_f32 v75, v59, v123, 1.0
    v_fma_f32 v76, v60, v124, 1.0
    v_fma_f32 v77, v61, v125, 1.0
    v_fma_f32 v78, v62, v126, 1.0
    v_fma_f32 v79, v63, v127, 1.0
    ds_read_b128 v[56:59], v4 offset:4416
    ds_read_b128 v[60:63], v4 offset:4448
    v_rcp_f32 v72, v72
    v_rcp_f32 v73, v73
    v_rcp_f32 v74, v74
    v_rcp_f32 v75, v75
    v_rcp_f32 v76, v76
    v_rcp_f32 v77, v77
    v_rcp_f32 v78, v78
    v_rcp_f32 v79, v79
    s_nop 0
    v_cvt_pk_bf16_f32 v84, v72, v73
    v_cvt_pk_bf16_f32 v85, v74, v75
    v_cvt_pk_bf16_f32 v86, v76, v77
    v_cvt_pk_bf16_f32 v87, v78, v79
    ds_write_b128 v2, v[84:87] offset:3072
    s_waitcnt lgkmcnt(10)
    v_fma_f32 v64, v32, v96, 1.0
    v_fma_f32 v65, v33, v97, 1.0
    v_fma_f32 v66, v34, v98, 1.0
    v_fma_f32 v67, v35, v99, 1.0
    v_fma_f32 v68, v36, v100, 1.0
    v_fma_f32 v69, v37, v101, 1.0
    v_fma_f32 v70, v38, v102, 1.0
    v_fma_f32 v71, v39, v103, 1.0
    ds_read_b128 v[32:35], v4 offset:8448
    ds_read_b128 v[36:39], v4 offset:8480
    v_rcp_f32 v64, v64
    v_rcp_f32 v65, v65
    v_rcp_f32 v66, v66
    v_rcp_f32 v67, v67
    v_rcp_f32 v68, v68
    v_rcp_f32 v69, v69
    v_rcp_f32 v70, v70
    v_rcp_f32 v71, v71
    s_nop 0
    v_cvt_pk_bf16_f32 v80, v64, v65
    v_cvt_pk_bf16_f32 v81, v66, v67
    v_cvt_pk_bf16_f32 v82, v68, v69
    v_cvt_pk_bf16_f32 v83, v70, v71
    ds_write_b128 v2, v[80:83] offset:16384
    s_waitcnt lgkmcnt(10)
    v_fma_f32 v72, v40, v104, 1.0
    v_fma_f32 v73, v41, v105, 1.0
    v_fma_f32 v74, v42, v106, 1.0
    v_fma_f32 v75, v43, v107, 1.0
    v_fma_f32 v76, v44, v108, 1.0
    v_fma_f32 v77, v45, v109, 1.0
    v_fma_f32 v78, v46, v110, 1.0
    v_fma_f32 v79, v47, v111, 1.0
    ds_read_b128 v[40:43], v4 offset:8512
    ds_read_b128 v[44:47], v4 offset:8544
    v_rcp_f32 v72, v72
    v_rcp_f32 v73, v73
    v_rcp_f32 v74, v74
    v_rcp_f32 v75, v75
    v_rcp_f32 v76, v76
    v_rcp_f32 v77, v77
    v_rcp_f32 v78, v78
    v_rcp_f32 v79, v79
    s_nop 0
    v_cvt_pk_bf16_f32 v84, v72, v73
    v_cvt_pk_bf16_f32 v85, v74, v75
    v_cvt_pk_bf16_f32 v86, v76, v77
    v_cvt_pk_bf16_f32 v87, v78, v79
    ds_write_b128 v2, v[84:87] offset:17408
    s_waitcnt lgkmcnt(10)
    v_fma_f32 v64, v48, v112, 1.0
    v_fma_f32 v65, v49, v113, 1.0
    v_fma_f32 v66, v50, v114, 1.0
    v_fma_f32 v67, v51, v115, 1.0
    v_fma_f32 v68, v52, v116, 1.0
    v_fma_f32 v69, v53, v117, 1.0
    v_fma_f32 v70, v54, v118, 1.0
    v_fma_f32 v71, v55, v119, 1.0
    ds_read_b128 v[48:51], v4 offset:8576
    ds_read_b128 v[52:55], v4 offset:8608
    v_rcp_f32 v64, v64
    v_rcp_f32 v65, v65
    v_rcp_f32 v66, v66
    v_rcp_f32 v67, v67
    v_rcp_f32 v68, v68
    v_rcp_f32 v69, v69
    v_rcp_f32 v70, v70
    v_rcp_f32 v71, v71
    s_nop 0
    v_cvt_pk_bf16_f32 v80, v64, v65
    v_cvt_pk_bf16_f32 v81, v66, v67
    v_cvt_pk_bf16_f32 v82, v68, v69
    v_cvt_pk_bf16_f32 v83, v70, v71
    ds_write_b128 v2, v[80:83] offset:18432
    s_waitcnt lgkmcnt(10)
    v_fma_f32 v72, v56, v120, 1.0
    v_fma_f32 v73, v57, v121, 1.0
    v_fma_f32 v74, v58, v122, 1.0
    v_fma_f32 v75, v59, v123, 1.0
    v_fma_f32 v76, v60, v124, 1.0
    v_fma_f32 v77, v61, v125, 1.0
    v_fma_f32 v78, v62, v126, 1.0
    v_fma_f32 v79, v63, v127, 1.0
    ds_read_b128 v[56:59], v4 offset:8640
    ds_read_b128 v[60:63], v4 offset:8672
    v_rcp_f32 v72, v72
    v_rcp_f32 v73, v73
    v_rcp_f32 v74, v74
    v_rcp_f32 v75, v75
    v_rcp_f32 v76, v76
    v_rcp_f32 v77, v77
    v_rcp_f32 v78, v78
    v_rcp_f32 v79, v79
    s_nop 0
    v_cvt_pk_bf16_f32 v84, v72, v73
    v_cvt_pk_bf16_f32 v85, v74, v75
    v_cvt_pk_bf16_f32 v86, v76, v77
    v_cvt_pk_bf16_f32 v87, v78, v79
    ds_write_b128 v2, v[84:87] offset:19456
    s_waitcnt lgkmcnt(0)
    s_barrier
    v_fma_f32 v64, v32, v96, 1.0
    v_fma_f32 v65, v33, v97, 1.0
    v_fma_f32 v66, v34, v98, 1.0
    v_fma_f32 v67, v35, v99, 1.0
    v_fma_f32 v68, v36, v100, 1.0
    v_fma_f32 v69, v37, v101, 1.0
    v_fma_f32 v70, v38, v102, 1.0
    v_fma_f32 v71, v39, v103, 1.0
    ds_read_b128 v[32:35], v4 offset:12672
    ds_read_b128 v[36:39], v4 offset:12704
    v_rcp_f32 v64, v64
    v_rcp_f32 v65, v65
    v_rcp_f32 v66, v66
    v_rcp_f32 v67, v67
    v_rcp_f32 v68, v68
    v_rcp_f32 v69, v69
    v_rcp_f32 v70, v70
    v_rcp_f32 v71, v71
    s_nop 0
    v_cvt_pk_bf16_f32 v80, v64, v65
    v_cvt_pk_bf16_f32 v81, v66, v67
    v_cvt_pk_bf16_f32 v82, v68, v69
    v_cvt_pk_bf16_f32 v83, v70, v71
    ds_write_b128 v2, v[80:83] offset:32768
    v_fma_f32 v72, v40, v104, 1.0
    v_fma_f32 v73, v41, v105, 1.0
    v_fma_f32 v74, v42, v106, 1.0
    v_fma_f32 v75, v43, v107, 1.0
    v_fma_f32 v76, v44, v108, 1.0
    v_fma_f32 v77, v45, v109, 1.0
    v_fma_f32 v78, v46, v110, 1.0
    v_fma_f32 v79, v47, v111, 1.0
    ds_read_b128 v[40:43], v4 offset:12736
    ds_read_b128 v[44:47], v4 offset:12768
    v_rcp_f32 v72, v72
    v_rcp_f32 v73, v73
    v_rcp_f32 v74, v74
    v_rcp_f32 v75, v75
    v_rcp_f32 v76, v76
    v_rcp_f32 v77, v77
    v_rcp_f32 v78, v78
    v_rcp_f32 v79, v79
    s_nop 0
    v_cvt_pk_bf16_f32 v84, v72, v73
    v_cvt_pk_bf16_f32 v85, v74, v75
    v_cvt_pk_bf16_f32 v86, v76, v77
    v_cvt_pk_bf16_f32 v87, v78, v79
    ds_write_b128 v2, v[84:87] offset:33792
    v_fma_f32 v64, v48, v112, 1.0
    v_fma_f32 v65, v49, v113, 1.0
    v_fma_f32 v66, v50, v114, 1.0
    v_fma_f32 v67, v51, v115, 1.0
    v_fma_f32 v68, v52, v116, 1.0
    v_fma_f32 v69, v53, v117, 1.0
    v_fma_f32 v70, v54, v118, 1.0
    v_fma_f32 v71, v55, v119, 1.0
    ds_read_b128 v[48:51], v4 offset:12800
    ds_read_b128 v[52:55], v4 offset:12832
    v_rcp_f32 v64, v64
    v_rcp_f32 v65, v65
    v_rcp_f32 v66, v66
    v_rcp_f32 v67, v67
    v_rcp_f32 v68, v68
    v_rcp_f32 v69, v69
    v_rcp_f32 v70, v70
    v_rcp_f32 v71, v71
    s_nop 0
    v_cvt_pk_bf16_f32 v80, v64, v65
    v_cvt_pk_bf16_f32 v81, v66, v67
    v_cvt_pk_bf16_f32 v82, v68, v69
    v_cvt_pk_bf16_f32 v83, v70, v71
    ds_write_b128 v2, v[80:83] offset:34816
    v_fma_f32 v72, v56, v120, 1.0
    v_fma_f32 v73, v57, v121, 1.0
    v_fma_f32 v74, v58, v122, 1.0
    v_fma_f32 v75, v59, v123, 1.0
    v_fma_f32 v76, v60, v124, 1.0
    v_fma_f32 v77, v61, v125, 1.0
    v_fma_f32 v78, v62, v126, 1.0
    v_fma_f32 v79, v63, v127, 1.0
    ds_read_b128 v[56:59], v4 offset:12864
    ds_read_b128 v[60:63], v4 offset:12896
    v_rcp_f32 v72, v72
    v_rcp_f32 v73, v73
    v_rcp_f32 v74, v74
    v_rcp_f32 v75, v75
    v_rcp_f32 v76, v76
    v_rcp_f32 v77, v77
    v_rcp_f32 v78, v78
    v_rcp_f32 v79, v79
    s_nop 0
    v_cvt_pk_bf16_f32 v84, v72, v73
    v_cvt_pk_bf16_f32 v85, v74, v75
    v_cvt_pk_bf16_f32 v86, v76, v77
    v_cvt_pk_bf16_f32 v87, v78, v79
    ds_write_b128 v2, v[84:87] offset:35840
    s_waitcnt lgkmcnt(0)
    s_barrier
    v_fma_f32 v64, v32, v96, 1.0
    v_fma_f32 v65, v33, v97, 1.0
    v_fma_f32 v66, v34, v98, 1.0
    v_fma_f32 v67, v35, v99, 1.0
    v_fma_f32 v68, v36, v100, 1.0
    v_fma_f32 v69, v37, v101, 1.0
    v_fma_f32 v70, v38, v102, 1.0
    v_fma_f32 v71, v39, v103, 1.0
    ds_read_b128 v[32:35], v4 offset:16896
    ds_read_b128 v[36:39], v4 offset:16928
    v_rcp_f32 v64, v64
    v_rcp_f32 v65, v65
    v_rcp_f32 v66, v66
    v_rcp_f32 v67, v67
    v_rcp_f32 v68, v68
    v_rcp_f32 v69, v69
    v_rcp_f32 v70, v70
    v_rcp_f32 v71, v71
    s_nop 0
    v_cvt_pk_bf16_f32 v80, v64, v65
    v_cvt_pk_bf16_f32 v81, v66, v67
    v_cvt_pk_bf16_f32 v82, v68, v69
    v_cvt_pk_bf16_f32 v83, v70, v71
    ds_write_b128 v2, v[80:83] offset:0
    v_fma_f32 v72, v40, v104, 1.0
    v_fma_f32 v73, v41, v105, 1.0
    v_fma_f32 v74, v42, v106, 1.0
    v_fma_f32 v75, v43, v107, 1.0
    v_fma_f32 v76, v44, v108, 1.0
    v_fma_f32 v77, v45, v109, 1.0
    v_fma_f32 v78, v46, v110, 1.0
    v_fma_f32 v79, v47, v111, 1.0
    ds_read_b128 v[40:43], v4 offset:16960
    ds_read_b128 v[44:47], v4 offset:16992
    v_rcp_f32 v72, v72
    v_rcp_f32 v73, v73
    v_rcp_f32 v74, v74
    v_rcp_f32 v75, v75
    v_rcp_f32 v76, v76
    v_rcp_f32 v77, v77
    v_rcp_f32 v78, v78
    v_rcp_f32 v79, v79
    s_nop 0
    v_cvt_pk_bf16_f32 v84, v72, v73
    v_cvt_pk_bf16_f32 v85, v74, v75
    v_cvt_pk_bf16_f32 v86, v76, v77
    v_cvt_pk_bf16_f32 v87, v78, v79
    ds_write_b128 v2, v[84:87] offset:1024
    v_fma_f32 v64, v48, v112, 1.0
    v_fma_f32 v65, v49, v113, 1.0
    v_fma_f32 v66, v50, v114, 1.0
    v_fma_f32 v67, v51, v115, 1.0
    v_fma_f32 v68, v52, v116, 1.0
    v_fma_f32 v69, v53, v117, 1.0
    v_fma_f32 v70, v54, v118, 1.0
    v_fma_f32 v71, v55, v119, 1.0
    ds_read_b128 v[48:51], v4 offset:17024
    ds_read_b128 v[52:55], v4 offset:17056
    v_rcp_f32 v64, v64
    v_rcp_f32 v65, v65
    v_rcp_f32 v66, v66
    v_rcp_f32 v67, v67
    v_rcp_f32 v68, v68
    v_rcp_f32 v69, v69
    v_rcp_f32 v70, v70
    v_rcp_f32 v71, v71
    s_nop 0
    v_cvt_pk_bf16_f32 v80, v64, v65
    v_cvt_pk_bf16_f32 v81, v66, v67
    v_cvt_pk_bf16_f32 v82, v68, v69
    v_cvt_pk_bf16_f32 v83, v70, v71
    ds_write_b128 v2, v[80:83] offset:2048
    v_fma_f32 v72, v56, v120, 1.0
    v_fma_f32 v73, v57, v121, 1.0
    v_fma_f32 v74, v58, v122, 1.0
    v_fma_f32 v75, v59, v123, 1.0
    v_fma_f32 v76, v60, v124, 1.0
    v_fma_f32 v77, v61, v125, 1.0
    v_fma_f32 v78, v62, v126, 1.0
    v_fma_f32 v79, v63, v127, 1.0
    ds_read_b128 v[56:59], v4 offset:17088
    ds_read_b128 v[60:63], v4 offset:17120
    v_rcp_f32 v72, v72
    v_rcp_f32 v73, v73
    v_rcp_f32 v74, v74
    v_rcp_f32 v75, v75
    v_rcp_f32 v76, v76
    v_rcp_f32 v77, v77
    v_rcp_f32 v78, v78
    v_rcp_f32 v79, v79
    s_nop 0
    v_cvt_pk_bf16_f32 v84, v72, v73
    v_cvt_pk_bf16_f32 v85, v74, v75
    v_cvt_pk_bf16_f32 v86, v76, v77
    v_cvt_pk_bf16_f32 v87, v78, v79
    ds_write_b128 v2, v[84:87] offset:3072
    s_waitcnt lgkmcnt(0)
    s_barrier
    ds_read_b128 a[0:3], v6 offset:0
    ds_read_b128 a[4:7], v6 offset:1056
    ds_read_b128 a[8:11], v6 offset:2112
    ds_read_b128 a[12:15], v6 offset:3168
    v_fma_f32 v64, v32, v96, 1.0
    v_fma_f32 v65, v33, v97, 1.0
    v_fma_f32 v66, v34, v98, 1.0
    v_fma_f32 v67, v35, v99, 1.0
    v_fma_f32 v68, v36, v100, 1.0
    v_fma_f32 v69, v37, v101, 1.0
    v_fma_f32 v70, v38, v102, 1.0
    v_fma_f32 v71, v39, v103, 1.0
    ds_read_b128 v[32:35], v4 offset:21120
    ds_read_b128 v[36:39], v4 offset:21152
    v_rcp_f32 v64, v64
    v_rcp_f32 v65, v65
    v_rcp_f32 v66, v66
    v_rcp_f32 v67, v67
    v_rcp_f32 v68, v68
    v_rcp_f32 v69, v69
    v_rcp_f32 v70, v70
    v_rcp_f32 v71, v71
    s_waitcnt lgkmcnt(5)
    s_mov_b32 s36, 0
    buffer_store_dwordx4 a[0:3], v7, s[16:19], s36 offen sc1
    s_waitcnt lgkmcnt(4)
    s_mov_b32 s36, 1024
    buffer_store_dwordx4 a[4:7], v7, s[16:19], s36 offen sc1
    v_cvt_pk_bf16_f32 v80, v64, v65
    v_cvt_pk_bf16_f32 v81, v66, v67
    v_cvt_pk_bf16_f32 v82, v68, v69
    v_cvt_pk_bf16_f32 v83, v70, v71
    ds_write_b128 v2, v[80:83] offset:16384
    v_fma_f32 v72, v40, v104, 1.0
    v_fma_f32 v73, v41, v105, 1.0
    v_fma_f32 v74, v42, v106, 1.0
    v_fma_f32 v75, v43, v107, 1.0
    v_fma_f32 v76, v44, v108, 1.0
    v_fma_f32 v77, v45, v109, 1.0
    v_fma_f32 v78, v46, v110, 1.0
    v_fma_f32 v79, v47, v111, 1.0
    ds_read_b128 v[40:43], v4 offset:21184
    ds_read_b128 v[44:47], v4 offset:21216
    v_rcp_f32 v72, v72
    v_rcp_f32 v73, v73
    v_rcp_f32 v74, v74
    v_rcp_f32 v75, v75
    v_rcp_f32 v76, v76
    v_rcp_f32 v77, v77
    v_rcp_f32 v78, v78
    v_rcp_f32 v79, v79
    s_waitcnt lgkmcnt(6)
    s_mov_b32 s36, 2048
    buffer_store_dwordx4 a[8:11], v7, s[16:19], s36 offen sc1
    s_waitcnt lgkmcnt(5)
    s_mov_b32 s36, 3072
    buffer_store_dwordx4 a[12:15], v7, s[16:19], s36 offen sc1
    v_cvt_pk_bf16_f32 v84, v72, v73
    v_cvt_pk_bf16_f32 v85, v74, v75
    v_cvt_pk_bf16_f32 v86, v76, v77
    v_cvt_pk_bf16_f32 v87, v78, v79
    ds_write_b128 v2, v[84:87] offset:17408
    v_fma_f32 v64, v48, v112, 1.0
    v_fma_f32 v65, v49, v113, 1.0
    v_fma_f32 v66, v50, v114, 1.0
    v_fma_f32 v67, v51, v115, 1.0
    v_fma_f32 v68, v52, v116, 1.0
    v_fma_f32 v69, v53, v117, 1.0
    v_fma_f32 v70, v54, v118, 1.0
    v_fma_f32 v71, v55, v119, 1.0
    ds_read_b128 v[48:51], v4 offset:21248
    ds_read_b128 v[52:55], v4 offset:21280
    v_rcp_f32 v64, v64
    v_rcp_f32 v65, v65
    v_rcp_f32 v66, v66
    v_rcp_f32 v67, v67
    v_rcp_f32 v68, v68
    v_rcp_f32 v69, v69
    v_rcp_f32 v70, v70
    v_rcp_f32 v71, v71
    s_nop 0
    v_cvt_pk_bf16_f32 v80, v64, v65
    v_cvt_pk_bf16_f32 v81, v66, v67
    v_cvt_pk_bf16_f32 v82, v68, v69
    v_cvt_pk_bf16_f32 v83, v70, v71
    ds_write_b128 v2, v[80:83] offset:18432
    v_fma_f32 v72, v56, v120, 1.0
    v_fma_f32 v73, v57, v121, 1.0
    v_fma_f32 v74, v58, v122, 1.0
    v_fma_f32 v75, v59, v123, 1.0
    v_fma_f32 v76, v60, v124, 1.0
    v_fma_f32 v77, v61, v125, 1.0
    v_fma_f32 v78, v62, v126, 1.0
    v_fma_f32 v79, v63, v127, 1.0
    ds_read_b128 v[56:59], v4 offset:21312
    ds_read_b128 v[60:63], v4 offset:21344
    v_rcp_f32 v72, v72
    v_rcp_f32 v73, v73
    v_rcp_f32 v74, v74
    v_rcp_f32 v75, v75
    v_rcp_f32 v76, v76
    v_rcp_f32 v77, v77
    v_rcp_f32 v78, v78
    v_rcp_f32 v79, v79
    s_nop 0
    v_cvt_pk_bf16_f32 v84, v72, v73
    v_cvt_pk_bf16_f32 v85, v74, v75
    v_cvt_pk_bf16_f32 v86, v76, v77
    v_cvt_pk_bf16_f32 v87, v78, v79
    ds_write_b128 v2, v[84:87] offset:19456
    s_waitcnt lgkmcnt(0)
    s_barrier
    ds_read_b128 a[0:3], v6 offset:16896
    ds_read_b128 a[4:7], v6 offset:17952
    ds_read_b128 a[8:11], v6 offset:19008
    ds_read_b128 a[12:15], v6 offset:20064
    v_fma_f32 v64, v32, v96, 1.0
    v_fma_f32 v65, v33, v97, 1.0
    v_fma_f32 v66, v34, v98, 1.0
    v_fma_f32 v67, v35, v99, 1.0
    v_fma_f32 v68, v36, v100, 1.0
    v_fma_f32 v69, v37, v101, 1.0
    v_fma_f32 v70, v38, v102, 1.0
    v_fma_f32 v71, v39, v103, 1.0
    ds_read_b128 v[32:35], v4 offset:25344
    ds_read_b128 v[36:39], v4 offset:25376
    v_rcp_f32 v64, v64
    v_rcp_f32 v65, v65
    v_rcp_f32 v66, v66
    v_rcp_f32 v67, v67
    v_rcp_f32 v68, v68
    v_rcp_f32 v69, v69
    v_rcp_f32 v70, v70
    v_rcp_f32 v71, v71
    s_waitcnt lgkmcnt(5)
    s_mov_b32 s36, 16384
    buffer_store_dwordx4 a[0:3], v7, s[16:19], s36 offen sc1
    s_waitcnt lgkmcnt(4)
    s_mov_b32 s36, 17408
    buffer_store_dwordx4 a[4:7], v7, s[16:19], s36 offen sc1
    v_cvt_pk_bf16_f32 v80, v64, v65
    v_cvt_pk_bf16_f32 v81, v66, v67
    v_cvt_pk_bf16_f32 v82, v68, v69
    v_cvt_pk_bf16_f32 v83, v70, v71
    ds_write_b128 v2, v[80:83] offset:32768
    v_fma_f32 v72, v40, v104, 1.0
    v_fma_f32 v73, v41, v105, 1.0
    v_fma_f32 v74, v42, v106, 1.0
    v_fma_f32 v75, v43, v107, 1.0
    v_fma_f32 v76, v44, v108, 1.0
    v_fma_f32 v77, v45, v109, 1.0
    v_fma_f32 v78, v46, v110, 1.0
    v_fma_f32 v79, v47, v111, 1.0
    ds_read_b128 v[40:43], v4 offset:25408
    ds_read_b128 v[44:47], v4 offset:25440
    v_rcp_f32 v72, v72
    v_rcp_f32 v73, v73
    v_rcp_f32 v74, v74
    v_rcp_f32 v75, v75
    v_rcp_f32 v76, v76
    v_rcp_f32 v77, v77
    v_rcp_f32 v78, v78
    v_rcp_f32 v79, v79
    s_waitcnt lgkmcnt(6)
    s_mov_b32 s36, 18432
    buffer_store_dwordx4 a[8:11], v7, s[16:19], s36 offen sc1
    s_waitcnt lgkmcnt(5)
    s_mov_b32 s36, 19456
    buffer_store_dwordx4 a[12:15], v7, s[16:19], s36 offen sc1
    v_cvt_pk_bf16_f32 v84, v72, v73
    v_cvt_pk_bf16_f32 v85, v74, v75
    v_cvt_pk_bf16_f32 v86, v76, v77
    v_cvt_pk_bf16_f32 v87, v78, v79
    ds_write_b128 v2, v[84:87] offset:33792
    v_fma_f32 v64, v48, v112, 1.0
    v_fma_f32 v65, v49, v113, 1.0
    v_fma_f32 v66, v50, v114, 1.0
    v_fma_f32 v67, v51, v115, 1.0
    v_fma_f32 v68, v52, v116, 1.0
    v_fma_f32 v69, v53, v117, 1.0
    v_fma_f32 v70, v54, v118, 1.0
    v_fma_f32 v71, v55, v119, 1.0
    ds_read_b128 v[48:51], v4 offset:25472
    ds_read_b128 v[52:55], v4 offset:25504
    v_rcp_f32 v64, v64
    v_rcp_f32 v65, v65
    v_rcp_f32 v66, v66
    v_rcp_f32 v67, v67
    v_rcp_f32 v68, v68
    v_rcp_f32 v69, v69
    v_rcp_f32 v70, v70
    v_rcp_f32 v71, v71
    s_nop 0
    v_cvt_pk_bf16_f32 v80, v64, v65
    v_cvt_pk_bf16_f32 v81, v66, v67
    v_cvt_pk_bf16_f32 v82, v68, v69
    v_cvt_pk_bf16_f32 v83, v70, v71
    ds_write_b128 v2, v[80:83] offset:34816
    v_fma_f32 v72, v56, v120, 1.0
    v_fma_f32 v73, v57, v121, 1.0
    v_fma_f32 v74, v58, v122, 1.0
    v_fma_f32 v75, v59, v123, 1.0
    v_fma_f32 v76, v60, v124, 1.0
    v_fma_f32 v77, v61, v125, 1.0
    v_fma_f32 v78, v62, v126, 1.0
    v_fma_f32 v79, v63, v127, 1.0
    ds_read_b128 v[56:59], v4 offset:25536
    ds_read_b128 v[60:63], v4 offset:25568
    v_rcp_f32 v72, v72
    v_rcp_f32 v73, v73
    v_rcp_f32 v74, v74
    v_rcp_f32 v75, v75
    v_rcp_f32 v76, v76
    v_rcp_f32 v77, v77
    v_rcp_f32 v78, v78
    v_rcp_f32 v79, v79
    s_nop 0
    v_cvt_pk_bf16_f32 v84, v72, v73
    v_cvt_pk_bf16_f32 v85, v74, v75
    v_cvt_pk_bf16_f32 v86, v76, v77
    v_cvt_pk_bf16_f32 v87, v78, v79
    ds_write_b128 v2, v[84:87] offset:35840
    s_waitcnt lgkmcnt(0)
    s_barrier
    ds_read_b128 a[0:3], v6 offset:0
    ds_read_b128 a[4:7], v6 offset:1056
    ds_read_b128 a[8:11], v6 offset:2112
    ds_read_b128 a[12:15], v6 offset:3168
    v_fma_f32 v64, v32, v96, 1.0
    v_fma_f32 v65, v33, v97, 1.0
    v_fma_f32 v66, v34, v98, 1.0
    v_fma_f32 v67, v35, v99, 1.0
    v_fma_f32 v68, v36, v100, 1.0
    v_fma_f32 v69, v37, v101, 1.0
    v_fma_f32 v70, v38, v102, 1.0
    v_fma_f32 v71, v39, v103, 1.0
    ds_read_b128 v[32:35], v4 offset:29568
    ds_read_b128 v[36:39], v4 offset:29600
    v_rcp_f32 v64, v64
    v_rcp_f32 v65, v65
    v_rcp_f32 v66, v66
    v_rcp_f32 v67, v67
    v_rcp_f32 v68, v68
    v_rcp_f32 v69, v69
    v_rcp_f32 v70, v70
    v_rcp_f32 v71, v71
    s_waitcnt lgkmcnt(5)
    s_mov_b32 s36, 32768
    buffer_store_dwordx4 a[0:3], v7, s[16:19], s36 offen sc1
    s_waitcnt lgkmcnt(4)
    s_mov_b32 s36, 33792
    buffer_store_dwordx4 a[4:7], v7, s[16:19], s36 offen sc1
    v_cvt_pk_bf16_f32 v80, v64, v65
    v_cvt_pk_bf16_f32 v81, v66, v67
    v_cvt_pk_bf16_f32 v82, v68, v69
    v_cvt_pk_bf16_f32 v83, v70, v71
    ds_write_b128 v2, v[80:83] offset:0
    v_fma_f32 v72, v40, v104, 1.0
    v_fma_f32 v73, v41, v105, 1.0
    v_fma_f32 v74, v42, v106, 1.0
    v_fma_f32 v75, v43, v107, 1.0
    v_fma_f32 v76, v44, v108, 1.0
    v_fma_f32 v77, v45, v109, 1.0
    v_fma_f32 v78, v46, v110, 1.0
    v_fma_f32 v79, v47, v111, 1.0
    ds_read_b128 v[40:43], v4 offset:29632
    ds_read_b128 v[44:47], v4 offset:29664
    v_rcp_f32 v72, v72
    v_rcp_f32 v73, v73
    v_rcp_f32 v74, v74
    v_rcp_f32 v75, v75
    v_rcp_f32 v76, v76
    v_rcp_f32 v77, v77
    v_rcp_f32 v78, v78
    v_rcp_f32 v79, v79
    s_waitcnt lgkmcnt(6)
    s_mov_b32 s36, 34816
    buffer_store_dwordx4 a[8:11], v7, s[16:19], s36 offen sc1
    s_waitcnt lgkmcnt(5)
    s_mov_b32 s36, 35840
    buffer_store_dwordx4 a[12:15], v7, s[16:19], s36 offen sc1
    v_cvt_pk_bf16_f32 v84, v72, v73
    v_cvt_pk_bf16_f32 v85, v74, v75
    v_cvt_pk_bf16_f32 v86, v76, v77
    v_cvt_pk_bf16_f32 v87, v78, v79
    ds_write_b128 v2, v[84:87] offset:1024
    v_fma_f32 v64, v48, v112, 1.0
    v_fma_f32 v65, v49, v113, 1.0
    v_fma_f32 v66, v50, v114, 1.0
    v_fma_f32 v67, v51, v115, 1.0
    v_fma_f32 v68, v52, v116, 1.0
    v_fma_f32 v69, v53, v117, 1.0
    v_fma_f32 v70, v54, v118, 1.0
    v_fma_f32 v71, v55, v119, 1.0
    ds_read_b128 v[48:51], v4 offset:29696
    ds_read_b128 v[52:55], v4 offset:29728
    v_rcp_f32 v64, v64
    v_rcp_f32 v65, v65
    v_rcp_f32 v66, v66
    v_rcp_f32 v67, v67
    v_rcp_f32 v68, v68
    v_rcp_f32 v69, v69
    v_rcp_f32 v70, v70
    v_rcp_f32 v71, v71
    s_nop 0
    v_cvt_pk_bf16_f32 v80, v64, v65
    v_cvt_pk_bf16_f32 v81, v66, v67
    v_cvt_pk_bf16_f32 v82, v68, v69
    v_cvt_pk_bf16_f32 v83, v70, v71
    ds_write_b128 v2, v[80:83] offset:2048
    v_fma_f32 v72, v56, v120, 1.0
    v_fma_f32 v73, v57, v121, 1.0
    v_fma_f32 v74, v58, v122, 1.0
    v_fma_f32 v75, v59, v123, 1.0
    v_fma_f32 v76, v60, v124, 1.0
    v_fma_f32 v77, v61, v125, 1.0
    v_fma_f32 v78, v62, v126, 1.0
    v_fma_f32 v79, v63, v127, 1.0
    ds_read_b128 v[56:59], v4 offset:29760
    ds_read_b128 v[60:63], v4 offset:29792
    v_rcp_f32 v72, v72
    v_rcp_f32 v73, v73
    v_rcp_f32 v74, v74
    v_rcp_f32 v75, v75
    v_rcp_f32 v76, v76
    v_rcp_f32 v77, v77
    v_rcp_f32 v78, v78
    v_rcp_f32 v79, v79
    s_nop 0
    v_cvt_pk_bf16_f32 v84, v72, v73
    v_cvt_pk_bf16_f32 v85, v74, v75
    v_cvt_pk_bf16_f32 v86, v76, v77
    v_cvt_pk_bf16_f32 v87, v78, v79
    ds_write_b128 v2, v[84:87] offset:3072
    s_waitcnt lgkmcnt(0)
    s_barrier
    ds_read_b128 a[0:3], v6 offset:16896
    ds_read_b128 a[4:7], v6 offset:17952
    ds_read_b128 a[8:11], v6 offset:19008
    ds_read_b128 a[12:15], v6 offset:20064
    v_fma_f32 v64, v32, v96, 1.0
    v_fma_f32 v65, v33, v97, 1.0
    v_fma_f32 v66, v34, v98, 1.0
    v_fma_f32 v67, v35, v99, 1.0
    v_fma_f32 v68, v36, v100, 1.0
    v_fma_f32 v69, v37, v101, 1.0
    v_fma_f32 v70, v38, v102, 1.0
    v_fma_f32 v71, v39, v103, 1.0
    v_rcp_f32 v64, v64
    v_rcp_f32 v65, v65
    v_rcp_f32 v66, v66
    v_rcp_f32 v67, v67
    v_rcp_f32 v68, v68
    v_rcp_f32 v69, v69
    v_rcp_f32 v70, v70
    v_rcp_f32 v71, v71
    s_waitcnt lgkmcnt(3)
    s_mov_b32 s36, 49152
    buffer_store_dwordx4 a[0:3], v7, s[16:19], s36 offen sc1
    s_waitcnt lgkmcnt(2)
    s_mov_b32 s36, 50176
    buffer_store_dwordx4 a[4:7], v7, s[16:19], s36 offen sc1
    v_cvt_pk_bf16_f32 v80, v64, v65
    v_cvt_pk_bf16_f32 v81, v66, v67
    v_cvt_pk_bf16_f32 v82, v68, v69
    v_cvt_pk_bf16_f32 v83, v70, v71
    ds_write_b128 v2, v[80:83] offset:16384
    v_fma_f32 v72, v40, v104, 1.0
    v_fma_f32 v73, v41, v105, 1.0
    v_fma_f32 v74, v42, v106, 1.0
    v_fma_f32 v75, v43, v107, 1.0
    v_fma_f32 v76, v44, v108, 1.0
    v_fma_f32 v77, v45, v109, 1.0
    v_fma_f32 v78, v46, v110, 1.0
    v_fma_f32 v79, v47, v111, 1.0
    v_rcp_f32 v72, v72
    v_rcp_f32 v73, v73
    v_rcp_f32 v74, v74
    v_rcp_f32 v75, v75
    v_rcp_f32 v76, v76
    v_rcp_f32 v77, v77
    v_rcp_f32 v78, v78
    v_rcp_f32 v79, v79
    s_waitcnt lgkmcnt(2)
    s_mov_b32 s36, 51200
    buffer_store_dwordx4 a[8:11], v7, s[16:19], s36 offen sc1
    s_waitcnt lgkmcnt(1)
    s_mov_b32 s36, 52224
    buffer_store_dwordx4 a[12:15], v7, s[16:19], s36 offen sc1
    v_cvt_pk_bf16_f32 v84, v72, v73
    v_cvt_pk_bf16_f32 v85, v74, v75
    v_cvt_pk_bf16_f32 v86, v76, v77
    v_cvt_pk_bf16_f32 v87, v78, v79
    ds_write_b128 v2, v[84:87] offset:17408
    v_fma_f32 v64, v48, v112, 1.0
    v_fma_f32 v65, v49, v113, 1.0
    v_fma_f32 v66, v50, v114, 1.0
    v_fma_f32 v67, v51, v115, 1.0
    v_fma_f32 v68, v52, v116, 1.0
    v_fma_f32 v69, v53, v117, 1.0
    v_fma_f32 v70, v54, v118, 1.0
    v_fma_f32 v71, v55, v119, 1.0
    v_rcp_f32 v64, v64
    v_rcp_f32 v65, v65
    v_rcp_f32 v66, v66
    v_rcp_f32 v67, v67
    v_rcp_f32 v68, v68
    v_rcp_f32 v69, v69
    v_rcp_f32 v70, v70
    v_rcp_f32 v71, v71
    s_nop 0
    v_cvt_pk_bf16_f32 v80, v64, v65
    v_cvt_pk_bf16_f32 v81, v66, v67
    v_cvt_pk_bf16_f32 v82, v68, v69
    v_cvt_pk_bf16_f32 v83, v70, v71
    ds_write_b128 v2, v[80:83] offset:18432
    v_fma_f32 v72, v56, v120, 1.0
    v_fma_f32 v73, v57, v121, 1.0
    v_fma_f32 v74, v58, v122, 1.0
    v_fma_f32 v75, v59, v123, 1.0
    v_fma_f32 v76, v60, v124, 1.0
    v_fma_f32 v77, v61, v125, 1.0
    v_fma_f32 v78, v62, v126, 1.0
    v_fma_f32 v79, v63, v127, 1.0
    v_rcp_f32 v72, v72
    v_rcp_f32 v73, v73
    v_rcp_f32 v74, v74
    v_rcp_f32 v75, v75
    v_rcp_f32 v76, v76
    v_rcp_f32 v77, v77
    v_rcp_f32 v78, v78
    v_rcp_f32 v79, v79
    s_nop 0
    v_cvt_pk_bf16_f32 v84, v72, v73
    v_cvt_pk_bf16_f32 v85, v74, v75
    v_cvt_pk_bf16_f32 v86, v76, v77
    v_cvt_pk_bf16_f32 v87, v78, v79
    ds_write_b128 v2, v[84:87] offset:19456
    s_waitcnt lgkmcnt(0)
    s_barrier
    ds_read_b128 a[0:3], v6 offset:0
    ds_read_b128 a[4:7], v6 offset:1056
    ds_read_b128 a[8:11], v6 offset:2112
    ds_read_b128 a[12:15], v6 offset:3168
    s_waitcnt lgkmcnt(3)
    s_mov_b32 s36, 65536
    buffer_store_dwordx4 a[0:3], v7, s[16:19], s36 offen sc1
    s_waitcnt lgkmcnt(2)
    s_mov_b32 s36, 66560
    buffer_store_dwordx4 a[4:7], v7, s[16:19], s36 offen sc1
    s_waitcnt lgkmcnt(1)
    s_mov_b32 s36, 67584
    buffer_store_dwordx4 a[8:11], v7, s[16:19], s36 offen sc1
    s_waitcnt lgkmcnt(0)
    s_mov_b32 s36, 68608
    buffer_store_dwordx4 a[12:15], v7, s[16:19], s36 offen sc1
    s_barrier
    ds_read_b128 a[0:3], v6 offset:16896
    ds_read_b128 a[4:7], v6 offset:17952
    ds_read_b128 a[8:11], v6 offset:19008
    ds_read_b128 a[12:15], v6 offset:20064
    s_waitcnt lgkmcnt(3)
    s_mov_b32 s36, 81920
    buffer_store_dwordx4 a[0:3], v7, s[16:19], s36 offen sc1
    s_waitcnt lgkmcnt(2)
    s_mov_b32 s36, 82944
    buffer_store_dwordx4 a[4:7], v7, s[16:19], s36 offen sc1
    s_waitcnt lgkmcnt(1)
    s_mov_b32 s36, 83968
    buffer_store_dwordx4 a[8:11], v7, s[16:19], s36 offen sc1
    s_waitcnt lgkmcnt(0)
    s_mov_b32 s36, 84992
    buffer_store_dwordx4 a[12:15], v7, s[16:19], s36 offen sc1
    s_barrier
    ds_read_b128 a[0:3], v6 offset:0
    ds_read_b128 a[4:7], v6 offset:1056
    ds_read_b128 a[8:11], v6 offset:2112
    ds_read_b128 a[12:15], v6 offset:3168
    s_waitcnt lgkmcnt(3)
    s_mov_b32 s36, 98304
    buffer_store_dwordx4 a[0:3], v7, s[16:19], s36 offen sc1
    s_waitcnt lgkmcnt(2)
    s_mov_b32 s36, 99328
    buffer_store_dwordx4 a[4:7], v7, s[16:19], s36 offen sc1
    s_waitcnt lgkmcnt(1)
    s_mov_b32 s36, 100352
    buffer_store_dwordx4 a[8:11], v7, s[16:19], s36 offen sc1
    s_waitcnt lgkmcnt(0)
    s_mov_b32 s36, 101376
    buffer_store_dwordx4 a[12:15], v7, s[16:19], s36 offen sc1
    s_barrier
    ds_read_b128 a[0:3], v6 offset:16896
    ds_read_b128 a[4:7], v6 offset:17952
    ds_read_b128 a[8:11], v6 offset:19008
    ds_read_b128 a[12:15], v6 offset:20064
    s_waitcnt lgkmcnt(3)
    s_mov_b32 s36, 114688
    buffer_store_dwordx4 a[0:3], v7, s[16:19], s36 offen sc1
    s_waitcnt lgkmcnt(2)
    s_mov_b32 s36, 115712
    buffer_store_dwordx4 a[4:7], v7, s[16:19], s36 offen sc1
    s_waitcnt lgkmcnt(1)
    s_mov_b32 s36, 116736
    buffer_store_dwordx4 a[8:11], v7, s[16:19], s36 offen sc1
    s_waitcnt lgkmcnt(0)
    s_mov_b32 s36, 117760
    buffer_store_dwordx4 a[12:15], v7, s[16:19], s36 offen sc1
    s_endpgm
L_joint_kernel_slow:
    buffer_load_dwordx4 v[96:99], v14, s[12:15], s37 offen offset:0
    buffer_load_dwordx4 v[100:103], v14, s[12:15], s37 offen offset:32
    buffer_load_dwordx4 v[104:107], v14, s[12:15], s37 offen offset:64
    buffer_load_dwordx4 v[108:111], v14, s[12:15], s37 offen offset:96
    buffer_load_dwordx4 v[112:115], v14, s[12:15], s37 offen offset:128
    buffer_load_dwordx4 v[116:119], v14, s[12:15], s37 offen offset:160
    buffer_load_dwordx4 v[120:123], v14, s[12:15], s37 offen offset:192
    buffer_load_dwordx4 v[124:127], v14, s[12:15], s37 offen offset:224
    s_waitcnt vmcnt(0)
    ds_write_b128 v9, v[64:67] offset:0
    ds_write_b128 v9, v[68:71] offset:32
    ds_write_b128 v9, v[72:75] offset:64
    ds_write_b128 v9, v[76:79] offset:96
    ds_write_b128 v9, v[80:83] offset:128
    ds_write_b128 v9, v[84:87] offset:160
    ds_write_b128 v9, v[88:91] offset:192
    ds_write_b128 v9, v[92:95] offset:224
    s_waitcnt lgkmcnt(0)
    ds_read_b128 v[32:35], v4 offset:0
    ds_read_b128 v[36:39], v4 offset:32
    ds_read_b128 v[40:43], v4 offset:64
    ds_read_b128 v[44:47], v4 offset:96
    ds_read_b128 v[48:51], v4 offset:128
    ds_read_b128 v[52:55], v4 offset:160
    ds_read_b128 v[56:59], v4 offset:192
    ds_read_b128 v[60:63], v4 offset:224
    s_waitcnt lgkmcnt(6)
    v_add_f32 v64, v32, v96
    v_add_f32 v65, v33, v97
    v_add_f32 v66, v34, v98
    v_add_f32 v67, v35, v99
    v_add_f32 v68, v36, v100
    v_add_f32 v69, v37, v101
    v_add_f32 v70, v38, v102
    v_add_f32 v71, v39, v103
    ds_read_b128 v[32:35], v4 offset:4224
    ds_read_b128 v[36:39], v4 offset:4256
    v_exp_f32 v64, v64
    v_exp_f32 v65, v65
    v_exp_f32 v66, v66
    v_exp_f32 v67, v67
    v_exp_f32 v68, v68
    v_exp_f32 v69, v69
    v_exp_f32 v70, v70
    v_exp_f32 v71, v71
    v_add_f32 v64, 1.0, v64
    v_add_f32 v65, 1.0, v65
    v_add_f32 v66, 1.0, v66
    v_add_f32 v67, 1.0, v67
    v_add_f32 v68, 1.0, v68
    v_add_f32 v69, 1.0, v69
    v_add_f32 v70, 1.0, v70
    v_add_f32 v71, 1.0, v71
    v_rcp_f32 v64, v64
    v_rcp_f32 v65, v65
    v_rcp_f32 v66, v66
    v_rcp_f32 v67, v67
    v_rcp_f32 v68, v68
    v_rcp_f32 v69, v69
    v_rcp_f32 v70, v70
    v_rcp_f32 v71, v71
    s_nop 0
    v_cvt_pk_bf16_f32 v80, v64, v65
    v_cvt_pk_bf16_f32 v81, v66, v67
    v_cvt_pk_bf16_f32 v82, v68, v69
    v_cvt_pk_bf16_f32 v83, v70, v71
    ds_write_b128 v2, v[80:83] offset:0
    s_waitcnt lgkmcnt(7)
    v_add_f32 v72, v40, v104
    v_add_f32 v73, v41, v105
    v_add_f32 v74, v42, v106
    v_add_f32 v75, v43, v107
    v_add_f32 v76, v44, v108
    v_add_f32 v77, v45, v109
    v_add_f32 v78, v46, v110
    v_add_f32 v79, v47, v111
    ds_read_b128 v[40:43], v4 offset:4288
    ds_read_b128 v[44:47], v4 offset:4320
    v_exp_f32 v72, v72
    v_exp_f32 v73, v73
    v_exp_f32 v74, v74
    v_exp_f32 v75, v75
    v_exp_f32 v76, v76
    v_exp_f32 v77, v77
    v_exp_f32 v78, v78
    v_exp_f32 v79, v79
    v_add_f32 v72, 1.0, v72
    v_add_f32 v73, 1.0, v73
    v_add_f32 v74, 1.0, v74
    v_add_f32 v75, 1.0, v75
    v_add_f32 v76, 1.0, v76
    v_add_f32 v77, 1.0, v77
    v_add_f32 v78, 1.0, v78
    v_add_f32 v79, 1.0, v79
    v_rcp_f32 v72, v72
    v_rcp_f32 v73, v73
    v_rcp_f32 v74, v74
    v_rcp_f32 v75, v75
    v_rcp_f32 v76, v76
    v_rcp_f32 v77, v77
    v_rcp_f32 v78, v78
    v_rcp_f32 v79, v79
    s_nop 0
    v_cvt_pk_bf16_f32 v84, v72, v73
    v_cvt_pk_bf16_f32 v85, v74, v75
    v_cvt_pk_bf16_f32 v86, v76, v77
    v_cvt_pk_bf16_f32 v87, v78, v79
    ds_write_b128 v2, v[84:87] offset:1024
    s_waitcnt lgkmcnt(8)
    v_add_f32 v64, v48, v112
    v_add_f32 v65, v49, v113
    v_add_f32 v66, v50, v114
    v_add_f32 v67, v51, v115
    v_add_f32 v68, v52, v116
    v_add_f32 v69, v53, v117
    v_add_f32 v70, v54, v118
    v_add_f32 v71, v55, v119
    ds_read_b128 v[48:51], v4 offset:4352
    ds_read_b128 v[52:55], v4 offset:4384
    v_exp_f32 v64, v64
    v_exp_f32 v65, v65
    v_exp_f32 v66, v66
    v_exp_f32 v67, v67
    v_exp_f32 v68, v68
    v_exp_f32 v69, v69
    v_exp_f32 v70, v70
    v_exp_f32 v71, v71
    v_add_f32 v64, 1.0, v64
    v_add_f32 v65, 1.0, v65
    v_add_f32 v66, 1.0, v66
    v_add_f32 v67, 1.0, v67
    v_add_f32 v68, 1.0, v68
    v_add_f32 v69, 1.0, v69
    v_add_f32 v70, 1.0, v70
    v_add_f32 v71, 1.0, v71
    v_rcp_f32 v64, v64
    v_rcp_f32 v65, v65
    v_rcp_f32 v66, v66
    v_rcp_f32 v67, v67
    v_rcp_f32 v68, v68
    v_rcp_f32 v69, v69
    v_rcp_f32 v70, v70
    v_rcp_f32 v71, v71
    s_nop 0
    v_cvt_pk_bf16_f32 v80, v64, v65
    v_cvt_pk_bf16_f32 v81, v66, v67
    v_cvt_pk_bf16_f32 v82, v68, v69
    v_cvt_pk_bf16_f32 v83, v70, v71
    ds_write_b128 v2, v[80:83] offset:2048
    s_waitcnt lgkmcnt(9)
    v_add_f32 v72, v56, v120
    v_add_f32 v73, v57, v121
    v_add_f32 v74, v58, v122
    v_add_f32 v75, v59, v123
    v_add_f32 v76, v60, v124
    v_add_f32 v77, v61, v125
    v_add_f32 v78, v62, v126
    v_add_f32 v79, v63, v127
    ds_read_b128 v[56:59], v4 offset:4416
    ds_read_b128 v[60:63], v4 offset:4448
    v_exp_f32 v72, v72
    v_exp_f32 v73, v73
    v_exp_f32 v74, v74
    v_exp_f32 v75, v75
    v_exp_f32 v76, v76
    v_exp_f32 v77, v77
    v_exp_f32 v78, v78
    v_exp_f32 v79, v79
    v_add_f32 v72, 1.0, v72
    v_add_f32 v73, 1.0, v73
    v_add_f32 v74, 1.0, v74
    v_add_f32 v75, 1.0, v75
    v_add_f32 v76, 1.0, v76
    v_add_f32 v77, 1.0, v77
    v_add_f32 v78, 1.0, v78
    v_add_f32 v79, 1.0, v79
    v_rcp_f32 v72, v72
    v_rcp_f32 v73, v73
    v_rcp_f32 v74, v74
    v_rcp_f32 v75, v75
    v_rcp_f32 v76, v76
    v_rcp_f32 v77, v77
    v_rcp_f32 v78, v78
    v_rcp_f32 v79, v79
    s_nop 0
    v_cvt_pk_bf16_f32 v84, v72, v73
    v_cvt_pk_bf16_f32 v85, v74, v75
    v_cvt_pk_bf16_f32 v86, v76, v77
    v_cvt_pk_bf16_f32 v87, v78, v79
    ds_write_b128 v2, v[84:87] offset:3072
    s_waitcnt lgkmcnt(10)
    v_add_f32 v64, v32, v96
    v_add_f32 v65, v33, v97
    v_add_f32 v66, v34, v98
    v_add_f32 v67, v35, v99
    v_add_f32 v68, v36, v100
    v_add_f32 v69, v37, v101
    v_add_f32 v70, v38, v102
    v_add_f32 v71, v39, v103
    ds_read_b128 v[32:35], v4 offset:8448
    ds_read_b128 v[36:39], v4 offset:8480
    v_exp_f32 v64, v64
    v_exp_f32 v65, v65
    v_exp_f32 v66, v66
    v_exp_f32 v67, v67
    v_exp_f32 v68, v68
    v_exp_f32 v69, v69
    v_exp_f32 v70, v70
    v_exp_f32 v71, v71
    v_add_f32 v64, 1.0, v64
    v_add_f32 v65, 1.0, v65
    v_add_f32 v66, 1.0, v66
    v_add_f32 v67, 1.0, v67
    v_add_f32 v68, 1.0, v68
    v_add_f32 v69, 1.0, v69
    v_add_f32 v70, 1.0, v70
    v_add_f32 v71, 1.0, v71
    v_rcp_f32 v64, v64
    v_rcp_f32 v65, v65
    v_rcp_f32 v66, v66
    v_rcp_f32 v67, v67
    v_rcp_f32 v68, v68
    v_rcp_f32 v69, v69
    v_rcp_f32 v70, v70
    v_rcp_f32 v71, v71
    s_nop 0
    v_cvt_pk_bf16_f32 v80, v64, v65
    v_cvt_pk_bf16_f32 v81, v66, v67
    v_cvt_pk_bf16_f32 v82, v68, v69
    v_cvt_pk_bf16_f32 v83, v70, v71
    ds_write_b128 v2, v[80:83] offset:16384
    s_waitcnt lgkmcnt(10)
    v_add_f32 v72, v40, v104
    v_add_f32 v73, v41, v105
    v_add_f32 v74, v42, v106
    v_add_f32 v75, v43, v107
    v_add_f32 v76, v44, v108
    v_add_f32 v77, v45, v109
    v_add_f32 v78, v46, v110
    v_add_f32 v79, v47, v111
    ds_read_b128 v[40:43], v4 offset:8512
    ds_read_b128 v[44:47], v4 offset:8544
    v_exp_f32 v72, v72
    v_exp_f32 v73, v73
    v_exp_f32 v74, v74
    v_exp_f32 v75, v75
    v_exp_f32 v76, v76
    v_exp_f32 v77, v77
    v_exp_f32 v78, v78
    v_exp_f32 v79, v79
    v_add_f32 v72, 1.0, v72
    v_add_f32 v73, 1.0, v73
    v_add_f32 v74, 1.0, v74
    v_add_f32 v75, 1.0, v75
    v_add_f32 v76, 1.0, v76
    v_add_f32 v77, 1.0, v77
    v_add_f32 v78, 1.0, v78
    v_add_f32 v79, 1.0, v79
    v_rcp_f32 v72, v72
    v_rcp_f32 v73, v73
    v_rcp_f32 v74, v74
    v_rcp_f32 v75, v75
    v_rcp_f32 v76, v76
    v_rcp_f32 v77, v77
    v_rcp_f32 v78, v78
    v_rcp_f32 v79, v79
    s_nop 0
    v_cvt_pk_bf16_f32 v84, v72, v73
    v_cvt_pk_bf16_f32 v85, v74, v75
    v_cvt_pk_bf16_f32 v86, v76, v77
    v_cvt_pk_bf16_f32 v87, v78, v79
    ds_write_b128 v2, v[84:87] offset:17408
    s_waitcnt lgkmcnt(10)
    v_add_f32 v64, v48, v112
    v_add_f32 v65, v49, v113
    v_add_f32 v66, v50, v114
    v_add_f32 v67, v51, v115
    v_add_f32 v68, v52, v116
    v_add_f32 v69, v53, v117
    v_add_f32 v70, v54, v118
    v_add_f32 v71, v55, v119
    ds_read_b128 v[48:51], v4 offset:8576
    ds_read_b128 v[52:55], v4 offset:8608
    v_exp_f32 v64, v64
    v_exp_f32 v65, v65
    v_exp_f32 v66, v66
    v_exp_f32 v67, v67
    v_exp_f32 v68, v68
    v_exp_f32 v69, v69
    v_exp_f32 v70, v70
    v_exp_f32 v71, v71
    v_add_f32 v64, 1.0, v64
    v_add_f32 v65, 1.0, v65
    v_add_f32 v66, 1.0, v66
    v_add_f32 v67, 1.0, v67
    v_add_f32 v68, 1.0, v68
    v_add_f32 v69, 1.0, v69
    v_add_f32 v70, 1.0, v70
    v_add_f32 v71, 1.0, v71
    v_rcp_f32 v64, v64
    v_rcp_f32 v65, v65
    v_rcp_f32 v66, v66
    v_rcp_f32 v67, v67
    v_rcp_f32 v68, v68
    v_rcp_f32 v69, v69
    v_rcp_f32 v70, v70
    v_rcp_f32 v71, v71
    s_nop 0
    v_cvt_pk_bf16_f32 v80, v64, v65
    v_cvt_pk_bf16_f32 v81, v66, v67
    v_cvt_pk_bf16_f32 v82, v68, v69
    v_cvt_pk_bf16_f32 v83, v70, v71
    ds_write_b128 v2, v[80:83] offset:18432
    s_waitcnt lgkmcnt(10)
    v_add_f32 v72, v56, v120
    v_add_f32 v73, v57, v121
    v_add_f32 v74, v58, v122
    v_add_f32 v75, v59, v123
    v_add_f32 v76, v60, v124
    v_add_f32 v77, v61, v125
    v_add_f32 v78, v62, v126
    v_add_f32 v79, v63, v127
    ds_read_b128 v[56:59], v4 offset:8640
    ds_read_b128 v[60:63], v4 offset:8672
    v_exp_f32 v72, v72
    v_exp_f32 v73, v73
    v_exp_f32 v74, v74
    v_exp_f32 v75, v75
    v_exp_f32 v76, v76
    v_exp_f32 v77, v77
    v_exp_f32 v78, v78
    v_exp_f32 v79, v79
    v_add_f32 v72, 1.0, v72
    v_add_f32 v73, 1.0, v73
    v_add_f32 v74, 1.0, v74
    v_add_f32 v75, 1.0, v75
    v_add_f32 v76, 1.0, v76
    v_add_f32 v77, 1.0, v77
    v_add_f32 v78, 1.0, v78
    v_add_f32 v79, 1.0, v79
    v_rcp_f32 v72, v72
    v_rcp_f32 v73, v73
    v_rcp_f32 v74, v74
    v_rcp_f32 v75, v75
    v_rcp_f32 v76, v76
    v_rcp_f32 v77, v77
    v_rcp_f32 v78, v78
    v_rcp_f32 v79, v79
    s_nop 0
    v_cvt_pk_bf16_f32 v84, v72, v73
    v_cvt_pk_bf16_f32 v85, v74, v75
    v_cvt_pk_bf16_f32 v86, v76, v77
    v_cvt_pk_bf16_f32 v87, v78, v79
    ds_write_b128 v2, v[84:87] offset:19456
    s_waitcnt lgkmcnt(0)
    s_barrier
    v_add_f32 v64, v32, v96
    v_add_f32 v65, v33, v97
    v_add_f32 v66, v34, v98
    v_add_f32 v67, v35, v99
    v_add_f32 v68, v36, v100
    v_add_f32 v69, v37, v101
    v_add_f32 v70, v38, v102
    v_add_f32 v71, v39, v103
    ds_read_b128 v[32:35], v4 offset:12672
    ds_read_b128 v[36:39], v4 offset:12704
    v_exp_f32 v64, v64
    v_exp_f32 v65, v65
    v_exp_f32 v66, v66
    v_exp_f32 v67, v67
    v_exp_f32 v68, v68
    v_exp_f32 v69, v69
    v_exp_f32 v70, v70
    v_exp_f32 v71, v71
    v_add_f32 v64, 1.0, v64
    v_add_f32 v65, 1.0, v65
    v_add_f32 v66, 1.0, v66
    v_add_f32 v67, 1.0, v67
    v_add_f32 v68, 1.0, v68
    v_add_f32 v69, 1.0, v69
    v_add_f32 v70, 1.0, v70
    v_add_f32 v71, 1.0, v71
    v_rcp_f32 v64, v64
    v_rcp_f32 v65, v65
    v_rcp_f32 v66, v66
    v_rcp_f32 v67, v67
    v_rcp_f32 v68, v68
    v_rcp_f32 v69, v69
    v_rcp_f32 v70, v70
    v_rcp_f32 v71, v71
    s_nop 0
    v_cvt_pk_bf16_f32 v80, v64, v65
    v_cvt_pk_bf16_f32 v81, v66, v67
    v_cvt_pk_bf16_f32 v82, v68, v69
    v_cvt_pk_bf16_f32 v83, v70, v71
    ds_write_b128 v2, v[80:83] offset:32768
    v_add_f32 v72, v40, v104
    v_add_f32 v73, v41, v105
    v_add_f32 v74, v42, v106
    v_add_f32 v75, v43, v107
    v_add_f32 v76, v44, v108
    v_add_f32 v77, v45, v109
    v_add_f32 v78, v46, v110
    v_add_f32 v79, v47, v111
    ds_read_b128 v[40:43], v4 offset:12736
    ds_read_b128 v[44:47], v4 offset:12768
    v_exp_f32 v72, v72
    v_exp_f32 v73, v73
    v_exp_f32 v74, v74
    v_exp_f32 v75, v75
    v_exp_f32 v76, v76
    v_exp_f32 v77, v77
    v_exp_f32 v78, v78
    v_exp_f32 v79, v79
    v_add_f32 v72, 1.0, v72
    v_add_f32 v73, 1.0, v73
    v_add_f32 v74, 1.0, v74
    v_add_f32 v75, 1.0, v75
    v_add_f32 v76, 1.0, v76
    v_add_f32 v77, 1.0, v77
    v_add_f32 v78, 1.0, v78
    v_add_f32 v79, 1.0, v79
    v_rcp_f32 v72, v72
    v_rcp_f32 v73, v73
    v_rcp_f32 v74, v74
    v_rcp_f32 v75, v75
    v_rcp_f32 v76, v76
    v_rcp_f32 v77, v77
    v_rcp_f32 v78, v78
    v_rcp_f32 v79, v79
    s_nop 0
    v_cvt_pk_bf16_f32 v84, v72, v73
    v_cvt_pk_bf16_f32 v85, v74, v75
    v_cvt_pk_bf16_f32 v86, v76, v77
    v_cvt_pk_bf16_f32 v87, v78, v79
    ds_write_b128 v2, v[84:87] offset:33792
    v_add_f32 v64, v48, v112
    v_add_f32 v65, v49, v113
    v_add_f32 v66, v50, v114
    v_add_f32 v67, v51, v115
    v_add_f32 v68, v52, v116
    v_add_f32 v69, v53, v117
    v_add_f32 v70, v54, v118
    v_add_f32 v71, v55, v119
    ds_read_b128 v[48:51], v4 offset:12800
    ds_read_b128 v[52:55], v4 offset:12832
    v_exp_f32 v64, v64
    v_exp_f32 v65, v65
    v_exp_f32 v66, v66
    v_exp_f32 v67, v67
    v_exp_f32 v68, v68
    v_exp_f32 v69, v69
    v_exp_f32 v70, v70
    v_exp_f32 v71, v71
    v_add_f32 v64, 1.0, v64
    v_add_f32 v65, 1.0, v65
    v_add_f32 v66, 1.0, v66
    v_add_f32 v67, 1.0, v67
    v_add_f32 v68, 1.0, v68
    v_add_f32 v69, 1.0, v69
    v_add_f32 v70, 1.0, v70
    v_add_f32 v71, 1.0, v71
    v_rcp_f32 v64, v64
    v_rcp_f32 v65, v65
    v_rcp_f32 v66, v66
    v_rcp_f32 v67, v67
    v_rcp_f32 v68, v68
    v_rcp_f32 v69, v69
    v_rcp_f32 v70, v70
    v_rcp_f32 v71, v71
    s_nop 0
    v_cvt_pk_bf16_f32 v80, v64, v65
    v_cvt_pk_bf16_f32 v81, v66, v67
    v_cvt_pk_bf16_f32 v82, v68, v69
    v_cvt_pk_bf16_f32 v83, v70, v71
    ds_write_b128 v2, v[80:83] offset:34816
    v_add_f32 v72, v56, v120
    v_add_f32 v73, v57, v121
    v_add_f32 v74, v58, v122
    v_add_f32 v75, v59, v123
    v_add_f32 v76, v60, v124
    v_add_f32 v77, v61, v125
    v_add_f32 v78, v62, v126
    v_add_f32 v79, v63, v127
    ds_read_b128 v[56:59], v4 offset:12864
    ds_read_b128 v[60:63], v4 offset:12896
    v_exp_f32 v72, v72
    v_exp_f32 v73, v73
    v_exp_f32 v74, v74
    v_exp_f32 v75, v75
    v_exp_f32 v76, v76
    v_exp_f32 v77, v77
    v_exp_f32 v78, v78
    v_exp_f32 v79, v79
    v_add_f32 v72, 1.0, v72
    v_add_f32 v73, 1.0, v73
    v_add_f32 v74, 1.0, v74
    v_add_f32 v75, 1.0, v75
    v_add_f32 v76, 1.0, v76
    v_add_f32 v77, 1.0, v77
    v_add_f32 v78, 1.0, v78
    v_add_f32 v79, 1.0, v79
    v_rcp_f32 v72, v72
    v_rcp_f32 v73, v73
    v_rcp_f32 v74, v74
    v_rcp_f32 v75, v75
    v_rcp_f32 v76, v76
    v_rcp_f32 v77, v77
    v_rcp_f32 v78, v78
    v_rcp_f32 v79, v79
    s_nop 0
    v_cvt_pk_bf16_f32 v84, v72, v73
    v_cvt_pk_bf16_f32 v85, v74, v75
    v_cvt_pk_bf16_f32 v86, v76, v77
    v_cvt_pk_bf16_f32 v87, v78, v79
    ds_write_b128 v2, v[84:87] offset:35840
    s_waitcnt lgkmcnt(0)
    s_barrier
    v_add_f32 v64, v32, v96
    v_add_f32 v65, v33, v97
    v_add_f32 v66, v34, v98
    v_add_f32 v67, v35, v99
    v_add_f32 v68, v36, v100
    v_add_f32 v69, v37, v101
    v_add_f32 v70, v38, v102
    v_add_f32 v71, v39, v103
    ds_read_b128 v[32:35], v4 offset:16896
    ds_read_b128 v[36:39], v4 offset:16928
    v_exp_f32 v64, v64
    v_exp_f32 v65, v65
    v_exp_f32 v66, v66
    v_exp_f32 v67, v67
    v_exp_f32 v68, v68
    v_exp_f32 v69, v69
    v_exp_f32 v70, v70
    v_exp_f32 v71, v71
    v_add_f32 v64, 1.0, v64
    v_add_f32 v65, 1.0, v65
    v_add_f32 v66, 1.0, v66
    v_add_f32 v67, 1.0, v67
    v_add_f32 v68, 1.0, v68
    v_add_f32 v69, 1.0, v69
    v_add_f32 v70, 1.0, v70
    v_add_f32 v71, 1.0, v71
    v_rcp_f32 v64, v64
    v_rcp_f32 v65, v65
    v_rcp_f32 v66, v66
    v_rcp_f32 v67, v67
    v_rcp_f32 v68, v68
    v_rcp_f32 v69, v69
    v_rcp_f32 v70, v70
    v_rcp_f32 v71, v71
    s_nop 0
    v_cvt_pk_bf16_f32 v80, v64, v65
    v_cvt_pk_bf16_f32 v81, v66, v67
    v_cvt_pk_bf16_f32 v82, v68, v69
    v_cvt_pk_bf16_f32 v83, v70, v71
    ds_write_b128 v2, v[80:83] offset:0
    v_add_f32 v72, v40, v104
    v_add_f32 v73, v41, v105
    v_add_f32 v74, v42, v106
    v_add_f32 v75, v43, v107
    v_add_f32 v76, v44, v108
    v_add_f32 v77, v45, v109
    v_add_f32 v78, v46, v110
    v_add_f32 v79, v47, v111
    ds_read_b128 v[40:43], v4 offset:16960
    ds_read_b128 v[44:47], v4 offset:16992
    v_exp_f32 v72, v72
    v_exp_f32 v73, v73
    v_exp_f32 v74, v74
    v_exp_f32 v75, v75
    v_exp_f32 v76, v76
    v_exp_f32 v77, v77
    v_exp_f32 v78, v78
    v_exp_f32 v79, v79
    v_add_f32 v72, 1.0, v72
    v_add_f32 v73, 1.0, v73
    v_add_f32 v74, 1.0, v74
    v_add_f32 v75, 1.0, v75
    v_add_f32 v76, 1.0, v76
    v_add_f32 v77, 1.0, v77
    v_add_f32 v78, 1.0, v78
    v_add_f32 v79, 1.0, v79
    v_rcp_f32 v72, v72
    v_rcp_f32 v73, v73
    v_rcp_f32 v74, v74
    v_rcp_f32 v75, v75
    v_rcp_f32 v76, v76
    v_rcp_f32 v77, v77
    v_rcp_f32 v78, v78
    v_rcp_f32 v79, v79
    s_nop 0
    v_cvt_pk_bf16_f32 v84, v72, v73
    v_cvt_pk_bf16_f32 v85, v74, v75
    v_cvt_pk_bf16_f32 v86, v76, v77
    v_cvt_pk_bf16_f32 v87, v78, v79
    ds_write_b128 v2, v[84:87] offset:1024
    v_add_f32 v64, v48, v112
    v_add_f32 v65, v49, v113
    v_add_f32 v66, v50, v114
    v_add_f32 v67, v51, v115
    v_add_f32 v68, v52, v116
    v_add_f32 v69, v53, v117
    v_add_f32 v70, v54, v118
    v_add_f32 v71, v55, v119
    ds_read_b128 v[48:51], v4 offset:17024
    ds_read_b128 v[52:55], v4 offset:17056
    v_exp_f32 v64, v64
    v_exp_f32 v65, v65
    v_exp_f32 v66, v66
    v_exp_f32 v67, v67
    v_exp_f32 v68, v68
    v_exp_f32 v69, v69
    v_exp_f32 v70, v70
    v_exp_f32 v71, v71
    v_add_f32 v64, 1.0, v64
    v_add_f32 v65, 1.0, v65
    v_add_f32 v66, 1.0, v66
    v_add_f32 v67, 1.0, v67
    v_add_f32 v68, 1.0, v68
    v_add_f32 v69, 1.0, v69
    v_add_f32 v70, 1.0, v70
    v_add_f32 v71, 1.0, v71
    v_rcp_f32 v64, v64
    v_rcp_f32 v65, v65
    v_rcp_f32 v66, v66
    v_rcp_f32 v67, v67
    v_rcp_f32 v68, v68
    v_rcp_f32 v69, v69
    v_rcp_f32 v70, v70
    v_rcp_f32 v71, v71
    s_nop 0
    v_cvt_pk_bf16_f32 v80, v64, v65
    v_cvt_pk_bf16_f32 v81, v66, v67
    v_cvt_pk_bf16_f32 v82, v68, v69
    v_cvt_pk_bf16_f32 v83, v70, v71
    ds_write_b128 v2, v[80:83] offset:2048
    v_add_f32 v72, v56, v120
    v_add_f32 v73, v57, v121
    v_add_f32 v74, v58, v122
    v_add_f32 v75, v59, v123
    v_add_f32 v76, v60, v124
    v_add_f32 v77, v61, v125
    v_add_f32 v78, v62, v126
    v_add_f32 v79, v63, v127
    ds_read_b128 v[56:59], v4 offset:17088
    ds_read_b128 v[60:63], v4 offset:17120
    v_exp_f32 v72, v72
    v_exp_f32 v73, v73
    v_exp_f32 v74, v74
    v_exp_f32 v75, v75
    v_exp_f32 v76, v76
    v_exp_f32 v77, v77
    v_exp_f32 v78, v78
    v_exp_f32 v79, v79
    v_add_f32 v72, 1.0, v72
    v_add_f32 v73, 1.0, v73
    v_add_f32 v74, 1.0, v74
    v_add_f32 v75, 1.0, v75
    v_add_f32 v76, 1.0, v76
    v_add_f32 v77, 1.0, v77
    v_add_f32 v78, 1.0, v78
    v_add_f32 v79, 1.0, v79
    v_rcp_f32 v72, v72
    v_rcp_f32 v73, v73
    v_rcp_f32 v74, v74
    v_rcp_f32 v75, v75
    v_rcp_f32 v76, v76
    v_rcp_f32 v77, v77
    v_rcp_f32 v78, v78
    v_rcp_f32 v79, v79
    s_nop 0
    v_cvt_pk_bf16_f32 v84, v72, v73
    v_cvt_pk_bf16_f32 v85, v74, v75
    v_cvt_pk_bf16_f32 v86, v76, v77
    v_cvt_pk_bf16_f32 v87, v78, v79
    ds_write_b128 v2, v[84:87] offset:3072
    s_waitcnt lgkmcnt(0)
    s_barrier
    ds_read_b128 a[0:3], v6 offset:0
    ds_read_b128 a[4:7], v6 offset:1056
    ds_read_b128 a[8:11], v6 offset:2112
    ds_read_b128 a[12:15], v6 offset:3168
    v_add_f32 v64, v32, v96
    v_add_f32 v65, v33, v97
    v_add_f32 v66, v34, v98
    v_add_f32 v67, v35, v99
    v_add_f32 v68, v36, v100
    v_add_f32 v69, v37, v101
    v_add_f32 v70, v38, v102
    v_add_f32 v71, v39, v103
    ds_read_b128 v[32:35], v4 offset:21120
    ds_read_b128 v[36:39], v4 offset:21152
    v_exp_f32 v64, v64
    v_exp_f32 v65, v65
    v_exp_f32 v66, v66
    v_exp_f32 v67, v67
    v_exp_f32 v68, v68
    v_exp_f32 v69, v69
    v_exp_f32 v70, v70
    v_exp_f32 v71, v71
    v_add_f32 v64, 1.0, v64
    v_add_f32 v65, 1.0, v65
    v_add_f32 v66, 1.0, v66
    v_add_f32 v67, 1.0, v67
    v_add_f32 v68, 1.0, v68
    v_add_f32 v69, 1.0, v69
    v_add_f32 v70, 1.0, v70
    v_add_f32 v71, 1.0, v71
    v_rcp_f32 v64, v64
    v_rcp_f32 v65, v65
    v_rcp_f32 v66, v66
    v_rcp_f32 v67, v67
    v_rcp_f32 v68, v68
    v_rcp_f32 v69, v69
    v_rcp_f32 v70, v70
    v_rcp_f32 v71, v71
    s_waitcnt lgkmcnt(5)
    s_mov_b32 s36, 0
    buffer_store_dwordx4 a[0:3], v7, s[16:19], s36 offen sc1
    s_waitcnt lgkmcnt(4)
    s_mov_b32 s36, 1024
    buffer_store_dwordx4 a[4:7], v7, s[16:19], s36 offen sc1
    v_cvt_pk_bf16_f32 v80, v64, v65
    v_cvt_pk_bf16_f32 v81, v66, v67
    v_cvt_pk_bf16_f32 v82, v68, v69
    v_cvt_pk_bf16_f32 v83, v70, v71
    ds_write_b128 v2, v[80:83] offset:16384
    v_add_f32 v72, v40, v104
    v_add_f32 v73, v41, v105
    v_add_f32 v74, v42, v106
    v_add_f32 v75, v43, v107
    v_add_f32 v76, v44, v108
    v_add_f32 v77, v45, v109
    v_add_f32 v78, v46, v110
    v_add_f32 v79, v47, v111
    ds_read_b128 v[40:43], v4 offset:21184
    ds_read_b128 v[44:47], v4 offset:21216
    v_exp_f32 v72, v72
    v_exp_f32 v73, v73
    v_exp_f32 v74, v74
    v_exp_f32 v75, v75
    v_exp_f32 v76, v76
    v_exp_f32 v77, v77
    v_exp_f32 v78, v78
    v_exp_f32 v79, v79
    v_add_f32 v72, 1.0, v72
    v_add_f32 v73, 1.0, v73
    v_add_f32 v74, 1.0, v74
    v_add_f32 v75, 1.0, v75
    v_add_f32 v76, 1.0, v76
    v_add_f32 v77, 1.0, v77
    v_add_f32 v78, 1.0, v78
    v_add_f32 v79, 1.0, v79
    v_rcp_f32 v72, v72
    v_rcp_f32 v73, v73
    v_rcp_f32 v74, v74
    v_rcp_f32 v75, v75
    v_rcp_f32 v76, v76
    v_rcp_f32 v77, v77
    v_rcp_f32 v78, v78
    v_rcp_f32 v79, v79
    s_waitcnt lgkmcnt(6)
    s_mov_b32 s36, 2048
    buffer_store_dwordx4 a[8:11], v7, s[16:19], s36 offen sc1
    s_waitcnt lgkmcnt(5)
    s_mov_b32 s36, 3072
    buffer_store_dwordx4 a[12:15], v7, s[16:19], s36 offen sc1
    v_cvt_pk_bf16_f32 v84, v72, v73
    v_cvt_pk_bf16_f32 v85, v74, v75
    v_cvt_pk_bf16_f32 v86, v76, v77
    v_cvt_pk_bf16_f32 v87, v78, v79
    ds_write_b128 v2, v[84:87] offset:17408
    v_add_f32 v64, v48, v112
    v_add_f32 v65, v49, v113
    v_add_f32 v66, v50, v114
    v_add_f32 v67, v51, v115
    v_add_f32 v68, v52, v116
    v_add_f32 v69, v53, v117
    v_add_f32 v70, v54, v118
    v_add_f32 v71, v55, v119
    ds_read_b128 v[48:51], v4 offset:21248
    ds_read_b128 v[52:55], v4 offset:21280
    v_exp_f32 v64, v64
    v_exp_f32 v65, v65
    v_exp_f32 v66, v66
    v_exp_f32 v67, v67
    v_exp_f32 v68, v68
    v_exp_f32 v69, v69
    v_exp_f32 v70, v70
    v_exp_f32 v71, v71
    v_add_f32 v64, 1.0, v64
    v_add_f32 v65, 1.0, v65
    v_add_f32 v66, 1.0, v66
    v_add_f32 v67, 1.0, v67
    v_add_f32 v68, 1.0, v68
    v_add_f32 v69, 1.0, v69
    v_add_f32 v70, 1.0, v70
    v_add_f32 v71, 1.0, v71
    v_rcp_f32 v64, v64
    v_rcp_f32 v65, v65
    v_rcp_f32 v66, v66
    v_rcp_f32 v67, v67
    v_rcp_f32 v68, v68
    v_rcp_f32 v69, v69
    v_rcp_f32 v70, v70
    v_rcp_f32 v71, v71
    s_nop 0
    v_cvt_pk_bf16_f32 v80, v64, v65
    v_cvt_pk_bf16_f32 v81, v66, v67
    v_cvt_pk_bf16_f32 v82, v68, v69
    v_cvt_pk_bf16_f32 v83, v70, v71
    ds_write_b128 v2, v[80:83] offset:18432
    v_add_f32 v72, v56, v120
    v_add_f32 v73, v57, v121
    v_add_f32 v74, v58, v122
    v_add_f32 v75, v59, v123
    v_add_f32 v76, v60, v124
    v_add_f32 v77, v61, v125
    v_add_f32 v78, v62, v126
    v_add_f32 v79, v63, v127
    ds_read_b128 v[56:59], v4 offset:21312
    ds_read_b128 v[60:63], v4 offset:21344
    v_exp_f32 v72, v72
    v_exp_f32 v73, v73
    v_exp_f32 v74, v74
    v_exp_f32 v75, v75
    v_exp_f32 v76, v76
    v_exp_f32 v77, v77
    v_exp_f32 v78, v78
    v_exp_f32 v79, v79
    v_add_f32 v72, 1.0, v72
    v_add_f32 v73, 1.0, v73
    v_add_f32 v74, 1.0, v74
    v_add_f32 v75, 1.0, v75
    v_add_f32 v76, 1.0, v76
    v_add_f32 v77, 1.0, v77
    v_add_f32 v78, 1.0, v78
    v_add_f32 v79, 1.0, v79
    v_rcp_f32 v72, v72
    v_rcp_f32 v73, v73
    v_rcp_f32 v74, v74
    v_rcp_f32 v75, v75
    v_rcp_f32 v76, v76
    v_rcp_f32 v77, v77
    v_rcp_f32 v78, v78
    v_rcp_f32 v79, v79
    s_nop 0
    v_cvt_pk_bf16_f32 v84, v72, v73
    v_cvt_pk_bf16_f32 v85, v74, v75
    v_cvt_pk_bf16_f32 v86, v76, v77
    v_cvt_pk_bf16_f32 v87, v78, v79
    ds_write_b128 v2, v[84:87] offset:19456
    s_waitcnt lgkmcnt(0)
    s_barrier
    ds_read_b128 a[0:3], v6 offset:16896
    ds_read_b128 a[4:7], v6 offset:17952
    ds_read_b128 a[8:11], v6 offset:19008
    ds_read_b128 a[12:15], v6 offset:20064
    v_add_f32 v64, v32, v96
    v_add_f32 v65, v33, v97
    v_add_f32 v66, v34, v98
    v_add_f32 v67, v35, v99
    v_add_f32 v68, v36, v100
    v_add_f32 v69, v37, v101
    v_add_f32 v70, v38, v102
    v_add_f32 v71, v39, v103
    ds_read_b128 v[32:35], v4 offset:25344
    ds_read_b128 v[36:39], v4 offset:25376
    v_exp_f32 v64, v64
    v_exp_f32 v65, v65
    v_exp_f32 v66, v66
    v_exp_f32 v67, v67
    v_exp_f32 v68, v68
    v_exp_f32 v69, v69
    v_exp_f32 v70, v70
    v_exp_f32 v71, v71
    v_add_f32 v64, 1.0, v64
    v_add_f32 v65, 1.0, v65
    v_add_f32 v66, 1.0, v66
    v_add_f32 v67, 1.0, v67
    v_add_f32 v68, 1.0, v68
    v_add_f32 v69, 1.0, v69
    v_add_f32 v70, 1.0, v70
    v_add_f32 v71, 1.0, v71
    v_rcp_f32 v64, v64
    v_rcp_f32 v65, v65
    v_rcp_f32 v66, v66
    v_rcp_f32 v67, v67
    v_rcp_f32 v68, v68
    v_rcp_f32 v69, v69
    v_rcp_f32 v70, v70
    v_rcp_f32 v71, v71
    s_waitcnt lgkmcnt(5)
    s_mov_b32 s36, 16384
    buffer_store_dwordx4 a[0:3], v7, s[16:19], s36 offen sc1
    s_waitcnt lgkmcnt(4)
    s_mov_b32 s36, 17408
    buffer_store_dwordx4 a[4:7], v7, s[16:19], s36 offen sc1
    v_cvt_pk_bf16_f32 v80, v64, v65
    v_cvt_pk_bf16_f32 v81, v66, v67
    v_cvt_pk_bf16_f32 v82, v68, v69
    v_cvt_pk_bf16_f32 v83, v70, v71
    ds_write_b128 v2, v[80:83] offset:32768
    v_add_f32 v72, v40, v104
    v_add_f32 v73, v41, v105
    v_add_f32 v74, v42, v106
    v_add_f32 v75, v43, v107
    v_add_f32 v76, v44, v108
    v_add_f32 v77, v45, v109
    v_add_f32 v78, v46, v110
    v_add_f32 v79, v47, v111
    ds_read_b128 v[40:43], v4 offset:25408
    ds_read_b128 v[44:47], v4 offset:25440
    v_exp_f32 v72, v72
    v_exp_f32 v73, v73
    v_exp_f32 v74, v74
    v_exp_f32 v75, v75
    v_exp_f32 v76, v76
    v_exp_f32 v77, v77
    v_exp_f32 v78, v78
    v_exp_f32 v79, v79
    v_add_f32 v72, 1.0, v72
    v_add_f32 v73, 1.0, v73
    v_add_f32 v74, 1.0, v74
    v_add_f32 v75, 1.0, v75
    v_add_f32 v76, 1.0, v76
    v_add_f32 v77, 1.0, v77
    v_add_f32 v78, 1.0, v78
    v_add_f32 v79, 1.0, v79
    v_rcp_f32 v72, v72
    v_rcp_f32 v73, v73
    v_rcp_f32 v74, v74
    v_rcp_f32 v75, v75
    v_rcp_f32 v76, v76
    v_rcp_f32 v77, v77
    v_rcp_f32 v78, v78
    v_rcp_f32 v79, v79
    s_waitcnt lgkmcnt(6)
    s_mov_b32 s36, 18432
    buffer_store_dwordx4 a[8:11], v7, s[16:19], s36 offen sc1
    s_waitcnt lgkmcnt(5)
    s_mov_b32 s36, 19456
    buffer_store_dwordx4 a[12:15], v7, s[16:19], s36 offen sc1
    v_cvt_pk_bf16_f32 v84, v72, v73
    v_cvt_pk_bf16_f32 v85, v74, v75
    v_cvt_pk_bf16_f32 v86, v76, v77
    v_cvt_pk_bf16_f32 v87, v78, v79
    ds_write_b128 v2, v[84:87] offset:33792
    v_add_f32 v64, v48, v112
    v_add_f32 v65, v49, v113
    v_add_f32 v66, v50, v114
    v_add_f32 v67, v51, v115
    v_add_f32 v68, v52, v116
    v_add_f32 v69, v53, v117
    v_add_f32 v70, v54, v118
    v_add_f32 v71, v55, v119
    ds_read_b128 v[48:51], v4 offset:25472
    ds_read_b128 v[52:55], v4 offset:25504
    v_exp_f32 v64, v64
    v_exp_f32 v65, v65
    v_exp_f32 v66, v66
    v_exp_f32 v67, v67
    v_exp_f32 v68, v68
    v_exp_f32 v69, v69
    v_exp_f32 v70, v70
    v_exp_f32 v71, v71
    v_add_f32 v64, 1.0, v64
    v_add_f32 v65, 1.0, v65
    v_add_f32 v66, 1.0, v66
    v_add_f32 v67, 1.0, v67
    v_add_f32 v68, 1.0, v68
    v_add_f32 v69, 1.0, v69
    v_add_f32 v70, 1.0, v70
    v_add_f32 v71, 1.0, v71
    v_rcp_f32 v64, v64
    v_rcp_f32 v65, v65
    v_rcp_f32 v66, v66
    v_rcp_f32 v67, v67
    v_rcp_f32 v68, v68
    v_rcp_f32 v69, v69
    v_rcp_f32 v70, v70
    v_rcp_f32 v71, v71
    s_nop 0
    v_cvt_pk_bf16_f32 v80, v64, v65
    v_cvt_pk_bf16_f32 v81, v66, v67
    v_cvt_pk_bf16_f32 v82, v68, v69
    v_cvt_pk_bf16_f32 v83, v70, v71
    ds_write_b128 v2, v[80:83] offset:34816
    v_add_f32 v72, v56, v120
    v_add_f32 v73, v57, v121
    v_add_f32 v74, v58, v122
    v_add_f32 v75, v59, v123
    v_add_f32 v76, v60, v124
    v_add_f32 v77, v61, v125
    v_add_f32 v78, v62, v126
    v_add_f32 v79, v63, v127
    ds_read_b128 v[56:59], v4 offset:25536
    ds_read_b128 v[60:63], v4 offset:25568
    v_exp_f32 v72, v72
    v_exp_f32 v73, v73
    v_exp_f32 v74, v74
    v_exp_f32 v75, v75
    v_exp_f32 v76, v76
    v_exp_f32 v77, v77
    v_exp_f32 v78, v78
    v_exp_f32 v79, v79
    v_add_f32 v72, 1.0, v72
    v_add_f32 v73, 1.0, v73
    v_add_f32 v74, 1.0, v74
    v_add_f32 v75, 1.0, v75
    v_add_f32 v76, 1.0, v76
    v_add_f32 v77, 1.0, v77
    v_add_f32 v78, 1.0, v78
    v_add_f32 v79, 1.0, v79
    v_rcp_f32 v72, v72
    v_rcp_f32 v73, v73
    v_rcp_f32 v74, v74
    v_rcp_f32 v75, v75
    v_rcp_f32 v76, v76
    v_rcp_f32 v77, v77
    v_rcp_f32 v78, v78
    v_rcp_f32 v79, v79
    s_nop 0
    v_cvt_pk_bf16_f32 v84, v72, v73
    v_cvt_pk_bf16_f32 v85, v74, v75
    v_cvt_pk_bf16_f32 v86, v76, v77
    v_cvt_pk_bf16_f32 v87, v78, v79
    ds_write_b128 v2, v[84:87] offset:35840
    s_waitcnt lgkmcnt(0)
    s_barrier
    ds_read_b128 a[0:3], v6 offset:0
    ds_read_b128 a[4:7], v6 offset:1056
    ds_read_b128 a[8:11], v6 offset:2112
    ds_read_b128 a[12:15], v6 offset:3168
    v_add_f32 v64, v32, v96
    v_add_f32 v65, v33, v97
    v_add_f32 v66, v34, v98
    v_add_f32 v67, v35, v99
    v_add_f32 v68, v36, v100
    v_add_f32 v69, v37, v101
    v_add_f32 v70, v38, v102
    v_add_f32 v71, v39, v103
    ds_read_b128 v[32:35], v4 offset:29568
    ds_read_b128 v[36:39], v4 offset:29600
    v_exp_f32 v64, v64
    v_exp_f32 v65, v65
    v_exp_f32 v66, v66
    v_exp_f32 v67, v67
    v_exp_f32 v68, v68
    v_exp_f32 v69, v69
    v_exp_f32 v70, v70
    v_exp_f32 v71, v71
    v_add_f32 v64, 1.0, v64
    v_add_f32 v65, 1.0, v65
    v_add_f32 v66, 1.0, v66
    v_add_f32 v67, 1.0, v67
    v_add_f32 v68, 1.0, v68
    v_add_f32 v69, 1.0, v69
    v_add_f32 v70, 1.0, v70
    v_add_f32 v71, 1.0, v71
    v_rcp_f32 v64, v64
    v_rcp_f32 v65, v65
    v_rcp_f32 v66, v66
    v_rcp_f32 v67, v67
    v_rcp_f32 v68, v68
    v_rcp_f32 v69, v69
    v_rcp_f32 v70, v70
    v_rcp_f32 v71, v71
    s_waitcnt lgkmcnt(5)
    s_mov_b32 s36, 32768
    buffer_store_dwordx4 a[0:3], v7, s[16:19], s36 offen sc1
    s_waitcnt lgkmcnt(4)
    s_mov_b32 s36, 33792
    buffer_store_dwordx4 a[4:7], v7, s[16:19], s36 offen sc1
    v_cvt_pk_bf16_f32 v80, v64, v65
    v_cvt_pk_bf16_f32 v81, v66, v67
    v_cvt_pk_bf16_f32 v82, v68, v69
    v_cvt_pk_bf16_f32 v83, v70, v71
    ds_write_b128 v2, v[80:83] offset:0
    v_add_f32 v72, v40, v104
    v_add_f32 v73, v41, v105
    v_add_f32 v74, v42, v106
    v_add_f32 v75, v43, v107
    v_add_f32 v76, v44, v108
    v_add_f32 v77, v45, v109
    v_add_f32 v78, v46, v110
    v_add_f32 v79, v47, v111
    ds_read_b128 v[40:43], v4 offset:29632
    ds_read_b128 v[44:47], v4 offset:29664
    v_exp_f32 v72, v72
    v_exp_f32 v73, v73
    v_exp_f32 v74, v74
    v_exp_f32 v75, v75
    v_exp_f32 v76, v76
    v_exp_f32 v77, v77
    v_exp_f32 v78, v78
    v_exp_f32 v79, v79
    v_add_f32 v72, 1.0, v72
    v_add_f32 v73, 1.0, v73
    v_add_f32 v74, 1.0, v74
    v_add_f32 v75, 1.0, v75
    v_add_f32 v76, 1.0, v76
    v_add_f32 v77, 1.0, v77
    v_add_f32 v78, 1.0, v78
    v_add_f32 v79, 1.0, v79
    v_rcp_f32 v72, v72
    v_rcp_f32 v73, v73
    v_rcp_f32 v74, v74
    v_rcp_f32 v75, v75
    v_rcp_f32 v76, v76
    v_rcp_f32 v77, v77
    v_rcp_f32 v78, v78
    v_rcp_f32 v79, v79
    s_waitcnt lgkmcnt(6)
    s_mov_b32 s36, 34816
    buffer_store_dwordx4 a[8:11], v7, s[16:19], s36 offen sc1
    s_waitcnt lgkmcnt(5)
    s_mov_b32 s36, 35840
    buffer_store_dwordx4 a[12:15], v7, s[16:19], s36 offen sc1
    v_cvt_pk_bf16_f32 v84, v72, v73
    v_cvt_pk_bf16_f32 v85, v74, v75
    v_cvt_pk_bf16_f32 v86, v76, v77
    v_cvt_pk_bf16_f32 v87, v78, v79
    ds_write_b128 v2, v[84:87] offset:1024
    v_add_f32 v64, v48, v112
    v_add_f32 v65, v49, v113
    v_add_f32 v66, v50, v114
    v_add_f32 v67, v51, v115
    v_add_f32 v68, v52, v116
    v_add_f32 v69, v53, v117
    v_add_f32 v70, v54, v118
    v_add_f32 v71, v55, v119
    ds_read_b128 v[48:51], v4 offset:29696
    ds_read_b128 v[52:55], v4 offset:29728
    v_exp_f32 v64, v64
    v_exp_f32 v65, v65
    v_exp_f32 v66, v66
    v_exp_f32 v67, v67
    v_exp_f32 v68, v68
    v_exp_f32 v69, v69
    v_exp_f32 v70, v70
    v_exp_f32 v71, v71
    v_add_f32 v64, 1.0, v64
    v_add_f32 v65, 1.0, v65
    v_add_f32 v66, 1.0, v66
    v_add_f32 v67, 1.0, v67
    v_add_f32 v68, 1.0, v68
    v_add_f32 v69, 1.0, v69
    v_add_f32 v70, 1.0, v70
    v_add_f32 v71, 1.0, v71
    v_rcp_f32 v64, v64
    v_rcp_f32 v65, v65
    v_rcp_f32 v66, v66
    v_rcp_f32 v67, v67
    v_rcp_f32 v68, v68
    v_rcp_f32 v69, v69
    v_rcp_f32 v70, v70
    v_rcp_f32 v71, v71
    s_nop 0
    v_cvt_pk_bf16_f32 v80, v64, v65
    v_cvt_pk_bf16_f32 v81, v66, v67
    v_cvt_pk_bf16_f32 v82, v68, v69
    v_cvt_pk_bf16_f32 v83, v70, v71
    ds_write_b128 v2, v[80:83] offset:2048
    v_add_f32 v72, v56, v120
    v_add_f32 v73, v57, v121
    v_add_f32 v74, v58, v122
    v_add_f32 v75, v59, v123
    v_add_f32 v76, v60, v124
    v_add_f32 v77, v61, v125
    v_add_f32 v78, v62, v126
    v_add_f32 v79, v63, v127
    ds_read_b128 v[56:59], v4 offset:29760
    ds_read_b128 v[60:63], v4 offset:29792
    v_exp_f32 v72, v72
    v_exp_f32 v73, v73
    v_exp_f32 v74, v74
    v_exp_f32 v75, v75
    v_exp_f32 v76, v76
    v_exp_f32 v77, v77
    v_exp_f32 v78, v78
    v_exp_f32 v79, v79
    v_add_f32 v72, 1.0, v72
    v_add_f32 v73, 1.0, v73
    v_add_f32 v74, 1.0, v74
    v_add_f32 v75, 1.0, v75
    v_add_f32 v76, 1.0, v76
    v_add_f32 v77, 1.0, v77
    v_add_f32 v78, 1.0, v78
    v_add_f32 v79, 1.0, v79
    v_rcp_f32 v72, v72
    v_rcp_f32 v73, v73
    v_rcp_f32 v74, v74
    v_rcp_f32 v75, v75
    v_rcp_f32 v76, v76
    v_rcp_f32 v77, v77
    v_rcp_f32 v78, v78
    v_rcp_f32 v79, v79
    s_nop 0
    v_cvt_pk_bf16_f32 v84, v72, v73
    v_cvt_pk_bf16_f32 v85, v74, v75
    v_cvt_pk_bf16_f32 v86, v76, v77
    v_cvt_pk_bf16_f32 v87, v78, v79
    ds_write_b128 v2, v[84:87] offset:3072
    s_waitcnt lgkmcnt(0)
    s_barrier
    ds_read_b128 a[0:3], v6 offset:16896
    ds_read_b128 a[4:7], v6 offset:17952
    ds_read_b128 a[8:11], v6 offset:19008
    ds_read_b128 a[12:15], v6 offset:20064
    v_add_f32 v64, v32, v96
    v_add_f32 v65, v33, v97
    v_add_f32 v66, v34, v98
    v_add_f32 v67, v35, v99
    v_add_f32 v68, v36, v100
    v_add_f32 v69, v37, v101
    v_add_f32 v70, v38, v102
    v_add_f32 v71, v39, v103
    v_exp_f32 v64, v64
    v_exp_f32 v65, v65
    v_exp_f32 v66, v66
    v_exp_f32 v67, v67
    v_exp_f32 v68, v68
    v_exp_f32 v69, v69
    v_exp_f32 v70, v70
    v_exp_f32 v71, v71
    v_add_f32 v64, 1.0, v64
    v_add_f32 v65, 1.0, v65
    v_add_f32 v66, 1.0, v66
    v_add_f32 v67, 1.0, v67
    v_add_f32 v68, 1.0, v68
    v_add_f32 v69, 1.0, v69
    v_add_f32 v70, 1.0, v70
    v_add_f32 v71, 1.0, v71
    v_rcp_f32 v64, v64
    v_rcp_f32 v65, v65
    v_rcp_f32 v66, v66
    v_rcp_f32 v67, v67
    v_rcp_f32 v68, v68
    v_rcp_f32 v69, v69
    v_rcp_f32 v70, v70
    v_rcp_f32 v71, v71
    s_waitcnt lgkmcnt(3)
    s_mov_b32 s36, 49152
    buffer_store_dwordx4 a[0:3], v7, s[16:19], s36 offen sc1
    s_waitcnt lgkmcnt(2)
    s_mov_b32 s36, 50176
    buffer_store_dwordx4 a[4:7], v7, s[16:19], s36 offen sc1
    v_cvt_pk_bf16_f32 v80, v64, v65
    v_cvt_pk_bf16_f32 v81, v66, v67
    v_cvt_pk_bf16_f32 v82, v68, v69
    v_cvt_pk_bf16_f32 v83, v70, v71
    ds_write_b128 v2, v[80:83] offset:16384
    v_add_f32 v72, v40, v104
    v_add_f32 v73, v41, v105
    v_add_f32 v74, v42, v106
    v_add_f32 v75, v43, v107
    v_add_f32 v76, v44, v108
    v_add_f32 v77, v45, v109
    v_add_f32 v78, v46, v110
    v_add_f32 v79, v47, v111
    v_exp_f32 v72, v72
    v_exp_f32 v73, v73
    v_exp_f32 v74, v74
    v_exp_f32 v75, v75
    v_exp_f32 v76, v76
    v_exp_f32 v77, v77
    v_exp_f32 v78, v78
    v_exp_f32 v79, v79
    v_add_f32 v72, 1.0, v72
    v_add_f32 v73, 1.0, v73
    v_add_f32 v74, 1.0, v74
    v_add_f32 v75, 1.0, v75
    v_add_f32 v76, 1.0, v76
    v_add_f32 v77, 1.0, v77
    v_add_f32 v78, 1.0, v78
    v_add_f32 v79, 1.0, v79
    v_rcp_f32 v72, v72
    v_rcp_f32 v73, v73
    v_rcp_f32 v74, v74
    v_rcp_f32 v75, v75
    v_rcp_f32 v76, v76
    v_rcp_f32 v77, v77
    v_rcp_f32 v78, v78
    v_rcp_f32 v79, v79
    s_waitcnt lgkmcnt(2)
    s_mov_b32 s36, 51200
    buffer_store_dwordx4 a[8:11], v7, s[16:19], s36 offen sc1
    s_waitcnt lgkmcnt(1)
    s_mov_b32 s36, 52224
    buffer_store_dwordx4 a[12:15], v7, s[16:19], s36 offen sc1
    v_cvt_pk_bf16_f32 v84, v72, v73
    v_cvt_pk_bf16_f32 v85, v74, v75
    v_cvt_pk_bf16_f32 v86, v76, v77
    v_cvt_pk_bf16_f32 v87, v78, v79
    ds_write_b128 v2, v[84:87] offset:17408
    v_add_f32 v64, v48, v112
    v_add_f32 v65, v49, v113
    v_add_f32 v66, v50, v114
    v_add_f32 v67, v51, v115
    v_add_f32 v68, v52, v116
    v_add_f32 v69, v53, v117
    v_add_f32 v70, v54, v118
    v_add_f32 v71, v55, v119
    v_exp_f32 v64, v64
    v_exp_f32 v65, v65
    v_exp_f32 v66, v66
    v_exp_f32 v67, v67
    v_exp_f32 v68, v68
    v_exp_f32 v69, v69
    v_exp_f32 v70, v70
    v_exp_f32 v71, v71
    v_add_f32 v64, 1.0, v64
    v_add_f32 v65, 1.0, v65
    v_add_f32 v66, 1.0, v66
    v_add_f32 v67, 1.0, v67
    v_add_f32 v68, 1.0, v68
    v_add_f32 v69, 1.0, v69
    v_add_f32 v70, 1.0, v70
    v_add_f32 v71, 1.0, v71
    v_rcp_f32 v64, v64
    v_rcp_f32 v65, v65
    v_rcp_f32 v66, v66
    v_rcp_f32 v67, v67
    v_rcp_f32 v68, v68
    v_rcp_f32 v69, v69
    v_rcp_f32 v70, v70
    v_rcp_f32 v71, v71
    s_nop 0
    v_cvt_pk_bf16_f32 v80, v64, v65
    v_cvt_pk_bf16_f32 v81, v66, v67
    v_cvt_pk_bf16_f32 v82, v68, v69
    v_cvt_pk_bf16_f32 v83, v70, v71
    ds_write_b128 v2, v[80:83] offset:18432
    v_add_f32 v72, v56, v120
    v_add_f32 v73, v57, v121
    v_add_f32 v74, v58, v122
    v_add_f32 v75, v59, v123
    v_add_f32 v76, v60, v124
    v_add_f32 v77, v61, v125
    v_add_f32 v78, v62, v126
    v_add_f32 v79, v63, v127
    v_exp_f32 v72, v72
    v_exp_f32 v73, v73
    v_exp_f32 v74, v74
    v_exp_f32 v75, v75
    v_exp_f32 v76, v76
    v_exp_f32 v77, v77
    v_exp_f32 v78, v78
    v_exp_f32 v79, v79
    v_add_f32 v72, 1.0, v72
    v_add_f32 v73, 1.0, v73
    v_add_f32 v74, 1.0, v74
    v_add_f32 v75, 1.0, v75
    v_add_f32 v76, 1.0, v76
    v_add_f32 v77, 1.0, v77
    v_add_f32 v78, 1.0, v78
    v_add_f32 v79, 1.0, v79
    v_rcp_f32 v72, v72
    v_rcp_f32 v73, v73
    v_rcp_f32 v74, v74
    v_rcp_f32 v75, v75
    v_rcp_f32 v76, v76
    v_rcp_f32 v77, v77
    v_rcp_f32 v78, v78
    v_rcp_f32 v79, v79
    s_nop 0
    v_cvt_pk_bf16_f32 v84, v72, v73
    v_cvt_pk_bf16_f32 v85, v74, v75
    v_cvt_pk_bf16_f32 v86, v76, v77
    v_cvt_pk_bf16_f32 v87, v78, v79
    ds_write_b128 v2, v[84:87] offset:19456
    s_waitcnt lgkmcnt(0)
    s_barrier
    ds_read_b128 a[0:3], v6 offset:0
    ds_read_b128 a[4:7], v6 offset:1056
    ds_read_b128 a[8:11], v6 offset:2112
    ds_read_b128 a[12:15], v6 offset:3168
    s_waitcnt lgkmcnt(3)
    s_mov_b32 s36, 65536
    buffer_store_dwordx4 a[0:3], v7, s[16:19], s36 offen sc1
    s_waitcnt lgkmcnt(2)
    s_mov_b32 s36, 66560
    buffer_store_dwordx4 a[4:7], v7, s[16:19], s36 offen sc1
    s_waitcnt lgkmcnt(1)
    s_mov_b32 s36, 67584
    buffer_store_dwordx4 a[8:11], v7, s[16:19], s36 offen sc1
    s_waitcnt lgkmcnt(0)
    s_mov_b32 s36, 68608
    buffer_store_dwordx4 a[12:15], v7, s[16:19], s36 offen sc1
    s_barrier
    ds_read_b128 a[0:3], v6 offset:16896
    ds_read_b128 a[4:7], v6 offset:17952
    ds_read_b128 a[8:11], v6 offset:19008
    ds_read_b128 a[12:15], v6 offset:20064
    s_waitcnt lgkmcnt(3)
    s_mov_b32 s36, 81920
    buffer_store_dwordx4 a[0:3], v7, s[16:19], s36 offen sc1
    s_waitcnt lgkmcnt(2)
    s_mov_b32 s36, 82944
    buffer_store_dwordx4 a[4:7], v7, s[16:19], s36 offen sc1
    s_waitcnt lgkmcnt(1)
    s_mov_b32 s36, 83968
    buffer_store_dwordx4 a[8:11], v7, s[16:19], s36 offen sc1
    s_waitcnt lgkmcnt(0)
    s_mov_b32 s36, 84992
    buffer_store_dwordx4 a[12:15], v7, s[16:19], s36 offen sc1
    s_barrier
    ds_read_b128 a[0:3], v6 offset:0
    ds_read_b128 a[4:7], v6 offset:1056
    ds_read_b128 a[8:11], v6 offset:2112
    ds_read_b128 a[12:15], v6 offset:3168
    s_waitcnt lgkmcnt(3)
    s_mov_b32 s36, 98304
    buffer_store_dwordx4 a[0:3], v7, s[16:19], s36 offen sc1
    s_waitcnt lgkmcnt(2)
    s_mov_b32 s36, 99328
    buffer_store_dwordx4 a[4:7], v7, s[16:19], s36 offen sc1
    s_waitcnt lgkmcnt(1)
    s_mov_b32 s36, 100352
    buffer_store_dwordx4 a[8:11], v7, s[16:19], s36 offen sc1
    s_waitcnt lgkmcnt(0)
    s_mov_b32 s36, 101376
    buffer_store_dwordx4 a[12:15], v7, s[16:19], s36 offen sc1
    s_barrier
    ds_read_b128 a[0:3], v6 offset:16896
    ds_read_b128 a[4:7], v6 offset:17952
    ds_read_b128 a[8:11], v6 offset:19008
    ds_read_b128 a[12:15], v6 offset:20064
    s_waitcnt lgkmcnt(3)
    s_mov_b32 s36, 114688
    buffer_store_dwordx4 a[0:3], v7, s[16:19], s36 offen sc1
    s_waitcnt lgkmcnt(2)
    s_mov_b32 s36, 115712
    buffer_store_dwordx4 a[4:7], v7, s[16:19], s36 offen sc1
    s_waitcnt lgkmcnt(1)
    s_mov_b32 s36, 116736
    buffer_store_dwordx4 a[8:11], v7, s[16:19], s36 offen sc1
    s_waitcnt lgkmcnt(0)
    s_mov_b32 s36, 117760
    buffer_store_dwordx4 a[12:15], v7, s[16:19], s36 offen sc1
    s_endpgm
L_joint_kernel_done:
    s_endpgm
.section .rodata,"a"
.p2align 6
.amdhsa_kernel prep_kernel
  .amdhsa_next_free_vgpr 128
  .amdhsa_next_free_sgpr 102
  .amdhsa_accum_offset 128
  .amdhsa_group_segment_fixed_size 0
  .amdhsa_kernarg_size 80
  .amdhsa_user_sgpr_count 2
  .amdhsa_user_sgpr_kernarg_segment_ptr 1
  .amdhsa_system_sgpr_workgroup_id_x 1
.end_amdhsa_kernel
.p2align 6
.amdhsa_kernel gemm1_kernel
  .amdhsa_next_free_vgpr 232
  .amdhsa_next_free_sgpr 102
  .amdhsa_accum_offset 232
  .amdhsa_group_segment_fixed_size 0
  .amdhsa_kernarg_size 80
  .amdhsa_user_sgpr_count 2
  .amdhsa_user_sgpr_kernarg_segment_ptr 1
  .amdhsa_system_sgpr_workgroup_id_x 1
.end_amdhsa_kernel
.p2align 6
.amdhsa_kernel mid_kernel
  .amdhsa_next_free_vgpr 128
  .amdhsa_next_free_sgpr 102
  .amdhsa_accum_offset 128
  .amdhsa_group_segment_fixed_size 0
  .amdhsa_kernarg_size 80
  .amdhsa_user_sgpr_count 2
  .amdhsa_user_sgpr_kernarg_segment_ptr 1
  .amdhsa_system_sgpr_workgroup_id_x 1
.end_amdhsa_kernel
.p2align 6
.amdhsa_kernel gemm2_kernel
  .amdhsa_next_free_vgpr 152
  .amdhsa_next_free_sgpr 102
  .amdhsa_accum_offset 152
  .amdhsa_group_segment_fixed_size 0
  .amdhsa_kernarg_size 80
  .amdhsa_user_sgpr_count 2
  .amdhsa_user_sgpr_kernarg_segment_ptr 1
  .amdhsa_system_sgpr_workgroup_id_x 1
.end_amdhsa_kernel
.p2align 6
.amdhsa_kernel joint_kernel
  .amdhsa_next_free_vgpr 256
  .amdhsa_next_free_sgpr 102
  .amdhsa_accum_offset 128
  .amdhsa_group_segment_fixed_size 0
  .amdhsa_kernarg_size 80
  .amdhsa_user_sgpr_count 2
  .amdhsa_user_sgpr_kernarg_segment_ptr 1
  .amdhsa_system_sgpr_workgroup_id_x 1
.end_amdhsa_kernel
```

```asm
; @launch kernel=prep_kernel grid=(941,1,1) block=(256,1,1) lds=40960
; @launch kernel=gemm1_kernel grid=(256,1,1) block=(512,1,1) lds=143360
; @launch kernel=mid_kernel grid=(704,1,1) block=(256,1,1) lds=53248
; @launch kernel=gemm2_kernel grid=(256,1,1) block=(512,1,1) lds=143360
; @launch kernel=joint_kernel grid=(256,1,1) block=(512,1,1) lds=149504
.amdgcn_target "amdgcn-amd-amdhsa--gfx950"
.text
.globl prep_kernel
.p2align 8
.type prep_kernel,@function
prep_kernel:
    s_cmp_ge_u32 s2, 941
    s_cbranch_scc1 L_prep_kernel_done
    v_readfirstlane_b32 s20, v0
    s_lshr_b32 s20, s20, 6
    s_cmp_lt_u32 s2, 13
    s_cbranch_scc1 L_prep_kernel_slab
    s_cmp_lt_u32 s2, 269
    s_cbranch_scc1 L_prep_kernel_g
    s_load_dwordx2 s[4:5], s[0:1], 0
    s_load_dwordx2 s[6:7], s[0:1], 72
    s_sub_u32 s24, s2, 269
    s_and_b32 s25, s24, 7
    s_mul_i32 s25, s25, 84
    s_lshr_b32 s24, s24, 3
    s_add_u32 s24, s24, s25
    s_cmp_ge_u32 s24, 668
    s_cbranch_scc1 L_prep_kernel_done
    s_mul_hi_u32 s25, s24, 25718368
    s_mul_i32 s26, s25, 167
    s_sub_u32 s26, s24, s26
    s_and_b32 s27, s25, 1
    s_lshr_b32 s25, s25, 1
    v_and_b32 v1, 63, v0
    v_lshrrev_b32 v2, 3, v1
    s_mul_i32 s28, s26, 96
    s_add_u32 s28, s28, s27
    s_sub_u32 s28, s28, 15
    v_lshlrev_b32 v3, 1, v2
    v_add_u32 v3, s28, v3
    v_lshlrev_b32 v3, 9, v3
    s_lshl_b32 s29, s20, 7
    v_add_u32 v3, s29, v3
    v_bfe_u32 v4, v2, 1, 1
    v_lshlrev_b32 v4, 1, v4
    v_and_b32 v5, 7, v1
    v_xor_b32 v4, v4, v5
    v_lshl_add_u32 v3, v4, 4, v3
    v_xor_b32 v4, 64, v3
    s_waitcnt lgkmcnt(0)
    s_mul_i32 s30, s25, 8192000
    s_add_u32 s8, s4, s30
    s_addc_u32 s9, s5, 0
    s_mov_b32 s10, 8192000
    s_mov_b32 s11, 0x00020000
    s_lshl_b32 s31, s20, 13
    s_add_u32 m0, s31, 0
    v_add_u32 v5, 0, v3
    buffer_load_dwordx4 v5, s[8:11], 0 offen nt lds
    s_add_u32 m0, s31, 1024
    v_add_u32 v5, 8192, v4
    buffer_load_dwordx4 v5, s[8:11], 0 offen nt lds
    s_add_u32 m0, s31, 2048
    v_add_u32 v5, 16384, v3
    buffer_load_dwordx4 v5, s[8:11], 0 offen nt lds
    s_add_u32 m0, s31, 3072
    v_add_u32 v5, 24576, v4
    buffer_load_dwordx4 v5, s[8:11], 0 offen nt lds
    s_add_u32 m0, s31, 4096
    v_add_u32 v5, 32768, v3
    buffer_load_dwordx4 v5, s[8:11], 0 offen nt lds
    s_add_u32 m0, s31, 5120
    v_add_u32 v5, 40960, v4
    buffer_load_dwordx4 v5, s[8:11], 0 offen nt lds
    s_add_u32 m0, s31, 6144
    v_add_u32 v5, 49152, v3
    buffer_load_dwordx4 v5, s[8:11], 0 offen nt lds
    s_add_u32 m0, s31, 7168
    v_add_u32 v5, 57344, v4
    buffer_load_dwordx4 v5, s[8:11], 0 offen nt lds
    s_add_u32 s12, s6, 0
    s_addc_u32 s13, s7, 0
    s_mov_b32 s14, 21889024
    s_mov_b32 s15, 0x00020000
    v_mov_b32 v8, v1
    s_lshl_b32 s32, s20, 4
    v_lshlrev_b32 v6, 4, v1
    s_lshl_b32 s33, s20, 11
    v_add_u32 v7, s33, v6
    v_and_b32 v9, 15, v8
    v_lshrrev_b32 v10, 4, v8
    v_or_b32 v11, 1, v9
    v_add_u32 v11, s32, v11
    v_cvt_f32_u32 v11, v11
    v_mul_f32 v11, 0x3c000000, v11
    v_lshlrev_b32 v10, 3, v10
    v_add_u32 v10, 0, v10
    v_cvt_f32_u32 v10, v10
    v_and_b32 v9, 1, v9
    v_cvt_f32_u32 v9, v9
    v_mul_f32 v9, 0x3e800000, v9
    v_fma_f32 v12, v11, v10, v9
    v_fract_f32 v13, v12
    v_add_f32 v12, v12, v11
    v_fract_f32 v14, v12
    v_add_f32 v12, v12, v11
    v_fract_f32 v15, v12
    v_add_f32 v12, v12, v11
    v_fract_f32 v16, v12
    v_add_f32 v12, v12, v11
    v_fract_f32 v17, v12
    v_add_f32 v12, v12, v11
    v_fract_f32 v18, v12
    v_add_f32 v12, v12, v11
    v_fract_f32 v19, v12
    v_add_f32 v12, v12, v11
    v_fract_f32 v20, v12
    v_cos_f32 v13, v13
    v_cos_f32 v14, v14
    v_cos_f32 v15, v15
    v_cos_f32 v16, v16
    v_cos_f32 v17, v17
    v_cos_f32 v18, v18
    v_cos_f32 v19, v19
    v_cos_f32 v20, v20
    s_nop 0
    v_cvt_pk_bf16_f32 v24, v13, v14
    v_cvt_pk_bf16_f32 v25, v15, v16
    v_cvt_pk_bf16_f32 v26, v17, v18
    v_cvt_pk_bf16_f32 v27, v19, v20
    ds_write_b128 v7, v[24:27] offset:32768
    v_and_b32 v9, 15, v8
    v_lshrrev_b32 v10, 4, v8
    v_or_b32 v11, 1, v9
    v_add_u32 v11, s32, v11
    v_cvt_f32_u32 v11, v11
    v_mul_f32 v11, 0x3c000000, v11
    v_lshlrev_b32 v10, 3, v10
    v_add_u32 v10, 32, v10
    v_cvt_f32_u32 v10, v10
    v_and_b32 v9, 1, v9
    v_cvt_f32_u32 v9, v9
    v_mul_f32 v9, 0x3e800000, v9
    v_fma_f32 v12, v11, v10, v9
    v_fract_f32 v13, v12
    v_add_f32 v12, v12, v11
    v_fract_f32 v14, v12
    v_add_f32 v12, v12, v11
    v_fract_f32 v15, v12
    v_add_f32 v12, v12, v11
    v_fract_f32 v16, v12
    v_add_f32 v12, v12, v11
    v_fract_f32 v17, v12
    v_add_f32 v12, v12, v11
    v_fract_f32 v18, v12
    v_add_f32 v12, v12, v11
    v_fract_f32 v19, v12
    v_add_f32 v12, v12, v11
    v_fract_f32 v20, v12
    v_cos_f32 v13, v13
    v_cos_f32 v14, v14
    v_cos_f32 v15, v15
    v_cos_f32 v16, v16
    v_cos_f32 v17, v17
    v_cos_f32 v18, v18
    v_cos_f32 v19, v19
    v_cos_f32 v20, v20
    s_nop 0
    v_cvt_pk_bf16_f32 v28, v13, v14
    v_cvt_pk_bf16_f32 v29, v15, v16
    v_cvt_pk_bf16_f32 v30, v17, v18
    v_cvt_pk_bf16_f32 v31, v19, v20
    ds_write_b128 v7, v[28:31] offset:33792
    v_bfe_u32 v8, v1, 2, 2
    v_lshrrev_b32 v9, 4, v1
    v_lshl_add_u32 v10, v9, 3, v8
    v_lshlrev_b32 v10, 7, v10
    v_lshrrev_b32 v8, 1, v8
    v_and_b32 v11, 1, v9
    v_lshl_add_u32 v8, v11, 1, v8
    v_lshlrev_b32 v8, 1, v8
    v_bfe_u32 v11, v1, 1, 1
    v_xor_b32 v8, v8, v11
    v_lshl_add_u32 v10, v8, 4, v10
    v_and_b32 v11, 1, v1
    v_lshl_add_u32 v10, v11, 3, v10
    v_add_u32 v10, s31, v10
    v_xor_b32 v12, 0, v10
    v_xor_b32 v13, 32, v10
    v_xor_b32 v14, 64, v10
    v_xor_b32 v15, 96, v10
    v_bfe_u32 v8, v1, 1, 3
    s_mov_b32 s33, 684032
    v_mul_lo_u32 v8, v8, s33
    v_and_b32 v11, 1, v1
    v_lshl_add_u32 v8, v11, 6, v8
    v_lshl_add_u32 v16, v9, 4, v8
    s_mul_i32 s34, s25, 167
    s_add_u32 s34, s34, s26
    s_lshl_b32 s34, s34, 11
    s_lshl_b32 s35, s27, 3
    s_lshl_b32 s36, s20, 1
    s_add_u32 s35, s35, s36
    s_lshl_b32 s35, s35, 7
    s_add_u32 s34, s34, s35
    s_waitcnt lgkmcnt(0)
    s_barrier
    ds_read_b128 v[24:27], v6 offset:32768
    ds_read_b128 v[28:31], v6 offset:33792
    ds_read_b128 v[32:35], v6 offset:34816
    ds_read_b128 v[36:39], v6 offset:35840
    ds_read_b128 v[40:43], v6 offset:36864
    ds_read_b128 v[44:47], v6 offset:37888
    ds_read_b128 v[48:51], v6 offset:38912
    ds_read_b128 v[52:55], v6 offset:39936
    s_waitcnt vmcnt(0)
    ds_read_b64_tr_b16 v[56:57], v12 offset:0
    ds_read_b64_tr_b16 v[58:59], v12 offset:512
    ds_read_b64_tr_b16 v[60:61], v12 offset:4096
    ds_read_b64_tr_b16 v[62:63], v12 offset:4608
    ds_read_b64_tr_b16 v[64:65], v13 offset:0
    ds_read_b64_tr_b16 v[66:67], v13 offset:512
    ds_read_b64_tr_b16 v[68:69], v13 offset:4096
    ds_read_b64_tr_b16 v[70:71], v13 offset:4608
    s_waitcnt lgkmcnt(0)
    v_mfma_f32_16x16x32_bf16 v[72:75], v[56:59], v[24:27], 0
    v_mfma_f32_16x16x32_bf16 v[76:79], v[56:59], v[32:35], 0
    v_mfma_f32_16x16x32_bf16 v[80:83], v[56:59], v[40:43], 0
    v_mfma_f32_16x16x32_bf16 v[84:87], v[56:59], v[48:51], 0
    v_mfma_f32_16x16x32_bf16 v[88:91], v[64:67], v[24:27], 0
    v_mfma_f32_16x16x32_bf16 v[92:95], v[64:67], v[32:35], 0
    v_mfma_f32_16x16x32_bf16 v[96:99], v[64:67], v[40:43], 0
    v_mfma_f32_16x16x32_bf16 v[100:103], v[64:67], v[48:51], 0
    v_mfma_f32_16x16x32_bf16 v[72:75], v[60:63], v[28:31], v[72:75]
    v_mfma_f32_16x16x32_bf16 v[76:79], v[60:63], v[36:39], v[76:79]
    v_mfma_f32_16x16x32_bf16 v[80:83], v[60:63], v[44:47], v[80:83]
    v_mfma_f32_16x16x32_bf16 v[84:87], v[60:63], v[52:55], v[84:87]
    v_mfma_f32_16x16x32_bf16 v[88:91], v[68:71], v[28:31], v[88:91]
    v_mfma_f32_16x16x32_bf16 v[92:95], v[68:71], v[36:39], v[92:95]
    v_mfma_f32_16x16x32_bf16 v[96:99], v[68:71], v[44:47], v[96:99]
    v_mfma_f32_16x16x32_bf16 v[100:103], v[68:71], v[52:55], v[100:103]
    s_nop 7
    v_cvt_pk_bf16_f32 v104, v72, v73
    v_cvt_pk_bf16_f32 v105, v74, v75
    v_cvt_pk_bf16_f32 v106, v88, v89
    v_cvt_pk_bf16_f32 v107, v90, v91
    s_add_u32 s35, s34, 0
    buffer_store_dwordx4 v[104:107], v16, s[12:15], s35 offen sc1
    s_nop 1
    v_cvt_pk_bf16_f32 v108, v76, v77
    v_cvt_pk_bf16_f32 v109, v78, v79
    v_cvt_pk_bf16_f32 v110, v92, v93
    v_cvt_pk_bf16_f32 v111, v94, v95
    s_add_u32 s35, s34, 5472256
    buffer_store_dwordx4 v[108:111], v16, s[12:15], s35 offen sc1
    s_nop 1
    v_cvt_pk_bf16_f32 v104, v80, v81
    v_cvt_pk_bf16_f32 v105, v82, v83
    v_cvt_pk_bf16_f32 v106, v96, v97
    v_cvt_pk_bf16_f32 v107, v98, v99
    s_add_u32 s35, s34, 10944512
    buffer_store_dwordx4 v[104:107], v16, s[12:15], s35 offen sc1
    s_nop 1
    v_cvt_pk_bf16_f32 v108, v84, v85
    v_cvt_pk_bf16_f32 v109, v86, v87
    v_cvt_pk_bf16_f32 v110, v100, v101
    v_cvt_pk_bf16_f32 v111, v102, v103
    s_add_u32 s35, s34, 16416768
    buffer_store_dwordx4 v[108:111], v16, s[12:15], s35 offen sc1
    s_nop 1
    ds_read_b64_tr_b16 v[56:57], v14 offset:0
    ds_read_b64_tr_b16 v[58:59], v14 offset:512
    ds_read_b64_tr_b16 v[60:61], v14 offset:4096
    ds_read_b64_tr_b16 v[62:63], v14 offset:4608
    ds_read_b64_tr_b16 v[64:65], v15 offset:0
    ds_read_b64_tr_b16 v[66:67], v15 offset:512
    ds_read_b64_tr_b16 v[68:69], v15 offset:4096
    ds_read_b64_tr_b16 v[70:71], v15 offset:4608
    s_waitcnt lgkmcnt(0)
    v_mfma_f32_16x16x32_bf16 v[72:75], v[56:59], v[24:27], 0
    v_mfma_f32_16x16x32_bf16 v[76:79], v[56:59], v[32:35], 0
    v_mfma_f32_16x16x32_bf16 v[80:83], v[56:59], v[40:43], 0
    v_mfma_f32_16x16x32_bf16 v[84:87], v[56:59], v[48:51], 0
    v_mfma_f32_16x16x32_bf16 v[88:91], v[64:67], v[24:27], 0
    v_mfma_f32_16x16x32_bf16 v[92:95], v[64:67], v[32:35], 0
    v_mfma_f32_16x16x32_bf16 v[96:99], v[64:67], v[40:43], 0
    v_mfma_f32_16x16x32_bf16 v[100:103], v[64:67], v[48:51], 0
    v_mfma_f32_16x16x32_bf16 v[72:75], v[60:63], v[28:31], v[72:75]
    v_mfma_f32_16x16x32_bf16 v[76:79], v[60:63], v[36:39], v[76:79]
    v_mfma_f32_16x16x32_bf16 v[80:83], v[60:63], v[44:47], v[80:83]
    v_mfma_f32_16x16x32_bf16 v[84:87], v[60:63], v[52:55], v[84:87]
    v_mfma_f32_16x16x32_bf16 v[88:91], v[68:71], v[28:31], v[88:91]
    v_mfma_f32_16x16x32_bf16 v[92:95], v[68:71], v[36:39], v[92:95]
    v_mfma_f32_16x16x32_bf16 v[96:99], v[68:71], v[44:47], v[96:99]
    v_mfma_f32_16x16x32_bf16 v[100:103], v[68:71], v[52:55], v[100:103]
    s_nop 7
    v_cvt_pk_bf16_f32 v104, v72, v73
    v_cvt_pk_bf16_f32 v105, v74, v75
    v_cvt_pk_bf16_f32 v106, v88, v89
    v_cvt_pk_bf16_f32 v107, v90, v91
    s_add_u32 s35, s34, 128
    buffer_store_dwordx4 v[104:107], v16, s[12:15], s35 offen sc1
    s_nop 1
    v_cvt_pk_bf16_f32 v108, v76, v77
    v_cvt_pk_bf16_f32 v109, v78, v79
    v_cvt_pk_bf16_f32 v110, v92, v93
    v_cvt_pk_bf16_f32 v111, v94, v95
    s_add_u32 s35, s34, 5472384
    buffer_store_dwordx4 v[108:111], v16, s[12:15], s35 offen sc1
    s_nop 1
    v_cvt_pk_bf16_f32 v104, v80, v81
    v_cvt_pk_bf16_f32 v105, v82, v83
    v_cvt_pk_bf16_f32 v106, v96, v97
    v_cvt_pk_bf16_f32 v107, v98, v99
    s_add_u32 s35, s34, 10944640
    buffer_store_dwordx4 v[104:107], v16, s[12:15], s35 offen sc1
    s_nop 1
    v_cvt_pk_bf16_f32 v108, v84, v85
    v_cvt_pk_bf16_f32 v109, v86, v87
    v_cvt_pk_bf16_f32 v110, v100, v101
    v_cvt_pk_bf16_f32 v111, v102, v103
    s_add_u32 s35, s34, 16416896
    buffer_store_dwordx4 v[108:111], v16, s[12:15], s35 offen sc1
    s_nop 1
    s_endpgm
L_prep_kernel_g:
    s_sub_u32 s3, s2, 13
    s_load_dwordx2 s[4:5], s[0:1], 8
    s_load_dwordx2 s[6:7], s[0:1], 72
    s_lshr_b32 s24, s3, 4
    s_bfe_u32 s25, s3, 0x20002
    s_and_b32 s26, s3, 3
    s_lshr_b32 s27, s24, 3
    s_and_b32 s28, s24, 7
    v_and_b32 v1, 63, v0
    v_lshrrev_b32 v2, 3, v1
    v_lshrrev_b32 v3, 2, v2
    v_lshlrev_b32 v3, 4, v3
    v_and_b32 v4, 3, v2
    v_add_u32 v3, v3, v4
    s_lshl_b32 s29, s25, 2
    s_lshl_b32 s30, s28, 5
    s_add_u32 s29, s29, s30
    v_add_u32 v3, s29, v3
    v_lshlrev_b32 v3, 9, v3
    v_and_b32 v4, 7, v1
    s_lshr_b32 s30, s20, 1
    s_lshl_b32 s30, s30, 2
    v_xor_b32 v4, s30, v4
    v_lshl_add_u32 v3, v4, 4, v3
    s_lshl_b32 s30, s26, 7
    v_add_u32 v3, s30, v3
    v_xor_b32 v4, 32, v3
    s_waitcnt lgkmcnt(0)
    s_mov_b32 s8, s4
    s_mov_b32 s9, s5
    s_mov_b32 s10, 4063232
    s_mov_b32 s11, 0x00020000
    s_add_u32 s12, s6, 21954560
    s_addc_u32 s13, s7, 0
    s_mov_b32 s14, 16916480
    s_mov_b32 s15, 0x00020000
    s_lshl_b32 s30, s20, 3
    s_add_u32 s30, s30, s27
    s_lshl_b32 s30, s30, 17
    s_mul_i32 s31, s20, 4608
    s_add_u32 m0, s31, 0
    s_add_u32 s32, s30, 0
    buffer_load_dwordx4 v3, s[8:11], s32 offen nt lds
    s_add_u32 m0, s31, 1152
    s_add_u32 s32, s30, 262144
    buffer_load_dwordx4 v3, s[8:11], s32 offen nt lds
    s_add_u32 m0, s31, 2304
    s_add_u32 s32, s30, 524288
    buffer_load_dwordx4 v4, s[8:11], s32 offen nt lds
    s_add_u32 m0, s31, 3456
    s_add_u32 s32, s30, 786432
    buffer_load_dwordx4 v4, s[8:11], s32 offen nt lds
    v_and_b32 v8, 15, v1
    v_or_b32 v9, 1, v8
    s_lshl_b32 s33, s20, 4
    v_add_u32 v9, s33, v9
    v_cvt_f32_u32 v9, v9
    v_mul_f32 v9, 0x3c000000, v9
    v_bfe_u32 v10, v1, 4, 1
    v_lshlrev_b32 v10, 3, v10
    v_cvt_f32_u32 v10, v10
    v_and_b32 v8, 1, v8
    v_cvt_f32_u32 v8, v8
    v_mul_f32 v8, 0x3f400000, v8
    v_fma_f32 v11, v9, v10, v8
    v_fract_f32 v12, v11
    v_add_f32 v11, v11, v9
    v_fract_f32 v13, v11
    v_add_f32 v11, v11, v9
    v_fract_f32 v14, v11
    v_add_f32 v11, v11, v9
    v_fract_f32 v15, v11
    v_add_f32 v11, v11, v9
    v_fract_f32 v16, v11
    v_add_f32 v11, v11, v9
    v_fract_f32 v17, v11
    v_add_f32 v11, v11, v9
    v_fract_f32 v18, v11
    v_add_f32 v11, v11, v9
    v_fract_f32 v19, v11
    v_cos_f32 v12, v12
    v_cos_f32 v13, v13
    v_cos_f32 v14, v14
    v_cos_f32 v15, v15
    v_cos_f32 v16, v16
    v_cos_f32 v17, v17
    v_cos_f32 v18, v18
    v_cos_f32 v19, v19
    s_nop 0
    v_mul_f32 v12, 0x3d000000, v12
    v_mul_f32 v13, 0x3d000000, v13
    v_mul_f32 v14, 0x3d000000, v14
    v_mul_f32 v15, 0x3d000000, v15
    v_mul_f32 v16, 0x3d000000, v16
    v_mul_f32 v17, 0x3d000000, v17
    v_mul_f32 v18, 0x3d000000, v18
    v_mul_f32 v19, 0x3d000000, v19
    v_cvt_pk_bf16_f32 v20, v12, v13
    v_cvt_pk_bf16_f32 v21, v14, v15
    v_cvt_pk_bf16_f32 v22, v16, v17
    v_cvt_pk_bf16_f32 v23, v18, v19
    v_lshlrev_b32 v28, 16, v20
    v_and_b32 v29, 0xffff0000, v20
    v_sub_f32 v28, v12, v28
    v_sub_f32 v29, v13, v29
    v_cvt_pk_bf16_f32 v24, v28, v29
    v_lshlrev_b32 v28, 16, v21
    v_and_b32 v29, 0xffff0000, v21
    v_sub_f32 v28, v14, v28
    v_sub_f32 v29, v15, v29
    v_cvt_pk_bf16_f32 v25, v28, v29
    v_lshlrev_b32 v28, 16, v22
    v_and_b32 v29, 0xffff0000, v22
    v_sub_f32 v28, v16, v28
    v_sub_f32 v29, v17, v29
    v_cvt_pk_bf16_f32 v26, v28, v29
    v_lshlrev_b32 v28, 16, v23
    v_and_b32 v29, 0xffff0000, v23
    v_sub_f32 v28, v18, v28
    v_sub_f32 v29, v19, v29
    v_cvt_pk_bf16_f32 v27, v28, v29
    v_cmp_gt_u32 vcc, 32, v1
    s_nop 1
    v_cndmask_b32 v20, v24, v20, vcc
    v_cndmask_b32 v21, v25, v21, vcc
    v_cndmask_b32 v22, v26, v22, vcc
    v_cndmask_b32 v23, v27, v23, vcc
    v_lshlrev_b32 v28, 4, v1
    s_lshl_b32 s33, s20, 10
    v_add_u32 v29, s33, v28
    ds_write_b128 v29, v[20:23] offset:18432
    v_bfe_u32 v30, v1, 2, 2
    v_bfe_u32 v31, v1, 4, 1
    v_lshl_add_u32 v32, v31, 3, v30
    v_mul_u32_u24 v32, 1152, v32
    v_lshrrev_b32 v30, 1, v30
    v_lshl_add_u32 v30, v31, 1, v30
    v_lshlrev_b32 v30, 1, v30
    v_bfe_u32 v31, v1, 1, 1
    s_lshl_b32 s33, s20, 1
    v_add_u32 v31, s33, v31
    v_xor_b32 v30, v30, v31
    v_lshl_add_u32 v32, v30, 4, v32
    v_and_b32 v30, 1, v1
    v_lshl_add_u32 v32, v30, 3, v32
    v_lshrrev_b32 v30, 4, v1
    s_mov_b32 s33, 1057280
    v_mul_lo_u32 v30, v30, s33
    v_and_b32 v31, 15, v1
    v_lshl_add_u32 v33, v31, 4, v30
    s_lshl_b32 s34, s24, 15
    s_lshl_b32 s35, s26, 2
    s_add_u32 s35, s35, s20
    s_lshl_b32 s35, s35, 11
    s_add_u32 s34, s34, s35
    s_lshl_b32 s35, s25, 8
    s_add_u32 s34, s34, s35
    s_waitcnt vmcnt(0) lgkmcnt(0)
    s_barrier
    ds_read_b128 v[36:39], v28 offset:18432
    ds_read_b128 v[40:43], v28 offset:19456
    ds_read_b128 v[44:47], v28 offset:20480
    ds_read_b128 v[48:51], v28 offset:21504
    ds_read_b64_tr_b16 v[52:53], v32 offset:0
    ds_read_b64_tr_b16 v[54:55], v32 offset:4608
    ds_read_b64_tr_b16 v[56:57], v32 offset:128
    ds_read_b64_tr_b16 v[58:59], v32 offset:4736
    ds_read_b64_tr_b16 v[60:61], v32 offset:256
    ds_read_b64_tr_b16 v[62:63], v32 offset:4864
    ds_read_b64_tr_b16 v[64:65], v32 offset:384
    ds_read_b64_tr_b16 v[66:67], v32 offset:4992
    ds_read_b64_tr_b16 v[68:69], v32 offset:512
    ds_read_b64_tr_b16 v[70:71], v32 offset:5120
    s_waitcnt lgkmcnt(8)
    ds_read_b64_tr_b16 v[72:73], v32 offset:640
    ds_read_b64_tr_b16 v[74:75], v32 offset:5248
    ds_read_b64_tr_b16 v[76:77], v32 offset:768
    ds_read_b64_tr_b16 v[78:79], v32 offset:5376
    ds_read_b64_tr_b16 v[80:81], v32 offset:896
    ds_read_b64_tr_b16 v[82:83], v32 offset:5504
    s_waitcnt lgkmcnt(0)
    v_mfma_f32_16x16x32_bf16 v[84:87], v[36:39], v[52:55], 0
    v_mfma_f32_16x16x32_bf16 v[88:91], v[36:39], v[56:59], 0
    v_mfma_f32_16x16x32_bf16 v[92:95], v[36:39], v[60:63], 0
    v_mfma_f32_16x16x32_bf16 v[96:99], v[36:39], v[64:67], 0
    v_mfma_f32_16x16x32_bf16 v[100:103], v[36:39], v[68:71], 0
    v_mfma_f32_16x16x32_bf16 v[104:107], v[36:39], v[72:75], 0
    v_mfma_f32_16x16x32_bf16 v[108:111], v[36:39], v[76:79], 0
    v_mfma_f32_16x16x32_bf16 v[112:115], v[36:39], v[80:83], 0
    s_nop 7
    v_cvt_pk_bf16_f32 v116, v84, v88
    v_cvt_pk_bf16_f32 v117, v92, v96
    v_cvt_pk_bf16_f32 v118, v100, v104
    v_cvt_pk_bf16_f32 v119, v108, v112
    s_add_u32 s35, s34, 0
    buffer_store_dwordx4 v[116:119], v33, s[12:15], s35 offen sc1
    s_nop 1
    v_cvt_pk_bf16_f32 v120, v85, v89
    v_cvt_pk_bf16_f32 v121, v93, v97
    v_cvt_pk_bf16_f32 v122, v101, v105
    v_cvt_pk_bf16_f32 v123, v109, v113
    s_add_u32 s35, s34, 1024
    buffer_store_dwordx4 v[120:123], v33, s[12:15], s35 offen sc1
    s_nop 1
    v_cvt_pk_bf16_f32 v116, v86, v90
    v_cvt_pk_bf16_f32 v117, v94, v98
    v_cvt_pk_bf16_f32 v118, v102, v106
    v_cvt_pk_bf16_f32 v119, v110, v114
    s_add_u32 s35, s34, 528640
    buffer_store_dwordx4 v[116:119], v33, s[12:15], s35 offen sc1
    s_nop 1
    v_cvt_pk_bf16_f32 v120, v87, v91
    v_cvt_pk_bf16_f32 v121, v95, v99
    v_cvt_pk_bf16_f32 v122, v103, v107
    v_cvt_pk_bf16_f32 v123, v111, v115
    s_add_u32 s35, s34, 529664
    buffer_store_dwordx4 v[120:123], v33, s[12:15], s35 offen sc1
    s_nop 1
    v_mfma_f32_16x16x32_bf16 v[84:87], v[40:43], v[52:55], 0
    v_mfma_f32_16x16x32_bf16 v[88:91], v[40:43], v[56:59], 0
    v_mfma_f32_16x16x32_bf16 v[92:95], v[40:43], v[60:63], 0
    v_mfma_f32_16x16x32_bf16 v[96:99], v[40:43], v[64:67], 0
    v_mfma_f32_16x16x32_bf16 v[100:103], v[40:43], v[68:71], 0
    v_mfma_f32_16x16x32_bf16 v[104:107], v[40:43], v[72:75], 0
    v_mfma_f32_16x16x32_bf16 v[108:111], v[40:43], v[76:79], 0
    v_mfma_f32_16x16x32_bf16 v[112:115], v[40:43], v[80:83], 0
    s_nop 7
    v_cvt_pk_bf16_f32 v116, v84, v88
    v_cvt_pk_bf16_f32 v117, v92, v96
    v_cvt_pk_bf16_f32 v118, v100, v104
    v_cvt_pk_bf16_f32 v119, v108, v112
    s_add_u32 s35, s34, 4229120
    buffer_store_dwordx4 v[116:119], v33, s[12:15], s35 offen sc1
    s_nop 1
    v_cvt_pk_bf16_f32 v120, v85, v89
    v_cvt_pk_bf16_f32 v121, v93, v97
    v_cvt_pk_bf16_f32 v122, v101, v105
    v_cvt_pk_bf16_f32 v123, v109, v113
    s_add_u32 s35, s34, 4230144
    buffer_store_dwordx4 v[120:123], v33, s[12:15], s35 offen sc1
    s_nop 1
    v_cvt_pk_bf16_f32 v116, v86, v90
    v_cvt_pk_bf16_f32 v117, v94, v98
    v_cvt_pk_bf16_f32 v118, v102, v106
    v_cvt_pk_bf16_f32 v119, v110, v114
    s_add_u32 s35, s34, 4757760
    buffer_store_dwordx4 v[116:119], v33, s[12:15], s35 offen sc1
    s_nop 1
    v_cvt_pk_bf16_f32 v120, v87, v91
    v_cvt_pk_bf16_f32 v121, v95, v99
    v_cvt_pk_bf16_f32 v122, v103, v107
    v_cvt_pk_bf16_f32 v123, v111, v115
    s_add_u32 s35, s34, 4758784
    buffer_store_dwordx4 v[120:123], v33, s[12:15], s35 offen sc1
    s_nop 1
    v_mfma_f32_16x16x32_bf16 v[84:87], v[44:47], v[52:55], 0
    v_mfma_f32_16x16x32_bf16 v[88:91], v[44:47], v[56:59], 0
    v_mfma_f32_16x16x32_bf16 v[92:95], v[44:47], v[60:63], 0
    v_mfma_f32_16x16x32_bf16 v[96:99], v[44:47], v[64:67], 0
    v_mfma_f32_16x16x32_bf16 v[100:103], v[44:47], v[68:71], 0
    v_mfma_f32_16x16x32_bf16 v[104:107], v[44:47], v[72:75], 0
    v_mfma_f32_16x16x32_bf16 v[108:111], v[44:47], v[76:79], 0
    v_mfma_f32_16x16x32_bf16 v[112:115], v[44:47], v[80:83], 0
    s_nop 7
    v_cvt_pk_bf16_f32 v116, v84, v88
    v_cvt_pk_bf16_f32 v117, v92, v96
    v_cvt_pk_bf16_f32 v118, v100, v104
    v_cvt_pk_bf16_f32 v119, v108, v112
    s_add_u32 s35, s34, 8458240
    buffer_store_dwordx4 v[116:119], v33, s[12:15], s35 offen sc1
    s_nop 1
    v_cvt_pk_bf16_f32 v120, v85, v89
    v_cvt_pk_bf16_f32 v121, v93, v97
    v_cvt_pk_bf16_f32 v122, v101, v105
    v_cvt_pk_bf16_f32 v123, v109, v113
    s_add_u32 s35, s34, 8459264
    buffer_store_dwordx4 v[120:123], v33, s[12:15], s35 offen sc1
    s_nop 1
    v_cvt_pk_bf16_f32 v116, v86, v90
    v_cvt_pk_bf16_f32 v117, v94, v98
    v_cvt_pk_bf16_f32 v118, v102, v106
    v_cvt_pk_bf16_f32 v119, v110, v114
    s_add_u32 s35, s34, 8986880
    buffer_store_dwordx4 v[116:119], v33, s[12:15], s35 offen sc1
    s_nop 1
    v_cvt_pk_bf16_f32 v120, v87, v91
    v_cvt_pk_bf16_f32 v121, v95, v99
    v_cvt_pk_bf16_f32 v122, v103, v107
    v_cvt_pk_bf16_f32 v123, v111, v115
    s_add_u32 s35, s34, 8987904
    buffer_store_dwordx4 v[120:123], v33, s[12:15], s35 offen sc1
    s_nop 1
    v_mfma_f32_16x16x32_bf16 v[84:87], v[48:51], v[52:55], 0
    v_mfma_f32_16x16x32_bf16 v[88:91], v[48:51], v[56:59], 0
    v_mfma_f32_16x16x32_bf16 v[92:95], v[48:51], v[60:63], 0
    v_mfma_f32_16x16x32_bf16 v[96:99], v[48:51], v[64:67], 0
    v_mfma_f32_16x16x32_bf16 v[100:103], v[48:51], v[68:71], 0
    v_mfma_f32_16x16x32_bf16 v[104:107], v[48:51], v[72:75], 0
    v_mfma_f32_16x16x32_bf16 v[108:111], v[48:51], v[76:79], 0
    v_mfma_f32_16x16x32_bf16 v[112:115], v[48:51], v[80:83], 0
    s_nop 7
    v_cvt_pk_bf16_f32 v116, v84, v88
    v_cvt_pk_bf16_f32 v117, v92, v96
    v_cvt_pk_bf16_f32 v118, v100, v104
    v_cvt_pk_bf16_f32 v119, v108, v112
    s_add_u32 s35, s34, 12687360
    buffer_store_dwordx4 v[116:119], v33, s[12:15], s35 offen sc1
    s_nop 1
    v_cvt_pk_bf16_f32 v120, v85, v89
    v_cvt_pk_bf16_f32 v121, v93, v97
    v_cvt_pk_bf16_f32 v122, v101, v105
    v_cvt_pk_bf16_f32 v123, v109, v113
    s_add_u32 s35, s34, 12688384
    buffer_store_dwordx4 v[120:123], v33, s[12:15], s35 offen sc1
    s_nop 1
    v_cvt_pk_bf16_f32 v116, v86, v90
    v_cvt_pk_bf16_f32 v117, v94, v98
    v_cvt_pk_bf16_f32 v118, v102, v106
    v_cvt_pk_bf16_f32 v119, v110, v114
    s_add_u32 s35, s34, 13216000
    buffer_store_dwordx4 v[116:119], v33, s[12:15], s35 offen sc1
    s_nop 1
    v_cvt_pk_bf16_f32 v120, v87, v91
    v_cvt_pk_bf16_f32 v121, v95, v99
    v_cvt_pk_bf16_f32 v122, v103, v107
    v_cvt_pk_bf16_f32 v123, v111, v115
    s_add_u32 s35, s34, 13217024
    buffer_store_dwordx4 v[120:123], v33, s[12:15], s35 offen sc1
    s_nop 1
    s_endpgm
L_prep_kernel_slab:
    s_load_dwordx2 s[6:7], s[0:1], 72
    s_cmp_eq_u32 s2, 12
    s_cbranch_scc1 L_prep_kernel_tab
    s_lshr_b32 s24, s2, 2
    s_and_b32 s26, s2, 3
    s_mov_b32 s25, 40
    s_cmp_eq_u32 s24, 1
    s_cselect_b32 s25, 32, s25
    s_cmp_eq_u32 s24, 2
    s_cselect_b32 s25, 48, s25
    s_load_dwordx2 s[4:5], s[0:1], s25
    s_load_dwordx2 s[28:29], s[0:1], 24
    v_and_b32 v1, 63, v0
    v_lshrrev_b32 v2, 3, v1
    s_lshl_b32 s27, s20, 6
    v_add_u32 v2, s27, v2
    v_lshlrev_b32 v2, 9, v2
    v_and_b32 v3, 7, v1
    v_lshl_add_u32 v2, v3, 4, v2
    s_lshl_b32 s27, s26, 7
    v_add_u32 v2, s27, v2
    s_waitcnt lgkmcnt(0)
    s_mov_b32 s8, s4
    s_mov_b32 s9, s5
    s_mov_b32 s10, 131072
    s_mov_b32 s11, 0x00020000
    s_add_u32 s12, s6, 85499904
    s_addc_u32 s13, s7, 0
    s_mov_b32 s14, 294912
    s_mov_b32 s15, 0x00020000
    s_lshl_b32 s31, s20, 13
    s_add_u32 m0, s31, 0
    s_mov_b32 s32, 0
    buffer_load_dwordx4 v2, s[8:11], s32 offen nt lds
    s_add_u32 m0, s31, 1024
    s_mov_b32 s32, 4096
    buffer_load_dwordx4 v2, s[8:11], s32 offen nt lds
    s_add_u32 m0, s31, 2048
    s_mov_b32 s32, 8192
    buffer_load_dwordx4 v2, s[8:11], s32 offen nt lds
    s_add_u32 m0, s31, 3072
    s_mov_b32 s32, 12288
    buffer_load_dwordx4 v2, s[8:11], s32 offen nt lds
    s_add_u32 m0, s31, 4096
    s_mov_b32 s32, 16384
    buffer_load_dwordx4 v2, s[8:11], s32 offen nt lds
    s_add_u32 m0, s31, 5120
    s_mov_b32 s32, 20480
    buffer_load_dwordx4 v2, s[8:11], s32 offen nt lds
    s_add_u32 m0, s31, 6144
    s_mov_b32 s32, 24576
    buffer_load_dwordx4 v2, s[8:11], s32 offen nt lds
    s_add_u32 m0, s31, 7168
    s_mov_b32 s32, 28672
    buffer_load_dwordx4 v2, s[8:11], s32 offen nt lds
    s_cmp_eq_u32 s24, 0
    s_cbranch_scc1 L_prep_kernel_ge
    v_bfe_u32 v4, v1, 2, 2
    v_lshrrev_b32 v5, 5, v1
    v_bfe_u32 v6, v1, 4, 1
    v_and_b32 v7, 3, v1
    s_cmp_eq_u32 s24, 1
    s_cbranch_scc0 L_prep_kernel_wo
    v_lshl_add_u32 v8, v5, 4, v4
    v_lshlrev_b32 v8, 7, v8
    v_lshl_add_u32 v8, v6, 5, v8
    v_lshl_add_u32 v8, v7, 3, v8
    s_lshl_b32 s33, s20, 13
    v_add_u32 v8, s33, v8
    s_mov_b32 s34, 32768
    s_lshl_b32 s35, s26, 15
    s_add_u32 s34, s34, s35
    s_lshl_b32 s35, s20, 12
    s_add_u32 s34, s34, s35
    v_lshlrev_b32 v9, 4, v1
    s_waitcnt vmcnt(0)
    s_barrier
    ds_read_b64_tr_b16 v[16:17], v8 offset:0
    ds_read_b64_tr_b16 v[18:19], v8 offset:1024
    ds_read_b64_tr_b16 v[20:21], v8 offset:512
    ds_read_b64_tr_b16 v[22:23], v8 offset:1536
    ds_read_b64_tr_b16 v[24:25], v8 offset:4096
    ds_read_b64_tr_b16 v[26:27], v8 offset:5120
    ds_read_b64_tr_b16 v[28:29], v8 offset:4608
    ds_read_b64_tr_b16 v[30:31], v8 offset:5632
    s_waitcnt lgkmcnt(0)
    s_add_u32 s35, s34, 0
    buffer_store_dwordx4 v[16:19], v9, s[12:15], s35 offen sc1
    s_add_u32 s35, s34, 1024
    buffer_store_dwordx4 v[20:23], v9, s[12:15], s35 offen sc1
    s_add_u32 s35, s34, 2048
    buffer_store_dwordx4 v[24:27], v9, s[12:15], s35 offen sc1
    s_add_u32 s35, s34, 3072
    buffer_store_dwordx4 v[28:31], v9, s[12:15], s35 offen sc1
    ds_read_b64_tr_b16 v[32:33], v8 offset:64
    ds_read_b64_tr_b16 v[34:35], v8 offset:1088
    ds_read_b64_tr_b16 v[36:37], v8 offset:576
    ds_read_b64_tr_b16 v[38:39], v8 offset:1600
    ds_read_b64_tr_b16 v[40:41], v8 offset:4160
    ds_read_b64_tr_b16 v[42:43], v8 offset:5184
    ds_read_b64_tr_b16 v[44:45], v8 offset:4672
    ds_read_b64_tr_b16 v[46:47], v8 offset:5696
    s_waitcnt lgkmcnt(0)
    s_add_u32 s35, s34, 16384
    buffer_store_dwordx4 v[32:35], v9, s[12:15], s35 offen sc1
    s_add_u32 s35, s34, 17408
    buffer_store_dwordx4 v[36:39], v9, s[12:15], s35 offen sc1
    s_add_u32 s35, s34, 18432
    buffer_store_dwordx4 v[40:43], v9, s[12:15], s35 offen sc1
    s_add_u32 s35, s34, 19456
    buffer_store_dwordx4 v[44:47], v9, s[12:15], s35 offen sc1
    s_endpgm
L_prep_kernel_wo:
    v_lshl_add_u32 v8, v5, 2, v4
    v_lshlrev_b32 v8, 7, v8
    v_lshl_add_u32 v8, v6, 5, v8
    v_and_b32 v10, 1, v7
    v_lshl_add_u32 v8, v10, 4, v8
    v_lshrrev_b32 v10, 1, v7
    v_lshl_add_u32 v8, v10, 3, v8
    s_lshl_b32 s33, s20, 13
    v_add_u32 v8, s33, v8
    s_mov_b32 s34, 163840
    s_lshl_b32 s35, s26, 15
    s_add_u32 s34, s34, s35
    s_lshl_b32 s35, s20, 12
    s_add_u32 s34, s34, s35
    v_lshlrev_b32 v9, 4, v1
    s_waitcnt vmcnt(0)
    s_barrier
    ds_read_b64_tr_b16 v[16:17], v8 offset:0
    ds_read_b64_tr_b16 v[18:19], v8 offset:1024
    ds_read_b64_tr_b16 v[20:21], v8 offset:2048
    ds_read_b64_tr_b16 v[22:23], v8 offset:3072
    ds_read_b64_tr_b16 v[24:25], v8 offset:4096
    ds_read_b64_tr_b16 v[26:27], v8 offset:5120
    ds_read_b64_tr_b16 v[28:29], v8 offset:6144
    ds_read_b64_tr_b16 v[30:31], v8 offset:7168
    s_waitcnt lgkmcnt(0)
    v_mov_b32 v48, 0x3f803f80
    v_mov_b32 v49, 0x3f803f80
    v_mov_b32 v50, 0x3f803f80
    v_mov_b32 v51, 0x3f803f80
    s_nop 1
    v_mfma_f32_32x32x16_bf16 v[64:79], v[16:19], v[48:51], 0
    v_mfma_f32_32x32x16_bf16 v[64:79], v[20:23], v[48:51], v[64:79]
    v_mfma_f32_32x32x16_bf16 v[64:79], v[24:27], v[48:51], v[64:79]
    v_mfma_f32_32x32x16_bf16 v[64:79], v[28:31], v[48:51], v[64:79]
    v_lshlrev_b32 v52, 16, v16
    v_and_b32 v53, 0xffff0000, v16
    v_mul_f32 v52, -2.0, v52
    v_mul_f32 v53, -2.0, v53
    v_cvt_pk_bf16_f32 v16, v52, v53
    v_lshlrev_b32 v52, 16, v17
    v_and_b32 v53, 0xffff0000, v17
    v_mul_f32 v52, -2.0, v52
    v_mul_f32 v53, -2.0, v53
    v_cvt_pk_bf16_f32 v17, v52, v53
    v_lshlrev_b32 v52, 16, v18
    v_and_b32 v53, 0xffff0000, v18
    v_mul_f32 v52, -2.0, v52
    v_mul_f32 v53, -2.0, v53
    v_cvt_pk_bf16_f32 v18, v52, v53
    v_lshlrev_b32 v52, 16, v19
    v_and_b32 v53, 0xffff0000, v19
    v_mul_f32 v52, -2.0, v52
    v_mul_f32 v53, -2.0, v53
    v_cvt_pk_bf16_f32 v19, v52, v53
    v_lshlrev_b32 v52, 16, v20
    v_and_b32 v53, 0xffff0000, v20
    v_mul_f32 v52, -2.0, v52
    v_mul_f32 v53, -2.0, v53
    v_cvt_pk_bf16_f32 v20, v52, v53
    v_lshlrev_b32 v52, 16, v21
    v_and_b32 v53, 0xffff0000, v21
    v_mul_f32 v52, -2.0, v52
    v_mul_f32 v53, -2.0, v53
    v_cvt_pk_bf16_f32 v21, v52, v53
    v_lshlrev_b32 v52, 16, v22
    v_and_b32 v53, 0xffff0000, v22
    v_mul_f32 v52, -2.0, v52
    v_mul_f32 v53, -2.0, v53
    v_cvt_pk_bf16_f32 v22, v52, v53
    v_lshlrev_b32 v52, 16, v23
    v_and_b32 v53, 0xffff0000, v23
    v_mul_f32 v52, -2.0, v52
    v_mul_f32 v53, -2.0, v53
    v_cvt_pk_bf16_f32 v23, v52, v53
    v_lshlrev_b32 v52, 16, v24
    v_and_b32 v53, 0xffff0000, v24
    v_mul_f32 v52, -2.0, v52
    v_mul_f32 v53, -2.0, v53
    v_cvt_pk_bf16_f32 v24, v52, v53
    v_lshlrev_b32 v52, 16, v25
    v_and_b32 v53, 0xffff0000, v25
    v_mul_f32 v52, -2.0, v52
    v_mul_f32 v53, -2.0, v53
    v_cvt_pk_bf16_f32 v25, v52, v53
    v_lshlrev_b32 v52, 16, v26
    v_and_b32 v53, 0xffff0000, v26
    v_mul_f32 v52, -2.0, v52
    v_mul_f32 v53, -2.0, v53
    v_cvt_pk_bf16_f32 v26, v52, v53
    v_lshlrev_b32 v52, 16, v27
    v_and_b32 v53, 0xffff0000, v27
    v_mul_f32 v52, -2.0, v52
    v_mul_f32 v53, -2.0, v53
    v_cvt_pk_bf16_f32 v27, v52, v53
    v_lshlrev_b32 v52, 16, v28
    v_and_b32 v53, 0xffff0000, v28
    v_mul_f32 v52, -2.0, v52
    v_mul_f32 v53, -2.0, v53
    v_cvt_pk_bf16_f32 v28, v52, v53
    v_lshlrev_b32 v52, 16, v29
    v_and_b32 v53, 0xffff0000, v29
    v_mul_f32 v52, -2.0, v52
    v_mul_f32 v53, -2.0, v53
    v_cvt_pk_bf16_f32 v29, v52, v53
    v_lshlrev_b32 v52, 16, v30
    v_and_b32 v53, 0xffff0000, v30
    v_mul_f32 v52, -2.0, v52
    v_mul_f32 v53, -2.0, v53
    v_cvt_pk_bf16_f32 v30, v52, v53
    v_lshlrev_b32 v52, 16, v31
    v_and_b32 v53, 0xffff0000, v31
    v_mul_f32 v52, -2.0, v52
    v_mul_f32 v53, -2.0, v53
    v_cvt_pk_bf16_f32 v31, v52, v53
    s_add_u32 s35, s34, 0
    buffer_store_dwordx4 v[16:19], v9, s[12:15], s35 offen sc1
    s_add_u32 s35, s34, 1024
    buffer_store_dwordx4 v[20:23], v9, s[12:15], s35 offen sc1
    s_add_u32 s35, s34, 2048
    buffer_store_dwordx4 v[24:27], v9, s[12:15], s35 offen sc1
    s_add_u32 s35, s34, 3072
    buffer_store_dwordx4 v[28:31], v9, s[12:15], s35 offen sc1
    ds_read_b64_tr_b16 v[32:33], v8 offset:64
    ds_read_b64_tr_b16 v[34:35], v8 offset:1088
    ds_read_b64_tr_b16 v[36:37], v8 offset:2112
    ds_read_b64_tr_b16 v[38:39], v8 offset:3136
    ds_read_b64_tr_b16 v[40:41], v8 offset:4160
    ds_read_b64_tr_b16 v[42:43], v8 offset:5184
    ds_read_b64_tr_b16 v[44:45], v8 offset:6208
    ds_read_b64_tr_b16 v[46:47], v8 offset:7232
    s_waitcnt lgkmcnt(0)
    v_mfma_f32_32x32x16_bf16 v[80:95], v[32:35], v[48:51], 0
    v_mfma_f32_32x32x16_bf16 v[80:95], v[36:39], v[48:51], v[80:95]
    v_mfma_f32_32x32x16_bf16 v[80:95], v[40:43], v[48:51], v[80:95]
    v_mfma_f32_32x32x16_bf16 v[80:95], v[44:47], v[48:51], v[80:95]
    v_lshlrev_b32 v52, 16, v32
    v_and_b32 v53, 0xffff0000, v32
    v_mul_f32 v52, -2.0, v52
    v_mul_f32 v53, -2.0, v53
    v_cvt_pk_bf16_f32 v32, v52, v53
    v_lshlrev_b32 v52, 16, v33
    v_and_b32 v53, 0xffff0000, v33
    v_mul_f32 v52, -2.0, v52
    v_mul_f32 v53, -2.0, v53
    v_cvt_pk_bf16_f32 v33, v52, v53
    v_lshlrev_b32 v52, 16, v34
    v_and_b32 v53, 0xffff0000, v34
    v_mul_f32 v52, -2.0, v52
    v_mul_f32 v53, -2.0, v53
    v_cvt_pk_bf16_f32 v34, v52, v53
    v_lshlrev_b32 v52, 16, v35
    v_and_b32 v53, 0xffff0000, v35
    v_mul_f32 v52, -2.0, v52
    v_mul_f32 v53, -2.0, v53
    v_cvt_pk_bf16_f32 v35, v52, v53
    v_lshlrev_b32 v52, 16, v36
    v_and_b32 v53, 0xffff0000, v36
    v_mul_f32 v52, -2.0, v52
    v_mul_f32 v53, -2.0, v53
    v_cvt_pk_bf16_f32 v36, v52, v53
    v_lshlrev_b32 v52, 16, v37
    v_and_b32 v53, 0xffff0000, v37
    v_mul_f32 v52, -2.0, v52
    v_mul_f32 v53, -2.0, v53
    v_cvt_pk_bf16_f32 v37, v52, v53
    v_lshlrev_b32 v52, 16, v38
    v_and_b32 v53, 0xffff0000, v38
    v_mul_f32 v52, -2.0, v52
    v_mul_f32 v53, -2.0, v53
    v_cvt_pk_bf16_f32 v38, v52, v53
    v_lshlrev_b32 v52, 16, v39
    v_and_b32 v53, 0xffff0000, v39
    v_mul_f32 v52, -2.0, v52
    v_mul_f32 v53, -2.0, v53
    v_cvt_pk_bf16_f32 v39, v52, v53
    v_lshlrev_b32 v52, 16, v40
    v_and_b32 v53, 0xffff0000, v40
    v_mul_f32 v52, -2.0, v52
    v_mul_f32 v53, -2.0, v53
    v_cvt_pk_bf16_f32 v40, v52, v53
    v_lshlrev_b32 v52, 16, v41
    v_and_b32 v53, 0xffff0000, v41
    v_mul_f32 v52, -2.0, v52
    v_mul_f32 v53, -2.0, v53
    v_cvt_pk_bf16_f32 v41, v52, v53
    v_lshlrev_b32 v52, 16, v42
    v_and_b32 v53, 0xffff0000, v42
    v_mul_f32 v52, -2.0, v52
    v_mul_f32 v53, -2.0, v53
    v_cvt_pk_bf16_f32 v42, v52, v53
    v_lshlrev_b32 v52, 16, v43
    v_and_b32 v53, 0xffff0000, v43
    v_mul_f32 v52, -2.0, v52
    v_mul_f32 v53, -2.0, v53
    v_cvt_pk_bf16_f32 v43, v52, v53
    v_lshlrev_b32 v52, 16, v44
    v_and_b32 v53, 0xffff0000, v44
    v_mul_f32 v52, -2.0, v52
    v_mul_f32 v53, -2.0, v53
    v_cvt_pk_bf16_f32 v44, v52, v53
    v_lshlrev_b32 v52, 16, v45
    v_and_b32 v53, 0xffff0000, v45
    v_mul_f32 v52, -2.0, v52
    v_mul_f32 v53, -2.0, v53
    v_cvt_pk_bf16_f32 v45, v52, v53
    v_lshlrev_b32 v52, 16, v46
    v_and_b32 v53, 0xffff0000, v46
    v_mul_f32 v52, -2.0, v52
    v_mul_f32 v53, -2.0, v53
    v_cvt_pk_bf16_f32 v46, v52, v53
    v_lshlrev_b32 v52, 16, v47
    v_and_b32 v53, 0xffff0000, v47
    v_mul_f32 v52, -2.0, v52
    v_mul_f32 v53, -2.0, v53
    v_cvt_pk_bf16_f32 v47, v52, v53
    s_add_u32 s35, s34, 16384
    buffer_store_dwordx4 v[32:35], v9, s[12:15], s35 offen sc1
    s_add_u32 s35, s34, 17408
    buffer_store_dwordx4 v[36:39], v9, s[12:15], s35 offen sc1
    s_add_u32 s35, s34, 18432
    buffer_store_dwordx4 v[40:43], v9, s[12:15], s35 offen sc1
    s_add_u32 s35, s34, 19456
    buffer_store_dwordx4 v[44:47], v9, s[12:15], s35 offen sc1
    s_nop 7
    s_barrier
    v_lshlrev_b32 v10, 6, v1
    s_lshl_b32 s35, s20, 13
    v_add_u32 v11, s35, v10
    ds_write_b128 v11, v[64:67] offset:0
    ds_write_b128 v11, v[68:71] offset:16
    ds_write_b128 v11, v[72:75] offset:32
    ds_write_b128 v11, v[76:79] offset:48
    ds_write_b128 v11, v[80:83] offset:4096
    ds_write_b128 v11, v[84:87] offset:4112
    ds_write_b128 v11, v[88:91] offset:4128
    ds_write_b128 v11, v[92:95] offset:4144
    s_waitcnt lgkmcnt(0)
    s_barrier
    s_cmp_ge_u32 s20, 2
    s_cbranch_scc1 L_prep_kernel_done
    s_lshl_b32 s35, s20, 12
    v_add_u32 v11, s35, v10
    ds_read_b128 v[16:19], v11 offset:0
    ds_read_b128 v[20:23], v11 offset:16
    ds_read_b128 v[24:27], v11 offset:32
    ds_read_b128 v[28:31], v11 offset:48
    ds_read_b128 v[32:35], v11 offset:8192
    ds_read_b128 v[36:39], v11 offset:8208
    ds_read_b128 v[40:43], v11 offset:8224
    ds_read_b128 v[44:47], v11 offset:8240
    s_waitcnt lgkmcnt(0)
    ds_read_b128 v[48:51], v11 offset:16384
    ds_read_b128 v[52:55], v11 offset:16400
    ds_read_b128 v[56:59], v11 offset:16416
    ds_read_b128 v[60:63], v11 offset:16432
    ds_read_b128 v[64:67], v11 offset:24576
    ds_read_b128 v[68:71], v11 offset:24592
    ds_read_b128 v[72:75], v11 offset:24608
    ds_read_b128 v[76:79], v11 offset:24624
    s_waitcnt lgkmcnt(0)
    v_add_f32 v16, v16, v32
    v_add_f32 v48, v48, v64
    v_add_f32 v17, v17, v33
    v_add_f32 v49, v49, v65
    v_add_f32 v18, v18, v34
    v_add_f32 v50, v50, v66
    v_add_f32 v19, v19, v35
    v_add_f32 v51, v51, v67
    v_add_f32 v20, v20, v36
    v_add_f32 v52, v52, v68
    v_add_f32 v21, v21, v37
    v_add_f32 v53, v53, v69
    v_add_f32 v22, v22, v38
    v_add_f32 v54, v54, v70
    v_add_f32 v23, v23, v39
    v_add_f32 v55, v55, v71
    v_add_f32 v24, v24, v40
    v_add_f32 v56, v56, v72
    v_add_f32 v25, v25, v41
    v_add_f32 v57, v57, v73
    v_add_f32 v26, v26, v42
    v_add_f32 v58, v58, v74
    v_add_f32 v27, v27, v43
    v_add_f32 v59, v59, v75
    v_add_f32 v28, v28, v44
    v_add_f32 v60, v60, v76
    v_add_f32 v29, v29, v45
    v_add_f32 v61, v61, v77
    v_add_f32 v30, v30, v46
    v_add_f32 v62, v62, v78
    v_add_f32 v31, v31, v47
    v_add_f32 v63, v63, v79
    v_add_f32 v16, v16, v48
    v_add_f32 v17, v17, v49
    v_add_f32 v18, v18, v50
    v_add_f32 v19, v19, v51
    v_add_f32 v20, v20, v52
    v_add_f32 v21, v21, v53
    v_add_f32 v22, v22, v54
    v_add_f32 v23, v23, v55
    v_add_f32 v24, v24, v56
    v_add_f32 v25, v25, v57
    v_add_f32 v26, v26, v58
    v_add_f32 v27, v27, v59
    v_add_f32 v28, v28, v60
    v_add_f32 v29, v29, v61
    v_add_f32 v30, v30, v62
    v_add_f32 v31, v31, v63
    v_and_b32 v10, 31, v1
    v_cmp_eq_u32 vcc, 0, v10
    v_lshrrev_b32 v10, 5, v1
    v_lshlrev_b32 v10, 6, v10
    s_lshl_b32 s35, s26, 8
    s_lshl_b32 s36, s20, 7
    s_add_u32 s35, s35, s36
    s_add_u32 s35, s35, 14336
    s_and_saveexec_b64 s[38:39], vcc
    buffer_store_dwordx4 v[16:19], v10, s[12:15], s35 offen offset:0 sc1
    buffer_store_dwordx4 v[20:23], v10, s[12:15], s35 offen offset:16 sc1
    buffer_store_dwordx4 v[24:27], v10, s[12:15], s35 offen offset:32 sc1
    buffer_store_dwordx4 v[28:31], v10, s[12:15], s35 offen offset:48 sc1
    s_endpgm
L_prep_kernel_ge:
    s_mov_b32 s36, s28
    s_mov_b32 s37, s29
    s_mov_b32 s38, 8192
    s_mov_b32 s39, 0x00020000
    v_and_b32 v4, 15, v1
    v_lshrrev_b32 v5, 4, v1
    v_lshlrev_b32 v6, 9, v4
    v_lshl_add_u32 v6, v5, 4, v6
    buffer_load_dwordx4 v[16:19], v6, s[36:39], 0 offen offset:0
    buffer_load_dwordx4 v[20:23], v6, s[36:39], 0 offen offset:64
    buffer_load_dwordx4 v[24:27], v6, s[36:39], 0 offen offset:128
    buffer_load_dwordx4 v[28:31], v6, s[36:39], 0 offen offset:192
    buffer_load_dwordx4 v[32:35], v6, s[36:39], 0 offen offset:256
    buffer_load_dwordx4 v[36:39], v6, s[36:39], 0 offen offset:320
    buffer_load_dwordx4 v[40:43], v6, s[36:39], 0 offen offset:384
    buffer_load_dwordx4 v[44:47], v6, s[36:39], 0 offen offset:448
    v_bfe_u32 v7, v1, 2, 2
    v_lshl_add_u32 v7, v5, 3, v7
    v_lshlrev_b32 v7, 7, v7
    v_and_b32 v8, 3, v1
    v_lshl_add_u32 v7, v8, 3, v7
    s_lshl_b32 s33, s20, 5
    v_add_u32 v7, s33, v7
    s_waitcnt vmcnt(0)
    s_barrier
    ds_read_b64_tr_b16 v[48:49], v7 offset:0
    ds_read_b64_tr_b16 v[50:51], v7 offset:512
    ds_read_b64_tr_b16 v[52:53], v7 offset:4096
    ds_read_b64_tr_b16 v[54:55], v7 offset:4608
    ds_read_b64_tr_b16 v[56:57], v7 offset:8192
    ds_read_b64_tr_b16 v[58:59], v7 offset:8704
    ds_read_b64_tr_b16 v[60:61], v7 offset:12288
    ds_read_b64_tr_b16 v[62:63], v7 offset:12800
    s_waitcnt lgkmcnt(0)
    ds_read_b64_tr_b16 v[64:65], v7 offset:16384
    ds_read_b64_tr_b16 v[66:67], v7 offset:16896
    ds_read_b64_tr_b16 v[68:69], v7 offset:20480
    ds_read_b64_tr_b16 v[70:71], v7 offset:20992
    ds_read_b64_tr_b16 v[72:73], v7 offset:24576
    ds_read_b64_tr_b16 v[74:75], v7 offset:25088
    ds_read_b64_tr_b16 v[76:77], v7 offset:28672
    ds_read_b64_tr_b16 v[78:79], v7 offset:29184
    s_waitcnt lgkmcnt(0)
    v_mfma_f32_16x16x32_bf16 v[80:83], v[48:51], v[16:19], 0
    v_mfma_f32_16x16x32_bf16 v[80:83], v[52:55], v[20:23], v[80:83]
    v_mfma_f32_16x16x32_bf16 v[80:83], v[56:59], v[24:27], v[80:83]
    v_mfma_f32_16x16x32_bf16 v[80:83], v[60:63], v[28:31], v[80:83]
    v_mfma_f32_16x16x32_bf16 v[80:83], v[64:67], v[32:35], v[80:83]
    v_mfma_f32_16x16x32_bf16 v[80:83], v[68:71], v[36:39], v[80:83]
    v_mfma_f32_16x16x32_bf16 v[80:83], v[72:75], v[40:43], v[80:83]
    v_mfma_f32_16x16x32_bf16 v[80:83], v[76:79], v[44:47], v[80:83]
    s_nop 7
    v_cvt_pk_bf16_f32 v84, v80, v81
    v_cvt_pk_bf16_f32 v85, v82, v83
    s_mov_b32 s33, 0x4038aa3b
    v_lshlrev_b32 v80, 16, v84
    v_and_b32 v81, 0xffff0000, v84
    v_lshlrev_b32 v82, 16, v85
    v_and_b32 v83, 0xffff0000, v85
    v_mul_f32 v80, s33, v80
    v_mul_f32 v81, s33, v81
    v_mul_f32 v82, s33, v82
    v_mul_f32 v83, s33, v83
    v_lshlrev_b32 v6, 10, v4
    v_lshl_add_u32 v6, v5, 4, v6
    s_lshl_b32 s33, s26, 8
    s_lshl_b32 s34, s20, 6
    s_add_u32 s33, s33, s34
    s_add_u32 s33, s33, 16384
    buffer_store_dwordx4 v[80:83], v6, s[12:15], s33 offen sc1
    s_endpgm
L_prep_kernel_tab:
    v_and_b32 v8, 63, v0
    v_lshlrev_b32 v6, 4, v8
    s_waitcnt lgkmcnt(0)
    s_add_u32 s12, s6, 85499904
    s_addc_u32 s13, s7, 0
    s_mov_b32 s14, 294912
    s_mov_b32 s15, 0x00020000
    s_lshl_b32 s32, s20, 4
    s_lshl_b32 s33, s20, 11
    v_and_b32 v9, 15, v8
    v_lshrrev_b32 v10, 4, v8
    v_or_b32 v11, 1, v9
    v_add_u32 v11, s32, v11
    v_cvt_f32_u32 v11, v11
    v_mul_f32 v11, 0x3c000000, v11
    v_lshlrev_b32 v10, 3, v10
    v_add_u32 v10, 0, v10
    v_cvt_f32_u32 v10, v10
    v_and_b32 v9, 1, v9
    v_cvt_f32_u32 v9, v9
    v_mul_f32 v9, 0x3e800000, v9
    v_fma_f32 v12, v11, v10, v9
    v_fract_f32 v13, v12
    v_add_f32 v12, v12, v11
    v_fract_f32 v14, v12
    v_add_f32 v12, v12, v11
    v_fract_f32 v15, v12
    v_add_f32 v12, v12, v11
    v_fract_f32 v16, v12
    v_add_f32 v12, v12, v11
    v_fract_f32 v17, v12
    v_add_f32 v12, v12, v11
    v_fract_f32 v18, v12
    v_add_f32 v12, v12, v11
    v_fract_f32 v19, v12
    v_add_f32 v12, v12, v11
    v_fract_f32 v20, v12
    v_cos_f32 v13, v13
    v_cos_f32 v14, v14
    v_cos_f32 v15, v15
    v_cos_f32 v16, v16
    v_cos_f32 v17, v17
    v_cos_f32 v18, v18
    v_cos_f32 v19, v19
    v_cos_f32 v20, v20
    s_nop 0
    v_cvt_pk_bf16_f32 v24, v13, v14
    v_cvt_pk_bf16_f32 v25, v15, v16
    v_cvt_pk_bf16_f32 v26, v17, v18
    v_cvt_pk_bf16_f32 v27, v19, v20
    s_add_u32 s34, s33, 0
    buffer_store_dwordx4 v[24:27], v6, s[12:15], s34 offen sc1
    v_and_b32 v9, 15, v8
    v_lshrrev_b32 v10, 4, v8
    v_or_b32 v11, 1, v9
    v_add_u32 v11, s32, v11
    v_cvt_f32_u32 v11, v11
    v_mul_f32 v11, 0x3c000000, v11
    v_lshlrev_b32 v10, 3, v10
    v_add_u32 v10, 32, v10
    v_cvt_f32_u32 v10, v10
    v_and_b32 v9, 1, v9
    v_cvt_f32_u32 v9, v9
    v_mul_f32 v9, 0x3e800000, v9
    v_fma_f32 v12, v11, v10, v9
    v_fract_f32 v13, v12
    v_add_f32 v12, v12, v11
    v_fract_f32 v14, v12
    v_add_f32 v12, v12, v11
    v_fract_f32 v15, v12
    v_add_f32 v12, v12, v11
    v_fract_f32 v16, v12
    v_add_f32 v12, v12, v11
    v_fract_f32 v17, v12
    v_add_f32 v12, v12, v11
    v_fract_f32 v18, v12
    v_add_f32 v12, v12, v11
    v_fract_f32 v19, v12
    v_add_f32 v12, v12, v11
    v_fract_f32 v20, v12
    v_cos_f32 v13, v13
    v_cos_f32 v14, v14
    v_cos_f32 v15, v15
    v_cos_f32 v16, v16
    v_cos_f32 v17, v17
    v_cos_f32 v18, v18
    v_cos_f32 v19, v19
    v_cos_f32 v20, v20
    s_nop 0
    v_cvt_pk_bf16_f32 v28, v13, v14
    v_cvt_pk_bf16_f32 v29, v15, v16
    v_cvt_pk_bf16_f32 v30, v17, v18
    v_cvt_pk_bf16_f32 v31, v19, v20
    s_add_u32 s34, s33, 1024
    buffer_store_dwordx4 v[28:31], v6, s[12:15], s34 offen sc1
    s_cmp_ge_u32 s20, 3
    s_cbranch_scc1 L_prep_kernel_done
    v_and_b32 v9, 15, v8
    v_add_u32 v9, s32, v9
    v_cvt_f32_u32 v9, v9
    v_mul_f32 v9, 0x3c000000, v9
    v_lshrrev_b32 v10, 4, v8
    v_lshlrev_b32 v10, 3, v10
    v_add_u32 v11, 1, v10
    v_cvt_f32_u32 v11, v11
    v_mul_f32 v11, v11, v9
    v_fract_f32 v12, v11
    v_add_u32 v11, 1, v10
    v_cvt_f32_u32 v11, v11
    v_mul_f32 v11, v11, v9
    v_add_f32 v11, 0x3e800000, v11
    v_fract_f32 v13, v11
    v_add_u32 v11, 3, v10
    v_cvt_f32_u32 v11, v11
    v_mul_f32 v11, v11, v9
    v_fract_f32 v14, v11
    v_add_u32 v11, 3, v10
    v_cvt_f32_u32 v11, v11
    v_mul_f32 v11, v11, v9
    v_add_f32 v11, 0x3e800000, v11
    v_fract_f32 v15, v11
    v_add_u32 v11, 5, v10
    v_cvt_f32_u32 v11, v11
    v_mul_f32 v11, v11, v9
    v_fract_f32 v16, v11
    v_add_u32 v11, 5, v10
    v_cvt_f32_u32 v11, v11
    v_mul_f32 v11, v11, v9
    v_add_f32 v11, 0x3e800000, v11
    v_fract_f32 v17, v11
    v_add_u32 v11, 7, v10
    v_cvt_f32_u32 v11, v11
    v_mul_f32 v11, v11, v9
    v_fract_f32 v18, v11
    v_add_u32 v11, 7, v10
    v_cvt_f32_u32 v11, v11
    v_mul_f32 v11, v11, v9
    v_add_f32 v11, 0x3e800000, v11
    v_fract_f32 v19, v11
    v_cos_f32 v12, v12
    v_cos_f32 v13, v13
    v_cos_f32 v14, v14
    v_cos_f32 v15, v15
    v_cos_f32 v16, v16
    v_cos_f32 v17, v17
    v_cos_f32 v18, v18
    v_cos_f32 v19, v19
    s_nop 0
    v_cvt_pk_bf16_f32 v24, v12, v13
    v_cvt_pk_bf16_f32 v25, v14, v15
    v_cvt_pk_bf16_f32 v26, v16, v17
    v_cvt_pk_bf16_f32 v27, v18, v19
    s_add_u32 s34, s33, 8192
    buffer_store_dwordx4 v[24:27], v6, s[12:15], s34 offen sc1
    s_nop 1
    v_add_u32 v11, 33, v10
    v_cvt_f32_u32 v11, v11
    v_mul_f32 v11, v11, v9
    v_fract_f32 v12, v11
    v_add_u32 v11, 33, v10
    v_cvt_f32_u32 v11, v11
    v_mul_f32 v11, v11, v9
    v_add_f32 v11, 0x3e800000, v11
    v_fract_f32 v13, v11
    v_add_u32 v11, 35, v10
    v_cvt_f32_u32 v11, v11
    v_mul_f32 v11, v11, v9
    v_fract_f32 v14, v11
    v_add_u32 v11, 35, v10
    v_cvt_f32_u32 v11, v11
    v_mul_f32 v11, v11, v9
    v_add_f32 v11, 0x3e800000, v11
    v_fract_f32 v15, v11
    v_add_u32 v11, 37, v10
    v_cvt_f32_u32 v11, v11
    v_mul_f32 v11, v11, v9
    v_fract_f32 v16, v11
    v_add_u32 v11, 37, v10
    v_cvt_f32_u32 v11, v11
    v_mul_f32 v11, v11, v9
    v_add_f32 v11, 0x3e800000, v11
    v_fract_f32 v17, v11
    v_add_u32 v11, 39, v10
    v_cvt_f32_u32 v11, v11
    v_mul_f32 v11, v11, v9
    v_fract_f32 v18, v11
    v_add_u32 v11, 39, v10
    v_cvt_f32_u32 v11, v11
    v_mul_f32 v11, v11, v9
    v_add_f32 v11, 0x3e800000, v11
    v_fract_f32 v19, v11
    v_cos_f32 v12, v12
    v_cos_f32 v13, v13
    v_cos_f32 v14, v14
    v_cos_f32 v15, v15
    v_cos_f32 v16, v16
    v_cos_f32 v17, v17
    v_cos_f32 v18, v18
    v_cos_f32 v19, v19
    s_nop 0
    v_cvt_pk_bf16_f32 v24, v12, v13
    v_cvt_pk_bf16_f32 v25, v14, v15
    v_cvt_pk_bf16_f32 v26, v16, v17
    v_cvt_pk_bf16_f32 v27, v18, v19
    s_add_u32 s34, s33, 9216
    buffer_store_dwordx4 v[24:27], v6, s[12:15], s34 offen sc1
    s_nop 1
L_prep_kernel_done:
    s_endpgm
.globl gemm1_kernel
.p2align 8
.type gemm1_kernel,@function
gemm1_kernel:
    s_cmp_ge_u32 s2, 256
    s_cbranch_scc1 L_gemm1_kernel_done
    s_load_dwordx2 s[4:5], s[0:1], 72
    s_load_dwordx2 s[6:7], s[0:1], 72
    v_readfirstlane_b32 s20, v0
    s_lshr_b32 s20, s20, 6
    s_and_b32 s24, s2, 7
    s_lshr_b32 s25, s2, 3
    s_lshr_b32 s26, s25, 3
    s_lshl_b32 s24, s24, 2
    s_add_u32 s21, s24, s26
    s_and_b32 s25, s25, 7
    s_lshr_b32 s26, s25, 1
    s_and_b32 s27, s25, 1
    s_mul_i32 s22, s26, 84
    s_sub_u32 s28, 334, s22
    s_min_u32 s28, s28, 84
    s_waitcnt lgkmcnt(0)
    s_mul_i32 s29, s21, 684032
    s_lshl_b32 s30, s22, 11
    s_add_u32 s29, s29, s30
    s_add_u32 s29, s29, 0
    s_add_u32 s8, s6, s29
    s_addc_u32 s9, s7, 0
    s_lshl_b32 s10, s28, 11
    s_mov_b32 s11, 0x00020000
    s_mul_i32 s29, s21, 528640
    s_mul_i32 s30, s27, 16384
    s_add_u32 s29, s29, s30
    s_add_u32 s29, s29, 21954560
    s_add_u32 s12, s4, s29
    s_addc_u32 s13, s5, 0
    s_mov_b32 s14, 507904
    s_mov_b32 s15, 0x00020000
    s_cmp_ge_u32 s20, 4
    s_cbranch_scc1 L_gemm1_kernel_loader
    s_mul_i32 s29, s22, 37120
    s_add_u32 s29, s29, 38871040
    s_add_u32 s16, s4, s29
    s_addc_u32 s17, s5, 0
    s_mul_i32 s18, s28, 37120
    s_mov_b32 s19, 0x00020000
    s_lshr_b32 s29, s20, 1
    s_and_b32 s30, s20, 1
    v_and_b32 v217, 15, v0
    v_bfe_u32 v218, v0, 4, 2
    v_and_b32 v219, 63, v0
    s_mul_i32 s31, s29, 6144
    v_and_b32 v220, 7, v217
    v_xor_b32 v220, v218, v220
    v_lshlrev_b32 v220, 4, v220
    v_lshl_add_u32 v220, v217, 7, v220
    v_add_u32 v220, s31, v220
    v_add_u32 v208, 0, v220
    v_xor_b32 v211, 64, v208
    v_add_u32 v209, 57344, v220
    v_xor_b32 v212, 64, v209
    v_add_u32 v210, 114688, v220
    v_xor_b32 v213, 64, v210
    s_mul_i32 s31, s30, 8192
    s_add_u32 s31, s31, 12288
    v_lshlrev_b32 v220, 4, v219
    v_add_u32 v220, s31, v220
    v_add_u32 v214, 0, v220
    v_add_u32 v215, 57344, v220
    v_add_u32 v216, 114688, v220
    v_and_b32 v224, 7, v217
    v_lshrrev_b32 v225, 3, v217
    v_mul_u32_u24 v222, 37120, v224
    v_lshl_add_u32 v222, v218, 4, v222
    s_mul_i32 s31, s29, 1781760
    v_add_u32 v222, s31, v222
    v_lshl_add_u32 v222, v225, 6, v222
    v_xor_b32 v225, 64, v222
    v_add_u32 v223, 296960, v225
    s_mul_i32 s31, s27, 4
    s_mul_i32 s29, s30, 2
    s_add_u32 s31, s31, s29
    s_lshl_b32 s31, s31, 12
    s_lshl_b32 s29, s21, 7
    s_add_u32 s33, s31, s29
    s_mov_b32 s34, 0x80008000
    s_barrier
    ds_read_b128 v[96:99], v214 offset:0
    ds_read_b128 v[128:131], v208 offset:0
    ds_read_b128 v[136:139], v208 offset:2048
    ds_read_b128 v[144:147], v208 offset:4096
    ds_read_b128 v[104:107], v214 offset:2048
    ds_read_b128 v[112:115], v214 offset:4096
    ds_read_b128 v[120:123], v214 offset:6144
    ds_read_b128 v[132:135], v211 offset:0
    ds_read_b128 v[140:143], v211 offset:2048
    ds_read_b128 v[148:151], v211 offset:4096
    ds_read_b128 v[100:103], v214 offset:1024
    ds_read_b128 v[108:111], v214 offset:3072
    ds_read_b128 v[116:119], v214 offset:5120
    ds_read_b128 v[124:127], v214 offset:7168
    s_waitcnt lgkmcnt(0)
    s_barrier
    v_mfma_f32_16x16x32_bf16 v[0:3], v[96:99], v[128:131], 0
    ds_read_b128 v[152:155], v214 offset:28672
    v_mfma_f32_16x16x32_bf16 v[4:7], v[96:99], v[136:139], 0
    v_mfma_f32_16x16x32_bf16 v[8:11], v[96:99], v[144:147], 0
    ds_read_b128 v[184:187], v208 offset:28672
    v_mfma_f32_16x16x32_bf16 v[12:15], v[104:107], v[128:131], 0
    v_mfma_f32_16x16x32_bf16 v[16:19], v[104:107], v[136:139], 0
    ds_read_b128 v[192:195], v208 offset:30720
    v_mfma_f32_16x16x32_bf16 v[20:23], v[104:107], v[144:147], 0
    v_mfma_f32_16x16x32_bf16 v[24:27], v[112:115], v[128:131], 0
    ds_read_b128 v[200:203], v208 offset:32768
    v_mfma_f32_16x16x32_bf16 v[28:31], v[112:115], v[136:139], 0
    v_mfma_f32_16x16x32_bf16 v[32:35], v[112:115], v[144:147], 0
    ds_read_b128 v[160:163], v214 offset:30720
    v_mfma_f32_16x16x32_bf16 v[36:39], v[120:123], v[128:131], 0
    v_mfma_f32_16x16x32_bf16 v[40:43], v[120:123], v[136:139], 0
    ds_read_b128 v[168:171], v214 offset:32768
    v_mfma_f32_16x16x32_bf16 v[44:47], v[120:123], v[144:147], 0
    v_mfma_f32_16x16x32_bf16 v[48:51], v[96:99], v[132:135], 0
    ds_read_b128 v[176:179], v214 offset:34816
    v_mfma_f32_16x16x32_bf16 v[52:55], v[96:99], v[140:143], 0
    v_mfma_f32_16x16x32_bf16 v[56:59], v[96:99], v[148:151], 0
    ds_read_b128 v[188:191], v211 offset:28672
    v_mfma_f32_16x16x32_bf16 v[60:63], v[104:107], v[132:135], 0
    v_mfma_f32_16x16x32_bf16 v[64:67], v[104:107], v[140:143], 0
    ds_read_b128 v[196:199], v211 offset:30720
    v_mfma_f32_16x16x32_bf16 v[68:71], v[104:107], v[148:151], 0
    v_mfma_f32_16x16x32_bf16 v[72:75], v[112:115], v[132:135], 0
    ds_read_b128 v[204:207], v211 offset:32768
    v_mfma_f32_16x16x32_bf16 v[76:79], v[112:115], v[140:143], 0
    v_mfma_f32_16x16x32_bf16 v[80:83], v[112:115], v[148:151], 0
    ds_read_b128 v[156:159], v214 offset:29696
    v_mfma_f32_16x16x32_bf16 v[84:87], v[120:123], v[132:135], 0
    v_mfma_f32_16x16x32_bf16 v[88:91], v[120:123], v[140:143], 0
    ds_read_b128 v[164:167], v214 offset:31744
    v_mfma_f32_16x16x32_bf16 v[92:95], v[120:123], v[148:151], 0
    v_mfma_f32_16x16x32_bf16 v[48:51], v[100:103], v[128:131], v[48:51]
    ds_read_b128 v[172:175], v214 offset:33792
    v_xor_b32 v132, s34, v132
    v_xor_b32 v133, s34, v133
    v_mfma_f32_16x16x32_bf16 v[52:55], v[100:103], v[136:139], v[52:55]
    v_xor_b32 v134, s34, v134
    v_xor_b32 v135, s34, v135
    v_mfma_f32_16x16x32_bf16 v[56:59], v[100:103], v[144:147], v[56:59]
    ds_read_b128 v[180:183], v214 offset:35840
    v_xor_b32 v140, s34, v140
    v_xor_b32 v141, s34, v141
    v_mfma_f32_16x16x32_bf16 v[60:63], v[108:111], v[128:131], v[60:63]
    v_xor_b32 v142, s34, v142
    v_xor_b32 v143, s34, v143
    v_mfma_f32_16x16x32_bf16 v[64:67], v[108:111], v[136:139], v[64:67]
    v_xor_b32 v148, s34, v148
    v_xor_b32 v149, s34, v149
    v_mfma_f32_16x16x32_bf16 v[68:71], v[108:111], v[144:147], v[68:71]
    v_xor_b32 v150, s34, v150
    v_xor_b32 v151, s34, v151
    v_mfma_f32_16x16x32_bf16 v[72:75], v[116:119], v[128:131], v[72:75]
    v_mfma_f32_16x16x32_bf16 v[76:79], v[116:119], v[136:139], v[76:79]
    v_mfma_f32_16x16x32_bf16 v[80:83], v[116:119], v[144:147], v[80:83]
    v_mfma_f32_16x16x32_bf16 v[84:87], v[124:127], v[128:131], v[84:87]
    v_mfma_f32_16x16x32_bf16 v[88:91], v[124:127], v[136:139], v[88:91]
    v_mfma_f32_16x16x32_bf16 v[92:95], v[124:127], v[144:147], v[92:95]
    v_mfma_f32_16x16x32_bf16 v[0:3], v[100:103], v[132:135], v[0:3]
    v_mfma_f32_16x16x32_bf16 v[4:7], v[100:103], v[140:143], v[4:7]
    v_mfma_f32_16x16x32_bf16 v[8:11], v[100:103], v[148:151], v[8:11]
    v_mfma_f32_16x16x32_bf16 v[12:15], v[108:111], v[132:135], v[12:15]
    v_mfma_f32_16x16x32_bf16 v[16:19], v[108:111], v[140:143], v[16:19]
    s_waitcnt lgkmcnt(0)
    s_barrier
    v_mfma_f32_16x16x32_bf16 v[20:23], v[108:111], v[148:151], v[20:23]
    v_mfma_f32_16x16x32_bf16 v[24:27], v[116:119], v[132:135], v[24:27]
    v_mfma_f32_16x16x32_bf16 v[28:31], v[116:119], v[140:143], v[28:31]
    v_mfma_f32_16x16x32_bf16 v[32:35], v[116:119], v[148:151], v[32:35]
    v_mfma_f32_16x16x32_bf16 v[36:39], v[124:127], v[132:135], v[36:39]
    v_mfma_f32_16x16x32_bf16 v[40:43], v[124:127], v[140:143], v[40:43]
    v_mfma_f32_16x16x32_bf16 v[44:47], v[124:127], v[148:151], v[44:47]
    v_mfma_f32_16x16x32_bf16 v[0:3], v[152:155], v[184:187], v[0:3]
    ds_read_b128 v[96:99], v215 offset:0
    v_mfma_f32_16x16x32_bf16 v[4:7], v[152:155], v[192:195], v[4:7]
    v_mfma_f32_16x16x32_bf16 v[8:11], v[152:155], v[200:203], v[8:11]
    ds_read_b128 v[128:131], v209 offset:0
    v_mfma_f32_16x16x32_bf16 v[12:15], v[160:163], v[184:187], v[12:15]
    v_mfma_f32_16x16x32_bf16 v[16:19], v[160:163], v[192:195], v[16:19]
    ds_read_b128 v[136:139], v209 offset:2048
    v_mfma_f32_16x16x32_bf16 v[20:23], v[160:163], v[200:203], v[20:23]
    v_mfma_f32_16x16x32_bf16 v[24:27], v[168:171], v[184:187], v[24:27]
    ds_read_b128 v[144:147], v209 offset:4096
    v_mfma_f32_16x16x32_bf16 v[28:31], v[168:171], v[192:195], v[28:31]
    v_mfma_f32_16x16x32_bf16 v[32:35], v[168:171], v[200:203], v[32:35]
    ds_read_b128 v[104:107], v215 offset:2048
    v_mfma_f32_16x16x32_bf16 v[36:39], v[176:179], v[184:187], v[36:39]
    v_mfma_f32_16x16x32_bf16 v[40:43], v[176:179], v[192:195], v[40:43]
    ds_read_b128 v[112:115], v215 offset:4096
    v_mfma_f32_16x16x32_bf16 v[44:47], v[176:179], v[200:203], v[44:47]
    v_mfma_f32_16x16x32_bf16 v[48:51], v[152:155], v[188:191], v[48:51]
    ds_read_b128 v[120:123], v215 offset:6144
    v_mfma_f32_16x16x32_bf16 v[52:55], v[152:155], v[196:199], v[52:55]
    v_mfma_f32_16x16x32_bf16 v[56:59], v[152:155], v[204:207], v[56:59]
    ds_read_b128 v[132:135], v212 offset:0
    v_mfma_f32_16x16x32_bf16 v[60:63], v[160:163], v[188:191], v[60:63]
    v_mfma_f32_16x16x32_bf16 v[64:67], v[160:163], v[196:199], v[64:67]
    ds_read_b128 v[140:143], v212 offset:2048
    v_mfma_f32_16x16x32_bf16 v[68:71], v[160:163], v[204:207], v[68:71]
    v_mfma_f32_16x16x32_bf16 v[72:75], v[168:171], v[188:191], v[72:75]
    ds_read_b128 v[148:151], v212 offset:4096
    v_mfma_f32_16x16x32_bf16 v[76:79], v[168:171], v[196:199], v[76:79]
    v_mfma_f32_16x16x32_bf16 v[80:83], v[168:171], v[204:207], v[80:83]
    ds_read_b128 v[100:103], v215 offset:1024
    v_mfma_f32_16x16x32_bf16 v[84:87], v[176:179], v[188:191], v[84:87]
    v_mfma_f32_16x16x32_bf16 v[88:91], v[176:179], v[196:199], v[88:91]
    ds_read_b128 v[108:111], v215 offset:3072
    v_mfma_f32_16x16x32_bf16 v[92:95], v[176:179], v[204:207], v[92:95]
    v_mfma_f32_16x16x32_bf16 v[48:51], v[156:159], v[184:187], v[48:51]
    ds_read_b128 v[116:119], v215 offset:5120
    v_xor_b32 v188, s34, v188
    v_xor_b32 v189, s34, v189
    v_mfma_f32_16x16x32_bf16 v[52:55], v[156:159], v[192:195], v[52:55]
    v_xor_b32 v190, s34, v190
    v_xor_b32 v191, s34, v191
    v_mfma_f32_16x16x32_bf16 v[56:59], v[156:159], v[200:203], v[56:59]
    ds_read_b128 v[124:127], v215 offset:7168
    v_xor_b32 v196, s34, v196
    v_xor_b32 v197, s34, v197
    v_mfma_f32_16x16x32_bf16 v[60:63], v[164:167], v[184:187], v[60:63]
    v_xor_b32 v198, s34, v198
    v_xor_b32 v199, s34, v199
    v_mfma_f32_16x16x32_bf16 v[64:67], v[164:167], v[192:195], v[64:67]
    v_xor_b32 v204, s34, v204
    v_xor_b32 v205, s34, v205
    v_mfma_f32_16x16x32_bf16 v[68:71], v[164:167], v[200:203], v[68:71]
    v_xor_b32 v206, s34, v206
    v_xor_b32 v207, s34, v207
    v_mfma_f32_16x16x32_bf16 v[72:75], v[172:175], v[184:187], v[72:75]
    v_mfma_f32_16x16x32_bf16 v[76:79], v[172:175], v[192:195], v[76:79]
    v_mfma_f32_16x16x32_bf16 v[80:83], v[172:175], v[200:203], v[80:83]
    v_mfma_f32_16x16x32_bf16 v[84:87], v[180:183], v[184:187], v[84:87]
    v_mfma_f32_16x16x32_bf16 v[88:91], v[180:183], v[192:195], v[88:91]
    v_mfma_f32_16x16x32_bf16 v[92:95], v[180:183], v[200:203], v[92:95]
    v_mfma_f32_16x16x32_bf16 v[0:3], v[156:159], v[188:191], v[0:3]
    v_mfma_f32_16x16x32_bf16 v[4:7], v[156:159], v[196:199], v[4:7]
    v_mfma_f32_16x16x32_bf16 v[8:11], v[156:159], v[204:207], v[8:11]
    v_mfma_f32_16x16x32_bf16 v[12:15], v[164:167], v[188:191], v[12:15]
    v_mfma_f32_16x16x32_bf16 v[16:19], v[164:167], v[196:199], v[16:19]
    s_waitcnt lgkmcnt(0)
    s_barrier
    v_mfma_f32_16x16x32_bf16 v[20:23], v[164:167], v[204:207], v[20:23]
    v_mfma_f32_16x16x32_bf16 v[24:27], v[172:175], v[188:191], v[24:27]
    v_mfma_f32_16x16x32_bf16 v[28:31], v[172:175], v[196:199], v[28:31]
    v_mfma_f32_16x16x32_bf16 v[32:35], v[172:175], v[204:207], v[32:35]
    v_mfma_f32_16x16x32_bf16 v[36:39], v[180:183], v[188:191], v[36:39]
    v_mfma_f32_16x16x32_bf16 v[40:43], v[180:183], v[196:199], v[40:43]
    v_mfma_f32_16x16x32_bf16 v[44:47], v[180:183], v[204:207], v[44:47]
    v_mfma_f32_16x16x32_bf16 v[0:3], v[96:99], v[128:131], v[0:3]
    ds_read_b128 v[152:155], v215 offset:28672
    v_mfma_f32_16x16x32_bf16 v[4:7], v[96:99], v[136:139], v[4:7]
    v_mfma_f32_16x16x32_bf16 v[8:11], v[96:99], v[144:147], v[8:11]
    ds_read_b128 v[184:187], v209 offset:28672
    v_mfma_f32_16x16x32_bf16 v[12:15], v[104:107], v[128:131], v[12:15]
    v_mfma_f32_16x16x32_bf16 v[16:19], v[104:107], v[136:139], v[16:19]
    ds_read_b128 v[192:195], v209 offset:30720
    v_mfma_f32_16x16x32_bf16 v[20:23], v[104:107], v[144:147], v[20:23]
    v_mfma_f32_16x16x32_bf16 v[24:27], v[112:115], v[128:131], v[24:27]
    ds_read_b128 v[200:203], v209 offset:32768
    v_mfma_f32_16x16x32_bf16 v[28:31], v[112:115], v[136:139], v[28:31]
    v_mfma_f32_16x16x32_bf16 v[32:35], v[112:115], v[144:147], v[32:35]
    ds_read_b128 v[160:163], v215 offset:30720
    v_mfma_f32_16x16x32_bf16 v[36:39], v[120:123], v[128:131], v[36:39]
    v_mfma_f32_16x16x32_bf16 v[40:43], v[120:123], v[136:139], v[40:43]
    ds_read_b128 v[168:171], v215 offset:32768
    v_mfma_f32_16x16x32_bf16 v[44:47], v[120:123], v[144:147], v[44:47]
    v_mfma_f32_16x16x32_bf16 v[48:51], v[96:99], v[132:135], v[48:51]
    ds_read_b128 v[176:179], v215 offset:34816
    v_mfma_f32_16x16x32_bf16 v[52:55], v[96:99], v[140:143], v[52:55]
    v_mfma_f32_16x16x32_bf16 v[56:59], v[96:99], v[148:151], v[56:59]
    ds_read_b128 v[188:191], v212 offset:28672
    v_mfma_f32_16x16x32_bf16 v[60:63], v[104:107], v[132:135], v[60:63]
    v_mfma_f32_16x16x32_bf16 v[64:67], v[104:107], v[140:143], v[64:67]
    ds_read_b128 v[196:199], v212 offset:30720
    v_mfma_f32_16x16x32_bf16 v[68:71], v[104:107], v[148:151], v[68:71]
    v_mfma_f32_16x16x32_bf16 v[72:75], v[112:115], v[132:135], v[72:75]
    ds_read_b128 v[204:207], v212 offset:32768
    v_mfma_f32_16x16x32_bf16 v[76:79], v[112:115], v[140:143], v[76:79]
    v_mfma_f32_16x16x32_bf16 v[80:83], v[112:115], v[148:151], v[80:83]
    ds_read_b128 v[156:159], v215 offset:29696
    v_mfma_f32_16x16x32_bf16 v[84:87], v[120:123], v[132:135], v[84:87]
    v_mfma_f32_16x16x32_bf16 v[88:91], v[120:123], v[140:143], v[88:91]
    ds_read_b128 v[164:167], v215 offset:31744
    v_mfma_f32_16x16x32_bf16 v[92:95], v[120:123], v[148:151], v[92:95]
    v_mfma_f32_16x16x32_bf16 v[48:51], v[100:103], v[128:131], v[48:51]
    ds_read_b128 v[172:175], v215 offset:33792
    v_xor_b32 v132, s34, v132
    v_xor_b32 v133, s34, v133
    v_mfma_f32_16x16x32_bf16 v[52:55], v[100:103], v[136:139], v[52:55]
    v_xor_b32 v134, s34, v134
    v_xor_b32 v135, s34, v135
    v_mfma_f32_16x16x32_bf16 v[56:59], v[100:103], v[144:147], v[56:59]
    ds_read_b128 v[180:183], v215 offset:35840
    v_xor_b32 v140, s34, v140
    v_xor_b32 v141, s34, v141
    v_mfma_f32_16x16x32_bf16 v[60:63], v[108:111], v[128:131], v[60:63]
    v_xor_b32 v142, s34, v142
    v_xor_b32 v143, s34, v143
    v_mfma_f32_16x16x32_bf16 v[64:67], v[108:111], v[136:139], v[64:67]
    v_xor_b32 v148, s34, v148
    v_xor_b32 v149, s34, v149
    v_mfma_f32_16x16x32_bf16 v[68:71], v[108:111], v[144:147], v[68:71]
    v_xor_b32 v150, s34, v150
    v_xor_b32 v151, s34, v151
    v_mfma_f32_16x16x32_bf16 v[72:75], v[116:119], v[128:131], v[72:75]
    v_mfma_f32_16x16x32_bf16 v[76:79], v[116:119], v[136:139], v[76:79]
    v_mfma_f32_16x16x32_bf16 v[80:83], v[116:119], v[144:147], v[80:83]
    v_mfma_f32_16x16x32_bf16 v[84:87], v[124:127], v[128:131], v[84:87]
    v_mfma_f32_16x16x32_bf16 v[88:91], v[124:127], v[136:139], v[88:91]
    v_mfma_f32_16x16x32_bf16 v[92:95], v[124:127], v[144:147], v[92:95]
    v_mfma_f32_16x16x32_bf16 v[0:3], v[100:103], v[132:135], v[0:3]
    v_mfma_f32_16x16x32_bf16 v[4:7], v[100:103], v[140:143], v[4:7]
    v_mfma_f32_16x16x32_bf16 v[8:11], v[100:103], v[148:151], v[8:11]
    v_mfma_f32_16x16x32_bf16 v[12:15], v[108:111], v[132:135], v[12:15]
    v_mfma_f32_16x16x32_bf16 v[16:19], v[108:111], v[140:143], v[16:19]
    s_waitcnt lgkmcnt(0)
    s_barrier
    v_mfma_f32_16x16x32_bf16 v[20:23], v[108:111], v[148:151], v[20:23]
    v_mfma_f32_16x16x32_bf16 v[24:27], v[116:119], v[132:135], v[24:27]
    v_mfma_f32_16x16x32_bf16 v[28:31], v[116:119], v[140:143], v[28:31]
    v_mfma_f32_16x16x32_bf16 v[32:35], v[116:119], v[148:151], v[32:35]
    v_mfma_f32_16x16x32_bf16 v[36:39], v[124:127], v[132:135], v[36:39]
    v_mfma_f32_16x16x32_bf16 v[40:43], v[124:127], v[140:143], v[40:43]
    v_mfma_f32_16x16x32_bf16 v[44:47], v[124:127], v[148:151], v[44:47]
    v_mfma_f32_16x16x32_bf16 v[0:3], v[152:155], v[184:187], v[0:3]
    ds_read_b128 v[96:99], v216 offset:0
    v_mfma_f32_16x16x32_bf16 v[4:7], v[152:155], v[192:195], v[4:7]
    v_mfma_f32_16x16x32_bf16 v[8:11], v[152:155], v[200:203], v[8:11]
    ds_read_b128 v[128:131], v210 offset:0
    v_mfma_f32_16x16x32_bf16 v[12:15], v[160:163], v[184:187], v[12:15]
    v_mfma_f32_16x16x32_bf16 v[16:19], v[160:163], v[192:195], v[16:19]
    ds_read_b128 v[136:139], v210 offset:2048
    v_mfma_f32_16x16x32_bf16 v[20:23], v[160:163], v[200:203], v[20:23]
    v_mfma_f32_16x16x32_bf16 v[24:27], v[168:171], v[184:187], v[24:27]
    ds_read_b128 v[144:147], v210 offset:4096
    v_mfma_f32_16x16x32_bf16 v[28:31], v[168:171], v[192:195], v[28:31]
    v_mfma_f32_16x16x32_bf16 v[32:35], v[168:171], v[200:203], v[32:35]
    ds_read_b128 v[104:107], v216 offset:2048
    v_mfma_f32_16x16x32_bf16 v[36:39], v[176:179], v[184:187], v[36:39]
    v_mfma_f32_16x16x32_bf16 v[40:43], v[176:179], v[192:195], v[40:43]
    ds_read_b128 v[112:115], v216 offset:4096
    v_mfma_f32_16x16x32_bf16 v[44:47], v[176:179], v[200:203], v[44:47]
    v_mfma_f32_16x16x32_bf16 v[48:51], v[152:155], v[188:191], v[48:51]
    ds_read_b128 v[120:123], v216 offset:6144
    v_mfma_f32_16x16x32_bf16 v[52:55], v[152:155], v[196:199], v[52:55]
    v_mfma_f32_16x16x32_bf16 v[56:59], v[152:155], v[204:207], v[56:59]
    ds_read_b128 v[132:135], v213 offset:0
    v_mfma_f32_16x16x32_bf16 v[60:63], v[160:163], v[188:191], v[60:63]
    v_mfma_f32_16x16x32_bf16 v[64:67], v[160:163], v[196:199], v[64:67]
    ds_read_b128 v[140:143], v213 offset:2048
    v_mfma_f32_16x16x32_bf16 v[68:71], v[160:163], v[204:207], v[68:71]
    v_mfma_f32_16x16x32_bf16 v[72:75], v[168:171], v[188:191], v[72:75]
    ds_read_b128 v[148:151], v213 offset:4096
    v_mfma_f32_16x16x32_bf16 v[76:79], v[168:171], v[196:199], v[76:79]
    v_mfma_f32_16x16x32_bf16 v[80:83], v[168:171], v[204:207], v[80:83]
    ds_read_b128 v[100:103], v216 offset:1024
    v_mfma_f32_16x16x32_bf16 v[84:87], v[176:179], v[188:191], v[84:87]
    v_mfma_f32_16x16x32_bf16 v[88:91], v[176:179], v[196:199], v[88:91]
    ds_read_b128 v[108:111], v216 offset:3072
    v_mfma_f32_16x16x32_bf16 v[92:95], v[176:179], v[204:207], v[92:95]
    v_mfma_f32_16x16x32_bf16 v[48:51], v[156:159], v[184:187], v[48:51]
    ds_read_b128 v[116:119], v216 offset:5120
    v_xor_b32 v188, s34, v188
    v_xor_b32 v189, s34, v189
    v_mfma_f32_16x16x32_bf16 v[52:55], v[156:159], v[192:195], v[52:55]
    v_xor_b32 v190, s34, v190
    v_xor_b32 v191, s34, v191
    v_mfma_f32_16x16x32_bf16 v[56:59], v[156:159], v[200:203], v[56:59]
    ds_read_b128 v[124:127], v216 offset:7168
    v_xor_b32 v196, s34, v196
    v_xor_b32 v197, s34, v197
    v_mfma_f32_16x16x32_bf16 v[60:63], v[164:167], v[184:187], v[60:63]
    v_xor_b32 v198, s34, v198
    v_xor_b32 v199, s34, v199
    v_mfma_f32_16x16x32_bf16 v[64:67], v[164:167], v[192:195], v[64:67]
    v_xor_b32 v204, s34, v204
    v_xor_b32 v205, s34, v205
    v_mfma_f32_16x16x32_bf16 v[68:71], v[164:167], v[200:203], v[68:71]
    v_xor_b32 v206, s34, v206
    v_xor_b32 v207, s34, v207
    v_mfma_f32_16x16x32_bf16 v[72:75], v[172:175], v[184:187], v[72:75]
    v_mfma_f32_16x16x32_bf16 v[76:79], v[172:175], v[192:195], v[76:79]
    v_mfma_f32_16x16x32_bf16 v[80:83], v[172:175], v[200:203], v[80:83]
    v_mfma_f32_16x16x32_bf16 v[84:87], v[180:183], v[184:187], v[84:87]
    v_mfma_f32_16x16x32_bf16 v[88:91], v[180:183], v[192:195], v[88:91]
    v_mfma_f32_16x16x32_bf16 v[92:95], v[180:183], v[200:203], v[92:95]
    v_mfma_f32_16x16x32_bf16 v[0:3], v[156:159], v[188:191], v[0:3]
    v_mfma_f32_16x16x32_bf16 v[4:7], v[156:159], v[196:199], v[4:7]
    v_mfma_f32_16x16x32_bf16 v[8:11], v[156:159], v[204:207], v[8:11]
    v_mfma_f32_16x16x32_bf16 v[12:15], v[164:167], v[188:191], v[12:15]
    v_mfma_f32_16x16x32_bf16 v[16:19], v[164:167], v[196:199], v[16:19]
    s_waitcnt lgkmcnt(0)
    s_barrier
    v_mfma_f32_16x16x32_bf16 v[20:23], v[164:167], v[204:207], v[20:23]
    v_mfma_f32_16x16x32_bf16 v[24:27], v[172:175], v[188:191], v[24:27]
    v_mfma_f32_16x16x32_bf16 v[28:31], v[172:175], v[196:199], v[28:31]
    v_mfma_f32_16x16x32_bf16 v[32:35], v[172:175], v[204:207], v[32:35]
    v_mfma_f32_16x16x32_bf16 v[36:39], v[180:183], v[188:191], v[36:39]
    v_mfma_f32_16x16x32_bf16 v[40:43], v[180:183], v[196:199], v[40:43]
    v_mfma_f32_16x16x32_bf16 v[44:47], v[180:183], v[204:207], v[44:47]
    v_mfma_f32_16x16x32_bf16 v[0:3], v[96:99], v[128:131], v[0:3]
    ds_read_b128 v[152:155], v214 offset:0
    v_mfma_f32_16x16x32_bf16 v[4:7], v[96:99], v[136:139], v[4:7]
    v_mfma_f32_16x16x32_bf16 v[8:11], v[96:99], v[144:147], v[8:11]
    ds_read_b128 v[184:187], v208 offset:0
    v_mfma_f32_16x16x32_bf16 v[12:15], v[104:107], v[128:131], v[12:15]
    v_mfma_f32_16x16x32_bf16 v[16:19], v[104:107], v[136:139], v[16:19]
    ds_read_b128 v[192:195], v208 offset:2048
    v_mfma_f32_16x16x32_bf16 v[20:23], v[104:107], v[144:147], v[20:23]
    v_mfma_f32_16x16x32_bf16 v[24:27], v[112:115], v[128:131], v[24:27]
    ds_read_b128 v[200:203], v208 offset:4096
    v_mfma_f32_16x16x32_bf16 v[28:31], v[112:115], v[136:139], v[28:31]
    v_mfma_f32_16x16x32_bf16 v[32:35], v[112:115], v[144:147], v[32:35]
    ds_read_b128 v[160:163], v214 offset:2048
    v_mfma_f32_16x16x32_bf16 v[36:39], v[120:123], v[128:131], v[36:39]
    v_mfma_f32_16x16x32_bf16 v[40:43], v[120:123], v[136:139], v[40:43]
    ds_read_b128 v[168:171], v214 offset:4096
    v_mfma_f32_16x16x32_bf16 v[44:47], v[120:123], v[144:147], v[44:47]
    v_mfma_f32_16x16x32_bf16 v[48:51], v[96:99], v[132:135], v[48:51]
    ds_read_b128 v[176:179], v214 offset:6144
    v_mfma_f32_16x16x32_bf16 v[52:55], v[96:99], v[140:143], v[52:55]
    v_mfma_f32_16x16x32_bf16 v[56:59], v[96:99], v[148:151], v[56:59]
    ds_read_b128 v[188:191], v211 offset:0
    v_mfma_f32_16x16x32_bf16 v[60:63], v[104:107], v[132:135], v[60:63]
    v_mfma_f32_16x16x32_bf16 v[64:67], v[104:107], v[140:143], v[64:67]
    ds_read_b128 v[196:199], v211 offset:2048
    v_mfma_f32_16x16x32_bf16 v[68:71], v[104:107], v[148:151], v[68:71]
    v_mfma_f32_16x16x32_bf16 v[72:75], v[112:115], v[132:135], v[72:75]
    ds_read_b128 v[204:207], v211 offset:4096
    v_mfma_f32_16x16x32_bf16 v[76:79], v[112:115], v[140:143], v[76:79]
    v_mfma_f32_16x16x32_bf16 v[80:83], v[112:115], v[148:151], v[80:83]
    ds_read_b128 v[156:159], v214 offset:1024
    v_mfma_f32_16x16x32_bf16 v[84:87], v[120:123], v[132:135], v[84:87]
    v_mfma_f32_16x16x32_bf16 v[88:91], v[120:123], v[140:143], v[88:91]
    ds_read_b128 v[164:167], v214 offset:3072
    v_mfma_f32_16x16x32_bf16 v[92:95], v[120:123], v[148:151], v[92:95]
    v_mfma_f32_16x16x32_bf16 v[48:51], v[100:103], v[128:131], v[48:51]
    ds_read_b128 v[172:175], v214 offset:5120
    v_xor_b32 v132, s34, v132
    v_xor_b32 v133, s34, v133
    v_mfma_f32_16x16x32_bf16 v[52:55], v[100:103], v[136:139], v[52:55]
    v_xor_b32 v134, s34, v134
    v_xor_b32 v135, s34, v135
    v_mfma_f32_16x16x32_bf16 v[56:59], v[100:103], v[144:147], v[56:59]
    ds_read_b128 v[180:183], v214 offset:7168
    v_xor_b32 v140, s34, v140
    v_xor_b32 v141, s34, v141
    v_mfma_f32_16x16x32_bf16 v[60:63], v[108:111], v[128:131], v[60:63]
    v_xor_b32 v142, s34, v142
    v_xor_b32 v143, s34, v143
    v_mfma_f32_16x16x32_bf16 v[64:67], v[108:111], v[136:139], v[64:67]
    v_xor_b32 v148, s34, v148
    v_xor_b32 v149, s34, v149
    v_mfma_f32_16x16x32_bf16 v[68:71], v[108:111], v[144:147], v[68:71]
    v_xor_b32 v150, s34, v150
    v_xor_b32 v151, s34, v151
    v_mfma_f32_16x16x32_bf16 v[72:75], v[116:119], v[128:131], v[72:75]
    v_mfma_f32_16x16x32_bf16 v[76:79], v[116:119], v[136:139], v[76:79]
    v_mfma_f32_16x16x32_bf16 v[80:83], v[116:119], v[144:147], v[80:83]
    v_mfma_f32_16x16x32_bf16 v[84:87], v[124:127], v[128:131], v[84:87]
    v_mfma_f32_16x16x32_bf16 v[88:91], v[124:127], v[136:139], v[88:91]
    v_mfma_f32_16x16x32_bf16 v[92:95], v[124:127], v[144:147], v[92:95]
    v_mfma_f32_16x16x32_bf16 v[0:3], v[100:103], v[132:135], v[0:3]
    v_mfma_f32_16x16x32_bf16 v[4:7], v[100:103], v[140:143], v[4:7]
    v_mfma_f32_16x16x32_bf16 v[8:11], v[100:103], v[148:151], v[8:11]
    v_mfma_f32_16x16x32_bf16 v[12:15], v[108:111], v[132:135], v[12:15]
    v_mfma_f32_16x16x32_bf16 v[16:19], v[108:111], v[140:143], v[16:19]
    s_waitcnt lgkmcnt(0)
    s_barrier
    v_mfma_f32_16x16x32_bf16 v[20:23], v[108:111], v[148:151], v[20:23]
    v_mfma_f32_16x16x32_bf16 v[24:27], v[116:119], v[132:135], v[24:27]
    v_mfma_f32_16x16x32_bf16 v[28:31], v[116:119], v[140:143], v[28:31]
    v_mfma_f32_16x16x32_bf16 v[32:35], v[116:119], v[148:151], v[32:35]
    v_mfma_f32_16x16x32_bf16 v[36:39], v[124:127], v[132:135], v[36:39]
    v_mfma_f32_16x16x32_bf16 v[40:43], v[124:127], v[140:143], v[40:43]
    v_mfma_f32_16x16x32_bf16 v[44:47], v[124:127], v[148:151], v[44:47]
    v_mfma_f32_16x16x32_bf16 v[0:3], v[152:155], v[184:187], v[0:3]
    ds_read_b128 v[96:99], v214 offset:28672
    v_mfma_f32_16x16x32_bf16 v[4:7], v[152:155], v[192:195], v[4:7]
    v_mfma_f32_16x16x32_bf16 v[8:11], v[152:155], v[200:203], v[8:11]
    ds_read_b128 v[128:131], v208 offset:28672
    v_mfma_f32_16x16x32_bf16 v[12:15], v[160:163], v[184:187], v[12:15]
    v_mfma_f32_16x16x32_bf16 v[16:19], v[160:163], v[192:195], v[16:19]
    ds_read_b128 v[136:139], v208 offset:30720
    v_mfma_f32_16x16x32_bf16 v[20:23], v[160:163], v[200:203], v[20:23]
    v_mfma_f32_16x16x32_bf16 v[24:27], v[168:171], v[184:187], v[24:27]
    ds_read_b128 v[144:147], v208 offset:32768
    v_mfma_f32_16x16x32_bf16 v[28:31], v[168:171], v[192:195], v[28:31]
    v_mfma_f32_16x16x32_bf16 v[32:35], v[168:171], v[200:203], v[32:35]
    ds_read_b128 v[104:107], v214 offset:30720
    v_mfma_f32_16x16x32_bf16 v[36:39], v[176:179], v[184:187], v[36:39]
    v_mfma_f32_16x16x32_bf16 v[40:43], v[176:179], v[192:195], v[40:43]
    ds_read_b128 v[112:115], v214 offset:32768
    v_mfma_f32_16x16x32_bf16 v[44:47], v[176:179], v[200:203], v[44:47]
    v_mfma_f32_16x16x32_bf16 v[48:51], v[152:155], v[188:191], v[48:51]
    ds_read_b128 v[120:123], v214 offset:34816
    v_mfma_f32_16x16x32_bf16 v[52:55], v[152:155], v[196:199], v[52:55]
    v_mfma_f32_16x16x32_bf16 v[56:59], v[152:155], v[204:207], v[56:59]
    ds_read_b128 v[132:135], v211 offset:28672
    v_mfma_f32_16x16x32_bf16 v[60:63], v[160:163], v[188:191], v[60:63]
    v_mfma_f32_16x16x32_bf16 v[64:67], v[160:163], v[196:199], v[64:67]
    ds_read_b128 v[140:143], v211 offset:30720
    v_mfma_f32_16x16x32_bf16 v[68:71], v[160:163], v[204:207], v[68:71]
    v_mfma_f32_16x16x32_bf16 v[72:75], v[168:171], v[188:191], v[72:75]
    ds_read_b128 v[148:151], v211 offset:32768
    v_mfma_f32_16x16x32_bf16 v[76:79], v[168:171], v[196:199], v[76:79]
    v_mfma_f32_16x16x32_bf16 v[80:83], v[168:171], v[204:207], v[80:83]
    ds_read_b128 v[100:103], v214 offset:29696
    v_mfma_f32_16x16x32_bf16 v[84:87], v[176:179], v[188:191], v[84:87]
    v_mfma_f32_16x16x32_bf16 v[88:91], v[176:179], v[196:199], v[88:91]
    ds_read_b128 v[108:111], v214 offset:31744
    v_mfma_f32_16x16x32_bf16 v[92:95], v[176:179], v[204:207], v[92:95]
    v_mfma_f32_16x16x32_bf16 v[48:51], v[156:159], v[184:187], v[48:51]
    ds_read_b128 v[116:119], v214 offset:33792
    v_xor_b32 v188, s34, v188
    v_xor_b32 v189, s34, v189
    v_mfma_f32_16x16x32_bf16 v[52:55], v[156:159], v[192:195], v[52:55]
    v_xor_b32 v190, s34, v190
    v_xor_b32 v191, s34, v191
    v_mfma_f32_16x16x32_bf16 v[56:59], v[156:159], v[200:203], v[56:59]
    ds_read_b128 v[124:127], v214 offset:35840
    v_xor_b32 v196, s34, v196
    v_xor_b32 v197, s34, v197
    v_mfma_f32_16x16x32_bf16 v[60:63], v[164:167], v[184:187], v[60:63]
    v_xor_b32 v198, s34, v198
    v_xor_b32 v199, s34, v199
    v_mfma_f32_16x16x32_bf16 v[64:67], v[164:167], v[192:195], v[64:67]
    v_xor_b32 v204, s34, v204
    v_xor_b32 v205, s34, v205
    v_mfma_f32_16x16x32_bf16 v[68:71], v[164:167], v[200:203], v[68:71]
    v_xor_b32 v206, s34, v206
    v_xor_b32 v207, s34, v207
    v_mfma_f32_16x16x32_bf16 v[72:75], v[172:175], v[184:187], v[72:75]
    v_mfma_f32_16x16x32_bf16 v[76:79], v[172:175], v[192:195], v[76:79]
    v_mfma_f32_16x16x32_bf16 v[80:83], v[172:175], v[200:203], v[80:83]
    v_mfma_f32_16x16x32_bf16 v[84:87], v[180:183], v[184:187], v[84:87]
    v_mfma_f32_16x16x32_bf16 v[88:91], v[180:183], v[192:195], v[88:91]
    v_mfma_f32_16x16x32_bf16 v[92:95], v[180:183], v[200:203], v[92:95]
    v_mfma_f32_16x16x32_bf16 v[0:3], v[156:159], v[188:191], v[0:3]
    v_mfma_f32_16x16x32_bf16 v[4:7], v[156:159], v[196:199], v[4:7]
    v_mfma_f32_16x16x32_bf16 v[8:11], v[156:159], v[204:207], v[8:11]
    v_mfma_f32_16x16x32_bf16 v[12:15], v[164:167], v[188:191], v[12:15]
    v_mfma_f32_16x16x32_bf16 v[16:19], v[164:167], v[196:199], v[16:19]
    s_waitcnt lgkmcnt(0)
    s_barrier
    v_mfma_f32_16x16x32_bf16 v[20:23], v[164:167], v[204:207], v[20:23]
    v_mfma_f32_16x16x32_bf16 v[24:27], v[172:175], v[188:191], v[24:27]
    v_mfma_f32_16x16x32_bf16 v[28:31], v[172:175], v[196:199], v[28:31]
    v_mfma_f32_16x16x32_bf16 v[32:35], v[172:175], v[204:207], v[32:35]
    v_mfma_f32_16x16x32_bf16 v[36:39], v[180:183], v[188:191], v[36:39]
    v_mfma_f32_16x16x32_bf16 v[40:43], v[180:183], v[196:199], v[40:43]
    v_mfma_f32_16x16x32_bf16 v[44:47], v[180:183], v[204:207], v[44:47]
    v_mfma_f32_16x16x32_bf16 v[0:3], v[96:99], v[128:131], v[0:3]
    ds_read_b128 v[152:155], v215 offset:0
    v_mfma_f32_16x16x32_bf16 v[4:7], v[96:99], v[136:139], v[4:7]
    v_mfma_f32_16x16x32_bf16 v[8:11], v[96:99], v[144:147], v[8:11]
    ds_read_b128 v[184:187], v209 offset:0
    v_mfma_f32_16x16x32_bf16 v[12:15], v[104:107], v[128:131], v[12:15]
    v_mfma_f32_16x16x32_bf16 v[16:19], v[104:107], v[136:139], v[16:19]
    ds_read_b128 v[192:195], v209 offset:2048
    v_mfma_f32_16x16x32_bf16 v[20:23], v[104:107], v[144:147], v[20:23]
    v_mfma_f32_16x16x32_bf16 v[24:27], v[112:115], v[128:131], v[24:27]
    ds_read_b128 v[200:203], v209 offset:4096
    v_mfma_f32_16x16x32_bf16 v[28:31], v[112:115], v[136:139], v[28:31]
    v_mfma_f32_16x16x32_bf16 v[32:35], v[112:115], v[144:147], v[32:35]
    ds_read_b128 v[160:163], v215 offset:2048
    v_mfma_f32_16x16x32_bf16 v[36:39], v[120:123], v[128:131], v[36:39]
    v_mfma_f32_16x16x32_bf16 v[40:43], v[120:123], v[136:139], v[40:43]
    ds_read_b128 v[168:171], v215 offset:4096
    v_mfma_f32_16x16x32_bf16 v[44:47], v[120:123], v[144:147], v[44:47]
    v_mfma_f32_16x16x32_bf16 v[48:51], v[96:99], v[132:135], v[48:51]
    ds_read_b128 v[176:179], v215 offset:6144
    v_mfma_f32_16x16x32_bf16 v[52:55], v[96:99], v[140:143], v[52:55]
    v_mfma_f32_16x16x32_bf16 v[56:59], v[96:99], v[148:151], v[56:59]
    ds_read_b128 v[188:191], v212 offset:0
    v_mfma_f32_16x16x32_bf16 v[60:63], v[104:107], v[132:135], v[60:63]
    v_mfma_f32_16x16x32_bf16 v[64:67], v[104:107], v[140:143], v[64:67]
    ds_read_b128 v[196:199], v212 offset:2048
    v_mfma_f32_16x16x32_bf16 v[68:71], v[104:107], v[148:151], v[68:71]
    v_mfma_f32_16x16x32_bf16 v[72:75], v[112:115], v[132:135], v[72:75]
    ds_read_b128 v[204:207], v212 offset:4096
    v_mfma_f32_16x16x32_bf16 v[76:79], v[112:115], v[140:143], v[76:79]
    v_mfma_f32_16x16x32_bf16 v[80:83], v[112:115], v[148:151], v[80:83]
    ds_read_b128 v[156:159], v215 offset:1024
    v_mfma_f32_16x16x32_bf16 v[84:87], v[120:123], v[132:135], v[84:87]
    v_mfma_f32_16x16x32_bf16 v[88:91], v[120:123], v[140:143], v[88:91]
    ds_read_b128 v[164:167], v215 offset:3072
    v_mfma_f32_16x16x32_bf16 v[92:95], v[120:123], v[148:151], v[92:95]
    v_mfma_f32_16x16x32_bf16 v[48:51], v[100:103], v[128:131], v[48:51]
    ds_read_b128 v[172:175], v215 offset:5120
    v_xor_b32 v132, s34, v132
    v_xor_b32 v133, s34, v133
    v_mfma_f32_16x16x32_bf16 v[52:55], v[100:103], v[136:139], v[52:55]
    v_xor_b32 v134, s34, v134
    v_xor_b32 v135, s34, v135
    v_mfma_f32_16x16x32_bf16 v[56:59], v[100:103], v[144:147], v[56:59]
    ds_read_b128 v[180:183], v215 offset:7168
    v_xor_b32 v140, s34, v140
    v_xor_b32 v141, s34, v141
    v_mfma_f32_16x16x32_bf16 v[60:63], v[108:111], v[128:131], v[60:63]
    v_xor_b32 v142, s34, v142
    v_xor_b32 v143, s34, v143
    v_mfma_f32_16x16x32_bf16 v[64:67], v[108:111], v[136:139], v[64:67]
    v_xor_b32 v148, s34, v148
    v_xor_b32 v149, s34, v149
    v_mfma_f32_16x16x32_bf16 v[68:71], v[108:111], v[144:147], v[68:71]
    v_xor_b32 v150, s34, v150
    v_xor_b32 v151, s34, v151
    v_mfma_f32_16x16x32_bf16 v[72:75], v[116:119], v[128:131], v[72:75]
    v_mfma_f32_16x16x32_bf16 v[76:79], v[116:119], v[136:139], v[76:79]
    v_mfma_f32_16x16x32_bf16 v[80:83], v[116:119], v[144:147], v[80:83]
    v_mfma_f32_16x16x32_bf16 v[84:87], v[124:127], v[128:131], v[84:87]
    v_mfma_f32_16x16x32_bf16 v[88:91], v[124:127], v[136:139], v[88:91]
    v_mfma_f32_16x16x32_bf16 v[92:95], v[124:127], v[144:147], v[92:95]
    v_mfma_f32_16x16x32_bf16 v[0:3], v[100:103], v[132:135], v[0:3]
    v_mfma_f32_16x16x32_bf16 v[4:7], v[100:103], v[140:143], v[4:7]
    v_mfma_f32_16x16x32_bf16 v[8:11], v[100:103], v[148:151], v[8:11]
    v_mfma_f32_16x16x32_bf16 v[12:15], v[108:111], v[132:135], v[12:15]
    v_mfma_f32_16x16x32_bf16 v[16:19], v[108:111], v[140:143], v[16:19]
    s_waitcnt lgkmcnt(0)
    s_barrier
    v_mfma_f32_16x16x32_bf16 v[20:23], v[108:111], v[148:151], v[20:23]
    v_mfma_f32_16x16x32_bf16 v[24:27], v[116:119], v[132:135], v[24:27]
    v_mfma_f32_16x16x32_bf16 v[28:31], v[116:119], v[140:143], v[28:31]
    v_mfma_f32_16x16x32_bf16 v[32:35], v[116:119], v[148:151], v[32:35]
    v_mfma_f32_16x16x32_bf16 v[36:39], v[124:127], v[132:135], v[36:39]
    v_mfma_f32_16x16x32_bf16 v[40:43], v[124:127], v[140:143], v[40:43]
    v_mfma_f32_16x16x32_bf16 v[44:47], v[124:127], v[148:151], v[44:47]
    v_mfma_f32_16x16x32_bf16 v[0:3], v[152:155], v[184:187], v[0:3]
    ds_read_b128 v[96:99], v215 offset:28672
    v_mfma_f32_16x16x32_bf16 v[4:7], v[152:155], v[192:195], v[4:7]
    v_mfma_f32_16x16x32_bf16 v[8:11], v[152:155], v[200:203], v[8:11]
    ds_read_b128 v[128:131], v209 offset:28672
    v_mfma_f32_16x16x32_bf16 v[12:15], v[160:163], v[184:187], v[12:15]
    v_mfma_f32_16x16x32_bf16 v[16:19], v[160:163], v[192:195], v[16:19]
    ds_read_b128 v[136:139], v209 offset:30720
    v_mfma_f32_16x16x32_bf16 v[20:23], v[160:163], v[200:203], v[20:23]
    v_mfma_f32_16x16x32_bf16 v[24:27], v[168:171], v[184:187], v[24:27]
    ds_read_b128 v[144:147], v209 offset:32768
    v_mfma_f32_16x16x32_bf16 v[28:31], v[168:171], v[192:195], v[28:31]
    v_mfma_f32_16x16x32_bf16 v[32:35], v[168:171], v[200:203], v[32:35]
    ds_read_b128 v[104:107], v215 offset:30720
    v_mfma_f32_16x16x32_bf16 v[36:39], v[176:179], v[184:187], v[36:39]
    v_mfma_f32_16x16x32_bf16 v[40:43], v[176:179], v[192:195], v[40:43]
    ds_read_b128 v[112:115], v215 offset:32768
    v_mfma_f32_16x16x32_bf16 v[44:47], v[176:179], v[200:203], v[44:47]
    v_mfma_f32_16x16x32_bf16 v[48:51], v[152:155], v[188:191], v[48:51]
    ds_read_b128 v[120:123], v215 offset:34816
    v_mfma_f32_16x16x32_bf16 v[52:55], v[152:155], v[196:199], v[52:55]
    v_mfma_f32_16x16x32_bf16 v[56:59], v[152:155], v[204:207], v[56:59]
    ds_read_b128 v[132:135], v212 offset:28672
    v_mfma_f32_16x16x32_bf16 v[60:63], v[160:163], v[188:191], v[60:63]
    v_mfma_f32_16x16x32_bf16 v[64:67], v[160:163], v[196:199], v[64:67]
    ds_read_b128 v[140:143], v212 offset:30720
    v_mfma_f32_16x16x32_bf16 v[68:71], v[160:163], v[204:207], v[68:71]
    v_mfma_f32_16x16x32_bf16 v[72:75], v[168:171], v[188:191], v[72:75]
    ds_read_b128 v[148:151], v212 offset:32768
    v_mfma_f32_16x16x32_bf16 v[76:79], v[168:171], v[196:199], v[76:79]
    v_mfma_f32_16x16x32_bf16 v[80:83], v[168:171], v[204:207], v[80:83]
    ds_read_b128 v[100:103], v215 offset:29696
    v_mfma_f32_16x16x32_bf16 v[84:87], v[176:179], v[188:191], v[84:87]
    v_mfma_f32_16x16x32_bf16 v[88:91], v[176:179], v[196:199], v[88:91]
    ds_read_b128 v[108:111], v215 offset:31744
    v_mfma_f32_16x16x32_bf16 v[92:95], v[176:179], v[204:207], v[92:95]
    v_mfma_f32_16x16x32_bf16 v[48:51], v[156:159], v[184:187], v[48:51]
    ds_read_b128 v[116:119], v215 offset:33792
    v_xor_b32 v188, s34, v188
    v_xor_b32 v189, s34, v189
    v_mfma_f32_16x16x32_bf16 v[52:55], v[156:159], v[192:195], v[52:55]
    v_xor_b32 v190, s34, v190
    v_xor_b32 v191, s34, v191
    v_mfma_f32_16x16x32_bf16 v[56:59], v[156:159], v[200:203], v[56:59]
    ds_read_b128 v[124:127], v215 offset:35840
    v_xor_b32 v196, s34, v196
    v_xor_b32 v197, s34, v197
    v_mfma_f32_16x16x32_bf16 v[60:63], v[164:167], v[184:187], v[60:63]
    v_xor_b32 v198, s34, v198
    v_xor_b32 v199, s34, v199
    v_mfma_f32_16x16x32_bf16 v[64:67], v[164:167], v[192:195], v[64:67]
    v_xor_b32 v204, s34, v204
    v_xor_b32 v205, s34, v205
    v_mfma_f32_16x16x32_bf16 v[68:71], v[164:167], v[200:203], v[68:71]
    v_xor_b32 v206, s34, v206
    v_xor_b32 v207, s34, v207
    v_mfma_f32_16x16x32_bf16 v[72:75], v[172:175], v[184:187], v[72:75]
    v_mfma_f32_16x16x32_bf16 v[76:79], v[172:175], v[192:195], v[76:79]
    v_mfma_f32_16x16x32_bf16 v[80:83], v[172:175], v[200:203], v[80:83]
    v_mfma_f32_16x16x32_bf16 v[84:87], v[180:183], v[184:187], v[84:87]
    v_mfma_f32_16x16x32_bf16 v[88:91], v[180:183], v[192:195], v[88:91]
    v_mfma_f32_16x16x32_bf16 v[92:95], v[180:183], v[200:203], v[92:95]
    v_mfma_f32_16x16x32_bf16 v[0:3], v[156:159], v[188:191], v[0:3]
    v_mfma_f32_16x16x32_bf16 v[4:7], v[156:159], v[196:199], v[4:7]
    v_mfma_f32_16x16x32_bf16 v[8:11], v[156:159], v[204:207], v[8:11]
    v_mfma_f32_16x16x32_bf16 v[12:15], v[164:167], v[188:191], v[12:15]
    v_mfma_f32_16x16x32_bf16 v[16:19], v[164:167], v[196:199], v[16:19]
    s_waitcnt lgkmcnt(0)
    s_barrier
    v_mfma_f32_16x16x32_bf16 v[20:23], v[164:167], v[204:207], v[20:23]
    v_mfma_f32_16x16x32_bf16 v[24:27], v[172:175], v[188:191], v[24:27]
    v_mfma_f32_16x16x32_bf16 v[28:31], v[172:175], v[196:199], v[28:31]
    v_mfma_f32_16x16x32_bf16 v[32:35], v[172:175], v[204:207], v[32:35]
    v_mfma_f32_16x16x32_bf16 v[36:39], v[180:183], v[188:191], v[36:39]
    v_mfma_f32_16x16x32_bf16 v[40:43], v[180:183], v[196:199], v[40:43]
    v_mfma_f32_16x16x32_bf16 v[44:47], v[180:183], v[204:207], v[44:47]
    v_mfma_f32_16x16x32_bf16 v[0:3], v[96:99], v[128:131], v[0:3]
    ds_read_b128 v[152:155], v216 offset:0
    v_mfma_f32_16x16x32_bf16 v[4:7], v[96:99], v[136:139], v[4:7]
    v_mfma_f32_16x16x32_bf16 v[8:11], v[96:99], v[144:147], v[8:11]
    ds_read_b128 v[184:187], v210 offset:0
    v_mfma_f32_16x16x32_bf16 v[12:15], v[104:107], v[128:131], v[12:15]
    v_mfma_f32_16x16x32_bf16 v[16:19], v[104:107], v[136:139], v[16:19]
    ds_read_b128 v[192:195], v210 offset:2048
    v_mfma_f32_16x16x32_bf16 v[20:23], v[104:107], v[144:147], v[20:23]
    v_mfma_f32_16x16x32_bf16 v[24:27], v[112:115], v[128:131], v[24:27]
    ds_read_b128 v[200:203], v210 offset:4096
    v_mfma_f32_16x16x32_bf16 v[28:31], v[112:115], v[136:139], v[28:31]
    v_mfma_f32_16x16x32_bf16 v[32:35], v[112:115], v[144:147], v[32:35]
    ds_read_b128 v[160:163], v216 offset:2048
    v_mfma_f32_16x16x32_bf16 v[36:39], v[120:123], v[128:131], v[36:39]
    v_mfma_f32_16x16x32_bf16 v[40:43], v[120:123], v[136:139], v[40:43]
    ds_read_b128 v[168:171], v216 offset:4096
    v_mfma_f32_16x16x32_bf16 v[44:47], v[120:123], v[144:147], v[44:47]
    v_mfma_f32_16x16x32_bf16 v[48:51], v[96:99], v[132:135], v[48:51]
    ds_read_b128 v[176:179], v216 offset:6144
    v_mfma_f32_16x16x32_bf16 v[52:55], v[96:99], v[140:143], v[52:55]
    v_mfma_f32_16x16x32_bf16 v[56:59], v[96:99], v[148:151], v[56:59]
    ds_read_b128 v[188:191], v213 offset:0
    v_mfma_f32_16x16x32_bf16 v[60:63], v[104:107], v[132:135], v[60:63]
    v_mfma_f32_16x16x32_bf16 v[64:67], v[104:107], v[140:143], v[64:67]
    ds_read_b128 v[196:199], v213 offset:2048
    v_mfma_f32_16x16x32_bf16 v[68:71], v[104:107], v[148:151], v[68:71]
    v_mfma_f32_16x16x32_bf16 v[72:75], v[112:115], v[132:135], v[72:75]
    ds_read_b128 v[204:207], v213 offset:4096
    v_mfma_f32_16x16x32_bf16 v[76:79], v[112:115], v[140:143], v[76:79]
    v_mfma_f32_16x16x32_bf16 v[80:83], v[112:115], v[148:151], v[80:83]
    ds_read_b128 v[156:159], v216 offset:1024
    v_mfma_f32_16x16x32_bf16 v[84:87], v[120:123], v[132:135], v[84:87]
    v_mfma_f32_16x16x32_bf16 v[88:91], v[120:123], v[140:143], v[88:91]
    ds_read_b128 v[164:167], v216 offset:3072
    v_mfma_f32_16x16x32_bf16 v[92:95], v[120:123], v[148:151], v[92:95]
    v_mfma_f32_16x16x32_bf16 v[48:51], v[100:103], v[128:131], v[48:51]
    ds_read_b128 v[172:175], v216 offset:5120
    v_xor_b32 v132, s34, v132
    v_xor_b32 v133, s34, v133
    v_mfma_f32_16x16x32_bf16 v[52:55], v[100:103], v[136:139], v[52:55]
    v_xor_b32 v134, s34, v134
    v_xor_b32 v135, s34, v135
    v_mfma_f32_16x16x32_bf16 v[56:59], v[100:103], v[144:147], v[56:59]
    ds_read_b128 v[180:183], v216 offset:7168
    v_xor_b32 v140, s34, v140
    v_xor_b32 v141, s34, v141
    v_mfma_f32_16x16x32_bf16 v[60:63], v[108:111], v[128:131], v[60:63]
    v_xor_b32 v142, s34, v142
    v_xor_b32 v143, s34, v143
    v_mfma_f32_16x16x32_bf16 v[64:67], v[108:111], v[136:139], v[64:67]
    v_xor_b32 v148, s34, v148
    v_xor_b32 v149, s34, v149
    v_mfma_f32_16x16x32_bf16 v[68:71], v[108:111], v[144:147], v[68:71]
    v_xor_b32 v150, s34, v150
    v_xor_b32 v151, s34, v151
    v_mfma_f32_16x16x32_bf16 v[72:75], v[116:119], v[128:131], v[72:75]
    v_mfma_f32_16x16x32_bf16 v[76:79], v[116:119], v[136:139], v[76:79]
    v_mfma_f32_16x16x32_bf16 v[80:83], v[116:119], v[144:147], v[80:83]
    v_mfma_f32_16x16x32_bf16 v[84:87], v[124:127], v[128:131], v[84:87]
    v_mfma_f32_16x16x32_bf16 v[88:91], v[124:127], v[136:139], v[88:91]
    v_mfma_f32_16x16x32_bf16 v[92:95], v[124:127], v[144:147], v[92:95]
    v_mfma_f32_16x16x32_bf16 v[0:3], v[100:103], v[132:135], v[0:3]
    v_mfma_f32_16x16x32_bf16 v[4:7], v[100:103], v[140:143], v[4:7]
    v_mfma_f32_16x16x32_bf16 v[8:11], v[100:103], v[148:151], v[8:11]
    v_mfma_f32_16x16x32_bf16 v[12:15], v[108:111], v[132:135], v[12:15]
    v_mfma_f32_16x16x32_bf16 v[16:19], v[108:111], v[140:143], v[16:19]
    s_waitcnt lgkmcnt(0)
    s_barrier
    v_mfma_f32_16x16x32_bf16 v[20:23], v[108:111], v[148:151], v[20:23]
    v_mfma_f32_16x16x32_bf16 v[24:27], v[116:119], v[132:135], v[24:27]
    v_mfma_f32_16x16x32_bf16 v[28:31], v[116:119], v[140:143], v[28:31]
    v_mfma_f32_16x16x32_bf16 v[32:35], v[116:119], v[148:151], v[32:35]
    v_mfma_f32_16x16x32_bf16 v[36:39], v[124:127], v[132:135], v[36:39]
    v_mfma_f32_16x16x32_bf16 v[40:43], v[124:127], v[140:143], v[40:43]
    v_mfma_f32_16x16x32_bf16 v[44:47], v[124:127], v[148:151], v[44:47]
    v_mfma_f32_16x16x32_bf16 v[0:3], v[152:155], v[184:187], v[0:3]
    ds_read_b128 v[96:99], v214 offset:0
    v_mfma_f32_16x16x32_bf16 v[4:7], v[152:155], v[192:195], v[4:7]
    v_mfma_f32_16x16x32_bf16 v[8:11], v[152:155], v[200:203], v[8:11]
    ds_read_b128 v[128:131], v208 offset:0
    v_mfma_f32_16x16x32_bf16 v[12:15], v[160:163], v[184:187], v[12:15]
    v_mfma_f32_16x16x32_bf16 v[16:19], v[160:163], v[192:195], v[16:19]
    ds_read_b128 v[136:139], v208 offset:2048
    v_mfma_f32_16x16x32_bf16 v[20:23], v[160:163], v[200:203], v[20:23]
    v_mfma_f32_16x16x32_bf16 v[24:27], v[168:171], v[184:187], v[24:27]
    ds_read_b128 v[144:147], v208 offset:4096
    v_mfma_f32_16x16x32_bf16 v[28:31], v[168:171], v[192:195], v[28:31]
    v_mfma_f32_16x16x32_bf16 v[32:35], v[168:171], v[200:203], v[32:35]
    ds_read_b128 v[104:107], v214 offset:2048
    v_mfma_f32_16x16x32_bf16 v[36:39], v[176:179], v[184:187], v[36:39]
    v_mfma_f32_16x16x32_bf16 v[40:43], v[176:179], v[192:195], v[40:43]
    ds_read_b128 v[112:115], v214 offset:4096
    v_mfma_f32_16x16x32_bf16 v[44:47], v[176:179], v[200:203], v[44:47]
    v_mfma_f32_16x16x32_bf16 v[48:51], v[152:155], v[188:191], v[48:51]
    ds_read_b128 v[120:123], v214 offset:6144
    v_mfma_f32_16x16x32_bf16 v[52:55], v[152:155], v[196:199], v[52:55]
    v_mfma_f32_16x16x32_bf16 v[56:59], v[152:155], v[204:207], v[56:59]
    ds_read_b128 v[132:135], v211 offset:0
    v_mfma_f32_16x16x32_bf16 v[60:63], v[160:163], v[188:191], v[60:63]
    v_mfma_f32_16x16x32_bf16 v[64:67], v[160:163], v[196:199], v[64:67]
    ds_read_b128 v[140:143], v211 offset:2048
    v_mfma_f32_16x16x32_bf16 v[68:71], v[160:163], v[204:207], v[68:71]
    v_mfma_f32_16x16x32_bf16 v[72:75], v[168:171], v[188:191], v[72:75]
    ds_read_b128 v[148:151], v211 offset:4096
    v_mfma_f32_16x16x32_bf16 v[76:79], v[168:171], v[196:199], v[76:79]
    v_mfma_f32_16x16x32_bf16 v[80:83], v[168:171], v[204:207], v[80:83]
    ds_read_b128 v[100:103], v214 offset:1024
    v_mfma_f32_16x16x32_bf16 v[84:87], v[176:179], v[188:191], v[84:87]
    v_mfma_f32_16x16x32_bf16 v[88:91], v[176:179], v[196:199], v[88:91]
    ds_read_b128 v[108:111], v214 offset:3072
    v_mfma_f32_16x16x32_bf16 v[92:95], v[176:179], v[204:207], v[92:95]
    v_mfma_f32_16x16x32_bf16 v[48:51], v[156:159], v[184:187], v[48:51]
    ds_read_b128 v[116:119], v214 offset:5120
    v_xor_b32 v188, s34, v188
    v_xor_b32 v189, s34, v189
    v_mfma_f32_16x16x32_bf16 v[52:55], v[156:159], v[192:195], v[52:55]
    v_xor_b32 v190, s34, v190
    v_xor_b32 v191, s34, v191
    v_mfma_f32_16x16x32_bf16 v[56:59], v[156:159], v[200:203], v[56:59]
    ds_read_b128 v[124:127], v214 offset:7168
    v_xor_b32 v196, s34, v196
    v_xor_b32 v197, s34, v197
    v_mfma_f32_16x16x32_bf16 v[60:63], v[164:167], v[184:187], v[60:63]
    v_xor_b32 v198, s34, v198
    v_xor_b32 v199, s34, v199
    v_mfma_f32_16x16x32_bf16 v[64:67], v[164:167], v[192:195], v[64:67]
    v_xor_b32 v204, s34, v204
    v_xor_b32 v205, s34, v205
    v_mfma_f32_16x16x32_bf16 v[68:71], v[164:167], v[200:203], v[68:71]
    v_xor_b32 v206, s34, v206
    v_xor_b32 v207, s34, v207
    v_mfma_f32_16x16x32_bf16 v[72:75], v[172:175], v[184:187], v[72:75]
    v_mfma_f32_16x16x32_bf16 v[76:79], v[172:175], v[192:195], v[76:79]
    v_mfma_f32_16x16x32_bf16 v[80:83], v[172:175], v[200:203], v[80:83]
    v_mfma_f32_16x16x32_bf16 v[84:87], v[180:183], v[184:187], v[84:87]
    v_mfma_f32_16x16x32_bf16 v[88:91], v[180:183], v[192:195], v[88:91]
    v_mfma_f32_16x16x32_bf16 v[92:95], v[180:183], v[200:203], v[92:95]
    v_mfma_f32_16x16x32_bf16 v[0:3], v[156:159], v[188:191], v[0:3]
    v_mfma_f32_16x16x32_bf16 v[4:7], v[156:159], v[196:199], v[4:7]
    v_mfma_f32_16x16x32_bf16 v[8:11], v[156:159], v[204:207], v[8:11]
    v_mfma_f32_16x16x32_bf16 v[12:15], v[164:167], v[188:191], v[12:15]
    v_mfma_f32_16x16x32_bf16 v[16:19], v[164:167], v[196:199], v[16:19]
    s_waitcnt lgkmcnt(0)
    s_barrier
    v_mfma_f32_16x16x32_bf16 v[20:23], v[164:167], v[204:207], v[20:23]
    v_mfma_f32_16x16x32_bf16 v[24:27], v[172:175], v[188:191], v[24:27]
    v_mfma_f32_16x16x32_bf16 v[28:31], v[172:175], v[196:199], v[28:31]
    v_mfma_f32_16x16x32_bf16 v[32:35], v[172:175], v[204:207], v[32:35]
    v_mfma_f32_16x16x32_bf16 v[36:39], v[180:183], v[188:191], v[36:39]
    v_mfma_f32_16x16x32_bf16 v[40:43], v[180:183], v[196:199], v[40:43]
    v_mfma_f32_16x16x32_bf16 v[44:47], v[180:183], v[204:207], v[44:47]
    v_mfma_f32_16x16x32_bf16 v[0:3], v[96:99], v[128:131], v[0:3]
    ds_read_b128 v[152:155], v214 offset:28672
    v_mfma_f32_16x16x32_bf16 v[4:7], v[96:99], v[136:139], v[4:7]
    v_mfma_f32_16x16x32_bf16 v[8:11], v[96:99], v[144:147], v[8:11]
    ds_read_b128 v[184:187], v208 offset:28672
    v_mfma_f32_16x16x32_bf16 v[12:15], v[104:107], v[128:131], v[12:15]
    v_mfma_f32_16x16x32_bf16 v[16:19], v[104:107], v[136:139], v[16:19]
    ds_read_b128 v[192:195], v208 offset:30720
    v_mfma_f32_16x16x32_bf16 v[20:23], v[104:107], v[144:147], v[20:23]
    v_mfma_f32_16x16x32_bf16 v[24:27], v[112:115], v[128:131], v[24:27]
    ds_read_b128 v[200:203], v208 offset:32768
    v_mfma_f32_16x16x32_bf16 v[28:31], v[112:115], v[136:139], v[28:31]
    v_mfma_f32_16x16x32_bf16 v[32:35], v[112:115], v[144:147], v[32:35]
    ds_read_b128 v[160:163], v214 offset:30720
    v_mfma_f32_16x16x32_bf16 v[36:39], v[120:123], v[128:131], v[36:39]
    v_mfma_f32_16x16x32_bf16 v[40:43], v[120:123], v[136:139], v[40:43]
    ds_read_b128 v[168:171], v214 offset:32768
    v_mfma_f32_16x16x32_bf16 v[44:47], v[120:123], v[144:147], v[44:47]
    v_mfma_f32_16x16x32_bf16 v[48:51], v[96:99], v[132:135], v[48:51]
    ds_read_b128 v[176:179], v214 offset:34816
    v_mfma_f32_16x16x32_bf16 v[52:55], v[96:99], v[140:143], v[52:55]
    v_mfma_f32_16x16x32_bf16 v[56:59], v[96:99], v[148:151], v[56:59]
    ds_read_b128 v[188:191], v211 offset:28672
    v_mfma_f32_16x16x32_bf16 v[60:63], v[104:107], v[132:135], v[60:63]
    v_mfma_f32_16x16x32_bf16 v[64:67], v[104:107], v[140:143], v[64:67]
    ds_read_b128 v[196:199], v211 offset:30720
    v_mfma_f32_16x16x32_bf16 v[68:71], v[104:107], v[148:151], v[68:71]
    v_mfma_f32_16x16x32_bf16 v[72:75], v[112:115], v[132:135], v[72:75]
    ds_read_b128 v[204:207], v211 offset:32768
    v_mfma_f32_16x16x32_bf16 v[76:79], v[112:115], v[140:143], v[76:79]
    v_mfma_f32_16x16x32_bf16 v[80:83], v[112:115], v[148:151], v[80:83]
    ds_read_b128 v[156:159], v214 offset:29696
    v_mfma_f32_16x16x32_bf16 v[84:87], v[120:123], v[132:135], v[84:87]
    v_mfma_f32_16x16x32_bf16 v[88:91], v[120:123], v[140:143], v[88:91]
    ds_read_b128 v[164:167], v214 offset:31744
    v_mfma_f32_16x16x32_bf16 v[92:95], v[120:123], v[148:151], v[92:95]
    v_mfma_f32_16x16x32_bf16 v[48:51], v[100:103], v[128:131], v[48:51]
    ds_read_b128 v[172:175], v214 offset:33792
    v_xor_b32 v132, s34, v132
    v_xor_b32 v133, s34, v133
    v_mfma_f32_16x16x32_bf16 v[52:55], v[100:103], v[136:139], v[52:55]
    v_xor_b32 v134, s34, v134
    v_xor_b32 v135, s34, v135
    v_mfma_f32_16x16x32_bf16 v[56:59], v[100:103], v[144:147], v[56:59]
    ds_read_b128 v[180:183], v214 offset:35840
    v_xor_b32 v140, s34, v140
    v_xor_b32 v141, s34, v141
    v_mfma_f32_16x16x32_bf16 v[60:63], v[108:111], v[128:131], v[60:63]
    v_xor_b32 v142, s34, v142
    v_xor_b32 v143, s34, v143
    v_mfma_f32_16x16x32_bf16 v[64:67], v[108:111], v[136:139], v[64:67]
    v_xor_b32 v148, s34, v148
    v_xor_b32 v149, s34, v149
    v_mfma_f32_16x16x32_bf16 v[68:71], v[108:111], v[144:147], v[68:71]
    v_xor_b32 v150, s34, v150
    v_xor_b32 v151, s34, v151
    v_mfma_f32_16x16x32_bf16 v[72:75], v[116:119], v[128:131], v[72:75]
    v_mfma_f32_16x16x32_bf16 v[76:79], v[116:119], v[136:139], v[76:79]
    v_mfma_f32_16x16x32_bf16 v[80:83], v[116:119], v[144:147], v[80:83]
    v_mfma_f32_16x16x32_bf16 v[84:87], v[124:127], v[128:131], v[84:87]
    v_mfma_f32_16x16x32_bf16 v[88:91], v[124:127], v[136:139], v[88:91]
    v_mfma_f32_16x16x32_bf16 v[92:95], v[124:127], v[144:147], v[92:95]
    v_mfma_f32_16x16x32_bf16 v[0:3], v[100:103], v[132:135], v[0:3]
    v_mfma_f32_16x16x32_bf16 v[4:7], v[100:103], v[140:143], v[4:7]
    v_mfma_f32_16x16x32_bf16 v[8:11], v[100:103], v[148:151], v[8:11]
    v_mfma_f32_16x16x32_bf16 v[12:15], v[108:111], v[132:135], v[12:15]
    v_mfma_f32_16x16x32_bf16 v[16:19], v[108:111], v[140:143], v[16:19]
    s_waitcnt lgkmcnt(0)
    s_barrier
    v_mfma_f32_16x16x32_bf16 v[20:23], v[108:111], v[148:151], v[20:23]
    v_mfma_f32_16x16x32_bf16 v[24:27], v[116:119], v[132:135], v[24:27]
    v_mfma_f32_16x16x32_bf16 v[28:31], v[116:119], v[140:143], v[28:31]
    v_mfma_f32_16x16x32_bf16 v[32:35], v[116:119], v[148:151], v[32:35]
    v_mfma_f32_16x16x32_bf16 v[36:39], v[124:127], v[132:135], v[36:39]
    v_mfma_f32_16x16x32_bf16 v[40:43], v[124:127], v[140:143], v[40:43]
    v_mfma_f32_16x16x32_bf16 v[44:47], v[124:127], v[148:151], v[44:47]
    v_mfma_f32_16x16x32_bf16 v[0:3], v[152:155], v[184:187], v[0:3]
    ds_read_b128 v[96:99], v215 offset:0
    v_mfma_f32_16x16x32_bf16 v[4:7], v[152:155], v[192:195], v[4:7]
    v_mfma_f32_16x16x32_bf16 v[8:11], v[152:155], v[200:203], v[8:11]
    ds_read_b128 v[128:131], v209 offset:0
    v_mfma_f32_16x16x32_bf16 v[12:15], v[160:163], v[184:187], v[12:15]
    v_mfma_f32_16x16x32_bf16 v[16:19], v[160:163], v[192:195], v[16:19]
    ds_read_b128 v[136:139], v209 offset:2048
    v_mfma_f32_16x16x32_bf16 v[20:23], v[160:163], v[200:203], v[20:23]
    v_mfma_f32_16x16x32_bf16 v[24:27], v[168:171], v[184:187], v[24:27]
    ds_read_b128 v[144:147], v209 offset:4096
    v_mfma_f32_16x16x32_bf16 v[28:31], v[168:171], v[192:195], v[28:31]
    v_mfma_f32_16x16x32_bf16 v[32:35], v[168:171], v[200:203], v[32:35]
    ds_read_b128 v[104:107], v215 offset:2048
    v_mfma_f32_16x16x32_bf16 v[36:39], v[176:179], v[184:187], v[36:39]
    v_mfma_f32_16x16x32_bf16 v[40:43], v[176:179], v[192:195], v[40:43]
    ds_read_b128 v[112:115], v215 offset:4096
    v_mfma_f32_16x16x32_bf16 v[44:47], v[176:179], v[200:203], v[44:47]
    v_mfma_f32_16x16x32_bf16 v[48:51], v[152:155], v[188:191], v[48:51]
    ds_read_b128 v[120:123], v215 offset:6144
    v_mfma_f32_16x16x32_bf16 v[52:55], v[152:155], v[196:199], v[52:55]
    v_mfma_f32_16x16x32_bf16 v[56:59], v[152:155], v[204:207], v[56:59]
    ds_read_b128 v[132:135], v212 offset:0
    v_mfma_f32_16x16x32_bf16 v[60:63], v[160:163], v[188:191], v[60:63]
    v_mfma_f32_16x16x32_bf16 v[64:67], v[160:163], v[196:199], v[64:67]
    ds_read_b128 v[140:143], v212 offset:2048
    v_mfma_f32_16x16x32_bf16 v[68:71], v[160:163], v[204:207], v[68:71]
    v_mfma_f32_16x16x32_bf16 v[72:75], v[168:171], v[188:191], v[72:75]
    ds_read_b128 v[148:151], v212 offset:4096
    v_mfma_f32_16x16x32_bf16 v[76:79], v[168:171], v[196:199], v[76:79]
    v_mfma_f32_16x16x32_bf16 v[80:83], v[168:171], v[204:207], v[80:83]
    ds_read_b128 v[100:103], v215 offset:1024
    v_mfma_f32_16x16x32_bf16 v[84:87], v[176:179], v[188:191], v[84:87]
    v_mfma_f32_16x16x32_bf16 v[88:91], v[176:179], v[196:199], v[88:91]
    ds_read_b128 v[108:111], v215 offset:3072
    v_mfma_f32_16x16x32_bf16 v[92:95], v[176:179], v[204:207], v[92:95]
    v_mfma_f32_16x16x32_bf16 v[48:51], v[156:159], v[184:187], v[48:51]
    ds_read_b128 v[116:119], v215 offset:5120
    v_xor_b32 v188, s34, v188
    v_xor_b32 v189, s34, v189
    v_mfma_f32_16x16x32_bf16 v[52:55], v[156:159], v[192:195], v[52:55]
    v_xor_b32 v190, s34, v190
    v_xor_b32 v191, s34, v191
    v_mfma_f32_16x16x32_bf16 v[56:59], v[156:159], v[200:203], v[56:59]
    ds_read_b128 v[124:127], v215 offset:7168
    v_xor_b32 v196, s34, v196
    v_xor_b32 v197, s34, v197
    v_mfma_f32_16x16x32_bf16 v[60:63], v[164:167], v[184:187], v[60:63]
    v_xor_b32 v198, s34, v198
    v_xor_b32 v199, s34, v199
    v_mfma_f32_16x16x32_bf16 v[64:67], v[164:167], v[192:195], v[64:67]
    v_xor_b32 v204, s34, v204
    v_xor_b32 v205, s34, v205
    v_mfma_f32_16x16x32_bf16 v[68:71], v[164:167], v[200:203], v[68:71]
    v_xor_b32 v206, s34, v206
    v_xor_b32 v207, s34, v207
    v_mfma_f32_16x16x32_bf16 v[72:75], v[172:175], v[184:187], v[72:75]
    v_mfma_f32_16x16x32_bf16 v[76:79], v[172:175], v[192:195], v[76:79]
    v_mfma_f32_16x16x32_bf16 v[80:83], v[172:175], v[200:203], v[80:83]
    v_mfma_f32_16x16x32_bf16 v[84:87], v[180:183], v[184:187], v[84:87]
    v_mfma_f32_16x16x32_bf16 v[88:91], v[180:183], v[192:195], v[88:91]
    v_mfma_f32_16x16x32_bf16 v[92:95], v[180:183], v[200:203], v[92:95]
    v_mfma_f32_16x16x32_bf16 v[0:3], v[156:159], v[188:191], v[0:3]
    v_mfma_f32_16x16x32_bf16 v[4:7], v[156:159], v[196:199], v[4:7]
    v_mfma_f32_16x16x32_bf16 v[8:11], v[156:159], v[204:207], v[8:11]
    v_mfma_f32_16x16x32_bf16 v[12:15], v[164:167], v[188:191], v[12:15]
    v_mfma_f32_16x16x32_bf16 v[16:19], v[164:167], v[196:199], v[16:19]
    s_waitcnt lgkmcnt(0)
    s_barrier
    v_mfma_f32_16x16x32_bf16 v[20:23], v[164:167], v[204:207], v[20:23]
    v_mfma_f32_16x16x32_bf16 v[24:27], v[172:175], v[188:191], v[24:27]
    v_mfma_f32_16x16x32_bf16 v[28:31], v[172:175], v[196:199], v[28:31]
    v_mfma_f32_16x16x32_bf16 v[32:35], v[172:175], v[204:207], v[32:35]
    v_mfma_f32_16x16x32_bf16 v[36:39], v[180:183], v[188:191], v[36:39]
    v_mfma_f32_16x16x32_bf16 v[40:43], v[180:183], v[196:199], v[40:43]
    v_mfma_f32_16x16x32_bf16 v[44:47], v[180:183], v[204:207], v[44:47]
    v_mfma_f32_16x16x32_bf16 v[0:3], v[96:99], v[128:131], v[0:3]
    ds_read_b128 v[152:155], v215 offset:28672
    v_mfma_f32_16x16x32_bf16 v[4:7], v[96:99], v[136:139], v[4:7]
    v_mfma_f32_16x16x32_bf16 v[8:11], v[96:99], v[144:147], v[8:11]
    ds_read_b128 v[184:187], v209 offset:28672
    v_mfma_f32_16x16x32_bf16 v[12:15], v[104:107], v[128:131], v[12:15]
    v_mfma_f32_16x16x32_bf16 v[16:19], v[104:107], v[136:139], v[16:19]
    ds_read_b128 v[192:195], v209 offset:30720
    v_mfma_f32_16x16x32_bf16 v[20:23], v[104:107], v[144:147], v[20:23]
    v_mfma_f32_16x16x32_bf16 v[24:27], v[112:115], v[128:131], v[24:27]
    ds_read_b128 v[200:203], v209 offset:32768
    v_mfma_f32_16x16x32_bf16 v[28:31], v[112:115], v[136:139], v[28:31]
    v_mfma_f32_16x16x32_bf16 v[32:35], v[112:115], v[144:147], v[32:35]
    ds_read_b128 v[160:163], v215 offset:30720
    v_mfma_f32_16x16x32_bf16 v[36:39], v[120:123], v[128:131], v[36:39]
    v_mfma_f32_16x16x32_bf16 v[40:43], v[120:123], v[136:139], v[40:43]
    ds_read_b128 v[168:171], v215 offset:32768
    v_mfma_f32_16x16x32_bf16 v[44:47], v[120:123], v[144:147], v[44:47]
    v_mfma_f32_16x16x32_bf16 v[48:51], v[96:99], v[132:135], v[48:51]
    ds_read_b128 v[176:179], v215 offset:34816
    v_mfma_f32_16x16x32_bf16 v[52:55], v[96:99], v[140:143], v[52:55]
    v_mfma_f32_16x16x32_bf16 v[56:59], v[96:99], v[148:151], v[56:59]
    ds_read_b128 v[188:191], v212 offset:28672
    v_mfma_f32_16x16x32_bf16 v[60:63], v[104:107], v[132:135], v[60:63]
    v_mfma_f32_16x16x32_bf16 v[64:67], v[104:107], v[140:143], v[64:67]
    ds_read_b128 v[196:199], v212 offset:30720
    v_mfma_f32_16x16x32_bf16 v[68:71], v[104:107], v[148:151], v[68:71]
    v_mfma_f32_16x16x32_bf16 v[72:75], v[112:115], v[132:135], v[72:75]
    ds_read_b128 v[204:207], v212 offset:32768
    v_mfma_f32_16x16x32_bf16 v[76:79], v[112:115], v[140:143], v[76:79]
    v_mfma_f32_16x16x32_bf16 v[80:83], v[112:115], v[148:151], v[80:83]
    ds_read_b128 v[156:159], v215 offset:29696
    v_mfma_f32_16x16x32_bf16 v[84:87], v[120:123], v[132:135], v[84:87]
    v_mfma_f32_16x16x32_bf16 v[88:91], v[120:123], v[140:143], v[88:91]
    ds_read_b128 v[164:167], v215 offset:31744
    v_mfma_f32_16x16x32_bf16 v[92:95], v[120:123], v[148:151], v[92:95]
    v_mfma_f32_16x16x32_bf16 v[48:51], v[100:103], v[128:131], v[48:51]
    ds_read_b128 v[172:175], v215 offset:33792
    v_xor_b32 v132, s34, v132
    v_xor_b32 v133, s34, v133
    v_mfma_f32_16x16x32_bf16 v[52:55], v[100:103], v[136:139], v[52:55]
    v_xor_b32 v134, s34, v134
    v_xor_b32 v135, s34, v135
    v_mfma_f32_16x16x32_bf16 v[56:59], v[100:103], v[144:147], v[56:59]
    ds_read_b128 v[180:183], v215 offset:35840
    v_xor_b32 v140, s34, v140
    v_xor_b32 v141, s34, v141
    v_mfma_f32_16x16x32_bf16 v[60:63], v[108:111], v[128:131], v[60:63]
    v_xor_b32 v142, s34, v142
    v_xor_b32 v143, s34, v143
    v_mfma_f32_16x16x32_bf16 v[64:67], v[108:111], v[136:139], v[64:67]
    v_xor_b32 v148, s34, v148
    v_xor_b32 v149, s34, v149
    v_mfma_f32_16x16x32_bf16 v[68:71], v[108:111], v[144:147], v[68:71]
    v_xor_b32 v150, s34, v150
    v_xor_b32 v151, s34, v151
    v_mfma_f32_16x16x32_bf16 v[72:75], v[116:119], v[128:131], v[72:75]
    v_mfma_f32_16x16x32_bf16 v[76:79], v[116:119], v[136:139], v[76:79]
    v_mfma_f32_16x16x32_bf16 v[80:83], v[116:119], v[144:147], v[80:83]
    v_mfma_f32_16x16x32_bf16 v[84:87], v[124:127], v[128:131], v[84:87]
    v_mfma_f32_16x16x32_bf16 v[88:91], v[124:127], v[136:139], v[88:91]
    v_mfma_f32_16x16x32_bf16 v[92:95], v[124:127], v[144:147], v[92:95]
    v_mfma_f32_16x16x32_bf16 v[0:3], v[100:103], v[132:135], v[0:3]
    v_mfma_f32_16x16x32_bf16 v[4:7], v[100:103], v[140:143], v[4:7]
    v_mfma_f32_16x16x32_bf16 v[8:11], v[100:103], v[148:151], v[8:11]
    v_mfma_f32_16x16x32_bf16 v[12:15], v[108:111], v[132:135], v[12:15]
    v_mfma_f32_16x16x32_bf16 v[16:19], v[108:111], v[140:143], v[16:19]
    s_waitcnt lgkmcnt(0)
    s_barrier
    v_mfma_f32_16x16x32_bf16 v[20:23], v[108:111], v[148:151], v[20:23]
    v_mfma_f32_16x16x32_bf16 v[24:27], v[116:119], v[132:135], v[24:27]
    v_mfma_f32_16x16x32_bf16 v[28:31], v[116:119], v[140:143], v[28:31]
    v_mfma_f32_16x16x32_bf16 v[32:35], v[116:119], v[148:151], v[32:35]
    v_mfma_f32_16x16x32_bf16 v[36:39], v[124:127], v[132:135], v[36:39]
    v_mfma_f32_16x16x32_bf16 v[40:43], v[124:127], v[140:143], v[40:43]
    v_mfma_f32_16x16x32_bf16 v[44:47], v[124:127], v[148:151], v[44:47]
    v_mfma_f32_16x16x32_bf16 v[0:3], v[152:155], v[184:187], v[0:3]
    ds_read_b128 v[96:99], v216 offset:0
    v_mfma_f32_16x16x32_bf16 v[4:7], v[152:155], v[192:195], v[4:7]
    v_mfma_f32_16x16x32_bf16 v[8:11], v[152:155], v[200:203], v[8:11]
    ds_read_b128 v[128:131], v210 offset:0
    v_mfma_f32_16x16x32_bf16 v[12:15], v[160:163], v[184:187], v[12:15]
    v_mfma_f32_16x16x32_bf16 v[16:19], v[160:163], v[192:195], v[16:19]
    ds_read_b128 v[136:139], v210 offset:2048
    v_mfma_f32_16x16x32_bf16 v[20:23], v[160:163], v[200:203], v[20:23]
    v_mfma_f32_16x16x32_bf16 v[24:27], v[168:171], v[184:187], v[24:27]
    ds_read_b128 v[144:147], v210 offset:4096
    v_mfma_f32_16x16x32_bf16 v[28:31], v[168:171], v[192:195], v[28:31]
    v_mfma_f32_16x16x32_bf16 v[32:35], v[168:171], v[200:203], v[32:35]
    ds_read_b128 v[104:107], v216 offset:2048
    v_mfma_f32_16x16x32_bf16 v[36:39], v[176:179], v[184:187], v[36:39]
    v_mfma_f32_16x16x32_bf16 v[40:43], v[176:179], v[192:195], v[40:43]
    ds_read_b128 v[112:115], v216 offset:4096
    v_mfma_f32_16x16x32_bf16 v[44:47], v[176:179], v[200:203], v[44:47]
    v_mfma_f32_16x16x32_bf16 v[48:51], v[152:155], v[188:191], v[48:51]
    ds_read_b128 v[120:123], v216 offset:6144
    v_mfma_f32_16x16x32_bf16 v[52:55], v[152:155], v[196:199], v[52:55]
    v_mfma_f32_16x16x32_bf16 v[56:59], v[152:155], v[204:207], v[56:59]
    ds_read_b128 v[132:135], v213 offset:0
    v_mfma_f32_16x16x32_bf16 v[60:63], v[160:163], v[188:191], v[60:63]
    v_mfma_f32_16x16x32_bf16 v[64:67], v[160:163], v[196:199], v[64:67]
    ds_read_b128 v[140:143], v213 offset:2048
    v_mfma_f32_16x16x32_bf16 v[68:71], v[160:163], v[204:207], v[68:71]
    v_mfma_f32_16x16x32_bf16 v[72:75], v[168:171], v[188:191], v[72:75]
    ds_read_b128 v[148:151], v213 offset:4096
    v_mfma_f32_16x16x32_bf16 v[76:79], v[168:171], v[196:199], v[76:79]
    v_mfma_f32_16x16x32_bf16 v[80:83], v[168:171], v[204:207], v[80:83]
    ds_read_b128 v[100:103], v216 offset:1024
    v_mfma_f32_16x16x32_bf16 v[84:87], v[176:179], v[188:191], v[84:87]
    v_mfma_f32_16x16x32_bf16 v[88:91], v[176:179], v[196:199], v[88:91]
    ds_read_b128 v[108:111], v216 offset:3072
    v_mfma_f32_16x16x32_bf16 v[92:95], v[176:179], v[204:207], v[92:95]
    v_mfma_f32_16x16x32_bf16 v[48:51], v[156:159], v[184:187], v[48:51]
    ds_read_b128 v[116:119], v216 offset:5120
    v_xor_b32 v188, s34, v188
    v_xor_b32 v189, s34, v189
    v_mfma_f32_16x16x32_bf16 v[52:55], v[156:159], v[192:195], v[52:55]
    v_xor_b32 v190, s34, v190
    v_xor_b32 v191, s34, v191
    v_mfma_f32_16x16x32_bf16 v[56:59], v[156:159], v[200:203], v[56:59]
    ds_read_b128 v[124:127], v216 offset:7168
    v_xor_b32 v196, s34, v196
    v_xor_b32 v197, s34, v197
    v_mfma_f32_16x16x32_bf16 v[60:63], v[164:167], v[184:187], v[60:63]
    v_xor_b32 v198, s34, v198
    v_xor_b32 v199, s34, v199
    v_mfma_f32_16x16x32_bf16 v[64:67], v[164:167], v[192:195], v[64:67]
    v_xor_b32 v204, s34, v204
    v_xor_b32 v205, s34, v205
    v_mfma_f32_16x16x32_bf16 v[68:71], v[164:167], v[200:203], v[68:71]
    v_xor_b32 v206, s34, v206
    v_xor_b32 v207, s34, v207
    v_mfma_f32_16x16x32_bf16 v[72:75], v[172:175], v[184:187], v[72:75]
    v_mfma_f32_16x16x32_bf16 v[76:79], v[172:175], v[192:195], v[76:79]
    v_mfma_f32_16x16x32_bf16 v[80:83], v[172:175], v[200:203], v[80:83]
    v_mfma_f32_16x16x32_bf16 v[84:87], v[180:183], v[184:187], v[84:87]
    v_mfma_f32_16x16x32_bf16 v[88:91], v[180:183], v[192:195], v[88:91]
    v_mfma_f32_16x16x32_bf16 v[92:95], v[180:183], v[200:203], v[92:95]
    v_mfma_f32_16x16x32_bf16 v[0:3], v[156:159], v[188:191], v[0:3]
    v_mfma_f32_16x16x32_bf16 v[4:7], v[156:159], v[196:199], v[4:7]
    v_mfma_f32_16x16x32_bf16 v[8:11], v[156:159], v[204:207], v[8:11]
    v_mfma_f32_16x16x32_bf16 v[12:15], v[164:167], v[188:191], v[12:15]
    v_mfma_f32_16x16x32_bf16 v[16:19], v[164:167], v[196:199], v[16:19]
    s_waitcnt lgkmcnt(0)
    s_barrier
    v_mfma_f32_16x16x32_bf16 v[20:23], v[164:167], v[204:207], v[20:23]
    v_mfma_f32_16x16x32_bf16 v[24:27], v[172:175], v[188:191], v[24:27]
    v_mfma_f32_16x16x32_bf16 v[28:31], v[172:175], v[196:199], v[28:31]
    v_mfma_f32_16x16x32_bf16 v[32:35], v[172:175], v[204:207], v[32:35]
    v_mfma_f32_16x16x32_bf16 v[36:39], v[180:183], v[188:191], v[36:39]
    v_mfma_f32_16x16x32_bf16 v[40:43], v[180:183], v[196:199], v[40:43]
    v_mfma_f32_16x16x32_bf16 v[44:47], v[180:183], v[204:207], v[44:47]
    v_mfma_f32_16x16x32_bf16 v[0:3], v[96:99], v[128:131], v[0:3]
    ds_read_b128 v[152:155], v214 offset:0
    v_mfma_f32_16x16x32_bf16 v[4:7], v[96:99], v[136:139], v[4:7]
    v_mfma_f32_16x16x32_bf16 v[8:11], v[96:99], v[144:147], v[8:11]
    ds_read_b128 v[184:187], v208 offset:0
    v_mfma_f32_16x16x32_bf16 v[12:15], v[104:107], v[128:131], v[12:15]
    v_mfma_f32_16x16x32_bf16 v[16:19], v[104:107], v[136:139], v[16:19]
    ds_read_b128 v[192:195], v208 offset:2048
    v_mfma_f32_16x16x32_bf16 v[20:23], v[104:107], v[144:147], v[20:23]
    v_mfma_f32_16x16x32_bf16 v[24:27], v[112:115], v[128:131], v[24:27]
    ds_read_b128 v[200:203], v208 offset:4096
    v_mfma_f32_16x16x32_bf16 v[28:31], v[112:115], v[136:139], v[28:31]
    v_mfma_f32_16x16x32_bf16 v[32:35], v[112:115], v[144:147], v[32:35]
    ds_read_b128 v[160:163], v214 offset:2048
    v_mfma_f32_16x16x32_bf16 v[36:39], v[120:123], v[128:131], v[36:39]
    v_mfma_f32_16x16x32_bf16 v[40:43], v[120:123], v[136:139], v[40:43]
    ds_read_b128 v[168:171], v214 offset:4096
    v_mfma_f32_16x16x32_bf16 v[44:47], v[120:123], v[144:147], v[44:47]
    v_mfma_f32_16x16x32_bf16 v[48:51], v[96:99], v[132:135], v[48:51]
    ds_read_b128 v[176:179], v214 offset:6144
    v_mfma_f32_16x16x32_bf16 v[52:55], v[96:99], v[140:143], v[52:55]
    v_mfma_f32_16x16x32_bf16 v[56:59], v[96:99], v[148:151], v[56:59]
    ds_read_b128 v[188:191], v211 offset:0
    v_mfma_f32_16x16x32_bf16 v[60:63], v[104:107], v[132:135], v[60:63]
    v_mfma_f32_16x16x32_bf16 v[64:67], v[104:107], v[140:143], v[64:67]
    ds_read_b128 v[196:199], v211 offset:2048
    v_mfma_f32_16x16x32_bf16 v[68:71], v[104:107], v[148:151], v[68:71]
    v_mfma_f32_16x16x32_bf16 v[72:75], v[112:115], v[132:135], v[72:75]
    ds_read_b128 v[204:207], v211 offset:4096
    v_mfma_f32_16x16x32_bf16 v[76:79], v[112:115], v[140:143], v[76:79]
    v_mfma_f32_16x16x32_bf16 v[80:83], v[112:115], v[148:151], v[80:83]
    ds_read_b128 v[156:159], v214 offset:1024
    v_mfma_f32_16x16x32_bf16 v[84:87], v[120:123], v[132:135], v[84:87]
    v_mfma_f32_16x16x32_bf16 v[88:91], v[120:123], v[140:143], v[88:91]
    ds_read_b128 v[164:167], v214 offset:3072
    v_mfma_f32_16x16x32_bf16 v[92:95], v[120:123], v[148:151], v[92:95]
    v_mfma_f32_16x16x32_bf16 v[48:51], v[100:103], v[128:131], v[48:51]
    ds_read_b128 v[172:175], v214 offset:5120
    v_xor_b32 v132, s34, v132
    v_xor_b32 v133, s34, v133
    v_mfma_f32_16x16x32_bf16 v[52:55], v[100:103], v[136:139], v[52:55]
    v_xor_b32 v134, s34, v134
    v_xor_b32 v135, s34, v135
    v_mfma_f32_16x16x32_bf16 v[56:59], v[100:103], v[144:147], v[56:59]
    ds_read_b128 v[180:183], v214 offset:7168
    v_xor_b32 v140, s34, v140
    v_xor_b32 v141, s34, v141
    v_mfma_f32_16x16x32_bf16 v[60:63], v[108:111], v[128:131], v[60:63]
    v_xor_b32 v142, s34, v142
    v_xor_b32 v143, s34, v143
    v_mfma_f32_16x16x32_bf16 v[64:67], v[108:111], v[136:139], v[64:67]
    v_xor_b32 v148, s34, v148
    v_xor_b32 v149, s34, v149
    v_mfma_f32_16x16x32_bf16 v[68:71], v[108:111], v[144:147], v[68:71]
    v_xor_b32 v150, s34, v150
    v_xor_b32 v151, s34, v151
    v_mfma_f32_16x16x32_bf16 v[72:75], v[116:119], v[128:131], v[72:75]
    v_mfma_f32_16x16x32_bf16 v[76:79], v[116:119], v[136:139], v[76:79]
    v_mfma_f32_16x16x32_bf16 v[80:83], v[116:119], v[144:147], v[80:83]
    v_mfma_f32_16x16x32_bf16 v[84:87], v[124:127], v[128:131], v[84:87]
    v_mfma_f32_16x16x32_bf16 v[88:91], v[124:127], v[136:139], v[88:91]
    v_mfma_f32_16x16x32_bf16 v[92:95], v[124:127], v[144:147], v[92:95]
    v_mfma_f32_16x16x32_bf16 v[0:3], v[100:103], v[132:135], v[0:3]
    v_mfma_f32_16x16x32_bf16 v[4:7], v[100:103], v[140:143], v[4:7]
    v_mfma_f32_16x16x32_bf16 v[8:11], v[100:103], v[148:151], v[8:11]
    v_mfma_f32_16x16x32_bf16 v[12:15], v[108:111], v[132:135], v[12:15]
    v_mfma_f32_16x16x32_bf16 v[16:19], v[108:111], v[140:143], v[16:19]
    s_waitcnt lgkmcnt(0)
    v_mfma_f32_16x16x32_bf16 v[20:23], v[108:111], v[148:151], v[20:23]
    v_mfma_f32_16x16x32_bf16 v[24:27], v[116:119], v[132:135], v[24:27]
    v_mfma_f32_16x16x32_bf16 v[28:31], v[116:119], v[140:143], v[28:31]
    v_mfma_f32_16x16x32_bf16 v[32:35], v[116:119], v[148:151], v[32:35]
    v_mfma_f32_16x16x32_bf16 v[36:39], v[124:127], v[132:135], v[36:39]
    v_mfma_f32_16x16x32_bf16 v[40:43], v[124:127], v[140:143], v[40:43]
    v_mfma_f32_16x16x32_bf16 v[44:47], v[124:127], v[148:151], v[44:47]
    v_mfma_f32_16x16x32_bf16 v[0:3], v[152:155], v[184:187], v[0:3]
    v_mfma_f32_16x16x32_bf16 v[4:7], v[152:155], v[192:195], v[4:7]
    v_mfma_f32_16x16x32_bf16 v[8:11], v[152:155], v[200:203], v[8:11]
    v_mfma_f32_16x16x32_bf16 v[12:15], v[160:163], v[184:187], v[12:15]
    v_mfma_f32_16x16x32_bf16 v[16:19], v[160:163], v[192:195], v[16:19]
    v_mfma_f32_16x16x32_bf16 v[20:23], v[160:163], v[200:203], v[20:23]
    v_mfma_f32_16x16x32_bf16 v[24:27], v[168:171], v[184:187], v[24:27]
    v_mfma_f32_16x16x32_bf16 v[28:31], v[168:171], v[192:195], v[28:31]
    v_mfma_f32_16x16x32_bf16 v[32:35], v[168:171], v[200:203], v[32:35]
    v_mfma_f32_16x16x32_bf16 v[36:39], v[176:179], v[184:187], v[36:39]
    v_mfma_f32_16x16x32_bf16 v[40:43], v[176:179], v[192:195], v[40:43]
    v_mfma_f32_16x16x32_bf16 v[44:47], v[176:179], v[200:203], v[44:47]
    v_mfma_f32_16x16x32_bf16 v[48:51], v[152:155], v[188:191], v[48:51]
    v_mfma_f32_16x16x32_bf16 v[52:55], v[152:155], v[196:199], v[52:55]
    v_mfma_f32_16x16x32_bf16 v[56:59], v[152:155], v[204:207], v[56:59]
    v_mfma_f32_16x16x32_bf16 v[60:63], v[160:163], v[188:191], v[60:63]
    v_mfma_f32_16x16x32_bf16 v[64:67], v[160:163], v[196:199], v[64:67]
    v_mfma_f32_16x16x32_bf16 v[68:71], v[160:163], v[204:207], v[68:71]
    v_mfma_f32_16x16x32_bf16 v[72:75], v[168:171], v[188:191], v[72:75]
    v_mfma_f32_16x16x32_bf16 v[76:79], v[168:171], v[196:199], v[76:79]
    v_mfma_f32_16x16x32_bf16 v[80:83], v[168:171], v[204:207], v[80:83]
    v_mfma_f32_16x16x32_bf16 v[84:87], v[176:179], v[188:191], v[84:87]
    v_mfma_f32_16x16x32_bf16 v[88:91], v[176:179], v[196:199], v[88:91]
    v_mfma_f32_16x16x32_bf16 v[92:95], v[176:179], v[204:207], v[92:95]
    v_mfma_f32_16x16x32_bf16 v[48:51], v[156:159], v[184:187], v[48:51]
    v_xor_b32 v188, s34, v188
    v_xor_b32 v189, s34, v189
    v_mfma_f32_16x16x32_bf16 v[52:55], v[156:159], v[192:195], v[52:55]
    v_xor_b32 v190, s34, v190
    v_xor_b32 v191, s34, v191
    v_mfma_f32_16x16x32_bf16 v[56:59], v[156:159], v[200:203], v[56:59]
    v_xor_b32 v196, s34, v196
    v_xor_b32 v197, s34, v197
    v_mfma_f32_16x16x32_bf16 v[60:63], v[164:167], v[184:187], v[60:63]
    v_xor_b32 v198, s34, v198
    v_xor_b32 v199, s34, v199
    v_mfma_f32_16x16x32_bf16 v[64:67], v[164:167], v[192:195], v[64:67]
    v_xor_b32 v204, s34, v204
    v_xor_b32 v205, s34, v205
    v_mfma_f32_16x16x32_bf16 v[68:71], v[164:167], v[200:203], v[68:71]
    v_xor_b32 v206, s34, v206
    v_xor_b32 v207, s34, v207
    v_mfma_f32_16x16x32_bf16 v[72:75], v[172:175], v[184:187], v[72:75]
    v_mfma_f32_16x16x32_bf16 v[76:79], v[172:175], v[192:195], v[76:79]
    v_mfma_f32_16x16x32_bf16 v[80:83], v[172:175], v[200:203], v[80:83]
    v_mfma_f32_16x16x32_bf16 v[84:87], v[180:183], v[184:187], v[84:87]
    v_mfma_f32_16x16x32_bf16 v[88:91], v[180:183], v[192:195], v[88:91]
    v_mfma_f32_16x16x32_bf16 v[92:95], v[180:183], v[200:203], v[92:95]
    v_mfma_f32_16x16x32_bf16 v[0:3], v[156:159], v[188:191], v[0:3]
    v_mfma_f32_16x16x32_bf16 v[4:7], v[156:159], v[196:199], v[4:7]
    v_mfma_f32_16x16x32_bf16 v[8:11], v[156:159], v[204:207], v[8:11]
    v_mfma_f32_16x16x32_bf16 v[12:15], v[164:167], v[188:191], v[12:15]
    v_mfma_f32_16x16x32_bf16 v[16:19], v[164:167], v[196:199], v[16:19]
    v_mfma_f32_16x16x32_bf16 v[20:23], v[164:167], v[204:207], v[20:23]
    v_mfma_f32_16x16x32_bf16 v[24:27], v[172:175], v[188:191], v[24:27]
    v_mfma_f32_16x16x32_bf16 v[28:31], v[172:175], v[196:199], v[28:31]
    v_mfma_f32_16x16x32_bf16 v[32:35], v[172:175], v[204:207], v[32:35]
    v_mfma_f32_16x16x32_bf16 v[36:39], v[180:183], v[188:191], v[36:39]
    v_mfma_f32_16x16x32_bf16 v[40:43], v[180:183], v[196:199], v[40:43]
    v_mfma_f32_16x16x32_bf16 v[44:47], v[180:183], v[204:207], v[44:47]
    s_nop 7
    s_nop 7
    v_cvt_pk_bf16_f32 v96, v0, v1
    v_cvt_pk_bf16_f32 v97, v2, v3
    v_cvt_pk_bf16_f32 v98, v12, v13
    v_cvt_pk_bf16_f32 v99, v14, v15
    v_cvt_pk_bf16_f32 v100, v48, v49
    v_cvt_pk_bf16_f32 v101, v50, v51
    v_cvt_pk_bf16_f32 v102, v60, v61
    v_cvt_pk_bf16_f32 v103, v62, v63
    v_mov_b32 v104, v96
    v_mov_b32 v105, v97
    v_mov_b32 v106, v98
    v_mov_b32 v107, v99
    s_add_u32 s35, s33, 0
    v_mov_b32_dpp v104, v100 row_ror:8 row_mask:0xf bank_mask:0x3
    v_mov_b32_dpp v105, v101 row_ror:8 row_mask:0xf bank_mask:0x3
    v_mov_b32_dpp v106, v102 row_ror:8 row_mask:0xf bank_mask:0x3
    v_mov_b32_dpp v107, v103 row_ror:8 row_mask:0xf bank_mask:0x3
    v_mov_b32_dpp v96, v100 row_ror:8 row_mask:0xf bank_mask:0xc
    v_mov_b32_dpp v97, v101 row_ror:8 row_mask:0xf bank_mask:0xc
    v_mov_b32_dpp v98, v102 row_ror:8 row_mask:0xf bank_mask:0xc
    v_mov_b32_dpp v99, v103 row_ror:8 row_mask:0xf bank_mask:0xc
    buffer_store_dwordx4 v[96:99], v222, s[16:19], s35 offen sc1
    buffer_store_dwordx4 v[104:107], v223, s[16:19], s35 offen sc1
    v_cvt_pk_bf16_f32 v108, v4, v5
    v_cvt_pk_bf16_f32 v109, v6, v7
    v_cvt_pk_bf16_f32 v110, v16, v17
    v_cvt_pk_bf16_f32 v111, v18, v19
    v_cvt_pk_bf16_f32 v112, v52, v53
    v_cvt_pk_bf16_f32 v113, v54, v55
    v_cvt_pk_bf16_f32 v114, v64, v65
    v_cvt_pk_bf16_f32 v115, v66, v67
    v_mov_b32 v116, v108
    v_mov_b32 v117, v109
    v_mov_b32 v118, v110
    v_mov_b32 v119, v111
    s_add_u32 s35, s33, 593920
    v_mov_b32_dpp v116, v112 row_ror:8 row_mask:0xf bank_mask:0x3
    v_mov_b32_dpp v117, v113 row_ror:8 row_mask:0xf bank_mask:0x3
    v_mov_b32_dpp v118, v114 row_ror:8 row_mask:0xf bank_mask:0x3
    v_mov_b32_dpp v119, v115 row_ror:8 row_mask:0xf bank_mask:0x3
    v_mov_b32_dpp v108, v112 row_ror:8 row_mask:0xf bank_mask:0xc
    v_mov_b32_dpp v109, v113 row_ror:8 row_mask:0xf bank_mask:0xc
    v_mov_b32_dpp v110, v114 row_ror:8 row_mask:0xf bank_mask:0xc
    v_mov_b32_dpp v111, v115 row_ror:8 row_mask:0xf bank_mask:0xc
    buffer_store_dwordx4 v[108:111], v222, s[16:19], s35 offen sc1
    buffer_store_dwordx4 v[116:119], v223, s[16:19], s35 offen sc1
    v_cvt_pk_bf16_f32 v120, v8, v9
    v_cvt_pk_bf16_f32 v121, v10, v11
    v_cvt_pk_bf16_f32 v122, v20, v21
    v_cvt_pk_bf16_f32 v123, v22, v23
    v_cvt_pk_bf16_f32 v124, v56, v57
    v_cvt_pk_bf16_f32 v125, v58, v59
    v_cvt_pk_bf16_f32 v126, v68, v69
    v_cvt_pk_bf16_f32 v127, v70, v71
    v_mov_b32 v128, v120
    v_mov_b32 v129, v121
    v_mov_b32 v130, v122
    v_mov_b32 v131, v123
    s_add_u32 s35, s33, 1187840
    v_mov_b32_dpp v128, v124 row_ror:8 row_mask:0xf bank_mask:0x3
    v_mov_b32_dpp v129, v125 row_ror:8 row_mask:0xf bank_mask:0x3
    v_mov_b32_dpp v130, v126 row_ror:8 row_mask:0xf bank_mask:0x3
    v_mov_b32_dpp v131, v127 row_ror:8 row_mask:0xf bank_mask:0x3
    v_mov_b32_dpp v120, v124 row_ror:8 row_mask:0xf bank_mask:0xc
    v_mov_b32_dpp v121, v125 row_ror:8 row_mask:0xf bank_mask:0xc
    v_mov_b32_dpp v122, v126 row_ror:8 row_mask:0xf bank_mask:0xc
    v_mov_b32_dpp v123, v127 row_ror:8 row_mask:0xf bank_mask:0xc
    buffer_store_dwordx4 v[120:123], v222, s[16:19], s35 offen sc1
    buffer_store_dwordx4 v[128:131], v223, s[16:19], s35 offen sc1
    v_cvt_pk_bf16_f32 v96, v24, v25
    v_cvt_pk_bf16_f32 v97, v26, v27
    v_cvt_pk_bf16_f32 v98, v36, v37
    v_cvt_pk_bf16_f32 v99, v38, v39
    v_cvt_pk_bf16_f32 v100, v72, v73
    v_cvt_pk_bf16_f32 v101, v74, v75
    v_cvt_pk_bf16_f32 v102, v84, v85
    v_cvt_pk_bf16_f32 v103, v86, v87
    v_mov_b32 v104, v96
    v_mov_b32 v105, v97
    v_mov_b32 v106, v98
    v_mov_b32 v107, v99
    s_add_u32 s35, s33, 4096
    v_mov_b32_dpp v104, v100 row_ror:8 row_mask:0xf bank_mask:0x3
    v_mov_b32_dpp v105, v101 row_ror:8 row_mask:0xf bank_mask:0x3
    v_mov_b32_dpp v106, v102 row_ror:8 row_mask:0xf bank_mask:0x3
    v_mov_b32_dpp v107, v103 row_ror:8 row_mask:0xf bank_mask:0x3
    v_mov_b32_dpp v96, v100 row_ror:8 row_mask:0xf bank_mask:0xc
    v_mov_b32_dpp v97, v101 row_ror:8 row_mask:0xf bank_mask:0xc
    v_mov_b32_dpp v98, v102 row_ror:8 row_mask:0xf bank_mask:0xc
    v_mov_b32_dpp v99, v103 row_ror:8 row_mask:0xf bank_mask:0xc
    buffer_store_dwordx4 v[96:99], v222, s[16:19], s35 offen sc1
    buffer_store_dwordx4 v[104:107], v223, s[16:19], s35 offen sc1
    v_cvt_pk_bf16_f32 v108, v28, v29
    v_cvt_pk_bf16_f32 v109, v30, v31
    v_cvt_pk_bf16_f32 v110, v40, v41
    v_cvt_pk_bf16_f32 v111, v42, v43
    v_cvt_pk_bf16_f32 v112, v76, v77
    v_cvt_pk_bf16_f32 v113, v78, v79
    v_cvt_pk_bf16_f32 v114, v88, v89
    v_cvt_pk_bf16_f32 v115, v90, v91
    v_mov_b32 v116, v108
    v_mov_b32 v117, v109
    v_mov_b32 v118, v110
    v_mov_b32 v119, v111
    s_add_u32 s35, s33, 598016
    v_mov_b32_dpp v116, v112 row_ror:8 row_mask:0xf bank_mask:0x3
    v_mov_b32_dpp v117, v113 row_ror:8 row_mask:0xf bank_mask:0x3
    v_mov_b32_dpp v118, v114 row_ror:8 row_mask:0xf bank_mask:0x3
    v_mov_b32_dpp v119, v115 row_ror:8 row_mask:0xf bank_mask:0x3
    v_mov_b32_dpp v108, v112 row_ror:8 row_mask:0xf bank_mask:0xc
    v_mov_b32_dpp v109, v113 row_ror:8 row_mask:0xf bank_mask:0xc
    v_mov_b32_dpp v110, v114 row_ror:8 row_mask:0xf bank_mask:0xc
    v_mov_b32_dpp v111, v115 row_ror:8 row_mask:0xf bank_mask:0xc
    buffer_store_dwordx4 v[108:111], v222, s[16:19], s35 offen sc1
    buffer_store_dwordx4 v[116:119], v223, s[16:19], s35 offen sc1
    v_cvt_pk_bf16_f32 v120, v32, v33
    v_cvt_pk_bf16_f32 v121, v34, v35
    v_cvt_pk_bf16_f32 v122, v44, v45
    v_cvt_pk_bf16_f32 v123, v46, v47
    v_cvt_pk_bf16_f32 v124, v80, v81
    v_cvt_pk_bf16_f32 v125, v82, v83
    v_cvt_pk_bf16_f32 v126, v92, v93
    v_cvt_pk_bf16_f32 v127, v94, v95
    v_mov_b32 v128, v120
    v_mov_b32 v129, v121
    v_mov_b32 v130, v122
    v_mov_b32 v131, v123
    s_add_u32 s35, s33, 1191936
    v_mov_b32_dpp v128, v124 row_ror:8 row_mask:0xf bank_mask:0x3
    v_mov_b32_dpp v129, v125 row_ror:8 row_mask:0xf bank_mask:0x3
    v_mov_b32_dpp v130, v126 row_ror:8 row_mask:0xf bank_mask:0x3
    v_mov_b32_dpp v131, v127 row_ror:8 row_mask:0xf bank_mask:0x3
    v_mov_b32_dpp v120, v124 row_ror:8 row_mask:0xf bank_mask:0xc
    v_mov_b32_dpp v121, v125 row_ror:8 row_mask:0xf bank_mask:0xc
    v_mov_b32_dpp v122, v126 row_ror:8 row_mask:0xf bank_mask:0xc
    v_mov_b32_dpp v123, v127 row_ror:8 row_mask:0xf bank_mask:0xc
    buffer_store_dwordx4 v[120:123], v222, s[16:19], s35 offen sc1
    buffer_store_dwordx4 v[128:131], v223, s[16:19], s35 offen sc1
    s_endpgm
L_gemm1_kernel_loader:
    s_sub_u32 s20, s20, 4
    v_and_b32 v1, 63, v0
    v_lshrrev_b32 v4, 3, v1
    v_and_b32 v5, 7, v1
    v_xor_b32 v5, v5, v4
    v_lshlrev_b32 v5, 4, v5
    v_lshl_add_u32 v2, v4, 11, v5
    v_lshlrev_b32 v3, 4, v1
    s_add_u32 s24, s20, 0
    s_lshl_b32 s40, s24, 10
    s_lshl_b32 s43, s24, 14
    s_add_u32 s24, s20, 4
    s_lshl_b32 s41, s24, 10
    s_lshl_b32 s44, s24, 14
    s_add_u32 s24, s20, 8
    s_lshl_b32 s42, s24, 10
    s_lshl_b32 s45, s24, 14
    s_mul_i32 s46, s20, 4096
    s_add_u32 s47, s46, 12288
    s_add_u32 m0, s40, 0
    s_add_u32 s24, s43, 0
    buffer_load_dwordx4 v2, s[8:11], s24 offen lds
    s_add_u32 m0, s41, 0
    s_add_u32 s24, s44, 0
    buffer_load_dwordx4 v2, s[8:11], s24 offen lds
    s_add_u32 m0, s42, 0
    s_add_u32 s24, s45, 0
    buffer_load_dwordx4 v2, s[8:11], s24 offen lds
    s_add_u32 m0, s47, 0
    s_add_u32 s24, s46, 0
    buffer_load_dwordx4 v3, s[12:15], s24 offen offset:0 lds
    buffer_load_dwordx4 v3, s[12:15], s24 offen offset:1024 lds
    buffer_load_dwordx4 v3, s[12:15], s24 offen offset:2048 lds
    buffer_load_dwordx4 v3, s[12:15], s24 offen offset:3072 lds
    s_add_u32 m0, s40, 28672
    s_add_u32 s24, s43, 128
    buffer_load_dwordx4 v2, s[8:11], s24 offen lds
    s_add_u32 m0, s41, 28672
    s_add_u32 s24, s44, 128
    buffer_load_dwordx4 v2, s[8:11], s24 offen lds
    s_add_u32 m0, s42, 28672
    s_add_u32 s24, s45, 128
    buffer_load_dwordx4 v2, s[8:11], s24 offen lds
    s_add_u32 m0, s47, 28672
    s_add_u32 s24, s46, 32768
    buffer_load_dwordx4 v3, s[12:15], s24 offen offset:0 lds
    buffer_load_dwordx4 v3, s[12:15], s24 offen offset:1024 lds
    buffer_load_dwordx4 v3, s[12:15], s24 offen offset:2048 lds
    buffer_load_dwordx4 v3, s[12:15], s24 offen offset:3072 lds
    s_waitcnt vmcnt(7)
    s_barrier
    s_add_u32 m0, s40, 57344
    s_add_u32 s24, s43, 256
    buffer_load_dwordx4 v2, s[8:11], s24 offen lds
    s_add_u32 m0, s41, 57344
    s_add_u32 s24, s44, 256
    buffer_load_dwordx4 v2, s[8:11], s24 offen lds
    s_add_u32 m0, s42, 57344
    s_add_u32 s24, s45, 256
    buffer_load_dwordx4 v2, s[8:11], s24 offen lds
    s_add_u32 m0, s47, 57344
    s_add_u32 s24, s46, 65536
    buffer_load_dwordx4 v3, s[12:15], s24 offen offset:0 lds
    buffer_load_dwordx4 v3, s[12:15], s24 offen offset:1024 lds
    buffer_load_dwordx4 v3, s[12:15], s24 offen offset:2048 lds
    buffer_load_dwordx4 v3, s[12:15], s24 offen offset:3072 lds
    s_waitcnt vmcnt(7)
    s_barrier
    s_add_u32 m0, s40, 86016
    s_add_u32 s24, s43, 384
    buffer_load_dwordx4 v2, s[8:11], s24 offen lds
    s_add_u32 m0, s41, 86016
    s_add_u32 s24, s44, 384
    buffer_load_dwordx4 v2, s[8:11], s24 offen lds
    s_add_u32 m0, s42, 86016
    s_add_u32 s24, s45, 384
    buffer_load_dwordx4 v2, s[8:11], s24 offen lds
    s_add_u32 m0, s47, 86016
    s_add_u32 s24, s46, 98304
    buffer_load_dwordx4 v3, s[12:15], s24 offen offset:0 lds
    buffer_load_dwordx4 v3, s[12:15], s24 offen offset:1024 lds
    buffer_load_dwordx4 v3, s[12:15], s24 offen offset:2048 lds
    buffer_load_dwordx4 v3, s[12:15], s24 offen offset:3072 lds
    s_add_u32 m0, s40, 114688
    s_add_u32 s24, s43, 512
    buffer_load_dwordx4 v2, s[8:11], s24 offen lds
    s_add_u32 m0, s41, 114688
    s_add_u32 s24, s44, 512
    buffer_load_dwordx4 v2, s[8:11], s24 offen lds
    s_add_u32 m0, s42, 114688
    s_add_u32 s24, s45, 512
    buffer_load_dwordx4 v2, s[8:11], s24 offen lds
    s_add_u32 m0, s47, 114688
    s_add_u32 s24, s46, 131072
    buffer_load_dwordx4 v3, s[12:15], s24 offen offset:0 lds
    buffer_load_dwordx4 v3, s[12:15], s24 offen offset:1024 lds
    buffer_load_dwordx4 v3, s[12:15], s24 offen offset:2048 lds
    buffer_load_dwordx4 v3, s[12:15], s24 offen offset:3072 lds
    s_waitcnt vmcnt(14)
    s_barrier
    s_add_u32 m0, s40, 0
    s_add_u32 s24, s43, 640
    buffer_load_dwordx4 v2, s[8:11], s24 offen lds
    s_add_u32 m0, s41, 0
    s_add_u32 s24, s44, 640
    buffer_load_dwordx4 v2, s[8:11], s24 offen lds
    s_add_u32 m0, s42, 0
    s_add_u32 s24, s45, 640
    buffer_load_dwordx4 v2, s[8:11], s24 offen lds
    s_add_u32 m0, s47, 0
    s_add_u32 s24, s46, 163840
    buffer_load_dwordx4 v3, s[12:15], s24 offen offset:0 lds
    buffer_load_dwordx4 v3, s[12:15], s24 offen offset:1024 lds
    buffer_load_dwordx4 v3, s[12:15], s24 offen offset:2048 lds
    buffer_load_dwordx4 v3, s[12:15], s24 offen offset:3072 lds
    s_add_u32 m0, s40, 28672
    s_add_u32 s24, s43, 768
    buffer_load_dwordx4 v2, s[8:11], s24 offen lds
    s_add_u32 m0, s41, 28672
    s_add_u32 s24, s44, 768
    buffer_load_dwordx4 v2, s[8:11], s24 offen lds
    s_add_u32 m0, s42, 28672
    s_add_u32 s24, s45, 768
    buffer_load_dwordx4 v2, s[8:11], s24 offen lds
    s_add_u32 m0, s47, 28672
    s_add_u32 s24, s46, 196608
    buffer_load_dwordx4 v3, s[12:15], s24 offen offset:0 lds
    buffer_load_dwordx4 v3, s[12:15], s24 offen offset:1024 lds
    buffer_load_dwordx4 v3, s[12:15], s24 offen offset:2048 lds
    buffer_load_dwordx4 v3, s[12:15], s24 offen offset:3072 lds
    s_waitcnt vmcnt(21)
    s_barrier
    s_add_u32 m0, s40, 57344
    s_add_u32 s24, s43, 896
    buffer_load_dwordx4 v2, s[8:11], s24 offen lds
    s_add_u32 m0, s41, 57344
    s_add_u32 s24, s44, 896
    buffer_load_dwordx4 v2, s[8:11], s24 offen lds
    s_add_u32 m0, s42, 57344
    s_add_u32 s24, s45, 896
    buffer_load_dwordx4 v2, s[8:11], s24 offen lds
    s_add_u32 m0, s47, 57344
    s_add_u32 s24, s46, 229376
    buffer_load_dwordx4 v3, s[12:15], s24 offen offset:0 lds
    buffer_load_dwordx4 v3, s[12:15], s24 offen offset:1024 lds
    buffer_load_dwordx4 v3, s[12:15], s24 offen offset:2048 lds
    buffer_load_dwordx4 v3, s[12:15], s24 offen offset:3072 lds
    s_waitcnt vmcnt(21)
    s_barrier
    s_add_u32 m0, s40, 86016
    s_add_u32 s24, s43, 1024
    buffer_load_dwordx4 v2, s[8:11], s24 offen lds
    s_add_u32 m0, s41, 86016
    s_add_u32 s24, s44, 1024
    buffer_load_dwordx4 v2, s[8:11], s24 offen lds
    s_add_u32 m0, s42, 86016
    s_add_u32 s24, s45, 1024
    buffer_load_dwordx4 v2, s[8:11], s24 offen lds
    s_add_u32 m0, s47, 86016
    s_add_u32 s24, s46, 262144
    buffer_load_dwordx4 v3, s[12:15], s24 offen offset:0 lds
    buffer_load_dwordx4 v3, s[12:15], s24 offen offset:1024 lds
    buffer_load_dwordx4 v3, s[12:15], s24 offen offset:2048 lds
    buffer_load_dwordx4 v3, s[12:15], s24 offen offset:3072 lds
    s_waitcnt vmcnt(21)
    s_barrier
    s_add_u32 m0, s40, 114688
    s_add_u32 s24, s43, 1152
    buffer_load_dwordx4 v2, s[8:11], s24 offen lds
    s_add_u32 m0, s41, 114688
    s_add_u32 s24, s44, 1152
    buffer_load_dwordx4 v2, s[8:11], s24 offen lds
    s_add_u32 m0, s42, 114688
    s_add_u32 s24, s45, 1152
    buffer_load_dwordx4 v2, s[8:11], s24 offen lds
    s_add_u32 m0, s47, 114688
    s_add_u32 s24, s46, 294912
    buffer_load_dwordx4 v3, s[12:15], s24 offen offset:0 lds
    buffer_load_dwordx4 v3, s[12:15], s24 offen offset:1024 lds
    buffer_load_dwordx4 v3, s[12:15], s24 offen offset:2048 lds
    buffer_load_dwordx4 v3, s[12:15], s24 offen offset:3072 lds
    s_waitcnt vmcnt(21)
    s_barrier
    s_add_u32 m0, s40, 0
    s_add_u32 s24, s43, 1280
    buffer_load_dwordx4 v2, s[8:11], s24 offen lds
    s_add_u32 m0, s41, 0
    s_add_u32 s24, s44, 1280
    buffer_load_dwordx4 v2, s[8:11], s24 offen lds
    s_add_u32 m0, s42, 0
    s_add_u32 s24, s45, 1280
    buffer_load_dwordx4 v2, s[8:11], s24 offen lds
    s_add_u32 m0, s47, 0
    s_add_u32 s24, s46, 327680
    buffer_load_dwordx4 v3, s[12:15], s24 offen offset:0 lds
    buffer_load_dwordx4 v3, s[12:15], s24 offen offset:1024 lds
    buffer_load_dwordx4 v3, s[12:15], s24 offen offset:2048 lds
    buffer_load_dwordx4 v3, s[12:15], s24 offen offset:3072 lds
    s_waitcnt vmcnt(21)
    s_barrier
    s_add_u32 m0, s40, 28672
    s_add_u32 s24, s43, 1408
    buffer_load_dwordx4 v2, s[8:11], s24 offen lds
    s_add_u32 m0, s41, 28672
    s_add_u32 s24, s44, 1408
    buffer_load_dwordx4 v2, s[8:11], s24 offen lds
    s_add_u32 m0, s42, 28672
    s_add_u32 s24, s45, 1408
    buffer_load_dwordx4 v2, s[8:11], s24 offen lds
    s_add_u32 m0, s47, 28672
    s_add_u32 s24, s46, 360448
    buffer_load_dwordx4 v3, s[12:15], s24 offen offset:0 lds
    buffer_load_dwordx4 v3, s[12:15], s24 offen offset:1024 lds
    buffer_load_dwordx4 v3, s[12:15], s24 offen offset:2048 lds
    buffer_load_dwordx4 v3, s[12:15], s24 offen offset:3072 lds
    s_waitcnt vmcnt(21)
    s_barrier
    s_add_u32 m0, s40, 57344
    s_add_u32 s24, s43, 1536
    buffer_load_dwordx4 v2, s[8:11], s24 offen lds
    s_add_u32 m0, s41, 57344
    s_add_u32 s24, s44, 1536
    buffer_load_dwordx4 v2, s[8:11], s24 offen lds
    s_add_u32 m0, s42, 57344
    s_add_u32 s24, s45, 1536
    buffer_load_dwordx4 v2, s[8:11], s24 offen lds
    s_add_u32 m0, s47, 57344
    s_add_u32 s24, s46, 393216
    buffer_load_dwordx4 v3, s[12:15], s24 offen offset:0 lds
    buffer_load_dwordx4 v3, s[12:15], s24 offen offset:1024 lds
    buffer_load_dwordx4 v3, s[12:15], s24 offen offset:2048 lds
    buffer_load_dwordx4 v3, s[12:15], s24 offen offset:3072 lds
    s_waitcnt vmcnt(21)
    s_barrier
    s_add_u32 m0, s40, 86016
    s_add_u32 s24, s43, 1664
    buffer_load_dwordx4 v2, s[8:11], s24 offen lds
    s_add_u32 m0, s41, 86016
    s_add_u32 s24, s44, 1664
    buffer_load_dwordx4 v2, s[8:11], s24 offen lds
    s_add_u32 m0, s42, 86016
    s_add_u32 s24, s45, 1664
    buffer_load_dwordx4 v2, s[8:11], s24 offen lds
    s_add_u32 m0, s47, 86016
    s_add_u32 s24, s46, 425984
    buffer_load_dwordx4 v3, s[12:15], s24 offen offset:0 lds
    buffer_load_dwordx4 v3, s[12:15], s24 offen offset:1024 lds
    buffer_load_dwordx4 v3, s[12:15], s24 offen offset:2048 lds
    buffer_load_dwordx4 v3, s[12:15], s24 offen offset:3072 lds
    s_waitcnt vmcnt(21)
    s_barrier
    s_add_u32 m0, s40, 114688
    s_add_u32 s24, s43, 1792
    buffer_load_dwordx4 v2, s[8:11], s24 offen lds
    s_add_u32 m0, s41, 114688
    s_add_u32 s24, s44, 1792
    buffer_load_dwordx4 v2, s[8:11], s24 offen lds
    s_add_u32 m0, s42, 114688
    s_add_u32 s24, s45, 1792
    buffer_load_dwordx4 v2, s[8:11], s24 offen lds
    s_add_u32 m0, s47, 114688
    s_add_u32 s24, s46, 458752
    buffer_load_dwordx4 v3, s[12:15], s24 offen offset:0 lds
    buffer_load_dwordx4 v3, s[12:15], s24 offen offset:1024 lds
    buffer_load_dwordx4 v3, s[12:15], s24 offen offset:2048 lds
    buffer_load_dwordx4 v3, s[12:15], s24 offen offset:3072 lds
    s_waitcnt vmcnt(21)
    s_barrier
    s_add_u32 m0, s40, 0
    s_add_u32 s24, s43, 1920
    buffer_load_dwordx4 v2, s[8:11], s24 offen lds
    s_add_u32 m0, s41, 0
    s_add_u32 s24, s44, 1920
    buffer_load_dwordx4 v2, s[8:11], s24 offen lds
    s_add_u32 m0, s42, 0
    s_add_u32 s24, s45, 1920
    buffer_load_dwordx4 v2, s[8:11], s24 offen lds
    s_add_u32 m0, s47, 0
    s_add_u32 s24, s46, 491520
    buffer_load_dwordx4 v3, s[12:15], s24 offen offset:0 lds
    buffer_load_dwordx4 v3, s[12:15], s24 offen offset:1024 lds
    buffer_load_dwordx4 v3, s[12:15], s24 offen offset:2048 lds
    buffer_load_dwordx4 v3, s[12:15], s24 offen offset:3072 lds
    s_waitcnt vmcnt(21)
    s_barrier
    s_waitcnt vmcnt(14)
    s_barrier
    s_waitcnt vmcnt(7)
    s_barrier
    s_waitcnt vmcnt(0)
    s_barrier
L_gemm1_kernel_done:
    s_endpgm
.globl mid_kernel
.p2align 8
.type mid_kernel,@function
mid_kernel:
    s_cmp_ge_u32 s2, 704
    s_cbranch_scc1 L_mid_kernel_done
    v_readfirstlane_b32 s20, v0
    s_lshr_b32 s20, s20, 6
    s_cmp_ge_u32 s2, 448
    s_cbranch_scc1 L_mid_kernel_g
    s_load_dwordx2 s[6:7], s[0:1], 72
    s_load_dwordx2 s[4:5], s[0:1], 72
    s_cmp_ge_u32 s2, 224
    s_cselect_b32 s24, 1, 0
    s_mul_i32 s25, s24, 224
    s_sub_u32 s25, s2, s25
    s_lshr_b32 s26, s25, 3
    s_and_b32 s27, s25, 7
    v_and_b32 v1, 63, v0
    v_lshrrev_b32 v2, 2, v1
    v_lshlrev_b32 v2, 6, v2
    v_lshrrev_b32 v3, 5, v1
    v_lshlrev_b32 v3, 1, v3
    v_and_b32 v4, 3, v1
    v_xor_b32 v3, v3, v4
    v_lshl_add_u32 v2, v3, 4, v2
    s_mul_i32 s28, s26, 6
    s_lshl_b32 s29, s20, 1
    s_add_u32 s28, s28, s29
    s_sub_u32 s28, s28, 1
    s_lshl_b32 s30, s27, 12
    s_add_u32 s31, s28, 0
    s_mul_i32 s32, s31, 37120
    s_add_u32 s32, s32, s30
    s_cmp_lt_i32 s31, 0
    s_cselect_b32 s32, 0x7f000000, s32
    v_add_u32 v3, s32, v2
    s_add_u32 s31, s28, 1
    s_mul_i32 s32, s31, 37120
    s_add_u32 s32, s32, s30
    s_cmp_lt_i32 s31, 0
    s_cselect_b32 s32, 0x7f000000, s32
    v_add_u32 v4, s32, v2
    s_waitcnt lgkmcnt(0)
    s_mul_i32 s33, s24, 6199040
    s_add_u32 s33, s33, 38871040
    s_add_u32 s8, s6, s33
    s_addc_u32 s9, s7, 0
    s_mov_b32 s10, 6199040
    s_mov_b32 s11, 0x00020000
    s_add_u32 s12, s6, 85499904
    s_addc_u32 s13, s7, 0
    s_mov_b32 s14, 16384
    s_mov_b32 s15, 0x00020000
    s_lshl_b32 s34, s20, 13
    s_add_u32 m0, s34, 0
    s_nop 0
    buffer_load_dwordx4 v3, s[8:11], 0 offen offset:0 lds
    buffer_load_dwordx4 v3, s[8:11], 0 offen offset:1024 lds
    buffer_load_dwordx4 v3, s[8:11], 0 offen offset:2048 lds
    buffer_load_dwordx4 v3, s[8:11], 0 offen offset:3072 lds
    s_add_u32 m0, s34, 4096
    s_nop 0
    buffer_load_dwordx4 v4, s[8:11], 0 offen offset:0 lds
    buffer_load_dwordx4 v4, s[8:11], 0 offen offset:1024 lds
    buffer_load_dwordx4 v4, s[8:11], 0 offen offset:2048 lds
    buffer_load_dwordx4 v4, s[8:11], 0 offen offset:3072 lds
    v_lshlrev_b32 v5, 4, v1
    s_mov_b32 s35, 8192
    buffer_load_dwordx4 v[8:11], v5, s[12:15], s35 offen
    s_mov_b32 s35, 9216
    buffer_load_dwordx4 v[12:15], v5, s[12:15], s35 offen
    s_mov_b32 s35, 10240
    buffer_load_dwordx4 v[16:19], v5, s[12:15], s35 offen
    s_mov_b32 s35, 11264
    buffer_load_dwordx4 v[20:23], v5, s[12:15], s35 offen
    s_mov_b32 s35, 12288
    buffer_load_dwordx4 v[24:27], v5, s[12:15], s35 offen
    s_mov_b32 s35, 13312
    buffer_load_dwordx4 v[28:31], v5, s[12:15], s35 offen
    s_lshl_b32 s35, s20, 11
    buffer_load_dwordx4 v[32:35], v5, s[12:15], s35 offen offset:0
    buffer_load_dwordx4 v[36:39], v5, s[12:15], s35 offen offset:1024
    v_bfe_u32 v40, v1, 2, 2
    v_lshrrev_b32 v41, 4, v1
    v_and_b32 v42, 3, v1
    v_lshl_add_u32 v43, v41, 3, v40
    v_lshlrev_b32 v46, 6, v43
    v_and_b32 v47, 1, v41
    v_lshlrev_b32 v47, 1, v47
    v_lshrrev_b32 v48, 1, v42
    v_xor_b32 v47, v47, v48
    v_lshl_add_u32 v46, v47, 4, v46
    v_and_b32 v48, 1, v42
    v_lshl_add_u32 v46, v48, 3, v46
    v_add_u32 v44, s34, v46
    v_xor_b32 v45, 32, v44
    v_add_u32 v49, 43008, v46
    v_xor_b32 v50, 32, v49
    v_add_u32 v47, 1, v43
    v_bfe_u32 v48, v47, 3, 1
    v_lshlrev_b32 v48, 1, v48
    v_lshrrev_b32 v55, 1, v42
    v_xor_b32 v48, v48, v55
    v_lshlrev_b32 v47, 6, v47
    v_lshl_add_u32 v47, v48, 4, v47
    v_and_b32 v48, 1, v42
    v_lshl_add_u32 v47, v48, 3, v47
    v_add_u32 v51, 32704, v47
    v_xor_b32 v52, 32, v51
    v_add_u32 v47, 5, v43
    v_bfe_u32 v48, v47, 3, 1
    v_lshlrev_b32 v48, 1, v48
    v_lshrrev_b32 v55, 1, v42
    v_xor_b32 v48, v48, v55
    v_lshlrev_b32 v47, 6, v47
    v_lshl_add_u32 v47, v48, 4, v47
    v_and_b32 v48, 1, v42
    v_lshl_add_u32 v47, v48, 3, v47
    v_add_u32 v53, 32704, v47
    v_xor_b32 v54, 32, v53
    v_and_b32 v47, 1, v1
    v_mul_u32_u24 v55, 10304, v47
    v_bfe_u32 v48, v1, 1, 3
    v_lshl_add_u32 v55, v48, 6, v55
    v_lshl_add_u32 v55, v41, 4, v55
    s_mul_i32 s35, s20, 3072
    s_add_u32 s35, s35, 31680
    v_add_u32 v56, s35, v55
    v_xor_b32 v57, 32, v56
    s_mul_i32 s35, s20, 48
    s_sub_u32 s35, s35, 17
    v_add_u32 v122, v48, v47
    v_add_u32 v122, s35, v122
    s_mov_b32 s35, 344064
    v_mul_lo_u32 v58, v48, s35
    v_and_b32 v47, 1, v1
    v_lshl_add_u32 v58, v47, 6, v58
    v_lshl_add_u32 v58, v41, 4, v58
    s_mov_b32 s36, 0xbdd2d3e8
    v_mov_b32 v59, 0xc0135761
    s_mov_b32 s42, 0xbdd2d3e8
    s_mov_b32 s43, 0xbdd2d3e8
    v_mov_b32 v120, 0xc0135761
    v_mov_b32 v121, 0xc0135761
    s_add_u32 s16, s4, 51269632
    s_addc_u32 s17, s5, 0
    s_mov_b32 s18, 11010048
    s_mov_b32 s19, 0x00020000
    s_mul_i32 s37, s20, 2752512
    s_mul_i32 s38, s24, 84
    s_mul_i32 s39, s26, 3
    s_add_u32 s38, s38, s39
    s_lshl_b32 s38, s38, 11
    s_add_u32 s37, s37, s38
    s_lshl_b32 s38, s27, 7
    s_add_u32 s37, s37, s38
    s_waitcnt vmcnt(2)
    ds_read_b64_tr_b16 v[60:61], v44 offset:0
    ds_read_b64_tr_b16 v[62:63], v44 offset:256
    ds_read_b64_tr_b16 v[64:65], v44 offset:2048
    ds_read_b64_tr_b16 v[66:67], v44 offset:2304
    ds_read_b64_tr_b16 v[68:69], v45 offset:0
    ds_read_b64_tr_b16 v[70:71], v45 offset:256
    ds_read_b64_tr_b16 v[72:73], v45 offset:2048
    ds_read_b64_tr_b16 v[74:75], v45 offset:2304
    s_waitcnt lgkmcnt(0)
    v_mfma_f32_16x16x32_bf16 v[76:79], v[60:63], v[8:11], 0
    v_mfma_f32_16x16x32_bf16 v[80:83], v[68:71], v[8:11], 0
    v_mfma_f32_16x16x32_bf16 v[84:87], v[60:63], v[16:19], 0
    v_mfma_f32_16x16x32_bf16 v[88:91], v[68:71], v[16:19], 0
    v_mfma_f32_16x16x32_bf16 v[92:95], v[60:63], v[24:27], 0
    v_mfma_f32_16x16x32_bf16 v[96:99], v[68:71], v[24:27], 0
    v_mfma_f32_16x16x32_bf16 v[76:79], v[64:67], v[12:15], v[76:79]
    v_mfma_f32_16x16x32_bf16 v[80:83], v[72:75], v[12:15], v[80:83]
    v_mfma_f32_16x16x32_bf16 v[84:87], v[64:67], v[20:23], v[84:87]
    v_mfma_f32_16x16x32_bf16 v[88:91], v[72:75], v[20:23], v[88:91]
    v_mfma_f32_16x16x32_bf16 v[92:95], v[64:67], v[28:31], v[92:95]
    v_mfma_f32_16x16x32_bf16 v[96:99], v[72:75], v[28:31], v[96:99]
    s_add_u32 s31, s28, 0
    s_cmp_eq_u32 s31, 166
    s_cselect_b32 s39, 0, -1
    s_nop 4
    v_mul_f32 v100, v76, v76
    v_mul_f32 v101, v77, v77
    v_mul_f32 v102, v78, v78
    v_mul_f32 v103, v79, v79
    v_mul_f32 v104, v80, v80
    v_mul_f32 v105, v81, v81
    v_mul_f32 v106, v82, v82
    v_mul_f32 v107, v83, v83
    v_fma_f32 v100, v100, s36, v59
    v_fma_f32 v101, v101, s36, v59
    v_fma_f32 v102, v102, s36, v59
    v_fma_f32 v103, v103, s36, v59
    v_fma_f32 v104, v104, s36, v59
    v_fma_f32 v105, v105, s36, v59
    v_fma_f32 v106, v106, s36, v59
    v_fma_f32 v107, v107, s36, v59
    v_mul_f32 v100, v100, v76
    v_mul_f32 v101, v101, v77
    v_mul_f32 v102, v102, v78
    v_mul_f32 v103, v103, v79
    v_mul_f32 v104, v104, v80
    v_mul_f32 v105, v105, v81
    v_mul_f32 v106, v106, v82
    v_mul_f32 v107, v107, v83
    v_exp_f32 v100, v100
    v_exp_f32 v101, v101
    v_exp_f32 v102, v102
    v_exp_f32 v103, v103
    v_exp_f32 v104, v104
    v_exp_f32 v105, v105
    v_exp_f32 v106, v106
    v_exp_f32 v107, v107
    v_add_f32 v100, 1.0, v100
    v_add_f32 v101, 1.0, v101
    v_add_f32 v102, 1.0, v102
    v_add_f32 v103, 1.0, v103
    v_add_f32 v104, 1.0, v104
    v_add_f32 v105, 1.0, v105
    v_add_f32 v106, 1.0, v106
    v_add_f32 v107, 1.0, v107
    v_rcp_f32 v100, v100
    v_rcp_f32 v101, v101
    v_rcp_f32 v102, v102
    v_rcp_f32 v103, v103
    v_rcp_f32 v104, v104
    v_rcp_f32 v105, v105
    v_rcp_f32 v106, v106
    v_rcp_f32 v107, v107
    v_mul_f32 v76, v76, v100
    v_mul_f32 v77, v77, v101
    v_mul_f32 v78, v78, v102
    v_mul_f32 v79, v79, v103
    v_mul_f32 v80, v80, v104
    v_mul_f32 v81, v81, v105
    v_mul_f32 v82, v82, v106
    v_mul_f32 v83, v83, v107
    v_cvt_pk_bf16_f32 v108, v76, v77
    v_cvt_pk_bf16_f32 v109, v78, v79
    v_cvt_pk_bf16_f32 v110, v80, v81
    v_cvt_pk_bf16_f32 v111, v82, v83
    v_add_u32 v123, 0, v122
    v_cmp_gt_u32 vcc, 160, v123
    s_nop 0
    s_and_saveexec_b64 s[40:41], vcc
    ds_write_b128 v56, v[108:111] offset:0
    s_mov_b64 exec, s[40:41]
    v_mul_f32 v100, v84, v84
    v_mul_f32 v101, v85, v85
    v_mul_f32 v102, v86, v86
    v_mul_f32 v103, v87, v87
    v_mul_f32 v104, v88, v88
    v_mul_f32 v105, v89, v89
    v_mul_f32 v106, v90, v90
    v_mul_f32 v107, v91, v91
    v_fma_f32 v100, v100, s36, v59
    v_fma_f32 v101, v101, s36, v59
    v_fma_f32 v102, v102, s36, v59
    v_fma_f32 v103, v103, s36, v59
    v_fma_f32 v104, v104, s36, v59
    v_fma_f32 v105, v105, s36, v59
    v_fma_f32 v106, v106, s36, v59
    v_fma_f32 v107, v107, s36, v59
    v_mul_f32 v100, v100, v84
    v_mul_f32 v101, v101, v85
    v_mul_f32 v102, v102, v86
    v_mul_f32 v103, v103, v87
    v_mul_f32 v104, v104, v88
    v_mul_f32 v105, v105, v89
    v_mul_f32 v106, v106, v90
    v_mul_f32 v107, v107, v91
    v_exp_f32 v100, v100
    v_exp_f32 v101, v101
    v_exp_f32 v102, v102
    v_exp_f32 v103, v103
    v_exp_f32 v104, v104
    v_exp_f32 v105, v105
    v_exp_f32 v106, v106
    v_exp_f32 v107, v107
    v_add_f32 v100, 1.0, v100
    v_add_f32 v101, 1.0, v101
    v_add_f32 v102, 1.0, v102
    v_add_f32 v103, 1.0, v103
    v_add_f32 v104, 1.0, v104
    v_add_f32 v105, 1.0, v105
    v_add_f32 v106, 1.0, v106
    v_add_f32 v107, 1.0, v107
    v_rcp_f32 v100, v100
    v_rcp_f32 v101, v101
    v_rcp_f32 v102, v102
    v_rcp_f32 v103, v103
    v_rcp_f32 v104, v104
    v_rcp_f32 v105, v105
    v_rcp_f32 v106, v106
    v_rcp_f32 v107, v107
    v_mul_f32 v84, v84, v100
    v_mul_f32 v85, v85, v101
    v_mul_f32 v86, v86, v102
    v_mul_f32 v87, v87, v103
    v_mul_f32 v88, v88, v104
    v_mul_f32 v89, v89, v105
    v_mul_f32 v90, v90, v106
    v_mul_f32 v91, v91, v107
    v_cvt_pk_bf16_f32 v112, v84, v85
    v_cvt_pk_bf16_f32 v113, v86, v87
    v_cvt_pk_bf16_f32 v114, v88, v89
    v_cvt_pk_bf16_f32 v115, v90, v91
    v_add_u32 v123, 8, v122
    v_cmp_gt_u32 vcc, 160, v123
    s_nop 0
    s_and_saveexec_b64 s[40:41], vcc
    ds_write_b128 v57, v[112:115] offset:512
    s_mov_b64 exec, s[40:41]
    v_mul_f32 v100, v92, v92
    v_mul_f32 v101, v93, v93
    v_mul_f32 v102, v94, v94
    v_mul_f32 v103, v95, v95
    v_mul_f32 v104, v96, v96
    v_mul_f32 v105, v97, v97
    v_mul_f32 v106, v98, v98
    v_mul_f32 v107, v99, v99
    v_fma_f32 v100, v100, s36, v59
    v_fma_f32 v101, v101, s36, v59
    v_fma_f32 v102, v102, s36, v59
    v_fma_f32 v103, v103, s36, v59
    v_fma_f32 v104, v104, s36, v59
    v_fma_f32 v105, v105, s36, v59
    v_fma_f32 v106, v106, s36, v59
    v_fma_f32 v107, v107, s36, v59
    v_mul_f32 v100, v100, v92
    v_mul_f32 v101, v101, v93
    v_mul_f32 v102, v102, v94
    v_mul_f32 v103, v103, v95
    v_mul_f32 v104, v104, v96
    v_mul_f32 v105, v105, v97
    v_mul_f32 v106, v106, v98
    v_mul_f32 v107, v107, v99
    v_exp_f32 v100, v100
    v_exp_f32 v101, v101
    v_exp_f32 v102, v102
    v_exp_f32 v103, v103
    v_exp_f32 v104, v104
    v_exp_f32 v105, v105
    v_exp_f32 v106, v106
    v_exp_f32 v107, v107
    v_add_f32 v100, 1.0, v100
    v_add_f32 v101, 1.0, v101
    v_add_f32 v102, 1.0, v102
    v_add_f32 v103, 1.0, v103
    v_add_f32 v104, 1.0, v104
    v_add_f32 v105, 1.0, v105
    v_add_f32 v106, 1.0, v106
    v_add_f32 v107, 1.0, v107
    v_rcp_f32 v100, v100
    v_rcp_f32 v101, v101
    v_rcp_f32 v102, v102
    v_rcp_f32 v103, v103
    v_rcp_f32 v104, v104
    v_rcp_f32 v105, v105
    v_rcp_f32 v106, v106
    v_rcp_f32 v107, v107
    v_mul_f32 v92, v92, v100
    v_mul_f32 v93, v93, v101
    v_mul_f32 v94, v94, v102
    v_mul_f32 v95, v95, v103
    v_mul_f32 v96, v96, v104
    v_mul_f32 v97, v97, v105
    v_mul_f32 v98, v98, v106
    v_mul_f32 v99, v99, v107
    v_cvt_pk_bf16_f32 v116, v92, v93
    v_cvt_pk_bf16_f32 v117, v94, v95
    v_cvt_pk_bf16_f32 v118, v96, v97
    v_cvt_pk_bf16_f32 v119, v98, v99
    v_and_b32 v116, s39, v116
    v_and_b32 v117, s39, v117
    v_and_b32 v118, s39, v118
    v_and_b32 v119, s39, v119
    v_add_u32 v123, 16, v122
    v_cmp_gt_u32 vcc, 160, v123
    s_nop 0
    s_and_saveexec_b64 s[40:41], vcc
    ds_write_b128 v56, v[116:119] offset:1024
    s_mov_b64 exec, s[40:41]
    ds_read_b64_tr_b16 v[60:61], v44 offset:4096
    ds_read_b64_tr_b16 v[62:63], v44 offset:4352
    ds_read_b64_tr_b16 v[64:65], v44 offset:6144
    ds_read_b64_tr_b16 v[66:67], v44 offset:6400
    ds_read_b64_tr_b16 v[68:69], v45 offset:4096
    ds_read_b64_tr_b16 v[70:71], v45 offset:4352
    ds_read_b64_tr_b16 v[72:73], v45 offset:6144
    ds_read_b64_tr_b16 v[74:75], v45 offset:6400
    s_waitcnt lgkmcnt(0)
    v_mfma_f32_16x16x32_bf16 v[76:79], v[60:63], v[8:11], 0
    v_mfma_f32_16x16x32_bf16 v[80:83], v[68:71], v[8:11], 0
    v_mfma_f32_16x16x32_bf16 v[84:87], v[60:63], v[16:19], 0
    v_mfma_f32_16x16x32_bf16 v[88:91], v[68:71], v[16:19], 0
    v_mfma_f32_16x16x32_bf16 v[92:95], v[60:63], v[24:27], 0
    v_mfma_f32_16x16x32_bf16 v[96:99], v[68:71], v[24:27], 0
    v_mfma_f32_16x16x32_bf16 v[76:79], v[64:67], v[12:15], v[76:79]
    v_mfma_f32_16x16x32_bf16 v[80:83], v[72:75], v[12:15], v[80:83]
    v_mfma_f32_16x16x32_bf16 v[84:87], v[64:67], v[20:23], v[84:87]
    v_mfma_f32_16x16x32_bf16 v[88:91], v[72:75], v[20:23], v[88:91]
    v_mfma_f32_16x16x32_bf16 v[92:95], v[64:67], v[28:31], v[92:95]
    v_mfma_f32_16x16x32_bf16 v[96:99], v[72:75], v[28:31], v[96:99]
    s_add_u32 s31, s28, 1
    s_cmp_eq_u32 s31, 166
    s_cselect_b32 s39, 0, -1
    s_nop 4
    v_mul_f32 v100, v76, v76
    v_mul_f32 v101, v77, v77
    v_mul_f32 v102, v78, v78
    v_mul_f32 v103, v79, v79
    v_mul_f32 v104, v80, v80
    v_mul_f32 v105, v81, v81
    v_mul_f32 v106, v82, v82
    v_mul_f32 v107, v83, v83
    v_fma_f32 v100, v100, s36, v59
    v_fma_f32 v101, v101, s36, v59
    v_fma_f32 v102, v102, s36, v59
    v_fma_f32 v103, v103, s36, v59
    v_fma_f32 v104, v104, s36, v59
    v_fma_f32 v105, v105, s36, v59
    v_fma_f32 v106, v106, s36, v59
    v_fma_f32 v107, v107, s36, v59
    v_mul_f32 v100, v100, v76
    v_mul_f32 v101, v101, v77
    v_mul_f32 v102, v102, v78
    v_mul_f32 v103, v103, v79
    v_mul_f32 v104, v104, v80
    v_mul_f32 v105, v105, v81
    v_mul_f32 v106, v106, v82
    v_mul_f32 v107, v107, v83
    v_exp_f32 v100, v100
    v_exp_f32 v101, v101
    v_exp_f32 v102, v102
    v_exp_f32 v103, v103
    v_exp_f32 v104, v104
    v_exp_f32 v105, v105
    v_exp_f32 v106, v106
    v_exp_f32 v107, v107
    v_add_f32 v100, 1.0, v100
    v_add_f32 v101, 1.0, v101
    v_add_f32 v102, 1.0, v102
    v_add_f32 v103, 1.0, v103
    v_add_f32 v104, 1.0, v104
    v_add_f32 v105, 1.0, v105
    v_add_f32 v106, 1.0, v106
    v_add_f32 v107, 1.0, v107
    v_rcp_f32 v100, v100
    v_rcp_f32 v101, v101
    v_rcp_f32 v102, v102
    v_rcp_f32 v103, v103
    v_rcp_f32 v104, v104
    v_rcp_f32 v105, v105
    v_rcp_f32 v106, v106
    v_rcp_f32 v107, v107
    v_mul_f32 v76, v76, v100
    v_mul_f32 v77, v77, v101
    v_mul_f32 v78, v78, v102
    v_mul_f32 v79, v79, v103
    v_mul_f32 v80, v80, v104
    v_mul_f32 v81, v81, v105
    v_mul_f32 v82, v82, v106
    v_mul_f32 v83, v83, v107
    v_cvt_pk_bf16_f32 v108, v76, v77
    v_cvt_pk_bf16_f32 v109, v78, v79
    v_cvt_pk_bf16_f32 v110, v80, v81
    v_cvt_pk_bf16_f32 v111, v82, v83
    v_add_u32 v123, 24, v122
    v_cmp_gt_u32 vcc, 160, v123
    s_nop 0
    s_and_saveexec_b64 s[40:41], vcc
    ds_write_b128 v57, v[108:111] offset:1536
    s_mov_b64 exec, s[40:41]
    v_mul_f32 v100, v84, v84
    v_mul_f32 v101, v85, v85
    v_mul_f32 v102, v86, v86
    v_mul_f32 v103, v87, v87
    v_mul_f32 v104, v88, v88
    v_mul_f32 v105, v89, v89
    v_mul_f32 v106, v90, v90
    v_mul_f32 v107, v91, v91
    v_fma_f32 v100, v100, s36, v59
    v_fma_f32 v101, v101, s36, v59
    v_fma_f32 v102, v102, s36, v59
    v_fma_f32 v103, v103, s36, v59
    v_fma_f32 v104, v104, s36, v59
    v_fma_f32 v105, v105, s36, v59
    v_fma_f32 v106, v106, s36, v59
    v_fma_f32 v107, v107, s36, v59
    v_mul_f32 v100, v100, v84
    v_mul_f32 v101, v101, v85
    v_mul_f32 v102, v102, v86
    v_mul_f32 v103, v103, v87
    v_mul_f32 v104, v104, v88
    v_mul_f32 v105, v105, v89
    v_mul_f32 v106, v106, v90
    v_mul_f32 v107, v107, v91
    v_exp_f32 v100, v100
    v_exp_f32 v101, v101
    v_exp_f32 v102, v102
    v_exp_f32 v103, v103
    v_exp_f32 v104, v104
    v_exp_f32 v105, v105
    v_exp_f32 v106, v106
    v_exp_f32 v107, v107
    v_add_f32 v100, 1.0, v100
    v_add_f32 v101, 1.0, v101
    v_add_f32 v102, 1.0, v102
    v_add_f32 v103, 1.0, v103
    v_add_f32 v104, 1.0, v104
    v_add_f32 v105, 1.0, v105
    v_add_f32 v106, 1.0, v106
    v_add_f32 v107, 1.0, v107
    v_rcp_f32 v100, v100
    v_rcp_f32 v101, v101
    v_rcp_f32 v102, v102
    v_rcp_f32 v103, v103
    v_rcp_f32 v104, v104
    v_rcp_f32 v105, v105
    v_rcp_f32 v106, v106
    v_rcp_f32 v107, v107
    v_mul_f32 v84, v84, v100
    v_mul_f32 v85, v85, v101
    v_mul_f32 v86, v86, v102
    v_mul_f32 v87, v87, v103
    v_mul_f32 v88, v88, v104
    v_mul_f32 v89, v89, v105
    v_mul_f32 v90, v90, v106
    v_mul_f32 v91, v91, v107
    v_cvt_pk_bf16_f32 v112, v84, v85
    v_cvt_pk_bf16_f32 v113, v86, v87
    v_cvt_pk_bf16_f32 v114, v88, v89
    v_cvt_pk_bf16_f32 v115, v90, v91
    v_add_u32 v123, 32, v122
    v_cmp_gt_u32 vcc, 160, v123
    s_nop 0
    s_and_saveexec_b64 s[40:41], vcc
    ds_write_b128 v56, v[112:115] offset:2048
    s_mov_b64 exec, s[40:41]
    v_mul_f32 v100, v92, v92
    v_mul_f32 v101, v93, v93
    v_mul_f32 v102, v94, v94
    v_mul_f32 v103, v95, v95
    v_mul_f32 v104, v96, v96
    v_mul_f32 v105, v97, v97
    v_mul_f32 v106, v98, v98
    v_mul_f32 v107, v99, v99
    v_fma_f32 v100, v100, s36, v59
    v_fma_f32 v101, v101, s36, v59
    v_fma_f32 v102, v102, s36, v59
    v_fma_f32 v103, v103, s36, v59
    v_fma_f32 v104, v104, s36, v59
    v_fma_f32 v105, v105, s36, v59
    v_fma_f32 v106, v106, s36, v59
    v_fma_f32 v107, v107, s36, v59
    v_mul_f32 v100, v100, v92
    v_mul_f32 v101, v101, v93
    v_mul_f32 v102, v102, v94
    v_mul_f32 v103, v103, v95
    v_mul_f32 v104, v104, v96
    v_mul_f32 v105, v105, v97
    v_mul_f32 v106, v106, v98
    v_mul_f32 v107, v107, v99
    v_exp_f32 v100, v100
    v_exp_f32 v101, v101
    v_exp_f32 v102, v102
    v_exp_f32 v103, v103
    v_exp_f32 v104, v104
    v_exp_f32 v105, v105
    v_exp_f32 v106, v106
    v_exp_f32 v107, v107
    v_add_f32 v100, 1.0, v100
    v_add_f32 v101, 1.0, v101
    v_add_f32 v102, 1.0, v102
    v_add_f32 v103, 1.0, v103
    v_add_f32 v104, 1.0, v104
    v_add_f32 v105, 1.0, v105
    v_add_f32 v106, 1.0, v106
    v_add_f32 v107, 1.0, v107
    v_rcp_f32 v100, v100
    v_rcp_f32 v101, v101
    v_rcp_f32 v102, v102
    v_rcp_f32 v103, v103
    v_rcp_f32 v104, v104
    v_rcp_f32 v105, v105
    v_rcp_f32 v106, v106
    v_rcp_f32 v107, v107
    v_mul_f32 v92, v92, v100
    v_mul_f32 v93, v93, v101
    v_mul_f32 v94, v94, v102
    v_mul_f32 v95, v95, v103
    v_mul_f32 v96, v96, v104
    v_mul_f32 v97, v97, v105
    v_mul_f32 v98, v98, v106
    v_mul_f32 v99, v99, v107
    v_cvt_pk_bf16_f32 v116, v92, v93
    v_cvt_pk_bf16_f32 v117, v94, v95
    v_cvt_pk_bf16_f32 v118, v96, v97
    v_cvt_pk_bf16_f32 v119, v98, v99
    v_and_b32 v116, s39, v116
    v_and_b32 v117, s39, v117
    v_and_b32 v118, s39, v118
    v_and_b32 v119, s39, v119
    v_add_u32 v123, 40, v122
    v_cmp_gt_u32 vcc, 160, v123
    s_nop 0
    s_and_saveexec_b64 s[40:41], vcc
    ds_write_b128 v57, v[116:119] offset:2560
    s_mov_b64 exec, s[40:41]
    s_waitcnt vmcnt(0)
    s_waitcnt lgkmcnt(0)
    s_barrier
    ds_read_b64_tr_b16 v[60:61], v49 offset:0
    ds_read_b64_tr_b16 v[62:63], v49 offset:256
    ds_read_b64_tr_b16 v[64:65], v49 offset:2048
    ds_read_b64_tr_b16 v[66:67], v49 offset:2304
    ds_read_b64_tr_b16 v[68:69], v50 offset:0
    ds_read_b64_tr_b16 v[70:71], v50 offset:256
    ds_read_b64_tr_b16 v[72:73], v50 offset:2048
    ds_read_b64_tr_b16 v[74:75], v50 offset:2304
    s_waitcnt lgkmcnt(0)
    v_mfma_f32_16x16x32_bf16 v[92:95], v[60:63], v[32:35], 0
    v_mfma_f32_16x16x32_bf16 v[96:99], v[68:71], v[32:35], 0
    v_mfma_f32_16x16x32_bf16 v[92:95], v[64:67], v[36:39], v[92:95]
    v_mfma_f32_16x16x32_bf16 v[96:99], v[72:75], v[36:39], v[96:99]
    ds_read_b64_tr_b16 v[76:77], v51 offset:0
    ds_read_b64_tr_b16 v[78:79], v53 offset:0
    ds_read_b64_tr_b16 v[80:81], v51 offset:2048
    ds_read_b64_tr_b16 v[82:83], v53 offset:2048
    ds_read_b64_tr_b16 v[84:85], v52 offset:0
    ds_read_b64_tr_b16 v[86:87], v54 offset:0
    ds_read_b64_tr_b16 v[88:89], v52 offset:2048
    ds_read_b64_tr_b16 v[90:91], v54 offset:2048
    v_cvt_pk_bf16_f32 v108, v92, v93
    v_cvt_pk_bf16_f32 v109, v94, v95
    v_cvt_pk_bf16_f32 v110, v96, v97
    v_cvt_pk_bf16_f32 v111, v98, v99
    s_add_u32 s38, s37, 0
    buffer_store_dwordx4 v[108:111], v58, s[16:19], s38 offen sc1
    s_waitcnt lgkmcnt(0)
    v_mfma_f32_16x16x32_bf16 v[100:103], v[76:79], v[32:35], 0
    v_mfma_f32_16x16x32_bf16 v[104:107], v[84:87], v[32:35], 0
    v_mfma_f32_16x16x32_bf16 v[100:103], v[80:83], v[36:39], v[100:103]
    v_mfma_f32_16x16x32_bf16 v[104:107], v[88:91], v[36:39], v[104:107]
    ds_read_b64_tr_b16 v[60:61], v49 offset:3072
    ds_read_b64_tr_b16 v[62:63], v49 offset:3328
    ds_read_b64_tr_b16 v[64:65], v49 offset:5120
    ds_read_b64_tr_b16 v[66:67], v49 offset:5376
    ds_read_b64_tr_b16 v[68:69], v50 offset:3072
    ds_read_b64_tr_b16 v[70:71], v50 offset:3328
    ds_read_b64_tr_b16 v[72:73], v50 offset:5120
    ds_read_b64_tr_b16 v[74:75], v50 offset:5376
    v_cvt_pk_bf16_f32 v112, v100, v101
    v_cvt_pk_bf16_f32 v113, v102, v103
    v_cvt_pk_bf16_f32 v114, v104, v105
    v_cvt_pk_bf16_f32 v115, v106, v107
    s_add_u32 s38, s37, 1024
    buffer_store_dwordx4 v[112:115], v58, s[16:19], s38 offen sc1
    s_waitcnt lgkmcnt(0)
    v_mfma_f32_16x16x32_bf16 v[92:95], v[60:63], v[32:35], 0
    v_mfma_f32_16x16x32_bf16 v[96:99], v[68:71], v[32:35], 0
    v_mfma_f32_16x16x32_bf16 v[92:95], v[64:67], v[36:39], v[92:95]
    v_mfma_f32_16x16x32_bf16 v[96:99], v[72:75], v[36:39], v[96:99]
    ds_read_b64_tr_b16 v[76:77], v51 offset:3072
    ds_read_b64_tr_b16 v[78:79], v53 offset:3072
    ds_read_b64_tr_b16 v[80:81], v51 offset:5120
    ds_read_b64_tr_b16 v[82:83], v53 offset:5120
    ds_read_b64_tr_b16 v[84:85], v52 offset:3072
    ds_read_b64_tr_b16 v[86:87], v54 offset:3072
    ds_read_b64_tr_b16 v[88:89], v52 offset:5120
    ds_read_b64_tr_b16 v[90:91], v54 offset:5120
    v_cvt_pk_bf16_f32 v108, v92, v93
    v_cvt_pk_bf16_f32 v109, v94, v95
    v_cvt_pk_bf16_f32 v110, v96, v97
    v_cvt_pk_bf16_f32 v111, v98, v99
    s_add_u32 s38, s37, 2048
    buffer_store_dwordx4 v[108:111], v58, s[16:19], s38 offen sc1
    s_waitcnt lgkmcnt(0)
    v_mfma_f32_16x16x32_bf16 v[100:103], v[76:79], v[32:35], 0
    v_mfma_f32_16x16x32_bf16 v[104:107], v[84:87], v[32:35], 0
    v_mfma_f32_16x16x32_bf16 v[100:103], v[80:83], v[36:39], v[100:103]
    v_mfma_f32_16x16x32_bf16 v[104:107], v[88:91], v[36:39], v[104:107]
    ds_read_b64_tr_b16 v[60:61], v49 offset:6144
    ds_read_b64_tr_b16 v[62:63], v49 offset:6400
    ds_read_b64_tr_b16 v[64:65], v49 offset:8192
    ds_read_b64_tr_b16 v[66:67], v49 offset:8448
    ds_read_b64_tr_b16 v[68:69], v50 offset:6144
    ds_read_b64_tr_b16 v[70:71], v50 offset:6400
    ds_read_b64_tr_b16 v[72:73], v50 offset:8192
    ds_read_b64_tr_b16 v[74:75], v50 offset:8448
    v_cvt_pk_bf16_f32 v112, v100, v101
    v_cvt_pk_bf16_f32 v113, v102, v103
    v_cvt_pk_bf16_f32 v114, v104, v105
    v_cvt_pk_bf16_f32 v115, v106, v107
    s_add_u32 s38, s37, 3072
    buffer_store_dwordx4 v[112:115], v58, s[16:19], s38 offen sc1
    s_waitcnt lgkmcnt(0)
    v_mfma_f32_16x16x32_bf16 v[92:95], v[60:63], v[32:35], 0
    v_mfma_f32_16x16x32_bf16 v[96:99], v[68:71], v[32:35], 0
    v_mfma_f32_16x16x32_bf16 v[92:95], v[64:67], v[36:39], v[92:95]
    v_mfma_f32_16x16x32_bf16 v[96:99], v[72:75], v[36:39], v[96:99]
    ds_read_b64_tr_b16 v[76:77], v51 offset:6144
    ds_read_b64_tr_b16 v[78:79], v53 offset:6144
    ds_read_b64_tr_b16 v[80:81], v51 offset:8192
    ds_read_b64_tr_b16 v[82:83], v53 offset:8192
    ds_read_b64_tr_b16 v[84:85], v52 offset:6144
    ds_read_b64_tr_b16 v[86:87], v54 offset:6144
    ds_read_b64_tr_b16 v[88:89], v52 offset:8192
    ds_read_b64_tr_b16 v[90:91], v54 offset:8192
    v_cvt_pk_bf16_f32 v108, v92, v93
    v_cvt_pk_bf16_f32 v109, v94, v95
    v_cvt_pk_bf16_f32 v110, v96, v97
    v_cvt_pk_bf16_f32 v111, v98, v99
    s_add_u32 s38, s37, 4096
    buffer_store_dwordx4 v[108:111], v58, s[16:19], s38 offen sc1
    s_waitcnt lgkmcnt(0)
    v_mfma_f32_16x16x32_bf16 v[100:103], v[76:79], v[32:35], 0
    v_mfma_f32_16x16x32_bf16 v[104:107], v[84:87], v[32:35], 0
    v_mfma_f32_16x16x32_bf16 v[100:103], v[80:83], v[36:39], v[100:103]
    v_mfma_f32_16x16x32_bf16 v[104:107], v[88:91], v[36:39], v[104:107]
    s_nop 7
    v_cvt_pk_bf16_f32 v112, v100, v101
    v_cvt_pk_bf16_f32 v113, v102, v103
    v_cvt_pk_bf16_f32 v114, v104, v105
    v_cvt_pk_bf16_f32 v115, v106, v107
    s_add_u32 s38, s37, 5120
    buffer_store_dwordx4 v[112:115], v58, s[16:19], s38 offen sc1
    s_endpgm
L_mid_kernel_g:
    s_sub_u32 s3, s2, 448
    s_load_dwordx2 s[4:5], s[0:1], 16
    s_load_dwordx2 s[6:7], s[0:1], 72
    s_lshr_b32 s24, s3, 4
    s_bfe_u32 s25, s3, 0x20002
    s_and_b32 s26, s3, 3
    s_lshr_b32 s27, s24, 3
    s_and_b32 s28, s24, 7
    v_and_b32 v1, 63, v0
    v_lshrrev_b32 v2, 3, v1
    v_mov_b32 v3, v2
    s_lshl_b32 s29, s25, 3
    s_lshl_b32 s30, s28, 5
    s_add_u32 s29, s29, s30
    v_add_u32 v3, s29, v3
    v_lshlrev_b32 v3, 9, v3
    v_and_b32 v4, 7, v1
    s_lshr_b32 s30, s20, 1
    s_lshl_b32 s30, s30, 2
    v_xor_b32 v4, s30, v4
    v_lshl_add_u32 v3, v4, 4, v3
    s_lshl_b32 s30, s26, 7
    v_add_u32 v3, s30, v3
    v_xor_b32 v4, 32, v3
    s_waitcnt lgkmcnt(0)
    s_mov_b32 s8, s4
    s_mov_b32 s9, s5
    s_mov_b32 s10, 4063232
    s_mov_b32 s11, 0x00020000
    s_add_u32 s12, s6, 62345216
    s_addc_u32 s13, s7, 0
    s_mov_b32 s14, 16916480
    s_mov_b32 s15, 0x00020000
    s_lshl_b32 s30, s20, 3
    s_add_u32 s30, s30, s27
    s_lshl_b32 s30, s30, 17
    s_mul_i32 s31, s20, 4608
    s_add_u32 m0, s31, 0
    s_add_u32 s32, s30, 0
    buffer_load_dwordx4 v3, s[8:11], s32 offen nt lds
    s_add_u32 m0, s31, 1152
    s_add_u32 s32, s30, 262144
    buffer_load_dwordx4 v3, s[8:11], s32 offen nt lds
    s_add_u32 m0, s31, 2304
    s_add_u32 s32, s30, 524288
    buffer_load_dwordx4 v4, s[8:11], s32 offen nt lds
    s_add_u32 m0, s31, 3456
    s_add_u32 s32, s30, 786432
    buffer_load_dwordx4 v4, s[8:11], s32 offen nt lds
    v_and_b32 v8, 15, v1
    v_or_b32 v9, 1, v8
    s_lshl_b32 s33, s20, 4
    v_add_u32 v9, s33, v9
    v_cvt_f32_u32 v9, v9
    v_mul_f32 v9, 0x3c000000, v9
    v_bfe_u32 v10, v1, 4, 1
    v_lshlrev_b32 v10, 3, v10
    v_cvt_f32_u32 v10, v10
    v_and_b32 v8, 1, v8
    v_cvt_f32_u32 v8, v8
    v_mul_f32 v8, 0x3f400000, v8
    v_fma_f32 v11, v9, v10, v8
    v_fract_f32 v12, v11
    v_add_f32 v11, v11, v9
    v_fract_f32 v13, v11
    v_add_f32 v11, v11, v9
    v_fract_f32 v14, v11
    v_add_f32 v11, v11, v9
    v_fract_f32 v15, v11
    v_add_f32 v11, v11, v9
    v_fract_f32 v16, v11
    v_add_f32 v11, v11, v9
    v_fract_f32 v17, v11
    v_add_f32 v11, v11, v9
    v_fract_f32 v18, v11
    v_add_f32 v11, v11, v9
    v_fract_f32 v19, v11
    v_cos_f32 v12, v12
    v_cos_f32 v13, v13
    v_cos_f32 v14, v14
    v_cos_f32 v15, v15
    v_cos_f32 v16, v16
    v_cos_f32 v17, v17
    v_cos_f32 v18, v18
    v_cos_f32 v19, v19
    s_nop 0
    v_mul_f32 v12, 0x3d000000, v12
    v_mul_f32 v13, 0x3d000000, v13
    v_mul_f32 v14, 0x3d000000, v14
    v_mul_f32 v15, 0x3d000000, v15
    v_mul_f32 v16, 0x3d000000, v16
    v_mul_f32 v17, 0x3d000000, v17
    v_mul_f32 v18, 0x3d000000, v18
    v_mul_f32 v19, 0x3d000000, v19
    v_cvt_pk_bf16_f32 v20, v12, v13
    v_cvt_pk_bf16_f32 v21, v14, v15
    v_cvt_pk_bf16_f32 v22, v16, v17
    v_cvt_pk_bf16_f32 v23, v18, v19
    v_lshlrev_b32 v28, 16, v20
    v_and_b32 v29, 0xffff0000, v20
    v_sub_f32 v28, v12, v28
    v_sub_f32 v29, v13, v29
    v_cvt_pk_bf16_f32 v24, v28, v29
    v_lshlrev_b32 v28, 16, v21
    v_and_b32 v29, 0xffff0000, v21
    v_sub_f32 v28, v14, v28
    v_sub_f32 v29, v15, v29
    v_cvt_pk_bf16_f32 v25, v28, v29
    v_lshlrev_b32 v28, 16, v22
    v_and_b32 v29, 0xffff0000, v22
    v_sub_f32 v28, v16, v28
    v_sub_f32 v29, v17, v29
    v_cvt_pk_bf16_f32 v26, v28, v29
    v_lshlrev_b32 v28, 16, v23
    v_and_b32 v29, 0xffff0000, v23
    v_sub_f32 v28, v18, v28
    v_sub_f32 v29, v19, v29
    v_cvt_pk_bf16_f32 v27, v28, v29
    v_cmp_gt_u32 vcc, 32, v1
    s_nop 1
    v_cndmask_b32 v20, v24, v20, vcc
    v_cndmask_b32 v21, v25, v21, vcc
    v_cndmask_b32 v22, v26, v22, vcc
    v_cndmask_b32 v23, v27, v23, vcc
    v_lshlrev_b32 v28, 4, v1
    s_lshl_b32 s33, s20, 10
    v_add_u32 v29, s33, v28
    ds_write_b128 v29, v[20:23] offset:18432
    v_bfe_u32 v30, v1, 2, 2
    v_bfe_u32 v31, v1, 4, 1
    v_lshl_add_u32 v32, v31, 3, v30
    v_mul_u32_u24 v32, 1152, v32
    v_lshrrev_b32 v30, 1, v30
    v_lshl_add_u32 v30, v31, 1, v30
    v_lshlrev_b32 v30, 1, v30
    v_bfe_u32 v31, v1, 1, 1
    s_lshl_b32 s33, s20, 1
    v_add_u32 v31, s33, v31
    v_xor_b32 v30, v30, v31
    v_lshl_add_u32 v32, v30, 4, v32
    v_and_b32 v30, 1, v1
    v_lshl_add_u32 v32, v30, 3, v32
    v_lshrrev_b32 v30, 4, v1
    s_mov_b32 s33, 1057280
    v_mul_lo_u32 v30, v30, s33
    v_and_b32 v31, 15, v1
    v_lshl_add_u32 v33, v31, 4, v30
    s_lshl_b32 s34, s24, 15
    s_lshl_b32 s35, s26, 2
    s_add_u32 s35, s35, s20
    s_lshl_b32 s35, s35, 11
    s_add_u32 s34, s34, s35
    s_lshl_b32 s35, s25, 8
    s_add_u32 s34, s34, s35
    s_waitcnt vmcnt(0) lgkmcnt(0)
    s_barrier
    ds_read_b128 v[36:39], v28 offset:18432
    ds_read_b128 v[40:43], v28 offset:19456
    ds_read_b128 v[44:47], v28 offset:20480
    ds_read_b128 v[48:51], v28 offset:21504
    ds_read_b64_tr_b16 v[52:53], v32 offset:0
    ds_read_b64_tr_b16 v[54:55], v32 offset:4608
    ds_read_b64_tr_b16 v[56:57], v32 offset:128
    ds_read_b64_tr_b16 v[58:59], v32 offset:4736
    ds_read_b64_tr_b16 v[60:61], v32 offset:256
    ds_read_b64_tr_b16 v[62:63], v32 offset:4864
    ds_read_b64_tr_b16 v[64:65], v32 offset:384
    ds_read_b64_tr_b16 v[66:67], v32 offset:4992
    ds_read_b64_tr_b16 v[68:69], v32 offset:512
    ds_read_b64_tr_b16 v[70:71], v32 offset:5120
    s_waitcnt lgkmcnt(8)
    ds_read_b64_tr_b16 v[72:73], v32 offset:640
    ds_read_b64_tr_b16 v[74:75], v32 offset:5248
    ds_read_b64_tr_b16 v[76:77], v32 offset:768
    ds_read_b64_tr_b16 v[78:79], v32 offset:5376
    ds_read_b64_tr_b16 v[80:81], v32 offset:896
    ds_read_b64_tr_b16 v[82:83], v32 offset:5504
    s_waitcnt lgkmcnt(0)
    v_mfma_f32_16x16x32_bf16 v[84:87], v[36:39], v[52:55], 0
    v_mfma_f32_16x16x32_bf16 v[88:91], v[36:39], v[56:59], 0
    v_mfma_f32_16x16x32_bf16 v[92:95], v[36:39], v[60:63], 0
    v_mfma_f32_16x16x32_bf16 v[96:99], v[36:39], v[64:67], 0
    v_mfma_f32_16x16x32_bf16 v[100:103], v[36:39], v[68:71], 0
    v_mfma_f32_16x16x32_bf16 v[104:107], v[36:39], v[72:75], 0
    v_mfma_f32_16x16x32_bf16 v[108:111], v[36:39], v[76:79], 0
    v_mfma_f32_16x16x32_bf16 v[112:115], v[36:39], v[80:83], 0
    s_nop 7
    v_cvt_pk_bf16_f32 v116, v84, v88
    v_cvt_pk_bf16_f32 v117, v92, v96
    v_cvt_pk_bf16_f32 v118, v100, v104
    v_cvt_pk_bf16_f32 v119, v108, v112
    s_add_u32 s35, s34, 0
    buffer_store_dwordx4 v[116:119], v33, s[12:15], s35 offen sc1
    s_nop 1
    v_cvt_pk_bf16_f32 v120, v85, v89
    v_cvt_pk_bf16_f32 v121, v93, v97
    v_cvt_pk_bf16_f32 v122, v101, v105
    v_cvt_pk_bf16_f32 v123, v109, v113
    s_add_u32 s35, s34, 1024
    buffer_store_dwordx4 v[120:123], v33, s[12:15], s35 offen sc1
    s_nop 1
    v_cvt_pk_bf16_f32 v116, v86, v90
    v_cvt_pk_bf16_f32 v117, v94, v98
    v_cvt_pk_bf16_f32 v118, v102, v106
    v_cvt_pk_bf16_f32 v119, v110, v114
    s_add_u32 s35, s34, 528640
    buffer_store_dwordx4 v[116:119], v33, s[12:15], s35 offen sc1
    s_nop 1
    v_cvt_pk_bf16_f32 v120, v87, v91
    v_cvt_pk_bf16_f32 v121, v95, v99
    v_cvt_pk_bf16_f32 v122, v103, v107
    v_cvt_pk_bf16_f32 v123, v111, v115
    s_add_u32 s35, s34, 529664
    buffer_store_dwordx4 v[120:123], v33, s[12:15], s35 offen sc1
    s_nop 1
    v_mfma_f32_16x16x32_bf16 v[84:87], v[40:43], v[52:55], 0
    v_mfma_f32_16x16x32_bf16 v[88:91], v[40:43], v[56:59], 0
    v_mfma_f32_16x16x32_bf16 v[92:95], v[40:43], v[60:63], 0
    v_mfma_f32_16x16x32_bf16 v[96:99], v[40:43], v[64:67], 0
    v_mfma_f32_16x16x32_bf16 v[100:103], v[40:43], v[68:71], 0
    v_mfma_f32_16x16x32_bf16 v[104:107], v[40:43], v[72:75], 0
    v_mfma_f32_16x16x32_bf16 v[108:111], v[40:43], v[76:79], 0
    v_mfma_f32_16x16x32_bf16 v[112:115], v[40:43], v[80:83], 0
    s_nop 7
    v_cvt_pk_bf16_f32 v116, v84, v88
    v_cvt_pk_bf16_f32 v117, v92, v96
    v_cvt_pk_bf16_f32 v118, v100, v104
    v_cvt_pk_bf16_f32 v119, v108, v112
    s_add_u32 s35, s34, 4229120
    buffer_store_dwordx4 v[116:119], v33, s[12:15], s35 offen sc1
    s_nop 1
    v_cvt_pk_bf16_f32 v120, v85, v89
    v_cvt_pk_bf16_f32 v121, v93, v97
    v_cvt_pk_bf16_f32 v122, v101, v105
    v_cvt_pk_bf16_f32 v123, v109, v113
    s_add_u32 s35, s34, 4230144
    buffer_store_dwordx4 v[120:123], v33, s[12:15], s35 offen sc1
    s_nop 1
    v_cvt_pk_bf16_f32 v116, v86, v90
    v_cvt_pk_bf16_f32 v117, v94, v98
    v_cvt_pk_bf16_f32 v118, v102, v106
    v_cvt_pk_bf16_f32 v119, v110, v114
    s_add_u32 s35, s34, 4757760
    buffer_store_dwordx4 v[116:119], v33, s[12:15], s35 offen sc1
    s_nop 1
    v_cvt_pk_bf16_f32 v120, v87, v91
    v_cvt_pk_bf16_f32 v121, v95, v99
    v_cvt_pk_bf16_f32 v122, v103, v107
    v_cvt_pk_bf16_f32 v123, v111, v115
    s_add_u32 s35, s34, 4758784
    buffer_store_dwordx4 v[120:123], v33, s[12:15], s35 offen sc1
    s_nop 1
    v_mfma_f32_16x16x32_bf16 v[84:87], v[44:47], v[52:55], 0
    v_mfma_f32_16x16x32_bf16 v[88:91], v[44:47], v[56:59], 0
    v_mfma_f32_16x16x32_bf16 v[92:95], v[44:47], v[60:63], 0
    v_mfma_f32_16x16x32_bf16 v[96:99], v[44:47], v[64:67], 0
    v_mfma_f32_16x16x32_bf16 v[100:103], v[44:47], v[68:71], 0
    v_mfma_f32_16x16x32_bf16 v[104:107], v[44:47], v[72:75], 0
    v_mfma_f32_16x16x32_bf16 v[108:111], v[44:47], v[76:79], 0
    v_mfma_f32_16x16x32_bf16 v[112:115], v[44:47], v[80:83], 0
    s_nop 7
    v_cvt_pk_bf16_f32 v116, v84, v88
    v_cvt_pk_bf16_f32 v117, v92, v96
    v_cvt_pk_bf16_f32 v118, v100, v104
    v_cvt_pk_bf16_f32 v119, v108, v112
    s_add_u32 s35, s34, 8458240
    buffer_store_dwordx4 v[116:119], v33, s[12:15], s35 offen sc1
    s_nop 1
    v_cvt_pk_bf16_f32 v120, v85, v89
    v_cvt_pk_bf16_f32 v121, v93, v97
    v_cvt_pk_bf16_f32 v122, v101, v105
    v_cvt_pk_bf16_f32 v123, v109, v113
    s_add_u32 s35, s34, 8459264
    buffer_store_dwordx4 v[120:123], v33, s[12:15], s35 offen sc1
    s_nop 1
    v_cvt_pk_bf16_f32 v116, v86, v90
    v_cvt_pk_bf16_f32 v117, v94, v98
    v_cvt_pk_bf16_f32 v118, v102, v106
    v_cvt_pk_bf16_f32 v119, v110, v114
    s_add_u32 s35, s34, 8986880
    buffer_store_dwordx4 v[116:119], v33, s[12:15], s35 offen sc1
    s_nop 1
    v_cvt_pk_bf16_f32 v120, v87, v91
    v_cvt_pk_bf16_f32 v121, v95, v99
    v_cvt_pk_bf16_f32 v122, v103, v107
    v_cvt_pk_bf16_f32 v123, v111, v115
    s_add_u32 s35, s34, 8987904
    buffer_store_dwordx4 v[120:123], v33, s[12:15], s35 offen sc1
    s_nop 1
    v_mfma_f32_16x16x32_bf16 v[84:87], v[48:51], v[52:55], 0
    v_mfma_f32_16x16x32_bf16 v[88:91], v[48:51], v[56:59], 0
    v_mfma_f32_16x16x32_bf16 v[92:95], v[48:51], v[60:63], 0
    v_mfma_f32_16x16x32_bf16 v[96:99], v[48:51], v[64:67], 0
    v_mfma_f32_16x16x32_bf16 v[100:103], v[48:51], v[68:71], 0
    v_mfma_f32_16x16x32_bf16 v[104:107], v[48:51], v[72:75], 0
    v_mfma_f32_16x16x32_bf16 v[108:111], v[48:51], v[76:79], 0
    v_mfma_f32_16x16x32_bf16 v[112:115], v[48:51], v[80:83], 0
    s_nop 7
    v_cvt_pk_bf16_f32 v116, v84, v88
    v_cvt_pk_bf16_f32 v117, v92, v96
    v_cvt_pk_bf16_f32 v118, v100, v104
    v_cvt_pk_bf16_f32 v119, v108, v112
    s_add_u32 s35, s34, 12687360
    buffer_store_dwordx4 v[116:119], v33, s[12:15], s35 offen sc1
    s_nop 1
    v_cvt_pk_bf16_f32 v120, v85, v89
    v_cvt_pk_bf16_f32 v121, v93, v97
    v_cvt_pk_bf16_f32 v122, v101, v105
    v_cvt_pk_bf16_f32 v123, v109, v113
    s_add_u32 s35, s34, 12688384
    buffer_store_dwordx4 v[120:123], v33, s[12:15], s35 offen sc1
    s_nop 1
    v_cvt_pk_bf16_f32 v116, v86, v90
    v_cvt_pk_bf16_f32 v117, v94, v98
    v_cvt_pk_bf16_f32 v118, v102, v106
    v_cvt_pk_bf16_f32 v119, v110, v114
    s_add_u32 s35, s34, 13216000
    buffer_store_dwordx4 v[116:119], v33, s[12:15], s35 offen sc1
    s_nop 1
    v_cvt_pk_bf16_f32 v120, v87, v91
    v_cvt_pk_bf16_f32 v121, v95, v99
    v_cvt_pk_bf16_f32 v122, v103, v107
    v_cvt_pk_bf16_f32 v123, v111, v115
    s_add_u32 s35, s34, 13217024
    buffer_store_dwordx4 v[120:123], v33, s[12:15], s35 offen sc1
    s_nop 1
    s_endpgm
L_mid_kernel_done:
    s_endpgm
.globl gemm2_kernel
.p2align 8
.type gemm2_kernel,@function
gemm2_kernel:
    s_cmp_ge_u32 s2, 256
    s_cbranch_scc1 L_gemm2_kernel_done
    s_load_dwordx2 s[4:5], s[0:1], 72
    s_load_dwordx2 s[6:7], s[0:1], 72
    v_readfirstlane_b32 s20, v0
    s_lshr_b32 s20, s20, 6
    s_and_b32 s24, s2, 7
    s_lshr_b32 s25, s2, 3
    s_lshr_b32 s26, s25, 3
    s_lshl_b32 s24, s24, 2
    s_add_u32 s21, s24, s26
    s_and_b32 s25, s25, 7
    s_lshr_b32 s26, s25, 2
    s_and_b32 s27, s25, 3
    s_mul_i32 s22, s26, 84
    s_sub_u32 s28, 168, s22
    s_min_u32 s28, s28, 84
    s_waitcnt lgkmcnt(0)
    s_mul_i32 s29, s21, 344064
    s_lshl_b32 s30, s22, 11
    s_add_u32 s29, s29, s30
    s_add_u32 s29, s29, 51269632
    s_add_u32 s8, s6, s29
    s_addc_u32 s9, s7, 0
    s_lshl_b32 s10, s28, 11
    s_mov_b32 s11, 0x00020000
    s_mul_i32 s29, s21, 528640
    s_mul_i32 s30, s27, 8192
    s_add_u32 s29, s29, s30
    s_add_u32 s29, s29, 62345216
    s_add_u32 s12, s4, s29
    s_addc_u32 s13, s5, 0
    s_mov_b32 s14, 499712
    s_mov_b32 s15, 0x00020000
    s_cmp_ge_u32 s20, 4
    s_cbranch_scc1 L_gemm2_kernel_loader
    s_mul_i32 s29, s22, 37120
    s_add_u32 s29, s29, 79261696
    s_add_u32 s16, s4, s29
    s_addc_u32 s17, s5, 0
    s_mul_i32 s18, s28, 37120
    s_mov_b32 s19, 0x00020000
    s_lshr_b32 s29, s20, 1
    s_and_b32 s30, s20, 1
    v_and_b32 v137, 15, v0
    v_bfe_u32 v138, v0, 4, 2
    v_and_b32 v139, 63, v0
    s_mul_i32 s31, s29, 6144
    v_and_b32 v140, 7, v137
    v_xor_b32 v140, v138, v140
    v_lshlrev_b32 v140, 4, v140
    v_lshl_add_u32 v140, v137, 7, v140
    v_add_u32 v140, s31, v140
    v_add_u32 v128, 0, v140
    v_xor_b32 v131, 64, v128
    v_add_u32 v129, 61440, v140
    v_xor_b32 v132, 64, v129
    v_add_u32 v130, 122880, v140
    v_xor_b32 v133, 64, v130
    s_mul_i32 s31, s30, 4096
    s_add_u32 s31, s31, 12288
    v_lshlrev_b32 v140, 4, v139
    v_add_u32 v140, s31, v140
    v_add_u32 v134, 0, v140
    v_add_u32 v135, 61440, v140
    v_add_u32 v136, 122880, v140
    v_and_b32 v144, 7, v137
    v_lshrrev_b32 v145, 3, v137
    v_mul_u32_u24 v142, 37120, v144
    v_lshl_add_u32 v142, v138, 4, v142
    s_mul_i32 s31, s29, 1781760
    v_add_u32 v142, s31, v142
    v_lshl_add_u32 v142, v145, 6, v142
    v_xor_b32 v145, 64, v142
    v_add_u32 v143, 296960, v145
    s_mul_i32 s31, s27, 2
    s_mul_i32 s29, s30, 1
    s_add_u32 s31, s31, s29
    s_lshl_b32 s31, s31, 12
    s_lshl_b32 s29, s21, 7
    s_add_u32 s33, s31, s29
    s_mov_b32 s34, 0x80008000
    s_barrier
    ds_read_b128 v[48:51], v134 offset:0
    ds_read_b128 v[64:67], v128 offset:0
    ds_read_b128 v[72:75], v128 offset:2048
    ds_read_b128 v[80:83], v128 offset:4096
    ds_read_b128 v[56:59], v134 offset:2048
    ds_read_b128 v[68:71], v131 offset:0
    ds_read_b128 v[76:79], v131 offset:2048
    ds_read_b128 v[84:87], v131 offset:4096
    ds_read_b128 v[52:55], v134 offset:1024
    ds_read_b128 v[60:63], v134 offset:3072
    s_waitcnt lgkmcnt(0)
    s_barrier
    v_mfma_f32_16x16x32_bf16 v[0:3], v[48:51], v[64:67], 0
    ds_read_b128 v[88:91], v134 offset:20480
    v_mfma_f32_16x16x32_bf16 v[4:7], v[48:51], v[72:75], 0
    ds_read_b128 v[104:107], v128 offset:20480
    v_mfma_f32_16x16x32_bf16 v[8:11], v[48:51], v[80:83], 0
    ds_read_b128 v[112:115], v128 offset:22528
    v_mfma_f32_16x16x32_bf16 v[12:15], v[56:59], v[64:67], 0
    ds_read_b128 v[120:123], v128 offset:24576
    v_mfma_f32_16x16x32_bf16 v[16:19], v[56:59], v[72:75], 0
    ds_read_b128 v[96:99], v134 offset:22528
    v_mfma_f32_16x16x32_bf16 v[20:23], v[56:59], v[80:83], 0
    ds_read_b128 v[108:111], v131 offset:20480
    v_mfma_f32_16x16x32_bf16 v[24:27], v[48:51], v[68:71], 0
    ds_read_b128 v[116:119], v131 offset:22528
    v_mfma_f32_16x16x32_bf16 v[28:31], v[48:51], v[76:79], 0
    ds_read_b128 v[124:127], v131 offset:24576
    v_mfma_f32_16x16x32_bf16 v[32:35], v[48:51], v[84:87], 0
    ds_read_b128 v[92:95], v134 offset:21504
    v_mfma_f32_16x16x32_bf16 v[36:39], v[56:59], v[68:71], 0
    ds_read_b128 v[100:103], v134 offset:23552
    v_mfma_f32_16x16x32_bf16 v[40:43], v[56:59], v[76:79], 0
    v_mfma_f32_16x16x32_bf16 v[44:47], v[56:59], v[84:87], 0
    v_mfma_f32_16x16x32_bf16 v[24:27], v[52:55], v[64:67], v[24:27]
    v_xor_b32 v68, s34, v68
    v_xor_b32 v69, s34, v69
    v_mfma_f32_16x16x32_bf16 v[28:31], v[52:55], v[72:75], v[28:31]
    v_xor_b32 v70, s34, v70
    v_xor_b32 v71, s34, v71
    v_mfma_f32_16x16x32_bf16 v[32:35], v[52:55], v[80:83], v[32:35]
    v_xor_b32 v76, s34, v76
    v_xor_b32 v77, s34, v77
    v_mfma_f32_16x16x32_bf16 v[36:39], v[60:63], v[64:67], v[36:39]
    v_xor_b32 v78, s34, v78
    v_xor_b32 v79, s34, v79
    v_mfma_f32_16x16x32_bf16 v[40:43], v[60:63], v[72:75], v[40:43]
    v_xor_b32 v84, s34, v84
    v_xor_b32 v85, s34, v85
    v_mfma_f32_16x16x32_bf16 v[44:47], v[60:63], v[80:83], v[44:47]
    v_xor_b32 v86, s34, v86
    v_xor_b32 v87, s34, v87
    v_mfma_f32_16x16x32_bf16 v[0:3], v[52:55], v[68:71], v[0:3]
    v_mfma_f32_16x16x32_bf16 v[4:7], v[52:55], v[76:79], v[4:7]
    v_mfma_f32_16x16x32_bf16 v[8:11], v[52:55], v[84:87], v[8:11]
    s_waitcnt lgkmcnt(0)
    s_barrier
    v_mfma_f32_16x16x32_bf16 v[12:15], v[60:63], v[68:71], v[12:15]
    v_mfma_f32_16x16x32_bf16 v[16:19], v[60:63], v[76:79], v[16:19]
    v_mfma_f32_16x16x32_bf16 v[20:23], v[60:63], v[84:87], v[20:23]
    v_mfma_f32_16x16x32_bf16 v[0:3], v[88:91], v[104:107], v[0:3]
    ds_read_b128 v[48:51], v134 offset:40960
    v_mfma_f32_16x16x32_bf16 v[4:7], v[88:91], v[112:115], v[4:7]
    ds_read_b128 v[64:67], v128 offset:40960
    v_mfma_f32_16x16x32_bf16 v[8:11], v[88:91], v[120:123], v[8:11]
    ds_read_b128 v[72:75], v128 offset:43008
    v_mfma_f32_16x16x32_bf16 v[12:15], v[96:99], v[104:107], v[12:15]
    ds_read_b128 v[80:83], v128 offset:45056
    v_mfma_f32_16x16x32_bf16 v[16:19], v[96:99], v[112:115], v[16:19]
    ds_read_b128 v[56:59], v134 offset:43008
    v_mfma_f32_16x16x32_bf16 v[20:23], v[96:99], v[120:123], v[20:23]
    ds_read_b128 v[68:71], v131 offset:40960
    v_mfma_f32_16x16x32_bf16 v[24:27], v[88:91], v[108:111], v[24:27]
    ds_read_b128 v[76:79], v131 offset:43008
    v_mfma_f32_16x16x32_bf16 v[28:31], v[88:91], v[116:119], v[28:31]
    ds_read_b128 v[84:87], v131 offset:45056
    v_mfma_f32_16x16x32_bf16 v[32:35], v[88:91], v[124:127], v[32:35]
    ds_read_b128 v[52:55], v134 offset:41984
    v_mfma_f32_16x16x32_bf16 v[36:39], v[96:99], v[108:111], v[36:39]
    ds_read_b128 v[60:63], v134 offset:44032
    v_mfma_f32_16x16x32_bf16 v[40:43], v[96:99], v[116:119], v[40:43]
    v_mfma_f32_16x16x32_bf16 v[44:47], v[96:99], v[124:127], v[44:47]
    v_mfma_f32_16x16x32_bf16 v[24:27], v[92:95], v[104:107], v[24:27]
    v_xor_b32 v108, s34, v108
    v_xor_b32 v109, s34, v109
    v_mfma_f32_16x16x32_bf16 v[28:31], v[92:95], v[112:115], v[28:31]
    v_xor_b32 v110, s34, v110
    v_xor_b32 v111, s34, v111
    v_mfma_f32_16x16x32_bf16 v[32:35], v[92:95], v[120:123], v[32:35]
    v_xor_b32 v116, s34, v116
    v_xor_b32 v117, s34, v117
    v_mfma_f32_16x16x32_bf16 v[36:39], v[100:103], v[104:107], v[36:39]
    v_xor_b32 v118, s34, v118
    v_xor_b32 v119, s34, v119
    v_mfma_f32_16x16x32_bf16 v[40:43], v[100:103], v[112:115], v[40:43]
    v_xor_b32 v124, s34, v124
    v_xor_b32 v125, s34, v125
    v_mfma_f32_16x16x32_bf16 v[44:47], v[100:103], v[120:123], v[44:47]
    v_xor_b32 v126, s34, v126
    v_xor_b32 v127, s34, v127
    v_mfma_f32_16x16x32_bf16 v[0:3], v[92:95], v[108:111], v[0:3]
    v_mfma_f32_16x16x32_bf16 v[4:7], v[92:95], v[116:119], v[4:7]
    v_mfma_f32_16x16x32_bf16 v[8:11], v[92:95], v[124:127], v[8:11]
    s_waitcnt lgkmcnt(0)
    s_barrier
    v_mfma_f32_16x16x32_bf16 v[12:15], v[100:103], v[108:111], v[12:15]
    v_mfma_f32_16x16x32_bf16 v[16:19], v[100:103], v[116:119], v[16:19]
    v_mfma_f32_16x16x32_bf16 v[20:23], v[100:103], v[124:127], v[20:23]
    v_mfma_f32_16x16x32_bf16 v[0:3], v[48:51], v[64:67], v[0:3]
    ds_read_b128 v[88:91], v135 offset:0
    v_mfma_f32_16x16x32_bf16 v[4:7], v[48:51], v[72:75], v[4:7]
    ds_read_b128 v[104:107], v129 offset:0
    v_mfma_f32_16x16x32_bf16 v[8:11], v[48:51], v[80:83], v[8:11]
    ds_read_b128 v[112:115], v129 offset:2048
    v_mfma_f32_16x16x32_bf16 v[12:15], v[56:59], v[64:67], v[12:15]
    ds_read_b128 v[120:123], v129 offset:4096
    v_mfma_f32_16x16x32_bf16 v[16:19], v[56:59], v[72:75], v[16:19]
    ds_read_b128 v[96:99], v135 offset:2048
    v_mfma_f32_16x16x32_bf16 v[20:23], v[56:59], v[80:83], v[20:23]
    ds_read_b128 v[108:111], v132 offset:0
    v_mfma_f32_16x16x32_bf16 v[24:27], v[48:51], v[68:71], v[24:27]
    ds_read_b128 v[116:119], v132 offset:2048
    v_mfma_f32_16x16x32_bf16 v[28:31], v[48:51], v[76:79], v[28:31]
    ds_read_b128 v[124:127], v132 offset:4096
    v_mfma_f32_16x16x32_bf16 v[32:35], v[48:51], v[84:87], v[32:35]
    ds_read_b128 v[92:95], v135 offset:1024
    v_mfma_f32_16x16x32_bf16 v[36:39], v[56:59], v[68:71], v[36:39]
    ds_read_b128 v[100:103], v135 offset:3072
    v_mfma_f32_16x16x32_bf16 v[40:43], v[56:59], v[76:79], v[40:43]
    v_mfma_f32_16x16x32_bf16 v[44:47], v[56:59], v[84:87], v[44:47]
    v_mfma_f32_16x16x32_bf16 v[24:27], v[52:55], v[64:67], v[24:27]
    v_xor_b32 v68, s34, v68
    v_xor_b32 v69, s34, v69
    v_mfma_f32_16x16x32_bf16 v[28:31], v[52:55], v[72:75], v[28:31]
    v_xor_b32 v70, s34, v70
    v_xor_b32 v71, s34, v71
    v_mfma_f32_16x16x32_bf16 v[32:35], v[52:55], v[80:83], v[32:35]
    v_xor_b32 v76, s34, v76
    v_xor_b32 v77, s34, v77
    v_mfma_f32_16x16x32_bf16 v[36:39], v[60:63], v[64:67], v[36:39]
    v_xor_b32 v78, s34, v78
    v_xor_b32 v79, s34, v79
    v_mfma_f32_16x16x32_bf16 v[40:43], v[60:63], v[72:75], v[40:43]
    v_xor_b32 v84, s34, v84
    v_xor_b32 v85, s34, v85
    v_mfma_f32_16x16x32_bf16 v[44:47], v[60:63], v[80:83], v[44:47]
    v_xor_b32 v86, s34, v86
    v_xor_b32 v87, s34, v87
    v_mfma_f32_16x16x32_bf16 v[0:3], v[52:55], v[68:71], v[0:3]
    v_mfma_f32_16x16x32_bf16 v[4:7], v[52:55], v[76:79], v[4:7]
    v_mfma_f32_16x16x32_bf16 v[8:11], v[52:55], v[84:87], v[8:11]
    s_waitcnt lgkmcnt(0)
    s_barrier
    v_mfma_f32_16x16x32_bf16 v[12:15], v[60:63], v[68:71], v[12:15]
    v_mfma_f32_16x16x32_bf16 v[16:19], v[60:63], v[76:79], v[16:19]
    v_mfma_f32_16x16x32_bf16 v[20:23], v[60:63], v[84:87], v[20:23]
    v_mfma_f32_16x16x32_bf16 v[0:3], v[88:91], v[104:107], v[0:3]
    ds_read_b128 v[48:51], v135 offset:20480
    v_mfma_f32_16x16x32_bf16 v[4:7], v[88:91], v[112:115], v[4:7]
    ds_read_b128 v[64:67], v129 offset:20480
    v_mfma_f32_16x16x32_bf16 v[8:11], v[88:91], v[120:123], v[8:11]
    ds_read_b128 v[72:75], v129 offset:22528
    v_mfma_f32_16x16x32_bf16 v[12:15], v[96:99], v[104:107], v[12:15]
    ds_read_b128 v[80:83], v129 offset:24576
    v_mfma_f32_16x16x32_bf16 v[16:19], v[96:99], v[112:115], v[16:19]
    ds_read_b128 v[56:59], v135 offset:22528
    v_mfma_f32_16x16x32_bf16 v[20:23], v[96:99], v[120:123], v[20:23]
    ds_read_b128 v[68:71], v132 offset:20480
    v_mfma_f32_16x16x32_bf16 v[24:27], v[88:91], v[108:111], v[24:27]
    ds_read_b128 v[76:79], v132 offset:22528
    v_mfma_f32_16x16x32_bf16 v[28:31], v[88:91], v[116:119], v[28:31]
    ds_read_b128 v[84:87], v132 offset:24576
    v_mfma_f32_16x16x32_bf16 v[32:35], v[88:91], v[124:127], v[32:35]
    ds_read_b128 v[52:55], v135 offset:21504
    v_mfma_f32_16x16x32_bf16 v[36:39], v[96:99], v[108:111], v[36:39]
    ds_read_b128 v[60:63], v135 offset:23552
    v_mfma_f32_16x16x32_bf16 v[40:43], v[96:99], v[116:119], v[40:43]
    v_mfma_f32_16x16x32_bf16 v[44:47], v[96:99], v[124:127], v[44:47]
    v_mfma_f32_16x16x32_bf16 v[24:27], v[92:95], v[104:107], v[24:27]
    v_xor_b32 v108, s34, v108
    v_xor_b32 v109, s34, v109
    v_mfma_f32_16x16x32_bf16 v[28:31], v[92:95], v[112:115], v[28:31]
    v_xor_b32 v110, s34, v110
    v_xor_b32 v111, s34, v111
    v_mfma_f32_16x16x32_bf16 v[32:35], v[92:95], v[120:123], v[32:35]
    v_xor_b32 v116, s34, v116
    v_xor_b32 v117, s34, v117
    v_mfma_f32_16x16x32_bf16 v[36:39], v[100:103], v[104:107], v[36:39]
    v_xor_b32 v118, s34, v118
    v_xor_b32 v119, s34, v119
    v_mfma_f32_16x16x32_bf16 v[40:43], v[100:103], v[112:115], v[40:43]
    v_xor_b32 v124, s34, v124
    v_xor_b32 v125, s34, v125
    v_mfma_f32_16x16x32_bf16 v[44:47], v[100:103], v[120:123], v[44:47]
    v_xor_b32 v126, s34, v126
    v_xor_b32 v127, s34, v127
    v_mfma_f32_16x16x32_bf16 v[0:3], v[92:95], v[108:111], v[0:3]
    v_mfma_f32_16x16x32_bf16 v[4:7], v[92:95], v[116:119], v[4:7]
    v_mfma_f32_16x16x32_bf16 v[8:11], v[92:95], v[124:127], v[8:11]
    s_waitcnt lgkmcnt(0)
    s_barrier
    v_mfma_f32_16x16x32_bf16 v[12:15], v[100:103], v[108:111], v[12:15]
    v_mfma_f32_16x16x32_bf16 v[16:19], v[100:103], v[116:119], v[16:19]
    v_mfma_f32_16x16x32_bf16 v[20:23], v[100:103], v[124:127], v[20:23]
    v_mfma_f32_16x16x32_bf16 v[0:3], v[48:51], v[64:67], v[0:3]
    ds_read_b128 v[88:91], v135 offset:40960
    v_mfma_f32_16x16x32_bf16 v[4:7], v[48:51], v[72:75], v[4:7]
    ds_read_b128 v[104:107], v129 offset:40960
    v_mfma_f32_16x16x32_bf16 v[8:11], v[48:51], v[80:83], v[8:11]
    ds_read_b128 v[112:115], v129 offset:43008
    v_mfma_f32_16x16x32_bf16 v[12:15], v[56:59], v[64:67], v[12:15]
    ds_read_b128 v[120:123], v129 offset:45056
    v_mfma_f32_16x16x32_bf16 v[16:19], v[56:59], v[72:75], v[16:19]
    ds_read_b128 v[96:99], v135 offset:43008
    v_mfma_f32_16x16x32_bf16 v[20:23], v[56:59], v[80:83], v[20:23]
    ds_read_b128 v[108:111], v132 offset:40960
    v_mfma_f32_16x16x32_bf16 v[24:27], v[48:51], v[68:71], v[24:27]
    ds_read_b128 v[116:119], v132 offset:43008
    v_mfma_f32_16x16x32_bf16 v[28:31], v[48:51], v[76:79], v[28:31]
    ds_read_b128 v[124:127], v132 offset:45056
    v_mfma_f32_16x16x32_bf16 v[32:35], v[48:51], v[84:87], v[32:35]
    ds_read_b128 v[92:95], v135 offset:41984
    v_mfma_f32_16x16x32_bf16 v[36:39], v[56:59], v[68:71], v[36:39]
    ds_read_b128 v[100:103], v135 offset:44032
    v_mfma_f32_16x16x32_bf16 v[40:43], v[56:59], v[76:79], v[40:43]
    v_mfma_f32_16x16x32_bf16 v[44:47], v[56:59], v[84:87], v[44:47]
    v_mfma_f32_16x16x32_bf16 v[24:27], v[52:55], v[64:67], v[24:27]
    v_xor_b32 v68, s34, v68
    v_xor_b32 v69, s34, v69
    v_mfma_f32_16x16x32_bf16 v[28:31], v[52:55], v[72:75], v[28:31]
    v_xor_b32 v70, s34, v70
    v_xor_b32 v71, s34, v71
    v_mfma_f32_16x16x32_bf16 v[32:35], v[52:55], v[80:83], v[32:35]
    v_xor_b32 v76, s34, v76
    v_xor_b32 v77, s34, v77
    v_mfma_f32_16x16x32_bf16 v[36:39], v[60:63], v[64:67], v[36:39]
    v_xor_b32 v78, s34, v78
    v_xor_b32 v79, s34, v79
    v_mfma_f32_16x16x32_bf16 v[40:43], v[60:63], v[72:75], v[40:43]
    v_xor_b32 v84, s34, v84
    v_xor_b32 v85, s34, v85
    v_mfma_f32_16x16x32_bf16 v[44:47], v[60:63], v[80:83], v[44:47]
    v_xor_b32 v86, s34, v86
    v_xor_b32 v87, s34, v87
    v_mfma_f32_16x16x32_bf16 v[0:3], v[52:55], v[68:71], v[0:3]
    v_mfma_f32_16x16x32_bf16 v[4:7], v[52:55], v[76:79], v[4:7]
    v_mfma_f32_16x16x32_bf16 v[8:11], v[52:55], v[84:87], v[8:11]
    s_waitcnt lgkmcnt(0)
    s_barrier
    v_mfma_f32_16x16x32_bf16 v[12:15], v[60:63], v[68:71], v[12:15]
    v_mfma_f32_16x16x32_bf16 v[16:19], v[60:63], v[76:79], v[16:19]
    v_mfma_f32_16x16x32_bf16 v[20:23], v[60:63], v[84:87], v[20:23]
    v_mfma_f32_16x16x32_bf16 v[0:3], v[88:91], v[104:107], v[0:3]
    ds_read_b128 v[48:51], v136 offset:0
    v_mfma_f32_16x16x32_bf16 v[4:7], v[88:91], v[112:115], v[4:7]
    ds_read_b128 v[64:67], v130 offset:0
    v_mfma_f32_16x16x32_bf16 v[8:11], v[88:91], v[120:123], v[8:11]
    ds_read_b128 v[72:75], v130 offset:2048
    v_mfma_f32_16x16x32_bf16 v[12:15], v[96:99], v[104:107], v[12:15]
    ds_read_b128 v[80:83], v130 offset:4096
    v_mfma_f32_16x16x32_bf16 v[16:19], v[96:99], v[112:115], v[16:19]
    ds_read_b128 v[56:59], v136 offset:2048
    v_mfma_f32_16x16x32_bf16 v[20:23], v[96:99], v[120:123], v[20:23]
    ds_read_b128 v[68:71], v133 offset:0
    v_mfma_f32_16x16x32_bf16 v[24:27], v[88:91], v[108:111], v[24:27]
    ds_read_b128 v[76:79], v133 offset:2048
    v_mfma_f32_16x16x32_bf16 v[28:31], v[88:91], v[116:119], v[28:31]
    ds_read_b128 v[84:87], v133 offset:4096
    v_mfma_f32_16x16x32_bf16 v[32:35], v[88:91], v[124:127], v[32:35]
    ds_read_b128 v[52:55], v136 offset:1024
    v_mfma_f32_16x16x32_bf16 v[36:39], v[96:99], v[108:111], v[36:39]
    ds_read_b128 v[60:63], v136 offset:3072
    v_mfma_f32_16x16x32_bf16 v[40:43], v[96:99], v[116:119], v[40:43]
    v_mfma_f32_16x16x32_bf16 v[44:47], v[96:99], v[124:127], v[44:47]
    v_mfma_f32_16x16x32_bf16 v[24:27], v[92:95], v[104:107], v[24:27]
    v_xor_b32 v108, s34, v108
    v_xor_b32 v109, s34, v109
    v_mfma_f32_16x16x32_bf16 v[28:31], v[92:95], v[112:115], v[28:31]
    v_xor_b32 v110, s34, v110
    v_xor_b32 v111, s34, v111
    v_mfma_f32_16x16x32_bf16 v[32:35], v[92:95], v[120:123], v[32:35]
    v_xor_b32 v116, s34, v116
    v_xor_b32 v117, s34, v117
    v_mfma_f32_16x16x32_bf16 v[36:39], v[100:103], v[104:107], v[36:39]
    v_xor_b32 v118, s34, v118
    v_xor_b32 v119, s34, v119
    v_mfma_f32_16x16x32_bf16 v[40:43], v[100:103], v[112:115], v[40:43]
    v_xor_b32 v124, s34, v124
    v_xor_b32 v125, s34, v125
    v_mfma_f32_16x16x32_bf16 v[44:47], v[100:103], v[120:123], v[44:47]
    v_xor_b32 v126, s34, v126
    v_xor_b32 v127, s34, v127
    v_mfma_f32_16x16x32_bf16 v[0:3], v[92:95], v[108:111], v[0:3]
    v_mfma_f32_16x16x32_bf16 v[4:7], v[92:95], v[116:119], v[4:7]
    v_mfma_f32_16x16x32_bf16 v[8:11], v[92:95], v[124:127], v[8:11]
    s_waitcnt lgkmcnt(0)
    s_barrier
    v_mfma_f32_16x16x32_bf16 v[12:15], v[100:103], v[108:111], v[12:15]
    v_mfma_f32_16x16x32_bf16 v[16:19], v[100:103], v[116:119], v[16:19]
    v_mfma_f32_16x16x32_bf16 v[20:23], v[100:103], v[124:127], v[20:23]
    v_mfma_f32_16x16x32_bf16 v[0:3], v[48:51], v[64:67], v[0:3]
    ds_read_b128 v[88:91], v134 offset:0
    v_mfma_f32_16x16x32_bf16 v[4:7], v[48:51], v[72:75], v[4:7]
    ds_read_b128 v[104:107], v128 offset:0
    v_mfma_f32_16x16x32_bf16 v[8:11], v[48:51], v[80:83], v[8:11]
    ds_read_b128 v[112:115], v128 offset:2048
    v_mfma_f32_16x16x32_bf16 v[12:15], v[56:59], v[64:67], v[12:15]
    ds_read_b128 v[120:123], v128 offset:4096
    v_mfma_f32_16x16x32_bf16 v[16:19], v[56:59], v[72:75], v[16:19]
    ds_read_b128 v[96:99], v134 offset:2048
    v_mfma_f32_16x16x32_bf16 v[20:23], v[56:59], v[80:83], v[20:23]
    ds_read_b128 v[108:111], v131 offset:0
    v_mfma_f32_16x16x32_bf16 v[24:27], v[48:51], v[68:71], v[24:27]
    ds_read_b128 v[116:119], v131 offset:2048
    v_mfma_f32_16x16x32_bf16 v[28:31], v[48:51], v[76:79], v[28:31]
    ds_read_b128 v[124:127], v131 offset:4096
    v_mfma_f32_16x16x32_bf16 v[32:35], v[48:51], v[84:87], v[32:35]
    ds_read_b128 v[92:95], v134 offset:1024
    v_mfma_f32_16x16x32_bf16 v[36:39], v[56:59], v[68:71], v[36:39]
    ds_read_b128 v[100:103], v134 offset:3072
    v_mfma_f32_16x16x32_bf16 v[40:43], v[56:59], v[76:79], v[40:43]
    v_mfma_f32_16x16x32_bf16 v[44:47], v[56:59], v[84:87], v[44:47]
    v_mfma_f32_16x16x32_bf16 v[24:27], v[52:55], v[64:67], v[24:27]
    v_xor_b32 v68, s34, v68
    v_xor_b32 v69, s34, v69
    v_mfma_f32_16x16x32_bf16 v[28:31], v[52:55], v[72:75], v[28:31]
    v_xor_b32 v70, s34, v70
    v_xor_b32 v71, s34, v71
    v_mfma_f32_16x16x32_bf16 v[32:35], v[52:55], v[80:83], v[32:35]
    v_xor_b32 v76, s34, v76
    v_xor_b32 v77, s34, v77
    v_mfma_f32_16x16x32_bf16 v[36:39], v[60:63], v[64:67], v[36:39]
    v_xor_b32 v78, s34, v78
    v_xor_b32 v79, s34, v79
    v_mfma_f32_16x16x32_bf16 v[40:43], v[60:63], v[72:75], v[40:43]
    v_xor_b32 v84, s34, v84
    v_xor_b32 v85, s34, v85
    v_mfma_f32_16x16x32_bf16 v[44:47], v[60:63], v[80:83], v[44:47]
    v_xor_b32 v86, s34, v86
    v_xor_b32 v87, s34, v87
    v_mfma_f32_16x16x32_bf16 v[0:3], v[52:55], v[68:71], v[0:3]
    v_mfma_f32_16x16x32_bf16 v[4:7], v[52:55], v[76:79], v[4:7]
    v_mfma_f32_16x16x32_bf16 v[8:11], v[52:55], v[84:87], v[8:11]
    s_waitcnt lgkmcnt(0)
    s_barrier
    v_mfma_f32_16x16x32_bf16 v[12:15], v[60:63], v[68:71], v[12:15]
    v_mfma_f32_16x16x32_bf16 v[16:19], v[60:63], v[76:79], v[16:19]
    v_mfma_f32_16x16x32_bf16 v[20:23], v[60:63], v[84:87], v[20:23]
    v_mfma_f32_16x16x32_bf16 v[0:3], v[88:91], v[104:107], v[0:3]
    ds_read_b128 v[48:51], v134 offset:20480
    v_mfma_f32_16x16x32_bf16 v[4:7], v[88:91], v[112:115], v[4:7]
    ds_read_b128 v[64:67], v128 offset:20480
    v_mfma_f32_16x16x32_bf16 v[8:11], v[88:91], v[120:123], v[8:11]
    ds_read_b128 v[72:75], v128 offset:22528
    v_mfma_f32_16x16x32_bf16 v[12:15], v[96:99], v[104:107], v[12:15]
    ds_read_b128 v[80:83], v128 offset:24576
    v_mfma_f32_16x16x32_bf16 v[16:19], v[96:99], v[112:115], v[16:19]
    ds_read_b128 v[56:59], v134 offset:22528
    v_mfma_f32_16x16x32_bf16 v[20:23], v[96:99], v[120:123], v[20:23]
    ds_read_b128 v[68:71], v131 offset:20480
    v_mfma_f32_16x16x32_bf16 v[24:27], v[88:91], v[108:111], v[24:27]
    ds_read_b128 v[76:79], v131 offset:22528
    v_mfma_f32_16x16x32_bf16 v[28:31], v[88:91], v[116:119], v[28:31]
    ds_read_b128 v[84:87], v131 offset:24576
    v_mfma_f32_16x16x32_bf16 v[32:35], v[88:91], v[124:127], v[32:35]
    ds_read_b128 v[52:55], v134 offset:21504
    v_mfma_f32_16x16x32_bf16 v[36:39], v[96:99], v[108:111], v[36:39]
    ds_read_b128 v[60:63], v134 offset:23552
    v_mfma_f32_16x16x32_bf16 v[40:43], v[96:99], v[116:119], v[40:43]
    v_mfma_f32_16x16x32_bf16 v[44:47], v[96:99], v[124:127], v[44:47]
    v_mfma_f32_16x16x32_bf16 v[24:27], v[92:95], v[104:107], v[24:27]
    v_xor_b32 v108, s34, v108
    v_xor_b32 v109, s34, v109
    v_mfma_f32_16x16x32_bf16 v[28:31], v[92:95], v[112:115], v[28:31]
    v_xor_b32 v110, s34, v110
    v_xor_b32 v111, s34, v111
    v_mfma_f32_16x16x32_bf16 v[32:35], v[92:95], v[120:123], v[32:35]
    v_xor_b32 v116, s34, v116
    v_xor_b32 v117, s34, v117
    v_mfma_f32_16x16x32_bf16 v[36:39], v[100:103], v[104:107], v[36:39]
    v_xor_b32 v118, s34, v118
    v_xor_b32 v119, s34, v119
    v_mfma_f32_16x16x32_bf16 v[40:43], v[100:103], v[112:115], v[40:43]
    v_xor_b32 v124, s34, v124
    v_xor_b32 v125, s34, v125
    v_mfma_f32_16x16x32_bf16 v[44:47], v[100:103], v[120:123], v[44:47]
    v_xor_b32 v126, s34, v126
    v_xor_b32 v127, s34, v127
    v_mfma_f32_16x16x32_bf16 v[0:3], v[92:95], v[108:111], v[0:3]
    v_mfma_f32_16x16x32_bf16 v[4:7], v[92:95], v[116:119], v[4:7]
    v_mfma_f32_16x16x32_bf16 v[8:11], v[92:95], v[124:127], v[8:11]
    s_waitcnt lgkmcnt(0)
    s_barrier
    v_mfma_f32_16x16x32_bf16 v[12:15], v[100:103], v[108:111], v[12:15]
    v_mfma_f32_16x16x32_bf16 v[16:19], v[100:103], v[116:119], v[16:19]
    v_mfma_f32_16x16x32_bf16 v[20:23], v[100:103], v[124:127], v[20:23]
    v_mfma_f32_16x16x32_bf16 v[0:3], v[48:51], v[64:67], v[0:3]
    ds_read_b128 v[88:91], v134 offset:40960
    v_mfma_f32_16x16x32_bf16 v[4:7], v[48:51], v[72:75], v[4:7]
    ds_read_b128 v[104:107], v128 offset:40960
    v_mfma_f32_16x16x32_bf16 v[8:11], v[48:51], v[80:83], v[8:11]
    ds_read_b128 v[112:115], v128 offset:43008
    v_mfma_f32_16x16x32_bf16 v[12:15], v[56:59], v[64:67], v[12:15]
    ds_read_b128 v[120:123], v128 offset:45056
    v_mfma_f32_16x16x32_bf16 v[16:19], v[56:59], v[72:75], v[16:19]
    ds_read_b128 v[96:99], v134 offset:43008
    v_mfma_f32_16x16x32_bf16 v[20:23], v[56:59], v[80:83], v[20:23]
    ds_read_b128 v[108:111], v131 offset:40960
    v_mfma_f32_16x16x32_bf16 v[24:27], v[48:51], v[68:71], v[24:27]
    ds_read_b128 v[116:119], v131 offset:43008
    v_mfma_f32_16x16x32_bf16 v[28:31], v[48:51], v[76:79], v[28:31]
    ds_read_b128 v[124:127], v131 offset:45056
    v_mfma_f32_16x16x32_bf16 v[32:35], v[48:51], v[84:87], v[32:35]
    ds_read_b128 v[92:95], v134 offset:41984
    v_mfma_f32_16x16x32_bf16 v[36:39], v[56:59], v[68:71], v[36:39]
    ds_read_b128 v[100:103], v134 offset:44032
    v_mfma_f32_16x16x32_bf16 v[40:43], v[56:59], v[76:79], v[40:43]
    v_mfma_f32_16x16x32_bf16 v[44:47], v[56:59], v[84:87], v[44:47]
    v_mfma_f32_16x16x32_bf16 v[24:27], v[52:55], v[64:67], v[24:27]
    v_xor_b32 v68, s34, v68
    v_xor_b32 v69, s34, v69
    v_mfma_f32_16x16x32_bf16 v[28:31], v[52:55], v[72:75], v[28:31]
    v_xor_b32 v70, s34, v70
    v_xor_b32 v71, s34, v71
    v_mfma_f32_16x16x32_bf16 v[32:35], v[52:55], v[80:83], v[32:35]
    v_xor_b32 v76, s34, v76
    v_xor_b32 v77, s34, v77
    v_mfma_f32_16x16x32_bf16 v[36:39], v[60:63], v[64:67], v[36:39]
    v_xor_b32 v78, s34, v78
    v_xor_b32 v79, s34, v79
    v_mfma_f32_16x16x32_bf16 v[40:43], v[60:63], v[72:75], v[40:43]
    v_xor_b32 v84, s34, v84
    v_xor_b32 v85, s34, v85
    v_mfma_f32_16x16x32_bf16 v[44:47], v[60:63], v[80:83], v[44:47]
    v_xor_b32 v86, s34, v86
    v_xor_b32 v87, s34, v87
    v_mfma_f32_16x16x32_bf16 v[0:3], v[52:55], v[68:71], v[0:3]
    v_mfma_f32_16x16x32_bf16 v[4:7], v[52:55], v[76:79], v[4:7]
    v_mfma_f32_16x16x32_bf16 v[8:11], v[52:55], v[84:87], v[8:11]
    s_waitcnt lgkmcnt(0)
    s_barrier
    v_mfma_f32_16x16x32_bf16 v[12:15], v[60:63], v[68:71], v[12:15]
    v_mfma_f32_16x16x32_bf16 v[16:19], v[60:63], v[76:79], v[16:19]
    v_mfma_f32_16x16x32_bf16 v[20:23], v[60:63], v[84:87], v[20:23]
    v_mfma_f32_16x16x32_bf16 v[0:3], v[88:91], v[104:107], v[0:3]
    ds_read_b128 v[48:51], v135 offset:0
    v_mfma_f32_16x16x32_bf16 v[4:7], v[88:91], v[112:115], v[4:7]
    ds_read_b128 v[64:67], v129 offset:0
    v_mfma_f32_16x16x32_bf16 v[8:11], v[88:91], v[120:123], v[8:11]
    ds_read_b128 v[72:75], v129 offset:2048
    v_mfma_f32_16x16x32_bf16 v[12:15], v[96:99], v[104:107], v[12:15]
    ds_read_b128 v[80:83], v129 offset:4096
    v_mfma_f32_16x16x32_bf16 v[16:19], v[96:99], v[112:115], v[16:19]
    ds_read_b128 v[56:59], v135 offset:2048
    v_mfma_f32_16x16x32_bf16 v[20:23], v[96:99], v[120:123], v[20:23]
    ds_read_b128 v[68:71], v132 offset:0
    v_mfma_f32_16x16x32_bf16 v[24:27], v[88:91], v[108:111], v[24:27]
    ds_read_b128 v[76:79], v132 offset:2048
    v_mfma_f32_16x16x32_bf16 v[28:31], v[88:91], v[116:119], v[28:31]
    ds_read_b128 v[84:87], v132 offset:4096
    v_mfma_f32_16x16x32_bf16 v[32:35], v[88:91], v[124:127], v[32:35]
    ds_read_b128 v[52:55], v135 offset:1024
    v_mfma_f32_16x16x32_bf16 v[36:39], v[96:99], v[108:111], v[36:39]
    ds_read_b128 v[60:63], v135 offset:3072
    v_mfma_f32_16x16x32_bf16 v[40:43], v[96:99], v[116:119], v[40:43]
    v_mfma_f32_16x16x32_bf16 v[44:47], v[96:99], v[124:127], v[44:47]
    v_mfma_f32_16x16x32_bf16 v[24:27], v[92:95], v[104:107], v[24:27]
    v_xor_b32 v108, s34, v108
    v_xor_b32 v109, s34, v109
    v_mfma_f32_16x16x32_bf16 v[28:31], v[92:95], v[112:115], v[28:31]
    v_xor_b32 v110, s34, v110
    v_xor_b32 v111, s34, v111
    v_mfma_f32_16x16x32_bf16 v[32:35], v[92:95], v[120:123], v[32:35]
    v_xor_b32 v116, s34, v116
    v_xor_b32 v117, s34, v117
    v_mfma_f32_16x16x32_bf16 v[36:39], v[100:103], v[104:107], v[36:39]
    v_xor_b32 v118, s34, v118
    v_xor_b32 v119, s34, v119
    v_mfma_f32_16x16x32_bf16 v[40:43], v[100:103], v[112:115], v[40:43]
    v_xor_b32 v124, s34, v124
    v_xor_b32 v125, s34, v125
    v_mfma_f32_16x16x32_bf16 v[44:47], v[100:103], v[120:123], v[44:47]
    v_xor_b32 v126, s34, v126
    v_xor_b32 v127, s34, v127
    v_mfma_f32_16x16x32_bf16 v[0:3], v[92:95], v[108:111], v[0:3]
    v_mfma_f32_16x16x32_bf16 v[4:7], v[92:95], v[116:119], v[4:7]
    v_mfma_f32_16x16x32_bf16 v[8:11], v[92:95], v[124:127], v[8:11]
    s_waitcnt lgkmcnt(0)
    s_barrier
    v_mfma_f32_16x16x32_bf16 v[12:15], v[100:103], v[108:111], v[12:15]
    v_mfma_f32_16x16x32_bf16 v[16:19], v[100:103], v[116:119], v[16:19]
    v_mfma_f32_16x16x32_bf16 v[20:23], v[100:103], v[124:127], v[20:23]
    v_mfma_f32_16x16x32_bf16 v[0:3], v[48:51], v[64:67], v[0:3]
    ds_read_b128 v[88:91], v135 offset:20480
    v_mfma_f32_16x16x32_bf16 v[4:7], v[48:51], v[72:75], v[4:7]
    ds_read_b128 v[104:107], v129 offset:20480
    v_mfma_f32_16x16x32_bf16 v[8:11], v[48:51], v[80:83], v[8:11]
    ds_read_b128 v[112:115], v129 offset:22528
    v_mfma_f32_16x16x32_bf16 v[12:15], v[56:59], v[64:67], v[12:15]
    ds_read_b128 v[120:123], v129 offset:24576
    v_mfma_f32_16x16x32_bf16 v[16:19], v[56:59], v[72:75], v[16:19]
    ds_read_b128 v[96:99], v135 offset:22528
    v_mfma_f32_16x16x32_bf16 v[20:23], v[56:59], v[80:83], v[20:23]
    ds_read_b128 v[108:111], v132 offset:20480
    v_mfma_f32_16x16x32_bf16 v[24:27], v[48:51], v[68:71], v[24:27]
    ds_read_b128 v[116:119], v132 offset:22528
    v_mfma_f32_16x16x32_bf16 v[28:31], v[48:51], v[76:79], v[28:31]
    ds_read_b128 v[124:127], v132 offset:24576
    v_mfma_f32_16x16x32_bf16 v[32:35], v[48:51], v[84:87], v[32:35]
    ds_read_b128 v[92:95], v135 offset:21504
    v_mfma_f32_16x16x32_bf16 v[36:39], v[56:59], v[68:71], v[36:39]
    ds_read_b128 v[100:103], v135 offset:23552
    v_mfma_f32_16x16x32_bf16 v[40:43], v[56:59], v[76:79], v[40:43]
    v_mfma_f32_16x16x32_bf16 v[44:47], v[56:59], v[84:87], v[44:47]
    v_mfma_f32_16x16x32_bf16 v[24:27], v[52:55], v[64:67], v[24:27]
    v_xor_b32 v68, s34, v68
    v_xor_b32 v69, s34, v69
    v_mfma_f32_16x16x32_bf16 v[28:31], v[52:55], v[72:75], v[28:31]
    v_xor_b32 v70, s34, v70
    v_xor_b32 v71, s34, v71
    v_mfma_f32_16x16x32_bf16 v[32:35], v[52:55], v[80:83], v[32:35]
    v_xor_b32 v76, s34, v76
    v_xor_b32 v77, s34, v77
    v_mfma_f32_16x16x32_bf16 v[36:39], v[60:63], v[64:67], v[36:39]
    v_xor_b32 v78, s34, v78
    v_xor_b32 v79, s34, v79
    v_mfma_f32_16x16x32_bf16 v[40:43], v[60:63], v[72:75], v[40:43]
    v_xor_b32 v84, s34, v84
    v_xor_b32 v85, s34, v85
    v_mfma_f32_16x16x32_bf16 v[44:47], v[60:63], v[80:83], v[44:47]
    v_xor_b32 v86, s34, v86
    v_xor_b32 v87, s34, v87
    v_mfma_f32_16x16x32_bf16 v[0:3], v[52:55], v[68:71], v[0:3]
    v_mfma_f32_16x16x32_bf16 v[4:7], v[52:55], v[76:79], v[4:7]
    v_mfma_f32_16x16x32_bf16 v[8:11], v[52:55], v[84:87], v[8:11]
    s_waitcnt lgkmcnt(0)
    s_barrier
    v_mfma_f32_16x16x32_bf16 v[12:15], v[60:63], v[68:71], v[12:15]
    v_mfma_f32_16x16x32_bf16 v[16:19], v[60:63], v[76:79], v[16:19]
    v_mfma_f32_16x16x32_bf16 v[20:23], v[60:63], v[84:87], v[20:23]
    v_mfma_f32_16x16x32_bf16 v[0:3], v[88:91], v[104:107], v[0:3]
    ds_read_b128 v[48:51], v135 offset:40960
    v_mfma_f32_16x16x32_bf16 v[4:7], v[88:91], v[112:115], v[4:7]
    ds_read_b128 v[64:67], v129 offset:40960
    v_mfma_f32_16x16x32_bf16 v[8:11], v[88:91], v[120:123], v[8:11]
    ds_read_b128 v[72:75], v129 offset:43008
    v_mfma_f32_16x16x32_bf16 v[12:15], v[96:99], v[104:107], v[12:15]
    ds_read_b128 v[80:83], v129 offset:45056
    v_mfma_f32_16x16x32_bf16 v[16:19], v[96:99], v[112:115], v[16:19]
    ds_read_b128 v[56:59], v135 offset:43008
    v_mfma_f32_16x16x32_bf16 v[20:23], v[96:99], v[120:123], v[20:23]
    ds_read_b128 v[68:71], v132 offset:40960
    v_mfma_f32_16x16x32_bf16 v[24:27], v[88:91], v[108:111], v[24:27]
    ds_read_b128 v[76:79], v132 offset:43008
    v_mfma_f32_16x16x32_bf16 v[28:31], v[88:91], v[116:119], v[28:31]
    ds_read_b128 v[84:87], v132 offset:45056
    v_mfma_f32_16x16x32_bf16 v[32:35], v[88:91], v[124:127], v[32:35]
    ds_read_b128 v[52:55], v135 offset:41984
    v_mfma_f32_16x16x32_bf16 v[36:39], v[96:99], v[108:111], v[36:39]
    ds_read_b128 v[60:63], v135 offset:44032
    v_mfma_f32_16x16x32_bf16 v[40:43], v[96:99], v[116:119], v[40:43]
    v_mfma_f32_16x16x32_bf16 v[44:47], v[96:99], v[124:127], v[44:47]
    v_mfma_f32_16x16x32_bf16 v[24:27], v[92:95], v[104:107], v[24:27]
    v_xor_b32 v108, s34, v108
    v_xor_b32 v109, s34, v109
    v_mfma_f32_16x16x32_bf16 v[28:31], v[92:95], v[112:115], v[28:31]
    v_xor_b32 v110, s34, v110
    v_xor_b32 v111, s34, v111
    v_mfma_f32_16x16x32_bf16 v[32:35], v[92:95], v[120:123], v[32:35]
    v_xor_b32 v116, s34, v116
    v_xor_b32 v117, s34, v117
    v_mfma_f32_16x16x32_bf16 v[36:39], v[100:103], v[104:107], v[36:39]
    v_xor_b32 v118, s34, v118
    v_xor_b32 v119, s34, v119
    v_mfma_f32_16x16x32_bf16 v[40:43], v[100:103], v[112:115], v[40:43]
    v_xor_b32 v124, s34, v124
    v_xor_b32 v125, s34, v125
    v_mfma_f32_16x16x32_bf16 v[44:47], v[100:103], v[120:123], v[44:47]
    v_xor_b32 v126, s34, v126
    v_xor_b32 v127, s34, v127
    v_mfma_f32_16x16x32_bf16 v[0:3], v[92:95], v[108:111], v[0:3]
    v_mfma_f32_16x16x32_bf16 v[4:7], v[92:95], v[116:119], v[4:7]
    v_mfma_f32_16x16x32_bf16 v[8:11], v[92:95], v[124:127], v[8:11]
    s_waitcnt lgkmcnt(0)
    s_barrier
    v_mfma_f32_16x16x32_bf16 v[12:15], v[100:103], v[108:111], v[12:15]
    v_mfma_f32_16x16x32_bf16 v[16:19], v[100:103], v[116:119], v[16:19]
    v_mfma_f32_16x16x32_bf16 v[20:23], v[100:103], v[124:127], v[20:23]
    v_mfma_f32_16x16x32_bf16 v[0:3], v[48:51], v[64:67], v[0:3]
    ds_read_b128 v[88:91], v136 offset:0
    v_mfma_f32_16x16x32_bf16 v[4:7], v[48:51], v[72:75], v[4:7]
    ds_read_b128 v[104:107], v130 offset:0
    v_mfma_f32_16x16x32_bf16 v[8:11], v[48:51], v[80:83], v[8:11]
    ds_read_b128 v[112:115], v130 offset:2048
    v_mfma_f32_16x16x32_bf16 v[12:15], v[56:59], v[64:67], v[12:15]
    ds_read_b128 v[120:123], v130 offset:4096
    v_mfma_f32_16x16x32_bf16 v[16:19], v[56:59], v[72:75], v[16:19]
    ds_read_b128 v[96:99], v136 offset:2048
    v_mfma_f32_16x16x32_bf16 v[20:23], v[56:59], v[80:83], v[20:23]
    ds_read_b128 v[108:111], v133 offset:0
    v_mfma_f32_16x16x32_bf16 v[24:27], v[48:51], v[68:71], v[24:27]
    ds_read_b128 v[116:119], v133 offset:2048
    v_mfma_f32_16x16x32_bf16 v[28:31], v[48:51], v[76:79], v[28:31]
    ds_read_b128 v[124:127], v133 offset:4096
    v_mfma_f32_16x16x32_bf16 v[32:35], v[48:51], v[84:87], v[32:35]
    ds_read_b128 v[92:95], v136 offset:1024
    v_mfma_f32_16x16x32_bf16 v[36:39], v[56:59], v[68:71], v[36:39]
    ds_read_b128 v[100:103], v136 offset:3072
    v_mfma_f32_16x16x32_bf16 v[40:43], v[56:59], v[76:79], v[40:43]
    v_mfma_f32_16x16x32_bf16 v[44:47], v[56:59], v[84:87], v[44:47]
    v_mfma_f32_16x16x32_bf16 v[24:27], v[52:55], v[64:67], v[24:27]
    v_xor_b32 v68, s34, v68
    v_xor_b32 v69, s34, v69
    v_mfma_f32_16x16x32_bf16 v[28:31], v[52:55], v[72:75], v[28:31]
    v_xor_b32 v70, s34, v70
    v_xor_b32 v71, s34, v71
    v_mfma_f32_16x16x32_bf16 v[32:35], v[52:55], v[80:83], v[32:35]
    v_xor_b32 v76, s34, v76
    v_xor_b32 v77, s34, v77
    v_mfma_f32_16x16x32_bf16 v[36:39], v[60:63], v[64:67], v[36:39]
    v_xor_b32 v78, s34, v78
    v_xor_b32 v79, s34, v79
    v_mfma_f32_16x16x32_bf16 v[40:43], v[60:63], v[72:75], v[40:43]
    v_xor_b32 v84, s34, v84
    v_xor_b32 v85, s34, v85
    v_mfma_f32_16x16x32_bf16 v[44:47], v[60:63], v[80:83], v[44:47]
    v_xor_b32 v86, s34, v86
    v_xor_b32 v87, s34, v87
    v_mfma_f32_16x16x32_bf16 v[0:3], v[52:55], v[68:71], v[0:3]
    v_mfma_f32_16x16x32_bf16 v[4:7], v[52:55], v[76:79], v[4:7]
    v_mfma_f32_16x16x32_bf16 v[8:11], v[52:55], v[84:87], v[8:11]
    s_waitcnt lgkmcnt(0)
    s_barrier
    v_mfma_f32_16x16x32_bf16 v[12:15], v[60:63], v[68:71], v[12:15]
    v_mfma_f32_16x16x32_bf16 v[16:19], v[60:63], v[76:79], v[16:19]
    v_mfma_f32_16x16x32_bf16 v[20:23], v[60:63], v[84:87], v[20:23]
    v_mfma_f32_16x16x32_bf16 v[0:3], v[88:91], v[104:107], v[0:3]
    ds_read_b128 v[48:51], v134 offset:0
    v_mfma_f32_16x16x32_bf16 v[4:7], v[88:91], v[112:115], v[4:7]
    ds_read_b128 v[64:67], v128 offset:0
    v_mfma_f32_16x16x32_bf16 v[8:11], v[88:91], v[120:123], v[8:11]
    ds_read_b128 v[72:75], v128 offset:2048
    v_mfma_f32_16x16x32_bf16 v[12:15], v[96:99], v[104:107], v[12:15]
    ds_read_b128 v[80:83], v128 offset:4096
    v_mfma_f32_16x16x32_bf16 v[16:19], v[96:99], v[112:115], v[16:19]
    ds_read_b128 v[56:59], v134 offset:2048
    v_mfma_f32_16x16x32_bf16 v[20:23], v[96:99], v[120:123], v[20:23]
    ds_read_b128 v[68:71], v131 offset:0
    v_mfma_f32_16x16x32_bf16 v[24:27], v[88:91], v[108:111], v[24:27]
    ds_read_b128 v[76:79], v131 offset:2048
    v_mfma_f32_16x16x32_bf16 v[28:31], v[88:91], v[116:119], v[28:31]
    ds_read_b128 v[84:87], v131 offset:4096
    v_mfma_f32_16x16x32_bf16 v[32:35], v[88:91], v[124:127], v[32:35]
    ds_read_b128 v[52:55], v134 offset:1024
    v_mfma_f32_16x16x32_bf16 v[36:39], v[96:99], v[108:111], v[36:39]
    ds_read_b128 v[60:63], v134 offset:3072
    v_mfma_f32_16x16x32_bf16 v[40:43], v[96:99], v[116:119], v[40:43]
    v_mfma_f32_16x16x32_bf16 v[44:47], v[96:99], v[124:127], v[44:47]
    v_mfma_f32_16x16x32_bf16 v[24:27], v[92:95], v[104:107], v[24:27]
    v_xor_b32 v108, s34, v108
    v_xor_b32 v109, s34, v109
    v_mfma_f32_16x16x32_bf16 v[28:31], v[92:95], v[112:115], v[28:31]
    v_xor_b32 v110, s34, v110
    v_xor_b32 v111, s34, v111
    v_mfma_f32_16x16x32_bf16 v[32:35], v[92:95], v[120:123], v[32:35]
    v_xor_b32 v116, s34, v116
    v_xor_b32 v117, s34, v117
    v_mfma_f32_16x16x32_bf16 v[36:39], v[100:103], v[104:107], v[36:39]
    v_xor_b32 v118, s34, v118
    v_xor_b32 v119, s34, v119
    v_mfma_f32_16x16x32_bf16 v[40:43], v[100:103], v[112:115], v[40:43]
    v_xor_b32 v124, s34, v124
    v_xor_b32 v125, s34, v125
    v_mfma_f32_16x16x32_bf16 v[44:47], v[100:103], v[120:123], v[44:47]
    v_xor_b32 v126, s34, v126
    v_xor_b32 v127, s34, v127
    v_mfma_f32_16x16x32_bf16 v[0:3], v[92:95], v[108:111], v[0:3]
    v_mfma_f32_16x16x32_bf16 v[4:7], v[92:95], v[116:119], v[4:7]
    v_mfma_f32_16x16x32_bf16 v[8:11], v[92:95], v[124:127], v[8:11]
    s_waitcnt lgkmcnt(0)
    s_barrier
    v_mfma_f32_16x16x32_bf16 v[12:15], v[100:103], v[108:111], v[12:15]
    v_mfma_f32_16x16x32_bf16 v[16:19], v[100:103], v[116:119], v[16:19]
    v_mfma_f32_16x16x32_bf16 v[20:23], v[100:103], v[124:127], v[20:23]
    v_mfma_f32_16x16x32_bf16 v[0:3], v[48:51], v[64:67], v[0:3]
    ds_read_b128 v[88:91], v134 offset:20480
    v_mfma_f32_16x16x32_bf16 v[4:7], v[48:51], v[72:75], v[4:7]
    ds_read_b128 v[104:107], v128 offset:20480
    v_mfma_f32_16x16x32_bf16 v[8:11], v[48:51], v[80:83], v[8:11]
    ds_read_b128 v[112:115], v128 offset:22528
    v_mfma_f32_16x16x32_bf16 v[12:15], v[56:59], v[64:67], v[12:15]
    ds_read_b128 v[120:123], v128 offset:24576
    v_mfma_f32_16x16x32_bf16 v[16:19], v[56:59], v[72:75], v[16:19]
    ds_read_b128 v[96:99], v134 offset:22528
    v_mfma_f32_16x16x32_bf16 v[20:23], v[56:59], v[80:83], v[20:23]
    ds_read_b128 v[108:111], v131 offset:20480
    v_mfma_f32_16x16x32_bf16 v[24:27], v[48:51], v[68:71], v[24:27]
    ds_read_b128 v[116:119], v131 offset:22528
    v_mfma_f32_16x16x32_bf16 v[28:31], v[48:51], v[76:79], v[28:31]
    ds_read_b128 v[124:127], v131 offset:24576
    v_mfma_f32_16x16x32_bf16 v[32:35], v[48:51], v[84:87], v[32:35]
    ds_read_b128 v[92:95], v134 offset:21504
    v_mfma_f32_16x16x32_bf16 v[36:39], v[56:59], v[68:71], v[36:39]
    ds_read_b128 v[100:103], v134 offset:23552
    v_mfma_f32_16x16x32_bf16 v[40:43], v[56:59], v[76:79], v[40:43]
    v_mfma_f32_16x16x32_bf16 v[44:47], v[56:59], v[84:87], v[44:47]
    v_mfma_f32_16x16x32_bf16 v[24:27], v[52:55], v[64:67], v[24:27]
    v_xor_b32 v68, s34, v68
    v_xor_b32 v69, s34, v69
    v_mfma_f32_16x16x32_bf16 v[28:31], v[52:55], v[72:75], v[28:31]
    v_xor_b32 v70, s34, v70
    v_xor_b32 v71, s34, v71
    v_mfma_f32_16x16x32_bf16 v[32:35], v[52:55], v[80:83], v[32:35]
    v_xor_b32 v76, s34, v76
    v_xor_b32 v77, s34, v77
    v_mfma_f32_16x16x32_bf16 v[36:39], v[60:63], v[64:67], v[36:39]
    v_xor_b32 v78, s34, v78
    v_xor_b32 v79, s34, v79
    v_mfma_f32_16x16x32_bf16 v[40:43], v[60:63], v[72:75], v[40:43]
    v_xor_b32 v84, s34, v84
    v_xor_b32 v85, s34, v85
    v_mfma_f32_16x16x32_bf16 v[44:47], v[60:63], v[80:83], v[44:47]
    v_xor_b32 v86, s34, v86
    v_xor_b32 v87, s34, v87
    v_mfma_f32_16x16x32_bf16 v[0:3], v[52:55], v[68:71], v[0:3]
    v_mfma_f32_16x16x32_bf16 v[4:7], v[52:55], v[76:79], v[4:7]
    v_mfma_f32_16x16x32_bf16 v[8:11], v[52:55], v[84:87], v[8:11]
    s_waitcnt lgkmcnt(0)
    v_mfma_f32_16x16x32_bf16 v[12:15], v[60:63], v[68:71], v[12:15]
    v_mfma_f32_16x16x32_bf16 v[16:19], v[60:63], v[76:79], v[16:19]
    v_mfma_f32_16x16x32_bf16 v[20:23], v[60:63], v[84:87], v[20:23]
    v_mfma_f32_16x16x32_bf16 v[0:3], v[88:91], v[104:107], v[0:3]
    v_mfma_f32_16x16x32_bf16 v[4:7], v[88:91], v[112:115], v[4:7]
    v_mfma_f32_16x16x32_bf16 v[8:11], v[88:91], v[120:123], v[8:11]
    v_mfma_f32_16x16x32_bf16 v[12:15], v[96:99], v[104:107], v[12:15]
    v_mfma_f32_16x16x32_bf16 v[16:19], v[96:99], v[112:115], v[16:19]
    v_mfma_f32_16x16x32_bf16 v[20:23], v[96:99], v[120:123], v[20:23]
    v_mfma_f32_16x16x32_bf16 v[24:27], v[88:91], v[108:111], v[24:27]
    v_mfma_f32_16x16x32_bf16 v[28:31], v[88:91], v[116:119], v[28:31]
    v_mfma_f32_16x16x32_bf16 v[32:35], v[88:91], v[124:127], v[32:35]
    v_mfma_f32_16x16x32_bf16 v[36:39], v[96:99], v[108:111], v[36:39]
    v_mfma_f32_16x16x32_bf16 v[40:43], v[96:99], v[116:119], v[40:43]
    v_mfma_f32_16x16x32_bf16 v[44:47], v[96:99], v[124:127], v[44:47]
    v_mfma_f32_16x16x32_bf16 v[24:27], v[92:95], v[104:107], v[24:27]
    v_xor_b32 v108, s34, v108
    v_xor_b32 v109, s34, v109
    v_mfma_f32_16x16x32_bf16 v[28:31], v[92:95], v[112:115], v[28:31]
    v_xor_b32 v110, s34, v110
    v_xor_b32 v111, s34, v111
    v_mfma_f32_16x16x32_bf16 v[32:35], v[92:95], v[120:123], v[32:35]
    v_xor_b32 v116, s34, v116
    v_xor_b32 v117, s34, v117
    v_mfma_f32_16x16x32_bf16 v[36:39], v[100:103], v[104:107], v[36:39]
    v_xor_b32 v118, s34, v118
    v_xor_b32 v119, s34, v119
    v_mfma_f32_16x16x32_bf16 v[40:43], v[100:103], v[112:115], v[40:43]
    v_xor_b32 v124, s34, v124
    v_xor_b32 v125, s34, v125
    v_mfma_f32_16x16x32_bf16 v[44:47], v[100:103], v[120:123], v[44:47]
    v_xor_b32 v126, s34, v126
    v_xor_b32 v127, s34, v127
    v_mfma_f32_16x16x32_bf16 v[0:3], v[92:95], v[108:111], v[0:3]
    v_mfma_f32_16x16x32_bf16 v[4:7], v[92:95], v[116:119], v[4:7]
    v_mfma_f32_16x16x32_bf16 v[8:11], v[92:95], v[124:127], v[8:11]
    v_mfma_f32_16x16x32_bf16 v[12:15], v[100:103], v[108:111], v[12:15]
    v_mfma_f32_16x16x32_bf16 v[16:19], v[100:103], v[116:119], v[16:19]
    v_mfma_f32_16x16x32_bf16 v[20:23], v[100:103], v[124:127], v[20:23]
    s_nop 7
    s_nop 7
    v_cvt_pk_bf16_f32 v48, v0, v1
    v_cvt_pk_bf16_f32 v49, v2, v3
    v_cvt_pk_bf16_f32 v50, v12, v13
    v_cvt_pk_bf16_f32 v51, v14, v15
    v_cvt_pk_bf16_f32 v52, v24, v25
    v_cvt_pk_bf16_f32 v53, v26, v27
    v_cvt_pk_bf16_f32 v54, v36, v37
    v_cvt_pk_bf16_f32 v55, v38, v39
    v_mov_b32 v56, v48
    v_mov_b32 v57, v49
    v_mov_b32 v58, v50
    v_mov_b32 v59, v51
    s_add_u32 s35, s33, 0
    v_mov_b32_dpp v56, v52 row_ror:8 row_mask:0xf bank_mask:0x3
    v_mov_b32_dpp v57, v53 row_ror:8 row_mask:0xf bank_mask:0x3
    v_mov_b32_dpp v58, v54 row_ror:8 row_mask:0xf bank_mask:0x3
    v_mov_b32_dpp v59, v55 row_ror:8 row_mask:0xf bank_mask:0x3
    v_mov_b32_dpp v48, v52 row_ror:8 row_mask:0xf bank_mask:0xc
    v_mov_b32_dpp v49, v53 row_ror:8 row_mask:0xf bank_mask:0xc
    v_mov_b32_dpp v50, v54 row_ror:8 row_mask:0xf bank_mask:0xc
    v_mov_b32_dpp v51, v55 row_ror:8 row_mask:0xf bank_mask:0xc
    buffer_store_dwordx4 v[48:51], v142, s[16:19], s35 offen sc1
    buffer_store_dwordx4 v[56:59], v143, s[16:19], s35 offen sc1
    v_cvt_pk_bf16_f32 v60, v4, v5
    v_cvt_pk_bf16_f32 v61, v6, v7
    v_cvt_pk_bf16_f32 v62, v16, v17
    v_cvt_pk_bf16_f32 v63, v18, v19
    v_cvt_pk_bf16_f32 v64, v28, v29
    v_cvt_pk_bf16_f32 v65, v30, v31
    v_cvt_pk_bf16_f32 v66, v40, v41
    v_cvt_pk_bf16_f32 v67, v42, v43
    v_mov_b32 v68, v60
    v_mov_b32 v69, v61
    v_mov_b32 v70, v62
    v_mov_b32 v71, v63
    s_add_u32 s35, s33, 593920
    v_mov_b32_dpp v68, v64 row_ror:8 row_mask:0xf bank_mask:0x3
    v_mov_b32_dpp v69, v65 row_ror:8 row_mask:0xf bank_mask:0x3
    v_mov_b32_dpp v70, v66 row_ror:8 row_mask:0xf bank_mask:0x3
    v_mov_b32_dpp v71, v67 row_ror:8 row_mask:0xf bank_mask:0x3
    v_mov_b32_dpp v60, v64 row_ror:8 row_mask:0xf bank_mask:0xc
    v_mov_b32_dpp v61, v65 row_ror:8 row_mask:0xf bank_mask:0xc
    v_mov_b32_dpp v62, v66 row_ror:8 row_mask:0xf bank_mask:0xc
    v_mov_b32_dpp v63, v67 row_ror:8 row_mask:0xf bank_mask:0xc
    buffer_store_dwordx4 v[60:63], v142, s[16:19], s35 offen sc1
    buffer_store_dwordx4 v[68:71], v143, s[16:19], s35 offen sc1
    v_cvt_pk_bf16_f32 v72, v8, v9
    v_cvt_pk_bf16_f32 v73, v10, v11
    v_cvt_pk_bf16_f32 v74, v20, v21
    v_cvt_pk_bf16_f32 v75, v22, v23
    v_cvt_pk_bf16_f32 v76, v32, v33
    v_cvt_pk_bf16_f32 v77, v34, v35
    v_cvt_pk_bf16_f32 v78, v44, v45
    v_cvt_pk_bf16_f32 v79, v46, v47
    v_mov_b32 v80, v72
    v_mov_b32 v81, v73
    v_mov_b32 v82, v74
    v_mov_b32 v83, v75
    s_add_u32 s35, s33, 1187840
    v_mov_b32_dpp v80, v76 row_ror:8 row_mask:0xf bank_mask:0x3
    v_mov_b32_dpp v81, v77 row_ror:8 row_mask:0xf bank_mask:0x3
    v_mov_b32_dpp v82, v78 row_ror:8 row_mask:0xf bank_mask:0x3
    v_mov_b32_dpp v83, v79 row_ror:8 row_mask:0xf bank_mask:0x3
    v_mov_b32_dpp v72, v76 row_ror:8 row_mask:0xf bank_mask:0xc
    v_mov_b32_dpp v73, v77 row_ror:8 row_mask:0xf bank_mask:0xc
    v_mov_b32_dpp v74, v78 row_ror:8 row_mask:0xf bank_mask:0xc
    v_mov_b32_dpp v75, v79 row_ror:8 row_mask:0xf bank_mask:0xc
    buffer_store_dwordx4 v[72:75], v142, s[16:19], s35 offen sc1
    buffer_store_dwordx4 v[80:83], v143, s[16:19], s35 offen sc1
    s_endpgm
L_gemm2_kernel_loader:
    s_sub_u32 s20, s20, 4
    v_and_b32 v1, 63, v0
    v_lshrrev_b32 v4, 3, v1
    v_and_b32 v5, 7, v1
    v_xor_b32 v5, v5, v4
    v_lshlrev_b32 v5, 4, v5
    v_lshl_add_u32 v2, v4, 11, v5
    v_lshlrev_b32 v3, 4, v1
    s_add_u32 s24, s20, 0
    s_lshl_b32 s40, s24, 10
    s_lshl_b32 s43, s24, 14
    s_add_u32 s24, s20, 4
    s_lshl_b32 s41, s24, 10
    s_lshl_b32 s44, s24, 14
    s_add_u32 s24, s20, 8
    s_lshl_b32 s42, s24, 10
    s_lshl_b32 s45, s24, 14
    s_mul_i32 s46, s20, 2048
    s_add_u32 s47, s46, 12288
    s_add_u32 m0, s40, 0
    s_add_u32 s24, s43, 0
    buffer_load_dwordx4 v2, s[8:11], s24 offen lds
    s_add_u32 m0, s41, 0
    s_add_u32 s24, s44, 0
    buffer_load_dwordx4 v2, s[8:11], s24 offen lds
    s_add_u32 m0, s42, 0
    s_add_u32 s24, s45, 0
    buffer_load_dwordx4 v2, s[8:11], s24 offen lds
    s_add_u32 m0, s47, 0
    s_add_u32 s24, s46, 0
    buffer_load_dwordx4 v3, s[12:15], s24 offen offset:0 lds
    buffer_load_dwordx4 v3, s[12:15], s24 offen offset:1024 lds
    s_add_u32 m0, s40, 20480
    s_add_u32 s24, s43, 128
    buffer_load_dwordx4 v2, s[8:11], s24 offen lds
    s_add_u32 m0, s41, 20480
    s_add_u32 s24, s44, 128
    buffer_load_dwordx4 v2, s[8:11], s24 offen lds
    s_add_u32 m0, s42, 20480
    s_add_u32 s24, s45, 128
    buffer_load_dwordx4 v2, s[8:11], s24 offen lds
    s_add_u32 m0, s47, 20480
    s_add_u32 s24, s46, 32768
    buffer_load_dwordx4 v3, s[12:15], s24 offen offset:0 lds
    buffer_load_dwordx4 v3, s[12:15], s24 offen offset:1024 lds
    s_waitcnt vmcnt(5)
    s_barrier
    s_add_u32 m0, s40, 40960
    s_add_u32 s24, s43, 256
    buffer_load_dwordx4 v2, s[8:11], s24 offen lds
    s_add_u32 m0, s41, 40960
    s_add_u32 s24, s44, 256
    buffer_load_dwordx4 v2, s[8:11], s24 offen lds
    s_add_u32 m0, s42, 40960
    s_add_u32 s24, s45, 256
    buffer_load_dwordx4 v2, s[8:11], s24 offen lds
    s_add_u32 m0, s47, 40960
    s_add_u32 s24, s46, 65536
    buffer_load_dwordx4 v3, s[12:15], s24 offen offset:0 lds
    buffer_load_dwordx4 v3, s[12:15], s24 offen offset:1024 lds
    s_waitcnt vmcnt(5)
    s_barrier
    s_add_u32 m0, s40, 61440
    s_add_u32 s24, s43, 384
    buffer_load_dwordx4 v2, s[8:11], s24 offen lds
    s_add_u32 m0, s41, 61440
    s_add_u32 s24, s44, 384
    buffer_load_dwordx4 v2, s[8:11], s24 offen lds
    s_add_u32 m0, s42, 61440
    s_add_u32 s24, s45, 384
    buffer_load_dwordx4 v2, s[8:11], s24 offen lds
    s_add_u32 m0, s47, 61440
    s_add_u32 s24, s46, 98304
    buffer_load_dwordx4 v3, s[12:15], s24 offen offset:0 lds
    buffer_load_dwordx4 v3, s[12:15], s24 offen offset:1024 lds
    s_add_u32 m0, s40, 81920
    s_add_u32 s24, s43, 512
    buffer_load_dwordx4 v2, s[8:11], s24 offen lds
    s_add_u32 m0, s41, 81920
    s_add_u32 s24, s44, 512
    buffer_load_dwordx4 v2, s[8:11], s24 offen lds
    s_add_u32 m0, s42, 81920
    s_add_u32 s24, s45, 512
    buffer_load_dwordx4 v2, s[8:11], s24 offen lds
    s_add_u32 m0, s47, 81920
    s_add_u32 s24, s46, 131072
    buffer_load_dwordx4 v3, s[12:15], s24 offen offset:0 lds
    buffer_load_dwordx4 v3, s[12:15], s24 offen offset:1024 lds
    s_waitcnt vmcnt(10)
    s_barrier
    s_add_u32 m0, s40, 102400
    s_add_u32 s24, s43, 640
    buffer_load_dwordx4 v2, s[8:11], s24 offen lds
    s_add_u32 m0, s41, 102400
    s_add_u32 s24, s44, 640
    buffer_load_dwordx4 v2, s[8:11], s24 offen lds
    s_add_u32 m0, s42, 102400
    s_add_u32 s24, s45, 640
    buffer_load_dwordx4 v2, s[8:11], s24 offen lds
    s_add_u32 m0, s47, 102400
    s_add_u32 s24, s46, 163840
    buffer_load_dwordx4 v3, s[12:15], s24 offen offset:0 lds
    buffer_load_dwordx4 v3, s[12:15], s24 offen offset:1024 lds
    s_add_u32 m0, s40, 122880
    s_add_u32 s24, s43, 768
    buffer_load_dwordx4 v2, s[8:11], s24 offen lds
    s_add_u32 m0, s41, 122880
    s_add_u32 s24, s44, 768
    buffer_load_dwordx4 v2, s[8:11], s24 offen lds
    s_add_u32 m0, s42, 122880
    s_add_u32 s24, s45, 768
    buffer_load_dwordx4 v2, s[8:11], s24 offen lds
    s_add_u32 m0, s47, 122880
    s_add_u32 s24, s46, 196608
    buffer_load_dwordx4 v3, s[12:15], s24 offen offset:0 lds
    buffer_load_dwordx4 v3, s[12:15], s24 offen offset:1024 lds
    s_waitcnt vmcnt(15)
    s_barrier
    s_add_u32 m0, s40, 0
    s_add_u32 s24, s43, 896
    buffer_load_dwordx4 v2, s[8:11], s24 offen lds
    s_add_u32 m0, s41, 0
    s_add_u32 s24, s44, 896
    buffer_load_dwordx4 v2, s[8:11], s24 offen lds
    s_add_u32 m0, s42, 0
    s_add_u32 s24, s45, 896
    buffer_load_dwordx4 v2, s[8:11], s24 offen lds
    s_add_u32 m0, s47, 0
    s_add_u32 s24, s46, 229376
    buffer_load_dwordx4 v3, s[12:15], s24 offen offset:0 lds
    buffer_load_dwordx4 v3, s[12:15], s24 offen offset:1024 lds
    s_add_u32 m0, s40, 20480
    s_add_u32 s24, s43, 1024
    buffer_load_dwordx4 v2, s[8:11], s24 offen lds
    s_add_u32 m0, s41, 20480
    s_add_u32 s24, s44, 1024
    buffer_load_dwordx4 v2, s[8:11], s24 offen lds
    s_add_u32 m0, s42, 20480
    s_add_u32 s24, s45, 1024
    buffer_load_dwordx4 v2, s[8:11], s24 offen lds
    s_add_u32 m0, s47, 20480
    s_add_u32 s24, s46, 262144
    buffer_load_dwordx4 v3, s[12:15], s24 offen offset:0 lds
    buffer_load_dwordx4 v3, s[12:15], s24 offen offset:1024 lds
    s_waitcnt vmcnt(20)
    s_barrier
    s_add_u32 m0, s40, 40960
    s_add_u32 s24, s43, 1152
    buffer_load_dwordx4 v2, s[8:11], s24 offen lds
    s_add_u32 m0, s41, 40960
    s_add_u32 s24, s44, 1152
    buffer_load_dwordx4 v2, s[8:11], s24 offen lds
    s_add_u32 m0, s42, 40960
    s_add_u32 s24, s45, 1152
    buffer_load_dwordx4 v2, s[8:11], s24 offen lds
    s_add_u32 m0, s47, 40960
    s_add_u32 s24, s46, 294912
    buffer_load_dwordx4 v3, s[12:15], s24 offen offset:0 lds
    buffer_load_dwordx4 v3, s[12:15], s24 offen offset:1024 lds
    s_add_u32 m0, s40, 61440
    s_add_u32 s24, s43, 1280
    buffer_load_dwordx4 v2, s[8:11], s24 offen lds
    s_add_u32 m0, s41, 61440
    s_add_u32 s24, s44, 1280
    buffer_load_dwordx4 v2, s[8:11], s24 offen lds
    s_add_u32 m0, s42, 61440
    s_add_u32 s24, s45, 1280
    buffer_load_dwordx4 v2, s[8:11], s24 offen lds
    s_add_u32 m0, s47, 61440
    s_add_u32 s24, s46, 327680
    buffer_load_dwordx4 v3, s[12:15], s24 offen offset:0 lds
    buffer_load_dwordx4 v3, s[12:15], s24 offen offset:1024 lds
    s_waitcnt vmcnt(25)
    s_barrier
    s_add_u32 m0, s40, 81920
    s_add_u32 s24, s43, 1408
    buffer_load_dwordx4 v2, s[8:11], s24 offen lds
    s_add_u32 m0, s41, 81920
    s_add_u32 s24, s44, 1408
    buffer_load_dwordx4 v2, s[8:11], s24 offen lds
    s_add_u32 m0, s42, 81920
    s_add_u32 s24, s45, 1408
    buffer_load_dwordx4 v2, s[8:11], s24 offen lds
    s_add_u32 m0, s47, 81920
    s_add_u32 s24, s46, 360448
    buffer_load_dwordx4 v3, s[12:15], s24 offen offset:0 lds
    buffer_load_dwordx4 v3, s[12:15], s24 offen offset:1024 lds
    s_waitcnt vmcnt(25)
    s_barrier
    s_add_u32 m0, s40, 102400
    s_add_u32 s24, s43, 1536
    buffer_load_dwordx4 v2, s[8:11], s24 offen lds
    s_add_u32 m0, s41, 102400
    s_add_u32 s24, s44, 1536
    buffer_load_dwordx4 v2, s[8:11], s24 offen lds
    s_add_u32 m0, s42, 102400
    s_add_u32 s24, s45, 1536
    buffer_load_dwordx4 v2, s[8:11], s24 offen lds
    s_add_u32 m0, s47, 102400
    s_add_u32 s24, s46, 393216
    buffer_load_dwordx4 v3, s[12:15], s24 offen offset:0 lds
    buffer_load_dwordx4 v3, s[12:15], s24 offen offset:1024 lds
    s_waitcnt vmcnt(25)
    s_barrier
    s_add_u32 m0, s40, 122880
    s_add_u32 s24, s43, 1664
    buffer_load_dwordx4 v2, s[8:11], s24 offen lds
    s_add_u32 m0, s41, 122880
    s_add_u32 s24, s44, 1664
    buffer_load_dwordx4 v2, s[8:11], s24 offen lds
    s_add_u32 m0, s42, 122880
    s_add_u32 s24, s45, 1664
    buffer_load_dwordx4 v2, s[8:11], s24 offen lds
    s_add_u32 m0, s47, 122880
    s_add_u32 s24, s46, 425984
    buffer_load_dwordx4 v3, s[12:15], s24 offen offset:0 lds
    buffer_load_dwordx4 v3, s[12:15], s24 offen offset:1024 lds
    s_waitcnt vmcnt(25)
    s_barrier
    s_add_u32 m0, s40, 0
    s_add_u32 s24, s43, 1792
    buffer_load_dwordx4 v2, s[8:11], s24 offen lds
    s_add_u32 m0, s41, 0
    s_add_u32 s24, s44, 1792
    buffer_load_dwordx4 v2, s[8:11], s24 offen lds
    s_add_u32 m0, s42, 0
    s_add_u32 s24, s45, 1792
    buffer_load_dwordx4 v2, s[8:11], s24 offen lds
    s_add_u32 m0, s47, 0
    s_add_u32 s24, s46, 458752
    buffer_load_dwordx4 v3, s[12:15], s24 offen offset:0 lds
    buffer_load_dwordx4 v3, s[12:15], s24 offen offset:1024 lds
    s_waitcnt vmcnt(25)
    s_barrier
    s_add_u32 m0, s40, 20480
    s_add_u32 s24, s43, 1920
    buffer_load_dwordx4 v2, s[8:11], s24 offen lds
    s_add_u32 m0, s41, 20480
    s_add_u32 s24, s44, 1920
    buffer_load_dwordx4 v2, s[8:11], s24 offen lds
    s_add_u32 m0, s42, 20480
    s_add_u32 s24, s45, 1920
    buffer_load_dwordx4 v2, s[8:11], s24 offen lds
    s_add_u32 m0, s47, 20480
    s_add_u32 s24, s46, 491520
    buffer_load_dwordx4 v3, s[12:15], s24 offen offset:0 lds
    buffer_load_dwordx4 v3, s[12:15], s24 offen offset:1024 lds
    s_waitcnt vmcnt(25)
    s_barrier
    s_waitcnt vmcnt(20)
    s_barrier
    s_waitcnt vmcnt(15)
    s_barrier
    s_waitcnt vmcnt(10)
    s_barrier
    s_waitcnt vmcnt(5)
    s_barrier
    s_waitcnt vmcnt(0)
    s_barrier
L_gemm2_kernel_done:
    s_endpgm
.globl joint_kernel
.p2align 8
.type joint_kernel,@function
joint_kernel:
    s_cmp_ge_u32 s2, 256
    s_cbranch_scc1 L_joint_kernel_done
    s_load_dwordx2 s[6:7], s[0:1], 72
    s_load_dwordx2 s[4:5], s[0:1], 56
    v_readfirstlane_b32 s20, v0
    s_lshr_b32 s20, s20, 6
    s_and_b32 s21, s20, 3
    s_and_b32 s23, s2, 7
    s_lshl_b32 s23, s23, 5
    s_lshr_b32 s22, s2, 3
    s_add_u32 s23, s23, s22
    s_cmp_ge_u32 s23, 250
    s_cbranch_scc1 L_joint_kernel_done
    s_cmp_ge_u32 s23, 125
    s_cselect_b32 s24, 1, 0
    s_mul_i32 s25, s24, 125
    s_sub_u32 s25, s23, s25
    s_lshl_b32 s26, s25, 1
    s_add_u32 s26, s26, 0
    s_mul_i32 s27, s26, 171
    s_lshr_b32 s28, s27, 9
    s_mul_i32 s27, s28, 3
    s_sub_u32 s30, s26, s27
    s_lshl_b32 s26, s25, 1
    s_add_u32 s26, s26, 1
    s_mul_i32 s27, s26, 171
    s_lshr_b32 s29, s27, 9
    s_mul_i32 s27, s29, 3
    s_sub_u32 s31, s26, s27
    v_and_b32 v1, 63, v0
    v_lshlrev_b32 v5, 4, v1
    s_waitcnt lgkmcnt(0)
    s_add_u32 s12, s6, 85499904
    s_addc_u32 s13, s7, 0
    s_mov_b32 s14, 294912
    s_mov_b32 s15, 0x00020000
    s_mul_i32 s36, s24, 4000
    s_lshl_b32 s37, s25, 5
    s_add_u32 s36, s36, s37
    s_lshl_b32 s36, s36, 12
    s_add_u32 s16, s4, s36
    s_addc_u32 s17, s5, 0
    s_mov_b32 s18, 131072
    s_mov_b32 s19, 0x00020000
    s_lshl_b32 s38, s21, 15
    s_cmp_ge_u32 s20, 4
    s_cbranch_scc1 L_joint_kernel_helper
    s_lshr_b32 s36, s2, 3
    s_and_b32 s36, s36, 31
    s_lshl_b32 s36, s36, 13
    s_add_u32 s36, s36, 32768
    v_lshlrev_b32 v6, 7, v1
    s_cmp_lg_u32 s20, 0
    s_cbranch_scc1 L_joint_kernel_nopf
    buffer_load_dword v7, v6, s[12:15], s36 offen
L_joint_kernel_nopf:
    v_lshrrev_b32 v2, 2, v1
    v_lshlrev_b32 v2, 6, v2
    v_lshrrev_b32 v3, 5, v1
    v_lshlrev_b32 v3, 1, v3
    v_and_b32 v4, 3, v1
    v_xor_b32 v3, v3, v4
    v_lshl_add_u32 v2, v3, 4, v2
    s_lshl_b32 s34, s21, 14
    s_lshl_b32 s35, s21, 13
    s_mul_i32 s33, s24, 3118080
    s_add_u32 s33, s33, 79261696
    s_add_u32 s8, s6, s33
    s_addc_u32 s9, s7, 0
    s_mov_b32 s10, 3118080
    s_mov_b32 s11, 0x00020000
    s_mov_b32 s46, 0
    s_cmp_eq_u32 s28, s29
    s_cbranch_scc1 L_joint_kernel_same
    s_mul_i32 s36, s29, 37120
    s_add_u32 s36, s36, s35
    s_add_u32 m0, s34, 8192
    s_add_u32 s37, s36, 0
    buffer_load_dwordx4 v2, s[8:11], s37 offen offset:0 lds
    buffer_load_dwordx4 v2, s[8:11], s37 offen offset:1024 lds
    buffer_load_dwordx4 v2, s[8:11], s37 offen offset:2048 lds
    buffer_load_dwordx4 v2, s[8:11], s37 offen offset:3072 lds
    s_add_u32 m0, s34, 12288
    s_add_u32 s37, s36, 4096
    buffer_load_dwordx4 v2, s[8:11], s37 offen offset:0 lds
    buffer_load_dwordx4 v2, s[8:11], s37 offen offset:1024 lds
    buffer_load_dwordx4 v2, s[8:11], s37 offen offset:2048 lds
    buffer_load_dwordx4 v2, s[8:11], s37 offen offset:3072 lds
    s_mov_b32 s46, 8192
L_joint_kernel_same:
    s_lshl_b32 s36, s30, 11
    s_add_u32 s36, s36, 8192
    buffer_load_dwordx4 v[8:11], v5, s[12:15], s36 offen offset:0
    buffer_load_dwordx4 v[12:15], v5, s[12:15], s36 offen offset:1024
    s_lshl_b32 s36, s31, 11
    s_add_u32 s36, s36, 8192
    buffer_load_dwordx4 v[16:19], v5, s[12:15], s36 offen offset:0
    buffer_load_dwordx4 v[20:23], v5, s[12:15], s36 offen offset:1024
    s_mul_i32 s36, s28, 37120
    s_add_u32 s36, s36, s35
    s_add_u32 m0, s34, 0
    s_add_u32 s37, s36, 0
    buffer_load_dwordx4 v2, s[8:11], s37 offen offset:0 lds
    buffer_load_dwordx4 v2, s[8:11], s37 offen offset:1024 lds
    buffer_load_dwordx4 v2, s[8:11], s37 offen offset:2048 lds
    buffer_load_dwordx4 v2, s[8:11], s37 offen offset:3072 lds
    s_add_u32 m0, s34, 4096
    s_add_u32 s37, s36, 4096
    buffer_load_dwordx4 v2, s[8:11], s37 offen offset:0 lds
    buffer_load_dwordx4 v2, s[8:11], s37 offen offset:1024 lds
    buffer_load_dwordx4 v2, s[8:11], s37 offen offset:2048 lds
    buffer_load_dwordx4 v2, s[8:11], s37 offen offset:3072 lds
    v_bfe_u32 v32, v1, 2, 2
    v_lshrrev_b32 v33, 4, v1
    v_and_b32 v34, 3, v1
    v_lshl_add_u32 v35, v33, 3, v32
    v_lshlrev_b32 v40, 6, v35
    v_and_b32 v41, 1, v33
    v_lshlrev_b32 v41, 1, v41
    v_lshrrev_b32 v42, 1, v34
    v_xor_b32 v41, v41, v42
    v_lshl_add_u32 v40, v41, 4, v40
    v_and_b32 v42, 1, v34
    v_lshl_add_u32 v40, v42, 3, v40
    v_add_u32 v36, s34, v40
    v_xor_b32 v37, 32, v36
    v_add_u32 v38, s46, v36
    v_add_u32 v39, s46, v37
    v_lshrrev_b32 v41, 1, v33
    v_lshlrev_b32 v41, 10, v41
    v_and_b32 v42, 1, v33
    v_lshl_add_u32 v41, v42, 9, v41
    v_and_b32 v42, 15, v1
    v_lshl_add_u32 v41, v42, 4, v41
    s_lshl_b32 s36, s21, 12
    s_add_u32 s36, s36, 65536
    v_add_u32 v43, s36, v41
    s_mov_b32 s40, 0xbdd2d3e8
    v_mov_b32 v44, 0xc0135761
    s_mov_b32 s41, 0xbdd2d3e8
    v_mov_b32 v45, 0xc0135761
    s_waitcnt vmcnt(4)
    ds_read_b64_tr_b16 v[48:49], v36 offset:0
    ds_read_b64_tr_b16 v[50:51], v36 offset:256
    ds_read_b64_tr_b16 v[52:53], v36 offset:2048
    ds_read_b64_tr_b16 v[54:55], v36 offset:2304
    ds_read_b64_tr_b16 v[56:57], v37 offset:0
    ds_read_b64_tr_b16 v[58:59], v37 offset:256
    ds_read_b64_tr_b16 v[60:61], v37 offset:2048
    ds_read_b64_tr_b16 v[62:63], v37 offset:2304
    s_waitcnt lgkmcnt(0)
    v_mfma_f32_16x16x32_bf16 v[64:67], v[48:51], v[8:11], 0
    v_mfma_f32_16x16x32_bf16 v[68:71], v[56:59], v[8:11], 0
    v_mfma_f32_16x16x32_bf16 v[64:67], v[52:55], v[12:15], v[64:67]
    v_mfma_f32_16x16x32_bf16 v[68:71], v[60:63], v[12:15], v[68:71]
    ds_read_b64_tr_b16 v[84:85], v38 offset:0
    ds_read_b64_tr_b16 v[86:87], v38 offset:256
    ds_read_b64_tr_b16 v[88:89], v38 offset:2048
    ds_read_b64_tr_b16 v[90:91], v38 offset:2304
    ds_read_b64_tr_b16 v[92:93], v39 offset:0
    ds_read_b64_tr_b16 v[94:95], v39 offset:256
    ds_read_b64_tr_b16 v[96:97], v39 offset:2048
    ds_read_b64_tr_b16 v[98:99], v39 offset:2304
    v_mul_f32 v72, v64, v64
    v_mul_f32 v73, v65, v65
    v_mul_f32 v74, v66, v66
    v_mul_f32 v75, v67, v67
    v_mul_f32 v76, v68, v68
    v_mul_f32 v77, v69, v69
    v_mul_f32 v78, v70, v70
    v_mul_f32 v79, v71, v71
    v_fma_f32 v72, v72, s40, v44
    v_fma_f32 v73, v73, s40, v44
    v_fma_f32 v74, v74, s40, v44
    v_fma_f32 v75, v75, s40, v44
    v_fma_f32 v76, v76, s40, v44
    v_fma_f32 v77, v77, s40, v44
    v_fma_f32 v78, v78, s40, v44
    v_fma_f32 v79, v79, s40, v44
    v_mul_f32 v72, v72, v64
    v_mul_f32 v73, v73, v65
    v_mul_f32 v74, v74, v66
    v_mul_f32 v75, v75, v67
    v_mul_f32 v76, v76, v68
    v_mul_f32 v77, v77, v69
    v_mul_f32 v78, v78, v70
    v_mul_f32 v79, v79, v71
    v_exp_f32 v72, v72
    v_exp_f32 v73, v73
    v_exp_f32 v74, v74
    v_exp_f32 v75, v75
    v_exp_f32 v76, v76
    v_exp_f32 v77, v77
    v_exp_f32 v78, v78
    v_exp_f32 v79, v79
    v_add_f32 v72, 1.0, v72
    v_add_f32 v73, 1.0, v73
    v_add_f32 v74, 1.0, v74
    v_add_f32 v75, 1.0, v75
    v_add_f32 v76, 1.0, v76
    v_add_f32 v77, 1.0, v77
    v_add_f32 v78, 1.0, v78
    v_add_f32 v79, 1.0, v79
    v_rcp_f32 v72, v72
    v_rcp_f32 v73, v73
    v_rcp_f32 v74, v74
    v_rcp_f32 v75, v75
    v_rcp_f32 v76, v76
    v_rcp_f32 v77, v77
    v_rcp_f32 v78, v78
    v_rcp_f32 v79, v79
    v_mul_f32 v64, v64, v72
    v_mul_f32 v65, v65, v73
    v_mul_f32 v66, v66, v74
    v_mul_f32 v67, v67, v75
    v_mul_f32 v68, v68, v76
    v_mul_f32 v69, v69, v77
    v_mul_f32 v70, v70, v78
    v_mul_f32 v71, v71, v79
    v_cvt_pk_bf16_f32 v80, v64, v65
    v_cvt_pk_bf16_f32 v81, v66, v67
    v_cvt_pk_bf16_f32 v82, v68, v69
    v_cvt_pk_bf16_f32 v83, v70, v71
    ds_write_b128 v43, v[80:83] offset:0
    s_waitcnt vmcnt(0)
    s_waitcnt lgkmcnt(1)
    v_mfma_f32_16x16x32_bf16 v[100:103], v[84:87], v[16:19], 0
    v_mfma_f32_16x16x32_bf16 v[104:107], v[92:95], v[16:19], 0
    v_mfma_f32_16x16x32_bf16 v[100:103], v[88:91], v[20:23], v[100:103]
    v_mfma_f32_16x16x32_bf16 v[104:107], v[96:99], v[20:23], v[104:107]
    ds_read_b64_tr_b16 v[48:49], v36 offset:4096
    ds_read_b64_tr_b16 v[50:51], v36 offset:4352
    ds_read_b64_tr_b16 v[52:53], v36 offset:6144
    ds_read_b64_tr_b16 v[54:55], v36 offset:6400
    ds_read_b64_tr_b16 v[56:57], v37 offset:4096
    ds_read_b64_tr_b16 v[58:59], v37 offset:4352
    ds_read_b64_tr_b16 v[60:61], v37 offset:6144
    ds_read_b64_tr_b16 v[62:63], v37 offset:6400
    v_mul_f32 v72, v100, v100
    v_mul_f32 v73, v101, v101
    v_mul_f32 v74, v102, v102
    v_mul_f32 v75, v103, v103
    v_mul_f32 v76, v104, v104
    v_mul_f32 v77, v105, v105
    v_mul_f32 v78, v106, v106
    v_mul_f32 v79, v107, v107
    v_fma_f32 v72, v72, s40, v44
    v_fma_f32 v73, v73, s40, v44
    v_fma_f32 v74, v74, s40, v44
    v_fma_f32 v75, v75, s40, v44
    v_fma_f32 v76, v76, s40, v44
    v_fma_f32 v77, v77, s40, v44
    v_fma_f32 v78, v78, s40, v44
    v_fma_f32 v79, v79, s40, v44
    v_mul_f32 v72, v72, v100
    v_mul_f32 v73, v73, v101
    v_mul_f32 v74, v74, v102
    v_mul_f32 v75, v75, v103
    v_mul_f32 v76, v76, v104
    v_mul_f32 v77, v77, v105
    v_mul_f32 v78, v78, v106
    v_mul_f32 v79, v79, v107
    v_exp_f32 v72, v72
    v_exp_f32 v73, v73
    v_exp_f32 v74, v74
    v_exp_f32 v75, v75
    v_exp_f32 v76, v76
    v_exp_f32 v77, v77
    v_exp_f32 v78, v78
    v_exp_f32 v79, v79
    v_add_f32 v72, 1.0, v72
    v_add_f32 v73, 1.0, v73
    v_add_f32 v74, 1.0, v74
    v_add_f32 v75, 1.0, v75
    v_add_f32 v76, 1.0, v76
    v_add_f32 v77, 1.0, v77
    v_add_f32 v78, 1.0, v78
    v_add_f32 v79, 1.0, v79
    v_rcp_f32 v72, v72
    v_rcp_f32 v73, v73
    v_rcp_f32 v74, v74
    v_rcp_f32 v75, v75
    v_rcp_f32 v76, v76
    v_rcp_f32 v77, v77
    v_rcp_f32 v78, v78
    v_rcp_f32 v79, v79
    v_mul_f32 v100, v100, v72
    v_mul_f32 v101, v101, v73
    v_mul_f32 v102, v102, v74
    v_mul_f32 v103, v103, v75
    v_mul_f32 v104, v104, v76
    v_mul_f32 v105, v105, v77
    v_mul_f32 v106, v106, v78
    v_mul_f32 v107, v107, v79
    v_cvt_pk_bf16_f32 v108, v100, v101
    v_cvt_pk_bf16_f32 v109, v102, v103
    v_cvt_pk_bf16_f32 v110, v104, v105
    v_cvt_pk_bf16_f32 v111, v106, v107
    ds_write_b128 v43, v[108:111] offset:256
    s_waitcnt lgkmcnt(1)
    v_mfma_f32_16x16x32_bf16 v[64:67], v[48:51], v[8:11], 0
    v_mfma_f32_16x16x32_bf16 v[68:71], v[56:59], v[8:11], 0
    v_mfma_f32_16x16x32_bf16 v[64:67], v[52:55], v[12:15], v[64:67]
    v_mfma_f32_16x16x32_bf16 v[68:71], v[60:63], v[12:15], v[68:71]
    ds_read_b64_tr_b16 v[84:85], v38 offset:4096
    ds_read_b64_tr_b16 v[86:87], v38 offset:4352
    ds_read_b64_tr_b16 v[88:89], v38 offset:6144
    ds_read_b64_tr_b16 v[90:91], v38 offset:6400
    ds_read_b64_tr_b16 v[92:93], v39 offset:4096
    ds_read_b64_tr_b16 v[94:95], v39 offset:4352
    ds_read_b64_tr_b16 v[96:97], v39 offset:6144
    ds_read_b64_tr_b16 v[98:99], v39 offset:6400
    v_mul_f32 v72, v64, v64
    v_mul_f32 v73, v65, v65
    v_mul_f32 v74, v66, v66
    v_mul_f32 v75, v67, v67
    v_mul_f32 v76, v68, v68
    v_mul_f32 v77, v69, v69
    v_mul_f32 v78, v70, v70
    v_mul_f32 v79, v71, v71
    v_fma_f32 v72, v72, s40, v44
    v_fma_f32 v73, v73, s40, v44
    v_fma_f32 v74, v74, s40, v44
    v_fma_f32 v75, v75, s40, v44
    v_fma_f32 v76, v76, s40, v44
    v_fma_f32 v77, v77, s40, v44
    v_fma_f32 v78, v78, s40, v44
    v_fma_f32 v79, v79, s40, v44
    v_mul_f32 v72, v72, v64
    v_mul_f32 v73, v73, v65
    v_mul_f32 v74, v74, v66
    v_mul_f32 v75, v75, v67
    v_mul_f32 v76, v76, v68
    v_mul_f32 v77, v77, v69
    v_mul_f32 v78, v78, v70
    v_mul_f32 v79, v79, v71
    v_exp_f32 v72, v72
    v_exp_f32 v73, v73
    v_exp_f32 v74, v74
    v_exp_f32 v75, v75
    v_exp_f32 v76, v76
    v_exp_f32 v77, v77
    v_exp_f32 v78, v78
    v_exp_f32 v79, v79
    v_add_f32 v72, 1.0, v72
    v_add_f32 v73, 1.0, v73
    v_add_f32 v74, 1.0, v74
    v_add_f32 v75, 1.0, v75
    v_add_f32 v76, 1.0, v76
    v_add_f32 v77, 1.0, v77
    v_add_f32 v78, 1.0, v78
    v_add_f32 v79, 1.0, v79
    v_rcp_f32 v72, v72
    v_rcp_f32 v73, v73
    v_rcp_f32 v74, v74
    v_rcp_f32 v75, v75
    v_rcp_f32 v76, v76
    v_rcp_f32 v77, v77
    v_rcp_f32 v78, v78
    v_rcp_f32 v79, v79
    v_mul_f32 v64, v64, v72
    v_mul_f32 v65, v65, v73
    v_mul_f32 v66, v66, v74
    v_mul_f32 v67, v67, v75
    v_mul_f32 v68, v68, v76
    v_mul_f32 v69, v69, v77
    v_mul_f32 v70, v70, v78
    v_mul_f32 v71, v71, v79
    v_cvt_pk_bf16_f32 v80, v64, v65
    v_cvt_pk_bf16_f32 v81, v66, v67
    v_cvt_pk_bf16_f32 v82, v68, v69
    v_cvt_pk_bf16_f32 v83, v70, v71
    ds_write_b128 v43, v[80:83] offset:2048
    s_waitcnt lgkmcnt(1)
    v_mfma_f32_16x16x32_bf16 v[100:103], v[84:87], v[16:19], 0
    v_mfma_f32_16x16x32_bf16 v[104:107], v[92:95], v[16:19], 0
    v_mfma_f32_16x16x32_bf16 v[100:103], v[88:91], v[20:23], v[100:103]
    v_mfma_f32_16x16x32_bf16 v[104:107], v[96:99], v[20:23], v[104:107]
    s_nop 7
    v_mul_f32 v72, v100, v100
    v_mul_f32 v73, v101, v101
    v_mul_f32 v74, v102, v102
    v_mul_f32 v75, v103, v103
    v_mul_f32 v76, v104, v104
    v_mul_f32 v77, v105, v105
    v_mul_f32 v78, v106, v106
    v_mul_f32 v79, v107, v107
    v_fma_f32 v72, v72, s40, v44
    v_fma_f32 v73, v73, s40, v44
    v_fma_f32 v74, v74, s40, v44
    v_fma_f32 v75, v75, s40, v44
    v_fma_f32 v76, v76, s40, v44
    v_fma_f32 v77, v77, s40, v44
    v_fma_f32 v78, v78, s40, v44
    v_fma_f32 v79, v79, s40, v44
    v_mul_f32 v72, v72, v100
    v_mul_f32 v73, v73, v101
    v_mul_f32 v74, v74, v102
    v_mul_f32 v75, v75, v103
    v_mul_f32 v76, v76, v104
    v_mul_f32 v77, v77, v105
    v_mul_f32 v78, v78, v106
    v_mul_f32 v79, v79, v107
    v_exp_f32 v72, v72
    v_exp_f32 v73, v73
    v_exp_f32 v74, v74
    v_exp_f32 v75, v75
    v_exp_f32 v76, v76
    v_exp_f32 v77, v77
    v_exp_f32 v78, v78
    v_exp_f32 v79, v79
    v_add_f32 v72, 1.0, v72
    v_add_f32 v73, 1.0, v73
    v_add_f32 v74, 1.0, v74
    v_add_f32 v75, 1.0, v75
    v_add_f32 v76, 1.0, v76
    v_add_f32 v77, 1.0, v77
    v_add_f32 v78, 1.0, v78
    v_add_f32 v79, 1.0, v79
    v_rcp_f32 v72, v72
    v_rcp_f32 v73, v73
    v_rcp_f32 v74, v74
    v_rcp_f32 v75, v75
    v_rcp_f32 v76, v76
    v_rcp_f32 v77, v77
    v_rcp_f32 v78, v78
    v_rcp_f32 v79, v79
    v_mul_f32 v100, v100, v72
    v_mul_f32 v101, v101, v73
    v_mul_f32 v102, v102, v74
    v_mul_f32 v103, v103, v75
    v_mul_f32 v104, v104, v76
    v_mul_f32 v105, v105, v77
    v_mul_f32 v106, v106, v78
    v_mul_f32 v107, v107, v79
    v_cvt_pk_bf16_f32 v108, v100, v101
    v_cvt_pk_bf16_f32 v109, v102, v103
    v_cvt_pk_bf16_f32 v110, v104, v105
    v_cvt_pk_bf16_f32 v111, v106, v107
    ds_write_b128 v43, v[108:111] offset:2304
    s_waitcnt lgkmcnt(0)
    s_barrier
    s_add_u32 s36, s38, 163840
    buffer_load_dwordx4 a[0:3], v5, s[12:15], s36 offen
    s_add_u32 s36, s38, 180224
    buffer_load_dwordx4 a[64:67], v5, s[12:15], s36 offen
    s_add_u32 s36, s38, 164864
    buffer_load_dwordx4 a[4:7], v5, s[12:15], s36 offen
    s_add_u32 s36, s38, 181248
    buffer_load_dwordx4 a[68:71], v5, s[12:15], s36 offen
    s_add_u32 s36, s38, 165888
    buffer_load_dwordx4 a[8:11], v5, s[12:15], s36 offen
    s_add_u32 s36, s38, 182272
    buffer_load_dwordx4 a[72:75], v5, s[12:15], s36 offen
    s_add_u32 s36, s38, 166912
    buffer_load_dwordx4 a[12:15], v5, s[12:15], s36 offen
    s_add_u32 s36, s38, 183296
    buffer_load_dwordx4 a[76:79], v5, s[12:15], s36 offen
    s_add_u32 s36, s38, 167936
    buffer_load_dwordx4 a[16:19], v5, s[12:15], s36 offen
    s_add_u32 s36, s38, 184320
    buffer_load_dwordx4 a[80:83], v5, s[12:15], s36 offen
    s_add_u32 s36, s38, 168960
    buffer_load_dwordx4 a[20:23], v5, s[12:15], s36 offen
    s_add_u32 s36, s38, 185344
    buffer_load_dwordx4 a[84:87], v5, s[12:15], s36 offen
    s_add_u32 s36, s38, 169984
    buffer_load_dwordx4 a[24:27], v5, s[12:15], s36 offen
    s_add_u32 s36, s38, 186368
    buffer_load_dwordx4 a[88:91], v5, s[12:15], s36 offen
    s_add_u32 s36, s38, 171008
    buffer_load_dwordx4 a[28:31], v5, s[12:15], s36 offen
    s_add_u32 s36, s38, 187392
    buffer_load_dwordx4 a[92:95], v5, s[12:15], s36 offen
    s_add_u32 s36, s38, 172032
    buffer_load_dwordx4 a[32:35], v5, s[12:15], s36 offen
    s_add_u32 s36, s38, 188416
    buffer_load_dwordx4 a[96:99], v5, s[12:15], s36 offen
    s_add_u32 s36, s38, 173056
    buffer_load_dwordx4 a[36:39], v5, s[12:15], s36 offen
    s_add_u32 s36, s38, 189440
    buffer_load_dwordx4 a[100:103], v5, s[12:15], s36 offen
    s_add_u32 s36, s38, 174080
    buffer_load_dwordx4 a[40:43], v5, s[12:15], s36 offen
    s_add_u32 s36, s38, 190464
    buffer_load_dwordx4 a[104:107], v5, s[12:15], s36 offen
    s_add_u32 s36, s38, 175104
    buffer_load_dwordx4 a[44:47], v5, s[12:15], s36 offen
    s_add_u32 s36, s38, 191488
    buffer_load_dwordx4 a[108:111], v5, s[12:15], s36 offen
    s_add_u32 s36, s38, 176128
    buffer_load_dwordx4 a[48:51], v5, s[12:15], s36 offen
    s_add_u32 s36, s38, 192512
    buffer_load_dwordx4 a[112:115], v5, s[12:15], s36 offen
    s_add_u32 s36, s38, 177152
    buffer_load_dwordx4 a[52:55], v5, s[12:15], s36 offen
    s_add_u32 s36, s38, 193536
    buffer_load_dwordx4 a[116:119], v5, s[12:15], s36 offen
    s_add_u32 s36, s38, 178176
    buffer_load_dwordx4 a[56:59], v5, s[12:15], s36 offen
    s_add_u32 s36, s38, 194560
    buffer_load_dwordx4 a[120:123], v5, s[12:15], s36 offen
    s_add_u32 s36, s38, 179200
    buffer_load_dwordx4 a[60:63], v5, s[12:15], s36 offen
    s_add_u32 s36, s38, 195584
    buffer_load_dwordx4 a[124:127], v5, s[12:15], s36 offen
    v_and_b32 v46, 31, v1
    v_mul_u32_u24 v47, 528, v46
    v_lshrrev_b32 v45, 5, v1
    v_lshl_add_u32 v47, v45, 4, v47
    s_lshl_b32 s36, s21, 7
    s_add_u32 s36, s36, 115712
    v_add_u32 v6, s36, v47
    v_lshlrev_b32 v7, 6, v45
    s_lshl_b32 s36, s21, 8
    s_add_u32 s36, s36, 14336
    buffer_load_dwordx4 v[72:75], v7, s[12:15], s36 offen offset:0
    buffer_load_dwordx4 v[76:79], v7, s[12:15], s36 offen offset:16
    buffer_load_dwordx4 v[80:83], v7, s[12:15], s36 offen offset:32
    buffer_load_dwordx4 v[84:87], v7, s[12:15], s36 offen offset:48
    buffer_load_dwordx4 v[88:91], v7, s[12:15], s36 offen offset:128
    buffer_load_dwordx4 v[92:95], v7, s[12:15], s36 offen offset:144
    buffer_load_dwordx4 v[96:99], v7, s[12:15], s36 offen offset:160
    buffer_load_dwordx4 v[100:103], v7, s[12:15], s36 offen offset:176
    s_setprio 1
    s_waitcnt vmcnt(0)
    s_barrier
    ds_read_b128 v[104:107], v5 offset:0
    ds_read_b128 v[108:111], v5 offset:1024
    ds_read_b128 v[112:115], v5 offset:2048
    s_waitcnt lgkmcnt(2)
    v_mfma_f32_32x32x16_bf16 v[8:23], a[0:3], v[104:107], v[72:87]
    ds_read_b128 v[116:119], v5 offset:3072
    v_mfma_f32_32x32x16_bf16 v[24:39], a[64:67], v[104:107], v[88:103]
    s_waitcnt lgkmcnt(2)
    v_mfma_f32_32x32x16_bf16 v[8:23], a[4:7], v[108:111], v[8:23]
    ds_read_b128 v[104:107], v5 offset:4096
    v_mfma_f32_32x32x16_bf16 v[24:39], a[68:71], v[108:111], v[24:39]
    s_waitcnt lgkmcnt(2)
    v_mfma_f32_32x32x16_bf16 v[8:23], a[8:11], v[112:115], v[8:23]
    ds_read_b128 v[108:111], v5 offset:5120
    v_mfma_f32_32x32x16_bf16 v[24:39], a[72:75], v[112:115], v[24:39]
    s_waitcnt lgkmcnt(2)
    v_mfma_f32_32x32x16_bf16 v[8:23], a[12:15], v[116:119], v[8:23]
    ds_read_b128 v[112:115], v5 offset:6144
    v_mfma_f32_32x32x16_bf16 v[24:39], a[76:79], v[116:119], v[24:39]
    s_waitcnt lgkmcnt(2)
    v_mfma_f32_32x32x16_bf16 v[8:23], a[16:19], v[104:107], v[8:23]
    ds_read_b128 v[116:119], v5 offset:7168
    v_mfma_f32_32x32x16_bf16 v[24:39], a[80:83], v[104:107], v[24:39]
    s_waitcnt lgkmcnt(2)
    v_mfma_f32_32x32x16_bf16 v[8:23], a[20:23], v[108:111], v[8:23]
    ds_read_b128 v[104:107], v5 offset:8192
    v_mfma_f32_32x32x16_bf16 v[24:39], a[84:87], v[108:111], v[24:39]
    s_waitcnt lgkmcnt(2)
    v_mfma_f32_32x32x16_bf16 v[8:23], a[24:27], v[112:115], v[8:23]
    ds_read_b128 v[108:111], v5 offset:9216
    v_mfma_f32_32x32x16_bf16 v[24:39], a[88:91], v[112:115], v[24:39]
    s_waitcnt lgkmcnt(2)
    v_mfma_f32_32x32x16_bf16 v[8:23], a[28:31], v[116:119], v[8:23]
    ds_read_b128 v[112:115], v5 offset:10240
    v_mfma_f32_32x32x16_bf16 v[24:39], a[92:95], v[116:119], v[24:39]
    s_waitcnt lgkmcnt(2)
    v_mfma_f32_32x32x16_bf16 v[8:23], a[32:35], v[104:107], v[8:23]
    ds_read_b128 v[116:119], v5 offset:11264
    v_mfma_f32_32x32x16_bf16 v[24:39], a[96:99], v[104:107], v[24:39]
    s_waitcnt lgkmcnt(2)
    v_mfma_f32_32x32x16_bf16 v[8:23], a[36:39], v[108:111], v[8:23]
    ds_read_b128 v[104:107], v5 offset:12288
    v_mfma_f32_32x32x16_bf16 v[24:39], a[100:103], v[108:111], v[24:39]
    s_waitcnt lgkmcnt(2)
    v_mfma_f32_32x32x16_bf16 v[8:23], a[40:43], v[112:115], v[8:23]
    ds_read_b128 v[108:111], v5 offset:13312
    v_mfma_f32_32x32x16_bf16 v[24:39], a[104:107], v[112:115], v[24:39]
    s_waitcnt lgkmcnt(2)
    v_mfma_f32_32x32x16_bf16 v[8:23], a[44:47], v[116:119], v[8:23]
    ds_read_b128 v[112:115], v5 offset:14336
    v_mfma_f32_32x32x16_bf16 v[24:39], a[108:111], v[116:119], v[24:39]
    s_waitcnt lgkmcnt(2)
    v_mfma_f32_32x32x16_bf16 v[8:23], a[48:51], v[104:107], v[8:23]
    ds_read_b128 v[116:119], v5 offset:15360
    v_mfma_f32_32x32x16_bf16 v[24:39], a[112:115], v[104:107], v[24:39]
    s_waitcnt lgkmcnt(2)
    v_mfma_f32_32x32x16_bf16 v[8:23], a[52:55], v[108:111], v[8:23]
    ds_read_b128 v[104:107], v5 offset:16384
    v_mfma_f32_32x32x16_bf16 v[24:39], a[116:119], v[108:111], v[24:39]
    s_waitcnt lgkmcnt(2)
    v_mfma_f32_32x32x16_bf16 v[8:23], a[56:59], v[112:115], v[8:23]
    ds_read_b128 v[108:111], v5 offset:17408
    v_mfma_f32_32x32x16_bf16 v[24:39], a[120:123], v[112:115], v[24:39]
    s_waitcnt lgkmcnt(2)
    v_mfma_f32_32x32x16_bf16 v[8:23], a[60:63], v[116:119], v[8:23]
    ds_read_b128 v[112:115], v5 offset:18432
    v_mfma_f32_32x32x16_bf16 v[24:39], a[124:127], v[116:119], v[24:39]
    s_barrier
    s_waitcnt lgkmcnt(2)
    v_mfma_f32_32x32x16_bf16 v[40:55], a[0:3], v[104:107], v[72:87]
    ds_read_b128 v[116:119], v5 offset:19456
    v_mfma_f32_32x32x16_bf16 v[56:71], a[64:67], v[104:107], v[88:103]
    s_waitcnt lgkmcnt(2)
    v_mfma_f32_32x32x16_bf16 v[40:55], a[4:7], v[108:111], v[40:55]
    ds_read_b128 v[104:107], v5 offset:20480
    v_mfma_f32_32x32x16_bf16 v[56:71], a[68:71], v[108:111], v[56:71]
    s_waitcnt lgkmcnt(2)
    v_mfma_f32_32x32x16_bf16 v[40:55], a[8:11], v[112:115], v[40:55]
    ds_read_b128 v[108:111], v5 offset:21504
    v_cvt_pk_bf16_f32 v120, v8, v9
    v_mfma_f32_32x32x16_bf16 v[56:71], a[72:75], v[112:115], v[56:71]
    v_cvt_pk_bf16_f32 v121, v10, v11
    s_waitcnt lgkmcnt(2)
    v_mfma_f32_32x32x16_bf16 v[40:55], a[12:15], v[116:119], v[40:55]
    ds_read_b128 v[112:115], v5 offset:22528
    v_cvt_pk_bf16_f32 v122, v12, v13
    v_mfma_f32_32x32x16_bf16 v[56:71], a[76:79], v[116:119], v[56:71]
    v_cvt_pk_bf16_f32 v123, v14, v15
    s_waitcnt lgkmcnt(2)
    v_mfma_f32_32x32x16_bf16 v[40:55], a[16:19], v[104:107], v[40:55]
    ds_read_b128 v[116:119], v5 offset:23552
    ds_write_b128 v6, v[120:123] offset:0
    v_mfma_f32_32x32x16_bf16 v[56:71], a[80:83], v[104:107], v[56:71]
    v_cvt_pk_bf16_f32 v124, v16, v17
    s_waitcnt lgkmcnt(3)
    v_mfma_f32_32x32x16_bf16 v[40:55], a[20:23], v[108:111], v[40:55]
    ds_read_b128 v[104:107], v5 offset:24576
    v_cvt_pk_bf16_f32 v125, v18, v19
    v_mfma_f32_32x32x16_bf16 v[56:71], a[84:87], v[108:111], v[56:71]
    v_cvt_pk_bf16_f32 v126, v20, v21
    s_waitcnt lgkmcnt(3)
    v_mfma_f32_32x32x16_bf16 v[40:55], a[24:27], v[112:115], v[40:55]
    ds_read_b128 v[108:111], v5 offset:25600
    v_cvt_pk_bf16_f32 v127, v22, v23
    v_mfma_f32_32x32x16_bf16 v[56:71], a[88:91], v[112:115], v[56:71]
    ds_write_b128 v6, v[124:127] offset:32
    s_waitcnt lgkmcnt(4)
    v_mfma_f32_32x32x16_bf16 v[40:55], a[28:31], v[116:119], v[40:55]
    ds_read_b128 v[112:115], v5 offset:26624
    v_cvt_pk_bf16_f32 v120, v24, v25
    v_mfma_f32_32x32x16_bf16 v[56:71], a[92:95], v[116:119], v[56:71]
    v_cvt_pk_bf16_f32 v121, v26, v27
    s_waitcnt lgkmcnt(3)
    v_mfma_f32_32x32x16_bf16 v[40:55], a[32:35], v[104:107], v[40:55]
    ds_read_b128 v[116:119], v5 offset:27648
    v_cvt_pk_bf16_f32 v122, v28, v29
    v_mfma_f32_32x32x16_bf16 v[56:71], a[96:99], v[104:107], v[56:71]
    v_cvt_pk_bf16_f32 v123, v30, v31
    s_waitcnt lgkmcnt(3)
    v_mfma_f32_32x32x16_bf16 v[40:55], a[36:39], v[108:111], v[40:55]
    ds_read_b128 v[104:107], v5 offset:28672
    ds_write_b128 v6, v[120:123] offset:64
    v_mfma_f32_32x32x16_bf16 v[56:71], a[100:103], v[108:111], v[56:71]
    v_cvt_pk_bf16_f32 v124, v32, v33
    s_waitcnt lgkmcnt(3)
    v_mfma_f32_32x32x16_bf16 v[40:55], a[40:43], v[112:115], v[40:55]
    ds_read_b128 v[108:111], v5 offset:29696
    v_cvt_pk_bf16_f32 v125, v34, v35
    v_mfma_f32_32x32x16_bf16 v[56:71], a[104:107], v[112:115], v[56:71]
    v_cvt_pk_bf16_f32 v126, v36, v37
    s_waitcnt lgkmcnt(3)
    v_mfma_f32_32x32x16_bf16 v[40:55], a[44:47], v[116:119], v[40:55]
    ds_read_b128 v[112:115], v5 offset:30720
    v_cvt_pk_bf16_f32 v127, v38, v39
    v_mfma_f32_32x32x16_bf16 v[56:71], a[108:111], v[116:119], v[56:71]
    ds_write_b128 v6, v[124:127] offset:96
    s_waitcnt lgkmcnt(4)
    v_mfma_f32_32x32x16_bf16 v[40:55], a[48:51], v[104:107], v[40:55]
    ds_read_b128 v[116:119], v5 offset:31744
    v_mfma_f32_32x32x16_bf16 v[56:71], a[112:115], v[104:107], v[56:71]
    s_waitcnt lgkmcnt(3)
    v_mfma_f32_32x32x16_bf16 v[40:55], a[52:55], v[108:111], v[40:55]
    ds_read_b128 v[104:107], v5 offset:32768
    v_mfma_f32_32x32x16_bf16 v[56:71], a[116:119], v[108:111], v[56:71]
    s_waitcnt lgkmcnt(3)
    v_mfma_f32_32x32x16_bf16 v[40:55], a[56:59], v[112:115], v[40:55]
    ds_read_b128 v[108:111], v5 offset:33792
    v_mfma_f32_32x32x16_bf16 v[56:71], a[120:123], v[112:115], v[56:71]
    s_waitcnt lgkmcnt(2)
    v_mfma_f32_32x32x16_bf16 v[40:55], a[60:63], v[116:119], v[40:55]
    ds_read_b128 v[112:115], v5 offset:34816
    v_mfma_f32_32x32x16_bf16 v[56:71], a[124:127], v[116:119], v[56:71]
    s_barrier
    s_waitcnt lgkmcnt(2)
    v_mfma_f32_32x32x16_bf16 v[8:23], a[0:3], v[104:107], v[72:87]
    ds_read_b128 v[116:119], v5 offset:35840
    v_mfma_f32_32x32x16_bf16 v[24:39], a[64:67], v[104:107], v[88:103]
    s_waitcnt lgkmcnt(2)
    v_mfma_f32_32x32x16_bf16 v[8:23], a[4:7], v[108:111], v[8:23]
    ds_read_b128 v[104:107], v5 offset:36864
    v_mfma_f32_32x32x16_bf16 v[24:39], a[68:71], v[108:111], v[24:39]
    s_waitcnt lgkmcnt(2)
    v_mfma_f32_32x32x16_bf16 v[8:23], a[8:11], v[112:115], v[8:23]
    ds_read_b128 v[108:111], v5 offset:37888
    v_cvt_pk_bf16_f32 v120, v40, v41
    v_mfma_f32_32x32x16_bf16 v[24:39], a[72:75], v[112:115], v[24:39]
    v_cvt_pk_bf16_f32 v121, v42, v43
    s_waitcnt lgkmcnt(2)
    v_mfma_f32_32x32x16_bf16 v[8:23], a[12:15], v[116:119], v[8:23]
    ds_read_b128 v[112:115], v5 offset:38912
    v_cvt_pk_bf16_f32 v122, v44, v45
    v_mfma_f32_32x32x16_bf16 v[24:39], a[76:79], v[116:119], v[24:39]
    v_cvt_pk_bf16_f32 v123, v46, v47
    s_waitcnt lgkmcnt(2)
    v_mfma_f32_32x32x16_bf16 v[8:23], a[16:19], v[104:107], v[8:23]
    ds_read_b128 v[116:119], v5 offset:39936
    ds_write_b128 v6, v[120:123] offset:16896
    v_mfma_f32_32x32x16_bf16 v[24:39], a[80:83], v[104:107], v[24:39]
    v_cvt_pk_bf16_f32 v124, v48, v49
    s_waitcnt lgkmcnt(3)
    v_mfma_f32_32x32x16_bf16 v[8:23], a[20:23], v[108:111], v[8:23]
    ds_read_b128 v[104:107], v5 offset:40960
    v_cvt_pk_bf16_f32 v125, v50, v51
    v_mfma_f32_32x32x16_bf16 v[24:39], a[84:87], v[108:111], v[24:39]
    v_cvt_pk_bf16_f32 v126, v52, v53
    s_waitcnt lgkmcnt(3)
    v_mfma_f32_32x32x16_bf16 v[8:23], a[24:27], v[112:115], v[8:23]
    ds_read_b128 v[108:111], v5 offset:41984
    v_cvt_pk_bf16_f32 v127, v54, v55
    v_mfma_f32_32x32x16_bf16 v[24:39], a[88:91], v[112:115], v[24:39]
    ds_write_b128 v6, v[124:127] offset:16928
    s_waitcnt lgkmcnt(4)
    v_mfma_f32_32x32x16_bf16 v[8:23], a[28:31], v[116:119], v[8:23]
    ds_read_b128 v[112:115], v5 offset:43008
    v_cvt_pk_bf16_f32 v120, v56, v57
    v_mfma_f32_32x32x16_bf16 v[24:39], a[92:95], v[116:119], v[24:39]
    v_cvt_pk_bf16_f32 v121, v58, v59
    s_waitcnt lgkmcnt(3)
    v_mfma_f32_32x32x16_bf16 v[8:23], a[32:35], v[104:107], v[8:23]
    ds_read_b128 v[116:119], v5 offset:44032
    v_cvt_pk_bf16_f32 v122, v60, v61
    v_mfma_f32_32x32x16_bf16 v[24:39], a[96:99], v[104:107], v[24:39]
    v_cvt_pk_bf16_f32 v123, v62, v63
    s_waitcnt lgkmcnt(3)
    v_mfma_f32_32x32x16_bf16 v[8:23], a[36:39], v[108:111], v[8:23]
    ds_read_b128 v[104:107], v5 offset:45056
    ds_write_b128 v6, v[120:123] offset:16960
    v_mfma_f32_32x32x16_bf16 v[24:39], a[100:103], v[108:111], v[24:39]
    v_cvt_pk_bf16_f32 v124, v64, v65
    s_waitcnt lgkmcnt(3)
    v_mfma_f32_32x32x16_bf16 v[8:23], a[40:43], v[112:115], v[8:23]
    ds_read_b128 v[108:111], v5 offset:46080
    v_cvt_pk_bf16_f32 v125, v66, v67
    v_mfma_f32_32x32x16_bf16 v[24:39], a[104:107], v[112:115], v[24:39]
    v_cvt_pk_bf16_f32 v126, v68, v69
    s_waitcnt lgkmcnt(3)
    v_mfma_f32_32x32x16_bf16 v[8:23], a[44:47], v[116:119], v[8:23]
    ds_read_b128 v[112:115], v5 offset:47104
    v_cvt_pk_bf16_f32 v127, v70, v71
    v_mfma_f32_32x32x16_bf16 v[24:39], a[108:111], v[116:119], v[24:39]
    ds_write_b128 v6, v[124:127] offset:16992
    s_waitcnt lgkmcnt(4)
    v_mfma_f32_32x32x16_bf16 v[8:23], a[48:51], v[104:107], v[8:23]
    ds_read_b128 v[116:119], v5 offset:48128
    v_mfma_f32_32x32x16_bf16 v[24:39], a[112:115], v[104:107], v[24:39]
    s_waitcnt lgkmcnt(3)
    v_mfma_f32_32x32x16_bf16 v[8:23], a[52:55], v[108:111], v[8:23]
    ds_read_b128 v[104:107], v5 offset:0
    v_mfma_f32_32x32x16_bf16 v[24:39], a[116:119], v[108:111], v[24:39]
    s_waitcnt lgkmcnt(3)
    v_mfma_f32_32x32x16_bf16 v[8:23], a[56:59], v[112:115], v[8:23]
    ds_read_b128 v[108:111], v5 offset:1024
    v_mfma_f32_32x32x16_bf16 v[24:39], a[120:123], v[112:115], v[24:39]
    s_waitcnt lgkmcnt(2)
    v_mfma_f32_32x32x16_bf16 v[8:23], a[60:63], v[116:119], v[8:23]
    ds_read_b128 v[112:115], v5 offset:2048
    v_mfma_f32_32x32x16_bf16 v[24:39], a[124:127], v[116:119], v[24:39]
    s_barrier
    s_waitcnt lgkmcnt(2)
    v_mfma_f32_32x32x16_bf16 v[40:55], a[0:3], v[104:107], v[72:87]
    ds_read_b128 v[116:119], v5 offset:3072
    v_mfma_f32_32x32x16_bf16 v[56:71], a[64:67], v[104:107], v[88:103]
    s_waitcnt lgkmcnt(2)
    v_mfma_f32_32x32x16_bf16 v[40:55], a[4:7], v[108:111], v[40:55]
    ds_read_b128 v[104:107], v5 offset:4096
    v_mfma_f32_32x32x16_bf16 v[56:71], a[68:71], v[108:111], v[56:71]
    s_waitcnt lgkmcnt(2)
    v_mfma_f32_32x32x16_bf16 v[40:55], a[8:11], v[112:115], v[40:55]
    ds_read_b128 v[108:111], v5 offset:5120
    v_cvt_pk_bf16_f32 v120, v8, v9
    v_mfma_f32_32x32x16_bf16 v[56:71], a[72:75], v[112:115], v[56:71]
    v_cvt_pk_bf16_f32 v121, v10, v11
    s_waitcnt lgkmcnt(2)
    v_mfma_f32_32x32x16_bf16 v[40:55], a[12:15], v[116:119], v[40:55]
    ds_read_b128 v[112:115], v5 offset:6144
    v_cvt_pk_bf16_f32 v122, v12, v13
    v_mfma_f32_32x32x16_bf16 v[56:71], a[76:79], v[116:119], v[56:71]
    v_cvt_pk_bf16_f32 v123, v14, v15
    s_waitcnt lgkmcnt(2)
    v_mfma_f32_32x32x16_bf16 v[40:55], a[16:19], v[104:107], v[40:55]
    ds_read_b128 v[116:119], v5 offset:7168
    ds_write_b128 v6, v[120:123] offset:0
    v_mfma_f32_32x32x16_bf16 v[56:71], a[80:83], v[104:107], v[56:71]
    v_cvt_pk_bf16_f32 v124, v16, v17
    s_waitcnt lgkmcnt(3)
    v_mfma_f32_32x32x16_bf16 v[40:55], a[20:23], v[108:111], v[40:55]
    ds_read_b128 v[104:107], v5 offset:8192
    v_cvt_pk_bf16_f32 v125, v18, v19
    v_mfma_f32_32x32x16_bf16 v[56:71], a[84:87], v[108:111], v[56:71]
    v_cvt_pk_bf16_f32 v126, v20, v21
    s_waitcnt lgkmcnt(3)
    v_mfma_f32_32x32x16_bf16 v[40:55], a[24:27], v[112:115], v[40:55]
    ds_read_b128 v[108:111], v5 offset:9216
    v_cvt_pk_bf16_f32 v127, v22, v23
    v_mfma_f32_32x32x16_bf16 v[56:71], a[88:91], v[112:115], v[56:71]
    ds_write_b128 v6, v[124:127] offset:32
    s_waitcnt lgkmcnt(4)
    v_mfma_f32_32x32x16_bf16 v[40:55], a[28:31], v[116:119], v[40:55]
    ds_read_b128 v[112:115], v5 offset:10240
    v_cvt_pk_bf16_f32 v120, v24, v25
    v_mfma_f32_32x32x16_bf16 v[56:71], a[92:95], v[116:119], v[56:71]
    v_cvt_pk_bf16_f32 v121, v26, v27
    s_waitcnt lgkmcnt(3)
    v_mfma_f32_32x32x16_bf16 v[40:55], a[32:35], v[104:107], v[40:55]
    ds_read_b128 v[116:119], v5 offset:11264
    v_cvt_pk_bf16_f32 v122, v28, v29
    v_mfma_f32_32x32x16_bf16 v[56:71], a[96:99], v[104:107], v[56:71]
    v_cvt_pk_bf16_f32 v123, v30, v31
    s_waitcnt lgkmcnt(3)
    v_mfma_f32_32x32x16_bf16 v[40:55], a[36:39], v[108:111], v[40:55]
    ds_read_b128 v[104:107], v5 offset:12288
    ds_write_b128 v6, v[120:123] offset:64
    v_mfma_f32_32x32x16_bf16 v[56:71], a[100:103], v[108:111], v[56:71]
    v_cvt_pk_bf16_f32 v124, v32, v33
    s_waitcnt lgkmcnt(3)
    v_mfma_f32_32x32x16_bf16 v[40:55], a[40:43], v[112:115], v[40:55]
    ds_read_b128 v[108:111], v5 offset:13312
    v_cvt_pk_bf16_f32 v125, v34, v35
    v_mfma_f32_32x32x16_bf16 v[56:71], a[104:107], v[112:115], v[56:71]
    v_cvt_pk_bf16_f32 v126, v36, v37
    s_waitcnt lgkmcnt(3)
    v_mfma_f32_32x32x16_bf16 v[40:55], a[44:47], v[116:119], v[40:55]
    ds_read_b128 v[112:115], v5 offset:14336
    v_cvt_pk_bf16_f32 v127, v38, v39
    v_mfma_f32_32x32x16_bf16 v[56:71], a[108:111], v[116:119], v[56:71]
    ds_write_b128 v6, v[124:127] offset:96
    s_waitcnt lgkmcnt(4)
    v_mfma_f32_32x32x16_bf16 v[40:55], a[48:51], v[104:107], v[40:55]
    ds_read_b128 v[116:119], v5 offset:15360
    v_mfma_f32_32x32x16_bf16 v[56:71], a[112:115], v[104:107], v[56:71]
    s_waitcnt lgkmcnt(3)
    v_mfma_f32_32x32x16_bf16 v[40:55], a[52:55], v[108:111], v[40:55]
    ds_read_b128 v[104:107], v5 offset:16384
    v_mfma_f32_32x32x16_bf16 v[56:71], a[116:119], v[108:111], v[56:71]
    s_waitcnt lgkmcnt(3)
    v_mfma_f32_32x32x16_bf16 v[40:55], a[56:59], v[112:115], v[40:55]
    ds_read_b128 v[108:111], v5 offset:17408
    v_mfma_f32_32x32x16_bf16 v[56:71], a[120:123], v[112:115], v[56:71]
    s_waitcnt lgkmcnt(2)
    v_mfma_f32_32x32x16_bf16 v[40:55], a[60:63], v[116:119], v[40:55]
    ds_read_b128 v[112:115], v5 offset:18432
    v_mfma_f32_32x32x16_bf16 v[56:71], a[124:127], v[116:119], v[56:71]
    s_barrier
    s_waitcnt lgkmcnt(2)
    v_mfma_f32_32x32x16_bf16 v[8:23], a[0:3], v[104:107], v[72:87]
    ds_read_b128 v[116:119], v5 offset:19456
    v_mfma_f32_32x32x16_bf16 v[24:39], a[64:67], v[104:107], v[88:103]
    s_waitcnt lgkmcnt(2)
    v_mfma_f32_32x32x16_bf16 v[8:23], a[4:7], v[108:111], v[8:23]
    ds_read_b128 v[104:107], v5 offset:20480
    v_mfma_f32_32x32x16_bf16 v[24:39], a[68:71], v[108:111], v[24:39]
    s_waitcnt lgkmcnt(2)
    v_mfma_f32_32x32x16_bf16 v[8:23], a[8:11], v[112:115], v[8:23]
    ds_read_b128 v[108:111], v5 offset:21504
    v_cvt_pk_bf16_f32 v120, v40, v41
    v_mfma_f32_32x32x16_bf16 v[24:39], a[72:75], v[112:115], v[24:39]
    v_cvt_pk_bf16_f32 v121, v42, v43
    s_waitcnt lgkmcnt(2)
    v_mfma_f32_32x32x16_bf16 v[8:23], a[12:15], v[116:119], v[8:23]
    ds_read_b128 v[112:115], v5 offset:22528
    v_cvt_pk_bf16_f32 v122, v44, v45
    v_mfma_f32_32x32x16_bf16 v[24:39], a[76:79], v[116:119], v[24:39]
    v_cvt_pk_bf16_f32 v123, v46, v47
    s_waitcnt lgkmcnt(2)
    v_mfma_f32_32x32x16_bf16 v[8:23], a[16:19], v[104:107], v[8:23]
    ds_read_b128 v[116:119], v5 offset:23552
    ds_write_b128 v6, v[120:123] offset:16896
    v_mfma_f32_32x32x16_bf16 v[24:39], a[80:83], v[104:107], v[24:39]
    v_cvt_pk_bf16_f32 v124, v48, v49
    s_waitcnt lgkmcnt(3)
    v_mfma_f32_32x32x16_bf16 v[8:23], a[20:23], v[108:111], v[8:23]
    ds_read_b128 v[104:107], v5 offset:24576
    v_cvt_pk_bf16_f32 v125, v50, v51
    v_mfma_f32_32x32x16_bf16 v[24:39], a[84:87], v[108:111], v[24:39]
    v_cvt_pk_bf16_f32 v126, v52, v53
    s_waitcnt lgkmcnt(3)
    v_mfma_f32_32x32x16_bf16 v[8:23], a[24:27], v[112:115], v[8:23]
    ds_read_b128 v[108:111], v5 offset:25600
    v_cvt_pk_bf16_f32 v127, v54, v55
    v_mfma_f32_32x32x16_bf16 v[24:39], a[88:91], v[112:115], v[24:39]
    ds_write_b128 v6, v[124:127] offset:16928
    s_waitcnt lgkmcnt(4)
    v_mfma_f32_32x32x16_bf16 v[8:23], a[28:31], v[116:119], v[8:23]
    ds_read_b128 v[112:115], v5 offset:26624
    v_cvt_pk_bf16_f32 v120, v56, v57
    v_mfma_f32_32x32x16_bf16 v[24:39], a[92:95], v[116:119], v[24:39]
    v_cvt_pk_bf16_f32 v121, v58, v59
    s_waitcnt lgkmcnt(3)
    v_mfma_f32_32x32x16_bf16 v[8:23], a[32:35], v[104:107], v[8:23]
    ds_read_b128 v[116:119], v5 offset:27648
    v_cvt_pk_bf16_f32 v122, v60, v61
    v_mfma_f32_32x32x16_bf16 v[24:39], a[96:99], v[104:107], v[24:39]
    v_cvt_pk_bf16_f32 v123, v62, v63
    s_waitcnt lgkmcnt(3)
    v_mfma_f32_32x32x16_bf16 v[8:23], a[36:39], v[108:111], v[8:23]
    ds_read_b128 v[104:107], v5 offset:28672
    ds_write_b128 v6, v[120:123] offset:16960
    v_mfma_f32_32x32x16_bf16 v[24:39], a[100:103], v[108:111], v[24:39]
    v_cvt_pk_bf16_f32 v124, v64, v65
    s_waitcnt lgkmcnt(3)
    v_mfma_f32_32x32x16_bf16 v[8:23], a[40:43], v[112:115], v[8:23]
    ds_read_b128 v[108:111], v5 offset:29696
    v_cvt_pk_bf16_f32 v125, v66, v67
    v_mfma_f32_32x32x16_bf16 v[24:39], a[104:107], v[112:115], v[24:39]
    v_cvt_pk_bf16_f32 v126, v68, v69
    s_waitcnt lgkmcnt(3)
    v_mfma_f32_32x32x16_bf16 v[8:23], a[44:47], v[116:119], v[8:23]
    ds_read_b128 v[112:115], v5 offset:30720
    v_cvt_pk_bf16_f32 v127, v70, v71
    v_mfma_f32_32x32x16_bf16 v[24:39], a[108:111], v[116:119], v[24:39]
    ds_write_b128 v6, v[124:127] offset:16992
    s_waitcnt lgkmcnt(4)
    v_mfma_f32_32x32x16_bf16 v[8:23], a[48:51], v[104:107], v[8:23]
    ds_read_b128 v[116:119], v5 offset:31744
    v_mfma_f32_32x32x16_bf16 v[24:39], a[112:115], v[104:107], v[24:39]
    s_waitcnt lgkmcnt(3)
    v_mfma_f32_32x32x16_bf16 v[8:23], a[52:55], v[108:111], v[8:23]
    ds_read_b128 v[104:107], v5 offset:32768
    v_mfma_f32_32x32x16_bf16 v[24:39], a[116:119], v[108:111], v[24:39]
    s_waitcnt lgkmcnt(3)
    v_mfma_f32_32x32x16_bf16 v[8:23], a[56:59], v[112:115], v[8:23]
    ds_read_b128 v[108:111], v5 offset:33792
    v_mfma_f32_32x32x16_bf16 v[24:39], a[120:123], v[112:115], v[24:39]
    s_waitcnt lgkmcnt(2)
    v_mfma_f32_32x32x16_bf16 v[8:23], a[60:63], v[116:119], v[8:23]
    ds_read_b128 v[112:115], v5 offset:34816
    v_mfma_f32_32x32x16_bf16 v[24:39], a[124:127], v[116:119], v[24:39]
    s_barrier
    s_waitcnt lgkmcnt(2)
    v_mfma_f32_32x32x16_bf16 v[40:55], a[0:3], v[104:107], v[72:87]
    ds_read_b128 v[116:119], v5 offset:35840
    v_mfma_f32_32x32x16_bf16 v[56:71], a[64:67], v[104:107], v[88:103]
    s_waitcnt lgkmcnt(2)
    v_mfma_f32_32x32x16_bf16 v[40:55], a[4:7], v[108:111], v[40:55]
    ds_read_b128 v[104:107], v5 offset:36864
    v_mfma_f32_32x32x16_bf16 v[56:71], a[68:71], v[108:111], v[56:71]
    s_waitcnt lgkmcnt(2)
    v_mfma_f32_32x32x16_bf16 v[40:55], a[8:11], v[112:115], v[40:55]
    ds_read_b128 v[108:111], v5 offset:37888
    v_cvt_pk_bf16_f32 v120, v8, v9
    v_mfma_f32_32x32x16_bf16 v[56:71], a[72:75], v[112:115], v[56:71]
    v_cvt_pk_bf16_f32 v121, v10, v11
    s_waitcnt lgkmcnt(2)
    v_mfma_f32_32x32x16_bf16 v[40:55], a[12:15], v[116:119], v[40:55]
    ds_read_b128 v[112:115], v5 offset:38912
    v_cvt_pk_bf16_f32 v122, v12, v13
    v_mfma_f32_32x32x16_bf16 v[56:71], a[76:79], v[116:119], v[56:71]
    v_cvt_pk_bf16_f32 v123, v14, v15
    s_waitcnt lgkmcnt(2)
    v_mfma_f32_32x32x16_bf16 v[40:55], a[16:19], v[104:107], v[40:55]
    ds_read_b128 v[116:119], v5 offset:39936
    ds_write_b128 v6, v[120:123] offset:0
    v_mfma_f32_32x32x16_bf16 v[56:71], a[80:83], v[104:107], v[56:71]
    v_cvt_pk_bf16_f32 v124, v16, v17
    s_waitcnt lgkmcnt(3)
    v_mfma_f32_32x32x16_bf16 v[40:55], a[20:23], v[108:111], v[40:55]
    ds_read_b128 v[104:107], v5 offset:40960
    v_cvt_pk_bf16_f32 v125, v18, v19
    v_mfma_f32_32x32x16_bf16 v[56:71], a[84:87], v[108:111], v[56:71]
    v_cvt_pk_bf16_f32 v126, v20, v21
    s_waitcnt lgkmcnt(3)
    v_mfma_f32_32x32x16_bf16 v[40:55], a[24:27], v[112:115], v[40:55]
    ds_read_b128 v[108:111], v5 offset:41984
    v_cvt_pk_bf16_f32 v127, v22, v23
    v_mfma_f32_32x32x16_bf16 v[56:71], a[88:91], v[112:115], v[56:71]
    ds_write_b128 v6, v[124:127] offset:32
    s_waitcnt lgkmcnt(4)
    v_mfma_f32_32x32x16_bf16 v[40:55], a[28:31], v[116:119], v[40:55]
    ds_read_b128 v[112:115], v5 offset:43008
    v_cvt_pk_bf16_f32 v120, v24, v25
    v_mfma_f32_32x32x16_bf16 v[56:71], a[92:95], v[116:119], v[56:71]
    v_cvt_pk_bf16_f32 v121, v26, v27
    s_waitcnt lgkmcnt(3)
    v_mfma_f32_32x32x16_bf16 v[40:55], a[32:35], v[104:107], v[40:55]
    ds_read_b128 v[116:119], v5 offset:44032
    v_cvt_pk_bf16_f32 v122, v28, v29
    v_mfma_f32_32x32x16_bf16 v[56:71], a[96:99], v[104:107], v[56:71]
    v_cvt_pk_bf16_f32 v123, v30, v31
    s_waitcnt lgkmcnt(3)
    v_mfma_f32_32x32x16_bf16 v[40:55], a[36:39], v[108:111], v[40:55]
    ds_read_b128 v[104:107], v5 offset:45056
    ds_write_b128 v6, v[120:123] offset:64
    v_mfma_f32_32x32x16_bf16 v[56:71], a[100:103], v[108:111], v[56:71]
    v_cvt_pk_bf16_f32 v124, v32, v33
    s_waitcnt lgkmcnt(3)
    v_mfma_f32_32x32x16_bf16 v[40:55], a[40:43], v[112:115], v[40:55]
    ds_read_b128 v[108:111], v5 offset:46080
    v_cvt_pk_bf16_f32 v125, v34, v35
    v_mfma_f32_32x32x16_bf16 v[56:71], a[104:107], v[112:115], v[56:71]
    v_cvt_pk_bf16_f32 v126, v36, v37
    s_waitcnt lgkmcnt(3)
    v_mfma_f32_32x32x16_bf16 v[40:55], a[44:47], v[116:119], v[40:55]
    ds_read_b128 v[112:115], v5 offset:47104
    v_cvt_pk_bf16_f32 v127, v38, v39
    v_mfma_f32_32x32x16_bf16 v[56:71], a[108:111], v[116:119], v[56:71]
    ds_write_b128 v6, v[124:127] offset:96
    s_waitcnt lgkmcnt(4)
    v_mfma_f32_32x32x16_bf16 v[40:55], a[48:51], v[104:107], v[40:55]
    ds_read_b128 v[116:119], v5 offset:48128
    v_mfma_f32_32x32x16_bf16 v[56:71], a[112:115], v[104:107], v[56:71]
    s_waitcnt lgkmcnt(3)
    v_mfma_f32_32x32x16_bf16 v[40:55], a[52:55], v[108:111], v[40:55]
    ds_read_b128 v[104:107], v5 offset:0
    v_mfma_f32_32x32x16_bf16 v[56:71], a[116:119], v[108:111], v[56:71]
    s_waitcnt lgkmcnt(3)
    v_mfma_f32_32x32x16_bf16 v[40:55], a[56:59], v[112:115], v[40:55]
    ds_read_b128 v[108:111], v5 offset:1024
    v_mfma_f32_32x32x16_bf16 v[56:71], a[120:123], v[112:115], v[56:71]
    s_waitcnt lgkmcnt(2)
    v_mfma_f32_32x32x16_bf16 v[40:55], a[60:63], v[116:119], v[40:55]
    ds_read_b128 v[112:115], v5 offset:2048
    v_mfma_f32_32x32x16_bf16 v[56:71], a[124:127], v[116:119], v[56:71]
    s_barrier
    s_waitcnt lgkmcnt(2)
    v_mfma_f32_32x32x16_bf16 v[8:23], a[0:3], v[104:107], v[72:87]
    ds_read_b128 v[116:119], v5 offset:3072
    v_mfma_f32_32x32x16_bf16 v[24:39], a[64:67], v[104:107], v[88:103]
    s_waitcnt lgkmcnt(2)
    v_mfma_f32_32x32x16_bf16 v[8:23], a[4:7], v[108:111], v[8:23]
    ds_read_b128 v[104:107], v5 offset:4096
    v_mfma_f32_32x32x16_bf16 v[24:39], a[68:71], v[108:111], v[24:39]
    s_waitcnt lgkmcnt(2)
    v_mfma_f32_32x32x16_bf16 v[8:23], a[8:11], v[112:115], v[8:23]
    ds_read_b128 v[108:111], v5 offset:5120
    v_cvt_pk_bf16_f32 v120, v40, v41
    v_mfma_f32_32x32x16_bf16 v[24:39], a[72:75], v[112:115], v[24:39]
    v_cvt_pk_bf16_f32 v121, v42, v43
    s_waitcnt lgkmcnt(2)
    v_mfma_f32_32x32x16_bf16 v[8:23], a[12:15], v[116:119], v[8:23]
    ds_read_b128 v[112:115], v5 offset:6144
    v_cvt_pk_bf16_f32 v122, v44, v45
    v_mfma_f32_32x32x16_bf16 v[24:39], a[76:79], v[116:119], v[24:39]
    v_cvt_pk_bf16_f32 v123, v46, v47
    s_waitcnt lgkmcnt(2)
    v_mfma_f32_32x32x16_bf16 v[8:23], a[16:19], v[104:107], v[8:23]
    ds_read_b128 v[116:119], v5 offset:7168
    ds_write_b128 v6, v[120:123] offset:16896
    v_mfma_f32_32x32x16_bf16 v[24:39], a[80:83], v[104:107], v[24:39]
    v_cvt_pk_bf16_f32 v124, v48, v49
    s_waitcnt lgkmcnt(3)
    v_mfma_f32_32x32x16_bf16 v[8:23], a[20:23], v[108:111], v[8:23]
    ds_read_b128 v[104:107], v5 offset:8192
    v_cvt_pk_bf16_f32 v125, v50, v51
    v_mfma_f32_32x32x16_bf16 v[24:39], a[84:87], v[108:111], v[24:39]
    v_cvt_pk_bf16_f32 v126, v52, v53
    s_waitcnt lgkmcnt(3)
    v_mfma_f32_32x32x16_bf16 v[8:23], a[24:27], v[112:115], v[8:23]
    ds_read_b128 v[108:111], v5 offset:9216
    v_cvt_pk_bf16_f32 v127, v54, v55
    v_mfma_f32_32x32x16_bf16 v[24:39], a[88:91], v[112:115], v[24:39]
    ds_write_b128 v6, v[124:127] offset:16928
    s_waitcnt lgkmcnt(4)
    v_mfma_f32_32x32x16_bf16 v[8:23], a[28:31], v[116:119], v[8:23]
    ds_read_b128 v[112:115], v5 offset:10240
    v_cvt_pk_bf16_f32 v120, v56, v57
    v_mfma_f32_32x32x16_bf16 v[24:39], a[92:95], v[116:119], v[24:39]
    v_cvt_pk_bf16_f32 v121, v58, v59
    s_waitcnt lgkmcnt(3)
    v_mfma_f32_32x32x16_bf16 v[8:23], a[32:35], v[104:107], v[8:23]
    ds_read_b128 v[116:119], v5 offset:11264
    v_cvt_pk_bf16_f32 v122, v60, v61
    v_mfma_f32_32x32x16_bf16 v[24:39], a[96:99], v[104:107], v[24:39]
    v_cvt_pk_bf16_f32 v123, v62, v63
    s_waitcnt lgkmcnt(3)
    v_mfma_f32_32x32x16_bf16 v[8:23], a[36:39], v[108:111], v[8:23]
    ds_read_b128 v[104:107], v5 offset:12288
    ds_write_b128 v6, v[120:123] offset:16960
    v_mfma_f32_32x32x16_bf16 v[24:39], a[100:103], v[108:111], v[24:39]
    v_cvt_pk_bf16_f32 v124, v64, v65
    s_waitcnt lgkmcnt(3)
    v_mfma_f32_32x32x16_bf16 v[8:23], a[40:43], v[112:115], v[8:23]
    ds_read_b128 v[108:111], v5 offset:13312
    v_cvt_pk_bf16_f32 v125, v66, v67
    v_mfma_f32_32x32x16_bf16 v[24:39], a[104:107], v[112:115], v[24:39]
    v_cvt_pk_bf16_f32 v126, v68, v69
    s_waitcnt lgkmcnt(3)
    v_mfma_f32_32x32x16_bf16 v[8:23], a[44:47], v[116:119], v[8:23]
    ds_read_b128 v[112:115], v5 offset:14336
    v_cvt_pk_bf16_f32 v127, v70, v71
    v_mfma_f32_32x32x16_bf16 v[24:39], a[108:111], v[116:119], v[24:39]
    ds_write_b128 v6, v[124:127] offset:16992
    s_waitcnt lgkmcnt(4)
    v_mfma_f32_32x32x16_bf16 v[8:23], a[48:51], v[104:107], v[8:23]
    ds_read_b128 v[116:119], v5 offset:15360
    v_mfma_f32_32x32x16_bf16 v[24:39], a[112:115], v[104:107], v[24:39]
    s_waitcnt lgkmcnt(3)
    v_mfma_f32_32x32x16_bf16 v[8:23], a[52:55], v[108:111], v[8:23]
    ds_read_b128 v[104:107], v5 offset:16384
    v_mfma_f32_32x32x16_bf16 v[24:39], a[116:119], v[108:111], v[24:39]
    s_waitcnt lgkmcnt(3)
    v_mfma_f32_32x32x16_bf16 v[8:23], a[56:59], v[112:115], v[8:23]
    ds_read_b128 v[108:111], v5 offset:17408
    v_mfma_f32_32x32x16_bf16 v[24:39], a[120:123], v[112:115], v[24:39]
    s_waitcnt lgkmcnt(2)
    v_mfma_f32_32x32x16_bf16 v[8:23], a[60:63], v[116:119], v[8:23]
    ds_read_b128 v[112:115], v5 offset:18432
    v_mfma_f32_32x32x16_bf16 v[24:39], a[124:127], v[116:119], v[24:39]
    s_barrier
    s_waitcnt lgkmcnt(2)
    v_mfma_f32_32x32x16_bf16 v[40:55], a[0:3], v[104:107], v[72:87]
    ds_read_b128 v[116:119], v5 offset:19456
    v_mfma_f32_32x32x16_bf16 v[56:71], a[64:67], v[104:107], v[88:103]
    s_waitcnt lgkmcnt(2)
    v_mfma_f32_32x32x16_bf16 v[40:55], a[4:7], v[108:111], v[40:55]
    ds_read_b128 v[104:107], v5 offset:20480
    v_mfma_f32_32x32x16_bf16 v[56:71], a[68:71], v[108:111], v[56:71]
    s_waitcnt lgkmcnt(2)
    v_mfma_f32_32x32x16_bf16 v[40:55], a[8:11], v[112:115], v[40:55]
    ds_read_b128 v[108:111], v5 offset:21504
    v_cvt_pk_bf16_f32 v120, v8, v9
    v_mfma_f32_32x32x16_bf16 v[56:71], a[72:75], v[112:115], v[56:71]
    v_cvt_pk_bf16_f32 v121, v10, v11
    s_waitcnt lgkmcnt(2)
    v_mfma_f32_32x32x16_bf16 v[40:55], a[12:15], v[116:119], v[40:55]
    ds_read_b128 v[112:115], v5 offset:22528
    v_cvt_pk_bf16_f32 v122, v12, v13
    v_mfma_f32_32x32x16_bf16 v[56:71], a[76:79], v[116:119], v[56:71]
    v_cvt_pk_bf16_f32 v123, v14, v15
    s_waitcnt lgkmcnt(2)
    v_mfma_f32_32x32x16_bf16 v[40:55], a[16:19], v[104:107], v[40:55]
    ds_read_b128 v[116:119], v5 offset:23552
    ds_write_b128 v6, v[120:123] offset:0
    v_mfma_f32_32x32x16_bf16 v[56:71], a[80:83], v[104:107], v[56:71]
    v_cvt_pk_bf16_f32 v124, v16, v17
    s_waitcnt lgkmcnt(3)
    v_mfma_f32_32x32x16_bf16 v[40:55], a[20:23], v[108:111], v[40:55]
    ds_read_b128 v[104:107], v5 offset:24576
    v_cvt_pk_bf16_f32 v125, v18, v19
    v_mfma_f32_32x32x16_bf16 v[56:71], a[84:87], v[108:111], v[56:71]
    v_cvt_pk_bf16_f32 v126, v20, v21
    s_waitcnt lgkmcnt(3)
    v_mfma_f32_32x32x16_bf16 v[40:55], a[24:27], v[112:115], v[40:55]
    ds_read_b128 v[108:111], v5 offset:25600
    v_cvt_pk_bf16_f32 v127, v22, v23
    v_mfma_f32_32x32x16_bf16 v[56:71], a[88:91], v[112:115], v[56:71]
    ds_write_b128 v6, v[124:127] offset:32
    s_waitcnt lgkmcnt(4)
    v_mfma_f32_32x32x16_bf16 v[40:55], a[28:31], v[116:119], v[40:55]
    ds_read_b128 v[112:115], v5 offset:26624
    v_cvt_pk_bf16_f32 v120, v24, v25
    v_mfma_f32_32x32x16_bf16 v[56:71], a[92:95], v[116:119], v[56:71]
    v_cvt_pk_bf16_f32 v121, v26, v27
    s_waitcnt lgkmcnt(3)
    v_mfma_f32_32x32x16_bf16 v[40:55], a[32:35], v[104:107], v[40:55]
    ds_read_b128 v[116:119], v5 offset:27648
    v_cvt_pk_bf16_f32 v122, v28, v29
    v_mfma_f32_32x32x16_bf16 v[56:71], a[96:99], v[104:107], v[56:71]
    v_cvt_pk_bf16_f32 v123, v30, v31
    s_waitcnt lgkmcnt(3)
    v_mfma_f32_32x32x16_bf16 v[40:55], a[36:39], v[108:111], v[40:55]
    ds_read_b128 v[104:107], v5 offset:28672
    ds_write_b128 v6, v[120:123] offset:64
    v_mfma_f32_32x32x16_bf16 v[56:71], a[100:103], v[108:111], v[56:71]
    v_cvt_pk_bf16_f32 v124, v32, v33
    s_waitcnt lgkmcnt(3)
    v_mfma_f32_32x32x16_bf16 v[40:55], a[40:43], v[112:115], v[40:55]
    ds_read_b128 v[108:111], v5 offset:29696
    v_cvt_pk_bf16_f32 v125, v34, v35
    v_mfma_f32_32x32x16_bf16 v[56:71], a[104:107], v[112:115], v[56:71]
    v_cvt_pk_bf16_f32 v126, v36, v37
    s_waitcnt lgkmcnt(3)
    v_mfma_f32_32x32x16_bf16 v[40:55], a[44:47], v[116:119], v[40:55]
    ds_read_b128 v[112:115], v5 offset:30720
    v_cvt_pk_bf16_f32 v127, v38, v39
    v_mfma_f32_32x32x16_bf16 v[56:71], a[108:111], v[116:119], v[56:71]
    ds_write_b128 v6, v[124:127] offset:96
    s_waitcnt lgkmcnt(4)
    v_mfma_f32_32x32x16_bf16 v[40:55], a[48:51], v[104:107], v[40:55]
    ds_read_b128 v[116:119], v5 offset:31744
    v_mfma_f32_32x32x16_bf16 v[56:71], a[112:115], v[104:107], v[56:71]
    s_waitcnt lgkmcnt(3)
    v_mfma_f32_32x32x16_bf16 v[40:55], a[52:55], v[108:111], v[40:55]
    v_mfma_f32_32x32x16_bf16 v[56:71], a[116:119], v[108:111], v[56:71]
    s_waitcnt lgkmcnt(2)
    v_mfma_f32_32x32x16_bf16 v[40:55], a[56:59], v[112:115], v[40:55]
    v_mfma_f32_32x32x16_bf16 v[56:71], a[120:123], v[112:115], v[56:71]
    s_waitcnt lgkmcnt(0)
    v_mfma_f32_32x32x16_bf16 v[40:55], a[60:63], v[116:119], v[40:55]
    v_mfma_f32_32x32x16_bf16 v[56:71], a[124:127], v[116:119], v[56:71]
    s_barrier
    s_nop 7
    s_nop 7
    v_cvt_pk_bf16_f32 v120, v40, v41
    v_cvt_pk_bf16_f32 v121, v42, v43
    v_cvt_pk_bf16_f32 v122, v44, v45
    v_cvt_pk_bf16_f32 v123, v46, v47
    ds_write_b128 v6, v[120:123] offset:16896
    v_cvt_pk_bf16_f32 v124, v48, v49
    v_cvt_pk_bf16_f32 v125, v50, v51
    v_cvt_pk_bf16_f32 v126, v52, v53
    v_cvt_pk_bf16_f32 v127, v54, v55
    ds_write_b128 v6, v[124:127] offset:16928
    v_cvt_pk_bf16_f32 v120, v56, v57
    v_cvt_pk_bf16_f32 v121, v58, v59
    v_cvt_pk_bf16_f32 v122, v60, v61
    v_cvt_pk_bf16_f32 v123, v62, v63
    ds_write_b128 v6, v[120:123] offset:16960
    v_cvt_pk_bf16_f32 v124, v64, v65
    v_cvt_pk_bf16_f32 v125, v66, v67
    v_cvt_pk_bf16_f32 v126, v68, v69
    v_cvt_pk_bf16_f32 v127, v70, v71
    ds_write_b128 v6, v[124:127] offset:16992
    s_waitcnt lgkmcnt(0)
    s_barrier
    s_endpgm
L_joint_kernel_helper:
    v_and_b32 v14, 7, v1
    v_lshlrev_b32 v14, 10, v14
    v_lshrrev_b32 v15, 5, v1
    v_lshl_add_u32 v14, v15, 4, v14
    s_lshl_b32 s36, s24, 13
    s_lshl_b32 s37, s21, 8
    s_add_u32 s36, s36, s37
    s_add_u32 s37, s36, 16384
    buffer_load_dwordx4 v[96:99], v14, s[12:15], s37 offen offset:0
    buffer_load_dwordx4 v[100:103], v14, s[12:15], s37 offen offset:32
    buffer_load_dwordx4 v[104:107], v14, s[12:15], s37 offen offset:64
    buffer_load_dwordx4 v[108:111], v14, s[12:15], s37 offen offset:96
    buffer_load_dwordx4 v[112:115], v14, s[12:15], s37 offen offset:128
    buffer_load_dwordx4 v[116:119], v14, s[12:15], s37 offen offset:160
    buffer_load_dwordx4 v[120:123], v14, s[12:15], s37 offen offset:192
    buffer_load_dwordx4 v[124:127], v14, s[12:15], s37 offen offset:224
    s_add_u32 s36, s38, 32768
    buffer_load_dwordx4 a[0:3], v5, s[12:15], s36 offen
    s_add_u32 s36, s38, 49152
    buffer_load_dwordx4 a[64:67], v5, s[12:15], s36 offen
    s_add_u32 s36, s38, 33792
    buffer_load_dwordx4 a[4:7], v5, s[12:15], s36 offen
    s_add_u32 s36, s38, 50176
    buffer_load_dwordx4 a[68:71], v5, s[12:15], s36 offen
    s_add_u32 s36, s38, 34816
    buffer_load_dwordx4 a[8:11], v5, s[12:15], s36 offen
    s_add_u32 s36, s38, 51200
    buffer_load_dwordx4 a[72:75], v5, s[12:15], s36 offen
    s_add_u32 s36, s38, 35840
    buffer_load_dwordx4 a[12:15], v5, s[12:15], s36 offen
    s_add_u32 s36, s38, 52224
    buffer_load_dwordx4 a[76:79], v5, s[12:15], s36 offen
    s_add_u32 s36, s38, 36864
    buffer_load_dwordx4 a[16:19], v5, s[12:15], s36 offen
    s_add_u32 s36, s38, 53248
    buffer_load_dwordx4 a[80:83], v5, s[12:15], s36 offen
    s_add_u32 s36, s38, 37888
    buffer_load_dwordx4 a[20:23], v5, s[12:15], s36 offen
    s_add_u32 s36, s38, 54272
    buffer_load_dwordx4 a[84:87], v5, s[12:15], s36 offen
    s_add_u32 s36, s38, 38912
    buffer_load_dwordx4 a[24:27], v5, s[12:15], s36 offen
    s_add_u32 s36, s38, 55296
    buffer_load_dwordx4 a[88:91], v5, s[12:15], s36 offen
    s_add_u32 s36, s38, 39936
    buffer_load_dwordx4 a[28:31], v5, s[12:15], s36 offen
    s_add_u32 s36, s38, 56320
    buffer_load_dwordx4 a[92:95], v5, s[12:15], s36 offen
    s_add_u32 s36, s38, 40960
    buffer_load_dwordx4 a[32:35], v5, s[12:15], s36 offen
    s_add_u32 s36, s38, 57344
    buffer_load_dwordx4 a[96:99], v5, s[12:15], s36 offen
    s_add_u32 s36, s38, 41984
    buffer_load_dwordx4 a[36:39], v5, s[12:15], s36 offen
    s_add_u32 s36, s38, 58368
    buffer_load_dwordx4 a[100:103], v5, s[12:15], s36 offen
    s_add_u32 s36, s38, 43008
    buffer_load_dwordx4 a[40:43], v5, s[12:15], s36 offen
    s_add_u32 s36, s38, 59392
    buffer_load_dwordx4 a[104:107], v5, s[12:15], s36 offen
    s_add_u32 s36, s38, 44032
    buffer_load_dwordx4 a[44:47], v5, s[12:15], s36 offen
    s_add_u32 s36, s38, 60416
    buffer_load_dwordx4 a[108:111], v5, s[12:15], s36 offen
    s_add_u32 s36, s38, 45056
    buffer_load_dwordx4 a[48:51], v5, s[12:15], s36 offen
    s_add_u32 s36, s38, 61440
    buffer_load_dwordx4 a[112:115], v5, s[12:15], s36 offen
    s_add_u32 s36, s38, 46080
    buffer_load_dwordx4 a[52:55], v5, s[12:15], s36 offen
    s_add_u32 s36, s38, 62464
    buffer_load_dwordx4 a[116:119], v5, s[12:15], s36 offen
    s_add_u32 s36, s38, 47104
    buffer_load_dwordx4 a[56:59], v5, s[12:15], s36 offen
    s_add_u32 s36, s38, 63488
    buffer_load_dwordx4 a[120:123], v5, s[12:15], s36 offen
    s_add_u32 s36, s38, 48128
    buffer_load_dwordx4 a[60:63], v5, s[12:15], s36 offen
    s_add_u32 s36, s38, 64512
    buffer_load_dwordx4 a[124:127], v5, s[12:15], s36 offen
    s_waitcnt vmcnt(32)
    v_max3_f32 v8, |v96|, |v97|, |v98|
    v_max3_f32 v8, v8, |v99|, |v100|
    v_max3_f32 v8, v8, |v101|, |v102|
    v_max3_f32 v8, v8, |v103|, |v104|
    v_max3_f32 v8, v8, |v105|, |v106|
    v_max3_f32 v8, v8, |v107|, |v108|
    v_max3_f32 v8, v8, |v109|, |v110|
    v_max3_f32 v8, v8, |v111|, |v112|
    v_max3_f32 v8, v8, |v113|, |v114|
    v_max3_f32 v8, v8, |v115|, |v116|
    v_max3_f32 v8, v8, |v117|, |v118|
    v_max3_f32 v8, v8, |v119|, |v120|
    v_max3_f32 v8, v8, |v121|, |v122|
    v_max3_f32 v8, v8, |v123|, |v124|
    v_max3_f32 v8, v8, |v125|, |v126|
    v_max_f32 v8, v8, |v127|
    s_mov_b32 s41, 0x42a80000
    v_cmp_lt_f32 s[42:43], s41, v8
    v_exp_f32 v96, v96
    v_exp_f32 v97, v97
    v_exp_f32 v98, v98
    v_exp_f32 v99, v99
    v_exp_f32 v100, v100
    v_exp_f32 v101, v101
    v_exp_f32 v102, v102
    v_exp_f32 v103, v103
    v_exp_f32 v104, v104
    v_exp_f32 v105, v105
    v_exp_f32 v106, v106
    v_exp_f32 v107, v107
    v_exp_f32 v108, v108
    v_exp_f32 v109, v109
    v_exp_f32 v110, v110
    v_exp_f32 v111, v111
    v_exp_f32 v112, v112
    v_exp_f32 v113, v113
    v_exp_f32 v114, v114
    v_exp_f32 v115, v115
    v_exp_f32 v116, v116
    v_exp_f32 v117, v117
    v_exp_f32 v118, v118
    v_exp_f32 v119, v119
    v_exp_f32 v120, v120
    v_exp_f32 v121, v121
    v_exp_f32 v122, v122
    v_exp_f32 v123, v123
    v_exp_f32 v124, v124
    v_exp_f32 v125, v125
    v_exp_f32 v126, v126
    v_exp_f32 v127, v127
    s_barrier
    v_add_u32 v7, 65536, v5
    ds_read_b128 v[64:67], v7 offset:0
    ds_read_b128 v[68:71], v7 offset:1024
    ds_read_b128 v[72:75], v7 offset:2048
    ds_read_b128 v[76:79], v7 offset:3072
    ds_read_b128 v[80:83], v7 offset:4096
    ds_read_b128 v[84:87], v7 offset:5120
    ds_read_b128 v[88:91], v7 offset:6144
    ds_read_b128 v[92:95], v7 offset:7168
    s_waitcnt vmcnt(30) lgkmcnt(7)
    v_mfma_f32_32x32x16_bf16 v[32:47], a[0:3], v[64:67], 0
    v_mfma_f32_32x32x16_bf16 v[48:63], a[64:67], v[64:67], 0
    s_waitcnt vmcnt(28) lgkmcnt(6)
    v_mfma_f32_32x32x16_bf16 v[32:47], a[4:7], v[68:71], v[32:47]
    v_mfma_f32_32x32x16_bf16 v[48:63], a[68:71], v[68:71], v[48:63]
    ds_read_b128 v[64:67], v7 offset:8192
    s_waitcnt vmcnt(26) lgkmcnt(6)
    v_mfma_f32_32x32x16_bf16 v[32:47], a[8:11], v[72:75], v[32:47]
    v_mfma_f32_32x32x16_bf16 v[48:63], a[72:75], v[72:75], v[48:63]
    ds_read_b128 v[68:71], v7 offset:9216
    s_waitcnt vmcnt(24) lgkmcnt(6)
    v_mfma_f32_32x32x16_bf16 v[32:47], a[12:15], v[76:79], v[32:47]
    v_mfma_f32_32x32x16_bf16 v[48:63], a[76:79], v[76:79], v[48:63]
    ds_read_b128 v[72:75], v7 offset:10240
    s_waitcnt vmcnt(22) lgkmcnt(6)
    v_mfma_f32_32x32x16_bf16 v[32:47], a[16:19], v[80:83], v[32:47]
    v_mfma_f32_32x32x16_bf16 v[48:63], a[80:83], v[80:83], v[48:63]
    ds_read_b128 v[76:79], v7 offset:11264
    s_waitcnt vmcnt(20) lgkmcnt(6)
    v_mfma_f32_32x32x16_bf16 v[32:47], a[20:23], v[84:87], v[32:47]
    v_mfma_f32_32x32x16_bf16 v[48:63], a[84:87], v[84:87], v[48:63]
    ds_read_b128 v[80:83], v7 offset:12288
    s_waitcnt vmcnt(18) lgkmcnt(6)
    v_mfma_f32_32x32x16_bf16 v[32:47], a[24:27], v[88:91], v[32:47]
    v_mfma_f32_32x32x16_bf16 v[48:63], a[88:91], v[88:91], v[48:63]
    ds_read_b128 v[84:87], v7 offset:13312
    s_waitcnt vmcnt(16) lgkmcnt(6)
    v_mfma_f32_32x32x16_bf16 v[32:47], a[28:31], v[92:95], v[32:47]
    v_mfma_f32_32x32x16_bf16 v[48:63], a[92:95], v[92:95], v[48:63]
    ds_read_b128 v[88:91], v7 offset:14336
    s_waitcnt vmcnt(14) lgkmcnt(6)
    v_mfma_f32_32x32x16_bf16 v[32:47], a[32:35], v[64:67], v[32:47]
    v_mfma_f32_32x32x16_bf16 v[48:63], a[96:99], v[64:67], v[48:63]
    ds_read_b128 v[92:95], v7 offset:15360
    s_waitcnt vmcnt(12) lgkmcnt(6)
    v_mfma_f32_32x32x16_bf16 v[32:47], a[36:39], v[68:71], v[32:47]
    v_mfma_f32_32x32x16_bf16 v[48:63], a[100:103], v[68:71], v[48:63]
    s_waitcnt vmcnt(10) lgkmcnt(5)
    v_mfma_f32_32x32x16_bf16 v[32:47], a[40:43], v[72:75], v[32:47]
    v_mfma_f32_32x32x16_bf16 v[48:63], a[104:107], v[72:75], v[48:63]
    s_waitcnt vmcnt(8) lgkmcnt(4)
    v_mfma_f32_32x32x16_bf16 v[32:47], a[44:47], v[76:79], v[32:47]
    v_mfma_f32_32x32x16_bf16 v[48:63], a[108:111], v[76:79], v[48:63]
    s_waitcnt vmcnt(6) lgkmcnt(3)
    v_mfma_f32_32x32x16_bf16 v[32:47], a[48:51], v[80:83], v[32:47]
    v_mfma_f32_32x32x16_bf16 v[48:63], a[112:115], v[80:83], v[48:63]
    s_waitcnt vmcnt(4) lgkmcnt(2)
    v_mfma_f32_32x32x16_bf16 v[32:47], a[52:55], v[84:87], v[32:47]
    v_mfma_f32_32x32x16_bf16 v[48:63], a[116:119], v[84:87], v[48:63]
    s_waitcnt vmcnt(2) lgkmcnt(1)
    v_mfma_f32_32x32x16_bf16 v[32:47], a[56:59], v[88:91], v[32:47]
    v_mfma_f32_32x32x16_bf16 v[48:63], a[120:123], v[88:91], v[48:63]
    s_waitcnt vmcnt(0) lgkmcnt(0)
    v_mfma_f32_32x32x16_bf16 v[32:47], a[60:63], v[92:95], v[32:47]
    v_mfma_f32_32x32x16_bf16 v[48:63], a[124:127], v[92:95], v[48:63]
    s_lshl_b32 s36, s21, 12
    v_add_u32 v2, s36, v5
    v_lshrrev_b32 v10, 5, v1
    v_lshlrev_b32 v11, 4, v10
    s_lshl_b32 s36, s21, 8
    s_add_u32 s36, s36, 81920
    v_add_u32 v11, s36, v11
    v_and_b32 v12, 31, v1
    v_mul_u32_u24 v13, 1056, v12
    v_add_u32 v9, v11, v13
    v_lshrrev_b32 v13, 3, v12
    v_mul_u32_u24 v13, 1056, v13
    v_add_u32 v4, v11, v13
    s_lshl_b32 s36, s21, 3
    v_add_u32 v10, s36, v10
    v_mul_u32_u24 v13, 528, v10
    v_lshl_add_u32 v13, v12, 4, v13
    v_add_u32 v6, 115712, v13
    v_lshlrev_b32 v13, 9, v10
    v_lshl_add_u32 v7, v12, 4, v13
    s_mov_b32 s41, 0x4038aa3b
    v_mul_f32 v64, s41, v32
    v_mul_f32 v65, s41, v33
    v_mul_f32 v66, s41, v34
    v_mul_f32 v67, s41, v35
    v_mul_f32 v68, s41, v36
    v_mul_f32 v69, s41, v37
    v_mul_f32 v70, s41, v38
    v_mul_f32 v71, s41, v39
    v_mul_f32 v72, s41, v40
    v_mul_f32 v73, s41, v41
    v_mul_f32 v74, s41, v42
    v_mul_f32 v75, s41, v43
    v_mul_f32 v76, s41, v44
    v_mul_f32 v77, s41, v45
    v_mul_f32 v78, s41, v46
    v_mul_f32 v79, s41, v47
    v_mul_f32 v80, s41, v48
    v_mul_f32 v81, s41, v49
    v_mul_f32 v82, s41, v50
    v_mul_f32 v83, s41, v51
    v_mul_f32 v84, s41, v52
    v_mul_f32 v85, s41, v53
    v_mul_f32 v86, s41, v54
    v_mul_f32 v87, s41, v55
    v_mul_f32 v88, s41, v56
    v_mul_f32 v89, s41, v57
    v_mul_f32 v90, s41, v58
    v_mul_f32 v91, s41, v59
    v_mul_f32 v92, s41, v60
    v_mul_f32 v93, s41, v61
    v_mul_f32 v94, s41, v62
    v_mul_f32 v95, s41, v63
    v_max3_f32 v8, |v64|, |v65|, |v66|
    v_max3_f32 v8, v8, |v67|, |v68|
    v_max3_f32 v8, v8, |v69|, |v70|
    v_max3_f32 v8, v8, |v71|, |v72|
    v_max3_f32 v8, v8, |v73|, |v74|
    v_max3_f32 v8, v8, |v75|, |v76|
    v_max3_f32 v8, v8, |v77|, |v78|
    v_max3_f32 v8, v8, |v79|, |v80|
    v_max3_f32 v8, v8, |v81|, |v82|
    v_max3_f32 v8, v8, |v83|, |v84|
    v_max3_f32 v8, v8, |v85|, |v86|
    v_max3_f32 v8, v8, |v87|, |v88|
    v_max3_f32 v8, v8, |v89|, |v90|
    v_max3_f32 v8, v8, |v91|, |v92|
    v_max3_f32 v8, v8, |v93|, |v94|
    v_max_f32 v8, v8, |v95|
    s_mov_b32 s41, 0x42200000
    v_cmp_lt_f32 vcc, s41, v8
    s_nop 3
    s_or_b64 s[42:43], s[42:43], vcc
    s_cmp_lg_u64 s[42:43], 0
    s_cselect_b32 s44, 1, 0
    s_cmp_lg_u32 s44, 0
    s_cbranch_scc1 L_joint_kernel_slow
    v_exp_f32 v32, v64
    v_exp_f32 v33, v65
    v_exp_f32 v34, v66
    v_exp_f32 v35, v67
    v_exp_f32 v36, v68
    v_exp_f32 v37, v69
    v_exp_f32 v38, v70
    v_exp_f32 v39, v71
    v_exp_f32 v40, v72
    v_exp_f32 v41, v73
    v_exp_f32 v42, v74
    v_exp_f32 v43, v75
    v_exp_f32 v44, v76
    v_exp_f32 v45, v77
    v_exp_f32 v46, v78
    v_exp_f32 v47, v79
    v_exp_f32 v48, v80
    v_exp_f32 v49, v81
    v_exp_f32 v50, v82
    v_exp_f32 v51, v83
    v_exp_f32 v52, v84
    v_exp_f32 v53, v85
    v_exp_f32 v54, v86
    v_exp_f32 v55, v87
    v_exp_f32 v56, v88
    v_exp_f32 v57, v89
    v_exp_f32 v58, v90
    v_exp_f32 v59, v91
    v_exp_f32 v60, v92
    v_exp_f32 v61, v93
    v_exp_f32 v62, v94
    v_exp_f32 v63, v95
    ds_write_b128 v9, v[32:35] offset:0
    ds_write_b128 v9, v[36:39] offset:32
    ds_write_b128 v9, v[40:43] offset:64
    ds_write_b128 v9, v[44:47] offset:96
    ds_write_b128 v9, v[48:51] offset:128
    ds_write_b128 v9, v[52:55] offset:160
    ds_write_b128 v9, v[56:59] offset:192
    ds_write_b128 v9, v[60:63] offset:224
    s_waitcnt lgkmcnt(0)
    ds_read_b128 v[32:35], v4 offset:0
    ds_read_b128 v[36:39], v4 offset:32
    ds_read_b128 v[40:43], v4 offset:64
    ds_read_b128 v[44:47], v4 offset:96
    ds_read_b128 v[48:51], v4 offset:128
    ds_read_b128 v[52:55], v4 offset:160
    ds_read_b128 v[56:59], v4 offset:192
    ds_read_b128 v[60:63], v4 offset:224
    s_waitcnt lgkmcnt(6)
    v_fma_f32 v64, v32, v96, 1.0
    v_fma_f32 v65, v33, v97, 1.0
    v_fma_f32 v66, v34, v98, 1.0
    v_fma_f32 v67, v35, v99, 1.0
    v_fma_f32 v68, v36, v100, 1.0
    v_fma_f32 v69, v37, v101, 1.0
    v_fma_f32 v70, v38, v102, 1.0
    v_fma_f32 v71, v39, v103, 1.0
    ds_read_b128 v[32:35], v4 offset:4224
    ds_read_b128 v[36:39], v4 offset:4256
    v_rcp_f32 v64, v64
    v_rcp_f32 v65, v65
    v_rcp_f32 v66, v66
    v_rcp_f32 v67, v67
    v_rcp_f32 v68, v68
    v_rcp_f32 v69, v69
    v_rcp_f32 v70, v70
    v_rcp_f32 v71, v71
    s_nop 0
    v_cvt_pk_bf16_f32 v80, v64, v65
    v_cvt_pk_bf16_f32 v81, v66, v67
    v_cvt_pk_bf16_f32 v82, v68, v69
    v_cvt_pk_bf16_f32 v83, v70, v71
    ds_write_b128 v2, v[80:83] offset:0
    s_waitcnt lgkmcnt(7)
    v_fma_f32 v72, v40, v104, 1.0
    v_fma_f32 v73, v41, v105, 1.0
    v_fma_f32 v74, v42, v106, 1.0
    v_fma_f32 v75, v43, v107, 1.0
    v_fma_f32 v76, v44, v108, 1.0
    v_fma_f32 v77, v45, v109, 1.0
    v_fma_f32 v78, v46, v110, 1.0
    v_fma_f32 v79, v47, v111, 1.0
    ds_read_b128 v[40:43], v4 offset:4288
    ds_read_b128 v[44:47], v4 offset:4320
    v_rcp_f32 v72, v72
    v_rcp_f32 v73, v73
    v_rcp_f32 v74, v74
    v_rcp_f32 v75, v75
    v_rcp_f32 v76, v76
    v_rcp_f32 v77, v77
    v_rcp_f32 v78, v78
    v_rcp_f32 v79, v79
    s_nop 0
    v_cvt_pk_bf16_f32 v84, v72, v73
    v_cvt_pk_bf16_f32 v85, v74, v75
    v_cvt_pk_bf16_f32 v86, v76, v77
    v_cvt_pk_bf16_f32 v87, v78, v79
    ds_write_b128 v2, v[84:87] offset:1024
    s_waitcnt lgkmcnt(8)
    v_fma_f32 v64, v48, v112, 1.0
    v_fma_f32 v65, v49, v113, 1.0
    v_fma_f32 v66, v50, v114, 1.0
    v_fma_f32 v67, v51, v115, 1.0
    v_fma_f32 v68, v52, v116, 1.0
    v_fma_f32 v69, v53, v117, 1.0
    v_fma_f32 v70, v54, v118, 1.0
    v_fma_f32 v71, v55, v119, 1.0
    ds_read_b128 v[48:51], v4 offset:4352
    ds_read_b128 v[52:55], v4 offset:4384
    v_rcp_f32 v64, v64
    v_rcp_f32 v65, v65
    v_rcp_f32 v66, v66
    v_rcp_f32 v67, v67
    v_rcp_f32 v68, v68
    v_rcp_f32 v69, v69
    v_rcp_f32 v70, v70
    v_rcp_f32 v71, v71
    s_nop 0
    v_cvt_pk_bf16_f32 v80, v64, v65
    v_cvt_pk_bf16_f32 v81, v66, v67
    v_cvt_pk_bf16_f32 v82, v68, v69
    v_cvt_pk_bf16_f32 v83, v70, v71
    ds_write_b128 v2, v[80:83] offset:2048
    s_waitcnt lgkmcnt(9)
    v_fma_f32 v72, v56, v120, 1.0
    v_fma_f32 v73, v57, v121, 1.0
    v_fma_f32 v74, v58, v122, 1.0
    v_fma_f32 v75, v59, v123, 1.0
    v_fma_f32 v76, v60, v124, 1.0
    v_fma_f32 v77, v61, v125, 1.0
    v_fma_f32 v78, v62, v126, 1.0
    v_fma_f32 v79, v63, v127, 1.0
    ds_read_b128 v[56:59], v4 offset:4416
    ds_read_b128 v[60:63], v4 offset:4448
    v_rcp_f32 v72, v72
    v_rcp_f32 v73, v73
    v_rcp_f32 v74, v74
    v_rcp_f32 v75, v75
    v_rcp_f32 v76, v76
    v_rcp_f32 v77, v77
    v_rcp_f32 v78, v78
    v_rcp_f32 v79, v79
    s_nop 0
    v_cvt_pk_bf16_f32 v84, v72, v73
    v_cvt_pk_bf16_f32 v85, v74, v75
    v_cvt_pk_bf16_f32 v86, v76, v77
    v_cvt_pk_bf16_f32 v87, v78, v79
    ds_write_b128 v2, v[84:87] offset:3072
    s_waitcnt lgkmcnt(10)
    v_fma_f32 v64, v32, v96, 1.0
    v_fma_f32 v65, v33, v97, 1.0
    v_fma_f32 v66, v34, v98, 1.0
    v_fma_f32 v67, v35, v99, 1.0
    v_fma_f32 v68, v36, v100, 1.0
    v_fma_f32 v69, v37, v101, 1.0
    v_fma_f32 v70, v38, v102, 1.0
    v_fma_f32 v71, v39, v103, 1.0
    ds_read_b128 v[32:35], v4 offset:8448
    ds_read_b128 v[36:39], v4 offset:8480
    v_rcp_f32 v64, v64
    v_rcp_f32 v65, v65
    v_rcp_f32 v66, v66
    v_rcp_f32 v67, v67
    v_rcp_f32 v68, v68
    v_rcp_f32 v69, v69
    v_rcp_f32 v70, v70
    v_rcp_f32 v71, v71
    s_nop 0
    v_cvt_pk_bf16_f32 v80, v64, v65
    v_cvt_pk_bf16_f32 v81, v66, v67
    v_cvt_pk_bf16_f32 v82, v68, v69
    v_cvt_pk_bf16_f32 v83, v70, v71
    ds_write_b128 v2, v[80:83] offset:16384
    s_waitcnt lgkmcnt(10)
    v_fma_f32 v72, v40, v104, 1.0
    v_fma_f32 v73, v41, v105, 1.0
    v_fma_f32 v74, v42, v106, 1.0
    v_fma_f32 v75, v43, v107, 1.0
    v_fma_f32 v76, v44, v108, 1.0
    v_fma_f32 v77, v45, v109, 1.0
    v_fma_f32 v78, v46, v110, 1.0
    v_fma_f32 v79, v47, v111, 1.0
    ds_read_b128 v[40:43], v4 offset:8512
    ds_read_b128 v[44:47], v4 offset:8544
    v_rcp_f32 v72, v72
    v_rcp_f32 v73, v73
    v_rcp_f32 v74, v74
    v_rcp_f32 v75, v75
    v_rcp_f32 v76, v76
    v_rcp_f32 v77, v77
    v_rcp_f32 v78, v78
    v_rcp_f32 v79, v79
    s_nop 0
    v_cvt_pk_bf16_f32 v84, v72, v73
    v_cvt_pk_bf16_f32 v85, v74, v75
    v_cvt_pk_bf16_f32 v86, v76, v77
    v_cvt_pk_bf16_f32 v87, v78, v79
    ds_write_b128 v2, v[84:87] offset:17408
    s_waitcnt lgkmcnt(10)
    v_fma_f32 v64, v48, v112, 1.0
    v_fma_f32 v65, v49, v113, 1.0
    v_fma_f32 v66, v50, v114, 1.0
    v_fma_f32 v67, v51, v115, 1.0
    v_fma_f32 v68, v52, v116, 1.0
    v_fma_f32 v69, v53, v117, 1.0
    v_fma_f32 v70, v54, v118, 1.0
    v_fma_f32 v71, v55, v119, 1.0
    ds_read_b128 v[48:51], v4 offset:8576
    ds_read_b128 v[52:55], v4 offset:8608
    v_rcp_f32 v64, v64
    v_rcp_f32 v65, v65
    v_rcp_f32 v66, v66
    v_rcp_f32 v67, v67
    v_rcp_f32 v68, v68
    v_rcp_f32 v69, v69
    v_rcp_f32 v70, v70
    v_rcp_f32 v71, v71
    s_nop 0
    v_cvt_pk_bf16_f32 v80, v64, v65
    v_cvt_pk_bf16_f32 v81, v66, v67
    v_cvt_pk_bf16_f32 v82, v68, v69
    v_cvt_pk_bf16_f32 v83, v70, v71
    ds_write_b128 v2, v[80:83] offset:18432
    s_waitcnt lgkmcnt(10)
    v_fma_f32 v72, v56, v120, 1.0
    v_fma_f32 v73, v57, v121, 1.0
    v_fma_f32 v74, v58, v122, 1.0
    v_fma_f32 v75, v59, v123, 1.0
    v_fma_f32 v76, v60, v124, 1.0
    v_fma_f32 v77, v61, v125, 1.0
    v_fma_f32 v78, v62, v126, 1.0
    v_fma_f32 v79, v63, v127, 1.0
    ds_read_b128 v[56:59], v4 offset:8640
    ds_read_b128 v[60:63], v4 offset:8672
    v_rcp_f32 v72, v72
    v_rcp_f32 v73, v73
    v_rcp_f32 v74, v74
    v_rcp_f32 v75, v75
    v_rcp_f32 v76, v76
    v_rcp_f32 v77, v77
    v_rcp_f32 v78, v78
    v_rcp_f32 v79, v79
    s_nop 0
    v_cvt_pk_bf16_f32 v84, v72, v73
    v_cvt_pk_bf16_f32 v85, v74, v75
    v_cvt_pk_bf16_f32 v86, v76, v77
    v_cvt_pk_bf16_f32 v87, v78, v79
    ds_write_b128 v2, v[84:87] offset:19456
    s_waitcnt lgkmcnt(0)
    s_barrier
    v_fma_f32 v64, v32, v96, 1.0
    v_fma_f32 v65, v33, v97, 1.0
    v_fma_f32 v66, v34, v98, 1.0
    v_fma_f32 v67, v35, v99, 1.0
    v_fma_f32 v68, v36, v100, 1.0
    v_fma_f32 v69, v37, v101, 1.0
    v_fma_f32 v70, v38, v102, 1.0
    v_fma_f32 v71, v39, v103, 1.0
    ds_read_b128 v[32:35], v4 offset:12672
    ds_read_b128 v[36:39], v4 offset:12704
    v_rcp_f32 v64, v64
    v_rcp_f32 v65, v65
    v_rcp_f32 v66, v66
    v_rcp_f32 v67, v67
    v_rcp_f32 v68, v68
    v_rcp_f32 v69, v69
    v_rcp_f32 v70, v70
    v_rcp_f32 v71, v71
    s_nop 0
    v_cvt_pk_bf16_f32 v80, v64, v65
    v_cvt_pk_bf16_f32 v81, v66, v67
    v_cvt_pk_bf16_f32 v82, v68, v69
    v_cvt_pk_bf16_f32 v83, v70, v71
    ds_write_b128 v2, v[80:83] offset:32768
    v_fma_f32 v72, v40, v104, 1.0
    v_fma_f32 v73, v41, v105, 1.0
    v_fma_f32 v74, v42, v106, 1.0
    v_fma_f32 v75, v43, v107, 1.0
    v_fma_f32 v76, v44, v108, 1.0
    v_fma_f32 v77, v45, v109, 1.0
    v_fma_f32 v78, v46, v110, 1.0
    v_fma_f32 v79, v47, v111, 1.0
    ds_read_b128 v[40:43], v4 offset:12736
    ds_read_b128 v[44:47], v4 offset:12768
    v_rcp_f32 v72, v72
    v_rcp_f32 v73, v73
    v_rcp_f32 v74, v74
    v_rcp_f32 v75, v75
    v_rcp_f32 v76, v76
    v_rcp_f32 v77, v77
    v_rcp_f32 v78, v78
    v_rcp_f32 v79, v79
    s_nop 0
    v_cvt_pk_bf16_f32 v84, v72, v73
    v_cvt_pk_bf16_f32 v85, v74, v75
    v_cvt_pk_bf16_f32 v86, v76, v77
    v_cvt_pk_bf16_f32 v87, v78, v79
    ds_write_b128 v2, v[84:87] offset:33792
    v_fma_f32 v64, v48, v112, 1.0
    v_fma_f32 v65, v49, v113, 1.0
    v_fma_f32 v66, v50, v114, 1.0
    v_fma_f32 v67, v51, v115, 1.0
    v_fma_f32 v68, v52, v116, 1.0
    v_fma_f32 v69, v53, v117, 1.0
    v_fma_f32 v70, v54, v118, 1.0
    v_fma_f32 v71, v55, v119, 1.0
    ds_read_b128 v[48:51], v4 offset:12800
    ds_read_b128 v[52:55], v4 offset:12832
    v_rcp_f32 v64, v64
    v_rcp_f32 v65, v65
    v_rcp_f32 v66, v66
    v_rcp_f32 v67, v67
    v_rcp_f32 v68, v68
    v_rcp_f32 v69, v69
    v_rcp_f32 v70, v70
    v_rcp_f32 v71, v71
    s_nop 0
    v_cvt_pk_bf16_f32 v80, v64, v65
    v_cvt_pk_bf16_f32 v81, v66, v67
    v_cvt_pk_bf16_f32 v82, v68, v69
    v_cvt_pk_bf16_f32 v83, v70, v71
    ds_write_b128 v2, v[80:83] offset:34816
    v_fma_f32 v72, v56, v120, 1.0
    v_fma_f32 v73, v57, v121, 1.0
    v_fma_f32 v74, v58, v122, 1.0
    v_fma_f32 v75, v59, v123, 1.0
    v_fma_f32 v76, v60, v124, 1.0
    v_fma_f32 v77, v61, v125, 1.0
    v_fma_f32 v78, v62, v126, 1.0
    v_fma_f32 v79, v63, v127, 1.0
    ds_read_b128 v[56:59], v4 offset:12864
    ds_read_b128 v[60:63], v4 offset:12896
    v_rcp_f32 v72, v72
    v_rcp_f32 v73, v73
    v_rcp_f32 v74, v74
    v_rcp_f32 v75, v75
    v_rcp_f32 v76, v76
    v_rcp_f32 v77, v77
    v_rcp_f32 v78, v78
    v_rcp_f32 v79, v79
    s_nop 0
    v_cvt_pk_bf16_f32 v84, v72, v73
    v_cvt_pk_bf16_f32 v85, v74, v75
    v_cvt_pk_bf16_f32 v86, v76, v77
    v_cvt_pk_bf16_f32 v87, v78, v79
    ds_write_b128 v2, v[84:87] offset:35840
    s_waitcnt lgkmcnt(0)
    s_barrier
    v_fma_f32 v64, v32, v96, 1.0
    v_fma_f32 v65, v33, v97, 1.0
    v_fma_f32 v66, v34, v98, 1.0
    v_fma_f32 v67, v35, v99, 1.0
    v_fma_f32 v68, v36, v100, 1.0
    v_fma_f32 v69, v37, v101, 1.0
    v_fma_f32 v70, v38, v102, 1.0
    v_fma_f32 v71, v39, v103, 1.0
    ds_read_b128 v[32:35], v4 offset:16896
    ds_read_b128 v[36:39], v4 offset:16928
    v_rcp_f32 v64, v64
    v_rcp_f32 v65, v65
    v_rcp_f32 v66, v66
    v_rcp_f32 v67, v67
    v_rcp_f32 v68, v68
    v_rcp_f32 v69, v69
    v_rcp_f32 v70, v70
    v_rcp_f32 v71, v71
    s_nop 0
    v_cvt_pk_bf16_f32 v80, v64, v65
    v_cvt_pk_bf16_f32 v81, v66, v67
    v_cvt_pk_bf16_f32 v82, v68, v69
    v_cvt_pk_bf16_f32 v83, v70, v71
    ds_write_b128 v2, v[80:83] offset:0
    v_fma_f32 v72, v40, v104, 1.0
    v_fma_f32 v73, v41, v105, 1.0
    v_fma_f32 v74, v42, v106, 1.0
    v_fma_f32 v75, v43, v107, 1.0
    v_fma_f32 v76, v44, v108, 1.0
    v_fma_f32 v77, v45, v109, 1.0
    v_fma_f32 v78, v46, v110, 1.0
    v_fma_f32 v79, v47, v111, 1.0
    ds_read_b128 v[40:43], v4 offset:16960
    ds_read_b128 v[44:47], v4 offset:16992
    v_rcp_f32 v72, v72
    v_rcp_f32 v73, v73
    v_rcp_f32 v74, v74
    v_rcp_f32 v75, v75
    v_rcp_f32 v76, v76
    v_rcp_f32 v77, v77
    v_rcp_f32 v78, v78
    v_rcp_f32 v79, v79
    s_nop 0
    v_cvt_pk_bf16_f32 v84, v72, v73
    v_cvt_pk_bf16_f32 v85, v74, v75
    v_cvt_pk_bf16_f32 v86, v76, v77
    v_cvt_pk_bf16_f32 v87, v78, v79
    ds_write_b128 v2, v[84:87] offset:1024
    v_fma_f32 v64, v48, v112, 1.0
    v_fma_f32 v65, v49, v113, 1.0
    v_fma_f32 v66, v50, v114, 1.0
    v_fma_f32 v67, v51, v115, 1.0
    v_fma_f32 v68, v52, v116, 1.0
    v_fma_f32 v69, v53, v117, 1.0
    v_fma_f32 v70, v54, v118, 1.0
    v_fma_f32 v71, v55, v119, 1.0
    ds_read_b128 v[48:51], v4 offset:17024
    ds_read_b128 v[52:55], v4 offset:17056
    v_rcp_f32 v64, v64
    v_rcp_f32 v65, v65
    v_rcp_f32 v66, v66
    v_rcp_f32 v67, v67
    v_rcp_f32 v68, v68
    v_rcp_f32 v69, v69
    v_rcp_f32 v70, v70
    v_rcp_f32 v71, v71
    s_nop 0
    v_cvt_pk_bf16_f32 v80, v64, v65
    v_cvt_pk_bf16_f32 v81, v66, v67
    v_cvt_pk_bf16_f32 v82, v68, v69
    v_cvt_pk_bf16_f32 v83, v70, v71
    ds_write_b128 v2, v[80:83] offset:2048
    v_fma_f32 v72, v56, v120, 1.0
    v_fma_f32 v73, v57, v121, 1.0
    v_fma_f32 v74, v58, v122, 1.0
    v_fma_f32 v75, v59, v123, 1.0
    v_fma_f32 v76, v60, v124, 1.0
    v_fma_f32 v77, v61, v125, 1.0
    v_fma_f32 v78, v62, v126, 1.0
    v_fma_f32 v79, v63, v127, 1.0
    ds_read_b128 v[56:59], v4 offset:17088
    ds_read_b128 v[60:63], v4 offset:17120
    v_rcp_f32 v72, v72
    v_rcp_f32 v73, v73
    v_rcp_f32 v74, v74
    v_rcp_f32 v75, v75
    v_rcp_f32 v76, v76
    v_rcp_f32 v77, v77
    v_rcp_f32 v78, v78
    v_rcp_f32 v79, v79
    s_nop 0
    v_cvt_pk_bf16_f32 v84, v72, v73
    v_cvt_pk_bf16_f32 v85, v74, v75
    v_cvt_pk_bf16_f32 v86, v76, v77
    v_cvt_pk_bf16_f32 v87, v78, v79
    ds_write_b128 v2, v[84:87] offset:3072
    s_waitcnt lgkmcnt(0)
    s_barrier
    ds_read_b128 a[0:3], v6 offset:0
    ds_read_b128 a[4:7], v6 offset:1056
    ds_read_b128 a[8:11], v6 offset:2112
    ds_read_b128 a[12:15], v6 offset:3168
    v_fma_f32 v64, v32, v96, 1.0
    v_fma_f32 v65, v33, v97, 1.0
    v_fma_f32 v66, v34, v98, 1.0
    v_fma_f32 v67, v35, v99, 1.0
    v_fma_f32 v68, v36, v100, 1.0
    v_fma_f32 v69, v37, v101, 1.0
    v_fma_f32 v70, v38, v102, 1.0
    v_fma_f32 v71, v39, v103, 1.0
    ds_read_b128 v[32:35], v4 offset:21120
    ds_read_b128 v[36:39], v4 offset:21152
    v_rcp_f32 v64, v64
    v_rcp_f32 v65, v65
    v_rcp_f32 v66, v66
    v_rcp_f32 v67, v67
    v_rcp_f32 v68, v68
    v_rcp_f32 v69, v69
    v_rcp_f32 v70, v70
    v_rcp_f32 v71, v71
    s_waitcnt lgkmcnt(5)
    s_mov_b32 s36, 0
    buffer_store_dwordx4 a[0:3], v7, s[16:19], s36 offen sc1
    s_waitcnt lgkmcnt(4)
    s_mov_b32 s36, 1024
    buffer_store_dwordx4 a[4:7], v7, s[16:19], s36 offen sc1
    v_cvt_pk_bf16_f32 v80, v64, v65
    v_cvt_pk_bf16_f32 v81, v66, v67
    v_cvt_pk_bf16_f32 v82, v68, v69
    v_cvt_pk_bf16_f32 v83, v70, v71
    ds_write_b128 v2, v[80:83] offset:16384
    v_fma_f32 v72, v40, v104, 1.0
    v_fma_f32 v73, v41, v105, 1.0
    v_fma_f32 v74, v42, v106, 1.0
    v_fma_f32 v75, v43, v107, 1.0
    v_fma_f32 v76, v44, v108, 1.0
    v_fma_f32 v77, v45, v109, 1.0
    v_fma_f32 v78, v46, v110, 1.0
    v_fma_f32 v79, v47, v111, 1.0
    ds_read_b128 v[40:43], v4 offset:21184
    ds_read_b128 v[44:47], v4 offset:21216
    v_rcp_f32 v72, v72
    v_rcp_f32 v73, v73
    v_rcp_f32 v74, v74
    v_rcp_f32 v75, v75
    v_rcp_f32 v76, v76
    v_rcp_f32 v77, v77
    v_rcp_f32 v78, v78
    v_rcp_f32 v79, v79
    s_waitcnt lgkmcnt(6)
    s_mov_b32 s36, 2048
    buffer_store_dwordx4 a[8:11], v7, s[16:19], s36 offen sc1
    s_waitcnt lgkmcnt(5)
    s_mov_b32 s36, 3072
    buffer_store_dwordx4 a[12:15], v7, s[16:19], s36 offen sc1
    v_cvt_pk_bf16_f32 v84, v72, v73
    v_cvt_pk_bf16_f32 v85, v74, v75
    v_cvt_pk_bf16_f32 v86, v76, v77
    v_cvt_pk_bf16_f32 v87, v78, v79
    ds_write_b128 v2, v[84:87] offset:17408
    v_fma_f32 v64, v48, v112, 1.0
    v_fma_f32 v65, v49, v113, 1.0
    v_fma_f32 v66, v50, v114, 1.0
    v_fma_f32 v67, v51, v115, 1.0
    v_fma_f32 v68, v52, v116, 1.0
    v_fma_f32 v69, v53, v117, 1.0
    v_fma_f32 v70, v54, v118, 1.0
    v_fma_f32 v71, v55, v119, 1.0
    ds_read_b128 v[48:51], v4 offset:21248
    ds_read_b128 v[52:55], v4 offset:21280
    v_rcp_f32 v64, v64
    v_rcp_f32 v65, v65
    v_rcp_f32 v66, v66
    v_rcp_f32 v67, v67
    v_rcp_f32 v68, v68
    v_rcp_f32 v69, v69
    v_rcp_f32 v70, v70
    v_rcp_f32 v71, v71
    s_nop 0
    v_cvt_pk_bf16_f32 v80, v64, v65
    v_cvt_pk_bf16_f32 v81, v66, v67
    v_cvt_pk_bf16_f32 v82, v68, v69
    v_cvt_pk_bf16_f32 v83, v70, v71
    ds_write_b128 v2, v[80:83] offset:18432
    v_fma_f32 v72, v56, v120, 1.0
    v_fma_f32 v73, v57, v121, 1.0
    v_fma_f32 v74, v58, v122, 1.0
    v_fma_f32 v75, v59, v123, 1.0
    v_fma_f32 v76, v60, v124, 1.0
    v_fma_f32 v77, v61, v125, 1.0
    v_fma_f32 v78, v62, v126, 1.0
    v_fma_f32 v79, v63, v127, 1.0
    ds_read_b128 v[56:59], v4 offset:21312
    ds_read_b128 v[60:63], v4 offset:21344
    v_rcp_f32 v72, v72
    v_rcp_f32 v73, v73
    v_rcp_f32 v74, v74
    v_rcp_f32 v75, v75
    v_rcp_f32 v76, v76
    v_rcp_f32 v77, v77
    v_rcp_f32 v78, v78
    v_rcp_f32 v79, v79
    s_nop 0
    v_cvt_pk_bf16_f32 v84, v72, v73
    v_cvt_pk_bf16_f32 v85, v74, v75
    v_cvt_pk_bf16_f32 v86, v76, v77
    v_cvt_pk_bf16_f32 v87, v78, v79
    ds_write_b128 v2, v[84:87] offset:19456
    s_waitcnt lgkmcnt(0)
    s_barrier
    ds_read_b128 a[0:3], v6 offset:16896
    ds_read_b128 a[4:7], v6 offset:17952
    ds_read_b128 a[8:11], v6 offset:19008
    ds_read_b128 a[12:15], v6 offset:20064
    v_fma_f32 v64, v32, v96, 1.0
    v_fma_f32 v65, v33, v97, 1.0
    v_fma_f32 v66, v34, v98, 1.0
    v_fma_f32 v67, v35, v99, 1.0
    v_fma_f32 v68, v36, v100, 1.0
    v_fma_f32 v69, v37, v101, 1.0
    v_fma_f32 v70, v38, v102, 1.0
    v_fma_f32 v71, v39, v103, 1.0
    ds_read_b128 v[32:35], v4 offset:25344
    ds_read_b128 v[36:39], v4 offset:25376
    v_rcp_f32 v64, v64
    v_rcp_f32 v65, v65
    v_rcp_f32 v66, v66
    v_rcp_f32 v67, v67
    v_rcp_f32 v68, v68
    v_rcp_f32 v69, v69
    v_rcp_f32 v70, v70
    v_rcp_f32 v71, v71
    s_waitcnt lgkmcnt(5)
    s_mov_b32 s36, 16384
    buffer_store_dwordx4 a[0:3], v7, s[16:19], s36 offen sc1
    s_waitcnt lgkmcnt(4)
    s_mov_b32 s36, 17408
    buffer_store_dwordx4 a[4:7], v7, s[16:19], s36 offen sc1
    v_cvt_pk_bf16_f32 v80, v64, v65
    v_cvt_pk_bf16_f32 v81, v66, v67
    v_cvt_pk_bf16_f32 v82, v68, v69
    v_cvt_pk_bf16_f32 v83, v70, v71
    ds_write_b128 v2, v[80:83] offset:32768
    v_fma_f32 v72, v40, v104, 1.0
    v_fma_f32 v73, v41, v105, 1.0
    v_fma_f32 v74, v42, v106, 1.0
    v_fma_f32 v75, v43, v107, 1.0
    v_fma_f32 v76, v44, v108, 1.0
    v_fma_f32 v77, v45, v109, 1.0
    v_fma_f32 v78, v46, v110, 1.0
    v_fma_f32 v79, v47, v111, 1.0
    ds_read_b128 v[40:43], v4 offset:25408
    ds_read_b128 v[44:47], v4 offset:25440
    v_rcp_f32 v72, v72
    v_rcp_f32 v73, v73
    v_rcp_f32 v74, v74
    v_rcp_f32 v75, v75
    v_rcp_f32 v76, v76
    v_rcp_f32 v77, v77
    v_rcp_f32 v78, v78
    v_rcp_f32 v79, v79
    s_waitcnt lgkmcnt(6)
    s_mov_b32 s36, 18432
    buffer_store_dwordx4 a[8:11], v7, s[16:19], s36 offen sc1
    s_waitcnt lgkmcnt(5)
    s_mov_b32 s36, 19456
    buffer_store_dwordx4 a[12:15], v7, s[16:19], s36 offen sc1
    v_cvt_pk_bf16_f32 v84, v72, v73
    v_cvt_pk_bf16_f32 v85, v74, v75
    v_cvt_pk_bf16_f32 v86, v76, v77
    v_cvt_pk_bf16_f32 v87, v78, v79
    ds_write_b128 v2, v[84:87] offset:33792
    v_fma_f32 v64, v48, v112, 1.0
    v_fma_f32 v65, v49, v113, 1.0
    v_fma_f32 v66, v50, v114, 1.0
    v_fma_f32 v67, v51, v115, 1.0
    v_fma_f32 v68, v52, v116, 1.0
    v_fma_f32 v69, v53, v117, 1.0
    v_fma_f32 v70, v54, v118, 1.0
    v_fma_f32 v71, v55, v119, 1.0
    ds_read_b128 v[48:51], v4 offset:25472
    ds_read_b128 v[52:55], v4 offset:25504
    v_rcp_f32 v64, v64
    v_rcp_f32 v65, v65
    v_rcp_f32 v66, v66
    v_rcp_f32 v67, v67
    v_rcp_f32 v68, v68
    v_rcp_f32 v69, v69
    v_rcp_f32 v70, v70
    v_rcp_f32 v71, v71
    s_nop 0
    v_cvt_pk_bf16_f32 v80, v64, v65
    v_cvt_pk_bf16_f32 v81, v66, v67
    v_cvt_pk_bf16_f32 v82, v68, v69
    v_cvt_pk_bf16_f32 v83, v70, v71
    ds_write_b128 v2, v[80:83] offset:34816
    v_fma_f32 v72, v56, v120, 1.0
    v_fma_f32 v73, v57, v121, 1.0
    v_fma_f32 v74, v58, v122, 1.0
    v_fma_f32 v75, v59, v123, 1.0
    v_fma_f32 v76, v60, v124, 1.0
    v_fma_f32 v77, v61, v125, 1.0
    v_fma_f32 v78, v62, v126, 1.0
    v_fma_f32 v79, v63, v127, 1.0
    ds_read_b128 v[56:59], v4 offset:25536
    ds_read_b128 v[60:63], v4 offset:25568
    v_rcp_f32 v72, v72
    v_rcp_f32 v73, v73
    v_rcp_f32 v74, v74
    v_rcp_f32 v75, v75
    v_rcp_f32 v76, v76
    v_rcp_f32 v77, v77
    v_rcp_f32 v78, v78
    v_rcp_f32 v79, v79
    s_nop 0
    v_cvt_pk_bf16_f32 v84, v72, v73
    v_cvt_pk_bf16_f32 v85, v74, v75
    v_cvt_pk_bf16_f32 v86, v76, v77
    v_cvt_pk_bf16_f32 v87, v78, v79
    ds_write_b128 v2, v[84:87] offset:35840
    s_waitcnt lgkmcnt(0)
    s_barrier
    ds_read_b128 a[0:3], v6 offset:0
    ds_read_b128 a[4:7], v6 offset:1056
    ds_read_b128 a[8:11], v6 offset:2112
    ds_read_b128 a[12:15], v6 offset:3168
    v_fma_f32 v64, v32, v96, 1.0
    v_fma_f32 v65, v33, v97, 1.0
    v_fma_f32 v66, v34, v98, 1.0
    v_fma_f32 v67, v35, v99, 1.0
    v_fma_f32 v68, v36, v100, 1.0
    v_fma_f32 v69, v37, v101, 1.0
    v_fma_f32 v70, v38, v102, 1.0
    v_fma_f32 v71, v39, v103, 1.0
    ds_read_b128 v[32:35], v4 offset:29568
    ds_read_b128 v[36:39], v4 offset:29600
    v_rcp_f32 v64, v64
    v_rcp_f32 v65, v65
    v_rcp_f32 v66, v66
    v_rcp_f32 v67, v67
    v_rcp_f32 v68, v68
    v_rcp_f32 v69, v69
    v_rcp_f32 v70, v70
    v_rcp_f32 v71, v71
    s_waitcnt lgkmcnt(5)
    s_mov_b32 s36, 32768
    buffer_store_dwordx4 a[0:3], v7, s[16:19], s36 offen sc1
    s_waitcnt lgkmcnt(4)
    s_mov_b32 s36, 33792
    buffer_store_dwordx4 a[4:7], v7, s[16:19], s36 offen sc1
    v_cvt_pk_bf16_f32 v80, v64, v65
    v_cvt_pk_bf16_f32 v81, v66, v67
    v_cvt_pk_bf16_f32 v82, v68, v69
    v_cvt_pk_bf16_f32 v83, v70, v71
    ds_write_b128 v2, v[80:83] offset:0
    v_fma_f32 v72, v40, v104, 1.0
    v_fma_f32 v73, v41, v105, 1.0
    v_fma_f32 v74, v42, v106, 1.0
    v_fma_f32 v75, v43, v107, 1.0
    v_fma_f32 v76, v44, v108, 1.0
    v_fma_f32 v77, v45, v109, 1.0
    v_fma_f32 v78, v46, v110, 1.0
    v_fma_f32 v79, v47, v111, 1.0
    ds_read_b128 v[40:43], v4 offset:29632
    ds_read_b128 v[44:47], v4 offset:29664
    v_rcp_f32 v72, v72
    v_rcp_f32 v73, v73
    v_rcp_f32 v74, v74
    v_rcp_f32 v75, v75
    v_rcp_f32 v76, v76
    v_rcp_f32 v77, v77
    v_rcp_f32 v78, v78
    v_rcp_f32 v79, v79
    s_waitcnt lgkmcnt(6)
    s_mov_b32 s36, 34816
    buffer_store_dwordx4 a[8:11], v7, s[16:19], s36 offen sc1
    s_waitcnt lgkmcnt(5)
    s_mov_b32 s36, 35840
    buffer_store_dwordx4 a[12:15], v7, s[16:19], s36 offen sc1
    v_cvt_pk_bf16_f32 v84, v72, v73
    v_cvt_pk_bf16_f32 v85, v74, v75
    v_cvt_pk_bf16_f32 v86, v76, v77
    v_cvt_pk_bf16_f32 v87, v78, v79
    ds_write_b128 v2, v[84:87] offset:1024
    v_fma_f32 v64, v48, v112, 1.0
    v_fma_f32 v65, v49, v113, 1.0
    v_fma_f32 v66, v50, v114, 1.0
    v_fma_f32 v67, v51, v115, 1.0
    v_fma_f32 v68, v52, v116, 1.0
    v_fma_f32 v69, v53, v117, 1.0
    v_fma_f32 v70, v54, v118, 1.0
    v_fma_f32 v71, v55, v119, 1.0
    ds_read_b128 v[48:51], v4 offset:29696
    ds_read_b128 v[52:55], v4 offset:29728
    v_rcp_f32 v64, v64
    v_rcp_f32 v65, v65
    v_rcp_f32 v66, v66
    v_rcp_f32 v67, v67
    v_rcp_f32 v68, v68
    v_rcp_f32 v69, v69
    v_rcp_f32 v70, v70
    v_rcp_f32 v71, v71
    s_nop 0
    v_cvt_pk_bf16_f32 v80, v64, v65
    v_cvt_pk_bf16_f32 v81, v66, v67
    v_cvt_pk_bf16_f32 v82, v68, v69
    v_cvt_pk_bf16_f32 v83, v70, v71
    ds_write_b128 v2, v[80:83] offset:2048
    v_fma_f32 v72, v56, v120, 1.0
    v_fma_f32 v73, v57, v121, 1.0
    v_fma_f32 v74, v58, v122, 1.0
    v_fma_f32 v75, v59, v123, 1.0
    v_fma_f32 v76, v60, v124, 1.0
    v_fma_f32 v77, v61, v125, 1.0
    v_fma_f32 v78, v62, v126, 1.0
    v_fma_f32 v79, v63, v127, 1.0
    ds_read_b128 v[56:59], v4 offset:29760
    ds_read_b128 v[60:63], v4 offset:29792
    v_rcp_f32 v72, v72
    v_rcp_f32 v73, v73
    v_rcp_f32 v74, v74
    v_rcp_f32 v75, v75
    v_rcp_f32 v76, v76
    v_rcp_f32 v77, v77
    v_rcp_f32 v78, v78
    v_rcp_f32 v79, v79
    s_nop 0
    v_cvt_pk_bf16_f32 v84, v72, v73
    v_cvt_pk_bf16_f32 v85, v74, v75
    v_cvt_pk_bf16_f32 v86, v76, v77
    v_cvt_pk_bf16_f32 v87, v78, v79
    ds_write_b128 v2, v[84:87] offset:3072
    s_waitcnt lgkmcnt(0)
    s_barrier
    ds_read_b128 a[0:3], v6 offset:16896
    ds_read_b128 a[4:7], v6 offset:17952
    ds_read_b128 a[8:11], v6 offset:19008
    ds_read_b128 a[12:15], v6 offset:20064
    v_fma_f32 v64, v32, v96, 1.0
    v_fma_f32 v65, v33, v97, 1.0
    v_fma_f32 v66, v34, v98, 1.0
    v_fma_f32 v67, v35, v99, 1.0
    v_fma_f32 v68, v36, v100, 1.0
    v_fma_f32 v69, v37, v101, 1.0
    v_fma_f32 v70, v38, v102, 1.0
    v_fma_f32 v71, v39, v103, 1.0
    v_rcp_f32 v64, v64
    v_rcp_f32 v65, v65
    v_rcp_f32 v66, v66
    v_rcp_f32 v67, v67
    v_rcp_f32 v68, v68
    v_rcp_f32 v69, v69
    v_rcp_f32 v70, v70
    v_rcp_f32 v71, v71
    s_waitcnt lgkmcnt(3)
    s_mov_b32 s36, 49152
    buffer_store_dwordx4 a[0:3], v7, s[16:19], s36 offen sc1
    s_waitcnt lgkmcnt(2)
    s_mov_b32 s36, 50176
    buffer_store_dwordx4 a[4:7], v7, s[16:19], s36 offen sc1
    v_cvt_pk_bf16_f32 v80, v64, v65
    v_cvt_pk_bf16_f32 v81, v66, v67
    v_cvt_pk_bf16_f32 v82, v68, v69
    v_cvt_pk_bf16_f32 v83, v70, v71
    ds_write_b128 v2, v[80:83] offset:16384
    v_fma_f32 v72, v40, v104, 1.0
    v_fma_f32 v73, v41, v105, 1.0
    v_fma_f32 v74, v42, v106, 1.0
    v_fma_f32 v75, v43, v107, 1.0
    v_fma_f32 v76, v44, v108, 1.0
    v_fma_f32 v77, v45, v109, 1.0
    v_fma_f32 v78, v46, v110, 1.0
    v_fma_f32 v79, v47, v111, 1.0
    v_rcp_f32 v72, v72
    v_rcp_f32 v73, v73
    v_rcp_f32 v74, v74
    v_rcp_f32 v75, v75
    v_rcp_f32 v76, v76
    v_rcp_f32 v77, v77
    v_rcp_f32 v78, v78
    v_rcp_f32 v79, v79
    s_waitcnt lgkmcnt(2)
    s_mov_b32 s36, 51200
    buffer_store_dwordx4 a[8:11], v7, s[16:19], s36 offen sc1
    s_waitcnt lgkmcnt(1)
    s_mov_b32 s36, 52224
    buffer_store_dwordx4 a[12:15], v7, s[16:19], s36 offen sc1
    v_cvt_pk_bf16_f32 v84, v72, v73
    v_cvt_pk_bf16_f32 v85, v74, v75
    v_cvt_pk_bf16_f32 v86, v76, v77
    v_cvt_pk_bf16_f32 v87, v78, v79
    ds_write_b128 v2, v[84:87] offset:17408
    v_fma_f32 v64, v48, v112, 1.0
    v_fma_f32 v65, v49, v113, 1.0
    v_fma_f32 v66, v50, v114, 1.0
    v_fma_f32 v67, v51, v115, 1.0
    v_fma_f32 v68, v52, v116, 1.0
    v_fma_f32 v69, v53, v117, 1.0
    v_fma_f32 v70, v54, v118, 1.0
    v_fma_f32 v71, v55, v119, 1.0
    v_rcp_f32 v64, v64
    v_rcp_f32 v65, v65
    v_rcp_f32 v66, v66
    v_rcp_f32 v67, v67
    v_rcp_f32 v68, v68
    v_rcp_f32 v69, v69
    v_rcp_f32 v70, v70
    v_rcp_f32 v71, v71
    s_nop 0
    v_cvt_pk_bf16_f32 v80, v64, v65
    v_cvt_pk_bf16_f32 v81, v66, v67
    v_cvt_pk_bf16_f32 v82, v68, v69
    v_cvt_pk_bf16_f32 v83, v70, v71
    ds_write_b128 v2, v[80:83] offset:18432
    v_fma_f32 v72, v56, v120, 1.0
    v_fma_f32 v73, v57, v121, 1.0
    v_fma_f32 v74, v58, v122, 1.0
    v_fma_f32 v75, v59, v123, 1.0
    v_fma_f32 v76, v60, v124, 1.0
    v_fma_f32 v77, v61, v125, 1.0
    v_fma_f32 v78, v62, v126, 1.0
    v_fma_f32 v79, v63, v127, 1.0
    v_rcp_f32 v72, v72
    v_rcp_f32 v73, v73
    v_rcp_f32 v74, v74
    v_rcp_f32 v75, v75
    v_rcp_f32 v76, v76
    v_rcp_f32 v77, v77
    v_rcp_f32 v78, v78
    v_rcp_f32 v79, v79
    s_nop 0
    v_cvt_pk_bf16_f32 v84, v72, v73
    v_cvt_pk_bf16_f32 v85, v74, v75
    v_cvt_pk_bf16_f32 v86, v76, v77
    v_cvt_pk_bf16_f32 v87, v78, v79
    ds_write_b128 v2, v[84:87] offset:19456
    s_waitcnt lgkmcnt(0)
    s_barrier
    ds_read_b128 a[0:3], v6 offset:0
    ds_read_b128 a[4:7], v6 offset:1056
    ds_read_b128 a[8:11], v6 offset:2112
    ds_read_b128 a[12:15], v6 offset:3168
    s_waitcnt lgkmcnt(3)
    s_mov_b32 s36, 65536
    buffer_store_dwordx4 a[0:3], v7, s[16:19], s36 offen sc1
    s_waitcnt lgkmcnt(2)
    s_mov_b32 s36, 66560
    buffer_store_dwordx4 a[4:7], v7, s[16:19], s36 offen sc1
    s_waitcnt lgkmcnt(1)
    s_mov_b32 s36, 67584
    buffer_store_dwordx4 a[8:11], v7, s[16:19], s36 offen sc1
    s_waitcnt lgkmcnt(0)
    s_mov_b32 s36, 68608
    buffer_store_dwordx4 a[12:15], v7, s[16:19], s36 offen sc1
    s_barrier
    ds_read_b128 a[0:3], v6 offset:16896
    ds_read_b128 a[4:7], v6 offset:17952
    ds_read_b128 a[8:11], v6 offset:19008
    ds_read_b128 a[12:15], v6 offset:20064
    s_waitcnt lgkmcnt(3)
    s_mov_b32 s36, 81920
    buffer_store_dwordx4 a[0:3], v7, s[16:19], s36 offen sc1
    s_waitcnt lgkmcnt(2)
    s_mov_b32 s36, 82944
    buffer_store_dwordx4 a[4:7], v7, s[16:19], s36 offen sc1
    s_waitcnt lgkmcnt(1)
    s_mov_b32 s36, 83968
    buffer_store_dwordx4 a[8:11], v7, s[16:19], s36 offen sc1
    s_waitcnt lgkmcnt(0)
    s_mov_b32 s36, 84992
    buffer_store_dwordx4 a[12:15], v7, s[16:19], s36 offen sc1
    s_barrier
    ds_read_b128 a[0:3], v6 offset:0
    ds_read_b128 a[4:7], v6 offset:1056
    ds_read_b128 a[8:11], v6 offset:2112
    ds_read_b128 a[12:15], v6 offset:3168
    s_waitcnt lgkmcnt(3)
    s_mov_b32 s36, 98304
    buffer_store_dwordx4 a[0:3], v7, s[16:19], s36 offen sc1
    s_waitcnt lgkmcnt(2)
    s_mov_b32 s36, 99328
    buffer_store_dwordx4 a[4:7], v7, s[16:19], s36 offen sc1
    s_waitcnt lgkmcnt(1)
    s_mov_b32 s36, 100352
    buffer_store_dwordx4 a[8:11], v7, s[16:19], s36 offen sc1
    s_waitcnt lgkmcnt(0)
    s_mov_b32 s36, 101376
    buffer_store_dwordx4 a[12:15], v7, s[16:19], s36 offen sc1
    s_barrier
    ds_read_b128 a[0:3], v6 offset:16896
    ds_read_b128 a[4:7], v6 offset:17952
    ds_read_b128 a[8:11], v6 offset:19008
    ds_read_b128 a[12:15], v6 offset:20064
    s_waitcnt lgkmcnt(3)
    s_mov_b32 s36, 114688
    buffer_store_dwordx4 a[0:3], v7, s[16:19], s36 offen sc1
    s_waitcnt lgkmcnt(2)
    s_mov_b32 s36, 115712
    buffer_store_dwordx4 a[4:7], v7, s[16:19], s36 offen sc1
    s_waitcnt lgkmcnt(1)
    s_mov_b32 s36, 116736
    buffer_store_dwordx4 a[8:11], v7, s[16:19], s36 offen sc1
    s_waitcnt lgkmcnt(0)
    s_mov_b32 s36, 117760
    buffer_store_dwordx4 a[12:15], v7, s[16:19], s36 offen sc1
    s_endpgm
L_joint_kernel_slow:
    buffer_load_dwordx4 v[96:99], v14, s[12:15], s37 offen offset:0
    buffer_load_dwordx4 v[100:103], v14, s[12:15], s37 offen offset:32
    buffer_load_dwordx4 v[104:107], v14, s[12:15], s37 offen offset:64
    buffer_load_dwordx4 v[108:111], v14, s[12:15], s37 offen offset:96
    buffer_load_dwordx4 v[112:115], v14, s[12:15], s37 offen offset:128
    buffer_load_dwordx4 v[116:119], v14, s[12:15], s37 offen offset:160
    buffer_load_dwordx4 v[120:123], v14, s[12:15], s37 offen offset:192
    buffer_load_dwordx4 v[124:127], v14, s[12:15], s37 offen offset:224
    s_waitcnt vmcnt(0)
    ds_write_b128 v9, v[64:67] offset:0
    ds_write_b128 v9, v[68:71] offset:32
    ds_write_b128 v9, v[72:75] offset:64
    ds_write_b128 v9, v[76:79] offset:96
    ds_write_b128 v9, v[80:83] offset:128
    ds_write_b128 v9, v[84:87] offset:160
    ds_write_b128 v9, v[88:91] offset:192
    ds_write_b128 v9, v[92:95] offset:224
    s_waitcnt lgkmcnt(0)
    ds_read_b128 v[32:35], v4 offset:0
    ds_read_b128 v[36:39], v4 offset:32
    ds_read_b128 v[40:43], v4 offset:64
    ds_read_b128 v[44:47], v4 offset:96
    ds_read_b128 v[48:51], v4 offset:128
    ds_read_b128 v[52:55], v4 offset:160
    ds_read_b128 v[56:59], v4 offset:192
    ds_read_b128 v[60:63], v4 offset:224
    s_waitcnt lgkmcnt(6)
    v_add_f32 v64, v32, v96
    v_add_f32 v65, v33, v97
    v_add_f32 v66, v34, v98
    v_add_f32 v67, v35, v99
    v_add_f32 v68, v36, v100
    v_add_f32 v69, v37, v101
    v_add_f32 v70, v38, v102
    v_add_f32 v71, v39, v103
    ds_read_b128 v[32:35], v4 offset:4224
    ds_read_b128 v[36:39], v4 offset:4256
    v_exp_f32 v64, v64
    v_exp_f32 v65, v65
    v_exp_f32 v66, v66
    v_exp_f32 v67, v67
    v_exp_f32 v68, v68
    v_exp_f32 v69, v69
    v_exp_f32 v70, v70
    v_exp_f32 v71, v71
    v_add_f32 v64, 1.0, v64
    v_add_f32 v65, 1.0, v65
    v_add_f32 v66, 1.0, v66
    v_add_f32 v67, 1.0, v67
    v_add_f32 v68, 1.0, v68
    v_add_f32 v69, 1.0, v69
    v_add_f32 v70, 1.0, v70
    v_add_f32 v71, 1.0, v71
    v_rcp_f32 v64, v64
    v_rcp_f32 v65, v65
    v_rcp_f32 v66, v66
    v_rcp_f32 v67, v67
    v_rcp_f32 v68, v68
    v_rcp_f32 v69, v69
    v_rcp_f32 v70, v70
    v_rcp_f32 v71, v71
    s_nop 0
    v_cvt_pk_bf16_f32 v80, v64, v65
    v_cvt_pk_bf16_f32 v81, v66, v67
    v_cvt_pk_bf16_f32 v82, v68, v69
    v_cvt_pk_bf16_f32 v83, v70, v71
    ds_write_b128 v2, v[80:83] offset:0
    s_waitcnt lgkmcnt(7)
    v_add_f32 v72, v40, v104
    v_add_f32 v73, v41, v105
    v_add_f32 v74, v42, v106
    v_add_f32 v75, v43, v107
    v_add_f32 v76, v44, v108
    v_add_f32 v77, v45, v109
    v_add_f32 v78, v46, v110
    v_add_f32 v79, v47, v111
    ds_read_b128 v[40:43], v4 offset:4288
    ds_read_b128 v[44:47], v4 offset:4320
    v_exp_f32 v72, v72
    v_exp_f32 v73, v73
    v_exp_f32 v74, v74
    v_exp_f32 v75, v75
    v_exp_f32 v76, v76
    v_exp_f32 v77, v77
    v_exp_f32 v78, v78
    v_exp_f32 v79, v79
    v_add_f32 v72, 1.0, v72
    v_add_f32 v73, 1.0, v73
    v_add_f32 v74, 1.0, v74
    v_add_f32 v75, 1.0, v75
    v_add_f32 v76, 1.0, v76
    v_add_f32 v77, 1.0, v77
    v_add_f32 v78, 1.0, v78
    v_add_f32 v79, 1.0, v79
    v_rcp_f32 v72, v72
    v_rcp_f32 v73, v73
    v_rcp_f32 v74, v74
    v_rcp_f32 v75, v75
    v_rcp_f32 v76, v76
    v_rcp_f32 v77, v77
    v_rcp_f32 v78, v78
    v_rcp_f32 v79, v79
    s_nop 0
    v_cvt_pk_bf16_f32 v84, v72, v73
    v_cvt_pk_bf16_f32 v85, v74, v75
    v_cvt_pk_bf16_f32 v86, v76, v77
    v_cvt_pk_bf16_f32 v87, v78, v79
    ds_write_b128 v2, v[84:87] offset:1024
    s_waitcnt lgkmcnt(8)
    v_add_f32 v64, v48, v112
    v_add_f32 v65, v49, v113
    v_add_f32 v66, v50, v114
    v_add_f32 v67, v51, v115
    v_add_f32 v68, v52, v116
    v_add_f32 v69, v53, v117
    v_add_f32 v70, v54, v118
    v_add_f32 v71, v55, v119
    ds_read_b128 v[48:51], v4 offset:4352
    ds_read_b128 v[52:55], v4 offset:4384
    v_exp_f32 v64, v64
    v_exp_f32 v65, v65
    v_exp_f32 v66, v66
    v_exp_f32 v67, v67
    v_exp_f32 v68, v68
    v_exp_f32 v69, v69
    v_exp_f32 v70, v70
    v_exp_f32 v71, v71
    v_add_f32 v64, 1.0, v64
    v_add_f32 v65, 1.0, v65
    v_add_f32 v66, 1.0, v66
    v_add_f32 v67, 1.0, v67
    v_add_f32 v68, 1.0, v68
    v_add_f32 v69, 1.0, v69
    v_add_f32 v70, 1.0, v70
    v_add_f32 v71, 1.0, v71
    v_rcp_f32 v64, v64
    v_rcp_f32 v65, v65
    v_rcp_f32 v66, v66
    v_rcp_f32 v67, v67
    v_rcp_f32 v68, v68
    v_rcp_f32 v69, v69
    v_rcp_f32 v70, v70
    v_rcp_f32 v71, v71
    s_nop 0
    v_cvt_pk_bf16_f32 v80, v64, v65
    v_cvt_pk_bf16_f32 v81, v66, v67
    v_cvt_pk_bf16_f32 v82, v68, v69
    v_cvt_pk_bf16_f32 v83, v70, v71
    ds_write_b128 v2, v[80:83] offset:2048
    s_waitcnt lgkmcnt(9)
    v_add_f32 v72, v56, v120
    v_add_f32 v73, v57, v121
    v_add_f32 v74, v58, v122
    v_add_f32 v75, v59, v123
    v_add_f32 v76, v60, v124
    v_add_f32 v77, v61, v125
    v_add_f32 v78, v62, v126
    v_add_f32 v79, v63, v127
    ds_read_b128 v[56:59], v4 offset:4416
    ds_read_b128 v[60:63], v4 offset:4448
    v_exp_f32 v72, v72
    v_exp_f32 v73, v73
    v_exp_f32 v74, v74
    v_exp_f32 v75, v75
    v_exp_f32 v76, v76
    v_exp_f32 v77, v77
    v_exp_f32 v78, v78
    v_exp_f32 v79, v79
    v_add_f32 v72, 1.0, v72
    v_add_f32 v73, 1.0, v73
    v_add_f32 v74, 1.0, v74
    v_add_f32 v75, 1.0, v75
    v_add_f32 v76, 1.0, v76
    v_add_f32 v77, 1.0, v77
    v_add_f32 v78, 1.0, v78
    v_add_f32 v79, 1.0, v79
    v_rcp_f32 v72, v72
    v_rcp_f32 v73, v73
    v_rcp_f32 v74, v74
    v_rcp_f32 v75, v75
    v_rcp_f32 v76, v76
    v_rcp_f32 v77, v77
    v_rcp_f32 v78, v78
    v_rcp_f32 v79, v79
    s_nop 0
    v_cvt_pk_bf16_f32 v84, v72, v73
    v_cvt_pk_bf16_f32 v85, v74, v75
    v_cvt_pk_bf16_f32 v86, v76, v77
    v_cvt_pk_bf16_f32 v87, v78, v79
    ds_write_b128 v2, v[84:87] offset:3072
    s_waitcnt lgkmcnt(10)
    v_add_f32 v64, v32, v96
    v_add_f32 v65, v33, v97
    v_add_f32 v66, v34, v98
    v_add_f32 v67, v35, v99
    v_add_f32 v68, v36, v100
    v_add_f32 v69, v37, v101
    v_add_f32 v70, v38, v102
    v_add_f32 v71, v39, v103
    ds_read_b128 v[32:35], v4 offset:8448
    ds_read_b128 v[36:39], v4 offset:8480
    v_exp_f32 v64, v64
    v_exp_f32 v65, v65
    v_exp_f32 v66, v66
    v_exp_f32 v67, v67
    v_exp_f32 v68, v68
    v_exp_f32 v69, v69
    v_exp_f32 v70, v70
    v_exp_f32 v71, v71
    v_add_f32 v64, 1.0, v64
    v_add_f32 v65, 1.0, v65
    v_add_f32 v66, 1.0, v66
    v_add_f32 v67, 1.0, v67
    v_add_f32 v68, 1.0, v68
    v_add_f32 v69, 1.0, v69
    v_add_f32 v70, 1.0, v70
    v_add_f32 v71, 1.0, v71
    v_rcp_f32 v64, v64
    v_rcp_f32 v65, v65
    v_rcp_f32 v66, v66
    v_rcp_f32 v67, v67
    v_rcp_f32 v68, v68
    v_rcp_f32 v69, v69
    v_rcp_f32 v70, v70
    v_rcp_f32 v71, v71
    s_nop 0
    v_cvt_pk_bf16_f32 v80, v64, v65
    v_cvt_pk_bf16_f32 v81, v66, v67
    v_cvt_pk_bf16_f32 v82, v68, v69
    v_cvt_pk_bf16_f32 v83, v70, v71
    ds_write_b128 v2, v[80:83] offset:16384
    s_waitcnt lgkmcnt(10)
    v_add_f32 v72, v40, v104
    v_add_f32 v73, v41, v105
    v_add_f32 v74, v42, v106
    v_add_f32 v75, v43, v107
    v_add_f32 v76, v44, v108
    v_add_f32 v77, v45, v109
    v_add_f32 v78, v46, v110
    v_add_f32 v79, v47, v111
    ds_read_b128 v[40:43], v4 offset:8512
    ds_read_b128 v[44:47], v4 offset:8544
    v_exp_f32 v72, v72
    v_exp_f32 v73, v73
    v_exp_f32 v74, v74
    v_exp_f32 v75, v75
    v_exp_f32 v76, v76
    v_exp_f32 v77, v77
    v_exp_f32 v78, v78
    v_exp_f32 v79, v79
    v_add_f32 v72, 1.0, v72
    v_add_f32 v73, 1.0, v73
    v_add_f32 v74, 1.0, v74
    v_add_f32 v75, 1.0, v75
    v_add_f32 v76, 1.0, v76
    v_add_f32 v77, 1.0, v77
    v_add_f32 v78, 1.0, v78
    v_add_f32 v79, 1.0, v79
    v_rcp_f32 v72, v72
    v_rcp_f32 v73, v73
    v_rcp_f32 v74, v74
    v_rcp_f32 v75, v75
    v_rcp_f32 v76, v76
    v_rcp_f32 v77, v77
    v_rcp_f32 v78, v78
    v_rcp_f32 v79, v79
    s_nop 0
    v_cvt_pk_bf16_f32 v84, v72, v73
    v_cvt_pk_bf16_f32 v85, v74, v75
    v_cvt_pk_bf16_f32 v86, v76, v77
    v_cvt_pk_bf16_f32 v87, v78, v79
    ds_write_b128 v2, v[84:87] offset:17408
    s_waitcnt lgkmcnt(10)
    v_add_f32 v64, v48, v112
    v_add_f32 v65, v49, v113
    v_add_f32 v66, v50, v114
    v_add_f32 v67, v51, v115
    v_add_f32 v68, v52, v116
    v_add_f32 v69, v53, v117
    v_add_f32 v70, v54, v118
    v_add_f32 v71, v55, v119
    ds_read_b128 v[48:51], v4 offset:8576
    ds_read_b128 v[52:55], v4 offset:8608
    v_exp_f32 v64, v64
    v_exp_f32 v65, v65
    v_exp_f32 v66, v66
    v_exp_f32 v67, v67
    v_exp_f32 v68, v68
    v_exp_f32 v69, v69
    v_exp_f32 v70, v70
    v_exp_f32 v71, v71
    v_add_f32 v64, 1.0, v64
    v_add_f32 v65, 1.0, v65
    v_add_f32 v66, 1.0, v66
    v_add_f32 v67, 1.0, v67
    v_add_f32 v68, 1.0, v68
    v_add_f32 v69, 1.0, v69
    v_add_f32 v70, 1.0, v70
    v_add_f32 v71, 1.0, v71
    v_rcp_f32 v64, v64
    v_rcp_f32 v65, v65
    v_rcp_f32 v66, v66
    v_rcp_f32 v67, v67
    v_rcp_f32 v68, v68
    v_rcp_f32 v69, v69
    v_rcp_f32 v70, v70
    v_rcp_f32 v71, v71
    s_nop 0
    v_cvt_pk_bf16_f32 v80, v64, v65
    v_cvt_pk_bf16_f32 v81, v66, v67
    v_cvt_pk_bf16_f32 v82, v68, v69
    v_cvt_pk_bf16_f32 v83, v70, v71
    ds_write_b128 v2, v[80:83] offset:18432
    s_waitcnt lgkmcnt(10)
    v_add_f32 v72, v56, v120
    v_add_f32 v73, v57, v121
    v_add_f32 v74, v58, v122
    v_add_f32 v75, v59, v123
    v_add_f32 v76, v60, v124
    v_add_f32 v77, v61, v125
    v_add_f32 v78, v62, v126
    v_add_f32 v79, v63, v127
    ds_read_b128 v[56:59], v4 offset:8640
    ds_read_b128 v[60:63], v4 offset:8672
    v_exp_f32 v72, v72
    v_exp_f32 v73, v73
    v_exp_f32 v74, v74
    v_exp_f32 v75, v75
    v_exp_f32 v76, v76
    v_exp_f32 v77, v77
    v_exp_f32 v78, v78
    v_exp_f32 v79, v79
    v_add_f32 v72, 1.0, v72
    v_add_f32 v73, 1.0, v73
    v_add_f32 v74, 1.0, v74
    v_add_f32 v75, 1.0, v75
    v_add_f32 v76, 1.0, v76
    v_add_f32 v77, 1.0, v77
    v_add_f32 v78, 1.0, v78
    v_add_f32 v79, 1.0, v79
    v_rcp_f32 v72, v72
    v_rcp_f32 v73, v73
    v_rcp_f32 v74, v74
    v_rcp_f32 v75, v75
    v_rcp_f32 v76, v76
    v_rcp_f32 v77, v77
    v_rcp_f32 v78, v78
    v_rcp_f32 v79, v79
    s_nop 0
    v_cvt_pk_bf16_f32 v84, v72, v73
    v_cvt_pk_bf16_f32 v85, v74, v75
    v_cvt_pk_bf16_f32 v86, v76, v77
    v_cvt_pk_bf16_f32 v87, v78, v79
    ds_write_b128 v2, v[84:87] offset:19456
    s_waitcnt lgkmcnt(0)
    s_barrier
    v_add_f32 v64, v32, v96
    v_add_f32 v65, v33, v97
    v_add_f32 v66, v34, v98
    v_add_f32 v67, v35, v99
    v_add_f32 v68, v36, v100
    v_add_f32 v69, v37, v101
    v_add_f32 v70, v38, v102
    v_add_f32 v71, v39, v103
    ds_read_b128 v[32:35], v4 offset:12672
    ds_read_b128 v[36:39], v4 offset:12704
    v_exp_f32 v64, v64
    v_exp_f32 v65, v65
    v_exp_f32 v66, v66
    v_exp_f32 v67, v67
    v_exp_f32 v68, v68
    v_exp_f32 v69, v69
    v_exp_f32 v70, v70
    v_exp_f32 v71, v71
    v_add_f32 v64, 1.0, v64
    v_add_f32 v65, 1.0, v65
    v_add_f32 v66, 1.0, v66
    v_add_f32 v67, 1.0, v67
    v_add_f32 v68, 1.0, v68
    v_add_f32 v69, 1.0, v69
    v_add_f32 v70, 1.0, v70
    v_add_f32 v71, 1.0, v71
    v_rcp_f32 v64, v64
    v_rcp_f32 v65, v65
    v_rcp_f32 v66, v66
    v_rcp_f32 v67, v67
    v_rcp_f32 v68, v68
    v_rcp_f32 v69, v69
    v_rcp_f32 v70, v70
    v_rcp_f32 v71, v71
    s_nop 0
    v_cvt_pk_bf16_f32 v80, v64, v65
    v_cvt_pk_bf16_f32 v81, v66, v67
    v_cvt_pk_bf16_f32 v82, v68, v69
    v_cvt_pk_bf16_f32 v83, v70, v71
    ds_write_b128 v2, v[80:83] offset:32768
    v_add_f32 v72, v40, v104
    v_add_f32 v73, v41, v105
    v_add_f32 v74, v42, v106
    v_add_f32 v75, v43, v107
    v_add_f32 v76, v44, v108
    v_add_f32 v77, v45, v109
    v_add_f32 v78, v46, v110
    v_add_f32 v79, v47, v111
    ds_read_b128 v[40:43], v4 offset:12736
    ds_read_b128 v[44:47], v4 offset:12768
    v_exp_f32 v72, v72
    v_exp_f32 v73, v73
    v_exp_f32 v74, v74
    v_exp_f32 v75, v75
    v_exp_f32 v76, v76
    v_exp_f32 v77, v77
    v_exp_f32 v78, v78
    v_exp_f32 v79, v79
    v_add_f32 v72, 1.0, v72
    v_add_f32 v73, 1.0, v73
    v_add_f32 v74, 1.0, v74
    v_add_f32 v75, 1.0, v75
    v_add_f32 v76, 1.0, v76
    v_add_f32 v77, 1.0, v77
    v_add_f32 v78, 1.0, v78
    v_add_f32 v79, 1.0, v79
    v_rcp_f32 v72, v72
    v_rcp_f32 v73, v73
    v_rcp_f32 v74, v74
    v_rcp_f32 v75, v75
    v_rcp_f32 v76, v76
    v_rcp_f32 v77, v77
    v_rcp_f32 v78, v78
    v_rcp_f32 v79, v79
    s_nop 0
    v_cvt_pk_bf16_f32 v84, v72, v73
    v_cvt_pk_bf16_f32 v85, v74, v75
    v_cvt_pk_bf16_f32 v86, v76, v77
    v_cvt_pk_bf16_f32 v87, v78, v79
    ds_write_b128 v2, v[84:87] offset:33792
    v_add_f32 v64, v48, v112
    v_add_f32 v65, v49, v113
    v_add_f32 v66, v50, v114
    v_add_f32 v67, v51, v115
    v_add_f32 v68, v52, v116
    v_add_f32 v69, v53, v117
    v_add_f32 v70, v54, v118
    v_add_f32 v71, v55, v119
    ds_read_b128 v[48:51], v4 offset:12800
    ds_read_b128 v[52:55], v4 offset:12832
    v_exp_f32 v64, v64
    v_exp_f32 v65, v65
    v_exp_f32 v66, v66
    v_exp_f32 v67, v67
    v_exp_f32 v68, v68
    v_exp_f32 v69, v69
    v_exp_f32 v70, v70
    v_exp_f32 v71, v71
    v_add_f32 v64, 1.0, v64
    v_add_f32 v65, 1.0, v65
    v_add_f32 v66, 1.0, v66
    v_add_f32 v67, 1.0, v67
    v_add_f32 v68, 1.0, v68
    v_add_f32 v69, 1.0, v69
    v_add_f32 v70, 1.0, v70
    v_add_f32 v71, 1.0, v71
    v_rcp_f32 v64, v64
    v_rcp_f32 v65, v65
    v_rcp_f32 v66, v66
    v_rcp_f32 v67, v67
    v_rcp_f32 v68, v68
    v_rcp_f32 v69, v69
    v_rcp_f32 v70, v70
    v_rcp_f32 v71, v71
    s_nop 0
    v_cvt_pk_bf16_f32 v80, v64, v65
    v_cvt_pk_bf16_f32 v81, v66, v67
    v_cvt_pk_bf16_f32 v82, v68, v69
    v_cvt_pk_bf16_f32 v83, v70, v71
    ds_write_b128 v2, v[80:83] offset:34816
    v_add_f32 v72, v56, v120
    v_add_f32 v73, v57, v121
    v_add_f32 v74, v58, v122
    v_add_f32 v75, v59, v123
    v_add_f32 v76, v60, v124
    v_add_f32 v77, v61, v125
    v_add_f32 v78, v62, v126
    v_add_f32 v79, v63, v127
    ds_read_b128 v[56:59], v4 offset:12864
    ds_read_b128 v[60:63], v4 offset:12896
    v_exp_f32 v72, v72
    v_exp_f32 v73, v73
    v_exp_f32 v74, v74
    v_exp_f32 v75, v75
    v_exp_f32 v76, v76
    v_exp_f32 v77, v77
    v_exp_f32 v78, v78
    v_exp_f32 v79, v79
    v_add_f32 v72, 1.0, v72
    v_add_f32 v73, 1.0, v73
    v_add_f32 v74, 1.0, v74
    v_add_f32 v75, 1.0, v75
    v_add_f32 v76, 1.0, v76
    v_add_f32 v77, 1.0, v77
    v_add_f32 v78, 1.0, v78
    v_add_f32 v79, 1.0, v79
    v_rcp_f32 v72, v72
    v_rcp_f32 v73, v73
    v_rcp_f32 v74, v74
    v_rcp_f32 v75, v75
    v_rcp_f32 v76, v76
    v_rcp_f32 v77, v77
    v_rcp_f32 v78, v78
    v_rcp_f32 v79, v79
    s_nop 0
    v_cvt_pk_bf16_f32 v84, v72, v73
    v_cvt_pk_bf16_f32 v85, v74, v75
    v_cvt_pk_bf16_f32 v86, v76, v77
    v_cvt_pk_bf16_f32 v87, v78, v79
    ds_write_b128 v2, v[84:87] offset:35840
    s_waitcnt lgkmcnt(0)
    s_barrier
    v_add_f32 v64, v32, v96
    v_add_f32 v65, v33, v97
    v_add_f32 v66, v34, v98
    v_add_f32 v67, v35, v99
    v_add_f32 v68, v36, v100
    v_add_f32 v69, v37, v101
    v_add_f32 v70, v38, v102
    v_add_f32 v71, v39, v103
    ds_read_b128 v[32:35], v4 offset:16896
    ds_read_b128 v[36:39], v4 offset:16928
    v_exp_f32 v64, v64
    v_exp_f32 v65, v65
    v_exp_f32 v66, v66
    v_exp_f32 v67, v67
    v_exp_f32 v68, v68
    v_exp_f32 v69, v69
    v_exp_f32 v70, v70
    v_exp_f32 v71, v71
    v_add_f32 v64, 1.0, v64
    v_add_f32 v65, 1.0, v65
    v_add_f32 v66, 1.0, v66
    v_add_f32 v67, 1.0, v67
    v_add_f32 v68, 1.0, v68
    v_add_f32 v69, 1.0, v69
    v_add_f32 v70, 1.0, v70
    v_add_f32 v71, 1.0, v71
    v_rcp_f32 v64, v64
    v_rcp_f32 v65, v65
    v_rcp_f32 v66, v66
    v_rcp_f32 v67, v67
    v_rcp_f32 v68, v68
    v_rcp_f32 v69, v69
    v_rcp_f32 v70, v70
    v_rcp_f32 v71, v71
    s_nop 0
    v_cvt_pk_bf16_f32 v80, v64, v65
    v_cvt_pk_bf16_f32 v81, v66, v67
    v_cvt_pk_bf16_f32 v82, v68, v69
    v_cvt_pk_bf16_f32 v83, v70, v71
    ds_write_b128 v2, v[80:83] offset:0
    v_add_f32 v72, v40, v104
    v_add_f32 v73, v41, v105
    v_add_f32 v74, v42, v106
    v_add_f32 v75, v43, v107
    v_add_f32 v76, v44, v108
    v_add_f32 v77, v45, v109
    v_add_f32 v78, v46, v110
    v_add_f32 v79, v47, v111
    ds_read_b128 v[40:43], v4 offset:16960
    ds_read_b128 v[44:47], v4 offset:16992
    v_exp_f32 v72, v72
    v_exp_f32 v73, v73
    v_exp_f32 v74, v74
    v_exp_f32 v75, v75
    v_exp_f32 v76, v76
    v_exp_f32 v77, v77
    v_exp_f32 v78, v78
    v_exp_f32 v79, v79
    v_add_f32 v72, 1.0, v72
    v_add_f32 v73, 1.0, v73
    v_add_f32 v74, 1.0, v74
    v_add_f32 v75, 1.0, v75
    v_add_f32 v76, 1.0, v76
    v_add_f32 v77, 1.0, v77
    v_add_f32 v78, 1.0, v78
    v_add_f32 v79, 1.0, v79
    v_rcp_f32 v72, v72
    v_rcp_f32 v73, v73
    v_rcp_f32 v74, v74
    v_rcp_f32 v75, v75
    v_rcp_f32 v76, v76
    v_rcp_f32 v77, v77
    v_rcp_f32 v78, v78
    v_rcp_f32 v79, v79
    s_nop 0
    v_cvt_pk_bf16_f32 v84, v72, v73
    v_cvt_pk_bf16_f32 v85, v74, v75
    v_cvt_pk_bf16_f32 v86, v76, v77
    v_cvt_pk_bf16_f32 v87, v78, v79
    ds_write_b128 v2, v[84:87] offset:1024
    v_add_f32 v64, v48, v112
    v_add_f32 v65, v49, v113
    v_add_f32 v66, v50, v114
    v_add_f32 v67, v51, v115
    v_add_f32 v68, v52, v116
    v_add_f32 v69, v53, v117
    v_add_f32 v70, v54, v118
    v_add_f32 v71, v55, v119
    ds_read_b128 v[48:51], v4 offset:17024
    ds_read_b128 v[52:55], v4 offset:17056
    v_exp_f32 v64, v64
    v_exp_f32 v65, v65
    v_exp_f32 v66, v66
    v_exp_f32 v67, v67
    v_exp_f32 v68, v68
    v_exp_f32 v69, v69
    v_exp_f32 v70, v70
    v_exp_f32 v71, v71
    v_add_f32 v64, 1.0, v64
    v_add_f32 v65, 1.0, v65
    v_add_f32 v66, 1.0, v66
    v_add_f32 v67, 1.0, v67
    v_add_f32 v68, 1.0, v68
    v_add_f32 v69, 1.0, v69
    v_add_f32 v70, 1.0, v70
    v_add_f32 v71, 1.0, v71
    v_rcp_f32 v64, v64
    v_rcp_f32 v65, v65
    v_rcp_f32 v66, v66
    v_rcp_f32 v67, v67
    v_rcp_f32 v68, v68
    v_rcp_f32 v69, v69
    v_rcp_f32 v70, v70
    v_rcp_f32 v71, v71
    s_nop 0
    v_cvt_pk_bf16_f32 v80, v64, v65
    v_cvt_pk_bf16_f32 v81, v66, v67
    v_cvt_pk_bf16_f32 v82, v68, v69
    v_cvt_pk_bf16_f32 v83, v70, v71
    ds_write_b128 v2, v[80:83] offset:2048
    v_add_f32 v72, v56, v120
    v_add_f32 v73, v57, v121
    v_add_f32 v74, v58, v122
    v_add_f32 v75, v59, v123
    v_add_f32 v76, v60, v124
    v_add_f32 v77, v61, v125
    v_add_f32 v78, v62, v126
    v_add_f32 v79, v63, v127
    ds_read_b128 v[56:59], v4 offset:17088
    ds_read_b128 v[60:63], v4 offset:17120
    v_exp_f32 v72, v72
    v_exp_f32 v73, v73
    v_exp_f32 v74, v74
    v_exp_f32 v75, v75
    v_exp_f32 v76, v76
    v_exp_f32 v77, v77
    v_exp_f32 v78, v78
    v_exp_f32 v79, v79
    v_add_f32 v72, 1.0, v72
    v_add_f32 v73, 1.0, v73
    v_add_f32 v74, 1.0, v74
    v_add_f32 v75, 1.0, v75
    v_add_f32 v76, 1.0, v76
    v_add_f32 v77, 1.0, v77
    v_add_f32 v78, 1.0, v78
    v_add_f32 v79, 1.0, v79
    v_rcp_f32 v72, v72
    v_rcp_f32 v73, v73
    v_rcp_f32 v74, v74
    v_rcp_f32 v75, v75
    v_rcp_f32 v76, v76
    v_rcp_f32 v77, v77
    v_rcp_f32 v78, v78
    v_rcp_f32 v79, v79
    s_nop 0
    v_cvt_pk_bf16_f32 v84, v72, v73
    v_cvt_pk_bf16_f32 v85, v74, v75
    v_cvt_pk_bf16_f32 v86, v76, v77
    v_cvt_pk_bf16_f32 v87, v78, v79
    ds_write_b128 v2, v[84:87] offset:3072
    s_waitcnt lgkmcnt(0)
    s_barrier
    ds_read_b128 a[0:3], v6 offset:0
    ds_read_b128 a[4:7], v6 offset:1056
    ds_read_b128 a[8:11], v6 offset:2112
    ds_read_b128 a[12:15], v6 offset:3168
    v_add_f32 v64, v32, v96
    v_add_f32 v65, v33, v97
    v_add_f32 v66, v34, v98
    v_add_f32 v67, v35, v99
    v_add_f32 v68, v36, v100
    v_add_f32 v69, v37, v101
    v_add_f32 v70, v38, v102
    v_add_f32 v71, v39, v103
    ds_read_b128 v[32:35], v4 offset:21120
    ds_read_b128 v[36:39], v4 offset:21152
    v_exp_f32 v64, v64
    v_exp_f32 v65, v65
    v_exp_f32 v66, v66
    v_exp_f32 v67, v67
    v_exp_f32 v68, v68
    v_exp_f32 v69, v69
    v_exp_f32 v70, v70
    v_exp_f32 v71, v71
    v_add_f32 v64, 1.0, v64
    v_add_f32 v65, 1.0, v65
    v_add_f32 v66, 1.0, v66
    v_add_f32 v67, 1.0, v67
    v_add_f32 v68, 1.0, v68
    v_add_f32 v69, 1.0, v69
    v_add_f32 v70, 1.0, v70
    v_add_f32 v71, 1.0, v71
    v_rcp_f32 v64, v64
    v_rcp_f32 v65, v65
    v_rcp_f32 v66, v66
    v_rcp_f32 v67, v67
    v_rcp_f32 v68, v68
    v_rcp_f32 v69, v69
    v_rcp_f32 v70, v70
    v_rcp_f32 v71, v71
    s_waitcnt lgkmcnt(5)
    s_mov_b32 s36, 0
    buffer_store_dwordx4 a[0:3], v7, s[16:19], s36 offen sc1
    s_waitcnt lgkmcnt(4)
    s_mov_b32 s36, 1024
    buffer_store_dwordx4 a[4:7], v7, s[16:19], s36 offen sc1
    v_cvt_pk_bf16_f32 v80, v64, v65
    v_cvt_pk_bf16_f32 v81, v66, v67
    v_cvt_pk_bf16_f32 v82, v68, v69
    v_cvt_pk_bf16_f32 v83, v70, v71
    ds_write_b128 v2, v[80:83] offset:16384
    v_add_f32 v72, v40, v104
    v_add_f32 v73, v41, v105
    v_add_f32 v74, v42, v106
    v_add_f32 v75, v43, v107
    v_add_f32 v76, v44, v108
    v_add_f32 v77, v45, v109
    v_add_f32 v78, v46, v110
    v_add_f32 v79, v47, v111
    ds_read_b128 v[40:43], v4 offset:21184
    ds_read_b128 v[44:47], v4 offset:21216
    v_exp_f32 v72, v72
    v_exp_f32 v73, v73
    v_exp_f32 v74, v74
    v_exp_f32 v75, v75
    v_exp_f32 v76, v76
    v_exp_f32 v77, v77
    v_exp_f32 v78, v78
    v_exp_f32 v79, v79
    v_add_f32 v72, 1.0, v72
    v_add_f32 v73, 1.0, v73
    v_add_f32 v74, 1.0, v74
    v_add_f32 v75, 1.0, v75
    v_add_f32 v76, 1.0, v76
    v_add_f32 v77, 1.0, v77
    v_add_f32 v78, 1.0, v78
    v_add_f32 v79, 1.0, v79
    v_rcp_f32 v72, v72
    v_rcp_f32 v73, v73
    v_rcp_f32 v74, v74
    v_rcp_f32 v75, v75
    v_rcp_f32 v76, v76
    v_rcp_f32 v77, v77
    v_rcp_f32 v78, v78
    v_rcp_f32 v79, v79
    s_waitcnt lgkmcnt(6)
    s_mov_b32 s36, 2048
    buffer_store_dwordx4 a[8:11], v7, s[16:19], s36 offen sc1
    s_waitcnt lgkmcnt(5)
    s_mov_b32 s36, 3072
    buffer_store_dwordx4 a[12:15], v7, s[16:19], s36 offen sc1
    v_cvt_pk_bf16_f32 v84, v72, v73
    v_cvt_pk_bf16_f32 v85, v74, v75
    v_cvt_pk_bf16_f32 v86, v76, v77
    v_cvt_pk_bf16_f32 v87, v78, v79
    ds_write_b128 v2, v[84:87] offset:17408
    v_add_f32 v64, v48, v112
    v_add_f32 v65, v49, v113
    v_add_f32 v66, v50, v114
    v_add_f32 v67, v51, v115
    v_add_f32 v68, v52, v116
    v_add_f32 v69, v53, v117
    v_add_f32 v70, v54, v118
    v_add_f32 v71, v55, v119
    ds_read_b128 v[48:51], v4 offset:21248
    ds_read_b128 v[52:55], v4 offset:21280
    v_exp_f32 v64, v64
    v_exp_f32 v65, v65
    v_exp_f32 v66, v66
    v_exp_f32 v67, v67
    v_exp_f32 v68, v68
    v_exp_f32 v69, v69
    v_exp_f32 v70, v70
    v_exp_f32 v71, v71
    v_add_f32 v64, 1.0, v64
    v_add_f32 v65, 1.0, v65
    v_add_f32 v66, 1.0, v66
    v_add_f32 v67, 1.0, v67
    v_add_f32 v68, 1.0, v68
    v_add_f32 v69, 1.0, v69
    v_add_f32 v70, 1.0, v70
    v_add_f32 v71, 1.0, v71
    v_rcp_f32 v64, v64
    v_rcp_f32 v65, v65
    v_rcp_f32 v66, v66
    v_rcp_f32 v67, v67
    v_rcp_f32 v68, v68
    v_rcp_f32 v69, v69
    v_rcp_f32 v70, v70
    v_rcp_f32 v71, v71
    s_nop 0
    v_cvt_pk_bf16_f32 v80, v64, v65
    v_cvt_pk_bf16_f32 v81, v66, v67
    v_cvt_pk_bf16_f32 v82, v68, v69
    v_cvt_pk_bf16_f32 v83, v70, v71
    ds_write_b128 v2, v[80:83] offset:18432
    v_add_f32 v72, v56, v120
    v_add_f32 v73, v57, v121
    v_add_f32 v74, v58, v122
    v_add_f32 v75, v59, v123
    v_add_f32 v76, v60, v124
    v_add_f32 v77, v61, v125
    v_add_f32 v78, v62, v126
    v_add_f32 v79, v63, v127
    ds_read_b128 v[56:59], v4 offset:21312
    ds_read_b128 v[60:63], v4 offset:21344
    v_exp_f32 v72, v72
    v_exp_f32 v73, v73
    v_exp_f32 v74, v74
    v_exp_f32 v75, v75
    v_exp_f32 v76, v76
    v_exp_f32 v77, v77
    v_exp_f32 v78, v78
    v_exp_f32 v79, v79
    v_add_f32 v72, 1.0, v72
    v_add_f32 v73, 1.0, v73
    v_add_f32 v74, 1.0, v74
    v_add_f32 v75, 1.0, v75
    v_add_f32 v76, 1.0, v76
    v_add_f32 v77, 1.0, v77
    v_add_f32 v78, 1.0, v78
    v_add_f32 v79, 1.0, v79
    v_rcp_f32 v72, v72
    v_rcp_f32 v73, v73
    v_rcp_f32 v74, v74
    v_rcp_f32 v75, v75
    v_rcp_f32 v76, v76
    v_rcp_f32 v77, v77
    v_rcp_f32 v78, v78
    v_rcp_f32 v79, v79
    s_nop 0
    v_cvt_pk_bf16_f32 v84, v72, v73
    v_cvt_pk_bf16_f32 v85, v74, v75
    v_cvt_pk_bf16_f32 v86, v76, v77
    v_cvt_pk_bf16_f32 v87, v78, v79
    ds_write_b128 v2, v[84:87] offset:19456
    s_waitcnt lgkmcnt(0)
    s_barrier
    ds_read_b128 a[0:3], v6 offset:16896
    ds_read_b128 a[4:7], v6 offset:17952
    ds_read_b128 a[8:11], v6 offset:19008
    ds_read_b128 a[12:15], v6 offset:20064
    v_add_f32 v64, v32, v96
    v_add_f32 v65, v33, v97
    v_add_f32 v66, v34, v98
    v_add_f32 v67, v35, v99
    v_add_f32 v68, v36, v100
    v_add_f32 v69, v37, v101
    v_add_f32 v70, v38, v102
    v_add_f32 v71, v39, v103
    ds_read_b128 v[32:35], v4 offset:25344
    ds_read_b128 v[36:39], v4 offset:25376
    v_exp_f32 v64, v64
    v_exp_f32 v65, v65
    v_exp_f32 v66, v66
    v_exp_f32 v67, v67
    v_exp_f32 v68, v68
    v_exp_f32 v69, v69
    v_exp_f32 v70, v70
    v_exp_f32 v71, v71
    v_add_f32 v64, 1.0, v64
    v_add_f32 v65, 1.0, v65
    v_add_f32 v66, 1.0, v66
    v_add_f32 v67, 1.0, v67
    v_add_f32 v68, 1.0, v68
    v_add_f32 v69, 1.0, v69
    v_add_f32 v70, 1.0, v70
    v_add_f32 v71, 1.0, v71
    v_rcp_f32 v64, v64
    v_rcp_f32 v65, v65
    v_rcp_f32 v66, v66
    v_rcp_f32 v67, v67
    v_rcp_f32 v68, v68
    v_rcp_f32 v69, v69
    v_rcp_f32 v70, v70
    v_rcp_f32 v71, v71
    s_waitcnt lgkmcnt(5)
    s_mov_b32 s36, 16384
    buffer_store_dwordx4 a[0:3], v7, s[16:19], s36 offen sc1
    s_waitcnt lgkmcnt(4)
    s_mov_b32 s36, 17408
    buffer_store_dwordx4 a[4:7], v7, s[16:19], s36 offen sc1
    v_cvt_pk_bf16_f32 v80, v64, v65
    v_cvt_pk_bf16_f32 v81, v66, v67
    v_cvt_pk_bf16_f32 v82, v68, v69
    v_cvt_pk_bf16_f32 v83, v70, v71
    ds_write_b128 v2, v[80:83] offset:32768
    v_add_f32 v72, v40, v104
    v_add_f32 v73, v41, v105
    v_add_f32 v74, v42, v106
    v_add_f32 v75, v43, v107
    v_add_f32 v76, v44, v108
    v_add_f32 v77, v45, v109
    v_add_f32 v78, v46, v110
    v_add_f32 v79, v47, v111
    ds_read_b128 v[40:43], v4 offset:25408
    ds_read_b128 v[44:47], v4 offset:25440
    v_exp_f32 v72, v72
    v_exp_f32 v73, v73
    v_exp_f32 v74, v74
    v_exp_f32 v75, v75
    v_exp_f32 v76, v76
    v_exp_f32 v77, v77
    v_exp_f32 v78, v78
    v_exp_f32 v79, v79
    v_add_f32 v72, 1.0, v72
    v_add_f32 v73, 1.0, v73
    v_add_f32 v74, 1.0, v74
    v_add_f32 v75, 1.0, v75
    v_add_f32 v76, 1.0, v76
    v_add_f32 v77, 1.0, v77
    v_add_f32 v78, 1.0, v78
    v_add_f32 v79, 1.0, v79
    v_rcp_f32 v72, v72
    v_rcp_f32 v73, v73
    v_rcp_f32 v74, v74
    v_rcp_f32 v75, v75
    v_rcp_f32 v76, v76
    v_rcp_f32 v77, v77
    v_rcp_f32 v78, v78
    v_rcp_f32 v79, v79
    s_waitcnt lgkmcnt(6)
    s_mov_b32 s36, 18432
    buffer_store_dwordx4 a[8:11], v7, s[16:19], s36 offen sc1
    s_waitcnt lgkmcnt(5)
    s_mov_b32 s36, 19456
    buffer_store_dwordx4 a[12:15], v7, s[16:19], s36 offen sc1
    v_cvt_pk_bf16_f32 v84, v72, v73
    v_cvt_pk_bf16_f32 v85, v74, v75
    v_cvt_pk_bf16_f32 v86, v76, v77
    v_cvt_pk_bf16_f32 v87, v78, v79
    ds_write_b128 v2, v[84:87] offset:33792
    v_add_f32 v64, v48, v112
    v_add_f32 v65, v49, v113
    v_add_f32 v66, v50, v114
    v_add_f32 v67, v51, v115
    v_add_f32 v68, v52, v116
    v_add_f32 v69, v53, v117
    v_add_f32 v70, v54, v118
    v_add_f32 v71, v55, v119
    ds_read_b128 v[48:51], v4 offset:25472
    ds_read_b128 v[52:55], v4 offset:25504
    v_exp_f32 v64, v64
    v_exp_f32 v65, v65
    v_exp_f32 v66, v66
    v_exp_f32 v67, v67
    v_exp_f32 v68, v68
    v_exp_f32 v69, v69
    v_exp_f32 v70, v70
    v_exp_f32 v71, v71
    v_add_f32 v64, 1.0, v64
    v_add_f32 v65, 1.0, v65
    v_add_f32 v66, 1.0, v66
    v_add_f32 v67, 1.0, v67
    v_add_f32 v68, 1.0, v68
    v_add_f32 v69, 1.0, v69
    v_add_f32 v70, 1.0, v70
    v_add_f32 v71, 1.0, v71
    v_rcp_f32 v64, v64
    v_rcp_f32 v65, v65
    v_rcp_f32 v66, v66
    v_rcp_f32 v67, v67
    v_rcp_f32 v68, v68
    v_rcp_f32 v69, v69
    v_rcp_f32 v70, v70
    v_rcp_f32 v71, v71
    s_nop 0
    v_cvt_pk_bf16_f32 v80, v64, v65
    v_cvt_pk_bf16_f32 v81, v66, v67
    v_cvt_pk_bf16_f32 v82, v68, v69
    v_cvt_pk_bf16_f32 v83, v70, v71
    ds_write_b128 v2, v[80:83] offset:34816
    v_add_f32 v72, v56, v120
    v_add_f32 v73, v57, v121
    v_add_f32 v74, v58, v122
    v_add_f32 v75, v59, v123
    v_add_f32 v76, v60, v124
    v_add_f32 v77, v61, v125
    v_add_f32 v78, v62, v126
    v_add_f32 v79, v63, v127
    ds_read_b128 v[56:59], v4 offset:25536
    ds_read_b128 v[60:63], v4 offset:25568
    v_exp_f32 v72, v72
    v_exp_f32 v73, v73
    v_exp_f32 v74, v74
    v_exp_f32 v75, v75
    v_exp_f32 v76, v76
    v_exp_f32 v77, v77
    v_exp_f32 v78, v78
    v_exp_f32 v79, v79
    v_add_f32 v72, 1.0, v72
    v_add_f32 v73, 1.0, v73
    v_add_f32 v74, 1.0, v74
    v_add_f32 v75, 1.0, v75
    v_add_f32 v76, 1.0, v76
    v_add_f32 v77, 1.0, v77
    v_add_f32 v78, 1.0, v78
    v_add_f32 v79, 1.0, v79
    v_rcp_f32 v72, v72
    v_rcp_f32 v73, v73
    v_rcp_f32 v74, v74
    v_rcp_f32 v75, v75
    v_rcp_f32 v76, v76
    v_rcp_f32 v77, v77
    v_rcp_f32 v78, v78
    v_rcp_f32 v79, v79
    s_nop 0
    v_cvt_pk_bf16_f32 v84, v72, v73
    v_cvt_pk_bf16_f32 v85, v74, v75
    v_cvt_pk_bf16_f32 v86, v76, v77
    v_cvt_pk_bf16_f32 v87, v78, v79
    ds_write_b128 v2, v[84:87] offset:35840
    s_waitcnt lgkmcnt(0)
    s_barrier
    ds_read_b128 a[0:3], v6 offset:0
    ds_read_b128 a[4:7], v6 offset:1056
    ds_read_b128 a[8:11], v6 offset:2112
    ds_read_b128 a[12:15], v6 offset:3168
    v_add_f32 v64, v32, v96
    v_add_f32 v65, v33, v97
    v_add_f32 v66, v34, v98
    v_add_f32 v67, v35, v99
    v_add_f32 v68, v36, v100
    v_add_f32 v69, v37, v101
    v_add_f32 v70, v38, v102
    v_add_f32 v71, v39, v103
    ds_read_b128 v[32:35], v4 offset:29568
    ds_read_b128 v[36:39], v4 offset:29600
    v_exp_f32 v64, v64
    v_exp_f32 v65, v65
    v_exp_f32 v66, v66
    v_exp_f32 v67, v67
    v_exp_f32 v68, v68
    v_exp_f32 v69, v69
    v_exp_f32 v70, v70
    v_exp_f32 v71, v71
    v_add_f32 v64, 1.0, v64
    v_add_f32 v65, 1.0, v65
    v_add_f32 v66, 1.0, v66
    v_add_f32 v67, 1.0, v67
    v_add_f32 v68, 1.0, v68
    v_add_f32 v69, 1.0, v69
    v_add_f32 v70, 1.0, v70
    v_add_f32 v71, 1.0, v71
    v_rcp_f32 v64, v64
    v_rcp_f32 v65, v65
    v_rcp_f32 v66, v66
    v_rcp_f32 v67, v67
    v_rcp_f32 v68, v68
    v_rcp_f32 v69, v69
    v_rcp_f32 v70, v70
    v_rcp_f32 v71, v71
    s_waitcnt lgkmcnt(5)
    s_mov_b32 s36, 32768
    buffer_store_dwordx4 a[0:3], v7, s[16:19], s36 offen sc1
    s_waitcnt lgkmcnt(4)
    s_mov_b32 s36, 33792
    buffer_store_dwordx4 a[4:7], v7, s[16:19], s36 offen sc1
    v_cvt_pk_bf16_f32 v80, v64, v65
    v_cvt_pk_bf16_f32 v81, v66, v67
    v_cvt_pk_bf16_f32 v82, v68, v69
    v_cvt_pk_bf16_f32 v83, v70, v71
    ds_write_b128 v2, v[80:83] offset:0
    v_add_f32 v72, v40, v104
    v_add_f32 v73, v41, v105
    v_add_f32 v74, v42, v106
    v_add_f32 v75, v43, v107
    v_add_f32 v76, v44, v108
    v_add_f32 v77, v45, v109
    v_add_f32 v78, v46, v110
    v_add_f32 v79, v47, v111
    ds_read_b128 v[40:43], v4 offset:29632
    ds_read_b128 v[44:47], v4 offset:29664
    v_exp_f32 v72, v72
    v_exp_f32 v73, v73
    v_exp_f32 v74, v74
    v_exp_f32 v75, v75
    v_exp_f32 v76, v76
    v_exp_f32 v77, v77
    v_exp_f32 v78, v78
    v_exp_f32 v79, v79
    v_add_f32 v72, 1.0, v72
    v_add_f32 v73, 1.0, v73
    v_add_f32 v74, 1.0, v74
    v_add_f32 v75, 1.0, v75
    v_add_f32 v76, 1.0, v76
    v_add_f32 v77, 1.0, v77
    v_add_f32 v78, 1.0, v78
    v_add_f32 v79, 1.0, v79
    v_rcp_f32 v72, v72
    v_rcp_f32 v73, v73
    v_rcp_f32 v74, v74
    v_rcp_f32 v75, v75
    v_rcp_f32 v76, v76
    v_rcp_f32 v77, v77
    v_rcp_f32 v78, v78
    v_rcp_f32 v79, v79
    s_waitcnt lgkmcnt(6)
    s_mov_b32 s36, 34816
    buffer_store_dwordx4 a[8:11], v7, s[16:19], s36 offen sc1
    s_waitcnt lgkmcnt(5)
    s_mov_b32 s36, 35840
    buffer_store_dwordx4 a[12:15], v7, s[16:19], s36 offen sc1
    v_cvt_pk_bf16_f32 v84, v72, v73
    v_cvt_pk_bf16_f32 v85, v74, v75
    v_cvt_pk_bf16_f32 v86, v76, v77
    v_cvt_pk_bf16_f32 v87, v78, v79
    ds_write_b128 v2, v[84:87] offset:1024
    v_add_f32 v64, v48, v112
    v_add_f32 v65, v49, v113
    v_add_f32 v66, v50, v114
    v_add_f32 v67, v51, v115
    v_add_f32 v68, v52, v116
    v_add_f32 v69, v53, v117
    v_add_f32 v70, v54, v118
    v_add_f32 v71, v55, v119
    ds_read_b128 v[48:51], v4 offset:29696
    ds_read_b128 v[52:55], v4 offset:29728
    v_exp_f32 v64, v64
    v_exp_f32 v65, v65
    v_exp_f32 v66, v66
    v_exp_f32 v67, v67
    v_exp_f32 v68, v68
    v_exp_f32 v69, v69
    v_exp_f32 v70, v70
    v_exp_f32 v71, v71
    v_add_f32 v64, 1.0, v64
    v_add_f32 v65, 1.0, v65
    v_add_f32 v66, 1.0, v66
    v_add_f32 v67, 1.0, v67
    v_add_f32 v68, 1.0, v68
    v_add_f32 v69, 1.0, v69
    v_add_f32 v70, 1.0, v70
    v_add_f32 v71, 1.0, v71
    v_rcp_f32 v64, v64
    v_rcp_f32 v65, v65
    v_rcp_f32 v66, v66
    v_rcp_f32 v67, v67
    v_rcp_f32 v68, v68
    v_rcp_f32 v69, v69
    v_rcp_f32 v70, v70
    v_rcp_f32 v71, v71
    s_nop 0
    v_cvt_pk_bf16_f32 v80, v64, v65
    v_cvt_pk_bf16_f32 v81, v66, v67
    v_cvt_pk_bf16_f32 v82, v68, v69
    v_cvt_pk_bf16_f32 v83, v70, v71
    ds_write_b128 v2, v[80:83] offset:2048
    v_add_f32 v72, v56, v120
    v_add_f32 v73, v57, v121
    v_add_f32 v74, v58, v122
    v_add_f32 v75, v59, v123
    v_add_f32 v76, v60, v124
    v_add_f32 v77, v61, v125
    v_add_f32 v78, v62, v126
    v_add_f32 v79, v63, v127
    ds_read_b128 v[56:59], v4 offset:29760
    ds_read_b128 v[60:63], v4 offset:29792
    v_exp_f32 v72, v72
    v_exp_f32 v73, v73
    v_exp_f32 v74, v74
    v_exp_f32 v75, v75
    v_exp_f32 v76, v76
    v_exp_f32 v77, v77
    v_exp_f32 v78, v78
    v_exp_f32 v79, v79
    v_add_f32 v72, 1.0, v72
    v_add_f32 v73, 1.0, v73
    v_add_f32 v74, 1.0, v74
    v_add_f32 v75, 1.0, v75
    v_add_f32 v76, 1.0, v76
    v_add_f32 v77, 1.0, v77
    v_add_f32 v78, 1.0, v78
    v_add_f32 v79, 1.0, v79
    v_rcp_f32 v72, v72
    v_rcp_f32 v73, v73
    v_rcp_f32 v74, v74
    v_rcp_f32 v75, v75
    v_rcp_f32 v76, v76
    v_rcp_f32 v77, v77
    v_rcp_f32 v78, v78
    v_rcp_f32 v79, v79
    s_nop 0
    v_cvt_pk_bf16_f32 v84, v72, v73
    v_cvt_pk_bf16_f32 v85, v74, v75
    v_cvt_pk_bf16_f32 v86, v76, v77
    v_cvt_pk_bf16_f32 v87, v78, v79
    ds_write_b128 v2, v[84:87] offset:3072
    s_waitcnt lgkmcnt(0)
    s_barrier
    ds_read_b128 a[0:3], v6 offset:16896
    ds_read_b128 a[4:7], v6 offset:17952
    ds_read_b128 a[8:11], v6 offset:19008
    ds_read_b128 a[12:15], v6 offset:20064
    v_add_f32 v64, v32, v96
    v_add_f32 v65, v33, v97
    v_add_f32 v66, v34, v98
    v_add_f32 v67, v35, v99
    v_add_f32 v68, v36, v100
    v_add_f32 v69, v37, v101
    v_add_f32 v70, v38, v102
    v_add_f32 v71, v39, v103
    v_exp_f32 v64, v64
    v_exp_f32 v65, v65
    v_exp_f32 v66, v66
    v_exp_f32 v67, v67
    v_exp_f32 v68, v68
    v_exp_f32 v69, v69
    v_exp_f32 v70, v70
    v_exp_f32 v71, v71
    v_add_f32 v64, 1.0, v64
    v_add_f32 v65, 1.0, v65
    v_add_f32 v66, 1.0, v66
    v_add_f32 v67, 1.0, v67
    v_add_f32 v68, 1.0, v68
    v_add_f32 v69, 1.0, v69
    v_add_f32 v70, 1.0, v70
    v_add_f32 v71, 1.0, v71
    v_rcp_f32 v64, v64
    v_rcp_f32 v65, v65
    v_rcp_f32 v66, v66
    v_rcp_f32 v67, v67
    v_rcp_f32 v68, v68
    v_rcp_f32 v69, v69
    v_rcp_f32 v70, v70
    v_rcp_f32 v71, v71
    s_waitcnt lgkmcnt(3)
    s_mov_b32 s36, 49152
    buffer_store_dwordx4 a[0:3], v7, s[16:19], s36 offen sc1
    s_waitcnt lgkmcnt(2)
    s_mov_b32 s36, 50176
    buffer_store_dwordx4 a[4:7], v7, s[16:19], s36 offen sc1
    v_cvt_pk_bf16_f32 v80, v64, v65
    v_cvt_pk_bf16_f32 v81, v66, v67
    v_cvt_pk_bf16_f32 v82, v68, v69
    v_cvt_pk_bf16_f32 v83, v70, v71
    ds_write_b128 v2, v[80:83] offset:16384
    v_add_f32 v72, v40, v104
    v_add_f32 v73, v41, v105
    v_add_f32 v74, v42, v106
    v_add_f32 v75, v43, v107
    v_add_f32 v76, v44, v108
    v_add_f32 v77, v45, v109
    v_add_f32 v78, v46, v110
    v_add_f32 v79, v47, v111
    v_exp_f32 v72, v72
    v_exp_f32 v73, v73
    v_exp_f32 v74, v74
    v_exp_f32 v75, v75
    v_exp_f32 v76, v76
    v_exp_f32 v77, v77
    v_exp_f32 v78, v78
    v_exp_f32 v79, v79
    v_add_f32 v72, 1.0, v72
    v_add_f32 v73, 1.0, v73
    v_add_f32 v74, 1.0, v74
    v_add_f32 v75, 1.0, v75
    v_add_f32 v76, 1.0, v76
    v_add_f32 v77, 1.0, v77
    v_add_f32 v78, 1.0, v78
    v_add_f32 v79, 1.0, v79
    v_rcp_f32 v72, v72
    v_rcp_f32 v73, v73
    v_rcp_f32 v74, v74
    v_rcp_f32 v75, v75
    v_rcp_f32 v76, v76
    v_rcp_f32 v77, v77
    v_rcp_f32 v78, v78
    v_rcp_f32 v79, v79
    s_waitcnt lgkmcnt(2)
    s_mov_b32 s36, 51200
    buffer_store_dwordx4 a[8:11], v7, s[16:19], s36 offen sc1
    s_waitcnt lgkmcnt(1)
    s_mov_b32 s36, 52224
    buffer_store_dwordx4 a[12:15], v7, s[16:19], s36 offen sc1
    v_cvt_pk_bf16_f32 v84, v72, v73
    v_cvt_pk_bf16_f32 v85, v74, v75
    v_cvt_pk_bf16_f32 v86, v76, v77
    v_cvt_pk_bf16_f32 v87, v78, v79
    ds_write_b128 v2, v[84:87] offset:17408
    v_add_f32 v64, v48, v112
    v_add_f32 v65, v49, v113
    v_add_f32 v66, v50, v114
    v_add_f32 v67, v51, v115
    v_add_f32 v68, v52, v116
    v_add_f32 v69, v53, v117
    v_add_f32 v70, v54, v118
    v_add_f32 v71, v55, v119
    v_exp_f32 v64, v64
    v_exp_f32 v65, v65
    v_exp_f32 v66, v66
    v_exp_f32 v67, v67
    v_exp_f32 v68, v68
    v_exp_f32 v69, v69
    v_exp_f32 v70, v70
    v_exp_f32 v71, v71
    v_add_f32 v64, 1.0, v64
    v_add_f32 v65, 1.0, v65
    v_add_f32 v66, 1.0, v66
    v_add_f32 v67, 1.0, v67
    v_add_f32 v68, 1.0, v68
    v_add_f32 v69, 1.0, v69
    v_add_f32 v70, 1.0, v70
    v_add_f32 v71, 1.0, v71
    v_rcp_f32 v64, v64
    v_rcp_f32 v65, v65
    v_rcp_f32 v66, v66
    v_rcp_f32 v67, v67
    v_rcp_f32 v68, v68
    v_rcp_f32 v69, v69
    v_rcp_f32 v70, v70
    v_rcp_f32 v71, v71
    s_nop 0
    v_cvt_pk_bf16_f32 v80, v64, v65
    v_cvt_pk_bf16_f32 v81, v66, v67
    v_cvt_pk_bf16_f32 v82, v68, v69
    v_cvt_pk_bf16_f32 v83, v70, v71
    ds_write_b128 v2, v[80:83] offset:18432
    v_add_f32 v72, v56, v120
    v_add_f32 v73, v57, v121
    v_add_f32 v74, v58, v122
    v_add_f32 v75, v59, v123
    v_add_f32 v76, v60, v124
    v_add_f32 v77, v61, v125
    v_add_f32 v78, v62, v126
    v_add_f32 v79, v63, v127
    v_exp_f32 v72, v72
    v_exp_f32 v73, v73
    v_exp_f32 v74, v74
    v_exp_f32 v75, v75
    v_exp_f32 v76, v76
    v_exp_f32 v77, v77
    v_exp_f32 v78, v78
    v_exp_f32 v79, v79
    v_add_f32 v72, 1.0, v72
    v_add_f32 v73, 1.0, v73
    v_add_f32 v74, 1.0, v74
    v_add_f32 v75, 1.0, v75
    v_add_f32 v76, 1.0, v76
    v_add_f32 v77, 1.0, v77
    v_add_f32 v78, 1.0, v78
    v_add_f32 v79, 1.0, v79
    v_rcp_f32 v72, v72
    v_rcp_f32 v73, v73
    v_rcp_f32 v74, v74
    v_rcp_f32 v75, v75
    v_rcp_f32 v76, v76
    v_rcp_f32 v77, v77
    v_rcp_f32 v78, v78
    v_rcp_f32 v79, v79
    s_nop 0
    v_cvt_pk_bf16_f32 v84, v72, v73
    v_cvt_pk_bf16_f32 v85, v74, v75
    v_cvt_pk_bf16_f32 v86, v76, v77
    v_cvt_pk_bf16_f32 v87, v78, v79
    ds_write_b128 v2, v[84:87] offset:19456
    s_waitcnt lgkmcnt(0)
    s_barrier
    ds_read_b128 a[0:3], v6 offset:0
    ds_read_b128 a[4:7], v6 offset:1056
    ds_read_b128 a[8:11], v6 offset:2112
    ds_read_b128 a[12:15], v6 offset:3168
    s_waitcnt lgkmcnt(3)
    s_mov_b32 s36, 65536
    buffer_store_dwordx4 a[0:3], v7, s[16:19], s36 offen sc1
    s_waitcnt lgkmcnt(2)
    s_mov_b32 s36, 66560
    buffer_store_dwordx4 a[4:7], v7, s[16:19], s36 offen sc1
    s_waitcnt lgkmcnt(1)
    s_mov_b32 s36, 67584
    buffer_store_dwordx4 a[8:11], v7, s[16:19], s36 offen sc1
    s_waitcnt lgkmcnt(0)
    s_mov_b32 s36, 68608
    buffer_store_dwordx4 a[12:15], v7, s[16:19], s36 offen sc1
    s_barrier
    ds_read_b128 a[0:3], v6 offset:16896
    ds_read_b128 a[4:7], v6 offset:17952
    ds_read_b128 a[8:11], v6 offset:19008
    ds_read_b128 a[12:15], v6 offset:20064
    s_waitcnt lgkmcnt(3)
    s_mov_b32 s36, 81920
    buffer_store_dwordx4 a[0:3], v7, s[16:19], s36 offen sc1
    s_waitcnt lgkmcnt(2)
    s_mov_b32 s36, 82944
    buffer_store_dwordx4 a[4:7], v7, s[16:19], s36 offen sc1
    s_waitcnt lgkmcnt(1)
    s_mov_b32 s36, 83968
    buffer_store_dwordx4 a[8:11], v7, s[16:19], s36 offen sc1
    s_waitcnt lgkmcnt(0)
    s_mov_b32 s36, 84992
    buffer_store_dwordx4 a[12:15], v7, s[16:19], s36 offen sc1
    s_barrier
    ds_read_b128 a[0:3], v6 offset:0
    ds_read_b128 a[4:7], v6 offset:1056
    ds_read_b128 a[8:11], v6 offset:2112
    ds_read_b128 a[12:15], v6 offset:3168
    s_waitcnt lgkmcnt(3)
    s_mov_b32 s36, 98304
    buffer_store_dwordx4 a[0:3], v7, s[16:19], s36 offen sc1
    s_waitcnt lgkmcnt(2)
    s_mov_b32 s36, 99328
    buffer_store_dwordx4 a[4:7], v7, s[16:19], s36 offen sc1
    s_waitcnt lgkmcnt(1)
    s_mov_b32 s36, 100352
    buffer_store_dwordx4 a[8:11], v7, s[16:19], s36 offen sc1
    s_waitcnt lgkmcnt(0)
    s_mov_b32 s36, 101376
    buffer_store_dwordx4 a[12:15], v7, s[16:19], s36 offen sc1
    s_barrier
    ds_read_b128 a[0:3], v6 offset:16896
    ds_read_b128 a[4:7], v6 offset:17952
    ds_read_b128 a[8:11], v6 offset:19008
    ds_read_b128 a[12:15], v6 offset:20064
    s_waitcnt lgkmcnt(3)
    s_mov_b32 s36, 114688
    buffer_store_dwordx4 a[0:3], v7, s[16:19], s36 offen sc1
    s_waitcnt lgkmcnt(2)
    s_mov_b32 s36, 115712
    buffer_store_dwordx4 a[4:7], v7, s[16:19], s36 offen sc1
    s_waitcnt lgkmcnt(1)
    s_mov_b32 s36, 116736
    buffer_store_dwordx4 a[8:11], v7, s[16:19], s36 offen sc1
    s_waitcnt lgkmcnt(0)
    s_mov_b32 s36, 117760
    buffer_store_dwordx4 a[12:15], v7, s[16:19], s36 offen sc1
    s_endpgm
L_joint_kernel_done:
    s_endpgm
.section .rodata,"a"
.p2align 6
.amdhsa_kernel prep_kernel
  .amdhsa_next_free_vgpr 128
  .amdhsa_next_free_sgpr 102
  .amdhsa_accum_offset 128
  .amdhsa_group_segment_fixed_size 0
  .amdhsa_kernarg_size 80
  .amdhsa_user_sgpr_count 2
  .amdhsa_user_sgpr_kernarg_segment_ptr 1
  .amdhsa_system_sgpr_workgroup_id_x 1
.end_amdhsa_kernel
.p2align 6
.amdhsa_kernel gemm1_kernel
  .amdhsa_next_free_vgpr 232
  .amdhsa_next_free_sgpr 102
  .amdhsa_accum_offset 232
  .amdhsa_group_segment_fixed_size 0
  .amdhsa_kernarg_size 80
  .amdhsa_user_sgpr_count 2
  .amdhsa_user_sgpr_kernarg_segment_ptr 1
  .amdhsa_system_sgpr_workgroup_id_x 1
.end_amdhsa_kernel
.p2align 6
.amdhsa_kernel mid_kernel
  .amdhsa_next_free_vgpr 128
  .amdhsa_next_free_sgpr 102
  .amdhsa_accum_offset 128
  .amdhsa_group_segment_fixed_size 0
  .amdhsa_kernarg_size 80
  .amdhsa_user_sgpr_count 2
  .amdhsa_user_sgpr_kernarg_segment_ptr 1
  .amdhsa_system_sgpr_workgroup_id_x 1
.end_amdhsa_kernel
.p2align 6
.amdhsa_kernel gemm2_kernel
  .amdhsa_next_free_vgpr 152
  .amdhsa_next_free_sgpr 102
  .amdhsa_accum_offset 152
  .amdhsa_group_segment_fixed_size 0
  .amdhsa_kernarg_size 80
  .amdhsa_user_sgpr_count 2
  .amdhsa_user_sgpr_kernarg_segment_ptr 1
  .amdhsa_system_sgpr_workgroup_id_x 1
.end_amdhsa_kernel
.p2align 6
.amdhsa_kernel joint_kernel
  .amdhsa_next_free_vgpr 256
  .amdhsa_next_free_sgpr 102
  .amdhsa_accum_offset 128
  .amdhsa_group_segment_fixed_size 0
  .amdhsa_kernarg_size 80
  .amdhsa_user_sgpr_count 2
  .amdhsa_user_sgpr_kernarg_segment_ptr 1
  .amdhsa_system_sgpr_workgroup_id_x 1
.end_amdhsa_kernel
```

```asm
; @launch kernel=prep_kernel grid=(941,1,1) block=(256,1,1) lds=40960
; @launch kernel=gemm1_kernel grid=(256,1,1) block=(512,1,1) lds=143360
; @launch kernel=mid_kernel grid=(704,1,1) block=(256,1,1) lds=53248
; @launch kernel=gemm2_kernel grid=(256,1,1) block=(512,1,1) lds=143360
; @launch kernel=joint_kernel grid=(256,1,1) block=(512,1,1) lds=149504
.amdgcn_target "amdgcn-amd-amdhsa--gfx950"
.text
.globl prep_kernel
.p2align 8
.type prep_kernel,@function
prep_kernel:
    s_cmp_ge_u32 s2, 941
    s_cbranch_scc1 L_prep_kernel_done
    v_readfirstlane_b32 s20, v0
    s_lshr_b32 s20, s20, 6
    s_cmp_lt_u32 s2, 13
    s_cbranch_scc1 L_prep_kernel_slab
    s_cmp_lt_u32 s2, 269
    s_cbranch_scc1 L_prep_kernel_g
    s_load_dwordx2 s[4:5], s[0:1], 0
    s_load_dwordx2 s[6:7], s[0:1], 72
    s_sub_u32 s24, s2, 269
    s_and_b32 s25, s24, 7
    s_mul_i32 s25, s25, 84
    s_lshr_b32 s24, s24, 3
    s_add_u32 s24, s24, s25
    s_cmp_ge_u32 s24, 668
    s_cbranch_scc1 L_prep_kernel_done
    s_mul_hi_u32 s25, s24, 25718368
    s_mul_i32 s26, s25, 167
    s_sub_u32 s26, s24, s26
    s_and_b32 s27, s25, 1
    s_lshr_b32 s25, s25, 1
    v_and_b32 v1, 63, v0
    v_lshrrev_b32 v2, 3, v1
    s_mul_i32 s28, s26, 96
    s_add_u32 s28, s28, s27
    s_sub_u32 s28, s28, 15
    v_lshlrev_b32 v3, 1, v2
    v_add_u32 v3, s28, v3
    v_lshlrev_b32 v3, 9, v3
    s_lshl_b32 s29, s20, 7
    v_add_u32 v3, s29, v3
    v_bfe_u32 v4, v2, 1, 1
    v_lshlrev_b32 v4, 1, v4
    v_and_b32 v5, 7, v1
    v_xor_b32 v4, v4, v5
    v_lshl_add_u32 v3, v4, 4, v3
    v_xor_b32 v4, 64, v3
    s_waitcnt lgkmcnt(0)
    s_mul_i32 s30, s25, 8192000
    s_add_u32 s8, s4, s30
    s_addc_u32 s9, s5, 0
    s_mov_b32 s10, 8192000
    s_mov_b32 s11, 0x00020000
    s_lshl_b32 s31, s20, 13
    s_add_u32 m0, s31, 0
    v_add_u32 v5, 0, v3
    buffer_load_dwordx4 v5, s[8:11], 0 offen nt lds
    s_add_u32 m0, s31, 1024
    v_add_u32 v5, 8192, v4
    buffer_load_dwordx4 v5, s[8:11], 0 offen nt lds
    s_add_u32 m0, s31, 2048
    v_add_u32 v5, 16384, v3
    buffer_load_dwordx4 v5, s[8:11], 0 offen nt lds
    s_add_u32 m0, s31, 3072
    v_add_u32 v5, 24576, v4
    buffer_load_dwordx4 v5, s[8:11], 0 offen nt lds
    s_add_u32 m0, s31, 4096
    v_add_u32 v5, 32768, v3
    buffer_load_dwordx4 v5, s[8:11], 0 offen nt lds
    s_add_u32 m0, s31, 5120
    v_add_u32 v5, 40960, v4
    buffer_load_dwordx4 v5, s[8:11], 0 offen nt lds
    s_add_u32 m0, s31, 6144
    v_add_u32 v5, 49152, v3
    buffer_load_dwordx4 v5, s[8:11], 0 offen nt lds
    s_add_u32 m0, s31, 7168
    v_add_u32 v5, 57344, v4
    buffer_load_dwordx4 v5, s[8:11], 0 offen nt lds
    s_add_u32 s12, s6, 0
    s_addc_u32 s13, s7, 0
    s_mov_b32 s14, 21889024
    s_mov_b32 s15, 0x00020000
    v_mov_b32 v8, v1
    s_lshl_b32 s32, s20, 4
    v_lshlrev_b32 v6, 4, v1
    s_lshl_b32 s33, s20, 11
    v_add_u32 v7, s33, v6
    v_and_b32 v9, 15, v8
    v_lshrrev_b32 v10, 4, v8
    v_or_b32 v11, 1, v9
    v_add_u32 v11, s32, v11
    v_cvt_f32_u32 v11, v11
    v_mul_f32 v11, 0x3c000000, v11
    v_lshlrev_b32 v10, 3, v10
    v_add_u32 v10, 0, v10
    v_cvt_f32_u32 v10, v10
    v_and_b32 v9, 1, v9
    v_cvt_f32_u32 v9, v9
    v_mul_f32 v9, 0x3e800000, v9
    v_fma_f32 v12, v11, v10, v9
    v_fract_f32 v13, v12
    v_add_f32 v12, v12, v11
    v_fract_f32 v14, v12
    v_add_f32 v12, v12, v11
    v_fract_f32 v15, v12
    v_add_f32 v12, v12, v11
    v_fract_f32 v16, v12
    v_add_f32 v12, v12, v11
    v_fract_f32 v17, v12
    v_add_f32 v12, v12, v11
    v_fract_f32 v18, v12
    v_add_f32 v12, v12, v11
    v_fract_f32 v19, v12
    v_add_f32 v12, v12, v11
    v_fract_f32 v20, v12
    v_cos_f32 v13, v13
    v_cos_f32 v14, v14
    v_cos_f32 v15, v15
    v_cos_f32 v16, v16
    v_cos_f32 v17, v17
    v_cos_f32 v18, v18
    v_cos_f32 v19, v19
    v_cos_f32 v20, v20
    s_nop 0
    v_cvt_pk_bf16_f32 v24, v13, v14
    v_cvt_pk_bf16_f32 v25, v15, v16
    v_cvt_pk_bf16_f32 v26, v17, v18
    v_cvt_pk_bf16_f32 v27, v19, v20
    ds_write_b128 v7, v[24:27] offset:32768
    v_and_b32 v9, 15, v8
    v_lshrrev_b32 v10, 4, v8
    v_or_b32 v11, 1, v9
    v_add_u32 v11, s32, v11
    v_cvt_f32_u32 v11, v11
    v_mul_f32 v11, 0x3c000000, v11
    v_lshlrev_b32 v10, 3, v10
    v_add_u32 v10, 32, v10
    v_cvt_f32_u32 v10, v10
    v_and_b32 v9, 1, v9
    v_cvt_f32_u32 v9, v9
    v_mul_f32 v9, 0x3e800000, v9
    v_fma_f32 v12, v11, v10, v9
    v_fract_f32 v13, v12
    v_add_f32 v12, v12, v11
    v_fract_f32 v14, v12
    v_add_f32 v12, v12, v11
    v_fract_f32 v15, v12
    v_add_f32 v12, v12, v11
    v_fract_f32 v16, v12
    v_add_f32 v12, v12, v11
    v_fract_f32 v17, v12
    v_add_f32 v12, v12, v11
    v_fract_f32 v18, v12
    v_add_f32 v12, v12, v11
    v_fract_f32 v19, v12
    v_add_f32 v12, v12, v11
    v_fract_f32 v20, v12
    v_cos_f32 v13, v13
    v_cos_f32 v14, v14
    v_cos_f32 v15, v15
    v_cos_f32 v16, v16
    v_cos_f32 v17, v17
    v_cos_f32 v18, v18
    v_cos_f32 v19, v19
    v_cos_f32 v20, v20
    s_nop 0
    v_cvt_pk_bf16_f32 v28, v13, v14
    v_cvt_pk_bf16_f32 v29, v15, v16
    v_cvt_pk_bf16_f32 v30, v17, v18
    v_cvt_pk_bf16_f32 v31, v19, v20
    ds_write_b128 v7, v[28:31] offset:33792
    v_bfe_u32 v8, v1, 2, 2
    v_lshrrev_b32 v9, 4, v1
    v_lshl_add_u32 v10, v9, 3, v8
    v_lshlrev_b32 v10, 7, v10
    v_lshrrev_b32 v8, 1, v8
    v_and_b32 v11, 1, v9
    v_lshl_add_u32 v8, v11, 1, v8
    v_lshlrev_b32 v8, 1, v8
    v_bfe_u32 v11, v1, 1, 1
    v_xor_b32 v8, v8, v11
    v_lshl_add_u32 v10, v8, 4, v10
    v_and_b32 v11, 1, v1
    v_lshl_add_u32 v10, v11, 3, v10
    v_add_u32 v10, s31, v10
    v_xor_b32 v12, 0, v10
    v_xor_b32 v13, 32, v10
    v_xor_b32 v14, 64, v10
    v_xor_b32 v15, 96, v10
    v_bfe_u32 v8, v1, 1, 3
    s_mov_b32 s33, 684032
    v_mul_lo_u32 v8, v8, s33
    v_and_b32 v11, 1, v1
    v_lshl_add_u32 v8, v11, 6, v8
    v_lshl_add_u32 v16, v9, 4, v8
    s_mul_i32 s34, s25, 167
    s_add_u32 s34, s34, s26
    s_lshl_b32 s34, s34, 11
    s_lshl_b32 s35, s27, 3
    s_lshl_b32 s36, s20, 1
    s_add_u32 s35, s35, s36
    s_lshl_b32 s35, s35, 7
    s_add_u32 s34, s34, s35
    s_waitcnt lgkmcnt(0)
    s_barrier
    ds_read_b128 v[24:27], v6 offset:32768
    ds_read_b128 v[28:31], v6 offset:33792
    ds_read_b128 v[32:35], v6 offset:34816
    ds_read_b128 v[36:39], v6 offset:35840
    ds_read_b128 v[40:43], v6 offset:36864
    ds_read_b128 v[44:47], v6 offset:37888
    ds_read_b128 v[48:51], v6 offset:38912
    ds_read_b128 v[52:55], v6 offset:39936
    s_waitcnt vmcnt(0)
    ds_read_b64_tr_b16 v[56:57], v12 offset:0
    ds_read_b64_tr_b16 v[58:59], v12 offset:512
    ds_read_b64_tr_b16 v[60:61], v12 offset:4096
    ds_read_b64_tr_b16 v[62:63], v12 offset:4608
    ds_read_b64_tr_b16 v[64:65], v13 offset:0
    ds_read_b64_tr_b16 v[66:67], v13 offset:512
    ds_read_b64_tr_b16 v[68:69], v13 offset:4096
    ds_read_b64_tr_b16 v[70:71], v13 offset:4608
    s_waitcnt lgkmcnt(0)
    v_mfma_f32_16x16x32_bf16 v[72:75], v[56:59], v[24:27], 0
    v_mfma_f32_16x16x32_bf16 v[76:79], v[56:59], v[32:35], 0
    v_mfma_f32_16x16x32_bf16 v[80:83], v[56:59], v[40:43], 0
    v_mfma_f32_16x16x32_bf16 v[84:87], v[56:59], v[48:51], 0
    v_mfma_f32_16x16x32_bf16 v[88:91], v[64:67], v[24:27], 0
    v_mfma_f32_16x16x32_bf16 v[92:95], v[64:67], v[32:35], 0
    v_mfma_f32_16x16x32_bf16 v[96:99], v[64:67], v[40:43], 0
    v_mfma_f32_16x16x32_bf16 v[100:103], v[64:67], v[48:51], 0
    v_mfma_f32_16x16x32_bf16 v[72:75], v[60:63], v[28:31], v[72:75]
    v_mfma_f32_16x16x32_bf16 v[76:79], v[60:63], v[36:39], v[76:79]
    v_mfma_f32_16x16x32_bf16 v[80:83], v[60:63], v[44:47], v[80:83]
    v_mfma_f32_16x16x32_bf16 v[84:87], v[60:63], v[52:55], v[84:87]
    v_mfma_f32_16x16x32_bf16 v[88:91], v[68:71], v[28:31], v[88:91]
    v_mfma_f32_16x16x32_bf16 v[92:95], v[68:71], v[36:39], v[92:95]
    v_mfma_f32_16x16x32_bf16 v[96:99], v[68:71], v[44:47], v[96:99]
    v_mfma_f32_16x16x32_bf16 v[100:103], v[68:71], v[52:55], v[100:103]
    s_nop 7
    v_cvt_pk_bf16_f32 v104, v72, v73
    v_cvt_pk_bf16_f32 v105, v74, v75
    v_cvt_pk_bf16_f32 v106, v88, v89
    v_cvt_pk_bf16_f32 v107, v90, v91
    s_add_u32 s35, s34, 0
    buffer_store_dwordx4 v[104:107], v16, s[12:15], s35 offen sc1
    s_nop 1
    v_cvt_pk_bf16_f32 v108, v76, v77
    v_cvt_pk_bf16_f32 v109, v78, v79
    v_cvt_pk_bf16_f32 v110, v92, v93
    v_cvt_pk_bf16_f32 v111, v94, v95
    s_add_u32 s35, s34, 5472256
    buffer_store_dwordx4 v[108:111], v16, s[12:15], s35 offen sc1
    s_nop 1
    v_cvt_pk_bf16_f32 v104, v80, v81
    v_cvt_pk_bf16_f32 v105, v82, v83
    v_cvt_pk_bf16_f32 v106, v96, v97
    v_cvt_pk_bf16_f32 v107, v98, v99
    s_add_u32 s35, s34, 10944512
    buffer_store_dwordx4 v[104:107], v16, s[12:15], s35 offen sc1
    s_nop 1
    v_cvt_pk_bf16_f32 v108, v84, v85
    v_cvt_pk_bf16_f32 v109, v86, v87
    v_cvt_pk_bf16_f32 v110, v100, v101
    v_cvt_pk_bf16_f32 v111, v102, v103
    s_add_u32 s35, s34, 16416768
    buffer_store_dwordx4 v[108:111], v16, s[12:15], s35 offen sc1
    s_nop 1
    ds_read_b64_tr_b16 v[56:57], v14 offset:0
    ds_read_b64_tr_b16 v[58:59], v14 offset:512
    ds_read_b64_tr_b16 v[60:61], v14 offset:4096
    ds_read_b64_tr_b16 v[62:63], v14 offset:4608
    ds_read_b64_tr_b16 v[64:65], v15 offset:0
    ds_read_b64_tr_b16 v[66:67], v15 offset:512
    ds_read_b64_tr_b16 v[68:69], v15 offset:4096
    ds_read_b64_tr_b16 v[70:71], v15 offset:4608
    s_waitcnt lgkmcnt(0)
    v_mfma_f32_16x16x32_bf16 v[72:75], v[56:59], v[24:27], 0
    v_mfma_f32_16x16x32_bf16 v[76:79], v[56:59], v[32:35], 0
    v_mfma_f32_16x16x32_bf16 v[80:83], v[56:59], v[40:43], 0
    v_mfma_f32_16x16x32_bf16 v[84:87], v[56:59], v[48:51], 0
    v_mfma_f32_16x16x32_bf16 v[88:91], v[64:67], v[24:27], 0
    v_mfma_f32_16x16x32_bf16 v[92:95], v[64:67], v[32:35], 0
    v_mfma_f32_16x16x32_bf16 v[96:99], v[64:67], v[40:43], 0
    v_mfma_f32_16x16x32_bf16 v[100:103], v[64:67], v[48:51], 0
    v_mfma_f32_16x16x32_bf16 v[72:75], v[60:63], v[28:31], v[72:75]
    v_mfma_f32_16x16x32_bf16 v[76:79], v[60:63], v[36:39], v[76:79]
    v_mfma_f32_16x16x32_bf16 v[80:83], v[60:63], v[44:47], v[80:83]
    v_mfma_f32_16x16x32_bf16 v[84:87], v[60:63], v[52:55], v[84:87]
    v_mfma_f32_16x16x32_bf16 v[88:91], v[68:71], v[28:31], v[88:91]
    v_mfma_f32_16x16x32_bf16 v[92:95], v[68:71], v[36:39], v[92:95]
    v_mfma_f32_16x16x32_bf16 v[96:99], v[68:71], v[44:47], v[96:99]
    v_mfma_f32_16x16x32_bf16 v[100:103], v[68:71], v[52:55], v[100:103]
    s_nop 7
    v_cvt_pk_bf16_f32 v104, v72, v73
    v_cvt_pk_bf16_f32 v105, v74, v75
    v_cvt_pk_bf16_f32 v106, v88, v89
    v_cvt_pk_bf16_f32 v107, v90, v91
    s_add_u32 s35, s34, 128
    buffer_store_dwordx4 v[104:107], v16, s[12:15], s35 offen sc1
    s_nop 1
    v_cvt_pk_bf16_f32 v108, v76, v77
    v_cvt_pk_bf16_f32 v109, v78, v79
    v_cvt_pk_bf16_f32 v110, v92, v93
    v_cvt_pk_bf16_f32 v111, v94, v95
    s_add_u32 s35, s34, 5472384
    buffer_store_dwordx4 v[108:111], v16, s[12:15], s35 offen sc1
    s_nop 1
    v_cvt_pk_bf16_f32 v104, v80, v81
    v_cvt_pk_bf16_f32 v105, v82, v83
    v_cvt_pk_bf16_f32 v106, v96, v97
    v_cvt_pk_bf16_f32 v107, v98, v99
    s_add_u32 s35, s34, 10944640
    buffer_store_dwordx4 v[104:107], v16, s[12:15], s35 offen sc1
    s_nop 1
    v_cvt_pk_bf16_f32 v108, v84, v85
    v_cvt_pk_bf16_f32 v109, v86, v87
    v_cvt_pk_bf16_f32 v110, v100, v101
    v_cvt_pk_bf16_f32 v111, v102, v103
    s_add_u32 s35, s34, 16416896
    buffer_store_dwordx4 v[108:111], v16, s[12:15], s35 offen sc1
    s_nop 1
    s_endpgm
L_prep_kernel_g:
    s_sub_u32 s3, s2, 13
    s_load_dwordx2 s[4:5], s[0:1], 8
    s_load_dwordx2 s[6:7], s[0:1], 72
    s_lshr_b32 s24, s3, 4
    s_bfe_u32 s25, s3, 0x20002
    s_and_b32 s26, s3, 3
    s_lshr_b32 s27, s24, 3
    s_and_b32 s28, s24, 7
    v_and_b32 v1, 63, v0
    v_lshrrev_b32 v2, 3, v1
    v_lshrrev_b32 v3, 2, v2
    v_lshlrev_b32 v3, 4, v3
    v_and_b32 v4, 3, v2
    v_add_u32 v3, v3, v4
    s_lshl_b32 s29, s25, 2
    s_lshl_b32 s30, s28, 5
    s_add_u32 s29, s29, s30
    v_add_u32 v3, s29, v3
    v_lshlrev_b32 v3, 9, v3
    v_and_b32 v4, 7, v1
    s_lshr_b32 s30, s20, 1
    s_lshl_b32 s30, s30, 2
    v_xor_b32 v4, s30, v4
    v_lshl_add_u32 v3, v4, 4, v3
    s_lshl_b32 s30, s26, 7
    v_add_u32 v3, s30, v3
    v_xor_b32 v4, 32, v3
    s_waitcnt lgkmcnt(0)
    s_mov_b32 s8, s4
    s_mov_b32 s9, s5
    s_mov_b32 s10, 4063232
    s_mov_b32 s11, 0x00020000
    s_add_u32 s12, s6, 21954560
    s_addc_u32 s13, s7, 0
    s_mov_b32 s14, 16916480
    s_mov_b32 s15, 0x00020000
    s_lshl_b32 s30, s20, 3
    s_add_u32 s30, s30, s27
    s_lshl_b32 s30, s30, 17
    s_mul_i32 s31, s20, 4608
    s_add_u32 m0, s31, 0
    s_add_u32 s32, s30, 0
    buffer_load_dwordx4 v3, s[8:11], s32 offen nt lds
    s_add_u32 m0, s31, 1152
    s_add_u32 s32, s30, 262144
    buffer_load_dwordx4 v3, s[8:11], s32 offen nt lds
    s_add_u32 m0, s31, 2304
    s_add_u32 s32, s30, 524288
    buffer_load_dwordx4 v4, s[8:11], s32 offen nt lds
    s_add_u32 m0, s31, 3456
    s_add_u32 s32, s30, 786432
    buffer_load_dwordx4 v4, s[8:11], s32 offen nt lds
    v_and_b32 v8, 15, v1
    v_or_b32 v9, 1, v8
    s_lshl_b32 s33, s20, 4
    v_add_u32 v9, s33, v9
    v_cvt_f32_u32 v9, v9
    v_mul_f32 v9, 0x3c000000, v9
    v_bfe_u32 v10, v1, 4, 1
    v_lshlrev_b32 v10, 3, v10
    v_cvt_f32_u32 v10, v10
    v_and_b32 v8, 1, v8
    v_cvt_f32_u32 v8, v8
    v_mul_f32 v8, 0x3f400000, v8
    v_fma_f32 v11, v9, v10, v8
    v_fract_f32 v12, v11
    v_add_f32 v11, v11, v9
    v_fract_f32 v13, v11
    v_add_f32 v11, v11, v9
    v_fract_f32 v14, v11
    v_add_f32 v11, v11, v9
    v_fract_f32 v15, v11
    v_add_f32 v11, v11, v9
    v_fract_f32 v16, v11
    v_add_f32 v11, v11, v9
    v_fract_f32 v17, v11
    v_add_f32 v11, v11, v9
    v_fract_f32 v18, v11
    v_add_f32 v11, v11, v9
    v_fract_f32 v19, v11
    v_cos_f32 v12, v12
    v_cos_f32 v13, v13
    v_cos_f32 v14, v14
    v_cos_f32 v15, v15
    v_cos_f32 v16, v16
    v_cos_f32 v17, v17
    v_cos_f32 v18, v18
    v_cos_f32 v19, v19
    s_nop 0
    v_mul_f32 v12, 0x3d000000, v12
    v_mul_f32 v13, 0x3d000000, v13
    v_mul_f32 v14, 0x3d000000, v14
    v_mul_f32 v15, 0x3d000000, v15
    v_mul_f32 v16, 0x3d000000, v16
    v_mul_f32 v17, 0x3d000000, v17
    v_mul_f32 v18, 0x3d000000, v18
    v_mul_f32 v19, 0x3d000000, v19
    v_cvt_pk_bf16_f32 v20, v12, v13
    v_cvt_pk_bf16_f32 v21, v14, v15
    v_cvt_pk_bf16_f32 v22, v16, v17
    v_cvt_pk_bf16_f32 v23, v18, v19
    v_lshlrev_b32 v28, 16, v20
    v_and_b32 v29, 0xffff0000, v20
    v_sub_f32 v28, v12, v28
    v_sub_f32 v29, v13, v29
    v_cvt_pk_bf16_f32 v24, v28, v29
    v_lshlrev_b32 v28, 16, v21
    v_and_b32 v29, 0xffff0000, v21
    v_sub_f32 v28, v14, v28
    v_sub_f32 v29, v15, v29
    v_cvt_pk_bf16_f32 v25, v28, v29
    v_lshlrev_b32 v28, 16, v22
    v_and_b32 v29, 0xffff0000, v22
    v_sub_f32 v28, v16, v28
    v_sub_f32 v29, v17, v29
    v_cvt_pk_bf16_f32 v26, v28, v29
    v_lshlrev_b32 v28, 16, v23
    v_and_b32 v29, 0xffff0000, v23
    v_sub_f32 v28, v18, v28
    v_sub_f32 v29, v19, v29
    v_cvt_pk_bf16_f32 v27, v28, v29
    v_cmp_gt_u32 vcc, 32, v1
    s_nop 1
    v_cndmask_b32 v20, v24, v20, vcc
    v_cndmask_b32 v21, v25, v21, vcc
    v_cndmask_b32 v22, v26, v22, vcc
    v_cndmask_b32 v23, v27, v23, vcc
    v_lshlrev_b32 v28, 4, v1
    s_lshl_b32 s33, s20, 10
    v_add_u32 v29, s33, v28
    ds_write_b128 v29, v[20:23] offset:18432
    v_bfe_u32 v30, v1, 2, 2
    v_bfe_u32 v31, v1, 4, 1
    v_lshl_add_u32 v32, v31, 3, v30
    v_mul_u32_u24 v32, 1152, v32
    v_lshrrev_b32 v30, 1, v30
    v_lshl_add_u32 v30, v31, 1, v30
    v_lshlrev_b32 v30, 1, v30
    v_bfe_u32 v31, v1, 1, 1
    s_lshl_b32 s33, s20, 1
    v_add_u32 v31, s33, v31
    v_xor_b32 v30, v30, v31
    v_lshl_add_u32 v32, v30, 4, v32
    v_and_b32 v30, 1, v1
    v_lshl_add_u32 v32, v30, 3, v32
    v_lshrrev_b32 v30, 4, v1
    s_mov_b32 s33, 1057280
    v_mul_lo_u32 v30, v30, s33
    v_and_b32 v31, 15, v1
    v_lshl_add_u32 v33, v31, 4, v30
    s_lshl_b32 s34, s24, 15
    s_lshl_b32 s35, s26, 2
    s_add_u32 s35, s35, s20
    s_lshl_b32 s35, s35, 11
    s_add_u32 s34, s34, s35
    s_lshl_b32 s35, s25, 8
    s_add_u32 s34, s34, s35
    s_waitcnt vmcnt(0) lgkmcnt(0)
    s_barrier
    ds_read_b128 v[36:39], v28 offset:18432
    ds_read_b128 v[40:43], v28 offset:19456
    ds_read_b128 v[44:47], v28 offset:20480
    ds_read_b128 v[48:51], v28 offset:21504
    ds_read_b64_tr_b16 v[52:53], v32 offset:0
    ds_read_b64_tr_b16 v[54:55], v32 offset:4608
    ds_read_b64_tr_b16 v[56:57], v32 offset:128
    ds_read_b64_tr_b16 v[58:59], v32 offset:4736
    ds_read_b64_tr_b16 v[60:61], v32 offset:256
    ds_read_b64_tr_b16 v[62:63], v32 offset:4864
    ds_read_b64_tr_b16 v[64:65], v32 offset:384
    ds_read_b64_tr_b16 v[66:67], v32 offset:4992
    ds_read_b64_tr_b16 v[68:69], v32 offset:512
    ds_read_b64_tr_b16 v[70:71], v32 offset:5120
    s_waitcnt lgkmcnt(8)
    ds_read_b64_tr_b16 v[72:73], v32 offset:640
    ds_read_b64_tr_b16 v[74:75], v32 offset:5248
    ds_read_b64_tr_b16 v[76:77], v32 offset:768
    ds_read_b64_tr_b16 v[78:79], v32 offset:5376
    ds_read_b64_tr_b16 v[80:81], v32 offset:896
    ds_read_b64_tr_b16 v[82:83], v32 offset:5504
    s_waitcnt lgkmcnt(0)
    v_mfma_f32_16x16x32_bf16 v[84:87], v[36:39], v[52:55], 0
    v_mfma_f32_16x16x32_bf16 v[88:91], v[36:39], v[56:59], 0
    v_mfma_f32_16x16x32_bf16 v[92:95], v[36:39], v[60:63], 0
    v_mfma_f32_16x16x32_bf16 v[96:99], v[36:39], v[64:67], 0
    v_mfma_f32_16x16x32_bf16 v[100:103], v[36:39], v[68:71], 0
    v_mfma_f32_16x16x32_bf16 v[104:107], v[36:39], v[72:75], 0
    v_mfma_f32_16x16x32_bf16 v[108:111], v[36:39], v[76:79], 0
    v_mfma_f32_16x16x32_bf16 v[112:115], v[36:39], v[80:83], 0
    s_nop 7
    v_cvt_pk_bf16_f32 v116, v84, v88
    v_cvt_pk_bf16_f32 v117, v92, v96
    v_cvt_pk_bf16_f32 v118, v100, v104
    v_cvt_pk_bf16_f32 v119, v108, v112
    s_add_u32 s35, s34, 0
    buffer_store_dwordx4 v[116:119], v33, s[12:15], s35 offen sc1
    s_nop 1
    v_cvt_pk_bf16_f32 v120, v85, v89
    v_cvt_pk_bf16_f32 v121, v93, v97
    v_cvt_pk_bf16_f32 v122, v101, v105
    v_cvt_pk_bf16_f32 v123, v109, v113
    s_add_u32 s35, s34, 1024
    buffer_store_dwordx4 v[120:123], v33, s[12:15], s35 offen sc1
    s_nop 1
    v_cvt_pk_bf16_f32 v116, v86, v90
    v_cvt_pk_bf16_f32 v117, v94, v98
    v_cvt_pk_bf16_f32 v118, v102, v106
    v_cvt_pk_bf16_f32 v119, v110, v114
    s_add_u32 s35, s34, 528640
    buffer_store_dwordx4 v[116:119], v33, s[12:15], s35 offen sc1
    s_nop 1
    v_cvt_pk_bf16_f32 v120, v87, v91
    v_cvt_pk_bf16_f32 v121, v95, v99
    v_cvt_pk_bf16_f32 v122, v103, v107
    v_cvt_pk_bf16_f32 v123, v111, v115
    s_add_u32 s35, s34, 529664
    buffer_store_dwordx4 v[120:123], v33, s[12:15], s35 offen sc1
    s_nop 1
    v_mfma_f32_16x16x32_bf16 v[84:87], v[40:43], v[52:55], 0
    v_mfma_f32_16x16x32_bf16 v[88:91], v[40:43], v[56:59], 0
    v_mfma_f32_16x16x32_bf16 v[92:95], v[40:43], v[60:63], 0
    v_mfma_f32_16x16x32_bf16 v[96:99], v[40:43], v[64:67], 0
    v_mfma_f32_16x16x32_bf16 v[100:103], v[40:43], v[68:71], 0
    v_mfma_f32_16x16x32_bf16 v[104:107], v[40:43], v[72:75], 0
    v_mfma_f32_16x16x32_bf16 v[108:111], v[40:43], v[76:79], 0
    v_mfma_f32_16x16x32_bf16 v[112:115], v[40:43], v[80:83], 0
    s_nop 7
    v_cvt_pk_bf16_f32 v116, v84, v88
    v_cvt_pk_bf16_f32 v117, v92, v96
    v_cvt_pk_bf16_f32 v118, v100, v104
    v_cvt_pk_bf16_f32 v119, v108, v112
    s_add_u32 s35, s34, 4229120
    buffer_store_dwordx4 v[116:119], v33, s[12:15], s35 offen sc1
    s_nop 1
    v_cvt_pk_bf16_f32 v120, v85, v89
    v_cvt_pk_bf16_f32 v121, v93, v97
    v_cvt_pk_bf16_f32 v122, v101, v105
    v_cvt_pk_bf16_f32 v123, v109, v113
    s_add_u32 s35, s34, 4230144
    buffer_store_dwordx4 v[120:123], v33, s[12:15], s35 offen sc1
    s_nop 1
    v_cvt_pk_bf16_f32 v116, v86, v90
    v_cvt_pk_bf16_f32 v117, v94, v98
    v_cvt_pk_bf16_f32 v118, v102, v106
    v_cvt_pk_bf16_f32 v119, v110, v114
    s_add_u32 s35, s34, 4757760
    buffer_store_dwordx4 v[116:119], v33, s[12:15], s35 offen sc1
    s_nop 1
    v_cvt_pk_bf16_f32 v120, v87, v91
    v_cvt_pk_bf16_f32 v121, v95, v99
    v_cvt_pk_bf16_f32 v122, v103, v107
    v_cvt_pk_bf16_f32 v123, v111, v115
    s_add_u32 s35, s34, 4758784
    buffer_store_dwordx4 v[120:123], v33, s[12:15], s35 offen sc1
    s_nop 1
    v_mfma_f32_16x16x32_bf16 v[84:87], v[44:47], v[52:55], 0
    v_mfma_f32_16x16x32_bf16 v[88:91], v[44:47], v[56:59], 0
    v_mfma_f32_16x16x32_bf16 v[92:95], v[44:47], v[60:63], 0
    v_mfma_f32_16x16x32_bf16 v[96:99], v[44:47], v[64:67], 0
    v_mfma_f32_16x16x32_bf16 v[100:103], v[44:47], v[68:71], 0
    v_mfma_f32_16x16x32_bf16 v[104:107], v[44:47], v[72:75], 0
    v_mfma_f32_16x16x32_bf16 v[108:111], v[44:47], v[76:79], 0
    v_mfma_f32_16x16x32_bf16 v[112:115], v[44:47], v[80:83], 0
    s_nop 7
    v_cvt_pk_bf16_f32 v116, v84, v88
    v_cvt_pk_bf16_f32 v117, v92, v96
    v_cvt_pk_bf16_f32 v118, v100, v104
    v_cvt_pk_bf16_f32 v119, v108, v112
    s_add_u32 s35, s34, 8458240
    buffer_store_dwordx4 v[116:119], v33, s[12:15], s35 offen sc1
    s_nop 1
    v_cvt_pk_bf16_f32 v120, v85, v89
    v_cvt_pk_bf16_f32 v121, v93, v97
    v_cvt_pk_bf16_f32 v122, v101, v105
    v_cvt_pk_bf16_f32 v123, v109, v113
    s_add_u32 s35, s34, 8459264
    buffer_store_dwordx4 v[120:123], v33, s[12:15], s35 offen sc1
    s_nop 1
    v_cvt_pk_bf16_f32 v116, v86, v90
    v_cvt_pk_bf16_f32 v117, v94, v98
    v_cvt_pk_bf16_f32 v118, v102, v106
    v_cvt_pk_bf16_f32 v119, v110, v114
    s_add_u32 s35, s34, 8986880
    buffer_store_dwordx4 v[116:119], v33, s[12:15], s35 offen sc1
    s_nop 1
    v_cvt_pk_bf16_f32 v120, v87, v91
    v_cvt_pk_bf16_f32 v121, v95, v99
    v_cvt_pk_bf16_f32 v122, v103, v107
    v_cvt_pk_bf16_f32 v123, v111, v115
    s_add_u32 s35, s34, 8987904
    buffer_store_dwordx4 v[120:123], v33, s[12:15], s35 offen sc1
    s_nop 1
    v_mfma_f32_16x16x32_bf16 v[84:87], v[48:51], v[52:55], 0
    v_mfma_f32_16x16x32_bf16 v[88:91], v[48:51], v[56:59], 0
    v_mfma_f32_16x16x32_bf16 v[92:95], v[48:51], v[60:63], 0
    v_mfma_f32_16x16x32_bf16 v[96:99], v[48:51], v[64:67], 0
    v_mfma_f32_16x16x32_bf16 v[100:103], v[48:51], v[68:71], 0
    v_mfma_f32_16x16x32_bf16 v[104:107], v[48:51], v[72:75], 0
    v_mfma_f32_16x16x32_bf16 v[108:111], v[48:51], v[76:79], 0
    v_mfma_f32_16x16x32_bf16 v[112:115], v[48:51], v[80:83], 0
    s_nop 7
    v_cvt_pk_bf16_f32 v116, v84, v88
    v_cvt_pk_bf16_f32 v117, v92, v96
    v_cvt_pk_bf16_f32 v118, v100, v104
    v_cvt_pk_bf16_f32 v119, v108, v112
    s_add_u32 s35, s34, 12687360
    buffer_store_dwordx4 v[116:119], v33, s[12:15], s35 offen sc1
    s_nop 1
    v_cvt_pk_bf16_f32 v120, v85, v89
    v_cvt_pk_bf16_f32 v121, v93, v97
    v_cvt_pk_bf16_f32 v122, v101, v105
    v_cvt_pk_bf16_f32 v123, v109, v113
    s_add_u32 s35, s34, 12688384
    buffer_store_dwordx4 v[120:123], v33, s[12:15], s35 offen sc1
    s_nop 1
    v_cvt_pk_bf16_f32 v116, v86, v90
    v_cvt_pk_bf16_f32 v117, v94, v98
    v_cvt_pk_bf16_f32 v118, v102, v106
    v_cvt_pk_bf16_f32 v119, v110, v114
    s_add_u32 s35, s34, 13216000
    buffer_store_dwordx4 v[116:119], v33, s[12:15], s35 offen sc1
    s_nop 1
    v_cvt_pk_bf16_f32 v120, v87, v91
    v_cvt_pk_bf16_f32 v121, v95, v99
    v_cvt_pk_bf16_f32 v122, v103, v107
    v_cvt_pk_bf16_f32 v123, v111, v115
    s_add_u32 s35, s34, 13217024
    buffer_store_dwordx4 v[120:123], v33, s[12:15], s35 offen sc1
    s_nop 1
    s_endpgm
L_prep_kernel_slab:
    s_load_dwordx2 s[6:7], s[0:1], 72
    s_cmp_eq_u32 s2, 12
    s_cbranch_scc1 L_prep_kernel_tab
    s_lshr_b32 s24, s2, 2
    s_and_b32 s26, s2, 3
    s_mov_b32 s25, 40
    s_cmp_eq_u32 s24, 1
    s_cselect_b32 s25, 32, s25
    s_cmp_eq_u32 s24, 2
    s_cselect_b32 s25, 48, s25
    s_load_dwordx2 s[4:5], s[0:1], s25
    s_load_dwordx2 s[28:29], s[0:1], 24
    v_and_b32 v1, 63, v0
    v_lshrrev_b32 v2, 3, v1
    s_lshl_b32 s27, s20, 6
    v_add_u32 v2, s27, v2
    v_lshlrev_b32 v2, 9, v2
    v_and_b32 v3, 7, v1
    v_lshl_add_u32 v2, v3, 4, v2
    s_lshl_b32 s27, s26, 7
    v_add_u32 v2, s27, v2
    s_waitcnt lgkmcnt(0)
    s_mov_b32 s8, s4
    s_mov_b32 s9, s5
    s_mov_b32 s10, 131072
    s_mov_b32 s11, 0x00020000
    s_add_u32 s12, s6, 85499904
    s_addc_u32 s13, s7, 0
    s_mov_b32 s14, 294912
    s_mov_b32 s15, 0x00020000
    s_lshl_b32 s31, s20, 13
    s_add_u32 m0, s31, 0
    s_mov_b32 s32, 0
    buffer_load_dwordx4 v2, s[8:11], s32 offen nt lds
    s_add_u32 m0, s31, 1024
    s_mov_b32 s32, 4096
    buffer_load_dwordx4 v2, s[8:11], s32 offen nt lds
    s_add_u32 m0, s31, 2048
    s_mov_b32 s32, 8192
    buffer_load_dwordx4 v2, s[8:11], s32 offen nt lds
    s_add_u32 m0, s31, 3072
    s_mov_b32 s32, 12288
    buffer_load_dwordx4 v2, s[8:11], s32 offen nt lds
    s_add_u32 m0, s31, 4096
    s_mov_b32 s32, 16384
    buffer_load_dwordx4 v2, s[8:11], s32 offen nt lds
    s_add_u32 m0, s31, 5120
    s_mov_b32 s32, 20480
    buffer_load_dwordx4 v2, s[8:11], s32 offen nt lds
    s_add_u32 m0, s31, 6144
    s_mov_b32 s32, 24576
    buffer_load_dwordx4 v2, s[8:11], s32 offen nt lds
    s_add_u32 m0, s31, 7168
    s_mov_b32 s32, 28672
    buffer_load_dwordx4 v2, s[8:11], s32 offen nt lds
    s_cmp_eq_u32 s24, 0
    s_cbranch_scc1 L_prep_kernel_ge
    v_bfe_u32 v4, v1, 2, 2
    v_lshrrev_b32 v5, 5, v1
    v_bfe_u32 v6, v1, 4, 1
    v_and_b32 v7, 3, v1
    s_cmp_eq_u32 s24, 1
    s_cbranch_scc0 L_prep_kernel_wo
    v_lshl_add_u32 v8, v5, 4, v4
    v_lshlrev_b32 v8, 7, v8
    v_lshl_add_u32 v8, v6, 5, v8
    v_lshl_add_u32 v8, v7, 3, v8
    s_lshl_b32 s33, s20, 13
    v_add_u32 v8, s33, v8
    s_mov_b32 s34, 32768
    s_lshl_b32 s35, s26, 15
    s_add_u32 s34, s34, s35
    s_lshl_b32 s35, s20, 12
    s_add_u32 s34, s34, s35
    v_lshlrev_b32 v9, 4, v1
    s_waitcnt vmcnt(0)
    s_barrier
    ds_read_b64_tr_b16 v[16:17], v8 offset:0
    ds_read_b64_tr_b16 v[18:19], v8 offset:1024
    ds_read_b64_tr_b16 v[20:21], v8 offset:512
    ds_read_b64_tr_b16 v[22:23], v8 offset:1536
    ds_read_b64_tr_b16 v[24:25], v8 offset:4096
    ds_read_b64_tr_b16 v[26:27], v8 offset:5120
    ds_read_b64_tr_b16 v[28:29], v8 offset:4608
    ds_read_b64_tr_b16 v[30:31], v8 offset:5632
    s_waitcnt lgkmcnt(0)
    s_add_u32 s35, s34, 0
    buffer_store_dwordx4 v[16:19], v9, s[12:15], s35 offen sc1
    s_add_u32 s35, s34, 1024
    buffer_store_dwordx4 v[20:23], v9, s[12:15], s35 offen sc1
    s_add_u32 s35, s34, 2048
    buffer_store_dwordx4 v[24:27], v9, s[12:15], s35 offen sc1
    s_add_u32 s35, s34, 3072
    buffer_store_dwordx4 v[28:31], v9, s[12:15], s35 offen sc1
    ds_read_b64_tr_b16 v[32:33], v8 offset:64
    ds_read_b64_tr_b16 v[34:35], v8 offset:1088
    ds_read_b64_tr_b16 v[36:37], v8 offset:576
    ds_read_b64_tr_b16 v[38:39], v8 offset:1600
    ds_read_b64_tr_b16 v[40:41], v8 offset:4160
    ds_read_b64_tr_b16 v[42:43], v8 offset:5184
    ds_read_b64_tr_b16 v[44:45], v8 offset:4672
    ds_read_b64_tr_b16 v[46:47], v8 offset:5696
    s_waitcnt lgkmcnt(0)
    s_add_u32 s35, s34, 16384
    buffer_store_dwordx4 v[32:35], v9, s[12:15], s35 offen sc1
    s_add_u32 s35, s34, 17408
    buffer_store_dwordx4 v[36:39], v9, s[12:15], s35 offen sc1
    s_add_u32 s35, s34, 18432
    buffer_store_dwordx4 v[40:43], v9, s[12:15], s35 offen sc1
    s_add_u32 s35, s34, 19456
    buffer_store_dwordx4 v[44:47], v9, s[12:15], s35 offen sc1
    s_endpgm
L_prep_kernel_wo:
    v_lshl_add_u32 v8, v5, 2, v4
    v_lshlrev_b32 v8, 7, v8
    v_lshl_add_u32 v8, v6, 5, v8
    v_and_b32 v10, 1, v7
    v_lshl_add_u32 v8, v10, 4, v8
    v_lshrrev_b32 v10, 1, v7
    v_lshl_add_u32 v8, v10, 3, v8
    s_lshl_b32 s33, s20, 13
    v_add_u32 v8, s33, v8
    s_mov_b32 s34, 163840
    s_lshl_b32 s35, s26, 15
    s_add_u32 s34, s34, s35
    s_lshl_b32 s35, s20, 12
    s_add_u32 s34, s34, s35
    v_lshlrev_b32 v9, 4, v1
    s_waitcnt vmcnt(0)
    s_barrier
    ds_read_b64_tr_b16 v[16:17], v8 offset:0
    ds_read_b64_tr_b16 v[18:19], v8 offset:1024
    ds_read_b64_tr_b16 v[20:21], v8 offset:2048
    ds_read_b64_tr_b16 v[22:23], v8 offset:3072
    ds_read_b64_tr_b16 v[24:25], v8 offset:4096
    ds_read_b64_tr_b16 v[26:27], v8 offset:5120
    ds_read_b64_tr_b16 v[28:29], v8 offset:6144
    ds_read_b64_tr_b16 v[30:31], v8 offset:7168
    s_waitcnt lgkmcnt(0)
    v_mov_b32 v48, 0x3f803f80
    v_mov_b32 v49, 0x3f803f80
    v_mov_b32 v50, 0x3f803f80
    v_mov_b32 v51, 0x3f803f80
    s_nop 1
    v_mfma_f32_32x32x16_bf16 v[64:79], v[16:19], v[48:51], 0
    v_mfma_f32_32x32x16_bf16 v[64:79], v[20:23], v[48:51], v[64:79]
    v_mfma_f32_32x32x16_bf16 v[64:79], v[24:27], v[48:51], v[64:79]
    v_mfma_f32_32x32x16_bf16 v[64:79], v[28:31], v[48:51], v[64:79]
    v_lshlrev_b32 v52, 16, v16
    v_and_b32 v53, 0xffff0000, v16
    v_mul_f32 v52, -2.0, v52
    v_mul_f32 v53, -2.0, v53
    v_cvt_pk_bf16_f32 v16, v52, v53
    v_lshlrev_b32 v52, 16, v17
    v_and_b32 v53, 0xffff0000, v17
    v_mul_f32 v52, -2.0, v52
    v_mul_f32 v53, -2.0, v53
    v_cvt_pk_bf16_f32 v17, v52, v53
    v_lshlrev_b32 v52, 16, v18
    v_and_b32 v53, 0xffff0000, v18
    v_mul_f32 v52, -2.0, v52
    v_mul_f32 v53, -2.0, v53
    v_cvt_pk_bf16_f32 v18, v52, v53
    v_lshlrev_b32 v52, 16, v19
    v_and_b32 v53, 0xffff0000, v19
    v_mul_f32 v52, -2.0, v52
    v_mul_f32 v53, -2.0, v53
    v_cvt_pk_bf16_f32 v19, v52, v53
    v_lshlrev_b32 v52, 16, v20
    v_and_b32 v53, 0xffff0000, v20
    v_mul_f32 v52, -2.0, v52
    v_mul_f32 v53, -2.0, v53
    v_cvt_pk_bf16_f32 v20, v52, v53
    v_lshlrev_b32 v52, 16, v21
    v_and_b32 v53, 0xffff0000, v21
    v_mul_f32 v52, -2.0, v52
    v_mul_f32 v53, -2.0, v53
    v_cvt_pk_bf16_f32 v21, v52, v53
    v_lshlrev_b32 v52, 16, v22
    v_and_b32 v53, 0xffff0000, v22
    v_mul_f32 v52, -2.0, v52
    v_mul_f32 v53, -2.0, v53
    v_cvt_pk_bf16_f32 v22, v52, v53
    v_lshlrev_b32 v52, 16, v23
    v_and_b32 v53, 0xffff0000, v23
    v_mul_f32 v52, -2.0, v52
    v_mul_f32 v53, -2.0, v53
    v_cvt_pk_bf16_f32 v23, v52, v53
    v_lshlrev_b32 v52, 16, v24
    v_and_b32 v53, 0xffff0000, v24
    v_mul_f32 v52, -2.0, v52
    v_mul_f32 v53, -2.0, v53
    v_cvt_pk_bf16_f32 v24, v52, v53
    v_lshlrev_b32 v52, 16, v25
    v_and_b32 v53, 0xffff0000, v25
    v_mul_f32 v52, -2.0, v52
    v_mul_f32 v53, -2.0, v53
    v_cvt_pk_bf16_f32 v25, v52, v53
    v_lshlrev_b32 v52, 16, v26
    v_and_b32 v53, 0xffff0000, v26
    v_mul_f32 v52, -2.0, v52
    v_mul_f32 v53, -2.0, v53
    v_cvt_pk_bf16_f32 v26, v52, v53
    v_lshlrev_b32 v52, 16, v27
    v_and_b32 v53, 0xffff0000, v27
    v_mul_f32 v52, -2.0, v52
    v_mul_f32 v53, -2.0, v53
    v_cvt_pk_bf16_f32 v27, v52, v53
    v_lshlrev_b32 v52, 16, v28
    v_and_b32 v53, 0xffff0000, v28
    v_mul_f32 v52, -2.0, v52
    v_mul_f32 v53, -2.0, v53
    v_cvt_pk_bf16_f32 v28, v52, v53
    v_lshlrev_b32 v52, 16, v29
    v_and_b32 v53, 0xffff0000, v29
    v_mul_f32 v52, -2.0, v52
    v_mul_f32 v53, -2.0, v53
    v_cvt_pk_bf16_f32 v29, v52, v53
    v_lshlrev_b32 v52, 16, v30
    v_and_b32 v53, 0xffff0000, v30
    v_mul_f32 v52, -2.0, v52
    v_mul_f32 v53, -2.0, v53
    v_cvt_pk_bf16_f32 v30, v52, v53
    v_lshlrev_b32 v52, 16, v31
    v_and_b32 v53, 0xffff0000, v31
    v_mul_f32 v52, -2.0, v52
    v_mul_f32 v53, -2.0, v53
    v_cvt_pk_bf16_f32 v31, v52, v53
    s_add_u32 s35, s34, 0
    buffer_store_dwordx4 v[16:19], v9, s[12:15], s35 offen sc1
    s_add_u32 s35, s34, 1024
    buffer_store_dwordx4 v[20:23], v9, s[12:15], s35 offen sc1
    s_add_u32 s35, s34, 2048
    buffer_store_dwordx4 v[24:27], v9, s[12:15], s35 offen sc1
    s_add_u32 s35, s34, 3072
    buffer_store_dwordx4 v[28:31], v9, s[12:15], s35 offen sc1
    ds_read_b64_tr_b16 v[32:33], v8 offset:64
    ds_read_b64_tr_b16 v[34:35], v8 offset:1088
    ds_read_b64_tr_b16 v[36:37], v8 offset:2112
    ds_read_b64_tr_b16 v[38:39], v8 offset:3136
    ds_read_b64_tr_b16 v[40:41], v8 offset:4160
    ds_read_b64_tr_b16 v[42:43], v8 offset:5184
    ds_read_b64_tr_b16 v[44:45], v8 offset:6208
    ds_read_b64_tr_b16 v[46:47], v8 offset:7232
    s_waitcnt lgkmcnt(0)
    v_mfma_f32_32x32x16_bf16 v[80:95], v[32:35], v[48:51], 0
    v_mfma_f32_32x32x16_bf16 v[80:95], v[36:39], v[48:51], v[80:95]
    v_mfma_f32_32x32x16_bf16 v[80:95], v[40:43], v[48:51], v[80:95]
    v_mfma_f32_32x32x16_bf16 v[80:95], v[44:47], v[48:51], v[80:95]
    v_lshlrev_b32 v52, 16, v32
    v_and_b32 v53, 0xffff0000, v32
    v_mul_f32 v52, -2.0, v52
    v_mul_f32 v53, -2.0, v53
    v_cvt_pk_bf16_f32 v32, v52, v53
    v_lshlrev_b32 v52, 16, v33
    v_and_b32 v53, 0xffff0000, v33
    v_mul_f32 v52, -2.0, v52
    v_mul_f32 v53, -2.0, v53
    v_cvt_pk_bf16_f32 v33, v52, v53
    v_lshlrev_b32 v52, 16, v34
    v_and_b32 v53, 0xffff0000, v34
    v_mul_f32 v52, -2.0, v52
    v_mul_f32 v53, -2.0, v53
    v_cvt_pk_bf16_f32 v34, v52, v53
    v_lshlrev_b32 v52, 16, v35
    v_and_b32 v53, 0xffff0000, v35
    v_mul_f32 v52, -2.0, v52
    v_mul_f32 v53, -2.0, v53
    v_cvt_pk_bf16_f32 v35, v52, v53
    v_lshlrev_b32 v52, 16, v36
    v_and_b32 v53, 0xffff0000, v36
    v_mul_f32 v52, -2.0, v52
    v_mul_f32 v53, -2.0, v53
    v_cvt_pk_bf16_f32 v36, v52, v53
    v_lshlrev_b32 v52, 16, v37
    v_and_b32 v53, 0xffff0000, v37
    v_mul_f32 v52, -2.0, v52
    v_mul_f32 v53, -2.0, v53
    v_cvt_pk_bf16_f32 v37, v52, v53
    v_lshlrev_b32 v52, 16, v38
    v_and_b32 v53, 0xffff0000, v38
    v_mul_f32 v52, -2.0, v52
    v_mul_f32 v53, -2.0, v53
    v_cvt_pk_bf16_f32 v38, v52, v53
    v_lshlrev_b32 v52, 16, v39
    v_and_b32 v53, 0xffff0000, v39
    v_mul_f32 v52, -2.0, v52
    v_mul_f32 v53, -2.0, v53
    v_cvt_pk_bf16_f32 v39, v52, v53
    v_lshlrev_b32 v52, 16, v40
    v_and_b32 v53, 0xffff0000, v40
    v_mul_f32 v52, -2.0, v52
    v_mul_f32 v53, -2.0, v53
    v_cvt_pk_bf16_f32 v40, v52, v53
    v_lshlrev_b32 v52, 16, v41
    v_and_b32 v53, 0xffff0000, v41
    v_mul_f32 v52, -2.0, v52
    v_mul_f32 v53, -2.0, v53
    v_cvt_pk_bf16_f32 v41, v52, v53
    v_lshlrev_b32 v52, 16, v42
    v_and_b32 v53, 0xffff0000, v42
    v_mul_f32 v52, -2.0, v52
    v_mul_f32 v53, -2.0, v53
    v_cvt_pk_bf16_f32 v42, v52, v53
    v_lshlrev_b32 v52, 16, v43
    v_and_b32 v53, 0xffff0000, v43
    v_mul_f32 v52, -2.0, v52
    v_mul_f32 v53, -2.0, v53
    v_cvt_pk_bf16_f32 v43, v52, v53
    v_lshlrev_b32 v52, 16, v44
    v_and_b32 v53, 0xffff0000, v44
    v_mul_f32 v52, -2.0, v52
    v_mul_f32 v53, -2.0, v53
    v_cvt_pk_bf16_f32 v44, v52, v53
    v_lshlrev_b32 v52, 16, v45
    v_and_b32 v53, 0xffff0000, v45
    v_mul_f32 v52, -2.0, v52
    v_mul_f32 v53, -2.0, v53
    v_cvt_pk_bf16_f32 v45, v52, v53
    v_lshlrev_b32 v52, 16, v46
    v_and_b32 v53, 0xffff0000, v46
    v_mul_f32 v52, -2.0, v52
    v_mul_f32 v53, -2.0, v53
    v_cvt_pk_bf16_f32 v46, v52, v53
    v_lshlrev_b32 v52, 16, v47
    v_and_b32 v53, 0xffff0000, v47
    v_mul_f32 v52, -2.0, v52
    v_mul_f32 v53, -2.0, v53
    v_cvt_pk_bf16_f32 v47, v52, v53
    s_add_u32 s35, s34, 16384
    buffer_store_dwordx4 v[32:35], v9, s[12:15], s35 offen sc1
    s_add_u32 s35, s34, 17408
    buffer_store_dwordx4 v[36:39], v9, s[12:15], s35 offen sc1
    s_add_u32 s35, s34, 18432
    buffer_store_dwordx4 v[40:43], v9, s[12:15], s35 offen sc1
    s_add_u32 s35, s34, 19456
    buffer_store_dwordx4 v[44:47], v9, s[12:15], s35 offen sc1
    s_nop 7
    s_barrier
    v_lshlrev_b32 v10, 6, v1
    s_lshl_b32 s35, s20, 13
    v_add_u32 v11, s35, v10
    ds_write_b128 v11, v[64:67] offset:0
    ds_write_b128 v11, v[68:71] offset:16
    ds_write_b128 v11, v[72:75] offset:32
    ds_write_b128 v11, v[76:79] offset:48
    ds_write_b128 v11, v[80:83] offset:4096
    ds_write_b128 v11, v[84:87] offset:4112
    ds_write_b128 v11, v[88:91] offset:4128
    ds_write_b128 v11, v[92:95] offset:4144
    s_waitcnt lgkmcnt(0)
    s_barrier
    s_cmp_ge_u32 s20, 2
    s_cbranch_scc1 L_prep_kernel_done
    s_lshl_b32 s35, s20, 12
    v_add_u32 v11, s35, v10
    ds_read_b128 v[16:19], v11 offset:0
    ds_read_b128 v[20:23], v11 offset:16
    ds_read_b128 v[24:27], v11 offset:32
    ds_read_b128 v[28:31], v11 offset:48
    ds_read_b128 v[32:35], v11 offset:8192
    ds_read_b128 v[36:39], v11 offset:8208
    ds_read_b128 v[40:43], v11 offset:8224
    ds_read_b128 v[44:47], v11 offset:8240
    s_waitcnt lgkmcnt(0)
    ds_read_b128 v[48:51], v11 offset:16384
    ds_read_b128 v[52:55], v11 offset:16400
    ds_read_b128 v[56:59], v11 offset:16416
    ds_read_b128 v[60:63], v11 offset:16432
    ds_read_b128 v[64:67], v11 offset:24576
    ds_read_b128 v[68:71], v11 offset:24592
    ds_read_b128 v[72:75], v11 offset:24608
    ds_read_b128 v[76:79], v11 offset:24624
    s_waitcnt lgkmcnt(0)
    v_add_f32 v16, v16, v32
    v_add_f32 v48, v48, v64
    v_add_f32 v17, v17, v33
    v_add_f32 v49, v49, v65
    v_add_f32 v18, v18, v34
    v_add_f32 v50, v50, v66
    v_add_f32 v19, v19, v35
    v_add_f32 v51, v51, v67
    v_add_f32 v20, v20, v36
    v_add_f32 v52, v52, v68
    v_add_f32 v21, v21, v37
    v_add_f32 v53, v53, v69
    v_add_f32 v22, v22, v38
    v_add_f32 v54, v54, v70
    v_add_f32 v23, v23, v39
    v_add_f32 v55, v55, v71
    v_add_f32 v24, v24, v40
    v_add_f32 v56, v56, v72
    v_add_f32 v25, v25, v41
    v_add_f32 v57, v57, v73
    v_add_f32 v26, v26, v42
    v_add_f32 v58, v58, v74
    v_add_f32 v27, v27, v43
    v_add_f32 v59, v59, v75
    v_add_f32 v28, v28, v44
    v_add_f32 v60, v60, v76
    v_add_f32 v29, v29, v45
    v_add_f32 v61, v61, v77
    v_add_f32 v30, v30, v46
    v_add_f32 v62, v62, v78
    v_add_f32 v31, v31, v47
    v_add_f32 v63, v63, v79
    v_add_f32 v16, v16, v48
    v_add_f32 v17, v17, v49
    v_add_f32 v18, v18, v50
    v_add_f32 v19, v19, v51
    v_add_f32 v20, v20, v52
    v_add_f32 v21, v21, v53
    v_add_f32 v22, v22, v54
    v_add_f32 v23, v23, v55
    v_add_f32 v24, v24, v56
    v_add_f32 v25, v25, v57
    v_add_f32 v26, v26, v58
    v_add_f32 v27, v27, v59
    v_add_f32 v28, v28, v60
    v_add_f32 v29, v29, v61
    v_add_f32 v30, v30, v62
    v_add_f32 v31, v31, v63
    v_and_b32 v10, 31, v1
    v_cmp_eq_u32 vcc, 0, v10
    v_lshrrev_b32 v10, 5, v1
    v_lshlrev_b32 v10, 6, v10
    s_lshl_b32 s35, s26, 8
    s_lshl_b32 s36, s20, 7
    s_add_u32 s35, s35, s36
    s_add_u32 s35, s35, 14336
    s_and_saveexec_b64 s[38:39], vcc
    buffer_store_dwordx4 v[16:19], v10, s[12:15], s35 offen offset:0 sc1
    buffer_store_dwordx4 v[20:23], v10, s[12:15], s35 offen offset:16 sc1
    buffer_store_dwordx4 v[24:27], v10, s[12:15], s35 offen offset:32 sc1
    buffer_store_dwordx4 v[28:31], v10, s[12:15], s35 offen offset:48 sc1
    s_endpgm
L_prep_kernel_ge:
    s_mov_b32 s36, s28
    s_mov_b32 s37, s29
    s_mov_b32 s38, 8192
    s_mov_b32 s39, 0x00020000
    v_and_b32 v4, 15, v1
    v_lshrrev_b32 v5, 4, v1
    v_lshlrev_b32 v6, 9, v4
    v_lshl_add_u32 v6, v5, 4, v6
    buffer_load_dwordx4 v[16:19], v6, s[36:39], 0 offen offset:0
    buffer_load_dwordx4 v[20:23], v6, s[36:39], 0 offen offset:64
    buffer_load_dwordx4 v[24:27], v6, s[36:39], 0 offen offset:128
    buffer_load_dwordx4 v[28:31], v6, s[36:39], 0 offen offset:192
    buffer_load_dwordx4 v[32:35], v6, s[36:39], 0 offen offset:256
    buffer_load_dwordx4 v[36:39], v6, s[36:39], 0 offen offset:320
    buffer_load_dwordx4 v[40:43], v6, s[36:39], 0 offen offset:384
    buffer_load_dwordx4 v[44:47], v6, s[36:39], 0 offen offset:448
    v_bfe_u32 v7, v1, 2, 2
    v_lshl_add_u32 v7, v5, 3, v7
    v_lshlrev_b32 v7, 7, v7
    v_and_b32 v8, 3, v1
    v_lshl_add_u32 v7, v8, 3, v7
    s_lshl_b32 s33, s20, 5
    v_add_u32 v7, s33, v7
    s_waitcnt vmcnt(0)
    s_barrier
    ds_read_b64_tr_b16 v[48:49], v7 offset:0
    ds_read_b64_tr_b16 v[50:51], v7 offset:512
    ds_read_b64_tr_b16 v[52:53], v7 offset:4096
    ds_read_b64_tr_b16 v[54:55], v7 offset:4608
    ds_read_b64_tr_b16 v[56:57], v7 offset:8192
    ds_read_b64_tr_b16 v[58:59], v7 offset:8704
    ds_read_b64_tr_b16 v[60:61], v7 offset:12288
    ds_read_b64_tr_b16 v[62:63], v7 offset:12800
    s_waitcnt lgkmcnt(0)
    ds_read_b64_tr_b16 v[64:65], v7 offset:16384
    ds_read_b64_tr_b16 v[66:67], v7 offset:16896
    ds_read_b64_tr_b16 v[68:69], v7 offset:20480
    ds_read_b64_tr_b16 v[70:71], v7 offset:20992
    ds_read_b64_tr_b16 v[72:73], v7 offset:24576
    ds_read_b64_tr_b16 v[74:75], v7 offset:25088
    ds_read_b64_tr_b16 v[76:77], v7 offset:28672
    ds_read_b64_tr_b16 v[78:79], v7 offset:29184
    s_waitcnt lgkmcnt(0)
    v_mfma_f32_16x16x32_bf16 v[80:83], v[48:51], v[16:19], 0
    v_mfma_f32_16x16x32_bf16 v[80:83], v[52:55], v[20:23], v[80:83]
    v_mfma_f32_16x16x32_bf16 v[80:83], v[56:59], v[24:27], v[80:83]
    v_mfma_f32_16x16x32_bf16 v[80:83], v[60:63], v[28:31], v[80:83]
    v_mfma_f32_16x16x32_bf16 v[80:83], v[64:67], v[32:35], v[80:83]
    v_mfma_f32_16x16x32_bf16 v[80:83], v[68:71], v[36:39], v[80:83]
    v_mfma_f32_16x16x32_bf16 v[80:83], v[72:75], v[40:43], v[80:83]
    v_mfma_f32_16x16x32_bf16 v[80:83], v[76:79], v[44:47], v[80:83]
    s_nop 7
    v_cvt_pk_bf16_f32 v84, v80, v81
    v_cvt_pk_bf16_f32 v85, v82, v83
    s_mov_b32 s33, 0x4038aa3b
    v_lshlrev_b32 v80, 16, v84
    v_and_b32 v81, 0xffff0000, v84
    v_lshlrev_b32 v82, 16, v85
    v_and_b32 v83, 0xffff0000, v85
    v_mul_f32 v80, s33, v80
    v_mul_f32 v81, s33, v81
    v_mul_f32 v82, s33, v82
    v_mul_f32 v83, s33, v83
    v_lshlrev_b32 v6, 10, v4
    v_lshl_add_u32 v6, v5, 4, v6
    s_lshl_b32 s33, s26, 8
    s_lshl_b32 s34, s20, 6
    s_add_u32 s33, s33, s34
    s_add_u32 s33, s33, 16384
    buffer_store_dwordx4 v[80:83], v6, s[12:15], s33 offen sc1
    s_endpgm
L_prep_kernel_tab:
    v_and_b32 v8, 63, v0
    v_lshlrev_b32 v6, 4, v8
    s_waitcnt lgkmcnt(0)
    s_add_u32 s12, s6, 85499904
    s_addc_u32 s13, s7, 0
    s_mov_b32 s14, 294912
    s_mov_b32 s15, 0x00020000
    s_lshl_b32 s32, s20, 4
    s_lshl_b32 s33, s20, 11
    v_and_b32 v9, 15, v8
    v_lshrrev_b32 v10, 4, v8
    v_or_b32 v11, 1, v9
    v_add_u32 v11, s32, v11
    v_cvt_f32_u32 v11, v11
    v_mul_f32 v11, 0x3c000000, v11
    v_lshlrev_b32 v10, 3, v10
    v_add_u32 v10, 0, v10
    v_cvt_f32_u32 v10, v10
    v_and_b32 v9, 1, v9
    v_cvt_f32_u32 v9, v9
    v_mul_f32 v9, 0x3e800000, v9
    v_fma_f32 v12, v11, v10, v9
    v_fract_f32 v13, v12
    v_add_f32 v12, v12, v11
    v_fract_f32 v14, v12
    v_add_f32 v12, v12, v11
    v_fract_f32 v15, v12
    v_add_f32 v12, v12, v11
    v_fract_f32 v16, v12
    v_add_f32 v12, v12, v11
    v_fract_f32 v17, v12
    v_add_f32 v12, v12, v11
    v_fract_f32 v18, v12
    v_add_f32 v12, v12, v11
    v_fract_f32 v19, v12
    v_add_f32 v12, v12, v11
    v_fract_f32 v20, v12
    v_cos_f32 v13, v13
    v_cos_f32 v14, v14
    v_cos_f32 v15, v15
    v_cos_f32 v16, v16
    v_cos_f32 v17, v17
    v_cos_f32 v18, v18
    v_cos_f32 v19, v19
    v_cos_f32 v20, v20
    s_nop 0
    v_cvt_pk_bf16_f32 v24, v13, v14
    v_cvt_pk_bf16_f32 v25, v15, v16
    v_cvt_pk_bf16_f32 v26, v17, v18
    v_cvt_pk_bf16_f32 v27, v19, v20
    s_add_u32 s34, s33, 0
    buffer_store_dwordx4 v[24:27], v6, s[12:15], s34 offen sc1
    v_and_b32 v9, 15, v8
    v_lshrrev_b32 v10, 4, v8
    v_or_b32 v11, 1, v9
    v_add_u32 v11, s32, v11
    v_cvt_f32_u32 v11, v11
    v_mul_f32 v11, 0x3c000000, v11
    v_lshlrev_b32 v10, 3, v10
    v_add_u32 v10, 32, v10
    v_cvt_f32_u32 v10, v10
    v_and_b32 v9, 1, v9
    v_cvt_f32_u32 v9, v9
    v_mul_f32 v9, 0x3e800000, v9
    v_fma_f32 v12, v11, v10, v9
    v_fract_f32 v13, v12
    v_add_f32 v12, v12, v11
    v_fract_f32 v14, v12
    v_add_f32 v12, v12, v11
    v_fract_f32 v15, v12
    v_add_f32 v12, v12, v11
    v_fract_f32 v16, v12
    v_add_f32 v12, v12, v11
    v_fract_f32 v17, v12
    v_add_f32 v12, v12, v11
    v_fract_f32 v18, v12
    v_add_f32 v12, v12, v11
    v_fract_f32 v19, v12
    v_add_f32 v12, v12, v11
    v_fract_f32 v20, v12
    v_cos_f32 v13, v13
    v_cos_f32 v14, v14
    v_cos_f32 v15, v15
    v_cos_f32 v16, v16
    v_cos_f32 v17, v17
    v_cos_f32 v18, v18
    v_cos_f32 v19, v19
    v_cos_f32 v20, v20
    s_nop 0
    v_cvt_pk_bf16_f32 v28, v13, v14
    v_cvt_pk_bf16_f32 v29, v15, v16
    v_cvt_pk_bf16_f32 v30, v17, v18
    v_cvt_pk_bf16_f32 v31, v19, v20
    s_add_u32 s34, s33, 1024
    buffer_store_dwordx4 v[28:31], v6, s[12:15], s34 offen sc1
    s_cmp_ge_u32 s20, 3
    s_cbranch_scc1 L_prep_kernel_done
    v_and_b32 v9, 15, v8
    v_add_u32 v9, s32, v9
    v_cvt_f32_u32 v9, v9
    v_mul_f32 v9, 0x3c000000, v9
    v_lshrrev_b32 v10, 4, v8
    v_lshlrev_b32 v10, 3, v10
    v_add_u32 v11, 1, v10
    v_cvt_f32_u32 v11, v11
    v_mul_f32 v11, v11, v9
    v_fract_f32 v12, v11
    v_add_u32 v11, 1, v10
    v_cvt_f32_u32 v11, v11
    v_mul_f32 v11, v11, v9
    v_add_f32 v11, 0x3e800000, v11
    v_fract_f32 v13, v11
    v_add_u32 v11, 3, v10
    v_cvt_f32_u32 v11, v11
    v_mul_f32 v11, v11, v9
    v_fract_f32 v14, v11
    v_add_u32 v11, 3, v10
    v_cvt_f32_u32 v11, v11
    v_mul_f32 v11, v11, v9
    v_add_f32 v11, 0x3e800000, v11
    v_fract_f32 v15, v11
    v_add_u32 v11, 5, v10
    v_cvt_f32_u32 v11, v11
    v_mul_f32 v11, v11, v9
    v_fract_f32 v16, v11
    v_add_u32 v11, 5, v10
    v_cvt_f32_u32 v11, v11
    v_mul_f32 v11, v11, v9
    v_add_f32 v11, 0x3e800000, v11
    v_fract_f32 v17, v11
    v_add_u32 v11, 7, v10
    v_cvt_f32_u32 v11, v11
    v_mul_f32 v11, v11, v9
    v_fract_f32 v18, v11
    v_add_u32 v11, 7, v10
    v_cvt_f32_u32 v11, v11
    v_mul_f32 v11, v11, v9
    v_add_f32 v11, 0x3e800000, v11
    v_fract_f32 v19, v11
    v_cos_f32 v12, v12
    v_cos_f32 v13, v13
    v_cos_f32 v14, v14
    v_cos_f32 v15, v15
    v_cos_f32 v16, v16
    v_cos_f32 v17, v17
    v_cos_f32 v18, v18
    v_cos_f32 v19, v19
    s_nop 0
    v_cvt_pk_bf16_f32 v24, v12, v13
    v_cvt_pk_bf16_f32 v25, v14, v15
    v_cvt_pk_bf16_f32 v26, v16, v17
    v_cvt_pk_bf16_f32 v27, v18, v19
    s_add_u32 s34, s33, 8192
    buffer_store_dwordx4 v[24:27], v6, s[12:15], s34 offen sc1
    s_nop 1
    v_add_u32 v11, 33, v10
    v_cvt_f32_u32 v11, v11
    v_mul_f32 v11, v11, v9
    v_fract_f32 v12, v11
    v_add_u32 v11, 33, v10
    v_cvt_f32_u32 v11, v11
    v_mul_f32 v11, v11, v9
    v_add_f32 v11, 0x3e800000, v11
    v_fract_f32 v13, v11
    v_add_u32 v11, 35, v10
    v_cvt_f32_u32 v11, v11
    v_mul_f32 v11, v11, v9
    v_fract_f32 v14, v11
    v_add_u32 v11, 35, v10
    v_cvt_f32_u32 v11, v11
    v_mul_f32 v11, v11, v9
    v_add_f32 v11, 0x3e800000, v11
    v_fract_f32 v15, v11
    v_add_u32 v11, 37, v10
    v_cvt_f32_u32 v11, v11
    v_mul_f32 v11, v11, v9
    v_fract_f32 v16, v11
    v_add_u32 v11, 37, v10
    v_cvt_f32_u32 v11, v11
    v_mul_f32 v11, v11, v9
    v_add_f32 v11, 0x3e800000, v11
    v_fract_f32 v17, v11
    v_add_u32 v11, 39, v10
    v_cvt_f32_u32 v11, v11
    v_mul_f32 v11, v11, v9
    v_fract_f32 v18, v11
    v_add_u32 v11, 39, v10
    v_cvt_f32_u32 v11, v11
    v_mul_f32 v11, v11, v9
    v_add_f32 v11, 0x3e800000, v11
    v_fract_f32 v19, v11
    v_cos_f32 v12, v12
    v_cos_f32 v13, v13
    v_cos_f32 v14, v14
    v_cos_f32 v15, v15
    v_cos_f32 v16, v16
    v_cos_f32 v17, v17
    v_cos_f32 v18, v18
    v_cos_f32 v19, v19
    s_nop 0
    v_cvt_pk_bf16_f32 v24, v12, v13
    v_cvt_pk_bf16_f32 v25, v14, v15
    v_cvt_pk_bf16_f32 v26, v16, v17
    v_cvt_pk_bf16_f32 v27, v18, v19
    s_add_u32 s34, s33, 9216
    buffer_store_dwordx4 v[24:27], v6, s[12:15], s34 offen sc1
    s_nop 1
L_prep_kernel_done:
    s_endpgm
.globl gemm1_kernel
.p2align 8
.type gemm1_kernel,@function
gemm1_kernel:
    s_cmp_ge_u32 s2, 256
    s_cbranch_scc1 L_gemm1_kernel_done
    s_load_dwordx2 s[4:5], s[0:1], 72
    s_load_dwordx2 s[6:7], s[0:1], 72
    v_readfirstlane_b32 s20, v0
    s_lshr_b32 s20, s20, 6
    s_and_b32 s24, s2, 7
    s_lshr_b32 s25, s2, 3
    s_lshr_b32 s26, s25, 3
    s_lshl_b32 s24, s24, 2
    s_add_u32 s21, s24, s26
    s_and_b32 s25, s25, 7
    s_lshr_b32 s26, s25, 1
    s_and_b32 s27, s25, 1
    s_mul_i32 s22, s26, 84
    s_sub_u32 s28, 334, s22
    s_min_u32 s28, s28, 84
    s_waitcnt lgkmcnt(0)
    s_mul_i32 s29, s21, 684032
    s_lshl_b32 s30, s22, 11
    s_add_u32 s29, s29, s30
    s_add_u32 s29, s29, 0
    s_add_u32 s8, s6, s29
    s_addc_u32 s9, s7, 0
    s_lshl_b32 s10, s28, 11
    s_mov_b32 s11, 0x00020000
    s_mul_i32 s29, s21, 528640
    s_mul_i32 s30, s27, 16384
    s_add_u32 s29, s29, s30
    s_add_u32 s29, s29, 21954560
    s_add_u32 s12, s4, s29
    s_addc_u32 s13, s5, 0
    s_mov_b32 s14, 507904
    s_mov_b32 s15, 0x00020000
    s_cmp_ge_u32 s20, 4
    s_cbranch_scc1 L_gemm1_kernel_loader
    s_mul_i32 s29, s22, 37120
    s_add_u32 s29, s29, 38871040
    s_add_u32 s16, s4, s29
    s_addc_u32 s17, s5, 0
    s_mul_i32 s18, s28, 37120
    s_mov_b32 s19, 0x00020000
    s_lshr_b32 s29, s20, 1
    s_and_b32 s30, s20, 1
    v_and_b32 v217, 15, v0
    v_bfe_u32 v218, v0, 4, 2
    v_and_b32 v219, 63, v0
    s_mul_i32 s31, s29, 6144
    v_and_b32 v220, 7, v217
    v_xor_b32 v220, v218, v220
    v_lshlrev_b32 v220, 4, v220
    v_lshl_add_u32 v220, v217, 7, v220
    v_add_u32 v220, s31, v220
    v_add_u32 v208, 0, v220
    v_xor_b32 v211, 64, v208
    v_add_u32 v209, 57344, v220
    v_xor_b32 v212, 64, v209
    v_add_u32 v210, 114688, v220
    v_xor_b32 v213, 64, v210
    s_mul_i32 s31, s30, 8192
    s_add_u32 s31, s31, 12288
    v_lshlrev_b32 v220, 4, v219
    v_add_u32 v220, s31, v220
    v_add_u32 v214, 0, v220
    v_add_u32 v215, 57344, v220
    v_add_u32 v216, 114688, v220
    v_and_b32 v224, 7, v217
    v_lshrrev_b32 v225, 3, v217
    v_mul_u32_u24 v222, 37120, v224
    v_lshl_add_u32 v222, v218, 4, v222
    s_mul_i32 s31, s29, 1781760
    v_add_u32 v222, s31, v222
    v_lshl_add_u32 v222, v225, 6, v222
    v_xor_b32 v225, 64, v222
    v_add_u32 v223, 296960, v225
    s_mul_i32 s31, s27, 4
    s_mul_i32 s29, s30, 2
    s_add_u32 s31, s31, s29
    s_lshl_b32 s31, s31, 12
    s_lshl_b32 s29, s21, 7
    s_add_u32 s33, s31, s29
    s_mov_b32 s34, 0x80008000
    s_barrier
    ds_read_b128 v[96:99], v214 offset:0
    ds_read_b128 v[128:131], v208 offset:0
    ds_read_b128 v[136:139], v208 offset:2048
    ds_read_b128 v[144:147], v208 offset:4096
    ds_read_b128 v[104:107], v214 offset:2048
    ds_read_b128 v[112:115], v214 offset:4096
    ds_read_b128 v[120:123], v214 offset:6144
    ds_read_b128 v[132:135], v211 offset:0
    ds_read_b128 v[140:143], v211 offset:2048
    ds_read_b128 v[148:151], v211 offset:4096
    ds_read_b128 v[100:103], v214 offset:1024
    ds_read_b128 v[108:111], v214 offset:3072
    ds_read_b128 v[116:119], v214 offset:5120
    ds_read_b128 v[124:127], v214 offset:7168
    s_waitcnt lgkmcnt(0)
    s_barrier
    v_mfma_f32_16x16x32_bf16 v[0:3], v[96:99], v[128:131], 0
    ds_read_b128 v[152:155], v214 offset:28672
    v_mfma_f32_16x16x32_bf16 v[4:7], v[96:99], v[136:139], 0
    v_mfma_f32_16x16x32_bf16 v[8:11], v[96:99], v[144:147], 0
    ds_read_b128 v[184:187], v208 offset:28672
    v_mfma_f32_16x16x32_bf16 v[12:15], v[104:107], v[128:131], 0
    v_mfma_f32_16x16x32_bf16 v[16:19], v[104:107], v[136:139], 0
    ds_read_b128 v[192:195], v208 offset:30720
    v_mfma_f32_16x16x32_bf16 v[20:23], v[104:107], v[144:147], 0
    v_mfma_f32_16x16x32_bf16 v[24:27], v[112:115], v[128:131], 0
    ds_read_b128 v[200:203], v208 offset:32768
    v_mfma_f32_16x16x32_bf16 v[28:31], v[112:115], v[136:139], 0
    v_mfma_f32_16x16x32_bf16 v[32:35], v[112:115], v[144:147], 0
    ds_read_b128 v[160:163], v214 offset:30720
    v_mfma_f32_16x16x32_bf16 v[36:39], v[120:123], v[128:131], 0
    v_mfma_f32_16x16x32_bf16 v[40:43], v[120:123], v[136:139], 0
    ds_read_b128 v[168:171], v214 offset:32768
    v_mfma_f32_16x16x32_bf16 v[44:47], v[120:123], v[144:147], 0
    v_mfma_f32_16x16x32_bf16 v[48:51], v[96:99], v[132:135], 0
    ds_read_b128 v[176:179], v214 offset:34816
    v_mfma_f32_16x16x32_bf16 v[52:55], v[96:99], v[140:143], 0
    v_mfma_f32_16x16x32_bf16 v[56:59], v[96:99], v[148:151], 0
    ds_read_b128 v[188:191], v211 offset:28672
    v_mfma_f32_16x16x32_bf16 v[60:63], v[104:107], v[132:135], 0
    v_mfma_f32_16x16x32_bf16 v[64:67], v[104:107], v[140:143], 0
    ds_read_b128 v[196:199], v211 offset:30720
    v_mfma_f32_16x16x32_bf16 v[68:71], v[104:107], v[148:151], 0
    v_mfma_f32_16x16x32_bf16 v[72:75], v[112:115], v[132:135], 0
    ds_read_b128 v[204:207], v211 offset:32768
    v_mfma_f32_16x16x32_bf16 v[76:79], v[112:115], v[140:143], 0
    v_mfma_f32_16x16x32_bf16 v[80:83], v[112:115], v[148:151], 0
    ds_read_b128 v[156:159], v214 offset:29696
    v_mfma_f32_16x16x32_bf16 v[84:87], v[120:123], v[132:135], 0
    v_mfma_f32_16x16x32_bf16 v[88:91], v[120:123], v[140:143], 0
    ds_read_b128 v[164:167], v214 offset:31744
    v_mfma_f32_16x16x32_bf16 v[92:95], v[120:123], v[148:151], 0
    v_mfma_f32_16x16x32_bf16 v[48:51], v[100:103], v[128:131], v[48:51]
    ds_read_b128 v[172:175], v214 offset:33792
    v_xor_b32 v132, s34, v132
    v_xor_b32 v133, s34, v133
    v_mfma_f32_16x16x32_bf16 v[52:55], v[100:103], v[136:139], v[52:55]
    v_xor_b32 v134, s34, v134
    v_xor_b32 v135, s34, v135
    v_mfma_f32_16x16x32_bf16 v[56:59], v[100:103], v[144:147], v[56:59]
    ds_read_b128 v[180:183], v214 offset:35840
    v_xor_b32 v140, s34, v140
    v_xor_b32 v141, s34, v141
    v_mfma_f32_16x16x32_bf16 v[60:63], v[108:111], v[128:131], v[60:63]
    v_xor_b32 v142, s34, v142
    v_xor_b32 v143, s34, v143
    v_mfma_f32_16x16x32_bf16 v[64:67], v[108:111], v[136:139], v[64:67]
    v_xor_b32 v148, s34, v148
    v_xor_b32 v149, s34, v149
    v_mfma_f32_16x16x32_bf16 v[68:71], v[108:111], v[144:147], v[68:71]
    v_xor_b32 v150, s34, v150
    v_xor_b32 v151, s34, v151
    v_mfma_f32_16x16x32_bf16 v[72:75], v[116:119], v[128:131], v[72:75]
    v_mfma_f32_16x16x32_bf16 v[76:79], v[116:119], v[136:139], v[76:79]
    v_mfma_f32_16x16x32_bf16 v[80:83], v[116:119], v[144:147], v[80:83]
    v_mfma_f32_16x16x32_bf16 v[84:87], v[124:127], v[128:131], v[84:87]
    v_mfma_f32_16x16x32_bf16 v[88:91], v[124:127], v[136:139], v[88:91]
    v_mfma_f32_16x16x32_bf16 v[92:95], v[124:127], v[144:147], v[92:95]
    v_mfma_f32_16x16x32_bf16 v[0:3], v[100:103], v[132:135], v[0:3]
    v_mfma_f32_16x16x32_bf16 v[4:7], v[100:103], v[140:143], v[4:7]
    v_mfma_f32_16x16x32_bf16 v[8:11], v[100:103], v[148:151], v[8:11]
    v_mfma_f32_16x16x32_bf16 v[12:15], v[108:111], v[132:135], v[12:15]
    v_mfma_f32_16x16x32_bf16 v[16:19], v[108:111], v[140:143], v[16:19]
    s_waitcnt lgkmcnt(0)
    s_barrier
    v_mfma_f32_16x16x32_bf16 v[20:23], v[108:111], v[148:151], v[20:23]
    v_mfma_f32_16x16x32_bf16 v[24:27], v[116:119], v[132:135], v[24:27]
    v_mfma_f32_16x16x32_bf16 v[28:31], v[116:119], v[140:143], v[28:31]
    v_mfma_f32_16x16x32_bf16 v[32:35], v[116:119], v[148:151], v[32:35]
    v_mfma_f32_16x16x32_bf16 v[36:39], v[124:127], v[132:135], v[36:39]
    v_mfma_f32_16x16x32_bf16 v[40:43], v[124:127], v[140:143], v[40:43]
    v_mfma_f32_16x16x32_bf16 v[44:47], v[124:127], v[148:151], v[44:47]
    v_mfma_f32_16x16x32_bf16 v[0:3], v[152:155], v[184:187], v[0:3]
    ds_read_b128 v[96:99], v215 offset:0
    v_mfma_f32_16x16x32_bf16 v[4:7], v[152:155], v[192:195], v[4:7]
    v_mfma_f32_16x16x32_bf16 v[8:11], v[152:155], v[200:203], v[8:11]
    ds_read_b128 v[128:131], v209 offset:0
    v_mfma_f32_16x16x32_bf16 v[12:15], v[160:163], v[184:187], v[12:15]
    v_mfma_f32_16x16x32_bf16 v[16:19], v[160:163], v[192:195], v[16:19]
    ds_read_b128 v[136:139], v209 offset:2048
    v_mfma_f32_16x16x32_bf16 v[20:23], v[160:163], v[200:203], v[20:23]
    v_mfma_f32_16x16x32_bf16 v[24:27], v[168:171], v[184:187], v[24:27]
    ds_read_b128 v[144:147], v209 offset:4096
    v_mfma_f32_16x16x32_bf16 v[28:31], v[168:171], v[192:195], v[28:31]
    v_mfma_f32_16x16x32_bf16 v[32:35], v[168:171], v[200:203], v[32:35]
    ds_read_b128 v[104:107], v215 offset:2048
    v_mfma_f32_16x16x32_bf16 v[36:39], v[176:179], v[184:187], v[36:39]
    v_mfma_f32_16x16x32_bf16 v[40:43], v[176:179], v[192:195], v[40:43]
    ds_read_b128 v[112:115], v215 offset:4096
    v_mfma_f32_16x16x32_bf16 v[44:47], v[176:179], v[200:203], v[44:47]
    v_mfma_f32_16x16x32_bf16 v[48:51], v[152:155], v[188:191], v[48:51]
    ds_read_b128 v[120:123], v215 offset:6144
    v_mfma_f32_16x16x32_bf16 v[52:55], v[152:155], v[196:199], v[52:55]
    v_mfma_f32_16x16x32_bf16 v[56:59], v[152:155], v[204:207], v[56:59]
    ds_read_b128 v[132:135], v212 offset:0
    v_mfma_f32_16x16x32_bf16 v[60:63], v[160:163], v[188:191], v[60:63]
    v_mfma_f32_16x16x32_bf16 v[64:67], v[160:163], v[196:199], v[64:67]
    ds_read_b128 v[140:143], v212 offset:2048
    v_mfma_f32_16x16x32_bf16 v[68:71], v[160:163], v[204:207], v[68:71]
    v_mfma_f32_16x16x32_bf16 v[72:75], v[168:171], v[188:191], v[72:75]
    ds_read_b128 v[148:151], v212 offset:4096
    v_mfma_f32_16x16x32_bf16 v[76:79], v[168:171], v[196:199], v[76:79]
    v_mfma_f32_16x16x32_bf16 v[80:83], v[168:171], v[204:207], v[80:83]
    ds_read_b128 v[100:103], v215 offset:1024
    v_mfma_f32_16x16x32_bf16 v[84:87], v[176:179], v[188:191], v[84:87]
    v_mfma_f32_16x16x32_bf16 v[88:91], v[176:179], v[196:199], v[88:91]
    ds_read_b128 v[108:111], v215 offset:3072
    v_mfma_f32_16x16x32_bf16 v[92:95], v[176:179], v[204:207], v[92:95]
    v_mfma_f32_16x16x32_bf16 v[48:51], v[156:159], v[184:187], v[48:51]
    ds_read_b128 v[116:119], v215 offset:5120
    v_xor_b32 v188, s34, v188
    v_xor_b32 v189, s34, v189
    v_mfma_f32_16x16x32_bf16 v[52:55], v[156:159], v[192:195], v[52:55]
    v_xor_b32 v190, s34, v190
    v_xor_b32 v191, s34, v191
    v_mfma_f32_16x16x32_bf16 v[56:59], v[156:159], v[200:203], v[56:59]
    ds_read_b128 v[124:127], v215 offset:7168
    v_xor_b32 v196, s34, v196
    v_xor_b32 v197, s34, v197
    v_mfma_f32_16x16x32_bf16 v[60:63], v[164:167], v[184:187], v[60:63]
    v_xor_b32 v198, s34, v198
    v_xor_b32 v199, s34, v199
    v_mfma_f32_16x16x32_bf16 v[64:67], v[164:167], v[192:195], v[64:67]
    v_xor_b32 v204, s34, v204
    v_xor_b32 v205, s34, v205
    v_mfma_f32_16x16x32_bf16 v[68:71], v[164:167], v[200:203], v[68:71]
    v_xor_b32 v206, s34, v206
    v_xor_b32 v207, s34, v207
    v_mfma_f32_16x16x32_bf16 v[72:75], v[172:175], v[184:187], v[72:75]
    v_mfma_f32_16x16x32_bf16 v[76:79], v[172:175], v[192:195], v[76:79]
    v_mfma_f32_16x16x32_bf16 v[80:83], v[172:175], v[200:203], v[80:83]
    v_mfma_f32_16x16x32_bf16 v[84:87], v[180:183], v[184:187], v[84:87]
    v_mfma_f32_16x16x32_bf16 v[88:91], v[180:183], v[192:195], v[88:91]
    v_mfma_f32_16x16x32_bf16 v[92:95], v[180:183], v[200:203], v[92:95]
    v_mfma_f32_16x16x32_bf16 v[0:3], v[156:159], v[188:191], v[0:3]
    v_mfma_f32_16x16x32_bf16 v[4:7], v[156:159], v[196:199], v[4:7]
    v_mfma_f32_16x16x32_bf16 v[8:11], v[156:159], v[204:207], v[8:11]
    v_mfma_f32_16x16x32_bf16 v[12:15], v[164:167], v[188:191], v[12:15]
    v_mfma_f32_16x16x32_bf16 v[16:19], v[164:167], v[196:199], v[16:19]
    s_waitcnt lgkmcnt(0)
    s_barrier
    v_mfma_f32_16x16x32_bf16 v[20:23], v[164:167], v[204:207], v[20:23]
    v_mfma_f32_16x16x32_bf16 v[24:27], v[172:175], v[188:191], v[24:27]
    v_mfma_f32_16x16x32_bf16 v[28:31], v[172:175], v[196:199], v[28:31]
    v_mfma_f32_16x16x32_bf16 v[32:35], v[172:175], v[204:207], v[32:35]
    v_mfma_f32_16x16x32_bf16 v[36:39], v[180:183], v[188:191], v[36:39]
    v_mfma_f32_16x16x32_bf16 v[40:43], v[180:183], v[196:199], v[40:43]
    v_mfma_f32_16x16x32_bf16 v[44:47], v[180:183], v[204:207], v[44:47]
    v_mfma_f32_16x16x32_bf16 v[0:3], v[96:99], v[128:131], v[0:3]
    ds_read_b128 v[152:155], v215 offset:28672
    v_mfma_f32_16x16x32_bf16 v[4:7], v[96:99], v[136:139], v[4:7]
    v_mfma_f32_16x16x32_bf16 v[8:11], v[96:99], v[144:147], v[8:11]
    ds_read_b128 v[184:187], v209 offset:28672
    v_mfma_f32_16x16x32_bf16 v[12:15], v[104:107], v[128:131], v[12:15]
    v_mfma_f32_16x16x32_bf16 v[16:19], v[104:107], v[136:139], v[16:19]
    ds_read_b128 v[192:195], v209 offset:30720
    v_mfma_f32_16x16x32_bf16 v[20:23], v[104:107], v[144:147], v[20:23]
    v_mfma_f32_16x16x32_bf16 v[24:27], v[112:115], v[128:131], v[24:27]
    ds_read_b128 v[200:203], v209 offset:32768
    v_mfma_f32_16x16x32_bf16 v[28:31], v[112:115], v[136:139], v[28:31]
    v_mfma_f32_16x16x32_bf16 v[32:35], v[112:115], v[144:147], v[32:35]
    ds_read_b128 v[160:163], v215 offset:30720
    v_mfma_f32_16x16x32_bf16 v[36:39], v[120:123], v[128:131], v[36:39]
    v_mfma_f32_16x16x32_bf16 v[40:43], v[120:123], v[136:139], v[40:43]
    ds_read_b128 v[168:171], v215 offset:32768
    v_mfma_f32_16x16x32_bf16 v[44:47], v[120:123], v[144:147], v[44:47]
    v_mfma_f32_16x16x32_bf16 v[48:51], v[96:99], v[132:135], v[48:51]
    ds_read_b128 v[176:179], v215 offset:34816
    v_mfma_f32_16x16x32_bf16 v[52:55], v[96:99], v[140:143], v[52:55]
    v_mfma_f32_16x16x32_bf16 v[56:59], v[96:99], v[148:151], v[56:59]
    ds_read_b128 v[188:191], v212 offset:28672
    v_mfma_f32_16x16x32_bf16 v[60:63], v[104:107], v[132:135], v[60:63]
    v_mfma_f32_16x16x32_bf16 v[64:67], v[104:107], v[140:143], v[64:67]
    ds_read_b128 v[196:199], v212 offset:30720
    v_mfma_f32_16x16x32_bf16 v[68:71], v[104:107], v[148:151], v[68:71]
    v_mfma_f32_16x16x32_bf16 v[72:75], v[112:115], v[132:135], v[72:75]
    ds_read_b128 v[204:207], v212 offset:32768
    v_mfma_f32_16x16x32_bf16 v[76:79], v[112:115], v[140:143], v[76:79]
    v_mfma_f32_16x16x32_bf16 v[80:83], v[112:115], v[148:151], v[80:83]
    ds_read_b128 v[156:159], v215 offset:29696
    v_mfma_f32_16x16x32_bf16 v[84:87], v[120:123], v[132:135], v[84:87]
    v_mfma_f32_16x16x32_bf16 v[88:91], v[120:123], v[140:143], v[88:91]
    ds_read_b128 v[164:167], v215 offset:31744
    v_mfma_f32_16x16x32_bf16 v[92:95], v[120:123], v[148:151], v[92:95]
    v_mfma_f32_16x16x32_bf16 v[48:51], v[100:103], v[128:131], v[48:51]
    ds_read_b128 v[172:175], v215 offset:33792
    v_xor_b32 v132, s34, v132
    v_xor_b32 v133, s34, v133
    v_mfma_f32_16x16x32_bf16 v[52:55], v[100:103], v[136:139], v[52:55]
    v_xor_b32 v134, s34, v134
    v_xor_b32 v135, s34, v135
    v_mfma_f32_16x16x32_bf16 v[56:59], v[100:103], v[144:147], v[56:59]
    ds_read_b128 v[180:183], v215 offset:35840
    v_xor_b32 v140, s34, v140
    v_xor_b32 v141, s34, v141
    v_mfma_f32_16x16x32_bf16 v[60:63], v[108:111], v[128:131], v[60:63]
    v_xor_b32 v142, s34, v142
    v_xor_b32 v143, s34, v143
    v_mfma_f32_16x16x32_bf16 v[64:67], v[108:111], v[136:139], v[64:67]
    v_xor_b32 v148, s34, v148
    v_xor_b32 v149, s34, v149
    v_mfma_f32_16x16x32_bf16 v[68:71], v[108:111], v[144:147], v[68:71]
    v_xor_b32 v150, s34, v150
    v_xor_b32 v151, s34, v151
    v_mfma_f32_16x16x32_bf16 v[72:75], v[116:119], v[128:131], v[72:75]
    v_mfma_f32_16x16x32_bf16 v[76:79], v[116:119], v[136:139], v[76:79]
    v_mfma_f32_16x16x32_bf16 v[80:83], v[116:119], v[144:147], v[80:83]
    v_mfma_f32_16x16x32_bf16 v[84:87], v[124:127], v[128:131], v[84:87]
    v_mfma_f32_16x16x32_bf16 v[88:91], v[124:127], v[136:139], v[88:91]
    v_mfma_f32_16x16x32_bf16 v[92:95], v[124:127], v[144:147], v[92:95]
    v_mfma_f32_16x16x32_bf16 v[0:3], v[100:103], v[132:135], v[0:3]
    v_mfma_f32_16x16x32_bf16 v[4:7], v[100:103], v[140:143], v[4:7]
    v_mfma_f32_16x16x32_bf16 v[8:11], v[100:103], v[148:151], v[8:11]
    v_mfma_f32_16x16x32_bf16 v[12:15], v[108:111], v[132:135], v[12:15]
    v_mfma_f32_16x16x32_bf16 v[16:19], v[108:111], v[140:143], v[16:19]
    s_waitcnt lgkmcnt(0)
    s_barrier
    v_mfma_f32_16x16x32_bf16 v[20:23], v[108:111], v[148:151], v[20:23]
    v_mfma_f32_16x16x32_bf16 v[24:27], v[116:119], v[132:135], v[24:27]
    v_mfma_f32_16x16x32_bf16 v[28:31], v[116:119], v[140:143], v[28:31]
    v_mfma_f32_16x16x32_bf16 v[32:35], v[116:119], v[148:151], v[32:35]
    v_mfma_f32_16x16x32_bf16 v[36:39], v[124:127], v[132:135], v[36:39]
    v_mfma_f32_16x16x32_bf16 v[40:43], v[124:127], v[140:143], v[40:43]
    v_mfma_f32_16x16x32_bf16 v[44:47], v[124:127], v[148:151], v[44:47]
    v_mfma_f32_16x16x32_bf16 v[0:3], v[152:155], v[184:187], v[0:3]
    ds_read_b128 v[96:99], v216 offset:0
    v_mfma_f32_16x16x32_bf16 v[4:7], v[152:155], v[192:195], v[4:7]
    v_mfma_f32_16x16x32_bf16 v[8:11], v[152:155], v[200:203], v[8:11]
    ds_read_b128 v[128:131], v210 offset:0
    v_mfma_f32_16x16x32_bf16 v[12:15], v[160:163], v[184:187], v[12:15]
    v_mfma_f32_16x16x32_bf16 v[16:19], v[160:163], v[192:195], v[16:19]
    ds_read_b128 v[136:139], v210 offset:2048
    v_mfma_f32_16x16x32_bf16 v[20:23], v[160:163], v[200:203], v[20:23]
    v_mfma_f32_16x16x32_bf16 v[24:27], v[168:171], v[184:187], v[24:27]
    ds_read_b128 v[144:147], v210 offset:4096
    v_mfma_f32_16x16x32_bf16 v[28:31], v[168:171], v[192:195], v[28:31]
    v_mfma_f32_16x16x32_bf16 v[32:35], v[168:171], v[200:203], v[32:35]
    ds_read_b128 v[104:107], v216 offset:2048
    v_mfma_f32_16x16x32_bf16 v[36:39], v[176:179], v[184:187], v[36:39]
    v_mfma_f32_16x16x32_bf16 v[40:43], v[176:179], v[192:195], v[40:43]
    ds_read_b128 v[112:115], v216 offset:4096
    v_mfma_f32_16x16x32_bf16 v[44:47], v[176:179], v[200:203], v[44:47]
    v_mfma_f32_16x16x32_bf16 v[48:51], v[152:155], v[188:191], v[48:51]
    ds_read_b128 v[120:123], v216 offset:6144
    v_mfma_f32_16x16x32_bf16 v[52:55], v[152:155], v[196:199], v[52:55]
    v_mfma_f32_16x16x32_bf16 v[56:59], v[152:155], v[204:207], v[56:59]
    ds_read_b128 v[132:135], v213 offset:0
    v_mfma_f32_16x16x32_bf16 v[60:63], v[160:163], v[188:191], v[60:63]
    v_mfma_f32_16x16x32_bf16 v[64:67], v[160:163], v[196:199], v[64:67]
    ds_read_b128 v[140:143], v213 offset:2048
    v_mfma_f32_16x16x32_bf16 v[68:71], v[160:163], v[204:207], v[68:71]
    v_mfma_f32_16x16x32_bf16 v[72:75], v[168:171], v[188:191], v[72:75]
    ds_read_b128 v[148:151], v213 offset:4096
    v_mfma_f32_16x16x32_bf16 v[76:79], v[168:171], v[196:199], v[76:79]
    v_mfma_f32_16x16x32_bf16 v[80:83], v[168:171], v[204:207], v[80:83]
    ds_read_b128 v[100:103], v216 offset:1024
    v_mfma_f32_16x16x32_bf16 v[84:87], v[176:179], v[188:191], v[84:87]
    v_mfma_f32_16x16x32_bf16 v[88:91], v[176:179], v[196:199], v[88:91]
    ds_read_b128 v[108:111], v216 offset:3072
    v_mfma_f32_16x16x32_bf16 v[92:95], v[176:179], v[204:207], v[92:95]
    v_mfma_f32_16x16x32_bf16 v[48:51], v[156:159], v[184:187], v[48:51]
    ds_read_b128 v[116:119], v216 offset:5120
    v_xor_b32 v188, s34, v188
    v_xor_b32 v189, s34, v189
    v_mfma_f32_16x16x32_bf16 v[52:55], v[156:159], v[192:195], v[52:55]
    v_xor_b32 v190, s34, v190
    v_xor_b32 v191, s34, v191
    v_mfma_f32_16x16x32_bf16 v[56:59], v[156:159], v[200:203], v[56:59]
    ds_read_b128 v[124:127], v216 offset:7168
    v_xor_b32 v196, s34, v196
    v_xor_b32 v197, s34, v197
    v_mfma_f32_16x16x32_bf16 v[60:63], v[164:167], v[184:187], v[60:63]
    v_xor_b32 v198, s34, v198
    v_xor_b32 v199, s34, v199
    v_mfma_f32_16x16x32_bf16 v[64:67], v[164:167], v[192:195], v[64:67]
    v_xor_b32 v204, s34, v204
    v_xor_b32 v205, s34, v205
    v_mfma_f32_16x16x32_bf16 v[68:71], v[164:167], v[200:203], v[68:71]
    v_xor_b32 v206, s34, v206
    v_xor_b32 v207, s34, v207
    v_mfma_f32_16x16x32_bf16 v[72:75], v[172:175], v[184:187], v[72:75]
    v_mfma_f32_16x16x32_bf16 v[76:79], v[172:175], v[192:195], v[76:79]
    v_mfma_f32_16x16x32_bf16 v[80:83], v[172:175], v[200:203], v[80:83]
    v_mfma_f32_16x16x32_bf16 v[84:87], v[180:183], v[184:187], v[84:87]
    v_mfma_f32_16x16x32_bf16 v[88:91], v[180:183], v[192:195], v[88:91]
    v_mfma_f32_16x16x32_bf16 v[92:95], v[180:183], v[200:203], v[92:95]
    v_mfma_f32_16x16x32_bf16 v[0:3], v[156:159], v[188:191], v[0:3]
    v_mfma_f32_16x16x32_bf16 v[4:7], v[156:159], v[196:199], v[4:7]
    v_mfma_f32_16x16x32_bf16 v[8:11], v[156:159], v[204:207], v[8:11]
    v_mfma_f32_16x16x32_bf16 v[12:15], v[164:167], v[188:191], v[12:15]
    v_mfma_f32_16x16x32_bf16 v[16:19], v[164:167], v[196:199], v[16:19]
    s_waitcnt lgkmcnt(0)
    s_barrier
    v_mfma_f32_16x16x32_bf16 v[20:23], v[164:167], v[204:207], v[20:23]
    v_mfma_f32_16x16x32_bf16 v[24:27], v[172:175], v[188:191], v[24:27]
    v_mfma_f32_16x16x32_bf16 v[28:31], v[172:175], v[196:199], v[28:31]
    v_mfma_f32_16x16x32_bf16 v[32:35], v[172:175], v[204:207], v[32:35]
    v_mfma_f32_16x16x32_bf16 v[36:39], v[180:183], v[188:191], v[36:39]
    v_mfma_f32_16x16x32_bf16 v[40:43], v[180:183], v[196:199], v[40:43]
    v_mfma_f32_16x16x32_bf16 v[44:47], v[180:183], v[204:207], v[44:47]
    v_mfma_f32_16x16x32_bf16 v[0:3], v[96:99], v[128:131], v[0:3]
    ds_read_b128 v[152:155], v214 offset:0
    v_mfma_f32_16x16x32_bf16 v[4:7], v[96:99], v[136:139], v[4:7]
    v_mfma_f32_16x16x32_bf16 v[8:11], v[96:99], v[144:147], v[8:11]
    ds_read_b128 v[184:187], v208 offset:0
    v_mfma_f32_16x16x32_bf16 v[12:15], v[104:107], v[128:131], v[12:15]
    v_mfma_f32_16x16x32_bf16 v[16:19], v[104:107], v[136:139], v[16:19]
    ds_read_b128 v[192:195], v208 offset:2048
    v_mfma_f32_16x16x32_bf16 v[20:23], v[104:107], v[144:147], v[20:23]
    v_mfma_f32_16x16x32_bf16 v[24:27], v[112:115], v[128:131], v[24:27]
    ds_read_b128 v[200:203], v208 offset:4096
    v_mfma_f32_16x16x32_bf16 v[28:31], v[112:115], v[136:139], v[28:31]
    v_mfma_f32_16x16x32_bf16 v[32:35], v[112:115], v[144:147], v[32:35]
    ds_read_b128 v[160:163], v214 offset:2048
    v_mfma_f32_16x16x32_bf16 v[36:39], v[120:123], v[128:131], v[36:39]
    v_mfma_f32_16x16x32_bf16 v[40:43], v[120:123], v[136:139], v[40:43]
    ds_read_b128 v[168:171], v214 offset:4096
    v_mfma_f32_16x16x32_bf16 v[44:47], v[120:123], v[144:147], v[44:47]
    v_mfma_f32_16x16x32_bf16 v[48:51], v[96:99], v[132:135], v[48:51]
    ds_read_b128 v[176:179], v214 offset:6144
    v_mfma_f32_16x16x32_bf16 v[52:55], v[96:99], v[140:143], v[52:55]
    v_mfma_f32_16x16x32_bf16 v[56:59], v[96:99], v[148:151], v[56:59]
    ds_read_b128 v[188:191], v211 offset:0
    v_mfma_f32_16x16x32_bf16 v[60:63], v[104:107], v[132:135], v[60:63]
    v_mfma_f32_16x16x32_bf16 v[64:67], v[104:107], v[140:143], v[64:67]
    ds_read_b128 v[196:199], v211 offset:2048
    v_mfma_f32_16x16x32_bf16 v[68:71], v[104:107], v[148:151], v[68:71]
    v_mfma_f32_16x16x32_bf16 v[72:75], v[112:115], v[132:135], v[72:75]
    ds_read_b128 v[204:207], v211 offset:4096
    v_mfma_f32_16x16x32_bf16 v[76:79], v[112:115], v[140:143], v[76:79]
    v_mfma_f32_16x16x32_bf16 v[80:83], v[112:115], v[148:151], v[80:83]
    ds_read_b128 v[156:159], v214 offset:1024
    v_mfma_f32_16x16x32_bf16 v[84:87], v[120:123], v[132:135], v[84:87]
    v_mfma_f32_16x16x32_bf16 v[88:91], v[120:123], v[140:143], v[88:91]
    ds_read_b128 v[164:167], v214 offset:3072
    v_mfma_f32_16x16x32_bf16 v[92:95], v[120:123], v[148:151], v[92:95]
    v_mfma_f32_16x16x32_bf16 v[48:51], v[100:103], v[128:131], v[48:51]
    ds_read_b128 v[172:175], v214 offset:5120
    v_xor_b32 v132, s34, v132
    v_xor_b32 v133, s34, v133
    v_mfma_f32_16x16x32_bf16 v[52:55], v[100:103], v[136:139], v[52:55]
    v_xor_b32 v134, s34, v134
    v_xor_b32 v135, s34, v135
    v_mfma_f32_16x16x32_bf16 v[56:59], v[100:103], v[144:147], v[56:59]
    ds_read_b128 v[180:183], v214 offset:7168
    v_xor_b32 v140, s34, v140
    v_xor_b32 v141, s34, v141
    v_mfma_f32_16x16x32_bf16 v[60:63], v[108:111], v[128:131], v[60:63]
    v_xor_b32 v142, s34, v142
    v_xor_b32 v143, s34, v143
    v_mfma_f32_16x16x32_bf16 v[64:67], v[108:111], v[136:139], v[64:67]
    v_xor_b32 v148, s34, v148
    v_xor_b32 v149, s34, v149
    v_mfma_f32_16x16x32_bf16 v[68:71], v[108:111], v[144:147], v[68:71]
    v_xor_b32 v150, s34, v150
    v_xor_b32 v151, s34, v151
    v_mfma_f32_16x16x32_bf16 v[72:75], v[116:119], v[128:131], v[72:75]
    v_mfma_f32_16x16x32_bf16 v[76:79], v[116:119], v[136:139], v[76:79]
    v_mfma_f32_16x16x32_bf16 v[80:83], v[116:119], v[144:147], v[80:83]
    v_mfma_f32_16x16x32_bf16 v[84:87], v[124:127], v[128:131], v[84:87]
    v_mfma_f32_16x16x32_bf16 v[88:91], v[124:127], v[136:139], v[88:91]
    v_mfma_f32_16x16x32_bf16 v[92:95], v[124:127], v[144:147], v[92:95]
    v_mfma_f32_16x16x32_bf16 v[0:3], v[100:103], v[132:135], v[0:3]
    v_mfma_f32_16x16x32_bf16 v[4:7], v[100:103], v[140:143], v[4:7]
    v_mfma_f32_16x16x32_bf16 v[8:11], v[100:103], v[148:151], v[8:11]
    v_mfma_f32_16x16x32_bf16 v[12:15], v[108:111], v[132:135], v[12:15]
    v_mfma_f32_16x16x32_bf16 v[16:19], v[108:111], v[140:143], v[16:19]
    s_waitcnt lgkmcnt(0)
    s_barrier
    v_mfma_f32_16x16x32_bf16 v[20:23], v[108:111], v[148:151], v[20:23]
    v_mfma_f32_16x16x32_bf16 v[24:27], v[116:119], v[132:135], v[24:27]
    v_mfma_f32_16x16x32_bf16 v[28:31], v[116:119], v[140:143], v[28:31]
    v_mfma_f32_16x16x32_bf16 v[32:35], v[116:119], v[148:151], v[32:35]
    v_mfma_f32_16x16x32_bf16 v[36:39], v[124:127], v[132:135], v[36:39]
    v_mfma_f32_16x16x32_bf16 v[40:43], v[124:127], v[140:143], v[40:43]
    v_mfma_f32_16x16x32_bf16 v[44:47], v[124:127], v[148:151], v[44:47]
    v_mfma_f32_16x16x32_bf16 v[0:3], v[152:155], v[184:187], v[0:3]
    ds_read_b128 v[96:99], v214 offset:28672
    v_mfma_f32_16x16x32_bf16 v[4:7], v[152:155], v[192:195], v[4:7]
    v_mfma_f32_16x16x32_bf16 v[8:11], v[152:155], v[200:203], v[8:11]
    ds_read_b128 v[128:131], v208 offset:28672
    v_mfma_f32_16x16x32_bf16 v[12:15], v[160:163], v[184:187], v[12:15]
    v_mfma_f32_16x16x32_bf16 v[16:19], v[160:163], v[192:195], v[16:19]
    ds_read_b128 v[136:139], v208 offset:30720
    v_mfma_f32_16x16x32_bf16 v[20:23], v[160:163], v[200:203], v[20:23]
    v_mfma_f32_16x16x32_bf16 v[24:27], v[168:171], v[184:187], v[24:27]
    ds_read_b128 v[144:147], v208 offset:32768
    v_mfma_f32_16x16x32_bf16 v[28:31], v[168:171], v[192:195], v[28:31]
    v_mfma_f32_16x16x32_bf16 v[32:35], v[168:171], v[200:203], v[32:35]
    ds_read_b128 v[104:107], v214 offset:30720
    v_mfma_f32_16x16x32_bf16 v[36:39], v[176:179], v[184:187], v[36:39]
    v_mfma_f32_16x16x32_bf16 v[40:43], v[176:179], v[192:195], v[40:43]
    ds_read_b128 v[112:115], v214 offset:32768
    v_mfma_f32_16x16x32_bf16 v[44:47], v[176:179], v[200:203], v[44:47]
    v_mfma_f32_16x16x32_bf16 v[48:51], v[152:155], v[188:191], v[48:51]
    ds_read_b128 v[120:123], v214 offset:34816
    v_mfma_f32_16x16x32_bf16 v[52:55], v[152:155], v[196:199], v[52:55]
    v_mfma_f32_16x16x32_bf16 v[56:59], v[152:155], v[204:207], v[56:59]
    ds_read_b128 v[132:135], v211 offset:28672
    v_mfma_f32_16x16x32_bf16 v[60:63], v[160:163], v[188:191], v[60:63]
    v_mfma_f32_16x16x32_bf16 v[64:67], v[160:163], v[196:199], v[64:67]
    ds_read_b128 v[140:143], v211 offset:30720
    v_mfma_f32_16x16x32_bf16 v[68:71], v[160:163], v[204:207], v[68:71]
    v_mfma_f32_16x16x32_bf16 v[72:75], v[168:171], v[188:191], v[72:75]
    ds_read_b128 v[148:151], v211 offset:32768
    v_mfma_f32_16x16x32_bf16 v[76:79], v[168:171], v[196:199], v[76:79]
    v_mfma_f32_16x16x32_bf16 v[80:83], v[168:171], v[204:207], v[80:83]
    ds_read_b128 v[100:103], v214 offset:29696
    v_mfma_f32_16x16x32_bf16 v[84:87], v[176:179], v[188:191], v[84:87]
    v_mfma_f32_16x16x32_bf16 v[88:91], v[176:179], v[196:199], v[88:91]
    ds_read_b128 v[108:111], v214 offset:31744
    v_mfma_f32_16x16x32_bf16 v[92:95], v[176:179], v[204:207], v[92:95]
    v_mfma_f32_16x16x32_bf16 v[48:51], v[156:159], v[184:187], v[48:51]
    ds_read_b128 v[116:119], v214 offset:33792
    v_xor_b32 v188, s34, v188
    v_xor_b32 v189, s34, v189
    v_mfma_f32_16x16x32_bf16 v[52:55], v[156:159], v[192:195], v[52:55]
    v_xor_b32 v190, s34, v190
    v_xor_b32 v191, s34, v191
    v_mfma_f32_16x16x32_bf16 v[56:59], v[156:159], v[200:203], v[56:59]
    ds_read_b128 v[124:127], v214 offset:35840
    v_xor_b32 v196, s34, v196
    v_xor_b32 v197, s34, v197
    v_mfma_f32_16x16x32_bf16 v[60:63], v[164:167], v[184:187], v[60:63]
    v_xor_b32 v198, s34, v198
    v_xor_b32 v199, s34, v199
    v_mfma_f32_16x16x32_bf16 v[64:67], v[164:167], v[192:195], v[64:67]
    v_xor_b32 v204, s34, v204
    v_xor_b32 v205, s34, v205
    v_mfma_f32_16x16x32_bf16 v[68:71], v[164:167], v[200:203], v[68:71]
    v_xor_b32 v206, s34, v206
    v_xor_b32 v207, s34, v207
    v_mfma_f32_16x16x32_bf16 v[72:75], v[172:175], v[184:187], v[72:75]
    v_mfma_f32_16x16x32_bf16 v[76:79], v[172:175], v[192:195], v[76:79]
    v_mfma_f32_16x16x32_bf16 v[80:83], v[172:175], v[200:203], v[80:83]
    v_mfma_f32_16x16x32_bf16 v[84:87], v[180:183], v[184:187], v[84:87]
    v_mfma_f32_16x16x32_bf16 v[88:91], v[180:183], v[192:195], v[88:91]
    v_mfma_f32_16x16x32_bf16 v[92:95], v[180:183], v[200:203], v[92:95]
    v_mfma_f32_16x16x32_bf16 v[0:3], v[156:159], v[188:191], v[0:3]
    v_mfma_f32_16x16x32_bf16 v[4:7], v[156:159], v[196:199], v[4:7]
    v_mfma_f32_16x16x32_bf16 v[8:11], v[156:159], v[204:207], v[8:11]
    v_mfma_f32_16x16x32_bf16 v[12:15], v[164:167], v[188:191], v[12:15]
    v_mfma_f32_16x16x32_bf16 v[16:19], v[164:167], v[196:199], v[16:19]
    s_waitcnt lgkmcnt(0)
    s_barrier
    v_mfma_f32_16x16x32_bf16 v[20:23], v[164:167], v[204:207], v[20:23]
    v_mfma_f32_16x16x32_bf16 v[24:27], v[172:175], v[188:191], v[24:27]
    v_mfma_f32_16x16x32_bf16 v[28:31], v[172:175], v[196:199], v[28:31]
    v_mfma_f32_16x16x32_bf16 v[32:35], v[172:175], v[204:207], v[32:35]
    v_mfma_f32_16x16x32_bf16 v[36:39], v[180:183], v[188:191], v[36:39]
    v_mfma_f32_16x16x32_bf16 v[40:43], v[180:183], v[196:199], v[40:43]
    v_mfma_f32_16x16x32_bf16 v[44:47], v[180:183], v[204:207], v[44:47]
    v_mfma_f32_16x16x32_bf16 v[0:3], v[96:99], v[128:131], v[0:3]
    ds_read_b128 v[152:155], v215 offset:0
    v_mfma_f32_16x16x32_bf16 v[4:7], v[96:99], v[136:139], v[4:7]
    v_mfma_f32_16x16x32_bf16 v[8:11], v[96:99], v[144:147], v[8:11]
    ds_read_b128 v[184:187], v209 offset:0
    v_mfma_f32_16x16x32_bf16 v[12:15], v[104:107], v[128:131], v[12:15]
    v_mfma_f32_16x16x32_bf16 v[16:19], v[104:107], v[136:139], v[16:19]
    ds_read_b128 v[192:195], v209 offset:2048
    v_mfma_f32_16x16x32_bf16 v[20:23], v[104:107], v[144:147], v[20:23]
    v_mfma_f32_16x16x32_bf16 v[24:27], v[112:115], v[128:131], v[24:27]
    ds_read_b128 v[200:203], v209 offset:4096
    v_mfma_f32_16x16x32_bf16 v[28:31], v[112:115], v[136:139], v[28:31]
    v_mfma_f32_16x16x32_bf16 v[32:35], v[112:115], v[144:147], v[32:35]
    ds_read_b128 v[160:163], v215 offset:2048
    v_mfma_f32_16x16x32_bf16 v[36:39], v[120:123], v[128:131], v[36:39]
    v_mfma_f32_16x16x32_bf16 v[40:43], v[120:123], v[136:139], v[40:43]
    ds_read_b128 v[168:171], v215 offset:4096
    v_mfma_f32_16x16x32_bf16 v[44:47], v[120:123], v[144:147], v[44:47]
    v_mfma_f32_16x16x32_bf16 v[48:51], v[96:99], v[132:135], v[48:51]
    ds_read_b128 v[176:179], v215 offset:6144
    v_mfma_f32_16x16x32_bf16 v[52:55], v[96:99], v[140:143], v[52:55]
    v_mfma_f32_16x16x32_bf16 v[56:59], v[96:99], v[148:151], v[56:59]
    ds_read_b128 v[188:191], v212 offset:0
    v_mfma_f32_16x16x32_bf16 v[60:63], v[104:107], v[132:135], v[60:63]
    v_mfma_f32_16x16x32_bf16 v[64:67], v[104:107], v[140:143], v[64:67]
    ds_read_b128 v[196:199], v212 offset:2048
    v_mfma_f32_16x16x32_bf16 v[68:71], v[104:107], v[148:151], v[68:71]
    v_mfma_f32_16x16x32_bf16 v[72:75], v[112:115], v[132:135], v[72:75]
    ds_read_b128 v[204:207], v212 offset:4096
    v_mfma_f32_16x16x32_bf16 v[76:79], v[112:115], v[140:143], v[76:79]
    v_mfma_f32_16x16x32_bf16 v[80:83], v[112:115], v[148:151], v[80:83]
    ds_read_b128 v[156:159], v215 offset:1024
    v_mfma_f32_16x16x32_bf16 v[84:87], v[120:123], v[132:135], v[84:87]
    v_mfma_f32_16x16x32_bf16 v[88:91], v[120:123], v[140:143], v[88:91]
    ds_read_b128 v[164:167], v215 offset:3072
    v_mfma_f32_16x16x32_bf16 v[92:95], v[120:123], v[148:151], v[92:95]
    v_mfma_f32_16x16x32_bf16 v[48:51], v[100:103], v[128:131], v[48:51]
    ds_read_b128 v[172:175], v215 offset:5120
    v_xor_b32 v132, s34, v132
    v_xor_b32 v133, s34, v133
    v_mfma_f32_16x16x32_bf16 v[52:55], v[100:103], v[136:139], v[52:55]
    v_xor_b32 v134, s34, v134
    v_xor_b32 v135, s34, v135
    v_mfma_f32_16x16x32_bf16 v[56:59], v[100:103], v[144:147], v[56:59]
    ds_read_b128 v[180:183], v215 offset:7168
    v_xor_b32 v140, s34, v140
    v_xor_b32 v141, s34, v141
    v_mfma_f32_16x16x32_bf16 v[60:63], v[108:111], v[128:131], v[60:63]
    v_xor_b32 v142, s34, v142
    v_xor_b32 v143, s34, v143
    v_mfma_f32_16x16x32_bf16 v[64:67], v[108:111], v[136:139], v[64:67]
    v_xor_b32 v148, s34, v148
    v_xor_b32 v149, s34, v149
    v_mfma_f32_16x16x32_bf16 v[68:71], v[108:111], v[144:147], v[68:71]
    v_xor_b32 v150, s34, v150
    v_xor_b32 v151, s34, v151
    v_mfma_f32_16x16x32_bf16 v[72:75], v[116:119], v[128:131], v[72:75]
    v_mfma_f32_16x16x32_bf16 v[76:79], v[116:119], v[136:139], v[76:79]
    v_mfma_f32_16x16x32_bf16 v[80:83], v[116:119], v[144:147], v[80:83]
    v_mfma_f32_16x16x32_bf16 v[84:87], v[124:127], v[128:131], v[84:87]
    v_mfma_f32_16x16x32_bf16 v[88:91], v[124:127], v[136:139], v[88:91]
    v_mfma_f32_16x16x32_bf16 v[92:95], v[124:127], v[144:147], v[92:95]
    v_mfma_f32_16x16x32_bf16 v[0:3], v[100:103], v[132:135], v[0:3]
    v_mfma_f32_16x16x32_bf16 v[4:7], v[100:103], v[140:143], v[4:7]
    v_mfma_f32_16x16x32_bf16 v[8:11], v[100:103], v[148:151], v[8:11]
    v_mfma_f32_16x16x32_bf16 v[12:15], v[108:111], v[132:135], v[12:15]
    v_mfma_f32_16x16x32_bf16 v[16:19], v[108:111], v[140:143], v[16:19]
    s_waitcnt lgkmcnt(0)
    s_barrier
    v_mfma_f32_16x16x32_bf16 v[20:23], v[108:111], v[148:151], v[20:23]
    v_mfma_f32_16x16x32_bf16 v[24:27], v[116:119], v[132:135], v[24:27]
    v_mfma_f32_16x16x32_bf16 v[28:31], v[116:119], v[140:143], v[28:31]
    v_mfma_f32_16x16x32_bf16 v[32:35], v[116:119], v[148:151], v[32:35]
    v_mfma_f32_16x16x32_bf16 v[36:39], v[124:127], v[132:135], v[36:39]
    v_mfma_f32_16x16x32_bf16 v[40:43], v[124:127], v[140:143], v[40:43]
    v_mfma_f32_16x16x32_bf16 v[44:47], v[124:127], v[148:151], v[44:47]
    v_mfma_f32_16x16x32_bf16 v[0:3], v[152:155], v[184:187], v[0:3]
    ds_read_b128 v[96:99], v215 offset:28672
    v_mfma_f32_16x16x32_bf16 v[4:7], v[152:155], v[192:195], v[4:7]
    v_mfma_f32_16x16x32_bf16 v[8:11], v[152:155], v[200:203], v[8:11]
    ds_read_b128 v[128:131], v209 offset:28672
    v_mfma_f32_16x16x32_bf16 v[12:15], v[160:163], v[184:187], v[12:15]
    v_mfma_f32_16x16x32_bf16 v[16:19], v[160:163], v[192:195], v[16:19]
    ds_read_b128 v[136:139], v209 offset:30720
    v_mfma_f32_16x16x32_bf16 v[20:23], v[160:163], v[200:203], v[20:23]
    v_mfma_f32_16x16x32_bf16 v[24:27], v[168:171], v[184:187], v[24:27]
    ds_read_b128 v[144:147], v209 offset:32768
    v_mfma_f32_16x16x32_bf16 v[28:31], v[168:171], v[192:195], v[28:31]
    v_mfma_f32_16x16x32_bf16 v[32:35], v[168:171], v[200:203], v[32:35]
    ds_read_b128 v[104:107], v215 offset:30720
    v_mfma_f32_16x16x32_bf16 v[36:39], v[176:179], v[184:187], v[36:39]
    v_mfma_f32_16x16x32_bf16 v[40:43], v[176:179], v[192:195], v[40:43]
    ds_read_b128 v[112:115], v215 offset:32768
    v_mfma_f32_16x16x32_bf16 v[44:47], v[176:179], v[200:203], v[44:47]
    v_mfma_f32_16x16x32_bf16 v[48:51], v[152:155], v[188:191], v[48:51]
    ds_read_b128 v[120:123], v215 offset:34816
    v_mfma_f32_16x16x32_bf16 v[52:55], v[152:155], v[196:199], v[52:55]
    v_mfma_f32_16x16x32_bf16 v[56:59], v[152:155], v[204:207], v[56:59]
    ds_read_b128 v[132:135], v212 offset:28672
    v_mfma_f32_16x16x32_bf16 v[60:63], v[160:163], v[188:191], v[60:63]
    v_mfma_f32_16x16x32_bf16 v[64:67], v[160:163], v[196:199], v[64:67]
    ds_read_b128 v[140:143], v212 offset:30720
    v_mfma_f32_16x16x32_bf16 v[68:71], v[160:163], v[204:207], v[68:71]
    v_mfma_f32_16x16x32_bf16 v[72:75], v[168:171], v[188:191], v[72:75]
    ds_read_b128 v[148:151], v212 offset:32768
    v_mfma_f32_16x16x32_bf16 v[76:79], v[168:171], v[196:199], v[76:79]
    v_mfma_f32_16x16x32_bf16 v[80:83], v[168:171], v[204:207], v[80:83]
    ds_read_b128 v[100:103], v215 offset:29696
    v_mfma_f32_16x16x32_bf16 v[84:87], v[176:179], v[188:191], v[84:87]
    v_mfma_f32_16x16x32_bf16 v[88:91], v[176:179], v[196:199], v[88:91]
    ds_read_b128 v[108:111], v215 offset:31744
    v_mfma_f32_16x16x32_bf16 v[92:95], v[176:179], v[204:207], v[92:95]
    v_mfma_f32_16x16x32_bf16 v[48:51], v[156:159], v[184:187], v[48:51]
    ds_read_b128 v[116:119], v215 offset:33792
    v_xor_b32 v188, s34, v188
    v_xor_b32 v189, s34, v189
    v_mfma_f32_16x16x32_bf16 v[52:55], v[156:159], v[192:195], v[52:55]
    v_xor_b32 v190, s34, v190
    v_xor_b32 v191, s34, v191
    v_mfma_f32_16x16x32_bf16 v[56:59], v[156:159], v[200:203], v[56:59]
    ds_read_b128 v[124:127], v215 offset:35840
    v_xor_b32 v196, s34, v196
    v_xor_b32 v197, s34, v197
    v_mfma_f32_16x16x32_bf16 v[60:63], v[164:167], v[184:187], v[60:63]
    v_xor_b32 v198, s34, v198
    v_xor_b32 v199, s34, v199
    v_mfma_f32_16x16x32_bf16 v[64:67], v[164:167], v[192:195], v[64:67]
    v_xor_b32 v204, s34, v204
    v_xor_b32 v205, s34, v205
    v_mfma_f32_16x16x32_bf16 v[68:71], v[164:167], v[200:203], v[68:71]
    v_xor_b32 v206, s34, v206
    v_xor_b32 v207, s34, v207
    v_mfma_f32_16x16x32_bf16 v[72:75], v[172:175], v[184:187], v[72:75]
    v_mfma_f32_16x16x32_bf16 v[76:79], v[172:175], v[192:195], v[76:79]
    v_mfma_f32_16x16x32_bf16 v[80:83], v[172:175], v[200:203], v[80:83]
    v_mfma_f32_16x16x32_bf16 v[84:87], v[180:183], v[184:187], v[84:87]
    v_mfma_f32_16x16x32_bf16 v[88:91], v[180:183], v[192:195], v[88:91]
    v_mfma_f32_16x16x32_bf16 v[92:95], v[180:183], v[200:203], v[92:95]
    v_mfma_f32_16x16x32_bf16 v[0:3], v[156:159], v[188:191], v[0:3]
    v_mfma_f32_16x16x32_bf16 v[4:7], v[156:159], v[196:199], v[4:7]
    v_mfma_f32_16x16x32_bf16 v[8:11], v[156:159], v[204:207], v[8:11]
    v_mfma_f32_16x16x32_bf16 v[12:15], v[164:167], v[188:191], v[12:15]
    v_mfma_f32_16x16x32_bf16 v[16:19], v[164:167], v[196:199], v[16:19]
    s_waitcnt lgkmcnt(0)
    s_barrier
    v_mfma_f32_16x16x32_bf16 v[20:23], v[164:167], v[204:207], v[20:23]
    v_mfma_f32_16x16x32_bf16 v[24:27], v[172:175], v[188:191], v[24:27]
    v_mfma_f32_16x16x32_bf16 v[28:31], v[172:175], v[196:199], v[28:31]
    v_mfma_f32_16x16x32_bf16 v[32:35], v[172:175], v[204:207], v[32:35]
    v_mfma_f32_16x16x32_bf16 v[36:39], v[180:183], v[188:191], v[36:39]
    v_mfma_f32_16x16x32_bf16 v[40:43], v[180:183], v[196:199], v[40:43]
    v_mfma_f32_16x16x32_bf16 v[44:47], v[180:183], v[204:207], v[44:47]
    v_mfma_f32_16x16x32_bf16 v[0:3], v[96:99], v[128:131], v[0:3]
    ds_read_b128 v[152:155], v216 offset:0
    v_mfma_f32_16x16x32_bf16 v[4:7], v[96:99], v[136:139], v[4:7]
    v_mfma_f32_16x16x32_bf16 v[8:11], v[96:99], v[144:147], v[8:11]
    ds_read_b128 v[184:187], v210 offset:0
    v_mfma_f32_16x16x32_bf16 v[12:15], v[104:107], v[128:131], v[12:15]
    v_mfma_f32_16x16x32_bf16 v[16:19], v[104:107], v[136:139], v[16:19]
    ds_read_b128 v[192:195], v210 offset:2048
    v_mfma_f32_16x16x32_bf16 v[20:23], v[104:107], v[144:147], v[20:23]
    v_mfma_f32_16x16x32_bf16 v[24:27], v[112:115], v[128:131], v[24:27]
    ds_read_b128 v[200:203], v210 offset:4096
    v_mfma_f32_16x16x32_bf16 v[28:31], v[112:115], v[136:139], v[28:31]
    v_mfma_f32_16x16x32_bf16 v[32:35], v[112:115], v[144:147], v[32:35]
    ds_read_b128 v[160:163], v216 offset:2048
    v_mfma_f32_16x16x32_bf16 v[36:39], v[120:123], v[128:131], v[36:39]
    v_mfma_f32_16x16x32_bf16 v[40:43], v[120:123], v[136:139], v[40:43]
    ds_read_b128 v[168:171], v216 offset:4096
    v_mfma_f32_16x16x32_bf16 v[44:47], v[120:123], v[144:147], v[44:47]
    v_mfma_f32_16x16x32_bf16 v[48:51], v[96:99], v[132:135], v[48:51]
    ds_read_b128 v[176:179], v216 offset:6144
    v_mfma_f32_16x16x32_bf16 v[52:55], v[96:99], v[140:143], v[52:55]
    v_mfma_f32_16x16x32_bf16 v[56:59], v[96:99], v[148:151], v[56:59]
    ds_read_b128 v[188:191], v213 offset:0
    v_mfma_f32_16x16x32_bf16 v[60:63], v[104:107], v[132:135], v[60:63]
    v_mfma_f32_16x16x32_bf16 v[64:67], v[104:107], v[140:143], v[64:67]
    ds_read_b128 v[196:199], v213 offset:2048
    v_mfma_f32_16x16x32_bf16 v[68:71], v[104:107], v[148:151], v[68:71]
    v_mfma_f32_16x16x32_bf16 v[72:75], v[112:115], v[132:135], v[72:75]
    ds_read_b128 v[204:207], v213 offset:4096
    v_mfma_f32_16x16x32_bf16 v[76:79], v[112:115], v[140:143], v[76:79]
    v_mfma_f32_16x16x32_bf16 v[80:83], v[112:115], v[148:151], v[80:83]
    ds_read_b128 v[156:159], v216 offset:1024
    v_mfma_f32_16x16x32_bf16 v[84:87], v[120:123], v[132:135], v[84:87]
    v_mfma_f32_16x16x32_bf16 v[88:91], v[120:123], v[140:143], v[88:91]
    ds_read_b128 v[164:167], v216 offset:3072
    v_mfma_f32_16x16x32_bf16 v[92:95], v[120:123], v[148:151], v[92:95]
    v_mfma_f32_16x16x32_bf16 v[48:51], v[100:103], v[128:131], v[48:51]
    ds_read_b128 v[172:175], v216 offset:5120
    v_xor_b32 v132, s34, v132
    v_xor_b32 v133, s34, v133
    v_mfma_f32_16x16x32_bf16 v[52:55], v[100:103], v[136:139], v[52:55]
    v_xor_b32 v134, s34, v134
    v_xor_b32 v135, s34, v135
    v_mfma_f32_16x16x32_bf16 v[56:59], v[100:103], v[144:147], v[56:59]
    ds_read_b128 v[180:183], v216 offset:7168
    v_xor_b32 v140, s34, v140
    v_xor_b32 v141, s34, v141
    v_mfma_f32_16x16x32_bf16 v[60:63], v[108:111], v[128:131], v[60:63]
    v_xor_b32 v142, s34, v142
    v_xor_b32 v143, s34, v143
    v_mfma_f32_16x16x32_bf16 v[64:67], v[108:111], v[136:139], v[64:67]
    v_xor_b32 v148, s34, v148
    v_xor_b32 v149, s34, v149
    v_mfma_f32_16x16x32_bf16 v[68:71], v[108:111], v[144:147], v[68:71]
    v_xor_b32 v150, s34, v150
    v_xor_b32 v151, s34, v151
    v_mfma_f32_16x16x32_bf16 v[72:75], v[116:119], v[128:131], v[72:75]
    v_mfma_f32_16x16x32_bf16 v[76:79], v[116:119], v[136:139], v[76:79]
    v_mfma_f32_16x16x32_bf16 v[80:83], v[116:119], v[144:147], v[80:83]
    v_mfma_f32_16x16x32_bf16 v[84:87], v[124:127], v[128:131], v[84:87]
    v_mfma_f32_16x16x32_bf16 v[88:91], v[124:127], v[136:139], v[88:91]
    v_mfma_f32_16x16x32_bf16 v[92:95], v[124:127], v[144:147], v[92:95]
    v_mfma_f32_16x16x32_bf16 v[0:3], v[100:103], v[132:135], v[0:3]
    v_mfma_f32_16x16x32_bf16 v[4:7], v[100:103], v[140:143], v[4:7]
    v_mfma_f32_16x16x32_bf16 v[8:11], v[100:103], v[148:151], v[8:11]
    v_mfma_f32_16x16x32_bf16 v[12:15], v[108:111], v[132:135], v[12:15]
    v_mfma_f32_16x16x32_bf16 v[16:19], v[108:111], v[140:143], v[16:19]
    s_waitcnt lgkmcnt(0)
    s_barrier
    v_mfma_f32_16x16x32_bf16 v[20:23], v[108:111], v[148:151], v[20:23]
    v_mfma_f32_16x16x32_bf16 v[24:27], v[116:119], v[132:135], v[24:27]
    v_mfma_f32_16x16x32_bf16 v[28:31], v[116:119], v[140:143], v[28:31]
    v_mfma_f32_16x16x32_bf16 v[32:35], v[116:119], v[148:151], v[32:35]
    v_mfma_f32_16x16x32_bf16 v[36:39], v[124:127], v[132:135], v[36:39]
    v_mfma_f32_16x16x32_bf16 v[40:43], v[124:127], v[140:143], v[40:43]
    v_mfma_f32_16x16x32_bf16 v[44:47], v[124:127], v[148:151], v[44:47]
    v_mfma_f32_16x16x32_bf16 v[0:3], v[152:155], v[184:187], v[0:3]
    ds_read_b128 v[96:99], v214 offset:0
    v_mfma_f32_16x16x32_bf16 v[4:7], v[152:155], v[192:195], v[4:7]
    v_mfma_f32_16x16x32_bf16 v[8:11], v[152:155], v[200:203], v[8:11]
    ds_read_b128 v[128:131], v208 offset:0
    v_mfma_f32_16x16x32_bf16 v[12:15], v[160:163], v[184:187], v[12:15]
    v_mfma_f32_16x16x32_bf16 v[16:19], v[160:163], v[192:195], v[16:19]
    ds_read_b128 v[136:139], v208 offset:2048
    v_mfma_f32_16x16x32_bf16 v[20:23], v[160:163], v[200:203], v[20:23]
    v_mfma_f32_16x16x32_bf16 v[24:27], v[168:171], v[184:187], v[24:27]
    ds_read_b128 v[144:147], v208 offset:4096
    v_mfma_f32_16x16x32_bf16 v[28:31], v[168:171], v[192:195], v[28:31]
    v_mfma_f32_16x16x32_bf16 v[32:35], v[168:171], v[200:203], v[32:35]
    ds_read_b128 v[104:107], v214 offset:2048
    v_mfma_f32_16x16x32_bf16 v[36:39], v[176:179], v[184:187], v[36:39]
    v_mfma_f32_16x16x32_bf16 v[40:43], v[176:179], v[192:195], v[40:43]
    ds_read_b128 v[112:115], v214 offset:4096
    v_mfma_f32_16x16x32_bf16 v[44:47], v[176:179], v[200:203], v[44:47]
    v_mfma_f32_16x16x32_bf16 v[48:51], v[152:155], v[188:191], v[48:51]
    ds_read_b128 v[120:123], v214 offset:6144
    v_mfma_f32_16x16x32_bf16 v[52:55], v[152:155], v[196:199], v[52:55]
    v_mfma_f32_16x16x32_bf16 v[56:59], v[152:155], v[204:207], v[56:59]
    ds_read_b128 v[132:135], v211 offset:0
    v_mfma_f32_16x16x32_bf16 v[60:63], v[160:163], v[188:191], v[60:63]
    v_mfma_f32_16x16x32_bf16 v[64:67], v[160:163], v[196:199], v[64:67]
    ds_read_b128 v[140:143], v211 offset:2048
    v_mfma_f32_16x16x32_bf16 v[68:71], v[160:163], v[204:207], v[68:71]
    v_mfma_f32_16x16x32_bf16 v[72:75], v[168:171], v[188:191], v[72:75]
    ds_read_b128 v[148:151], v211 offset:4096
    v_mfma_f32_16x16x32_bf16 v[76:79], v[168:171], v[196:199], v[76:79]
    v_mfma_f32_16x16x32_bf16 v[80:83], v[168:171], v[204:207], v[80:83]
    ds_read_b128 v[100:103], v214 offset:1024
    v_mfma_f32_16x16x32_bf16 v[84:87], v[176:179], v[188:191], v[84:87]
    v_mfma_f32_16x16x32_bf16 v[88:91], v[176:179], v[196:199], v[88:91]
    ds_read_b128 v[108:111], v214 offset:3072
    v_mfma_f32_16x16x32_bf16 v[92:95], v[176:179], v[204:207], v[92:95]
    v_mfma_f32_16x16x32_bf16 v[48:51], v[156:159], v[184:187], v[48:51]
    ds_read_b128 v[116:119], v214 offset:5120
    v_xor_b32 v188, s34, v188
    v_xor_b32 v189, s34, v189
    v_mfma_f32_16x16x32_bf16 v[52:55], v[156:159], v[192:195], v[52:55]
    v_xor_b32 v190, s34, v190
    v_xor_b32 v191, s34, v191
    v_mfma_f32_16x16x32_bf16 v[56:59], v[156:159], v[200:203], v[56:59]
    ds_read_b128 v[124:127], v214 offset:7168
    v_xor_b32 v196, s34, v196
    v_xor_b32 v197, s34, v197
    v_mfma_f32_16x16x32_bf16 v[60:63], v[164:167], v[184:187], v[60:63]
    v_xor_b32 v198, s34, v198
    v_xor_b32 v199, s34, v199
    v_mfma_f32_16x16x32_bf16 v[64:67], v[164:167], v[192:195], v[64:67]
    v_xor_b32 v204, s34, v204
    v_xor_b32 v205, s34, v205
    v_mfma_f32_16x16x32_bf16 v[68:71], v[164:167], v[200:203], v[68:71]
    v_xor_b32 v206, s34, v206
    v_xor_b32 v207, s34, v207
    v_mfma_f32_16x16x32_bf16 v[72:75], v[172:175], v[184:187], v[72:75]
    v_mfma_f32_16x16x32_bf16 v[76:79], v[172:175], v[192:195], v[76:79]
    v_mfma_f32_16x16x32_bf16 v[80:83], v[172:175], v[200:203], v[80:83]
    v_mfma_f32_16x16x32_bf16 v[84:87], v[180:183], v[184:187], v[84:87]
    v_mfma_f32_16x16x32_bf16 v[88:91], v[180:183], v[192:195], v[88:91]
    v_mfma_f32_16x16x32_bf16 v[92:95], v[180:183], v[200:203], v[92:95]
    v_mfma_f32_16x16x32_bf16 v[0:3], v[156:159], v[188:191], v[0:3]
    v_mfma_f32_16x16x32_bf16 v[4:7], v[156:159], v[196:199], v[4:7]
    v_mfma_f32_16x16x32_bf16 v[8:11], v[156:159], v[204:207], v[8:11]
    v_mfma_f32_16x16x32_bf16 v[12:15], v[164:167], v[188:191], v[12:15]
    v_mfma_f32_16x16x32_bf16 v[16:19], v[164:167], v[196:199], v[16:19]
    s_waitcnt lgkmcnt(0)
    s_barrier
    v_mfma_f32_16x16x32_bf16 v[20:23], v[164:167], v[204:207], v[20:23]
    v_mfma_f32_16x16x32_bf16 v[24:27], v[172:175], v[188:191], v[24:27]
    v_mfma_f32_16x16x32_bf16 v[28:31], v[172:175], v[196:199], v[28:31]
    v_mfma_f32_16x16x32_bf16 v[32:35], v[172:175], v[204:207], v[32:35]
    v_mfma_f32_16x16x32_bf16 v[36:39], v[180:183], v[188:191], v[36:39]
    v_mfma_f32_16x16x32_bf16 v[40:43], v[180:183], v[196:199], v[40:43]
    v_mfma_f32_16x16x32_bf16 v[44:47], v[180:183], v[204:207], v[44:47]
    v_mfma_f32_16x16x32_bf16 v[0:3], v[96:99], v[128:131], v[0:3]
    ds_read_b128 v[152:155], v214 offset:28672
    v_mfma_f32_16x16x32_bf16 v[4:7], v[96:99], v[136:139], v[4:7]
    v_mfma_f32_16x16x32_bf16 v[8:11], v[96:99], v[144:147], v[8:11]
    ds_read_b128 v[184:187], v208 offset:28672
    v_mfma_f32_16x16x32_bf16 v[12:15], v[104:107], v[128:131], v[12:15]
    v_mfma_f32_16x16x32_bf16 v[16:19], v[104:107], v[136:139], v[16:19]
    ds_read_b128 v[192:195], v208 offset:30720
    v_mfma_f32_16x16x32_bf16 v[20:23], v[104:107], v[144:147], v[20:23]
    v_mfma_f32_16x16x32_bf16 v[24:27], v[112:115], v[128:131], v[24:27]
    ds_read_b128 v[200:203], v208 offset:32768
    v_mfma_f32_16x16x32_bf16 v[28:31], v[112:115], v[136:139], v[28:31]
    v_mfma_f32_16x16x32_bf16 v[32:35], v[112:115], v[144:147], v[32:35]
    ds_read_b128 v[160:163], v214 offset:30720
    v_mfma_f32_16x16x32_bf16 v[36:39], v[120:123], v[128:131], v[36:39]
    v_mfma_f32_16x16x32_bf16 v[40:43], v[120:123], v[136:139], v[40:43]
    ds_read_b128 v[168:171], v214 offset:32768
    v_mfma_f32_16x16x32_bf16 v[44:47], v[120:123], v[144:147], v[44:47]
    v_mfma_f32_16x16x32_bf16 v[48:51], v[96:99], v[132:135], v[48:51]
    ds_read_b128 v[176:179], v214 offset:34816
    v_mfma_f32_16x16x32_bf16 v[52:55], v[96:99], v[140:143], v[52:55]
    v_mfma_f32_16x16x32_bf16 v[56:59], v[96:99], v[148:151], v[56:59]
    ds_read_b128 v[188:191], v211 offset:28672
    v_mfma_f32_16x16x32_bf16 v[60:63], v[104:107], v[132:135], v[60:63]
    v_mfma_f32_16x16x32_bf16 v[64:67], v[104:107], v[140:143], v[64:67]
    ds_read_b128 v[196:199], v211 offset:30720
    v_mfma_f32_16x16x32_bf16 v[68:71], v[104:107], v[148:151], v[68:71]
    v_mfma_f32_16x16x32_bf16 v[72:75], v[112:115], v[132:135], v[72:75]
    ds_read_b128 v[204:207], v211 offset:32768
    v_mfma_f32_16x16x32_bf16 v[76:79], v[112:115], v[140:143], v[76:79]
    v_mfma_f32_16x16x32_bf16 v[80:83], v[112:115], v[148:151], v[80:83]
    ds_read_b128 v[156:159], v214 offset:29696
    v_mfma_f32_16x16x32_bf16 v[84:87], v[120:123], v[132:135], v[84:87]
    v_mfma_f32_16x16x32_bf16 v[88:91], v[120:123], v[140:143], v[88:91]
    ds_read_b128 v[164:167], v214 offset:31744
    v_mfma_f32_16x16x32_bf16 v[92:95], v[120:123], v[148:151], v[92:95]
    v_mfma_f32_16x16x32_bf16 v[48:51], v[100:103], v[128:131], v[48:51]
    ds_read_b128 v[172:175], v214 offset:33792
    v_xor_b32 v132, s34, v132
    v_xor_b32 v133, s34, v133
    v_mfma_f32_16x16x32_bf16 v[52:55], v[100:103], v[136:139], v[52:55]
    v_xor_b32 v134, s34, v134
    v_xor_b32 v135, s34, v135
    v_mfma_f32_16x16x32_bf16 v[56:59], v[100:103], v[144:147], v[56:59]
    ds_read_b128 v[180:183], v214 offset:35840
    v_xor_b32 v140, s34, v140
    v_xor_b32 v141, s34, v141
    v_mfma_f32_16x16x32_bf16 v[60:63], v[108:111], v[128:131], v[60:63]
    v_xor_b32 v142, s34, v142
    v_xor_b32 v143, s34, v143
    v_mfma_f32_16x16x32_bf16 v[64:67], v[108:111], v[136:139], v[64:67]
    v_xor_b32 v148, s34, v148
    v_xor_b32 v149, s34, v149
    v_mfma_f32_16x16x32_bf16 v[68:71], v[108:111], v[144:147], v[68:71]
    v_xor_b32 v150, s34, v150
    v_xor_b32 v151, s34, v151
    v_mfma_f32_16x16x32_bf16 v[72:75], v[116:119], v[128:131], v[72:75]
    v_mfma_f32_16x16x32_bf16 v[76:79], v[116:119], v[136:139], v[76:79]
    v_mfma_f32_16x16x32_bf16 v[80:83], v[116:119], v[144:147], v[80:83]
    v_mfma_f32_16x16x32_bf16 v[84:87], v[124:127], v[128:131], v[84:87]
    v_mfma_f32_16x16x32_bf16 v[88:91], v[124:127], v[136:139], v[88:91]
    v_mfma_f32_16x16x32_bf16 v[92:95], v[124:127], v[144:147], v[92:95]
    v_mfma_f32_16x16x32_bf16 v[0:3], v[100:103], v[132:135], v[0:3]
    v_mfma_f32_16x16x32_bf16 v[4:7], v[100:103], v[140:143], v[4:7]
    v_mfma_f32_16x16x32_bf16 v[8:11], v[100:103], v[148:151], v[8:11]
    v_mfma_f32_16x16x32_bf16 v[12:15], v[108:111], v[132:135], v[12:15]
    v_mfma_f32_16x16x32_bf16 v[16:19], v[108:111], v[140:143], v[16:19]
    s_waitcnt lgkmcnt(0)
    s_barrier
    v_mfma_f32_16x16x32_bf16 v[20:23], v[108:111], v[148:151], v[20:23]
    v_mfma_f32_16x16x32_bf16 v[24:27], v[116:119], v[132:135], v[24:27]
    v_mfma_f32_16x16x32_bf16 v[28:31], v[116:119], v[140:143], v[28:31]
    v_mfma_f32_16x16x32_bf16 v[32:35], v[116:119], v[148:151], v[32:35]
    v_mfma_f32_16x16x32_bf16 v[36:39], v[124:127], v[132:135], v[36:39]
    v_mfma_f32_16x16x32_bf16 v[40:43], v[124:127], v[140:143], v[40:43]
    v_mfma_f32_16x16x32_bf16 v[44:47], v[124:127], v[148:151], v[44:47]
    v_mfma_f32_16x16x32_bf16 v[0:3], v[152:155], v[184:187], v[0:3]
    ds_read_b128 v[96:99], v215 offset:0
    v_mfma_f32_16x16x32_bf16 v[4:7], v[152:155], v[192:195], v[4:7]
    v_mfma_f32_16x16x32_bf16 v[8:11], v[152:155], v[200:203], v[8:11]
    ds_read_b128 v[128:131], v209 offset:0
    v_mfma_f32_16x16x32_bf16 v[12:15], v[160:163], v[184:187], v[12:15]
    v_mfma_f32_16x16x32_bf16 v[16:19], v[160:163], v[192:195], v[16:19]
    ds_read_b128 v[136:139], v209 offset:2048
    v_mfma_f32_16x16x32_bf16 v[20:23], v[160:163], v[200:203], v[20:23]
    v_mfma_f32_16x16x32_bf16 v[24:27], v[168:171], v[184:187], v[24:27]
    ds_read_b128 v[144:147], v209 offset:4096
    v_mfma_f32_16x16x32_bf16 v[28:31], v[168:171], v[192:195], v[28:31]
    v_mfma_f32_16x16x32_bf16 v[32:35], v[168:171], v[200:203], v[32:35]
    ds_read_b128 v[104:107], v215 offset:2048
    v_mfma_f32_16x16x32_bf16 v[36:39], v[176:179], v[184:187], v[36:39]
    v_mfma_f32_16x16x32_bf16 v[40:43], v[176:179], v[192:195], v[40:43]
    ds_read_b128 v[112:115], v215 offset:4096
    v_mfma_f32_16x16x32_bf16 v[44:47], v[176:179], v[200:203], v[44:47]
    v_mfma_f32_16x16x32_bf16 v[48:51], v[152:155], v[188:191], v[48:51]
    ds_read_b128 v[120:123], v215 offset:6144
    v_mfma_f32_16x16x32_bf16 v[52:55], v[152:155], v[196:199], v[52:55]
    v_mfma_f32_16x16x32_bf16 v[56:59], v[152:155], v[204:207], v[56:59]
    ds_read_b128 v[132:135], v212 offset:0
    v_mfma_f32_16x16x32_bf16 v[60:63], v[160:163], v[188:191], v[60:63]
    v_mfma_f32_16x16x32_bf16 v[64:67], v[160:163], v[196:199], v[64:67]
    ds_read_b128 v[140:143], v212 offset:2048
    v_mfma_f32_16x16x32_bf16 v[68:71], v[160:163], v[204:207], v[68:71]
    v_mfma_f32_16x16x32_bf16 v[72:75], v[168:171], v[188:191], v[72:75]
    ds_read_b128 v[148:151], v212 offset:4096
    v_mfma_f32_16x16x32_bf16 v[76:79], v[168:171], v[196:199], v[76:79]
    v_mfma_f32_16x16x32_bf16 v[80:83], v[168:171], v[204:207], v[80:83]
    ds_read_b128 v[100:103], v215 offset:1024
    v_mfma_f32_16x16x32_bf16 v[84:87], v[176:179], v[188:191], v[84:87]
    v_mfma_f32_16x16x32_bf16 v[88:91], v[176:179], v[196:199], v[88:91]
    ds_read_b128 v[108:111], v215 offset:3072
    v_mfma_f32_16x16x32_bf16 v[92:95], v[176:179], v[204:207], v[92:95]
    v_mfma_f32_16x16x32_bf16 v[48:51], v[156:159], v[184:187], v[48:51]
    ds_read_b128 v[116:119], v215 offset:5120
    v_xor_b32 v188, s34, v188
    v_xor_b32 v189, s34, v189
    v_mfma_f32_16x16x32_bf16 v[52:55], v[156:159], v[192:195], v[52:55]
    v_xor_b32 v190, s34, v190
    v_xor_b32 v191, s34, v191
    v_mfma_f32_16x16x32_bf16 v[56:59], v[156:159], v[200:203], v[56:59]
    ds_read_b128 v[124:127], v215 offset:7168
    v_xor_b32 v196, s34, v196
    v_xor_b32 v197, s34, v197
    v_mfma_f32_16x16x32_bf16 v[60:63], v[164:167], v[184:187], v[60:63]
    v_xor_b32 v198, s34, v198
    v_xor_b32 v199, s34, v199
    v_mfma_f32_16x16x32_bf16 v[64:67], v[164:167], v[192:195], v[64:67]
    v_xor_b32 v204, s34, v204
    v_xor_b32 v205, s34, v205
    v_mfma_f32_16x16x32_bf16 v[68:71], v[164:167], v[200:203], v[68:71]
    v_xor_b32 v206, s34, v206
    v_xor_b32 v207, s34, v207
    v_mfma_f32_16x16x32_bf16 v[72:75], v[172:175], v[184:187], v[72:75]
    v_mfma_f32_16x16x32_bf16 v[76:79], v[172:175], v[192:195], v[76:79]
    v_mfma_f32_16x16x32_bf16 v[80:83], v[172:175], v[200:203], v[80:83]
    v_mfma_f32_16x16x32_bf16 v[84:87], v[180:183], v[184:187], v[84:87]
    v_mfma_f32_16x16x32_bf16 v[88:91], v[180:183], v[192:195], v[88:91]
    v_mfma_f32_16x16x32_bf16 v[92:95], v[180:183], v[200:203], v[92:95]
    v_mfma_f32_16x16x32_bf16 v[0:3], v[156:159], v[188:191], v[0:3]
    v_mfma_f32_16x16x32_bf16 v[4:7], v[156:159], v[196:199], v[4:7]
    v_mfma_f32_16x16x32_bf16 v[8:11], v[156:159], v[204:207], v[8:11]
    v_mfma_f32_16x16x32_bf16 v[12:15], v[164:167], v[188:191], v[12:15]
    v_mfma_f32_16x16x32_bf16 v[16:19], v[164:167], v[196:199], v[16:19]
    s_waitcnt lgkmcnt(0)
    s_barrier
    v_mfma_f32_16x16x32_bf16 v[20:23], v[164:167], v[204:207], v[20:23]
    v_mfma_f32_16x16x32_bf16 v[24:27], v[172:175], v[188:191], v[24:27]
    v_mfma_f32_16x16x32_bf16 v[28:31], v[172:175], v[196:199], v[28:31]
    v_mfma_f32_16x16x32_bf16 v[32:35], v[172:175], v[204:207], v[32:35]
    v_mfma_f32_16x16x32_bf16 v[36:39], v[180:183], v[188:191], v[36:39]
    v_mfma_f32_16x16x32_bf16 v[40:43], v[180:183], v[196:199], v[40:43]
    v_mfma_f32_16x16x32_bf16 v[44:47], v[180:183], v[204:207], v[44:47]
    v_mfma_f32_16x16x32_bf16 v[0:3], v[96:99], v[128:131], v[0:3]
    ds_read_b128 v[152:155], v215 offset:28672
    v_mfma_f32_16x16x32_bf16 v[4:7], v[96:99], v[136:139], v[4:7]
    v_mfma_f32_16x16x32_bf16 v[8:11], v[96:99], v[144:147], v[8:11]
    ds_read_b128 v[184:187], v209 offset:28672
    v_mfma_f32_16x16x32_bf16 v[12:15], v[104:107], v[128:131], v[12:15]
    v_mfma_f32_16x16x32_bf16 v[16:19], v[104:107], v[136:139], v[16:19]
    ds_read_b128 v[192:195], v209 offset:30720
    v_mfma_f32_16x16x32_bf16 v[20:23], v[104:107], v[144:147], v[20:23]
    v_mfma_f32_16x16x32_bf16 v[24:27], v[112:115], v[128:131], v[24:27]
    ds_read_b128 v[200:203], v209 offset:32768
    v_mfma_f32_16x16x32_bf16 v[28:31], v[112:115], v[136:139], v[28:31]
    v_mfma_f32_16x16x32_bf16 v[32:35], v[112:115], v[144:147], v[32:35]
    ds_read_b128 v[160:163], v215 offset:30720
    v_mfma_f32_16x16x32_bf16 v[36:39], v[120:123], v[128:131], v[36:39]
    v_mfma_f32_16x16x32_bf16 v[40:43], v[120:123], v[136:139], v[40:43]
    ds_read_b128 v[168:171], v215 offset:32768
    v_mfma_f32_16x16x32_bf16 v[44:47], v[120:123], v[144:147], v[44:47]
    v_mfma_f32_16x16x32_bf16 v[48:51], v[96:99], v[132:135], v[48:51]
    ds_read_b128 v[176:179], v215 offset:34816
    v_mfma_f32_16x16x32_bf16 v[52:55], v[96:99], v[140:143], v[52:55]
    v_mfma_f32_16x16x32_bf16 v[56:59], v[96:99], v[148:151], v[56:59]
    ds_read_b128 v[188:191], v212 offset:28672
    v_mfma_f32_16x16x32_bf16 v[60:63], v[104:107], v[132:135], v[60:63]
    v_mfma_f32_16x16x32_bf16 v[64:67], v[104:107], v[140:143], v[64:67]
    ds_read_b128 v[196:199], v212 offset:30720
    v_mfma_f32_16x16x32_bf16 v[68:71], v[104:107], v[148:151], v[68:71]
    v_mfma_f32_16x16x32_bf16 v[72:75], v[112:115], v[132:135], v[72:75]
    ds_read_b128 v[204:207], v212 offset:32768
    v_mfma_f32_16x16x32_bf16 v[76:79], v[112:115], v[140:143], v[76:79]
    v_mfma_f32_16x16x32_bf16 v[80:83], v[112:115], v[148:151], v[80:83]
    ds_read_b128 v[156:159], v215 offset:29696
    v_mfma_f32_16x16x32_bf16 v[84:87], v[120:123], v[132:135], v[84:87]
    v_mfma_f32_16x16x32_bf16 v[88:91], v[120:123], v[140:143], v[88:91]
    ds_read_b128 v[164:167], v215 offset:31744
    v_mfma_f32_16x16x32_bf16 v[92:95], v[120:123], v[148:151], v[92:95]
    v_mfma_f32_16x16x32_bf16 v[48:51], v[100:103], v[128:131], v[48:51]
    ds_read_b128 v[172:175], v215 offset:33792
    v_xor_b32 v132, s34, v132
    v_xor_b32 v133, s34, v133
    v_mfma_f32_16x16x32_bf16 v[52:55], v[100:103], v[136:139], v[52:55]
    v_xor_b32 v134, s34, v134
    v_xor_b32 v135, s34, v135
    v_mfma_f32_16x16x32_bf16 v[56:59], v[100:103], v[144:147], v[56:59]
    ds_read_b128 v[180:183], v215 offset:35840
    v_xor_b32 v140, s34, v140
    v_xor_b32 v141, s34, v141
    v_mfma_f32_16x16x32_bf16 v[60:63], v[108:111], v[128:131], v[60:63]
    v_xor_b32 v142, s34, v142
    v_xor_b32 v143, s34, v143
    v_mfma_f32_16x16x32_bf16 v[64:67], v[108:111], v[136:139], v[64:67]
    v_xor_b32 v148, s34, v148
    v_xor_b32 v149, s34, v149
    v_mfma_f32_16x16x32_bf16 v[68:71], v[108:111], v[144:147], v[68:71]
    v_xor_b32 v150, s34, v150
    v_xor_b32 v151, s34, v151
    v_mfma_f32_16x16x32_bf16 v[72:75], v[116:119], v[128:131], v[72:75]
    v_mfma_f32_16x16x32_bf16 v[76:79], v[116:119], v[136:139], v[76:79]
    v_mfma_f32_16x16x32_bf16 v[80:83], v[116:119], v[144:147], v[80:83]
    v_mfma_f32_16x16x32_bf16 v[84:87], v[124:127], v[128:131], v[84:87]
    v_mfma_f32_16x16x32_bf16 v[88:91], v[124:127], v[136:139], v[88:91]
    v_mfma_f32_16x16x32_bf16 v[92:95], v[124:127], v[144:147], v[92:95]
    v_mfma_f32_16x16x32_bf16 v[0:3], v[100:103], v[132:135], v[0:3]
    v_mfma_f32_16x16x32_bf16 v[4:7], v[100:103], v[140:143], v[4:7]
    v_mfma_f32_16x16x32_bf16 v[8:11], v[100:103], v[148:151], v[8:11]
    v_mfma_f32_16x16x32_bf16 v[12:15], v[108:111], v[132:135], v[12:15]
    v_mfma_f32_16x16x32_bf16 v[16:19], v[108:111], v[140:143], v[16:19]
    s_waitcnt lgkmcnt(0)
    s_barrier
    v_mfma_f32_16x16x32_bf16 v[20:23], v[108:111], v[148:151], v[20:23]
    v_mfma_f32_16x16x32_bf16 v[24:27], v[116:119], v[132:135], v[24:27]
    v_mfma_f32_16x16x32_bf16 v[28:31], v[116:119], v[140:143], v[28:31]
    v_mfma_f32_16x16x32_bf16 v[32:35], v[116:119], v[148:151], v[32:35]
    v_mfma_f32_16x16x32_bf16 v[36:39], v[124:127], v[132:135], v[36:39]
    v_mfma_f32_16x16x32_bf16 v[40:43], v[124:127], v[140:143], v[40:43]
    v_mfma_f32_16x16x32_bf16 v[44:47], v[124:127], v[148:151], v[44:47]
    v_mfma_f32_16x16x32_bf16 v[0:3], v[152:155], v[184:187], v[0:3]
    ds_read_b128 v[96:99], v216 offset:0
    v_mfma_f32_16x16x32_bf16 v[4:7], v[152:155], v[192:195], v[4:7]
    v_mfma_f32_16x16x32_bf16 v[8:11], v[152:155], v[200:203], v[8:11]
    ds_read_b128 v[128:131], v210 offset:0
    v_mfma_f32_16x16x32_bf16 v[12:15], v[160:163], v[184:187], v[12:15]
    v_mfma_f32_16x16x32_bf16 v[16:19], v[160:163], v[192:195], v[16:19]
    ds_read_b128 v[136:139], v210 offset:2048
    v_mfma_f32_16x16x32_bf16 v[20:23], v[160:163], v[200:203], v[20:23]
    v_mfma_f32_16x16x32_bf16 v[24:27], v[168:171], v[184:187], v[24:27]
    ds_read_b128 v[144:147], v210 offset:4096
    v_mfma_f32_16x16x32_bf16 v[28:31], v[168:171], v[192:195], v[28:31]
    v_mfma_f32_16x16x32_bf16 v[32:35], v[168:171], v[200:203], v[32:35]
    ds_read_b128 v[104:107], v216 offset:2048
    v_mfma_f32_16x16x32_bf16 v[36:39], v[176:179], v[184:187], v[36:39]
    v_mfma_f32_16x16x32_bf16 v[40:43], v[176:179], v[192:195], v[40:43]
    ds_read_b128 v[112:115], v216 offset:4096
    v_mfma_f32_16x16x32_bf16 v[44:47], v[176:179], v[200:203], v[44:47]
    v_mfma_f32_16x16x32_bf16 v[48:51], v[152:155], v[188:191], v[48:51]
    ds_read_b128 v[120:123], v216 offset:6144
    v_mfma_f32_16x16x32_bf16 v[52:55], v[152:155], v[196:199], v[52:55]
    v_mfma_f32_16x16x32_bf16 v[56:59], v[152:155], v[204:207], v[56:59]
    ds_read_b128 v[132:135], v213 offset:0
    v_mfma_f32_16x16x32_bf16 v[60:63], v[160:163], v[188:191], v[60:63]
    v_mfma_f32_16x16x32_bf16 v[64:67], v[160:163], v[196:199], v[64:67]
    ds_read_b128 v[140:143], v213 offset:2048
    v_mfma_f32_16x16x32_bf16 v[68:71], v[160:163], v[204:207], v[68:71]
    v_mfma_f32_16x16x32_bf16 v[72:75], v[168:171], v[188:191], v[72:75]
    ds_read_b128 v[148:151], v213 offset:4096
    v_mfma_f32_16x16x32_bf16 v[76:79], v[168:171], v[196:199], v[76:79]
    v_mfma_f32_16x16x32_bf16 v[80:83], v[168:171], v[204:207], v[80:83]
    ds_read_b128 v[100:103], v216 offset:1024
    v_mfma_f32_16x16x32_bf16 v[84:87], v[176:179], v[188:191], v[84:87]
    v_mfma_f32_16x16x32_bf16 v[88:91], v[176:179], v[196:199], v[88:91]
    ds_read_b128 v[108:111], v216 offset:3072
    v_mfma_f32_16x16x32_bf16 v[92:95], v[176:179], v[204:207], v[92:95]
    v_mfma_f32_16x16x32_bf16 v[48:51], v[156:159], v[184:187], v[48:51]
    ds_read_b128 v[116:119], v216 offset:5120
    v_xor_b32 v188, s34, v188
    v_xor_b32 v189, s34, v189
    v_mfma_f32_16x16x32_bf16 v[52:55], v[156:159], v[192:195], v[52:55]
    v_xor_b32 v190, s34, v190
    v_xor_b32 v191, s34, v191
    v_mfma_f32_16x16x32_bf16 v[56:59], v[156:159], v[200:203], v[56:59]
    ds_read_b128 v[124:127], v216 offset:7168
    v_xor_b32 v196, s34, v196
    v_xor_b32 v197, s34, v197
    v_mfma_f32_16x16x32_bf16 v[60:63], v[164:167], v[184:187], v[60:63]
    v_xor_b32 v198, s34, v198
    v_xor_b32 v199, s34, v199
    v_mfma_f32_16x16x32_bf16 v[64:67], v[164:167], v[192:195], v[64:67]
    v_xor_b32 v204, s34, v204
    v_xor_b32 v205, s34, v205
    v_mfma_f32_16x16x32_bf16 v[68:71], v[164:167], v[200:203], v[68:71]
    v_xor_b32 v206, s34, v206
    v_xor_b32 v207, s34, v207
    v_mfma_f32_16x16x32_bf16 v[72:75], v[172:175], v[184:187], v[72:75]
    v_mfma_f32_16x16x32_bf16 v[76:79], v[172:175], v[192:195], v[76:79]
    v_mfma_f32_16x16x32_bf16 v[80:83], v[172:175], v[200:203], v[80:83]
    v_mfma_f32_16x16x32_bf16 v[84:87], v[180:183], v[184:187], v[84:87]
    v_mfma_f32_16x16x32_bf16 v[88:91], v[180:183], v[192:195], v[88:91]
    v_mfma_f32_16x16x32_bf16 v[92:95], v[180:183], v[200:203], v[92:95]
    v_mfma_f32_16x16x32_bf16 v[0:3], v[156:159], v[188:191], v[0:3]
    v_mfma_f32_16x16x32_bf16 v[4:7], v[156:159], v[196:199], v[4:7]
    v_mfma_f32_16x16x32_bf16 v[8:11], v[156:159], v[204:207], v[8:11]
    v_mfma_f32_16x16x32_bf16 v[12:15], v[164:167], v[188:191], v[12:15]
    v_mfma_f32_16x16x32_bf16 v[16:19], v[164:167], v[196:199], v[16:19]
    s_waitcnt lgkmcnt(0)
    s_barrier
    v_mfma_f32_16x16x32_bf16 v[20:23], v[164:167], v[204:207], v[20:23]
    v_mfma_f32_16x16x32_bf16 v[24:27], v[172:175], v[188:191], v[24:27]
    v_mfma_f32_16x16x32_bf16 v[28:31], v[172:175], v[196:199], v[28:31]
    v_mfma_f32_16x16x32_bf16 v[32:35], v[172:175], v[204:207], v[32:35]
    v_mfma_f32_16x16x32_bf16 v[36:39], v[180:183], v[188:191], v[36:39]
    v_mfma_f32_16x16x32_bf16 v[40:43], v[180:183], v[196:199], v[40:43]
    v_mfma_f32_16x16x32_bf16 v[44:47], v[180:183], v[204:207], v[44:47]
    v_mfma_f32_16x16x32_bf16 v[0:3], v[96:99], v[128:131], v[0:3]
    ds_read_b128 v[152:155], v214 offset:0
    v_mfma_f32_16x16x32_bf16 v[4:7], v[96:99], v[136:139], v[4:7]
    v_mfma_f32_16x16x32_bf16 v[8:11], v[96:99], v[144:147], v[8:11]
    ds_read_b128 v[184:187], v208 offset:0
    v_mfma_f32_16x16x32_bf16 v[12:15], v[104:107], v[128:131], v[12:15]
    v_mfma_f32_16x16x32_bf16 v[16:19], v[104:107], v[136:139], v[16:19]
    ds_read_b128 v[192:195], v208 offset:2048
    v_mfma_f32_16x16x32_bf16 v[20:23], v[104:107], v[144:147], v[20:23]
    v_mfma_f32_16x16x32_bf16 v[24:27], v[112:115], v[128:131], v[24:27]
    ds_read_b128 v[200:203], v208 offset:4096
    v_mfma_f32_16x16x32_bf16 v[28:31], v[112:115], v[136:139], v[28:31]
    v_mfma_f32_16x16x32_bf16 v[32:35], v[112:115], v[144:147], v[32:35]
    ds_read_b128 v[160:163], v214 offset:2048
    v_mfma_f32_16x16x32_bf16 v[36:39], v[120:123], v[128:131], v[36:39]
    v_mfma_f32_16x16x32_bf16 v[40:43], v[120:123], v[136:139], v[40:43]
    ds_read_b128 v[168:171], v214 offset:4096
    v_mfma_f32_16x16x32_bf16 v[44:47], v[120:123], v[144:147], v[44:47]
    v_mfma_f32_16x16x32_bf16 v[48:51], v[96:99], v[132:135], v[48:51]
    ds_read_b128 v[176:179], v214 offset:6144
    v_mfma_f32_16x16x32_bf16 v[52:55], v[96:99], v[140:143], v[52:55]
    v_mfma_f32_16x16x32_bf16 v[56:59], v[96:99], v[148:151], v[56:59]
    ds_read_b128 v[188:191], v211 offset:0
    v_mfma_f32_16x16x32_bf16 v[60:63], v[104:107], v[132:135], v[60:63]
    v_mfma_f32_16x16x32_bf16 v[64:67], v[104:107], v[140:143], v[64:67]
    ds_read_b128 v[196:199], v211 offset:2048
    v_mfma_f32_16x16x32_bf16 v[68:71], v[104:107], v[148:151], v[68:71]
    v_mfma_f32_16x16x32_bf16 v[72:75], v[112:115], v[132:135], v[72:75]
    ds_read_b128 v[204:207], v211 offset:4096
    v_mfma_f32_16x16x32_bf16 v[76:79], v[112:115], v[140:143], v[76:79]
    v_mfma_f32_16x16x32_bf16 v[80:83], v[112:115], v[148:151], v[80:83]
    ds_read_b128 v[156:159], v214 offset:1024
    v_mfma_f32_16x16x32_bf16 v[84:87], v[120:123], v[132:135], v[84:87]
    v_mfma_f32_16x16x32_bf16 v[88:91], v[120:123], v[140:143], v[88:91]
    ds_read_b128 v[164:167], v214 offset:3072
    v_mfma_f32_16x16x32_bf16 v[92:95], v[120:123], v[148:151], v[92:95]
    v_mfma_f32_16x16x32_bf16 v[48:51], v[100:103], v[128:131], v[48:51]
    ds_read_b128 v[172:175], v214 offset:5120
    v_xor_b32 v132, s34, v132
    v_xor_b32 v133, s34, v133
    v_mfma_f32_16x16x32_bf16 v[52:55], v[100:103], v[136:139], v[52:55]
    v_xor_b32 v134, s34, v134
    v_xor_b32 v135, s34, v135
    v_mfma_f32_16x16x32_bf16 v[56:59], v[100:103], v[144:147], v[56:59]
    ds_read_b128 v[180:183], v214 offset:7168
    v_xor_b32 v140, s34, v140
    v_xor_b32 v141, s34, v141
    v_mfma_f32_16x16x32_bf16 v[60:63], v[108:111], v[128:131], v[60:63]
    v_xor_b32 v142, s34, v142
    v_xor_b32 v143, s34, v143
    v_mfma_f32_16x16x32_bf16 v[64:67], v[108:111], v[136:139], v[64:67]
    v_xor_b32 v148, s34, v148
    v_xor_b32 v149, s34, v149
    v_mfma_f32_16x16x32_bf16 v[68:71], v[108:111], v[144:147], v[68:71]
    v_xor_b32 v150, s34, v150
    v_xor_b32 v151, s34, v151
    v_mfma_f32_16x16x32_bf16 v[72:75], v[116:119], v[128:131], v[72:75]
    v_mfma_f32_16x16x32_bf16 v[76:79], v[116:119], v[136:139], v[76:79]
    v_mfma_f32_16x16x32_bf16 v[80:83], v[116:119], v[144:147], v[80:83]
    v_mfma_f32_16x16x32_bf16 v[84:87], v[124:127], v[128:131], v[84:87]
    v_mfma_f32_16x16x32_bf16 v[88:91], v[124:127], v[136:139], v[88:91]
    v_mfma_f32_16x16x32_bf16 v[92:95], v[124:127], v[144:147], v[92:95]
    v_mfma_f32_16x16x32_bf16 v[0:3], v[100:103], v[132:135], v[0:3]
    v_mfma_f32_16x16x32_bf16 v[4:7], v[100:103], v[140:143], v[4:7]
    v_mfma_f32_16x16x32_bf16 v[8:11], v[100:103], v[148:151], v[8:11]
    v_mfma_f32_16x16x32_bf16 v[12:15], v[108:111], v[132:135], v[12:15]
    v_mfma_f32_16x16x32_bf16 v[16:19], v[108:111], v[140:143], v[16:19]
    s_waitcnt lgkmcnt(0)
    v_mfma_f32_16x16x32_bf16 v[20:23], v[108:111], v[148:151], v[20:23]
    v_mfma_f32_16x16x32_bf16 v[24:27], v[116:119], v[132:135], v[24:27]
    v_mfma_f32_16x16x32_bf16 v[28:31], v[116:119], v[140:143], v[28:31]
    v_mfma_f32_16x16x32_bf16 v[32:35], v[116:119], v[148:151], v[32:35]
    v_mfma_f32_16x16x32_bf16 v[36:39], v[124:127], v[132:135], v[36:39]
    v_mfma_f32_16x16x32_bf16 v[40:43], v[124:127], v[140:143], v[40:43]
    v_mfma_f32_16x16x32_bf16 v[44:47], v[124:127], v[148:151], v[44:47]
    v_mfma_f32_16x16x32_bf16 v[0:3], v[152:155], v[184:187], v[0:3]
    v_mfma_f32_16x16x32_bf16 v[4:7], v[152:155], v[192:195], v[4:7]
    v_mfma_f32_16x16x32_bf16 v[8:11], v[152:155], v[200:203], v[8:11]
    v_mfma_f32_16x16x32_bf16 v[12:15], v[160:163], v[184:187], v[12:15]
    v_mfma_f32_16x16x32_bf16 v[16:19], v[160:163], v[192:195], v[16:19]
    v_mfma_f32_16x16x32_bf16 v[20:23], v[160:163], v[200:203], v[20:23]
    v_mfma_f32_16x16x32_bf16 v[24:27], v[168:171], v[184:187], v[24:27]
    v_mfma_f32_16x16x32_bf16 v[28:31], v[168:171], v[192:195], v[28:31]
    v_mfma_f32_16x16x32_bf16 v[32:35], v[168:171], v[200:203], v[32:35]
    v_mfma_f32_16x16x32_bf16 v[36:39], v[176:179], v[184:187], v[36:39]
    v_mfma_f32_16x16x32_bf16 v[40:43], v[176:179], v[192:195], v[40:43]
    v_mfma_f32_16x16x32_bf16 v[44:47], v[176:179], v[200:203], v[44:47]
    v_mfma_f32_16x16x32_bf16 v[48:51], v[152:155], v[188:191], v[48:51]
    v_mfma_f32_16x16x32_bf16 v[52:55], v[152:155], v[196:199], v[52:55]
    v_mfma_f32_16x16x32_bf16 v[56:59], v[152:155], v[204:207], v[56:59]
    v_mfma_f32_16x16x32_bf16 v[60:63], v[160:163], v[188:191], v[60:63]
    v_mfma_f32_16x16x32_bf16 v[64:67], v[160:163], v[196:199], v[64:67]
    v_mfma_f32_16x16x32_bf16 v[68:71], v[160:163], v[204:207], v[68:71]
    v_mfma_f32_16x16x32_bf16 v[72:75], v[168:171], v[188:191], v[72:75]
    v_mfma_f32_16x16x32_bf16 v[76:79], v[168:171], v[196:199], v[76:79]
    v_mfma_f32_16x16x32_bf16 v[80:83], v[168:171], v[204:207], v[80:83]
    v_mfma_f32_16x16x32_bf16 v[84:87], v[176:179], v[188:191], v[84:87]
    v_mfma_f32_16x16x32_bf16 v[88:91], v[176:179], v[196:199], v[88:91]
    v_mfma_f32_16x16x32_bf16 v[92:95], v[176:179], v[204:207], v[92:95]
    v_mfma_f32_16x16x32_bf16 v[48:51], v[156:159], v[184:187], v[48:51]
    v_xor_b32 v188, s34, v188
    v_xor_b32 v189, s34, v189
    v_mfma_f32_16x16x32_bf16 v[52:55], v[156:159], v[192:195], v[52:55]
    v_xor_b32 v190, s34, v190
    v_xor_b32 v191, s34, v191
    v_mfma_f32_16x16x32_bf16 v[56:59], v[156:159], v[200:203], v[56:59]
    v_xor_b32 v196, s34, v196
    v_xor_b32 v197, s34, v197
    v_mfma_f32_16x16x32_bf16 v[60:63], v[164:167], v[184:187], v[60:63]
    v_xor_b32 v198, s34, v198
    v_xor_b32 v199, s34, v199
    v_mfma_f32_16x16x32_bf16 v[64:67], v[164:167], v[192:195], v[64:67]
    v_xor_b32 v204, s34, v204
    v_xor_b32 v205, s34, v205
    v_mfma_f32_16x16x32_bf16 v[68:71], v[164:167], v[200:203], v[68:71]
    v_xor_b32 v206, s34, v206
    v_xor_b32 v207, s34, v207
    v_mfma_f32_16x16x32_bf16 v[72:75], v[172:175], v[184:187], v[72:75]
    v_mfma_f32_16x16x32_bf16 v[76:79], v[172:175], v[192:195], v[76:79]
    v_mfma_f32_16x16x32_bf16 v[80:83], v[172:175], v[200:203], v[80:83]
    v_mfma_f32_16x16x32_bf16 v[84:87], v[180:183], v[184:187], v[84:87]
    v_mfma_f32_16x16x32_bf16 v[88:91], v[180:183], v[192:195], v[88:91]
    v_mfma_f32_16x16x32_bf16 v[92:95], v[180:183], v[200:203], v[92:95]
    v_mfma_f32_16x16x32_bf16 v[0:3], v[156:159], v[188:191], v[0:3]
    v_mfma_f32_16x16x32_bf16 v[4:7], v[156:159], v[196:199], v[4:7]
    v_mfma_f32_16x16x32_bf16 v[8:11], v[156:159], v[204:207], v[8:11]
    v_mfma_f32_16x16x32_bf16 v[12:15], v[164:167], v[188:191], v[12:15]
    v_mfma_f32_16x16x32_bf16 v[16:19], v[164:167], v[196:199], v[16:19]
    v_mfma_f32_16x16x32_bf16 v[20:23], v[164:167], v[204:207], v[20:23]
    v_mfma_f32_16x16x32_bf16 v[24:27], v[172:175], v[188:191], v[24:27]
    v_mfma_f32_16x16x32_bf16 v[28:31], v[172:175], v[196:199], v[28:31]
    v_mfma_f32_16x16x32_bf16 v[32:35], v[172:175], v[204:207], v[32:35]
    v_mfma_f32_16x16x32_bf16 v[36:39], v[180:183], v[188:191], v[36:39]
    v_mfma_f32_16x16x32_bf16 v[40:43], v[180:183], v[196:199], v[40:43]
    v_mfma_f32_16x16x32_bf16 v[44:47], v[180:183], v[204:207], v[44:47]
    s_nop 7
    s_nop 7
    v_cvt_pk_bf16_f32 v96, v0, v1
    v_cvt_pk_bf16_f32 v97, v2, v3
    v_cvt_pk_bf16_f32 v98, v12, v13
    v_cvt_pk_bf16_f32 v99, v14, v15
    v_cvt_pk_bf16_f32 v100, v48, v49
    v_cvt_pk_bf16_f32 v101, v50, v51
    v_cvt_pk_bf16_f32 v102, v60, v61
    v_cvt_pk_bf16_f32 v103, v62, v63
    v_mov_b32 v104, v96
    v_mov_b32 v105, v97
    v_mov_b32 v106, v98
    v_mov_b32 v107, v99
    s_add_u32 s35, s33, 0
    v_mov_b32_dpp v104, v100 row_ror:8 row_mask:0xf bank_mask:0x3
    v_mov_b32_dpp v105, v101 row_ror:8 row_mask:0xf bank_mask:0x3
    v_mov_b32_dpp v106, v102 row_ror:8 row_mask:0xf bank_mask:0x3
    v_mov_b32_dpp v107, v103 row_ror:8 row_mask:0xf bank_mask:0x3
    v_mov_b32_dpp v96, v100 row_ror:8 row_mask:0xf bank_mask:0xc
    v_mov_b32_dpp v97, v101 row_ror:8 row_mask:0xf bank_mask:0xc
    v_mov_b32_dpp v98, v102 row_ror:8 row_mask:0xf bank_mask:0xc
    v_mov_b32_dpp v99, v103 row_ror:8 row_mask:0xf bank_mask:0xc
    buffer_store_dwordx4 v[96:99], v222, s[16:19], s35 offen sc1
    buffer_store_dwordx4 v[104:107], v223, s[16:19], s35 offen sc1
    v_cvt_pk_bf16_f32 v108, v4, v5
    v_cvt_pk_bf16_f32 v109, v6, v7
    v_cvt_pk_bf16_f32 v110, v16, v17
    v_cvt_pk_bf16_f32 v111, v18, v19
    v_cvt_pk_bf16_f32 v112, v52, v53
    v_cvt_pk_bf16_f32 v113, v54, v55
    v_cvt_pk_bf16_f32 v114, v64, v65
    v_cvt_pk_bf16_f32 v115, v66, v67
    v_mov_b32 v116, v108
    v_mov_b32 v117, v109
    v_mov_b32 v118, v110
    v_mov_b32 v119, v111
    s_add_u32 s35, s33, 593920
    v_mov_b32_dpp v116, v112 row_ror:8 row_mask:0xf bank_mask:0x3
    v_mov_b32_dpp v117, v113 row_ror:8 row_mask:0xf bank_mask:0x3
    v_mov_b32_dpp v118, v114 row_ror:8 row_mask:0xf bank_mask:0x3
    v_mov_b32_dpp v119, v115 row_ror:8 row_mask:0xf bank_mask:0x3
    v_mov_b32_dpp v108, v112 row_ror:8 row_mask:0xf bank_mask:0xc
    v_mov_b32_dpp v109, v113 row_ror:8 row_mask:0xf bank_mask:0xc
    v_mov_b32_dpp v110, v114 row_ror:8 row_mask:0xf bank_mask:0xc
    v_mov_b32_dpp v111, v115 row_ror:8 row_mask:0xf bank_mask:0xc
    buffer_store_dwordx4 v[108:111], v222, s[16:19], s35 offen sc1
    buffer_store_dwordx4 v[116:119], v223, s[16:19], s35 offen sc1
    v_cvt_pk_bf16_f32 v120, v8, v9
    v_cvt_pk_bf16_f32 v121, v10, v11
    v_cvt_pk_bf16_f32 v122, v20, v21
    v_cvt_pk_bf16_f32 v123, v22, v23
    v_cvt_pk_bf16_f32 v124, v56, v57
    v_cvt_pk_bf16_f32 v125, v58, v59
    v_cvt_pk_bf16_f32 v126, v68, v69
    v_cvt_pk_bf16_f32 v127, v70, v71
    v_mov_b32 v128, v120
    v_mov_b32 v129, v121
    v_mov_b32 v130, v122
    v_mov_b32 v131, v123
    s_add_u32 s35, s33, 1187840
    v_mov_b32_dpp v128, v124 row_ror:8 row_mask:0xf bank_mask:0x3
    v_mov_b32_dpp v129, v125 row_ror:8 row_mask:0xf bank_mask:0x3
    v_mov_b32_dpp v130, v126 row_ror:8 row_mask:0xf bank_mask:0x3
    v_mov_b32_dpp v131, v127 row_ror:8 row_mask:0xf bank_mask:0x3
    v_mov_b32_dpp v120, v124 row_ror:8 row_mask:0xf bank_mask:0xc
    v_mov_b32_dpp v121, v125 row_ror:8 row_mask:0xf bank_mask:0xc
    v_mov_b32_dpp v122, v126 row_ror:8 row_mask:0xf bank_mask:0xc
    v_mov_b32_dpp v123, v127 row_ror:8 row_mask:0xf bank_mask:0xc
    buffer_store_dwordx4 v[120:123], v222, s[16:19], s35 offen sc1
    buffer_store_dwordx4 v[128:131], v223, s[16:19], s35 offen sc1
    v_cvt_pk_bf16_f32 v96, v24, v25
    v_cvt_pk_bf16_f32 v97, v26, v27
    v_cvt_pk_bf16_f32 v98, v36, v37
    v_cvt_pk_bf16_f32 v99, v38, v39
    v_cvt_pk_bf16_f32 v100, v72, v73
    v_cvt_pk_bf16_f32 v101, v74, v75
    v_cvt_pk_bf16_f32 v102, v84, v85
    v_cvt_pk_bf16_f32 v103, v86, v87
    v_mov_b32 v104, v96
    v_mov_b32 v105, v97
    v_mov_b32 v106, v98
    v_mov_b32 v107, v99
    s_add_u32 s35, s33, 4096
    v_mov_b32_dpp v104, v100 row_ror:8 row_mask:0xf bank_mask:0x3
    v_mov_b32_dpp v105, v101 row_ror:8 row_mask:0xf bank_mask:0x3
    v_mov_b32_dpp v106, v102 row_ror:8 row_mask:0xf bank_mask:0x3
    v_mov_b32_dpp v107, v103 row_ror:8 row_mask:0xf bank_mask:0x3
    v_mov_b32_dpp v96, v100 row_ror:8 row_mask:0xf bank_mask:0xc
    v_mov_b32_dpp v97, v101 row_ror:8 row_mask:0xf bank_mask:0xc
    v_mov_b32_dpp v98, v102 row_ror:8 row_mask:0xf bank_mask:0xc
    v_mov_b32_dpp v99, v103 row_ror:8 row_mask:0xf bank_mask:0xc
    buffer_store_dwordx4 v[96:99], v222, s[16:19], s35 offen sc1
    buffer_store_dwordx4 v[104:107], v223, s[16:19], s35 offen sc1
    v_cvt_pk_bf16_f32 v108, v28, v29
    v_cvt_pk_bf16_f32 v109, v30, v31
    v_cvt_pk_bf16_f32 v110, v40, v41
    v_cvt_pk_bf16_f32 v111, v42, v43
    v_cvt_pk_bf16_f32 v112, v76, v77
    v_cvt_pk_bf16_f32 v113, v78, v79
    v_cvt_pk_bf16_f32 v114, v88, v89
    v_cvt_pk_bf16_f32 v115, v90, v91
    v_mov_b32 v116, v108
    v_mov_b32 v117, v109
    v_mov_b32 v118, v110
    v_mov_b32 v119, v111
    s_add_u32 s35, s33, 598016
    v_mov_b32_dpp v116, v112 row_ror:8 row_mask:0xf bank_mask:0x3
    v_mov_b32_dpp v117, v113 row_ror:8 row_mask:0xf bank_mask:0x3
    v_mov_b32_dpp v118, v114 row_ror:8 row_mask:0xf bank_mask:0x3
    v_mov_b32_dpp v119, v115 row_ror:8 row_mask:0xf bank_mask:0x3
    v_mov_b32_dpp v108, v112 row_ror:8 row_mask:0xf bank_mask:0xc
    v_mov_b32_dpp v109, v113 row_ror:8 row_mask:0xf bank_mask:0xc
    v_mov_b32_dpp v110, v114 row_ror:8 row_mask:0xf bank_mask:0xc
    v_mov_b32_dpp v111, v115 row_ror:8 row_mask:0xf bank_mask:0xc
    buffer_store_dwordx4 v[108:111], v222, s[16:19], s35 offen sc1
    buffer_store_dwordx4 v[116:119], v223, s[16:19], s35 offen sc1
    v_cvt_pk_bf16_f32 v120, v32, v33
    v_cvt_pk_bf16_f32 v121, v34, v35
    v_cvt_pk_bf16_f32 v122, v44, v45
    v_cvt_pk_bf16_f32 v123, v46, v47
    v_cvt_pk_bf16_f32 v124, v80, v81
    v_cvt_pk_bf16_f32 v125, v82, v83
    v_cvt_pk_bf16_f32 v126, v92, v93
    v_cvt_pk_bf16_f32 v127, v94, v95
    v_mov_b32 v128, v120
    v_mov_b32 v129, v121
    v_mov_b32 v130, v122
    v_mov_b32 v131, v123
    s_add_u32 s35, s33, 1191936
    v_mov_b32_dpp v128, v124 row_ror:8 row_mask:0xf bank_mask:0x3
    v_mov_b32_dpp v129, v125 row_ror:8 row_mask:0xf bank_mask:0x3
    v_mov_b32_dpp v130, v126 row_ror:8 row_mask:0xf bank_mask:0x3
    v_mov_b32_dpp v131, v127 row_ror:8 row_mask:0xf bank_mask:0x3
    v_mov_b32_dpp v120, v124 row_ror:8 row_mask:0xf bank_mask:0xc
    v_mov_b32_dpp v121, v125 row_ror:8 row_mask:0xf bank_mask:0xc
    v_mov_b32_dpp v122, v126 row_ror:8 row_mask:0xf bank_mask:0xc
    v_mov_b32_dpp v123, v127 row_ror:8 row_mask:0xf bank_mask:0xc
    buffer_store_dwordx4 v[120:123], v222, s[16:19], s35 offen sc1
    buffer_store_dwordx4 v[128:131], v223, s[16:19], s35 offen sc1
    s_endpgm
L_gemm1_kernel_loader:
    s_sub_u32 s20, s20, 4
    v_and_b32 v1, 63, v0
    v_lshrrev_b32 v4, 3, v1
    v_and_b32 v5, 7, v1
    v_xor_b32 v5, v5, v4
    v_lshlrev_b32 v5, 4, v5
    v_lshl_add_u32 v2, v4, 11, v5
    v_lshlrev_b32 v3, 4, v1
    s_add_u32 s24, s20, 0
    s_lshl_b32 s40, s24, 10
    s_lshl_b32 s43, s24, 14
    s_add_u32 s24, s20, 4
    s_lshl_b32 s41, s24, 10
    s_lshl_b32 s44, s24, 14
    s_add_u32 s24, s20, 8
    s_lshl_b32 s42, s24, 10
    s_lshl_b32 s45, s24, 14
    s_mul_i32 s46, s20, 4096
    s_add_u32 s47, s46, 12288
    s_add_u32 m0, s40, 0
    s_add_u32 s24, s43, 0
    buffer_load_dwordx4 v2, s[8:11], s24 offen lds
    s_add_u32 m0, s41, 0
    s_add_u32 s24, s44, 0
    buffer_load_dwordx4 v2, s[8:11], s24 offen lds
    s_add_u32 m0, s42, 0
    s_add_u32 s24, s45, 0
    buffer_load_dwordx4 v2, s[8:11], s24 offen lds
    s_add_u32 m0, s47, 0
    s_add_u32 s24, s46, 0
    buffer_load_dwordx4 v3, s[12:15], s24 offen offset:0 lds
    buffer_load_dwordx4 v3, s[12:15], s24 offen offset:1024 lds
    buffer_load_dwordx4 v3, s[12:15], s24 offen offset:2048 lds
    buffer_load_dwordx4 v3, s[12:15], s24 offen offset:3072 lds
    s_add_u32 m0, s40, 28672
    s_add_u32 s24, s43, 128
    buffer_load_dwordx4 v2, s[8:11], s24 offen lds
    s_add_u32 m0, s41, 28672
    s_add_u32 s24, s44, 128
    buffer_load_dwordx4 v2, s[8:11], s24 offen lds
    s_add_u32 m0, s42, 28672
    s_add_u32 s24, s45, 128
    buffer_load_dwordx4 v2, s[8:11], s24 offen lds
    s_add_u32 m0, s47, 28672
    s_add_u32 s24, s46, 32768
    buffer_load_dwordx4 v3, s[12:15], s24 offen offset:0 lds
    buffer_load_dwordx4 v3, s[12:15], s24 offen offset:1024 lds
    buffer_load_dwordx4 v3, s[12:15], s24 offen offset:2048 lds
    buffer_load_dwordx4 v3, s[12:15], s24 offen offset:3072 lds
    s_waitcnt vmcnt(7)
    s_barrier
    s_add_u32 m0, s40, 57344
    s_add_u32 s24, s43, 256
    buffer_load_dwordx4 v2, s[8:11], s24 offen lds
    s_add_u32 m0, s41, 57344
    s_add_u32 s24, s44, 256
    buffer_load_dwordx4 v2, s[8:11], s24 offen lds
    s_add_u32 m0, s42, 57344
    s_add_u32 s24, s45, 256
    buffer_load_dwordx4 v2, s[8:11], s24 offen lds
    s_add_u32 m0, s47, 57344
    s_add_u32 s24, s46, 65536
    buffer_load_dwordx4 v3, s[12:15], s24 offen offset:0 lds
    buffer_load_dwordx4 v3, s[12:15], s24 offen offset:1024 lds
    buffer_load_dwordx4 v3, s[12:15], s24 offen offset:2048 lds
    buffer_load_dwordx4 v3, s[12:15], s24 offen offset:3072 lds
    s_waitcnt vmcnt(7)
    s_barrier
    s_add_u32 m0, s40, 86016
    s_add_u32 s24, s43, 384
    buffer_load_dwordx4 v2, s[8:11], s24 offen lds
    s_add_u32 m0, s41, 86016
    s_add_u32 s24, s44, 384
    buffer_load_dwordx4 v2, s[8:11], s24 offen lds
    s_add_u32 m0, s42, 86016
    s_add_u32 s24, s45, 384
    buffer_load_dwordx4 v2, s[8:11], s24 offen lds
    s_add_u32 m0, s47, 86016
    s_add_u32 s24, s46, 98304
    buffer_load_dwordx4 v3, s[12:15], s24 offen offset:0 lds
    buffer_load_dwordx4 v3, s[12:15], s24 offen offset:1024 lds
    buffer_load_dwordx4 v3, s[12:15], s24 offen offset:2048 lds
    buffer_load_dwordx4 v3, s[12:15], s24 offen offset:3072 lds
    s_add_u32 m0, s40, 114688
    s_add_u32 s24, s43, 512
    buffer_load_dwordx4 v2, s[8:11], s24 offen lds
    s_add_u32 m0, s41, 114688
    s_add_u32 s24, s44, 512
    buffer_load_dwordx4 v2, s[8:11], s24 offen lds
    s_add_u32 m0, s42, 114688
    s_add_u32 s24, s45, 512
    buffer_load_dwordx4 v2, s[8:11], s24 offen lds
    s_add_u32 m0, s47, 114688
    s_add_u32 s24, s46, 131072
    buffer_load_dwordx4 v3, s[12:15], s24 offen offset:0 lds
    buffer_load_dwordx4 v3, s[12:15], s24 offen offset:1024 lds
    buffer_load_dwordx4 v3, s[12:15], s24 offen offset:2048 lds
    buffer_load_dwordx4 v3, s[12:15], s24 offen offset:3072 lds
    s_waitcnt vmcnt(14)
    s_barrier
    s_add_u32 m0, s40, 0
    s_add_u32 s24, s43, 640
    buffer_load_dwordx4 v2, s[8:11], s24 offen lds
    s_add_u32 m0, s41, 0
    s_add_u32 s24, s44, 640
    buffer_load_dwordx4 v2, s[8:11], s24 offen lds
    s_add_u32 m0, s42, 0
    s_add_u32 s24, s45, 640
    buffer_load_dwordx4 v2, s[8:11], s24 offen lds
    s_add_u32 m0, s47, 0
    s_add_u32 s24, s46, 163840
    buffer_load_dwordx4 v3, s[12:15], s24 offen offset:0 lds
    buffer_load_dwordx4 v3, s[12:15], s24 offen offset:1024 lds
    buffer_load_dwordx4 v3, s[12:15], s24 offen offset:2048 lds
    buffer_load_dwordx4 v3, s[12:15], s24 offen offset:3072 lds
    s_add_u32 m0, s40, 28672
    s_add_u32 s24, s43, 768
    buffer_load_dwordx4 v2, s[8:11], s24 offen lds
    s_add_u32 m0, s41, 28672
    s_add_u32 s24, s44, 768
    buffer_load_dwordx4 v2, s[8:11], s24 offen lds
    s_add_u32 m0, s42, 28672
    s_add_u32 s24, s45, 768
    buffer_load_dwordx4 v2, s[8:11], s24 offen lds
    s_add_u32 m0, s47, 28672
    s_add_u32 s24, s46, 196608
    buffer_load_dwordx4 v3, s[12:15], s24 offen offset:0 lds
    buffer_load_dwordx4 v3, s[12:15], s24 offen offset:1024 lds
    buffer_load_dwordx4 v3, s[12:15], s24 offen offset:2048 lds
    buffer_load_dwordx4 v3, s[12:15], s24 offen offset:3072 lds
    s_waitcnt vmcnt(21)
    s_barrier
    s_add_u32 m0, s40, 57344
    s_add_u32 s24, s43, 896
    buffer_load_dwordx4 v2, s[8:11], s24 offen lds
    s_add_u32 m0, s41, 57344
    s_add_u32 s24, s44, 896
    buffer_load_dwordx4 v2, s[8:11], s24 offen lds
    s_add_u32 m0, s42, 57344
    s_add_u32 s24, s45, 896
    buffer_load_dwordx4 v2, s[8:11], s24 offen lds
    s_add_u32 m0, s47, 57344
    s_add_u32 s24, s46, 229376
    buffer_load_dwordx4 v3, s[12:15], s24 offen offset:0 lds
    buffer_load_dwordx4 v3, s[12:15], s24 offen offset:1024 lds
    buffer_load_dwordx4 v3, s[12:15], s24 offen offset:2048 lds
    buffer_load_dwordx4 v3, s[12:15], s24 offen offset:3072 lds
    s_waitcnt vmcnt(21)
    s_barrier
    s_add_u32 m0, s40, 86016
    s_add_u32 s24, s43, 1024
    buffer_load_dwordx4 v2, s[8:11], s24 offen lds
    s_add_u32 m0, s41, 86016
    s_add_u32 s24, s44, 1024
    buffer_load_dwordx4 v2, s[8:11], s24 offen lds
    s_add_u32 m0, s42, 86016
    s_add_u32 s24, s45, 1024
    buffer_load_dwordx4 v2, s[8:11], s24 offen lds
    s_add_u32 m0, s47, 86016
    s_add_u32 s24, s46, 262144
    buffer_load_dwordx4 v3, s[12:15], s24 offen offset:0 lds
    buffer_load_dwordx4 v3, s[12:15], s24 offen offset:1024 lds
    buffer_load_dwordx4 v3, s[12:15], s24 offen offset:2048 lds
    buffer_load_dwordx4 v3, s[12:15], s24 offen offset:3072 lds
    s_waitcnt vmcnt(21)
    s_barrier
    s_add_u32 m0, s40, 114688
    s_add_u32 s24, s43, 1152
    buffer_load_dwordx4 v2, s[8:11], s24 offen lds
    s_add_u32 m0, s41, 114688
    s_add_u32 s24, s44, 1152
    buffer_load_dwordx4 v2, s[8:11], s24 offen lds
    s_add_u32 m0, s42, 114688
    s_add_u32 s24, s45, 1152
    buffer_load_dwordx4 v2, s[8:11], s24 offen lds
    s_add_u32 m0, s47, 114688
    s_add_u32 s24, s46, 294912
    buffer_load_dwordx4 v3, s[12:15], s24 offen offset:0 lds
    buffer_load_dwordx4 v3, s[12:15], s24 offen offset:1024 lds
    buffer_load_dwordx4 v3, s[12:15], s24 offen offset:2048 lds
    buffer_load_dwordx4 v3, s[12:15], s24 offen offset:3072 lds
    s_waitcnt vmcnt(21)
    s_barrier
    s_add_u32 m0, s40, 0
    s_add_u32 s24, s43, 1280
    buffer_load_dwordx4 v2, s[8:11], s24 offen lds
    s_add_u32 m0, s41, 0
    s_add_u32 s24, s44, 1280
    buffer_load_dwordx4 v2, s[8:11], s24 offen lds
    s_add_u32 m0, s42, 0
    s_add_u32 s24, s45, 1280
    buffer_load_dwordx4 v2, s[8:11], s24 offen lds
    s_add_u32 m0, s47, 0
    s_add_u32 s24, s46, 327680
    buffer_load_dwordx4 v3, s[12:15], s24 offen offset:0 lds
    buffer_load_dwordx4 v3, s[12:15], s24 offen offset:1024 lds
    buffer_load_dwordx4 v3, s[12:15], s24 offen offset:2048 lds
    buffer_load_dwordx4 v3, s[12:15], s24 offen offset:3072 lds
    s_waitcnt vmcnt(21)
    s_barrier
    s_add_u32 m0, s40, 28672
    s_add_u32 s24, s43, 1408
    buffer_load_dwordx4 v2, s[8:11], s24 offen lds
    s_add_u32 m0, s41, 28672
    s_add_u32 s24, s44, 1408
    buffer_load_dwordx4 v2, s[8:11], s24 offen lds
    s_add_u32 m0, s42, 28672
    s_add_u32 s24, s45, 1408
    buffer_load_dwordx4 v2, s[8:11], s24 offen lds
    s_add_u32 m0, s47, 28672
    s_add_u32 s24, s46, 360448
    buffer_load_dwordx4 v3, s[12:15], s24 offen offset:0 lds
    buffer_load_dwordx4 v3, s[12:15], s24 offen offset:1024 lds
    buffer_load_dwordx4 v3, s[12:15], s24 offen offset:2048 lds
    buffer_load_dwordx4 v3, s[12:15], s24 offen offset:3072 lds
    s_waitcnt vmcnt(21)
    s_barrier
    s_add_u32 m0, s40, 57344
    s_add_u32 s24, s43, 1536
    buffer_load_dwordx4 v2, s[8:11], s24 offen lds
    s_add_u32 m0, s41, 57344
    s_add_u32 s24, s44, 1536
    buffer_load_dwordx4 v2, s[8:11], s24 offen lds
    s_add_u32 m0, s42, 57344
    s_add_u32 s24, s45, 1536
    buffer_load_dwordx4 v2, s[8:11], s24 offen lds
    s_add_u32 m0, s47, 57344
    s_add_u32 s24, s46, 393216
    buffer_load_dwordx4 v3, s[12:15], s24 offen offset:0 lds
    buffer_load_dwordx4 v3, s[12:15], s24 offen offset:1024 lds
    buffer_load_dwordx4 v3, s[12:15], s24 offen offset:2048 lds
    buffer_load_dwordx4 v3, s[12:15], s24 offen offset:3072 lds
    s_waitcnt vmcnt(21)
    s_barrier
    s_add_u32 m0, s40, 86016
    s_add_u32 s24, s43, 1664
    buffer_load_dwordx4 v2, s[8:11], s24 offen lds
    s_add_u32 m0, s41, 86016
    s_add_u32 s24, s44, 1664
    buffer_load_dwordx4 v2, s[8:11], s24 offen lds
    s_add_u32 m0, s42, 86016
    s_add_u32 s24, s45, 1664
    buffer_load_dwordx4 v2, s[8:11], s24 offen lds
    s_add_u32 m0, s47, 86016
    s_add_u32 s24, s46, 425984
    buffer_load_dwordx4 v3, s[12:15], s24 offen offset:0 lds
    buffer_load_dwordx4 v3, s[12:15], s24 offen offset:1024 lds
    buffer_load_dwordx4 v3, s[12:15], s24 offen offset:2048 lds
    buffer_load_dwordx4 v3, s[12:15], s24 offen offset:3072 lds
    s_waitcnt vmcnt(21)
    s_barrier
    s_add_u32 m0, s40, 114688
    s_add_u32 s24, s43, 1792
    buffer_load_dwordx4 v2, s[8:11], s24 offen lds
    s_add_u32 m0, s41, 114688
    s_add_u32 s24, s44, 1792
    buffer_load_dwordx4 v2, s[8:11], s24 offen lds
    s_add_u32 m0, s42, 114688
    s_add_u32 s24, s45, 1792
    buffer_load_dwordx4 v2, s[8:11], s24 offen lds
    s_add_u32 m0, s47, 114688
    s_add_u32 s24, s46, 458752
    buffer_load_dwordx4 v3, s[12:15], s24 offen offset:0 lds
    buffer_load_dwordx4 v3, s[12:15], s24 offen offset:1024 lds
    buffer_load_dwordx4 v3, s[12:15], s24 offen offset:2048 lds
    buffer_load_dwordx4 v3, s[12:15], s24 offen offset:3072 lds
    s_waitcnt vmcnt(21)
    s_barrier
    s_add_u32 m0, s40, 0
    s_add_u32 s24, s43, 1920
    buffer_load_dwordx4 v2, s[8:11], s24 offen lds
    s_add_u32 m0, s41, 0
    s_add_u32 s24, s44, 1920
    buffer_load_dwordx4 v2, s[8:11], s24 offen lds
    s_add_u32 m0, s42, 0
    s_add_u32 s24, s45, 1920
    buffer_load_dwordx4 v2, s[8:11], s24 offen lds
    s_add_u32 m0, s47, 0
    s_add_u32 s24, s46, 491520
    buffer_load_dwordx4 v3, s[12:15], s24 offen offset:0 lds
    buffer_load_dwordx4 v3, s[12:15], s24 offen offset:1024 lds
    buffer_load_dwordx4 v3, s[12:15], s24 offen offset:2048 lds
    buffer_load_dwordx4 v3, s[12:15], s24 offen offset:3072 lds
    s_waitcnt vmcnt(21)
    s_barrier
    s_waitcnt vmcnt(14)
    s_barrier
    s_waitcnt vmcnt(7)
    s_barrier
    s_waitcnt vmcnt(0)
    s_barrier
L_gemm1_kernel_done:
    s_endpgm
.globl mid_kernel
.p2align 8
.type mid_kernel,@function
mid_kernel:
    s_cmp_ge_u32 s2, 704
    s_cbranch_scc1 L_mid_kernel_done
    v_readfirstlane_b32 s20, v0
    s_lshr_b32 s20, s20, 6
    s_cmp_ge_u32 s2, 448
    s_cbranch_scc1 L_mid_kernel_g
    s_load_dwordx2 s[6:7], s[0:1], 72
    s_load_dwordx2 s[4:5], s[0:1], 72
    s_cmp_ge_u32 s2, 224
    s_cselect_b32 s24, 1, 0
    s_mul_i32 s25, s24, 224
    s_sub_u32 s25, s2, s25
    s_lshr_b32 s26, s25, 3
    s_and_b32 s27, s25, 7
    v_and_b32 v1, 63, v0
    v_lshrrev_b32 v2, 2, v1
    v_lshlrev_b32 v2, 6, v2
    v_lshrrev_b32 v3, 5, v1
    v_lshlrev_b32 v3, 1, v3
    v_and_b32 v4, 3, v1
    v_xor_b32 v3, v3, v4
    v_lshl_add_u32 v2, v3, 4, v2
    s_mul_i32 s28, s26, 6
    s_lshl_b32 s29, s20, 1
    s_add_u32 s28, s28, s29
    s_sub_u32 s28, s28, 1
    s_lshl_b32 s30, s27, 12
    s_add_u32 s31, s28, 0
    s_mul_i32 s32, s31, 37120
    s_add_u32 s32, s32, s30
    s_cmp_lt_i32 s31, 0
    s_cselect_b32 s32, 0x7f000000, s32
    v_add_u32 v3, s32, v2
    s_add_u32 s31, s28, 1
    s_mul_i32 s32, s31, 37120
    s_add_u32 s32, s32, s30
    s_cmp_lt_i32 s31, 0
    s_cselect_b32 s32, 0x7f000000, s32
    v_add_u32 v4, s32, v2
    s_waitcnt lgkmcnt(0)
    s_mul_i32 s33, s24, 6199040
    s_add_u32 s33, s33, 38871040
    s_add_u32 s8, s6, s33
    s_addc_u32 s9, s7, 0
    s_mov_b32 s10, 6199040
    s_mov_b32 s11, 0x00020000
    s_add_u32 s12, s6, 85499904
    s_addc_u32 s13, s7, 0
    s_mov_b32 s14, 16384
    s_mov_b32 s15, 0x00020000
    s_lshl_b32 s34, s20, 13
    s_add_u32 m0, s34, 0
    s_nop 0
    buffer_load_dwordx4 v3, s[8:11], 0 offen offset:0 lds
    buffer_load_dwordx4 v3, s[8:11], 0 offen offset:1024 lds
    buffer_load_dwordx4 v3, s[8:11], 0 offen offset:2048 lds
    buffer_load_dwordx4 v3, s[8:11], 0 offen offset:3072 lds
    s_add_u32 m0, s34, 4096
    s_nop 0
    buffer_load_dwordx4 v4, s[8:11], 0 offen offset:0 lds
    buffer_load_dwordx4 v4, s[8:11], 0 offen offset:1024 lds
    buffer_load_dwordx4 v4, s[8:11], 0 offen offset:2048 lds
    buffer_load_dwordx4 v4, s[8:11], 0 offen offset:3072 lds
    v_lshlrev_b32 v5, 4, v1
    s_mov_b32 s35, 8192
    buffer_load_dwordx4 v[8:11], v5, s[12:15], s35 offen
    s_mov_b32 s35, 9216
    buffer_load_dwordx4 v[12:15], v5, s[12:15], s35 offen
    s_mov_b32 s35, 10240
    buffer_load_dwordx4 v[16:19], v5, s[12:15], s35 offen
    s_mov_b32 s35, 11264
    buffer_load_dwordx4 v[20:23], v5, s[12:15], s35 offen
    s_mov_b32 s35, 12288
    buffer_load_dwordx4 v[24:27], v5, s[12:15], s35 offen
    s_mov_b32 s35, 13312
    buffer_load_dwordx4 v[28:31], v5, s[12:15], s35 offen
    s_lshl_b32 s35, s20, 11
    buffer_load_dwordx4 v[32:35], v5, s[12:15], s35 offen offset:0
    buffer_load_dwordx4 v[36:39], v5, s[12:15], s35 offen offset:1024
    v_bfe_u32 v40, v1, 2, 2
    v_lshrrev_b32 v41, 4, v1
    v_and_b32 v42, 3, v1
    v_lshl_add_u32 v43, v41, 3, v40
    v_lshlrev_b32 v46, 6, v43
    v_and_b32 v47, 1, v41
    v_lshlrev_b32 v47, 1, v47
    v_lshrrev_b32 v48, 1, v42
    v_xor_b32 v47, v47, v48
    v_lshl_add_u32 v46, v47, 4, v46
    v_and_b32 v48, 1, v42
    v_lshl_add_u32 v46, v48, 3, v46
    v_add_u32 v44, s34, v46
    v_xor_b32 v45, 32, v44
    v_add_u32 v49, 43008, v46
    v_xor_b32 v50, 32, v49
    v_add_u32 v47, 1, v43
    v_bfe_u32 v48, v47, 3, 1
    v_lshlrev_b32 v48, 1, v48
    v_lshrrev_b32 v55, 1, v42
    v_xor_b32 v48, v48, v55
    v_lshlrev_b32 v47, 6, v47
    v_lshl_add_u32 v47, v48, 4, v47
    v_and_b32 v48, 1, v42
    v_lshl_add_u32 v47, v48, 3, v47
    v_add_u32 v51, 32704, v47
    v_xor_b32 v52, 32, v51
    v_add_u32 v47, 5, v43
    v_bfe_u32 v48, v47, 3, 1
    v_lshlrev_b32 v48, 1, v48
    v_lshrrev_b32 v55, 1, v42
    v_xor_b32 v48, v48, v55
    v_lshlrev_b32 v47, 6, v47
    v_lshl_add_u32 v47, v48, 4, v47
    v_and_b32 v48, 1, v42
    v_lshl_add_u32 v47, v48, 3, v47
    v_add_u32 v53, 32704, v47
    v_xor_b32 v54, 32, v53
    v_and_b32 v47, 1, v1
    v_mul_u32_u24 v55, 10304, v47
    v_bfe_u32 v48, v1, 1, 3
    v_lshl_add_u32 v55, v48, 6, v55
    v_lshl_add_u32 v55, v41, 4, v55
    s_mul_i32 s35, s20, 3072
    s_add_u32 s35, s35, 31680
    v_add_u32 v56, s35, v55
    v_xor_b32 v57, 32, v56
    s_mul_i32 s35, s20, 48
    s_sub_u32 s35, s35, 17
    v_add_u32 v122, v48, v47
    v_add_u32 v122, s35, v122
    s_mov_b32 s35, 344064
    v_mul_lo_u32 v58, v48, s35
    v_and_b32 v47, 1, v1
    v_lshl_add_u32 v58, v47, 6, v58
    v_lshl_add_u32 v58, v41, 4, v58
    s_mov_b32 s36, 0xbdd2d3e8
    v_mov_b32 v59, 0xc0135761
    s_mov_b32 s42, 0xbdd2d3e8
    s_mov_b32 s43, 0xbdd2d3e8
    v_mov_b32 v120, 0xc0135761
    v_mov_b32 v121, 0xc0135761
    s_add_u32 s16, s4, 51269632
    s_addc_u32 s17, s5, 0
    s_mov_b32 s18, 11010048
    s_mov_b32 s19, 0x00020000
    s_mul_i32 s37, s20, 2752512
    s_mul_i32 s38, s24, 84
    s_mul_i32 s39, s26, 3
    s_add_u32 s38, s38, s39
    s_lshl_b32 s38, s38, 11
    s_add_u32 s37, s37, s38
    s_lshl_b32 s38, s27, 7
    s_add_u32 s37, s37, s38
    s_waitcnt vmcnt(2)
    ds_read_b64_tr_b16 v[60:61], v44 offset:0
    ds_read_b64_tr_b16 v[62:63], v44 offset:256
    ds_read_b64_tr_b16 v[64:65], v44 offset:2048
    ds_read_b64_tr_b16 v[66:67], v44 offset:2304
    ds_read_b64_tr_b16 v[68:69], v45 offset:0
    ds_read_b64_tr_b16 v[70:71], v45 offset:256
    ds_read_b64_tr_b16 v[72:73], v45 offset:2048
    ds_read_b64_tr_b16 v[74:75], v45 offset:2304
    s_waitcnt lgkmcnt(0)
    v_mfma_f32_16x16x32_bf16 v[76:79], v[60:63], v[8:11], 0
    v_mfma_f32_16x16x32_bf16 v[80:83], v[68:71], v[8:11], 0
    v_mfma_f32_16x16x32_bf16 v[84:87], v[60:63], v[16:19], 0
    v_mfma_f32_16x16x32_bf16 v[88:91], v[68:71], v[16:19], 0
    v_mfma_f32_16x16x32_bf16 v[92:95], v[60:63], v[24:27], 0
    v_mfma_f32_16x16x32_bf16 v[96:99], v[68:71], v[24:27], 0
    v_mfma_f32_16x16x32_bf16 v[76:79], v[64:67], v[12:15], v[76:79]
    v_mfma_f32_16x16x32_bf16 v[80:83], v[72:75], v[12:15], v[80:83]
    v_mfma_f32_16x16x32_bf16 v[84:87], v[64:67], v[20:23], v[84:87]
    v_mfma_f32_16x16x32_bf16 v[88:91], v[72:75], v[20:23], v[88:91]
    v_mfma_f32_16x16x32_bf16 v[92:95], v[64:67], v[28:31], v[92:95]
    v_mfma_f32_16x16x32_bf16 v[96:99], v[72:75], v[28:31], v[96:99]
    s_add_u32 s31, s28, 0
    s_cmp_eq_u32 s31, 166
    s_cselect_b32 s39, 0, -1
    s_nop 4
    v_mul_f32 v100, v76, v76
    v_mul_f32 v101, v77, v77
    v_mul_f32 v102, v78, v78
    v_mul_f32 v103, v79, v79
    v_mul_f32 v104, v80, v80
    v_mul_f32 v105, v81, v81
    v_mul_f32 v106, v82, v82
    v_mul_f32 v107, v83, v83
    v_fma_f32 v100, v100, s36, v59
    v_fma_f32 v101, v101, s36, v59
    v_fma_f32 v102, v102, s36, v59
    v_fma_f32 v103, v103, s36, v59
    v_fma_f32 v104, v104, s36, v59
    v_fma_f32 v105, v105, s36, v59
    v_fma_f32 v106, v106, s36, v59
    v_fma_f32 v107, v107, s36, v59
    v_mul_f32 v100, v100, v76
    v_mul_f32 v101, v101, v77
    v_mul_f32 v102, v102, v78
    v_mul_f32 v103, v103, v79
    v_mul_f32 v104, v104, v80
    v_mul_f32 v105, v105, v81
    v_mul_f32 v106, v106, v82
    v_mul_f32 v107, v107, v83
    v_exp_f32 v100, v100
    v_exp_f32 v101, v101
    v_exp_f32 v102, v102
    v_exp_f32 v103, v103
    v_exp_f32 v104, v104
    v_exp_f32 v105, v105
    v_exp_f32 v106, v106
    v_exp_f32 v107, v107
    v_add_f32 v100, 1.0, v100
    v_add_f32 v101, 1.0, v101
    v_add_f32 v102, 1.0, v102
    v_add_f32 v103, 1.0, v103
    v_add_f32 v104, 1.0, v104
    v_add_f32 v105, 1.0, v105
    v_add_f32 v106, 1.0, v106
    v_add_f32 v107, 1.0, v107
    v_rcp_f32 v100, v100
    v_rcp_f32 v101, v101
    v_rcp_f32 v102, v102
    v_rcp_f32 v103, v103
    v_rcp_f32 v104, v104
    v_rcp_f32 v105, v105
    v_rcp_f32 v106, v106
    v_rcp_f32 v107, v107
    v_mul_f32 v76, v76, v100
    v_mul_f32 v77, v77, v101
    v_mul_f32 v78, v78, v102
    v_mul_f32 v79, v79, v103
    v_mul_f32 v80, v80, v104
    v_mul_f32 v81, v81, v105
    v_mul_f32 v82, v82, v106
    v_mul_f32 v83, v83, v107
    v_cvt_pk_bf16_f32 v108, v76, v77
    v_cvt_pk_bf16_f32 v109, v78, v79
    v_cvt_pk_bf16_f32 v110, v80, v81
    v_cvt_pk_bf16_f32 v111, v82, v83
    v_add_u32 v123, 0, v122
    v_cmp_gt_u32 vcc, 160, v123
    s_nop 0
    s_and_saveexec_b64 s[40:41], vcc
    ds_write_b128 v56, v[108:111] offset:0
    s_mov_b64 exec, s[40:41]
    v_mul_f32 v100, v84, v84
    v_mul_f32 v101, v85, v85
    v_mul_f32 v102, v86, v86
    v_mul_f32 v103, v87, v87
    v_mul_f32 v104, v88, v88
    v_mul_f32 v105, v89, v89
    v_mul_f32 v106, v90, v90
    v_mul_f32 v107, v91, v91
    v_fma_f32 v100, v100, s36, v59
    v_fma_f32 v101, v101, s36, v59
    v_fma_f32 v102, v102, s36, v59
    v_fma_f32 v103, v103, s36, v59
    v_fma_f32 v104, v104, s36, v59
    v_fma_f32 v105, v105, s36, v59
    v_fma_f32 v106, v106, s36, v59
    v_fma_f32 v107, v107, s36, v59
    v_mul_f32 v100, v100, v84
    v_mul_f32 v101, v101, v85
    v_mul_f32 v102, v102, v86
    v_mul_f32 v103, v103, v87
    v_mul_f32 v104, v104, v88
    v_mul_f32 v105, v105, v89
    v_mul_f32 v106, v106, v90
    v_mul_f32 v107, v107, v91
    v_exp_f32 v100, v100
    v_exp_f32 v101, v101
    v_exp_f32 v102, v102
    v_exp_f32 v103, v103
    v_exp_f32 v104, v104
    v_exp_f32 v105, v105
    v_exp_f32 v106, v106
    v_exp_f32 v107, v107
    v_add_f32 v100, 1.0, v100
    v_add_f32 v101, 1.0, v101
    v_add_f32 v102, 1.0, v102
    v_add_f32 v103, 1.0, v103
    v_add_f32 v104, 1.0, v104
    v_add_f32 v105, 1.0, v105
    v_add_f32 v106, 1.0, v106
    v_add_f32 v107, 1.0, v107
    v_rcp_f32 v100, v100
    v_rcp_f32 v101, v101
    v_rcp_f32 v102, v102
    v_rcp_f32 v103, v103
    v_rcp_f32 v104, v104
    v_rcp_f32 v105, v105
    v_rcp_f32 v106, v106
    v_rcp_f32 v107, v107
    v_mul_f32 v84, v84, v100
    v_mul_f32 v85, v85, v101
    v_mul_f32 v86, v86, v102
    v_mul_f32 v87, v87, v103
    v_mul_f32 v88, v88, v104
    v_mul_f32 v89, v89, v105
    v_mul_f32 v90, v90, v106
    v_mul_f32 v91, v91, v107
    v_cvt_pk_bf16_f32 v112, v84, v85
    v_cvt_pk_bf16_f32 v113, v86, v87
    v_cvt_pk_bf16_f32 v114, v88, v89
    v_cvt_pk_bf16_f32 v115, v90, v91
    v_add_u32 v123, 8, v122
    v_cmp_gt_u32 vcc, 160, v123
    s_nop 0
    s_and_saveexec_b64 s[40:41], vcc
    ds_write_b128 v57, v[112:115] offset:512
    s_mov_b64 exec, s[40:41]
    v_mul_f32 v100, v92, v92
    v_mul_f32 v101, v93, v93
    v_mul_f32 v102, v94, v94
    v_mul_f32 v103, v95, v95
    v_mul_f32 v104, v96, v96
    v_mul_f32 v105, v97, v97
    v_mul_f32 v106, v98, v98
    v_mul_f32 v107, v99, v99
    v_fma_f32 v100, v100, s36, v59
    v_fma_f32 v101, v101, s36, v59
    v_fma_f32 v102, v102, s36, v59
    v_fma_f32 v103, v103, s36, v59
    v_fma_f32 v104, v104, s36, v59
    v_fma_f32 v105, v105, s36, v59
    v_fma_f32 v106, v106, s36, v59
    v_fma_f32 v107, v107, s36, v59
    v_mul_f32 v100, v100, v92
    v_mul_f32 v101, v101, v93
    v_mul_f32 v102, v102, v94
    v_mul_f32 v103, v103, v95
    v_mul_f32 v104, v104, v96
    v_mul_f32 v105, v105, v97
    v_mul_f32 v106, v106, v98
    v_mul_f32 v107, v107, v99
    v_exp_f32 v100, v100
    v_exp_f32 v101, v101
    v_exp_f32 v102, v102
    v_exp_f32 v103, v103
    v_exp_f32 v104, v104
    v_exp_f32 v105, v105
    v_exp_f32 v106, v106
    v_exp_f32 v107, v107
    v_add_f32 v100, 1.0, v100
    v_add_f32 v101, 1.0, v101
    v_add_f32 v102, 1.0, v102
    v_add_f32 v103, 1.0, v103
    v_add_f32 v104, 1.0, v104
    v_add_f32 v105, 1.0, v105
    v_add_f32 v106, 1.0, v106
    v_add_f32 v107, 1.0, v107
    v_rcp_f32 v100, v100
    v_rcp_f32 v101, v101
    v_rcp_f32 v102, v102
    v_rcp_f32 v103, v103
    v_rcp_f32 v104, v104
    v_rcp_f32 v105, v105
    v_rcp_f32 v106, v106
    v_rcp_f32 v107, v107
    v_mul_f32 v92, v92, v100
    v_mul_f32 v93, v93, v101
    v_mul_f32 v94, v94, v102
    v_mul_f32 v95, v95, v103
    v_mul_f32 v96, v96, v104
    v_mul_f32 v97, v97, v105
    v_mul_f32 v98, v98, v106
    v_mul_f32 v99, v99, v107
    v_cvt_pk_bf16_f32 v116, v92, v93
    v_cvt_pk_bf16_f32 v117, v94, v95
    v_cvt_pk_bf16_f32 v118, v96, v97
    v_cvt_pk_bf16_f32 v119, v98, v99
    v_and_b32 v116, s39, v116
    v_and_b32 v117, s39, v117
    v_and_b32 v118, s39, v118
    v_and_b32 v119, s39, v119
    v_add_u32 v123, 16, v122
    v_cmp_gt_u32 vcc, 160, v123
    s_nop 0
    s_and_saveexec_b64 s[40:41], vcc
    ds_write_b128 v56, v[116:119] offset:1024
    s_mov_b64 exec, s[40:41]
    ds_read_b64_tr_b16 v[60:61], v44 offset:4096
    ds_read_b64_tr_b16 v[62:63], v44 offset:4352
    ds_read_b64_tr_b16 v[64:65], v44 offset:6144
    ds_read_b64_tr_b16 v[66:67], v44 offset:6400
    ds_read_b64_tr_b16 v[68:69], v45 offset:4096
    ds_read_b64_tr_b16 v[70:71], v45 offset:4352
    ds_read_b64_tr_b16 v[72:73], v45 offset:6144
    ds_read_b64_tr_b16 v[74:75], v45 offset:6400
    s_waitcnt lgkmcnt(0)
    v_mfma_f32_16x16x32_bf16 v[76:79], v[60:63], v[8:11], 0
    v_mfma_f32_16x16x32_bf16 v[80:83], v[68:71], v[8:11], 0
    v_mfma_f32_16x16x32_bf16 v[84:87], v[60:63], v[16:19], 0
    v_mfma_f32_16x16x32_bf16 v[88:91], v[68:71], v[16:19], 0
    v_mfma_f32_16x16x32_bf16 v[92:95], v[60:63], v[24:27], 0
    v_mfma_f32_16x16x32_bf16 v[96:99], v[68:71], v[24:27], 0
    v_mfma_f32_16x16x32_bf16 v[76:79], v[64:67], v[12:15], v[76:79]
    v_mfma_f32_16x16x32_bf16 v[80:83], v[72:75], v[12:15], v[80:83]
    v_mfma_f32_16x16x32_bf16 v[84:87], v[64:67], v[20:23], v[84:87]
    v_mfma_f32_16x16x32_bf16 v[88:91], v[72:75], v[20:23], v[88:91]
    v_mfma_f32_16x16x32_bf16 v[92:95], v[64:67], v[28:31], v[92:95]
    v_mfma_f32_16x16x32_bf16 v[96:99], v[72:75], v[28:31], v[96:99]
    s_add_u32 s31, s28, 1
    s_cmp_eq_u32 s31, 166
    s_cselect_b32 s39, 0, -1
    s_nop 4
    v_mul_f32 v100, v76, v76
    v_mul_f32 v101, v77, v77
    v_mul_f32 v102, v78, v78
    v_mul_f32 v103, v79, v79
    v_mul_f32 v104, v80, v80
    v_mul_f32 v105, v81, v81
    v_mul_f32 v106, v82, v82
    v_mul_f32 v107, v83, v83
    v_fma_f32 v100, v100, s36, v59
    v_fma_f32 v101, v101, s36, v59
    v_fma_f32 v102, v102, s36, v59
    v_fma_f32 v103, v103, s36, v59
    v_fma_f32 v104, v104, s36, v59
    v_fma_f32 v105, v105, s36, v59
    v_fma_f32 v106, v106, s36, v59
    v_fma_f32 v107, v107, s36, v59
    v_mul_f32 v100, v100, v76
    v_mul_f32 v101, v101, v77
    v_mul_f32 v102, v102, v78
    v_mul_f32 v103, v103, v79
    v_mul_f32 v104, v104, v80
    v_mul_f32 v105, v105, v81
    v_mul_f32 v106, v106, v82
    v_mul_f32 v107, v107, v83
    v_exp_f32 v100, v100
    v_exp_f32 v101, v101
    v_exp_f32 v102, v102
    v_exp_f32 v103, v103
    v_exp_f32 v104, v104
    v_exp_f32 v105, v105
    v_exp_f32 v106, v106
    v_exp_f32 v107, v107
    v_add_f32 v100, 1.0, v100
    v_add_f32 v101, 1.0, v101
    v_add_f32 v102, 1.0, v102
    v_add_f32 v103, 1.0, v103
    v_add_f32 v104, 1.0, v104
    v_add_f32 v105, 1.0, v105
    v_add_f32 v106, 1.0, v106
    v_add_f32 v107, 1.0, v107
    v_rcp_f32 v100, v100
    v_rcp_f32 v101, v101
    v_rcp_f32 v102, v102
    v_rcp_f32 v103, v103
    v_rcp_f32 v104, v104
    v_rcp_f32 v105, v105
    v_rcp_f32 v106, v106
    v_rcp_f32 v107, v107
    v_mul_f32 v76, v76, v100
    v_mul_f32 v77, v77, v101
    v_mul_f32 v78, v78, v102
    v_mul_f32 v79, v79, v103
    v_mul_f32 v80, v80, v104
    v_mul_f32 v81, v81, v105
    v_mul_f32 v82, v82, v106
    v_mul_f32 v83, v83, v107
    v_cvt_pk_bf16_f32 v108, v76, v77
    v_cvt_pk_bf16_f32 v109, v78, v79
    v_cvt_pk_bf16_f32 v110, v80, v81
    v_cvt_pk_bf16_f32 v111, v82, v83
    v_add_u32 v123, 24, v122
    v_cmp_gt_u32 vcc, 160, v123
    s_nop 0
    s_and_saveexec_b64 s[40:41], vcc
    ds_write_b128 v57, v[108:111] offset:1536
    s_mov_b64 exec, s[40:41]
    v_mul_f32 v100, v84, v84
    v_mul_f32 v101, v85, v85
    v_mul_f32 v102, v86, v86
    v_mul_f32 v103, v87, v87
    v_mul_f32 v104, v88, v88
    v_mul_f32 v105, v89, v89
    v_mul_f32 v106, v90, v90
    v_mul_f32 v107, v91, v91
    v_fma_f32 v100, v100, s36, v59
    v_fma_f32 v101, v101, s36, v59
    v_fma_f32 v102, v102, s36, v59
    v_fma_f32 v103, v103, s36, v59
    v_fma_f32 v104, v104, s36, v59
    v_fma_f32 v105, v105, s36, v59
    v_fma_f32 v106, v106, s36, v59
    v_fma_f32 v107, v107, s36, v59
    v_mul_f32 v100, v100, v84
    v_mul_f32 v101, v101, v85
    v_mul_f32 v102, v102, v86
    v_mul_f32 v103, v103, v87
    v_mul_f32 v104, v104, v88
    v_mul_f32 v105, v105, v89
    v_mul_f32 v106, v106, v90
    v_mul_f32 v107, v107, v91
    v_exp_f32 v100, v100
    v_exp_f32 v101, v101
    v_exp_f32 v102, v102
    v_exp_f32 v103, v103
    v_exp_f32 v104, v104
    v_exp_f32 v105, v105
    v_exp_f32 v106, v106
    v_exp_f32 v107, v107
    v_add_f32 v100, 1.0, v100
    v_add_f32 v101, 1.0, v101
    v_add_f32 v102, 1.0, v102
    v_add_f32 v103, 1.0, v103
    v_add_f32 v104, 1.0, v104
    v_add_f32 v105, 1.0, v105
    v_add_f32 v106, 1.0, v106
    v_add_f32 v107, 1.0, v107
    v_rcp_f32 v100, v100
    v_rcp_f32 v101, v101
    v_rcp_f32 v102, v102
    v_rcp_f32 v103, v103
    v_rcp_f32 v104, v104
    v_rcp_f32 v105, v105
    v_rcp_f32 v106, v106
    v_rcp_f32 v107, v107
    v_mul_f32 v84, v84, v100
    v_mul_f32 v85, v85, v101
    v_mul_f32 v86, v86, v102
    v_mul_f32 v87, v87, v103
    v_mul_f32 v88, v88, v104
    v_mul_f32 v89, v89, v105
    v_mul_f32 v90, v90, v106
    v_mul_f32 v91, v91, v107
    v_cvt_pk_bf16_f32 v112, v84, v85
    v_cvt_pk_bf16_f32 v113, v86, v87
    v_cvt_pk_bf16_f32 v114, v88, v89
    v_cvt_pk_bf16_f32 v115, v90, v91
    v_add_u32 v123, 32, v122
    v_cmp_gt_u32 vcc, 160, v123
    s_nop 0
    s_and_saveexec_b64 s[40:41], vcc
    ds_write_b128 v56, v[112:115] offset:2048
    s_mov_b64 exec, s[40:41]
    v_mul_f32 v100, v92, v92
    v_mul_f32 v101, v93, v93
    v_mul_f32 v102, v94, v94
    v_mul_f32 v103, v95, v95
    v_mul_f32 v104, v96, v96
    v_mul_f32 v105, v97, v97
    v_mul_f32 v106, v98, v98
    v_mul_f32 v107, v99, v99
    v_fma_f32 v100, v100, s36, v59
    v_fma_f32 v101, v101, s36, v59
    v_fma_f32 v102, v102, s36, v59
    v_fma_f32 v103, v103, s36, v59
    v_fma_f32 v104, v104, s36, v59
    v_fma_f32 v105, v105, s36, v59
    v_fma_f32 v106, v106, s36, v59
    v_fma_f32 v107, v107, s36, v59
    v_mul_f32 v100, v100, v92
    v_mul_f32 v101, v101, v93
    v_mul_f32 v102, v102, v94
    v_mul_f32 v103, v103, v95
    v_mul_f32 v104, v104, v96
    v_mul_f32 v105, v105, v97
    v_mul_f32 v106, v106, v98
    v_mul_f32 v107, v107, v99
    v_exp_f32 v100, v100
    v_exp_f32 v101, v101
    v_exp_f32 v102, v102
    v_exp_f32 v103, v103
    v_exp_f32 v104, v104
    v_exp_f32 v105, v105
    v_exp_f32 v106, v106
    v_exp_f32 v107, v107
    v_add_f32 v100, 1.0, v100
    v_add_f32 v101, 1.0, v101
    v_add_f32 v102, 1.0, v102
    v_add_f32 v103, 1.0, v103
    v_add_f32 v104, 1.0, v104
    v_add_f32 v105, 1.0, v105
    v_add_f32 v106, 1.0, v106
    v_add_f32 v107, 1.0, v107
    v_rcp_f32 v100, v100
    v_rcp_f32 v101, v101
    v_rcp_f32 v102, v102
    v_rcp_f32 v103, v103
    v_rcp_f32 v104, v104
    v_rcp_f32 v105, v105
    v_rcp_f32 v106, v106
    v_rcp_f32 v107, v107
    v_mul_f32 v92, v92, v100
    v_mul_f32 v93, v93, v101
    v_mul_f32 v94, v94, v102
    v_mul_f32 v95, v95, v103
    v_mul_f32 v96, v96, v104
    v_mul_f32 v97, v97, v105
    v_mul_f32 v98, v98, v106
    v_mul_f32 v99, v99, v107
    v_cvt_pk_bf16_f32 v116, v92, v93
    v_cvt_pk_bf16_f32 v117, v94, v95
    v_cvt_pk_bf16_f32 v118, v96, v97
    v_cvt_pk_bf16_f32 v119, v98, v99
    v_and_b32 v116, s39, v116
    v_and_b32 v117, s39, v117
    v_and_b32 v118, s39, v118
    v_and_b32 v119, s39, v119
    v_add_u32 v123, 40, v122
    v_cmp_gt_u32 vcc, 160, v123
    s_nop 0
    s_and_saveexec_b64 s[40:41], vcc
    ds_write_b128 v57, v[116:119] offset:2560
    s_mov_b64 exec, s[40:41]
    s_waitcnt vmcnt(0)
    s_waitcnt lgkmcnt(0)
    s_barrier
    ds_read_b64_tr_b16 v[60:61], v49 offset:0
    ds_read_b64_tr_b16 v[62:63], v49 offset:256
    ds_read_b64_tr_b16 v[64:65], v49 offset:2048
    ds_read_b64_tr_b16 v[66:67], v49 offset:2304
    ds_read_b64_tr_b16 v[68:69], v50 offset:0
    ds_read_b64_tr_b16 v[70:71], v50 offset:256
    ds_read_b64_tr_b16 v[72:73], v50 offset:2048
    ds_read_b64_tr_b16 v[74:75], v50 offset:2304
    s_waitcnt lgkmcnt(0)
    v_mfma_f32_16x16x32_bf16 v[92:95], v[60:63], v[32:35], 0
    v_mfma_f32_16x16x32_bf16 v[96:99], v[68:71], v[32:35], 0
    v_mfma_f32_16x16x32_bf16 v[92:95], v[64:67], v[36:39], v[92:95]
    v_mfma_f32_16x16x32_bf16 v[96:99], v[72:75], v[36:39], v[96:99]
    ds_read_b64_tr_b16 v[76:77], v51 offset:0
    ds_read_b64_tr_b16 v[78:79], v53 offset:0
    ds_read_b64_tr_b16 v[80:81], v51 offset:2048
    ds_read_b64_tr_b16 v[82:83], v53 offset:2048
    ds_read_b64_tr_b16 v[84:85], v52 offset:0
    ds_read_b64_tr_b16 v[86:87], v54 offset:0
    ds_read_b64_tr_b16 v[88:89], v52 offset:2048
    ds_read_b64_tr_b16 v[90:91], v54 offset:2048
    v_cvt_pk_bf16_f32 v108, v92, v93
    v_cvt_pk_bf16_f32 v109, v94, v95
    v_cvt_pk_bf16_f32 v110, v96, v97
    v_cvt_pk_bf16_f32 v111, v98, v99
    s_add_u32 s38, s37, 0
    buffer_store_dwordx4 v[108:111], v58, s[16:19], s38 offen sc1
    s_waitcnt lgkmcnt(0)
    v_mfma_f32_16x16x32_bf16 v[100:103], v[76:79], v[32:35], 0
    v_mfma_f32_16x16x32_bf16 v[104:107], v[84:87], v[32:35], 0
    v_mfma_f32_16x16x32_bf16 v[100:103], v[80:83], v[36:39], v[100:103]
    v_mfma_f32_16x16x32_bf16 v[104:107], v[88:91], v[36:39], v[104:107]
    ds_read_b64_tr_b16 v[60:61], v49 offset:3072
    ds_read_b64_tr_b16 v[62:63], v49 offset:3328
    ds_read_b64_tr_b16 v[64:65], v49 offset:5120
    ds_read_b64_tr_b16 v[66:67], v49 offset:5376
    ds_read_b64_tr_b16 v[68:69], v50 offset:3072
    ds_read_b64_tr_b16 v[70:71], v50 offset:3328
    ds_read_b64_tr_b16 v[72:73], v50 offset:5120
    ds_read_b64_tr_b16 v[74:75], v50 offset:5376
    v_cvt_pk_bf16_f32 v112, v100, v101
    v_cvt_pk_bf16_f32 v113, v102, v103
    v_cvt_pk_bf16_f32 v114, v104, v105
    v_cvt_pk_bf16_f32 v115, v106, v107
    s_add_u32 s38, s37, 1024
    buffer_store_dwordx4 v[112:115], v58, s[16:19], s38 offen sc1
    s_waitcnt lgkmcnt(0)
    v_mfma_f32_16x16x32_bf16 v[92:95], v[60:63], v[32:35], 0
    v_mfma_f32_16x16x32_bf16 v[96:99], v[68:71], v[32:35], 0
    v_mfma_f32_16x16x32_bf16 v[92:95], v[64:67], v[36:39], v[92:95]
    v_mfma_f32_16x16x32_bf16 v[96:99], v[72:75], v[36:39], v[96:99]
    ds_read_b64_tr_b16 v[76:77], v51 offset:3072
    ds_read_b64_tr_b16 v[78:79], v53 offset:3072
    ds_read_b64_tr_b16 v[80:81], v51 offset:5120
    ds_read_b64_tr_b16 v[82:83], v53 offset:5120
    ds_read_b64_tr_b16 v[84:85], v52 offset:3072
    ds_read_b64_tr_b16 v[86:87], v54 offset:3072
    ds_read_b64_tr_b16 v[88:89], v52 offset:5120
    ds_read_b64_tr_b16 v[90:91], v54 offset:5120
    v_cvt_pk_bf16_f32 v108, v92, v93
    v_cvt_pk_bf16_f32 v109, v94, v95
    v_cvt_pk_bf16_f32 v110, v96, v97
    v_cvt_pk_bf16_f32 v111, v98, v99
    s_add_u32 s38, s37, 2048
    buffer_store_dwordx4 v[108:111], v58, s[16:19], s38 offen sc1
    s_waitcnt lgkmcnt(0)
    v_mfma_f32_16x16x32_bf16 v[100:103], v[76:79], v[32:35], 0
    v_mfma_f32_16x16x32_bf16 v[104:107], v[84:87], v[32:35], 0
    v_mfma_f32_16x16x32_bf16 v[100:103], v[80:83], v[36:39], v[100:103]
    v_mfma_f32_16x16x32_bf16 v[104:107], v[88:91], v[36:39], v[104:107]
    ds_read_b64_tr_b16 v[60:61], v49 offset:6144
    ds_read_b64_tr_b16 v[62:63], v49 offset:6400
    ds_read_b64_tr_b16 v[64:65], v49 offset:8192
    ds_read_b64_tr_b16 v[66:67], v49 offset:8448
    ds_read_b64_tr_b16 v[68:69], v50 offset:6144
    ds_read_b64_tr_b16 v[70:71], v50 offset:6400
    ds_read_b64_tr_b16 v[72:73], v50 offset:8192
    ds_read_b64_tr_b16 v[74:75], v50 offset:8448
    v_cvt_pk_bf16_f32 v112, v100, v101
    v_cvt_pk_bf16_f32 v113, v102, v103
    v_cvt_pk_bf16_f32 v114, v104, v105
    v_cvt_pk_bf16_f32 v115, v106, v107
    s_add_u32 s38, s37, 3072
    buffer_store_dwordx4 v[112:115], v58, s[16:19], s38 offen sc1
    s_waitcnt lgkmcnt(0)
    v_mfma_f32_16x16x32_bf16 v[92:95], v[60:63], v[32:35], 0
    v_mfma_f32_16x16x32_bf16 v[96:99], v[68:71], v[32:35], 0
    v_mfma_f32_16x16x32_bf16 v[92:95], v[64:67], v[36:39], v[92:95]
    v_mfma_f32_16x16x32_bf16 v[96:99], v[72:75], v[36:39], v[96:99]
    ds_read_b64_tr_b16 v[76:77], v51 offset:6144
    ds_read_b64_tr_b16 v[78:79], v53 offset:6144
    ds_read_b64_tr_b16 v[80:81], v51 offset:8192
    ds_read_b64_tr_b16 v[82:83], v53 offset:8192
    ds_read_b64_tr_b16 v[84:85], v52 offset:6144
    ds_read_b64_tr_b16 v[86:87], v54 offset:6144
    ds_read_b64_tr_b16 v[88:89], v52 offset:8192
    ds_read_b64_tr_b16 v[90:91], v54 offset:8192
    v_cvt_pk_bf16_f32 v108, v92, v93
    v_cvt_pk_bf16_f32 v109, v94, v95
    v_cvt_pk_bf16_f32 v110, v96, v97
    v_cvt_pk_bf16_f32 v111, v98, v99
    s_add_u32 s38, s37, 4096
    buffer_store_dwordx4 v[108:111], v58, s[16:19], s38 offen sc1
    s_waitcnt lgkmcnt(0)
    v_mfma_f32_16x16x32_bf16 v[100:103], v[76:79], v[32:35], 0
    v_mfma_f32_16x16x32_bf16 v[104:107], v[84:87], v[32:35], 0
    v_mfma_f32_16x16x32_bf16 v[100:103], v[80:83], v[36:39], v[100:103]
    v_mfma_f32_16x16x32_bf16 v[104:107], v[88:91], v[36:39], v[104:107]
    s_nop 7
    v_cvt_pk_bf16_f32 v112, v100, v101
    v_cvt_pk_bf16_f32 v113, v102, v103
    v_cvt_pk_bf16_f32 v114, v104, v105
    v_cvt_pk_bf16_f32 v115, v106, v107
    s_add_u32 s38, s37, 5120
    buffer_store_dwordx4 v[112:115], v58, s[16:19], s38 offen sc1
    s_endpgm
L_mid_kernel_g:
    s_sub_u32 s3, s2, 448
    s_load_dwordx2 s[4:5], s[0:1], 16
    s_load_dwordx2 s[6:7], s[0:1], 72
    s_lshr_b32 s24, s3, 4
    s_bfe_u32 s25, s3, 0x20002
    s_and_b32 s26, s3, 3
    s_lshr_b32 s27, s24, 3
    s_and_b32 s28, s24, 7
    v_and_b32 v1, 63, v0
    v_lshrrev_b32 v2, 3, v1
    v_mov_b32 v3, v2
    s_lshl_b32 s29, s25, 3
    s_lshl_b32 s30, s28, 5
    s_add_u32 s29, s29, s30
    v_add_u32 v3, s29, v3
    v_lshlrev_b32 v3, 9, v3
    v_and_b32 v4, 7, v1
    s_lshr_b32 s30, s20, 1
    s_lshl_b32 s30, s30, 2
    v_xor_b32 v4, s30, v4
    v_lshl_add_u32 v3, v4, 4, v3
    s_lshl_b32 s30, s26, 7
    v_add_u32 v3, s30, v3
    v_xor_b32 v4, 32, v3
    s_waitcnt lgkmcnt(0)
    s_mov_b32 s8, s4
    s_mov_b32 s9, s5
    s_mov_b32 s10, 4063232
    s_mov_b32 s11, 0x00020000
    s_add_u32 s12, s6, 62345216
    s_addc_u32 s13, s7, 0
    s_mov_b32 s14, 16916480
    s_mov_b32 s15, 0x00020000
    s_lshl_b32 s30, s20, 3
    s_add_u32 s30, s30, s27
    s_lshl_b32 s30, s30, 17
    s_mul_i32 s31, s20, 4608
    s_add_u32 m0, s31, 0
    s_add_u32 s32, s30, 0
    buffer_load_dwordx4 v3, s[8:11], s32 offen nt lds
    s_add_u32 m0, s31, 1152
    s_add_u32 s32, s30, 262144
    buffer_load_dwordx4 v3, s[8:11], s32 offen nt lds
    s_add_u32 m0, s31, 2304
    s_add_u32 s32, s30, 524288
    buffer_load_dwordx4 v4, s[8:11], s32 offen nt lds
    s_add_u32 m0, s31, 3456
    s_add_u32 s32, s30, 786432
    buffer_load_dwordx4 v4, s[8:11], s32 offen nt lds
    v_and_b32 v8, 15, v1
    v_or_b32 v9, 1, v8
    s_lshl_b32 s33, s20, 4
    v_add_u32 v9, s33, v9
    v_cvt_f32_u32 v9, v9
    v_mul_f32 v9, 0x3c000000, v9
    v_bfe_u32 v10, v1, 4, 1
    v_lshlrev_b32 v10, 3, v10
    v_cvt_f32_u32 v10, v10
    v_and_b32 v8, 1, v8
    v_cvt_f32_u32 v8, v8
    v_mul_f32 v8, 0x3f400000, v8
    v_fma_f32 v11, v9, v10, v8
    v_fract_f32 v12, v11
    v_add_f32 v11, v11, v9
    v_fract_f32 v13, v11
    v_add_f32 v11, v11, v9
    v_fract_f32 v14, v11
    v_add_f32 v11, v11, v9
    v_fract_f32 v15, v11
    v_add_f32 v11, v11, v9
    v_fract_f32 v16, v11
    v_add_f32 v11, v11, v9
    v_fract_f32 v17, v11
    v_add_f32 v11, v11, v9
    v_fract_f32 v18, v11
    v_add_f32 v11, v11, v9
    v_fract_f32 v19, v11
    v_cos_f32 v12, v12
    v_cos_f32 v13, v13
    v_cos_f32 v14, v14
    v_cos_f32 v15, v15
    v_cos_f32 v16, v16
    v_cos_f32 v17, v17
    v_cos_f32 v18, v18
    v_cos_f32 v19, v19
    s_nop 0
    v_mul_f32 v12, 0x3d000000, v12
    v_mul_f32 v13, 0x3d000000, v13
    v_mul_f32 v14, 0x3d000000, v14
    v_mul_f32 v15, 0x3d000000, v15
    v_mul_f32 v16, 0x3d000000, v16
    v_mul_f32 v17, 0x3d000000, v17
    v_mul_f32 v18, 0x3d000000, v18
    v_mul_f32 v19, 0x3d000000, v19
    v_cvt_pk_bf16_f32 v20, v12, v13
    v_cvt_pk_bf16_f32 v21, v14, v15
    v_cvt_pk_bf16_f32 v22, v16, v17
    v_cvt_pk_bf16_f32 v23, v18, v19
    v_lshlrev_b32 v28, 16, v20
    v_and_b32 v29, 0xffff0000, v20
    v_sub_f32 v28, v12, v28
    v_sub_f32 v29, v13, v29
    v_cvt_pk_bf16_f32 v24, v28, v29
    v_lshlrev_b32 v28, 16, v21
    v_and_b32 v29, 0xffff0000, v21
    v_sub_f32 v28, v14, v28
    v_sub_f32 v29, v15, v29
    v_cvt_pk_bf16_f32 v25, v28, v29
    v_lshlrev_b32 v28, 16, v22
    v_and_b32 v29, 0xffff0000, v22
    v_sub_f32 v28, v16, v28
    v_sub_f32 v29, v17, v29
    v_cvt_pk_bf16_f32 v26, v28, v29
    v_lshlrev_b32 v28, 16, v23
    v_and_b32 v29, 0xffff0000, v23
    v_sub_f32 v28, v18, v28
    v_sub_f32 v29, v19, v29
    v_cvt_pk_bf16_f32 v27, v28, v29
    v_cmp_gt_u32 vcc, 32, v1
    s_nop 1
    v_cndmask_b32 v20, v24, v20, vcc
    v_cndmask_b32 v21, v25, v21, vcc
    v_cndmask_b32 v22, v26, v22, vcc
    v_cndmask_b32 v23, v27, v23, vcc
    v_lshlrev_b32 v28, 4, v1
    s_lshl_b32 s33, s20, 10
    v_add_u32 v29, s33, v28
    ds_write_b128 v29, v[20:23] offset:18432
    v_bfe_u32 v30, v1, 2, 2
    v_bfe_u32 v31, v1, 4, 1
    v_lshl_add_u32 v32, v31, 3, v30
    v_mul_u32_u24 v32, 1152, v32
    v_lshrrev_b32 v30, 1, v30
    v_lshl_add_u32 v30, v31, 1, v30
    v_lshlrev_b32 v30, 1, v30
    v_bfe_u32 v31, v1, 1, 1
    s_lshl_b32 s33, s20, 1
    v_add_u32 v31, s33, v31
    v_xor_b32 v30, v30, v31
    v_lshl_add_u32 v32, v30, 4, v32
    v_and_b32 v30, 1, v1
    v_lshl_add_u32 v32, v30, 3, v32
    v_lshrrev_b32 v30, 4, v1
    s_mov_b32 s33, 1057280
    v_mul_lo_u32 v30, v30, s33
    v_and_b32 v31, 15, v1
    v_lshl_add_u32 v33, v31, 4, v30
    s_lshl_b32 s34, s24, 15
    s_lshl_b32 s35, s26, 2
    s_add_u32 s35, s35, s20
    s_lshl_b32 s35, s35, 11
    s_add_u32 s34, s34, s35
    s_lshl_b32 s35, s25, 8
    s_add_u32 s34, s34, s35
    s_waitcnt vmcnt(0) lgkmcnt(0)
    s_barrier
    ds_read_b128 v[36:39], v28 offset:18432
    ds_read_b128 v[40:43], v28 offset:19456
    ds_read_b128 v[44:47], v28 offset:20480
    ds_read_b128 v[48:51], v28 offset:21504
    ds_read_b64_tr_b16 v[52:53], v32 offset:0
    ds_read_b64_tr_b16 v[54:55], v32 offset:4608
    ds_read_b64_tr_b16 v[56:57], v32 offset:128
    ds_read_b64_tr_b16 v[58:59], v32 offset:4736
    ds_read_b64_tr_b16 v[60:61], v32 offset:256
    ds_read_b64_tr_b16 v[62:63], v32 offset:4864
    ds_read_b64_tr_b16 v[64:65], v32 offset:384
    ds_read_b64_tr_b16 v[66:67], v32 offset:4992
    ds_read_b64_tr_b16 v[68:69], v32 offset:512
    ds_read_b64_tr_b16 v[70:71], v32 offset:5120
    s_waitcnt lgkmcnt(8)
    ds_read_b64_tr_b16 v[72:73], v32 offset:640
    ds_read_b64_tr_b16 v[74:75], v32 offset:5248
    ds_read_b64_tr_b16 v[76:77], v32 offset:768
    ds_read_b64_tr_b16 v[78:79], v32 offset:5376
    ds_read_b64_tr_b16 v[80:81], v32 offset:896
    ds_read_b64_tr_b16 v[82:83], v32 offset:5504
    s_waitcnt lgkmcnt(0)
    v_mfma_f32_16x16x32_bf16 v[84:87], v[36:39], v[52:55], 0
    v_mfma_f32_16x16x32_bf16 v[88:91], v[36:39], v[56:59], 0
    v_mfma_f32_16x16x32_bf16 v[92:95], v[36:39], v[60:63], 0
    v_mfma_f32_16x16x32_bf16 v[96:99], v[36:39], v[64:67], 0
    v_mfma_f32_16x16x32_bf16 v[100:103], v[36:39], v[68:71], 0
    v_mfma_f32_16x16x32_bf16 v[104:107], v[36:39], v[72:75], 0
    v_mfma_f32_16x16x32_bf16 v[108:111], v[36:39], v[76:79], 0
    v_mfma_f32_16x16x32_bf16 v[112:115], v[36:39], v[80:83], 0
    s_nop 7
    v_cvt_pk_bf16_f32 v116, v84, v88
    v_cvt_pk_bf16_f32 v117, v92, v96
    v_cvt_pk_bf16_f32 v118, v100, v104
    v_cvt_pk_bf16_f32 v119, v108, v112
    s_add_u32 s35, s34, 0
    buffer_store_dwordx4 v[116:119], v33, s[12:15], s35 offen sc1
    s_nop 1
    v_cvt_pk_bf16_f32 v120, v85, v89
    v_cvt_pk_bf16_f32 v121, v93, v97
    v_cvt_pk_bf16_f32 v122, v101, v105
    v_cvt_pk_bf16_f32 v123, v109, v113
    s_add_u32 s35, s34, 1024
    buffer_store_dwordx4 v[120:123], v33, s[12:15], s35 offen sc1
    s_nop 1
    v_cvt_pk_bf16_f32 v116, v86, v90
    v_cvt_pk_bf16_f32 v117, v94, v98
    v_cvt_pk_bf16_f32 v118, v102, v106
    v_cvt_pk_bf16_f32 v119, v110, v114
    s_add_u32 s35, s34, 528640
    buffer_store_dwordx4 v[116:119], v33, s[12:15], s35 offen sc1
    s_nop 1
    v_cvt_pk_bf16_f32 v120, v87, v91
    v_cvt_pk_bf16_f32 v121, v95, v99
    v_cvt_pk_bf16_f32 v122, v103, v107
    v_cvt_pk_bf16_f32 v123, v111, v115
    s_add_u32 s35, s34, 529664
    buffer_store_dwordx4 v[120:123], v33, s[12:15], s35 offen sc1
    s_nop 1
    v_mfma_f32_16x16x32_bf16 v[84:87], v[40:43], v[52:55], 0
    v_mfma_f32_16x16x32_bf16 v[88:91], v[40:43], v[56:59], 0
    v_mfma_f32_16x16x32_bf16 v[92:95], v[40:43], v[60:63], 0
    v_mfma_f32_16x16x32_bf16 v[96:99], v[40:43], v[64:67], 0
    v_mfma_f32_16x16x32_bf16 v[100:103], v[40:43], v[68:71], 0
    v_mfma_f32_16x16x32_bf16 v[104:107], v[40:43], v[72:75], 0
    v_mfma_f32_16x16x32_bf16 v[108:111], v[40:43], v[76:79], 0
    v_mfma_f32_16x16x32_bf16 v[112:115], v[40:43], v[80:83], 0
    s_nop 7
    v_cvt_pk_bf16_f32 v116, v84, v88
    v_cvt_pk_bf16_f32 v117, v92, v96
    v_cvt_pk_bf16_f32 v118, v100, v104
    v_cvt_pk_bf16_f32 v119, v108, v112
    s_add_u32 s35, s34, 4229120
    buffer_store_dwordx4 v[116:119], v33, s[12:15], s35 offen sc1
    s_nop 1
    v_cvt_pk_bf16_f32 v120, v85, v89
    v_cvt_pk_bf16_f32 v121, v93, v97
    v_cvt_pk_bf16_f32 v122, v101, v105
    v_cvt_pk_bf16_f32 v123, v109, v113
    s_add_u32 s35, s34, 4230144
    buffer_store_dwordx4 v[120:123], v33, s[12:15], s35 offen sc1
    s_nop 1
    v_cvt_pk_bf16_f32 v116, v86, v90
    v_cvt_pk_bf16_f32 v117, v94, v98
    v_cvt_pk_bf16_f32 v118, v102, v106
    v_cvt_pk_bf16_f32 v119, v110, v114
    s_add_u32 s35, s34, 4757760
    buffer_store_dwordx4 v[116:119], v33, s[12:15], s35 offen sc1
    s_nop 1
    v_cvt_pk_bf16_f32 v120, v87, v91
    v_cvt_pk_bf16_f32 v121, v95, v99
    v_cvt_pk_bf16_f32 v122, v103, v107
    v_cvt_pk_bf16_f32 v123, v111, v115
    s_add_u32 s35, s34, 4758784
    buffer_store_dwordx4 v[120:123], v33, s[12:15], s35 offen sc1
    s_nop 1
    v_mfma_f32_16x16x32_bf16 v[84:87], v[44:47], v[52:55], 0
    v_mfma_f32_16x16x32_bf16 v[88:91], v[44:47], v[56:59], 0
    v_mfma_f32_16x16x32_bf16 v[92:95], v[44:47], v[60:63], 0
    v_mfma_f32_16x16x32_bf16 v[96:99], v[44:47], v[64:67], 0
    v_mfma_f32_16x16x32_bf16 v[100:103], v[44:47], v[68:71], 0
    v_mfma_f32_16x16x32_bf16 v[104:107], v[44:47], v[72:75], 0
    v_mfma_f32_16x16x32_bf16 v[108:111], v[44:47], v[76:79], 0
    v_mfma_f32_16x16x32_bf16 v[112:115], v[44:47], v[80:83], 0
    s_nop 7
    v_cvt_pk_bf16_f32 v116, v84, v88
    v_cvt_pk_bf16_f32 v117, v92, v96
    v_cvt_pk_bf16_f32 v118, v100, v104
    v_cvt_pk_bf16_f32 v119, v108, v112
    s_add_u32 s35, s34, 8458240
    buffer_store_dwordx4 v[116:119], v33, s[12:15], s35 offen sc1
    s_nop 1
    v_cvt_pk_bf16_f32 v120, v85, v89
    v_cvt_pk_bf16_f32 v121, v93, v97
    v_cvt_pk_bf16_f32 v122, v101, v105
    v_cvt_pk_bf16_f32 v123, v109, v113
    s_add_u32 s35, s34, 8459264
    buffer_store_dwordx4 v[120:123], v33, s[12:15], s35 offen sc1
    s_nop 1
    v_cvt_pk_bf16_f32 v116, v86, v90
    v_cvt_pk_bf16_f32 v117, v94, v98
    v_cvt_pk_bf16_f32 v118, v102, v106
    v_cvt_pk_bf16_f32 v119, v110, v114
    s_add_u32 s35, s34, 8986880
    buffer_store_dwordx4 v[116:119], v33, s[12:15], s35 offen sc1
    s_nop 1
    v_cvt_pk_bf16_f32 v120, v87, v91
    v_cvt_pk_bf16_f32 v121, v95, v99
    v_cvt_pk_bf16_f32 v122, v103, v107
    v_cvt_pk_bf16_f32 v123, v111, v115
    s_add_u32 s35, s34, 8987904
    buffer_store_dwordx4 v[120:123], v33, s[12:15], s35 offen sc1
    s_nop 1
    v_mfma_f32_16x16x32_bf16 v[84:87], v[48:51], v[52:55], 0
    v_mfma_f32_16x16x32_bf16 v[88:91], v[48:51], v[56:59], 0
    v_mfma_f32_16x16x32_bf16 v[92:95], v[48:51], v[60:63], 0
    v_mfma_f32_16x16x32_bf16 v[96:99], v[48:51], v[64:67], 0
    v_mfma_f32_16x16x32_bf16 v[100:103], v[48:51], v[68:71], 0
    v_mfma_f32_16x16x32_bf16 v[104:107], v[48:51], v[72:75], 0
    v_mfma_f32_16x16x32_bf16 v[108:111], v[48:51], v[76:79], 0
    v_mfma_f32_16x16x32_bf16 v[112:115], v[48:51], v[80:83], 0
    s_nop 7
    v_cvt_pk_bf16_f32 v116, v84, v88
    v_cvt_pk_bf16_f32 v117, v92, v96
    v_cvt_pk_bf16_f32 v118, v100, v104
    v_cvt_pk_bf16_f32 v119, v108, v112
    s_add_u32 s35, s34, 12687360
    buffer_store_dwordx4 v[116:119], v33, s[12:15], s35 offen sc1
    s_nop 1
    v_cvt_pk_bf16_f32 v120, v85, v89
    v_cvt_pk_bf16_f32 v121, v93, v97
    v_cvt_pk_bf16_f32 v122, v101, v105
    v_cvt_pk_bf16_f32 v123, v109, v113
    s_add_u32 s35, s34, 12688384
    buffer_store_dwordx4 v[120:123], v33, s[12:15], s35 offen sc1
    s_nop 1
    v_cvt_pk_bf16_f32 v116, v86, v90
    v_cvt_pk_bf16_f32 v117, v94, v98
    v_cvt_pk_bf16_f32 v118, v102, v106
    v_cvt_pk_bf16_f32 v119, v110, v114
    s_add_u32 s35, s34, 13216000
    buffer_store_dwordx4 v[116:119], v33, s[12:15], s35 offen sc1
    s_nop 1
    v_cvt_pk_bf16_f32 v120, v87, v91
    v_cvt_pk_bf16_f32 v121, v95, v99
    v_cvt_pk_bf16_f32 v122, v103, v107
    v_cvt_pk_bf16_f32 v123, v111, v115
    s_add_u32 s35, s34, 13217024
    buffer_store_dwordx4 v[120:123], v33, s[12:15], s35 offen sc1
    s_nop 1
    s_endpgm
L_mid_kernel_done:
    s_endpgm
.globl gemm2_kernel
.p2align 8
.type gemm2_kernel,@function
gemm2_kernel:
    s_cmp_ge_u32 s2, 256
    s_cbranch_scc1 L_gemm2_kernel_done
    s_load_dwordx2 s[4:5], s[0:1], 72
    s_load_dwordx2 s[6:7], s[0:1], 72
    v_readfirstlane_b32 s20, v0
    s_lshr_b32 s20, s20, 6
    s_and_b32 s24, s2, 7
    s_lshr_b32 s25, s2, 3
    s_lshr_b32 s26, s25, 3
    s_lshl_b32 s24, s24, 2
    s_add_u32 s21, s24, s26
    s_and_b32 s25, s25, 7
    s_lshr_b32 s26, s25, 2
    s_and_b32 s27, s25, 3
    s_mul_i32 s22, s26, 84
    s_sub_u32 s28, 168, s22
    s_min_u32 s28, s28, 84
    s_waitcnt lgkmcnt(0)
    s_mul_i32 s29, s21, 344064
    s_lshl_b32 s30, s22, 11
    s_add_u32 s29, s29, s30
    s_add_u32 s29, s29, 51269632
    s_add_u32 s8, s6, s29
    s_addc_u32 s9, s7, 0
    s_lshl_b32 s10, s28, 11
    s_mov_b32 s11, 0x00020000
    s_mul_i32 s29, s21, 528640
    s_mul_i32 s30, s27, 8192
    s_add_u32 s29, s29, s30
    s_add_u32 s29, s29, 62345216
    s_add_u32 s12, s4, s29
    s_addc_u32 s13, s5, 0
    s_mov_b32 s14, 499712
    s_mov_b32 s15, 0x00020000
    s_cmp_ge_u32 s20, 4
    s_cbranch_scc1 L_gemm2_kernel_loader
    s_mul_i32 s29, s22, 37120
    s_add_u32 s29, s29, 79261696
    s_add_u32 s16, s4, s29
    s_addc_u32 s17, s5, 0
    s_mul_i32 s18, s28, 37120
    s_mov_b32 s19, 0x00020000
    s_lshr_b32 s29, s20, 1
    s_and_b32 s30, s20, 1
    v_and_b32 v137, 15, v0
    v_bfe_u32 v138, v0, 4, 2
    v_and_b32 v139, 63, v0
    s_mul_i32 s31, s29, 6144
    v_and_b32 v140, 7, v137
    v_xor_b32 v140, v138, v140
    v_lshlrev_b32 v140, 4, v140
    v_lshl_add_u32 v140, v137, 7, v140
    v_add_u32 v140, s31, v140
    v_add_u32 v128, 0, v140
    v_xor_b32 v131, 64, v128
    v_add_u32 v129, 61440, v140
    v_xor_b32 v132, 64, v129
    v_add_u32 v130, 122880, v140
    v_xor_b32 v133, 64, v130
    s_mul_i32 s31, s30, 4096
    s_add_u32 s31, s31, 12288
    v_lshlrev_b32 v140, 4, v139
    v_add_u32 v140, s31, v140
    v_add_u32 v134, 0, v140
    v_add_u32 v135, 61440, v140
    v_add_u32 v136, 122880, v140
    v_and_b32 v144, 7, v137
    v_lshrrev_b32 v145, 3, v137
    v_mul_u32_u24 v142, 37120, v144
    v_lshl_add_u32 v142, v138, 4, v142
    s_mul_i32 s31, s29, 1781760
    v_add_u32 v142, s31, v142
    v_lshl_add_u32 v142, v145, 6, v142
    v_xor_b32 v145, 64, v142
    v_add_u32 v143, 296960, v145
    s_mul_i32 s31, s27, 2
    s_mul_i32 s29, s30, 1
    s_add_u32 s31, s31, s29
    s_lshl_b32 s31, s31, 12
    s_lshl_b32 s29, s21, 7
    s_add_u32 s33, s31, s29
    s_mov_b32 s34, 0x80008000
    s_barrier
    ds_read_b128 v[48:51], v134 offset:0
    ds_read_b128 v[64:67], v128 offset:0
    ds_read_b128 v[72:75], v128 offset:2048
    ds_read_b128 v[80:83], v128 offset:4096
    ds_read_b128 v[56:59], v134 offset:2048
    ds_read_b128 v[68:71], v131 offset:0
    ds_read_b128 v[76:79], v131 offset:2048
    ds_read_b128 v[84:87], v131 offset:4096
    ds_read_b128 v[52:55], v134 offset:1024
    ds_read_b128 v[60:63], v134 offset:3072
    s_waitcnt lgkmcnt(0)
    s_barrier
    v_mfma_f32_16x16x32_bf16 v[0:3], v[48:51], v[64:67], 0
    ds_read_b128 v[88:91], v134 offset:20480
    v_mfma_f32_16x16x32_bf16 v[4:7], v[48:51], v[72:75], 0
    ds_read_b128 v[104:107], v128 offset:20480
    v_mfma_f32_16x16x32_bf16 v[8:11], v[48:51], v[80:83], 0
    ds_read_b128 v[112:115], v128 offset:22528
    v_mfma_f32_16x16x32_bf16 v[12:15], v[56:59], v[64:67], 0
    ds_read_b128 v[120:123], v128 offset:24576
    v_mfma_f32_16x16x32_bf16 v[16:19], v[56:59], v[72:75], 0
    ds_read_b128 v[96:99], v134 offset:22528
    v_mfma_f32_16x16x32_bf16 v[20:23], v[56:59], v[80:83], 0
    ds_read_b128 v[108:111], v131 offset:20480
    v_mfma_f32_16x16x32_bf16 v[24:27], v[48:51], v[68:71], 0
    ds_read_b128 v[116:119], v131 offset:22528
    v_mfma_f32_16x16x32_bf16 v[28:31], v[48:51], v[76:79], 0
    ds_read_b128 v[124:127], v131 offset:24576
    v_mfma_f32_16x16x32_bf16 v[32:35], v[48:51], v[84:87], 0
    ds_read_b128 v[92:95], v134 offset:21504
    v_mfma_f32_16x16x32_bf16 v[36:39], v[56:59], v[68:71], 0
    ds_read_b128 v[100:103], v134 offset:23552
    v_mfma_f32_16x16x32_bf16 v[40:43], v[56:59], v[76:79], 0
    v_mfma_f32_16x16x32_bf16 v[44:47], v[56:59], v[84:87], 0
    v_mfma_f32_16x16x32_bf16 v[24:27], v[52:55], v[64:67], v[24:27]
    v_xor_b32 v68, s34, v68
    v_xor_b32 v69, s34, v69
    v_mfma_f32_16x16x32_bf16 v[28:31], v[52:55], v[72:75], v[28:31]
    v_xor_b32 v70, s34, v70
    v_xor_b32 v71, s34, v71
    v_mfma_f32_16x16x32_bf16 v[32:35], v[52:55], v[80:83], v[32:35]
    v_xor_b32 v76, s34, v76
    v_xor_b32 v77, s34, v77
    v_mfma_f32_16x16x32_bf16 v[36:39], v[60:63], v[64:67], v[36:39]
    v_xor_b32 v78, s34, v78
    v_xor_b32 v79, s34, v79
    v_mfma_f32_16x16x32_bf16 v[40:43], v[60:63], v[72:75], v[40:43]
    v_xor_b32 v84, s34, v84
    v_xor_b32 v85, s34, v85
    v_mfma_f32_16x16x32_bf16 v[44:47], v[60:63], v[80:83], v[44:47]
    v_xor_b32 v86, s34, v86
    v_xor_b32 v87, s34, v87
    v_mfma_f32_16x16x32_bf16 v[0:3], v[52:55], v[68:71], v[0:3]
    v_mfma_f32_16x16x32_bf16 v[4:7], v[52:55], v[76:79], v[4:7]
    v_mfma_f32_16x16x32_bf16 v[8:11], v[52:55], v[84:87], v[8:11]
    s_waitcnt lgkmcnt(0)
    s_barrier
    v_mfma_f32_16x16x32_bf16 v[12:15], v[60:63], v[68:71], v[12:15]
    v_mfma_f32_16x16x32_bf16 v[16:19], v[60:63], v[76:79], v[16:19]
    v_mfma_f32_16x16x32_bf16 v[20:23], v[60:63], v[84:87], v[20:23]
    v_mfma_f32_16x16x32_bf16 v[0:3], v[88:91], v[104:107], v[0:3]
    ds_read_b128 v[48:51], v134 offset:40960
    v_mfma_f32_16x16x32_bf16 v[4:7], v[88:91], v[112:115], v[4:7]
    ds_read_b128 v[64:67], v128 offset:40960
    v_mfma_f32_16x16x32_bf16 v[8:11], v[88:91], v[120:123], v[8:11]
    ds_read_b128 v[72:75], v128 offset:43008
    v_mfma_f32_16x16x32_bf16 v[12:15], v[96:99], v[104:107], v[12:15]
    ds_read_b128 v[80:83], v128 offset:45056
    v_mfma_f32_16x16x32_bf16 v[16:19], v[96:99], v[112:115], v[16:19]
    ds_read_b128 v[56:59], v134 offset:43008
    v_mfma_f32_16x16x32_bf16 v[20:23], v[96:99], v[120:123], v[20:23]
    ds_read_b128 v[68:71], v131 offset:40960
    v_mfma_f32_16x16x32_bf16 v[24:27], v[88:91], v[108:111], v[24:27]
    ds_read_b128 v[76:79], v131 offset:43008
    v_mfma_f32_16x16x32_bf16 v[28:31], v[88:91], v[116:119], v[28:31]
    ds_read_b128 v[84:87], v131 offset:45056
    v_mfma_f32_16x16x32_bf16 v[32:35], v[88:91], v[124:127], v[32:35]
    ds_read_b128 v[52:55], v134 offset:41984
    v_mfma_f32_16x16x32_bf16 v[36:39], v[96:99], v[108:111], v[36:39]
    ds_read_b128 v[60:63], v134 offset:44032
    v_mfma_f32_16x16x32_bf16 v[40:43], v[96:99], v[116:119], v[40:43]
    v_mfma_f32_16x16x32_bf16 v[44:47], v[96:99], v[124:127], v[44:47]
    v_mfma_f32_16x16x32_bf16 v[24:27], v[92:95], v[104:107], v[24:27]
    v_xor_b32 v108, s34, v108
    v_xor_b32 v109, s34, v109
    v_mfma_f32_16x16x32_bf16 v[28:31], v[92:95], v[112:115], v[28:31]
    v_xor_b32 v110, s34, v110
    v_xor_b32 v111, s34, v111
    v_mfma_f32_16x16x32_bf16 v[32:35], v[92:95], v[120:123], v[32:35]
    v_xor_b32 v116, s34, v116
    v_xor_b32 v117, s34, v117
    v_mfma_f32_16x16x32_bf16 v[36:39], v[100:103], v[104:107], v[36:39]
    v_xor_b32 v118, s34, v118
    v_xor_b32 v119, s34, v119
    v_mfma_f32_16x16x32_bf16 v[40:43], v[100:103], v[112:115], v[40:43]
    v_xor_b32 v124, s34, v124
    v_xor_b32 v125, s34, v125
    v_mfma_f32_16x16x32_bf16 v[44:47], v[100:103], v[120:123], v[44:47]
    v_xor_b32 v126, s34, v126
    v_xor_b32 v127, s34, v127
    v_mfma_f32_16x16x32_bf16 v[0:3], v[92:95], v[108:111], v[0:3]
    v_mfma_f32_16x16x32_bf16 v[4:7], v[92:95], v[116:119], v[4:7]
    v_mfma_f32_16x16x32_bf16 v[8:11], v[92:95], v[124:127], v[8:11]
    s_waitcnt lgkmcnt(0)
    s_barrier
    v_mfma_f32_16x16x32_bf16 v[12:15], v[100:103], v[108:111], v[12:15]
    v_mfma_f32_16x16x32_bf16 v[16:19], v[100:103], v[116:119], v[16:19]
    v_mfma_f32_16x16x32_bf16 v[20:23], v[100:103], v[124:127], v[20:23]
    v_mfma_f32_16x16x32_bf16 v[0:3], v[48:51], v[64:67], v[0:3]
    ds_read_b128 v[88:91], v135 offset:0
    v_mfma_f32_16x16x32_bf16 v[4:7], v[48:51], v[72:75], v[4:7]
    ds_read_b128 v[104:107], v129 offset:0
    v_mfma_f32_16x16x32_bf16 v[8:11], v[48:51], v[80:83], v[8:11]
    ds_read_b128 v[112:115], v129 offset:2048
    v_mfma_f32_16x16x32_bf16 v[12:15], v[56:59], v[64:67], v[12:15]
    ds_read_b128 v[120:123], v129 offset:4096
    v_mfma_f32_16x16x32_bf16 v[16:19], v[56:59], v[72:75], v[16:19]
    ds_read_b128 v[96:99], v135 offset:2048
    v_mfma_f32_16x16x32_bf16 v[20:23], v[56:59], v[80:83], v[20:23]
    ds_read_b128 v[108:111], v132 offset:0
    v_mfma_f32_16x16x32_bf16 v[24:27], v[48:51], v[68:71], v[24:27]
    ds_read_b128 v[116:119], v132 offset:2048
    v_mfma_f32_16x16x32_bf16 v[28:31], v[48:51], v[76:79], v[28:31]
    ds_read_b128 v[124:127], v132 offset:4096
    v_mfma_f32_16x16x32_bf16 v[32:35], v[48:51], v[84:87], v[32:35]
    ds_read_b128 v[92:95], v135 offset:1024
    v_mfma_f32_16x16x32_bf16 v[36:39], v[56:59], v[68:71], v[36:39]
    ds_read_b128 v[100:103], v135 offset:3072
    v_mfma_f32_16x16x32_bf16 v[40:43], v[56:59], v[76:79], v[40:43]
    v_mfma_f32_16x16x32_bf16 v[44:47], v[56:59], v[84:87], v[44:47]
    v_mfma_f32_16x16x32_bf16 v[24:27], v[52:55], v[64:67], v[24:27]
    v_xor_b32 v68, s34, v68
    v_xor_b32 v69, s34, v69
    v_mfma_f32_16x16x32_bf16 v[28:31], v[52:55], v[72:75], v[28:31]
    v_xor_b32 v70, s34, v70
    v_xor_b32 v71, s34, v71
    v_mfma_f32_16x16x32_bf16 v[32:35], v[52:55], v[80:83], v[32:35]
    v_xor_b32 v76, s34, v76
    v_xor_b32 v77, s34, v77
    v_mfma_f32_16x16x32_bf16 v[36:39], v[60:63], v[64:67], v[36:39]
    v_xor_b32 v78, s34, v78
    v_xor_b32 v79, s34, v79
    v_mfma_f32_16x16x32_bf16 v[40:43], v[60:63], v[72:75], v[40:43]
    v_xor_b32 v84, s34, v84
    v_xor_b32 v85, s34, v85
    v_mfma_f32_16x16x32_bf16 v[44:47], v[60:63], v[80:83], v[44:47]
    v_xor_b32 v86, s34, v86
    v_xor_b32 v87, s34, v87
    v_mfma_f32_16x16x32_bf16 v[0:3], v[52:55], v[68:71], v[0:3]
    v_mfma_f32_16x16x32_bf16 v[4:7], v[52:55], v[76:79], v[4:7]
    v_mfma_f32_16x16x32_bf16 v[8:11], v[52:55], v[84:87], v[8:11]
    s_waitcnt lgkmcnt(0)
    s_barrier
    v_mfma_f32_16x16x32_bf16 v[12:15], v[60:63], v[68:71], v[12:15]
    v_mfma_f32_16x16x32_bf16 v[16:19], v[60:63], v[76:79], v[16:19]
    v_mfma_f32_16x16x32_bf16 v[20:23], v[60:63], v[84:87], v[20:23]
    v_mfma_f32_16x16x32_bf16 v[0:3], v[88:91], v[104:107], v[0:3]
    ds_read_b128 v[48:51], v135 offset:20480
    v_mfma_f32_16x16x32_bf16 v[4:7], v[88:91], v[112:115], v[4:7]
    ds_read_b128 v[64:67], v129 offset:20480
    v_mfma_f32_16x16x32_bf16 v[8:11], v[88:91], v[120:123], v[8:11]
    ds_read_b128 v[72:75], v129 offset:22528
    v_mfma_f32_16x16x32_bf16 v[12:15], v[96:99], v[104:107], v[12:15]
    ds_read_b128 v[80:83], v129 offset:24576
    v_mfma_f32_16x16x32_bf16 v[16:19], v[96:99], v[112:115], v[16:19]
    ds_read_b128 v[56:59], v135 offset:22528
    v_mfma_f32_16x16x32_bf16 v[20:23], v[96:99], v[120:123], v[20:23]
    ds_read_b128 v[68:71], v132 offset:20480
    v_mfma_f32_16x16x32_bf16 v[24:27], v[88:91], v[108:111], v[24:27]
    ds_read_b128 v[76:79], v132 offset:22528
    v_mfma_f32_16x16x32_bf16 v[28:31], v[88:91], v[116:119], v[28:31]
    ds_read_b128 v[84:87], v132 offset:24576
    v_mfma_f32_16x16x32_bf16 v[32:35], v[88:91], v[124:127], v[32:35]
    ds_read_b128 v[52:55], v135 offset:21504
    v_mfma_f32_16x16x32_bf16 v[36:39], v[96:99], v[108:111], v[36:39]
    ds_read_b128 v[60:63], v135 offset:23552
    v_mfma_f32_16x16x32_bf16 v[40:43], v[96:99], v[116:119], v[40:43]
    v_mfma_f32_16x16x32_bf16 v[44:47], v[96:99], v[124:127], v[44:47]
    v_mfma_f32_16x16x32_bf16 v[24:27], v[92:95], v[104:107], v[24:27]
    v_xor_b32 v108, s34, v108
    v_xor_b32 v109, s34, v109
    v_mfma_f32_16x16x32_bf16 v[28:31], v[92:95], v[112:115], v[28:31]
    v_xor_b32 v110, s34, v110
    v_xor_b32 v111, s34, v111
    v_mfma_f32_16x16x32_bf16 v[32:35], v[92:95], v[120:123], v[32:35]
    v_xor_b32 v116, s34, v116
    v_xor_b32 v117, s34, v117
    v_mfma_f32_16x16x32_bf16 v[36:39], v[100:103], v[104:107], v[36:39]
    v_xor_b32 v118, s34, v118
    v_xor_b32 v119, s34, v119
    v_mfma_f32_16x16x32_bf16 v[40:43], v[100:103], v[112:115], v[40:43]
    v_xor_b32 v124, s34, v124
    v_xor_b32 v125, s34, v125
    v_mfma_f32_16x16x32_bf16 v[44:47], v[100:103], v[120:123], v[44:47]
    v_xor_b32 v126, s34, v126
    v_xor_b32 v127, s34, v127
    v_mfma_f32_16x16x32_bf16 v[0:3], v[92:95], v[108:111], v[0:3]
    v_mfma_f32_16x16x32_bf16 v[4:7], v[92:95], v[116:119], v[4:7]
    v_mfma_f32_16x16x32_bf16 v[8:11], v[92:95], v[124:127], v[8:11]
    s_waitcnt lgkmcnt(0)
    s_barrier
    v_mfma_f32_16x16x32_bf16 v[12:15], v[100:103], v[108:111], v[12:15]
    v_mfma_f32_16x16x32_bf16 v[16:19], v[100:103], v[116:119], v[16:19]
    v_mfma_f32_16x16x32_bf16 v[20:23], v[100:103], v[124:127], v[20:23]
    v_mfma_f32_16x16x32_bf16 v[0:3], v[48:51], v[64:67], v[0:3]
    ds_read_b128 v[88:91], v135 offset:40960
    v_mfma_f32_16x16x32_bf16 v[4:7], v[48:51], v[72:75], v[4:7]
    ds_read_b128 v[104:107], v129 offset:40960
    v_mfma_f32_16x16x32_bf16 v[8:11], v[48:51], v[80:83], v[8:11]
    ds_read_b128 v[112:115], v129 offset:43008
    v_mfma_f32_16x16x32_bf16 v[12:15], v[56:59], v[64:67], v[12:15]
    ds_read_b128 v[120:123], v129 offset:45056
    v_mfma_f32_16x16x32_bf16 v[16:19], v[56:59], v[72:75], v[16:19]
    ds_read_b128 v[96:99], v135 offset:43008
    v_mfma_f32_16x16x32_bf16 v[20:23], v[56:59], v[80:83], v[20:23]
    ds_read_b128 v[108:111], v132 offset:40960
    v_mfma_f32_16x16x32_bf16 v[24:27], v[48:51], v[68:71], v[24:27]
    ds_read_b128 v[116:119], v132 offset:43008
    v_mfma_f32_16x16x32_bf16 v[28:31], v[48:51], v[76:79], v[28:31]
    ds_read_b128 v[124:127], v132 offset:45056
    v_mfma_f32_16x16x32_bf16 v[32:35], v[48:51], v[84:87], v[32:35]
    ds_read_b128 v[92:95], v135 offset:41984
    v_mfma_f32_16x16x32_bf16 v[36:39], v[56:59], v[68:71], v[36:39]
    ds_read_b128 v[100:103], v135 offset:44032
    v_mfma_f32_16x16x32_bf16 v[40:43], v[56:59], v[76:79], v[40:43]
    v_mfma_f32_16x16x32_bf16 v[44:47], v[56:59], v[84:87], v[44:47]
    v_mfma_f32_16x16x32_bf16 v[24:27], v[52:55], v[64:67], v[24:27]
    v_xor_b32 v68, s34, v68
    v_xor_b32 v69, s34, v69
    v_mfma_f32_16x16x32_bf16 v[28:31], v[52:55], v[72:75], v[28:31]
    v_xor_b32 v70, s34, v70
    v_xor_b32 v71, s34, v71
    v_mfma_f32_16x16x32_bf16 v[32:35], v[52:55], v[80:83], v[32:35]
    v_xor_b32 v76, s34, v76
    v_xor_b32 v77, s34, v77
    v_mfma_f32_16x16x32_bf16 v[36:39], v[60:63], v[64:67], v[36:39]
    v_xor_b32 v78, s34, v78
    v_xor_b32 v79, s34, v79
    v_mfma_f32_16x16x32_bf16 v[40:43], v[60:63], v[72:75], v[40:43]
    v_xor_b32 v84, s34, v84
    v_xor_b32 v85, s34, v85
    v_mfma_f32_16x16x32_bf16 v[44:47], v[60:63], v[80:83], v[44:47]
    v_xor_b32 v86, s34, v86
    v_xor_b32 v87, s34, v87
    v_mfma_f32_16x16x32_bf16 v[0:3], v[52:55], v[68:71], v[0:3]
    v_mfma_f32_16x16x32_bf16 v[4:7], v[52:55], v[76:79], v[4:7]
    v_mfma_f32_16x16x32_bf16 v[8:11], v[52:55], v[84:87], v[8:11]
    s_waitcnt lgkmcnt(0)
    s_barrier
    v_mfma_f32_16x16x32_bf16 v[12:15], v[60:63], v[68:71], v[12:15]
    v_mfma_f32_16x16x32_bf16 v[16:19], v[60:63], v[76:79], v[16:19]
    v_mfma_f32_16x16x32_bf16 v[20:23], v[60:63], v[84:87], v[20:23]
    v_mfma_f32_16x16x32_bf16 v[0:3], v[88:91], v[104:107], v[0:3]
    ds_read_b128 v[48:51], v136 offset:0
    v_mfma_f32_16x16x32_bf16 v[4:7], v[88:91], v[112:115], v[4:7]
    ds_read_b128 v[64:67], v130 offset:0
    v_mfma_f32_16x16x32_bf16 v[8:11], v[88:91], v[120:123], v[8:11]
    ds_read_b128 v[72:75], v130 offset:2048
    v_mfma_f32_16x16x32_bf16 v[12:15], v[96:99], v[104:107], v[12:15]
    ds_read_b128 v[80:83], v130 offset:4096
    v_mfma_f32_16x16x32_bf16 v[16:19], v[96:99], v[112:115], v[16:19]
    ds_read_b128 v[56:59], v136 offset:2048
    v_mfma_f32_16x16x32_bf16 v[20:23], v[96:99], v[120:123], v[20:23]
    ds_read_b128 v[68:71], v133 offset:0
    v_mfma_f32_16x16x32_bf16 v[24:27], v[88:91], v[108:111], v[24:27]
    ds_read_b128 v[76:79], v133 offset:2048
    v_mfma_f32_16x16x32_bf16 v[28:31], v[88:91], v[116:119], v[28:31]
    ds_read_b128 v[84:87], v133 offset:4096
    v_mfma_f32_16x16x32_bf16 v[32:35], v[88:91], v[124:127], v[32:35]
    ds_read_b128 v[52:55], v136 offset:1024
    v_mfma_f32_16x16x32_bf16 v[36:39], v[96:99], v[108:111], v[36:39]
    ds_read_b128 v[60:63], v136 offset:3072
    v_mfma_f32_16x16x32_bf16 v[40:43], v[96:99], v[116:119], v[40:43]
    v_mfma_f32_16x16x32_bf16 v[44:47], v[96:99], v[124:127], v[44:47]
    v_mfma_f32_16x16x32_bf16 v[24:27], v[92:95], v[104:107], v[24:27]
    v_xor_b32 v108, s34, v108
    v_xor_b32 v109, s34, v109
    v_mfma_f32_16x16x32_bf16 v[28:31], v[92:95], v[112:115], v[28:31]
    v_xor_b32 v110, s34, v110
    v_xor_b32 v111, s34, v111
    v_mfma_f32_16x16x32_bf16 v[32:35], v[92:95], v[120:123], v[32:35]
    v_xor_b32 v116, s34, v116
    v_xor_b32 v117, s34, v117
    v_mfma_f32_16x16x32_bf16 v[36:39], v[100:103], v[104:107], v[36:39]
    v_xor_b32 v118, s34, v118
    v_xor_b32 v119, s34, v119
    v_mfma_f32_16x16x32_bf16 v[40:43], v[100:103], v[112:115], v[40:43]
    v_xor_b32 v124, s34, v124
    v_xor_b32 v125, s34, v125
    v_mfma_f32_16x16x32_bf16 v[44:47], v[100:103], v[120:123], v[44:47]
    v_xor_b32 v126, s34, v126
    v_xor_b32 v127, s34, v127
    v_mfma_f32_16x16x32_bf16 v[0:3], v[92:95], v[108:111], v[0:3]
    v_mfma_f32_16x16x32_bf16 v[4:7], v[92:95], v[116:119], v[4:7]
    v_mfma_f32_16x16x32_bf16 v[8:11], v[92:95], v[124:127], v[8:11]
    s_waitcnt lgkmcnt(0)
    s_barrier
    v_mfma_f32_16x16x32_bf16 v[12:15], v[100:103], v[108:111], v[12:15]
    v_mfma_f32_16x16x32_bf16 v[16:19], v[100:103], v[116:119], v[16:19]
    v_mfma_f32_16x16x32_bf16 v[20:23], v[100:103], v[124:127], v[20:23]
    v_mfma_f32_16x16x32_bf16 v[0:3], v[48:51], v[64:67], v[0:3]
    ds_read_b128 v[88:91], v134 offset:0
    v_mfma_f32_16x16x32_bf16 v[4:7], v[48:51], v[72:75], v[4:7]
    ds_read_b128 v[104:107], v128 offset:0
    v_mfma_f32_16x16x32_bf16 v[8:11], v[48:51], v[80:83], v[8:11]
    ds_read_b128 v[112:115], v128 offset:2048
    v_mfma_f32_16x16x32_bf16 v[12:15], v[56:59], v[64:67], v[12:15]
    ds_read_b128 v[120:123], v128 offset:4096
    v_mfma_f32_16x16x32_bf16 v[16:19], v[56:59], v[72:75], v[16:19]
    ds_read_b128 v[96:99], v134 offset:2048
    v_mfma_f32_16x16x32_bf16 v[20:23], v[56:59], v[80:83], v[20:23]
    ds_read_b128 v[108:111], v131 offset:0
    v_mfma_f32_16x16x32_bf16 v[24:27], v[48:51], v[68:71], v[24:27]
    ds_read_b128 v[116:119], v131 offset:2048
    v_mfma_f32_16x16x32_bf16 v[28:31], v[48:51], v[76:79], v[28:31]
    ds_read_b128 v[124:127], v131 offset:4096
    v_mfma_f32_16x16x32_bf16 v[32:35], v[48:51], v[84:87], v[32:35]
    ds_read_b128 v[92:95], v134 offset:1024
    v_mfma_f32_16x16x32_bf16 v[36:39], v[56:59], v[68:71], v[36:39]
    ds_read_b128 v[100:103], v134 offset:3072
    v_mfma_f32_16x16x32_bf16 v[40:43], v[56:59], v[76:79], v[40:43]
    v_mfma_f32_16x16x32_bf16 v[44:47], v[56:59], v[84:87], v[44:47]
    v_mfma_f32_16x16x32_bf16 v[24:27], v[52:55], v[64:67], v[24:27]
    v_xor_b32 v68, s34, v68
    v_xor_b32 v69, s34, v69
    v_mfma_f32_16x16x32_bf16 v[28:31], v[52:55], v[72:75], v[28:31]
    v_xor_b32 v70, s34, v70
    v_xor_b32 v71, s34, v71
    v_mfma_f32_16x16x32_bf16 v[32:35], v[52:55], v[80:83], v[32:35]
    v_xor_b32 v76, s34, v76
    v_xor_b32 v77, s34, v77
    v_mfma_f32_16x16x32_bf16 v[36:39], v[60:63], v[64:67], v[36:39]
    v_xor_b32 v78, s34, v78
    v_xor_b32 v79, s34, v79
    v_mfma_f32_16x16x32_bf16 v[40:43], v[60:63], v[72:75], v[40:43]
    v_xor_b32 v84, s34, v84
    v_xor_b32 v85, s34, v85
    v_mfma_f32_16x16x32_bf16 v[44:47], v[60:63], v[80:83], v[44:47]
    v_xor_b32 v86, s34, v86
    v_xor_b32 v87, s34, v87
    v_mfma_f32_16x16x32_bf16 v[0:3], v[52:55], v[68:71], v[0:3]
    v_mfma_f32_16x16x32_bf16 v[4:7], v[52:55], v[76:79], v[4:7]
    v_mfma_f32_16x16x32_bf16 v[8:11], v[52:55], v[84:87], v[8:11]
    s_waitcnt lgkmcnt(0)
    s_barrier
    v_mfma_f32_16x16x32_bf16 v[12:15], v[60:63], v[68:71], v[12:15]
    v_mfma_f32_16x16x32_bf16 v[16:19], v[60:63], v[76:79], v[16:19]
    v_mfma_f32_16x16x32_bf16 v[20:23], v[60:63], v[84:87], v[20:23]
    v_mfma_f32_16x16x32_bf16 v[0:3], v[88:91], v[104:107], v[0:3]
    ds_read_b128 v[48:51], v134 offset:20480
    v_mfma_f32_16x16x32_bf16 v[4:7], v[88:91], v[112:115], v[4:7]
    ds_read_b128 v[64:67], v128 offset:20480
    v_mfma_f32_16x16x32_bf16 v[8:11], v[88:91], v[120:123], v[8:11]
    ds_read_b128 v[72:75], v128 offset:22528
    v_mfma_f32_16x16x32_bf16 v[12:15], v[96:99], v[104:107], v[12:15]
    ds_read_b128 v[80:83], v128 offset:24576
    v_mfma_f32_16x16x32_bf16 v[16:19], v[96:99], v[112:115], v[16:19]
    ds_read_b128 v[56:59], v134 offset:22528
    v_mfma_f32_16x16x32_bf16 v[20:23], v[96:99], v[120:123], v[20:23]
    ds_read_b128 v[68:71], v131 offset:20480
    v_mfma_f32_16x16x32_bf16 v[24:27], v[88:91], v[108:111], v[24:27]
    ds_read_b128 v[76:79], v131 offset:22528
    v_mfma_f32_16x16x32_bf16 v[28:31], v[88:91], v[116:119], v[28:31]
    ds_read_b128 v[84:87], v131 offset:24576
    v_mfma_f32_16x16x32_bf16 v[32:35], v[88:91], v[124:127], v[32:35]
    ds_read_b128 v[52:55], v134 offset:21504
    v_mfma_f32_16x16x32_bf16 v[36:39], v[96:99], v[108:111], v[36:39]
    ds_read_b128 v[60:63], v134 offset:23552
    v_mfma_f32_16x16x32_bf16 v[40:43], v[96:99], v[116:119], v[40:43]
    v_mfma_f32_16x16x32_bf16 v[44:47], v[96:99], v[124:127], v[44:47]
    v_mfma_f32_16x16x32_bf16 v[24:27], v[92:95], v[104:107], v[24:27]
    v_xor_b32 v108, s34, v108
    v_xor_b32 v109, s34, v109
    v_mfma_f32_16x16x32_bf16 v[28:31], v[92:95], v[112:115], v[28:31]
    v_xor_b32 v110, s34, v110
    v_xor_b32 v111, s34, v111
    v_mfma_f32_16x16x32_bf16 v[32:35], v[92:95], v[120:123], v[32:35]
    v_xor_b32 v116, s34, v116
    v_xor_b32 v117, s34, v117
    v_mfma_f32_16x16x32_bf16 v[36:39], v[100:103], v[104:107], v[36:39]
    v_xor_b32 v118, s34, v118
    v_xor_b32 v119, s34, v119
    v_mfma_f32_16x16x32_bf16 v[40:43], v[100:103], v[112:115], v[40:43]
    v_xor_b32 v124, s34, v124
    v_xor_b32 v125, s34, v125
    v_mfma_f32_16x16x32_bf16 v[44:47], v[100:103], v[120:123], v[44:47]
    v_xor_b32 v126, s34, v126
    v_xor_b32 v127, s34, v127
    v_mfma_f32_16x16x32_bf16 v[0:3], v[92:95], v[108:111], v[0:3]
    v_mfma_f32_16x16x32_bf16 v[4:7], v[92:95], v[116:119], v[4:7]
    v_mfma_f32_16x16x32_bf16 v[8:11], v[92:95], v[124:127], v[8:11]
    s_waitcnt lgkmcnt(0)
    s_barrier
    v_mfma_f32_16x16x32_bf16 v[12:15], v[100:103], v[108:111], v[12:15]
    v_mfma_f32_16x16x32_bf16 v[16:19], v[100:103], v[116:119], v[16:19]
    v_mfma_f32_16x16x32_bf16 v[20:23], v[100:103], v[124:127], v[20:23]
    v_mfma_f32_16x16x32_bf16 v[0:3], v[48:51], v[64:67], v[0:3]
    ds_read_b128 v[88:91], v134 offset:40960
    v_mfma_f32_16x16x32_bf16 v[4:7], v[48:51], v[72:75], v[4:7]
    ds_read_b128 v[104:107], v128 offset:40960
    v_mfma_f32_16x16x32_bf16 v[8:11], v[48:51], v[80:83], v[8:11]
    ds_read_b128 v[112:115], v128 offset:43008
    v_mfma_f32_16x16x32_bf16 v[12:15], v[56:59], v[64:67], v[12:15]
    ds_read_b128 v[120:123], v128 offset:45056
    v_mfma_f32_16x16x32_bf16 v[16:19], v[56:59], v[72:75], v[16:19]
    ds_read_b128 v[96:99], v134 offset:43008
    v_mfma_f32_16x16x32_bf16 v[20:23], v[56:59], v[80:83], v[20:23]
    ds_read_b128 v[108:111], v131 offset:40960
    v_mfma_f32_16x16x32_bf16 v[24:27], v[48:51], v[68:71], v[24:27]
    ds_read_b128 v[116:119], v131 offset:43008
    v_mfma_f32_16x16x32_bf16 v[28:31], v[48:51], v[76:79], v[28:31]
    ds_read_b128 v[124:127], v131 offset:45056
    v_mfma_f32_16x16x32_bf16 v[32:35], v[48:51], v[84:87], v[32:35]
    ds_read_b128 v[92:95], v134 offset:41984
    v_mfma_f32_16x16x32_bf16 v[36:39], v[56:59], v[68:71], v[36:39]
    ds_read_b128 v[100:103], v134 offset:44032
    v_mfma_f32_16x16x32_bf16 v[40:43], v[56:59], v[76:79], v[40:43]
    v_mfma_f32_16x16x32_bf16 v[44:47], v[56:59], v[84:87], v[44:47]
    v_mfma_f32_16x16x32_bf16 v[24:27], v[52:55], v[64:67], v[24:27]
    v_xor_b32 v68, s34, v68
    v_xor_b32 v69, s34, v69
    v_mfma_f32_16x16x32_bf16 v[28:31], v[52:55], v[72:75], v[28:31]
    v_xor_b32 v70, s34, v70
    v_xor_b32 v71, s34, v71
    v_mfma_f32_16x16x32_bf16 v[32:35], v[52:55], v[80:83], v[32:35]
    v_xor_b32 v76, s34, v76
    v_xor_b32 v77, s34, v77
    v_mfma_f32_16x16x32_bf16 v[36:39], v[60:63], v[64:67], v[36:39]
    v_xor_b32 v78, s34, v78
    v_xor_b32 v79, s34, v79
    v_mfma_f32_16x16x32_bf16 v[40:43], v[60:63], v[72:75], v[40:43]
    v_xor_b32 v84, s34, v84
    v_xor_b32 v85, s34, v85
    v_mfma_f32_16x16x32_bf16 v[44:47], v[60:63], v[80:83], v[44:47]
    v_xor_b32 v86, s34, v86
    v_xor_b32 v87, s34, v87
    v_mfma_f32_16x16x32_bf16 v[0:3], v[52:55], v[68:71], v[0:3]
    v_mfma_f32_16x16x32_bf16 v[4:7], v[52:55], v[76:79], v[4:7]
    v_mfma_f32_16x16x32_bf16 v[8:11], v[52:55], v[84:87], v[8:11]
    s_waitcnt lgkmcnt(0)
    s_barrier
    v_mfma_f32_16x16x32_bf16 v[12:15], v[60:63], v[68:71], v[12:15]
    v_mfma_f32_16x16x32_bf16 v[16:19], v[60:63], v[76:79], v[16:19]
    v_mfma_f32_16x16x32_bf16 v[20:23], v[60:63], v[84:87], v[20:23]
    v_mfma_f32_16x16x32_bf16 v[0:3], v[88:91], v[104:107], v[0:3]
    ds_read_b128 v[48:51], v135 offset:0
    v_mfma_f32_16x16x32_bf16 v[4:7], v[88:91], v[112:115], v[4:7]
    ds_read_b128 v[64:67], v129 offset:0
    v_mfma_f32_16x16x32_bf16 v[8:11], v[88:91], v[120:123], v[8:11]
    ds_read_b128 v[72:75], v129 offset:2048
    v_mfma_f32_16x16x32_bf16 v[12:15], v[96:99], v[104:107], v[12:15]
    ds_read_b128 v[80:83], v129 offset:4096
    v_mfma_f32_16x16x32_bf16 v[16:19], v[96:99], v[112:115], v[16:19]
    ds_read_b128 v[56:59], v135 offset:2048
    v_mfma_f32_16x16x32_bf16 v[20:23], v[96:99], v[120:123], v[20:23]
    ds_read_b128 v[68:71], v132 offset:0
    v_mfma_f32_16x16x32_bf16 v[24:27], v[88:91], v[108:111], v[24:27]
    ds_read_b128 v[76:79], v132 offset:2048
    v_mfma_f32_16x16x32_bf16 v[28:31], v[88:91], v[116:119], v[28:31]
    ds_read_b128 v[84:87], v132 offset:4096
    v_mfma_f32_16x16x32_bf16 v[32:35], v[88:91], v[124:127], v[32:35]
    ds_read_b128 v[52:55], v135 offset:1024
    v_mfma_f32_16x16x32_bf16 v[36:39], v[96:99], v[108:111], v[36:39]
    ds_read_b128 v[60:63], v135 offset:3072
    v_mfma_f32_16x16x32_bf16 v[40:43], v[96:99], v[116:119], v[40:43]
    v_mfma_f32_16x16x32_bf16 v[44:47], v[96:99], v[124:127], v[44:47]
    v_mfma_f32_16x16x32_bf16 v[24:27], v[92:95], v[104:107], v[24:27]
    v_xor_b32 v108, s34, v108
    v_xor_b32 v109, s34, v109
    v_mfma_f32_16x16x32_bf16 v[28:31], v[92:95], v[112:115], v[28:31]
    v_xor_b32 v110, s34, v110
    v_xor_b32 v111, s34, v111
    v_mfma_f32_16x16x32_bf16 v[32:35], v[92:95], v[120:123], v[32:35]
    v_xor_b32 v116, s34, v116
    v_xor_b32 v117, s34, v117
    v_mfma_f32_16x16x32_bf16 v[36:39], v[100:103], v[104:107], v[36:39]
    v_xor_b32 v118, s34, v118
    v_xor_b32 v119, s34, v119
    v_mfma_f32_16x16x32_bf16 v[40:43], v[100:103], v[112:115], v[40:43]
    v_xor_b32 v124, s34, v124
    v_xor_b32 v125, s34, v125
    v_mfma_f32_16x16x32_bf16 v[44:47], v[100:103], v[120:123], v[44:47]
    v_xor_b32 v126, s34, v126
    v_xor_b32 v127, s34, v127
    v_mfma_f32_16x16x32_bf16 v[0:3], v[92:95], v[108:111], v[0:3]
    v_mfma_f32_16x16x32_bf16 v[4:7], v[92:95], v[116:119], v[4:7]
    v_mfma_f32_16x16x32_bf16 v[8:11], v[92:95], v[124:127], v[8:11]
    s_waitcnt lgkmcnt(0)
    s_barrier
    v_mfma_f32_16x16x32_bf16 v[12:15], v[100:103], v[108:111], v[12:15]
    v_mfma_f32_16x16x32_bf16 v[16:19], v[100:103], v[116:119], v[16:19]
    v_mfma_f32_16x16x32_bf16 v[20:23], v[100:103], v[124:127], v[20:23]
    v_mfma_f32_16x16x32_bf16 v[0:3], v[48:51], v[64:67], v[0:3]
    ds_read_b128 v[88:91], v135 offset:20480
    v_mfma_f32_16x16x32_bf16 v[4:7], v[48:51], v[72:75], v[4:7]
    ds_read_b128 v[104:107], v129 offset:20480
    v_mfma_f32_16x16x32_bf16 v[8:11], v[48:51], v[80:83], v[8:11]
    ds_read_b128 v[112:115], v129 offset:22528
    v_mfma_f32_16x16x32_bf16 v[12:15], v[56:59], v[64:67], v[12:15]
    ds_read_b128 v[120:123], v129 offset:24576
    v_mfma_f32_16x16x32_bf16 v[16:19], v[56:59], v[72:75], v[16:19]
    ds_read_b128 v[96:99], v135 offset:22528
    v_mfma_f32_16x16x32_bf16 v[20:23], v[56:59], v[80:83], v[20:23]
    ds_read_b128 v[108:111], v132 offset:20480
    v_mfma_f32_16x16x32_bf16 v[24:27], v[48:51], v[68:71], v[24:27]
    ds_read_b128 v[116:119], v132 offset:22528
    v_mfma_f32_16x16x32_bf16 v[28:31], v[48:51], v[76:79], v[28:31]
    ds_read_b128 v[124:127], v132 offset:24576
    v_mfma_f32_16x16x32_bf16 v[32:35], v[48:51], v[84:87], v[32:35]
    ds_read_b128 v[92:95], v135 offset:21504
    v_mfma_f32_16x16x32_bf16 v[36:39], v[56:59], v[68:71], v[36:39]
    ds_read_b128 v[100:103], v135 offset:23552
    v_mfma_f32_16x16x32_bf16 v[40:43], v[56:59], v[76:79], v[40:43]
    v_mfma_f32_16x16x32_bf16 v[44:47], v[56:59], v[84:87], v[44:47]
    v_mfma_f32_16x16x32_bf16 v[24:27], v[52:55], v[64:67], v[24:27]
    v_xor_b32 v68, s34, v68
    v_xor_b32 v69, s34, v69
    v_mfma_f32_16x16x32_bf16 v[28:31], v[52:55], v[72:75], v[28:31]
    v_xor_b32 v70, s34, v70
    v_xor_b32 v71, s34, v71
    v_mfma_f32_16x16x32_bf16 v[32:35], v[52:55], v[80:83], v[32:35]
    v_xor_b32 v76, s34, v76
    v_xor_b32 v77, s34, v77
    v_mfma_f32_16x16x32_bf16 v[36:39], v[60:63], v[64:67], v[36:39]
    v_xor_b32 v78, s34, v78
    v_xor_b32 v79, s34, v79
    v_mfma_f32_16x16x32_bf16 v[40:43], v[60:63], v[72:75], v[40:43]
    v_xor_b32 v84, s34, v84
    v_xor_b32 v85, s34, v85
    v_mfma_f32_16x16x32_bf16 v[44:47], v[60:63], v[80:83], v[44:47]
    v_xor_b32 v86, s34, v86
    v_xor_b32 v87, s34, v87
    v_mfma_f32_16x16x32_bf16 v[0:3], v[52:55], v[68:71], v[0:3]
    v_mfma_f32_16x16x32_bf16 v[4:7], v[52:55], v[76:79], v[4:7]
    v_mfma_f32_16x16x32_bf16 v[8:11], v[52:55], v[84:87], v[8:11]
    s_waitcnt lgkmcnt(0)
    s_barrier
    v_mfma_f32_16x16x32_bf16 v[12:15], v[60:63], v[68:71], v[12:15]
    v_mfma_f32_16x16x32_bf16 v[16:19], v[60:63], v[76:79], v[16:19]
    v_mfma_f32_16x16x32_bf16 v[20:23], v[60:63], v[84:87], v[20:23]
    v_mfma_f32_16x16x32_bf16 v[0:3], v[88:91], v[104:107], v[0:3]
    ds_read_b128 v[48:51], v135 offset:40960
    v_mfma_f32_16x16x32_bf16 v[4:7], v[88:91], v[112:115], v[4:7]
    ds_read_b128 v[64:67], v129 offset:40960
    v_mfma_f32_16x16x32_bf16 v[8:11], v[88:91], v[120:123], v[8:11]
    ds_read_b128 v[72:75], v129 offset:43008
    v_mfma_f32_16x16x32_bf16 v[12:15], v[96:99], v[104:107], v[12:15]
    ds_read_b128 v[80:83], v129 offset:45056
    v_mfma_f32_16x16x32_bf16 v[16:19], v[96:99], v[112:115], v[16:19]
    ds_read_b128 v[56:59], v135 offset:43008
    v_mfma_f32_16x16x32_bf16 v[20:23], v[96:99], v[120:123], v[20:23]
    ds_read_b128 v[68:71], v132 offset:40960
    v_mfma_f32_16x16x32_bf16 v[24:27], v[88:91], v[108:111], v[24:27]
    ds_read_b128 v[76:79], v132 offset:43008
    v_mfma_f32_16x16x32_bf16 v[28:31], v[88:91], v[116:119], v[28:31]
    ds_read_b128 v[84:87], v132 offset:45056
    v_mfma_f32_16x16x32_bf16 v[32:35], v[88:91], v[124:127], v[32:35]
    ds_read_b128 v[52:55], v135 offset:41984
    v_mfma_f32_16x16x32_bf16 v[36:39], v[96:99], v[108:111], v[36:39]
    ds_read_b128 v[60:63], v135 offset:44032
    v_mfma_f32_16x16x32_bf16 v[40:43], v[96:99], v[116:119], v[40:43]
    v_mfma_f32_16x16x32_bf16 v[44:47], v[96:99], v[124:127], v[44:47]
    v_mfma_f32_16x16x32_bf16 v[24:27], v[92:95], v[104:107], v[24:27]
    v_xor_b32 v108, s34, v108
    v_xor_b32 v109, s34, v109
    v_mfma_f32_16x16x32_bf16 v[28:31], v[92:95], v[112:115], v[28:31]
    v_xor_b32 v110, s34, v110
    v_xor_b32 v111, s34, v111
    v_mfma_f32_16x16x32_bf16 v[32:35], v[92:95], v[120:123], v[32:35]
    v_xor_b32 v116, s34, v116
    v_xor_b32 v117, s34, v117
    v_mfma_f32_16x16x32_bf16 v[36:39], v[100:103], v[104:107], v[36:39]
    v_xor_b32 v118, s34, v118
    v_xor_b32 v119, s34, v119
    v_mfma_f32_16x16x32_bf16 v[40:43], v[100:103], v[112:115], v[40:43]
    v_xor_b32 v124, s34, v124
    v_xor_b32 v125, s34, v125
    v_mfma_f32_16x16x32_bf16 v[44:47], v[100:103], v[120:123], v[44:47]
    v_xor_b32 v126, s34, v126
    v_xor_b32 v127, s34, v127
    v_mfma_f32_16x16x32_bf16 v[0:3], v[92:95], v[108:111], v[0:3]
    v_mfma_f32_16x16x32_bf16 v[4:7], v[92:95], v[116:119], v[4:7]
    v_mfma_f32_16x16x32_bf16 v[8:11], v[92:95], v[124:127], v[8:11]
    s_waitcnt lgkmcnt(0)
    s_barrier
    v_mfma_f32_16x16x32_bf16 v[12:15], v[100:103], v[108:111], v[12:15]
    v_mfma_f32_16x16x32_bf16 v[16:19], v[100:103], v[116:119], v[16:19]
    v_mfma_f32_16x16x32_bf16 v[20:23], v[100:103], v[124:127], v[20:23]
    v_mfma_f32_16x16x32_bf16 v[0:3], v[48:51], v[64:67], v[0:3]
    ds_read_b128 v[88:91], v136 offset:0
    v_mfma_f32_16x16x32_bf16 v[4:7], v[48:51], v[72:75], v[4:7]
    ds_read_b128 v[104:107], v130 offset:0
    v_mfma_f32_16x16x32_bf16 v[8:11], v[48:51], v[80:83], v[8:11]
    ds_read_b128 v[112:115], v130 offset:2048
    v_mfma_f32_16x16x32_bf16 v[12:15], v[56:59], v[64:67], v[12:15]
    ds_read_b128 v[120:123], v130 offset:4096
    v_mfma_f32_16x16x32_bf16 v[16:19], v[56:59], v[72:75], v[16:19]
    ds_read_b128 v[96:99], v136 offset:2048
    v_mfma_f32_16x16x32_bf16 v[20:23], v[56:59], v[80:83], v[20:23]
    ds_read_b128 v[108:111], v133 offset:0
    v_mfma_f32_16x16x32_bf16 v[24:27], v[48:51], v[68:71], v[24:27]
    ds_read_b128 v[116:119], v133 offset:2048
    v_mfma_f32_16x16x32_bf16 v[28:31], v[48:51], v[76:79], v[28:31]
    ds_read_b128 v[124:127], v133 offset:4096
    v_mfma_f32_16x16x32_bf16 v[32:35], v[48:51], v[84:87], v[32:35]
    ds_read_b128 v[92:95], v136 offset:1024
    v_mfma_f32_16x16x32_bf16 v[36:39], v[56:59], v[68:71], v[36:39]
    ds_read_b128 v[100:103], v136 offset:3072
    v_mfma_f32_16x16x32_bf16 v[40:43], v[56:59], v[76:79], v[40:43]
    v_mfma_f32_16x16x32_bf16 v[44:47], v[56:59], v[84:87], v[44:47]
    v_mfma_f32_16x16x32_bf16 v[24:27], v[52:55], v[64:67], v[24:27]
    v_xor_b32 v68, s34, v68
    v_xor_b32 v69, s34, v69
    v_mfma_f32_16x16x32_bf16 v[28:31], v[52:55], v[72:75], v[28:31]
    v_xor_b32 v70, s34, v70
    v_xor_b32 v71, s34, v71
    v_mfma_f32_16x16x32_bf16 v[32:35], v[52:55], v[80:83], v[32:35]
    v_xor_b32 v76, s34, v76
    v_xor_b32 v77, s34, v77
    v_mfma_f32_16x16x32_bf16 v[36:39], v[60:63], v[64:67], v[36:39]
    v_xor_b32 v78, s34, v78
    v_xor_b32 v79, s34, v79
    v_mfma_f32_16x16x32_bf16 v[40:43], v[60:63], v[72:75], v[40:43]
    v_xor_b32 v84, s34, v84
    v_xor_b32 v85, s34, v85
    v_mfma_f32_16x16x32_bf16 v[44:47], v[60:63], v[80:83], v[44:47]
    v_xor_b32 v86, s34, v86
    v_xor_b32 v87, s34, v87
    v_mfma_f32_16x16x32_bf16 v[0:3], v[52:55], v[68:71], v[0:3]
    v_mfma_f32_16x16x32_bf16 v[4:7], v[52:55], v[76:79], v[4:7]
    v_mfma_f32_16x16x32_bf16 v[8:11], v[52:55], v[84:87], v[8:11]
    s_waitcnt lgkmcnt(0)
    s_barrier
    v_mfma_f32_16x16x32_bf16 v[12:15], v[60:63], v[68:71], v[12:15]
    v_mfma_f32_16x16x32_bf16 v[16:19], v[60:63], v[76:79], v[16:19]
    v_mfma_f32_16x16x32_bf16 v[20:23], v[60:63], v[84:87], v[20:23]
    v_mfma_f32_16x16x32_bf16 v[0:3], v[88:91], v[104:107], v[0:3]
    ds_read_b128 v[48:51], v134 offset:0
    v_mfma_f32_16x16x32_bf16 v[4:7], v[88:91], v[112:115], v[4:7]
    ds_read_b128 v[64:67], v128 offset:0
    v_mfma_f32_16x16x32_bf16 v[8:11], v[88:91], v[120:123], v[8:11]
    ds_read_b128 v[72:75], v128 offset:2048
    v_mfma_f32_16x16x32_bf16 v[12:15], v[96:99], v[104:107], v[12:15]
    ds_read_b128 v[80:83], v128 offset:4096
    v_mfma_f32_16x16x32_bf16 v[16:19], v[96:99], v[112:115], v[16:19]
    ds_read_b128 v[56:59], v134 offset:2048
    v_mfma_f32_16x16x32_bf16 v[20:23], v[96:99], v[120:123], v[20:23]
    ds_read_b128 v[68:71], v131 offset:0
    v_mfma_f32_16x16x32_bf16 v[24:27], v[88:91], v[108:111], v[24:27]
    ds_read_b128 v[76:79], v131 offset:2048
    v_mfma_f32_16x16x32_bf16 v[28:31], v[88:91], v[116:119], v[28:31]
    ds_read_b128 v[84:87], v131 offset:4096
    v_mfma_f32_16x16x32_bf16 v[32:35], v[88:91], v[124:127], v[32:35]
    ds_read_b128 v[52:55], v134 offset:1024
    v_mfma_f32_16x16x32_bf16 v[36:39], v[96:99], v[108:111], v[36:39]
    ds_read_b128 v[60:63], v134 offset:3072
    v_mfma_f32_16x16x32_bf16 v[40:43], v[96:99], v[116:119], v[40:43]
    v_mfma_f32_16x16x32_bf16 v[44:47], v[96:99], v[124:127], v[44:47]
    v_mfma_f32_16x16x32_bf16 v[24:27], v[92:95], v[104:107], v[24:27]
    v_xor_b32 v108, s34, v108
    v_xor_b32 v109, s34, v109
    v_mfma_f32_16x16x32_bf16 v[28:31], v[92:95], v[112:115], v[28:31]
    v_xor_b32 v110, s34, v110
    v_xor_b32 v111, s34, v111
    v_mfma_f32_16x16x32_bf16 v[32:35], v[92:95], v[120:123], v[32:35]
    v_xor_b32 v116, s34, v116
    v_xor_b32 v117, s34, v117
    v_mfma_f32_16x16x32_bf16 v[36:39], v[100:103], v[104:107], v[36:39]
    v_xor_b32 v118, s34, v118
    v_xor_b32 v119, s34, v119
    v_mfma_f32_16x16x32_bf16 v[40:43], v[100:103], v[112:115], v[40:43]
    v_xor_b32 v124, s34, v124
    v_xor_b32 v125, s34, v125
    v_mfma_f32_16x16x32_bf16 v[44:47], v[100:103], v[120:123], v[44:47]
    v_xor_b32 v126, s34, v126
    v_xor_b32 v127, s34, v127
    v_mfma_f32_16x16x32_bf16 v[0:3], v[92:95], v[108:111], v[0:3]
    v_mfma_f32_16x16x32_bf16 v[4:7], v[92:95], v[116:119], v[4:7]
    v_mfma_f32_16x16x32_bf16 v[8:11], v[92:95], v[124:127], v[8:11]
    s_waitcnt lgkmcnt(0)
    s_barrier
    v_mfma_f32_16x16x32_bf16 v[12:15], v[100:103], v[108:111], v[12:15]
    v_mfma_f32_16x16x32_bf16 v[16:19], v[100:103], v[116:119], v[16:19]
    v_mfma_f32_16x16x32_bf16 v[20:23], v[100:103], v[124:127], v[20:23]
    v_mfma_f32_16x16x32_bf16 v[0:3], v[48:51], v[64:67], v[0:3]
    ds_read_b128 v[88:91], v134 offset:20480
    v_mfma_f32_16x16x32_bf16 v[4:7], v[48:51], v[72:75], v[4:7]
    ds_read_b128 v[104:107], v128 offset:20480
    v_mfma_f32_16x16x32_bf16 v[8:11], v[48:51], v[80:83], v[8:11]
    ds_read_b128 v[112:115], v128 offset:22528
    v_mfma_f32_16x16x32_bf16 v[12:15], v[56:59], v[64:67], v[12:15]
    ds_read_b128 v[120:123], v128 offset:24576
    v_mfma_f32_16x16x32_bf16 v[16:19], v[56:59], v[72:75], v[16:19]
    ds_read_b128 v[96:99], v134 offset:22528
    v_mfma_f32_16x16x32_bf16 v[20:23], v[56:59], v[80:83], v[20:23]
    ds_read_b128 v[108:111], v131 offset:20480
    v_mfma_f32_16x16x32_bf16 v[24:27], v[48:51], v[68:71], v[24:27]
    ds_read_b128 v[116:119], v131 offset:22528
    v_mfma_f32_16x16x32_bf16 v[28:31], v[48:51], v[76:79], v[28:31]
    ds_read_b128 v[124:127], v131 offset:24576
    v_mfma_f32_16x16x32_bf16 v[32:35], v[48:51], v[84:87], v[32:35]
    ds_read_b128 v[92:95], v134 offset:21504
    v_mfma_f32_16x16x32_bf16 v[36:39], v[56:59], v[68:71], v[36:39]
    ds_read_b128 v[100:103], v134 offset:23552
    v_mfma_f32_16x16x32_bf16 v[40:43], v[56:59], v[76:79], v[40:43]
    v_mfma_f32_16x16x32_bf16 v[44:47], v[56:59], v[84:87], v[44:47]
    v_mfma_f32_16x16x32_bf16 v[24:27], v[52:55], v[64:67], v[24:27]
    v_xor_b32 v68, s34, v68
    v_xor_b32 v69, s34, v69
    v_mfma_f32_16x16x32_bf16 v[28:31], v[52:55], v[72:75], v[28:31]
    v_xor_b32 v70, s34, v70
    v_xor_b32 v71, s34, v71
    v_mfma_f32_16x16x32_bf16 v[32:35], v[52:55], v[80:83], v[32:35]
    v_xor_b32 v76, s34, v76
    v_xor_b32 v77, s34, v77
    v_mfma_f32_16x16x32_bf16 v[36:39], v[60:63], v[64:67], v[36:39]
    v_xor_b32 v78, s34, v78
    v_xor_b32 v79, s34, v79
    v_mfma_f32_16x16x32_bf16 v[40:43], v[60:63], v[72:75], v[40:43]
    v_xor_b32 v84, s34, v84
    v_xor_b32 v85, s34, v85
    v_mfma_f32_16x16x32_bf16 v[44:47], v[60:63], v[80:83], v[44:47]
    v_xor_b32 v86, s34, v86
    v_xor_b32 v87, s34, v87
    v_mfma_f32_16x16x32_bf16 v[0:3], v[52:55], v[68:71], v[0:3]
    v_mfma_f32_16x16x32_bf16 v[4:7], v[52:55], v[76:79], v[4:7]
    v_mfma_f32_16x16x32_bf16 v[8:11], v[52:55], v[84:87], v[8:11]
    s_waitcnt lgkmcnt(0)
    v_mfma_f32_16x16x32_bf16 v[12:15], v[60:63], v[68:71], v[12:15]
    v_mfma_f32_16x16x32_bf16 v[16:19], v[60:63], v[76:79], v[16:19]
    v_mfma_f32_16x16x32_bf16 v[20:23], v[60:63], v[84:87], v[20:23]
    v_mfma_f32_16x16x32_bf16 v[0:3], v[88:91], v[104:107], v[0:3]
    v_mfma_f32_16x16x32_bf16 v[4:7], v[88:91], v[112:115], v[4:7]
    v_mfma_f32_16x16x32_bf16 v[8:11], v[88:91], v[120:123], v[8:11]
    v_mfma_f32_16x16x32_bf16 v[12:15], v[96:99], v[104:107], v[12:15]
    v_mfma_f32_16x16x32_bf16 v[16:19], v[96:99], v[112:115], v[16:19]
    v_mfma_f32_16x16x32_bf16 v[20:23], v[96:99], v[120:123], v[20:23]
    v_mfma_f32_16x16x32_bf16 v[24:27], v[88:91], v[108:111], v[24:27]
    v_mfma_f32_16x16x32_bf16 v[28:31], v[88:91], v[116:119], v[28:31]
    v_mfma_f32_16x16x32_bf16 v[32:35], v[88:91], v[124:127], v[32:35]
    v_mfma_f32_16x16x32_bf16 v[36:39], v[96:99], v[108:111], v[36:39]
    v_mfma_f32_16x16x32_bf16 v[40:43], v[96:99], v[116:119], v[40:43]
    v_mfma_f32_16x16x32_bf16 v[44:47], v[96:99], v[124:127], v[44:47]
    v_mfma_f32_16x16x32_bf16 v[24:27], v[92:95], v[104:107], v[24:27]
    v_xor_b32 v108, s34, v108
    v_xor_b32 v109, s34, v109
    v_mfma_f32_16x16x32_bf16 v[28:31], v[92:95], v[112:115], v[28:31]
    v_xor_b32 v110, s34, v110
    v_xor_b32 v111, s34, v111
    v_mfma_f32_16x16x32_bf16 v[32:35], v[92:95], v[120:123], v[32:35]
    v_xor_b32 v116, s34, v116
    v_xor_b32 v117, s34, v117
    v_mfma_f32_16x16x32_bf16 v[36:39], v[100:103], v[104:107], v[36:39]
    v_xor_b32 v118, s34, v118
    v_xor_b32 v119, s34, v119
    v_mfma_f32_16x16x32_bf16 v[40:43], v[100:103], v[112:115], v[40:43]
    v_xor_b32 v124, s34, v124
    v_xor_b32 v125, s34, v125
    v_mfma_f32_16x16x32_bf16 v[44:47], v[100:103], v[120:123], v[44:47]
    v_xor_b32 v126, s34, v126
    v_xor_b32 v127, s34, v127
    v_mfma_f32_16x16x32_bf16 v[0:3], v[92:95], v[108:111], v[0:3]
    v_mfma_f32_16x16x32_bf16 v[4:7], v[92:95], v[116:119], v[4:7]
    v_mfma_f32_16x16x32_bf16 v[8:11], v[92:95], v[124:127], v[8:11]
    v_mfma_f32_16x16x32_bf16 v[12:15], v[100:103], v[108:111], v[12:15]
    v_mfma_f32_16x16x32_bf16 v[16:19], v[100:103], v[116:119], v[16:19]
    v_mfma_f32_16x16x32_bf16 v[20:23], v[100:103], v[124:127], v[20:23]
    s_nop 7
    s_nop 7
    v_cvt_pk_bf16_f32 v48, v0, v1
    v_cvt_pk_bf16_f32 v49, v2, v3
    v_cvt_pk_bf16_f32 v50, v12, v13
    v_cvt_pk_bf16_f32 v51, v14, v15
    v_cvt_pk_bf16_f32 v52, v24, v25
    v_cvt_pk_bf16_f32 v53, v26, v27
    v_cvt_pk_bf16_f32 v54, v36, v37
    v_cvt_pk_bf16_f32 v55, v38, v39
    v_mov_b32 v56, v48
    v_mov_b32 v57, v49
    v_mov_b32 v58, v50
    v_mov_b32 v59, v51
    s_add_u32 s35, s33, 0
    v_mov_b32_dpp v56, v52 row_ror:8 row_mask:0xf bank_mask:0x3
    v_mov_b32_dpp v57, v53 row_ror:8 row_mask:0xf bank_mask:0x3
    v_mov_b32_dpp v58, v54 row_ror:8 row_mask:0xf bank_mask:0x3
    v_mov_b32_dpp v59, v55 row_ror:8 row_mask:0xf bank_mask:0x3
    v_mov_b32_dpp v48, v52 row_ror:8 row_mask:0xf bank_mask:0xc
    v_mov_b32_dpp v49, v53 row_ror:8 row_mask:0xf bank_mask:0xc
    v_mov_b32_dpp v50, v54 row_ror:8 row_mask:0xf bank_mask:0xc
    v_mov_b32_dpp v51, v55 row_ror:8 row_mask:0xf bank_mask:0xc
    buffer_store_dwordx4 v[48:51], v142, s[16:19], s35 offen sc1
    buffer_store_dwordx4 v[56:59], v143, s[16:19], s35 offen sc1
    v_cvt_pk_bf16_f32 v60, v4, v5
    v_cvt_pk_bf16_f32 v61, v6, v7
    v_cvt_pk_bf16_f32 v62, v16, v17
    v_cvt_pk_bf16_f32 v63, v18, v19
    v_cvt_pk_bf16_f32 v64, v28, v29
    v_cvt_pk_bf16_f32 v65, v30, v31
    v_cvt_pk_bf16_f32 v66, v40, v41
    v_cvt_pk_bf16_f32 v67, v42, v43
    v_mov_b32 v68, v60
    v_mov_b32 v69, v61
    v_mov_b32 v70, v62
    v_mov_b32 v71, v63
    s_add_u32 s35, s33, 593920
    v_mov_b32_dpp v68, v64 row_ror:8 row_mask:0xf bank_mask:0x3
    v_mov_b32_dpp v69, v65 row_ror:8 row_mask:0xf bank_mask:0x3
    v_mov_b32_dpp v70, v66 row_ror:8 row_mask:0xf bank_mask:0x3
    v_mov_b32_dpp v71, v67 row_ror:8 row_mask:0xf bank_mask:0x3
    v_mov_b32_dpp v60, v64 row_ror:8 row_mask:0xf bank_mask:0xc
    v_mov_b32_dpp v61, v65 row_ror:8 row_mask:0xf bank_mask:0xc
    v_mov_b32_dpp v62, v66 row_ror:8 row_mask:0xf bank_mask:0xc
    v_mov_b32_dpp v63, v67 row_ror:8 row_mask:0xf bank_mask:0xc
    buffer_store_dwordx4 v[60:63], v142, s[16:19], s35 offen sc1
    buffer_store_dwordx4 v[68:71], v143, s[16:19], s35 offen sc1
    v_cvt_pk_bf16_f32 v72, v8, v9
    v_cvt_pk_bf16_f32 v73, v10, v11
    v_cvt_pk_bf16_f32 v74, v20, v21
    v_cvt_pk_bf16_f32 v75, v22, v23
    v_cvt_pk_bf16_f32 v76, v32, v33
    v_cvt_pk_bf16_f32 v77, v34, v35
    v_cvt_pk_bf16_f32 v78, v44, v45
    v_cvt_pk_bf16_f32 v79, v46, v47
    v_mov_b32 v80, v72
    v_mov_b32 v81, v73
    v_mov_b32 v82, v74
    v_mov_b32 v83, v75
    s_add_u32 s35, s33, 1187840
    v_mov_b32_dpp v80, v76 row_ror:8 row_mask:0xf bank_mask:0x3
    v_mov_b32_dpp v81, v77 row_ror:8 row_mask:0xf bank_mask:0x3
    v_mov_b32_dpp v82, v78 row_ror:8 row_mask:0xf bank_mask:0x3
    v_mov_b32_dpp v83, v79 row_ror:8 row_mask:0xf bank_mask:0x3
    v_mov_b32_dpp v72, v76 row_ror:8 row_mask:0xf bank_mask:0xc
    v_mov_b32_dpp v73, v77 row_ror:8 row_mask:0xf bank_mask:0xc
    v_mov_b32_dpp v74, v78 row_ror:8 row_mask:0xf bank_mask:0xc
    v_mov_b32_dpp v75, v79 row_ror:8 row_mask:0xf bank_mask:0xc
    buffer_store_dwordx4 v[72:75], v142, s[16:19], s35 offen sc1
    buffer_store_dwordx4 v[80:83], v143, s[16:19], s35 offen sc1
    s_endpgm
L_gemm2_kernel_loader:
    s_sub_u32 s20, s20, 4
    v_and_b32 v1, 63, v0
    v_lshrrev_b32 v4, 3, v1
    v_and_b32 v5, 7, v1
    v_xor_b32 v5, v5, v4
    v_lshlrev_b32 v5, 4, v5
    v_lshl_add_u32 v2, v4, 11, v5
    v_lshlrev_b32 v3, 4, v1
    s_add_u32 s24, s20, 0
    s_lshl_b32 s40, s24, 10
    s_lshl_b32 s43, s24, 14
    s_add_u32 s24, s20, 4
    s_lshl_b32 s41, s24, 10
    s_lshl_b32 s44, s24, 14
    s_add_u32 s24, s20, 8
    s_lshl_b32 s42, s24, 10
    s_lshl_b32 s45, s24, 14
    s_mul_i32 s46, s20, 2048
    s_add_u32 s47, s46, 12288
    s_add_u32 m0, s40, 0
    s_add_u32 s24, s43, 0
    buffer_load_dwordx4 v2, s[8:11], s24 offen lds
    s_add_u32 m0, s41, 0
    s_add_u32 s24, s44, 0
    buffer_load_dwordx4 v2, s[8:11], s24 offen lds
    s_add_u32 m0, s42, 0
    s_add_u32 s24, s45, 0
    buffer_load_dwordx4 v2, s[8:11], s24 offen lds
    s_add_u32 m0, s47, 0
    s_add_u32 s24, s46, 0
    buffer_load_dwordx4 v3, s[12:15], s24 offen offset:0 lds
    buffer_load_dwordx4 v3, s[12:15], s24 offen offset:1024 lds
    s_add_u32 m0, s40, 20480
    s_add_u32 s24, s43, 128
    buffer_load_dwordx4 v2, s[8:11], s24 offen lds
    s_add_u32 m0, s41, 20480
    s_add_u32 s24, s44, 128
    buffer_load_dwordx4 v2, s[8:11], s24 offen lds
    s_add_u32 m0, s42, 20480
    s_add_u32 s24, s45, 128
    buffer_load_dwordx4 v2, s[8:11], s24 offen lds
    s_add_u32 m0, s47, 20480
    s_add_u32 s24, s46, 32768
    buffer_load_dwordx4 v3, s[12:15], s24 offen offset:0 lds
    buffer_load_dwordx4 v3, s[12:15], s24 offen offset:1024 lds
    s_waitcnt vmcnt(5)
    s_barrier
    s_add_u32 m0, s40, 40960
    s_add_u32 s24, s43, 256
    buffer_load_dwordx4 v2, s[8:11], s24 offen lds
    s_add_u32 m0, s41, 40960
    s_add_u32 s24, s44, 256
    buffer_load_dwordx4 v2, s[8:11], s24 offen lds
    s_add_u32 m0, s42, 40960
    s_add_u32 s24, s45, 256
    buffer_load_dwordx4 v2, s[8:11], s24 offen lds
    s_add_u32 m0, s47, 40960
    s_add_u32 s24, s46, 65536
    buffer_load_dwordx4 v3, s[12:15], s24 offen offset:0 lds
    buffer_load_dwordx4 v3, s[12:15], s24 offen offset:1024 lds
    s_waitcnt vmcnt(5)
    s_barrier
    s_add_u32 m0, s40, 61440
    s_add_u32 s24, s43, 384
    buffer_load_dwordx4 v2, s[8:11], s24 offen lds
    s_add_u32 m0, s41, 61440
    s_add_u32 s24, s44, 384
    buffer_load_dwordx4 v2, s[8:11], s24 offen lds
    s_add_u32 m0, s42, 61440
    s_add_u32 s24, s45, 384
    buffer_load_dwordx4 v2, s[8:11], s24 offen lds
    s_add_u32 m0, s47, 61440
    s_add_u32 s24, s46, 98304
    buffer_load_dwordx4 v3, s[12:15], s24 offen offset:0 lds
    buffer_load_dwordx4 v3, s[12:15], s24 offen offset:1024 lds
    s_add_u32 m0, s40, 81920
    s_add_u32 s24, s43, 512
    buffer_load_dwordx4 v2, s[8:11], s24 offen lds
    s_add_u32 m0, s41, 81920
    s_add_u32 s24, s44, 512
    buffer_load_dwordx4 v2, s[8:11], s24 offen lds
    s_add_u32 m0, s42, 81920
    s_add_u32 s24, s45, 512
    buffer_load_dwordx4 v2, s[8:11], s24 offen lds
    s_add_u32 m0, s47, 81920
    s_add_u32 s24, s46, 131072
    buffer_load_dwordx4 v3, s[12:15], s24 offen offset:0 lds
    buffer_load_dwordx4 v3, s[12:15], s24 offen offset:1024 lds
    s_waitcnt vmcnt(10)
    s_barrier
    s_add_u32 m0, s40, 102400
    s_add_u32 s24, s43, 640
    buffer_load_dwordx4 v2, s[8:11], s24 offen lds
    s_add_u32 m0, s41, 102400
    s_add_u32 s24, s44, 640
    buffer_load_dwordx4 v2, s[8:11], s24 offen lds
    s_add_u32 m0, s42, 102400
    s_add_u32 s24, s45, 640
    buffer_load_dwordx4 v2, s[8:11], s24 offen lds
    s_add_u32 m0, s47, 102400
    s_add_u32 s24, s46, 163840
    buffer_load_dwordx4 v3, s[12:15], s24 offen offset:0 lds
    buffer_load_dwordx4 v3, s[12:15], s24 offen offset:1024 lds
    s_add_u32 m0, s40, 122880
    s_add_u32 s24, s43, 768
    buffer_load_dwordx4 v2, s[8:11], s24 offen lds
    s_add_u32 m0, s41, 122880
    s_add_u32 s24, s44, 768
    buffer_load_dwordx4 v2, s[8:11], s24 offen lds
    s_add_u32 m0, s42, 122880
    s_add_u32 s24, s45, 768
    buffer_load_dwordx4 v2, s[8:11], s24 offen lds
    s_add_u32 m0, s47, 122880
    s_add_u32 s24, s46, 196608
    buffer_load_dwordx4 v3, s[12:15], s24 offen offset:0 lds
    buffer_load_dwordx4 v3, s[12:15], s24 offen offset:1024 lds
    s_waitcnt vmcnt(15)
    s_barrier
    s_add_u32 m0, s40, 0
    s_add_u32 s24, s43, 896
    buffer_load_dwordx4 v2, s[8:11], s24 offen lds
    s_add_u32 m0, s41, 0
    s_add_u32 s24, s44, 896
    buffer_load_dwordx4 v2, s[8:11], s24 offen lds
    s_add_u32 m0, s42, 0
    s_add_u32 s24, s45, 896
    buffer_load_dwordx4 v2, s[8:11], s24 offen lds
    s_add_u32 m0, s47, 0
    s_add_u32 s24, s46, 229376
    buffer_load_dwordx4 v3, s[12:15], s24 offen offset:0 lds
    buffer_load_dwordx4 v3, s[12:15], s24 offen offset:1024 lds
    s_add_u32 m0, s40, 20480
    s_add_u32 s24, s43, 1024
    buffer_load_dwordx4 v2, s[8:11], s24 offen lds
    s_add_u32 m0, s41, 20480
    s_add_u32 s24, s44, 1024
    buffer_load_dwordx4 v2, s[8:11], s24 offen lds
    s_add_u32 m0, s42, 20480
    s_add_u32 s24, s45, 1024
    buffer_load_dwordx4 v2, s[8:11], s24 offen lds
    s_add_u32 m0, s47, 20480
    s_add_u32 s24, s46, 262144
    buffer_load_dwordx4 v3, s[12:15], s24 offen offset:0 lds
    buffer_load_dwordx4 v3, s[12:15], s24 offen offset:1024 lds
    s_waitcnt vmcnt(20)
    s_barrier
    s_add_u32 m0, s40, 40960
    s_add_u32 s24, s43, 1152
    buffer_load_dwordx4 v2, s[8:11], s24 offen lds
    s_add_u32 m0, s41, 40960
    s_add_u32 s24, s44, 1152
    buffer_load_dwordx4 v2, s[8:11], s24 offen lds
    s_add_u32 m0, s42, 40960
    s_add_u32 s24, s45, 1152
    buffer_load_dwordx4 v2, s[8:11], s24 offen lds
    s_add_u32 m0, s47, 40960
    s_add_u32 s24, s46, 294912
    buffer_load_dwordx4 v3, s[12:15], s24 offen offset:0 lds
    buffer_load_dwordx4 v3, s[12:15], s24 offen offset:1024 lds
    s_add_u32 m0, s40, 61440
    s_add_u32 s24, s43, 1280
    buffer_load_dwordx4 v2, s[8:11], s24 offen lds
    s_add_u32 m0, s41, 61440
    s_add_u32 s24, s44, 1280
    buffer_load_dwordx4 v2, s[8:11], s24 offen lds
    s_add_u32 m0, s42, 61440
    s_add_u32 s24, s45, 1280
    buffer_load_dwordx4 v2, s[8:11], s24 offen lds
    s_add_u32 m0, s47, 61440
    s_add_u32 s24, s46, 327680
    buffer_load_dwordx4 v3, s[12:15], s24 offen offset:0 lds
    buffer_load_dwordx4 v3, s[12:15], s24 offen offset:1024 lds
    s_waitcnt vmcnt(25)
    s_barrier
    s_add_u32 m0, s40, 81920
    s_add_u32 s24, s43, 1408
    buffer_load_dwordx4 v2, s[8:11], s24 offen lds
    s_add_u32 m0, s41, 81920
    s_add_u32 s24, s44, 1408
    buffer_load_dwordx4 v2, s[8:11], s24 offen lds
    s_add_u32 m0, s42, 81920
    s_add_u32 s24, s45, 1408
    buffer_load_dwordx4 v2, s[8:11], s24 offen lds
    s_add_u32 m0, s47, 81920
    s_add_u32 s24, s46, 360448
    buffer_load_dwordx4 v3, s[12:15], s24 offen offset:0 lds
    buffer_load_dwordx4 v3, s[12:15], s24 offen offset:1024 lds
    s_waitcnt vmcnt(25)
    s_barrier
    s_add_u32 m0, s40, 102400
    s_add_u32 s24, s43, 1536
    buffer_load_dwordx4 v2, s[8:11], s24 offen lds
    s_add_u32 m0, s41, 102400
    s_add_u32 s24, s44, 1536
    buffer_load_dwordx4 v2, s[8:11], s24 offen lds
    s_add_u32 m0, s42, 102400
    s_add_u32 s24, s45, 1536
    buffer_load_dwordx4 v2, s[8:11], s24 offen lds
    s_add_u32 m0, s47, 102400
    s_add_u32 s24, s46, 393216
    buffer_load_dwordx4 v3, s[12:15], s24 offen offset:0 lds
    buffer_load_dwordx4 v3, s[12:15], s24 offen offset:1024 lds
    s_waitcnt vmcnt(25)
    s_barrier
    s_add_u32 m0, s40, 122880
    s_add_u32 s24, s43, 1664
    buffer_load_dwordx4 v2, s[8:11], s24 offen lds
    s_add_u32 m0, s41, 122880
    s_add_u32 s24, s44, 1664
    buffer_load_dwordx4 v2, s[8:11], s24 offen lds
    s_add_u32 m0, s42, 122880
    s_add_u32 s24, s45, 1664
    buffer_load_dwordx4 v2, s[8:11], s24 offen lds
    s_add_u32 m0, s47, 122880
    s_add_u32 s24, s46, 425984
    buffer_load_dwordx4 v3, s[12:15], s24 offen offset:0 lds
    buffer_load_dwordx4 v3, s[12:15], s24 offen offset:1024 lds
    s_waitcnt vmcnt(25)
    s_barrier
    s_add_u32 m0, s40, 0
    s_add_u32 s24, s43, 1792
    buffer_load_dwordx4 v2, s[8:11], s24 offen lds
    s_add_u32 m0, s41, 0
    s_add_u32 s24, s44, 1792
    buffer_load_dwordx4 v2, s[8:11], s24 offen lds
    s_add_u32 m0, s42, 0
    s_add_u32 s24, s45, 1792
    buffer_load_dwordx4 v2, s[8:11], s24 offen lds
    s_add_u32 m0, s47, 0
    s_add_u32 s24, s46, 458752
    buffer_load_dwordx4 v3, s[12:15], s24 offen offset:0 lds
    buffer_load_dwordx4 v3, s[12:15], s24 offen offset:1024 lds
    s_waitcnt vmcnt(25)
    s_barrier
    s_add_u32 m0, s40, 20480
    s_add_u32 s24, s43, 1920
    buffer_load_dwordx4 v2, s[8:11], s24 offen lds
    s_add_u32 m0, s41, 20480
    s_add_u32 s24, s44, 1920
    buffer_load_dwordx4 v2, s[8:11], s24 offen lds
    s_add_u32 m0, s42, 20480
    s_add_u32 s24, s45, 1920
    buffer_load_dwordx4 v2, s[8:11], s24 offen lds
    s_add_u32 m0, s47, 20480
    s_add_u32 s24, s46, 491520
    buffer_load_dwordx4 v3, s[12:15], s24 offen offset:0 lds
    buffer_load_dwordx4 v3, s[12:15], s24 offen offset:1024 lds
    s_waitcnt vmcnt(25)
    s_barrier
    s_waitcnt vmcnt(20)
    s_barrier
    s_waitcnt vmcnt(15)
    s_barrier
    s_waitcnt vmcnt(10)
    s_barrier
    s_waitcnt vmcnt(5)
    s_barrier
    s_waitcnt vmcnt(0)
    s_barrier
L_gemm2_kernel_done:
    s_endpgm
.globl joint_kernel
.p2align 8
.type joint_kernel,@function
joint_kernel:
    s_cmp_ge_u32 s2, 256
    s_cbranch_scc1 L_joint_kernel_done
    s_load_dwordx2 s[6:7], s[0:1], 72
    s_load_dwordx2 s[4:5], s[0:1], 56
    v_readfirstlane_b32 s20, v0
    s_lshr_b32 s20, s20, 6
    s_and_b32 s21, s20, 3
    s_and_b32 s23, s2, 7
    s_lshl_b32 s23, s23, 5
    s_lshr_b32 s22, s2, 3
    s_add_u32 s23, s23, s22
    s_cmp_ge_u32 s23, 250
    s_cbranch_scc1 L_joint_kernel_done
    s_cmp_ge_u32 s23, 125
    s_cselect_b32 s24, 1, 0
    s_mul_i32 s25, s24, 125
    s_sub_u32 s25, s23, s25
    s_lshl_b32 s26, s25, 1
    s_add_u32 s26, s26, 0
    s_mul_i32 s27, s26, 171
    s_lshr_b32 s28, s27, 9
    s_mul_i32 s27, s28, 3
    s_sub_u32 s30, s26, s27
    s_lshl_b32 s26, s25, 1
    s_add_u32 s26, s26, 1
    s_mul_i32 s27, s26, 171
    s_lshr_b32 s29, s27, 9
    s_mul_i32 s27, s29, 3
    s_sub_u32 s31, s26, s27
    v_and_b32 v1, 63, v0
    v_lshlrev_b32 v5, 4, v1
    s_waitcnt lgkmcnt(0)
    s_add_u32 s12, s6, 85499904
    s_addc_u32 s13, s7, 0
    s_mov_b32 s14, 295936
    s_mov_b32 s15, 0x00020000
    s_mul_i32 s36, s24, 4000
    s_lshl_b32 s37, s25, 5
    s_add_u32 s36, s36, s37
    s_lshl_b32 s36, s36, 12
    s_add_u32 s16, s4, s36
    s_addc_u32 s17, s5, 0
    s_mov_b32 s18, 131072
    s_mov_b32 s19, 0x00020000
    s_lshl_b32 s38, s21, 15
    s_cmp_ge_u32 s20, 4
    s_cbranch_scc1 L_joint_kernel_helper
    s_lshr_b32 s36, s2, 3
    s_and_b32 s36, s36, 31
    s_lshl_b32 s36, s36, 13
    s_add_u32 s36, s36, 32768
    v_lshlrev_b32 v6, 7, v1
    s_cmp_lg_u32 s20, 0
    s_cbranch_scc1 L_joint_kernel_nopf
    buffer_load_dword v7, v6, s[12:15], s36 offen
L_joint_kernel_nopf:
    v_lshrrev_b32 v2, 2, v1
    v_lshlrev_b32 v2, 6, v2
    v_lshrrev_b32 v3, 5, v1
    v_lshlrev_b32 v3, 1, v3
    v_and_b32 v4, 3, v1
    v_xor_b32 v3, v3, v4
    v_lshl_add_u32 v2, v3, 4, v2
    s_lshl_b32 s34, s21, 14
    s_lshl_b32 s35, s21, 13
    s_mul_i32 s33, s24, 3118080
    s_add_u32 s33, s33, 79261696
    s_add_u32 s8, s6, s33
    s_addc_u32 s9, s7, 0
    s_mov_b32 s10, 3118080
    s_mov_b32 s11, 0x00020000
    s_mov_b32 s46, 0
    s_cmp_eq_u32 s28, s29
    s_cbranch_scc1 L_joint_kernel_same
    s_mul_i32 s36, s29, 37120
    s_add_u32 s36, s36, s35
    s_add_u32 m0, s34, 8192
    s_add_u32 s37, s36, 0
    buffer_load_dwordx4 v2, s[8:11], s37 offen offset:0 lds
    buffer_load_dwordx4 v2, s[8:11], s37 offen offset:1024 lds
    buffer_load_dwordx4 v2, s[8:11], s37 offen offset:2048 lds
    buffer_load_dwordx4 v2, s[8:11], s37 offen offset:3072 lds
    s_add_u32 m0, s34, 12288
    s_add_u32 s37, s36, 4096
    buffer_load_dwordx4 v2, s[8:11], s37 offen offset:0 lds
    buffer_load_dwordx4 v2, s[8:11], s37 offen offset:1024 lds
    buffer_load_dwordx4 v2, s[8:11], s37 offen offset:2048 lds
    buffer_load_dwordx4 v2, s[8:11], s37 offen offset:3072 lds
    s_mov_b32 s46, 8192
L_joint_kernel_same:
    s_lshl_b32 s36, s30, 11
    s_add_u32 s36, s36, 8192
    buffer_load_dwordx4 v[8:11], v5, s[12:15], s36 offen offset:0
    buffer_load_dwordx4 v[12:15], v5, s[12:15], s36 offen offset:1024
    s_lshl_b32 s36, s31, 11
    s_add_u32 s36, s36, 8192
    buffer_load_dwordx4 v[16:19], v5, s[12:15], s36 offen offset:0
    buffer_load_dwordx4 v[20:23], v5, s[12:15], s36 offen offset:1024
    s_mul_i32 s36, s28, 37120
    s_add_u32 s36, s36, s35
    s_add_u32 m0, s34, 0
    s_add_u32 s37, s36, 0
    buffer_load_dwordx4 v2, s[8:11], s37 offen offset:0 lds
    buffer_load_dwordx4 v2, s[8:11], s37 offen offset:1024 lds
    buffer_load_dwordx4 v2, s[8:11], s37 offen offset:2048 lds
    buffer_load_dwordx4 v2, s[8:11], s37 offen offset:3072 lds
    s_add_u32 m0, s34, 4096
    s_add_u32 s37, s36, 4096
    buffer_load_dwordx4 v2, s[8:11], s37 offen offset:0 lds
    buffer_load_dwordx4 v2, s[8:11], s37 offen offset:1024 lds
    buffer_load_dwordx4 v2, s[8:11], s37 offen offset:2048 lds
    buffer_load_dwordx4 v2, s[8:11], s37 offen offset:3072 lds
    v_bfe_u32 v32, v1, 2, 2
    v_lshrrev_b32 v33, 4, v1
    v_and_b32 v34, 3, v1
    v_lshl_add_u32 v35, v33, 3, v32
    v_lshlrev_b32 v40, 6, v35
    v_and_b32 v41, 1, v33
    v_lshlrev_b32 v41, 1, v41
    v_lshrrev_b32 v42, 1, v34
    v_xor_b32 v41, v41, v42
    v_lshl_add_u32 v40, v41, 4, v40
    v_and_b32 v42, 1, v34
    v_lshl_add_u32 v40, v42, 3, v40
    v_add_u32 v36, s34, v40
    v_xor_b32 v37, 32, v36
    v_add_u32 v38, s46, v36
    v_add_u32 v39, s46, v37
    v_lshrrev_b32 v41, 1, v33
    v_lshlrev_b32 v41, 10, v41
    v_and_b32 v42, 1, v33
    v_lshl_add_u32 v41, v42, 9, v41
    v_and_b32 v42, 15, v1
    v_lshl_add_u32 v41, v42, 4, v41
    s_lshl_b32 s36, s21, 12
    s_add_u32 s36, s36, 65536
    v_add_u32 v43, s36, v41
    s_mov_b32 s40, 0xbdd2d3e8
    v_mov_b32 v44, 0xc0135761
    s_mov_b32 s41, 0xbdd2d3e8
    v_mov_b32 v45, 0xc0135761
    s_waitcnt vmcnt(4)
    ds_read_b64_tr_b16 v[48:49], v36 offset:0
    ds_read_b64_tr_b16 v[50:51], v36 offset:256
    ds_read_b64_tr_b16 v[52:53], v36 offset:2048
    ds_read_b64_tr_b16 v[54:55], v36 offset:2304
    ds_read_b64_tr_b16 v[56:57], v37 offset:0
    ds_read_b64_tr_b16 v[58:59], v37 offset:256
    ds_read_b64_tr_b16 v[60:61], v37 offset:2048
    ds_read_b64_tr_b16 v[62:63], v37 offset:2304
    s_waitcnt lgkmcnt(0)
    v_mfma_f32_16x16x32_bf16 v[64:67], v[48:51], v[8:11], 0
    v_mfma_f32_16x16x32_bf16 v[68:71], v[56:59], v[8:11], 0
    v_mfma_f32_16x16x32_bf16 v[64:67], v[52:55], v[12:15], v[64:67]
    v_mfma_f32_16x16x32_bf16 v[68:71], v[60:63], v[12:15], v[68:71]
    ds_read_b64_tr_b16 v[84:85], v38 offset:0
    ds_read_b64_tr_b16 v[86:87], v38 offset:256
    ds_read_b64_tr_b16 v[88:89], v38 offset:2048
    ds_read_b64_tr_b16 v[90:91], v38 offset:2304
    ds_read_b64_tr_b16 v[92:93], v39 offset:0
    ds_read_b64_tr_b16 v[94:95], v39 offset:256
    ds_read_b64_tr_b16 v[96:97], v39 offset:2048
    ds_read_b64_tr_b16 v[98:99], v39 offset:2304
    v_mul_f32 v72, v64, v64
    v_mul_f32 v73, v65, v65
    v_mul_f32 v74, v66, v66
    v_mul_f32 v75, v67, v67
    v_mul_f32 v76, v68, v68
    v_mul_f32 v77, v69, v69
    v_mul_f32 v78, v70, v70
    v_mul_f32 v79, v71, v71
    v_fma_f32 v72, v72, s40, v44
    v_fma_f32 v73, v73, s40, v44
    v_fma_f32 v74, v74, s40, v44
    v_fma_f32 v75, v75, s40, v44
    v_fma_f32 v76, v76, s40, v44
    v_fma_f32 v77, v77, s40, v44
    v_fma_f32 v78, v78, s40, v44
    v_fma_f32 v79, v79, s40, v44
    v_mul_f32 v72, v72, v64
    v_mul_f32 v73, v73, v65
    v_mul_f32 v74, v74, v66
    v_mul_f32 v75, v75, v67
    v_mul_f32 v76, v76, v68
    v_mul_f32 v77, v77, v69
    v_mul_f32 v78, v78, v70
    v_mul_f32 v79, v79, v71
    v_exp_f32 v72, v72
    v_exp_f32 v73, v73
    v_exp_f32 v74, v74
    v_exp_f32 v75, v75
    v_exp_f32 v76, v76
    v_exp_f32 v77, v77
    v_exp_f32 v78, v78
    v_exp_f32 v79, v79
    v_add_f32 v72, 1.0, v72
    v_add_f32 v73, 1.0, v73
    v_add_f32 v74, 1.0, v74
    v_add_f32 v75, 1.0, v75
    v_add_f32 v76, 1.0, v76
    v_add_f32 v77, 1.0, v77
    v_add_f32 v78, 1.0, v78
    v_add_f32 v79, 1.0, v79
    v_rcp_f32 v72, v72
    v_rcp_f32 v73, v73
    v_rcp_f32 v74, v74
    v_rcp_f32 v75, v75
    v_rcp_f32 v76, v76
    v_rcp_f32 v77, v77
    v_rcp_f32 v78, v78
    v_rcp_f32 v79, v79
    v_mul_f32 v64, v64, v72
    v_mul_f32 v65, v65, v73
    v_mul_f32 v66, v66, v74
    v_mul_f32 v67, v67, v75
    v_mul_f32 v68, v68, v76
    v_mul_f32 v69, v69, v77
    v_mul_f32 v70, v70, v78
    v_mul_f32 v71, v71, v79
    v_cvt_pk_bf16_f32 v80, v64, v65
    v_cvt_pk_bf16_f32 v81, v66, v67
    v_cvt_pk_bf16_f32 v82, v68, v69
    v_cvt_pk_bf16_f32 v83, v70, v71
    ds_write_b128 v43, v[80:83] offset:0
    s_waitcnt vmcnt(0)
    s_waitcnt lgkmcnt(1)
    v_mfma_f32_16x16x32_bf16 v[100:103], v[84:87], v[16:19], 0
    v_mfma_f32_16x16x32_bf16 v[104:107], v[92:95], v[16:19], 0
    v_mfma_f32_16x16x32_bf16 v[100:103], v[88:91], v[20:23], v[100:103]
    v_mfma_f32_16x16x32_bf16 v[104:107], v[96:99], v[20:23], v[104:107]
    ds_read_b64_tr_b16 v[48:49], v36 offset:4096
    ds_read_b64_tr_b16 v[50:51], v36 offset:4352
    ds_read_b64_tr_b16 v[52:53], v36 offset:6144
    ds_read_b64_tr_b16 v[54:55], v36 offset:6400
    ds_read_b64_tr_b16 v[56:57], v37 offset:4096
    ds_read_b64_tr_b16 v[58:59], v37 offset:4352
    ds_read_b64_tr_b16 v[60:61], v37 offset:6144
    ds_read_b64_tr_b16 v[62:63], v37 offset:6400
    v_mul_f32 v72, v100, v100
    v_mul_f32 v73, v101, v101
    v_mul_f32 v74, v102, v102
    v_mul_f32 v75, v103, v103
    v_mul_f32 v76, v104, v104
    v_mul_f32 v77, v105, v105
    v_mul_f32 v78, v106, v106
    v_mul_f32 v79, v107, v107
    v_fma_f32 v72, v72, s40, v44
    v_fma_f32 v73, v73, s40, v44
    v_fma_f32 v74, v74, s40, v44
    v_fma_f32 v75, v75, s40, v44
    v_fma_f32 v76, v76, s40, v44
    v_fma_f32 v77, v77, s40, v44
    v_fma_f32 v78, v78, s40, v44
    v_fma_f32 v79, v79, s40, v44
    v_mul_f32 v72, v72, v100
    v_mul_f32 v73, v73, v101
    v_mul_f32 v74, v74, v102
    v_mul_f32 v75, v75, v103
    v_mul_f32 v76, v76, v104
    v_mul_f32 v77, v77, v105
    v_mul_f32 v78, v78, v106
    v_mul_f32 v79, v79, v107
    v_exp_f32 v72, v72
    v_exp_f32 v73, v73
    v_exp_f32 v74, v74
    v_exp_f32 v75, v75
    v_exp_f32 v76, v76
    v_exp_f32 v77, v77
    v_exp_f32 v78, v78
    v_exp_f32 v79, v79
    v_add_f32 v72, 1.0, v72
    v_add_f32 v73, 1.0, v73
    v_add_f32 v74, 1.0, v74
    v_add_f32 v75, 1.0, v75
    v_add_f32 v76, 1.0, v76
    v_add_f32 v77, 1.0, v77
    v_add_f32 v78, 1.0, v78
    v_add_f32 v79, 1.0, v79
    v_rcp_f32 v72, v72
    v_rcp_f32 v73, v73
    v_rcp_f32 v74, v74
    v_rcp_f32 v75, v75
    v_rcp_f32 v76, v76
    v_rcp_f32 v77, v77
    v_rcp_f32 v78, v78
    v_rcp_f32 v79, v79
    v_mul_f32 v100, v100, v72
    v_mul_f32 v101, v101, v73
    v_mul_f32 v102, v102, v74
    v_mul_f32 v103, v103, v75
    v_mul_f32 v104, v104, v76
    v_mul_f32 v105, v105, v77
    v_mul_f32 v106, v106, v78
    v_mul_f32 v107, v107, v79
    v_cvt_pk_bf16_f32 v108, v100, v101
    v_cvt_pk_bf16_f32 v109, v102, v103
    v_cvt_pk_bf16_f32 v110, v104, v105
    v_cvt_pk_bf16_f32 v111, v106, v107
    ds_write_b128 v43, v[108:111] offset:256
    s_waitcnt lgkmcnt(1)
    v_mfma_f32_16x16x32_bf16 v[64:67], v[48:51], v[8:11], 0
    v_mfma_f32_16x16x32_bf16 v[68:71], v[56:59], v[8:11], 0
    v_mfma_f32_16x16x32_bf16 v[64:67], v[52:55], v[12:15], v[64:67]
    v_mfma_f32_16x16x32_bf16 v[68:71], v[60:63], v[12:15], v[68:71]
    ds_read_b64_tr_b16 v[84:85], v38 offset:4096
    ds_read_b64_tr_b16 v[86:87], v38 offset:4352
    ds_read_b64_tr_b16 v[88:89], v38 offset:6144
    ds_read_b64_tr_b16 v[90:91], v38 offset:6400
    ds_read_b64_tr_b16 v[92:93], v39 offset:4096
    ds_read_b64_tr_b16 v[94:95], v39 offset:4352
    ds_read_b64_tr_b16 v[96:97], v39 offset:6144
    ds_read_b64_tr_b16 v[98:99], v39 offset:6400
    v_mul_f32 v72, v64, v64
    v_mul_f32 v73, v65, v65
    v_mul_f32 v74, v66, v66
    v_mul_f32 v75, v67, v67
    v_mul_f32 v76, v68, v68
    v_mul_f32 v77, v69, v69
    v_mul_f32 v78, v70, v70
    v_mul_f32 v79, v71, v71
    v_fma_f32 v72, v72, s40, v44
    v_fma_f32 v73, v73, s40, v44
    v_fma_f32 v74, v74, s40, v44
    v_fma_f32 v75, v75, s40, v44
    v_fma_f32 v76, v76, s40, v44
    v_fma_f32 v77, v77, s40, v44
    v_fma_f32 v78, v78, s40, v44
    v_fma_f32 v79, v79, s40, v44
    v_mul_f32 v72, v72, v64
    v_mul_f32 v73, v73, v65
    v_mul_f32 v74, v74, v66
    v_mul_f32 v75, v75, v67
    v_mul_f32 v76, v76, v68
    v_mul_f32 v77, v77, v69
    v_mul_f32 v78, v78, v70
    v_mul_f32 v79, v79, v71
    v_exp_f32 v72, v72
    v_exp_f32 v73, v73
    v_exp_f32 v74, v74
    v_exp_f32 v75, v75
    v_exp_f32 v76, v76
    v_exp_f32 v77, v77
    v_exp_f32 v78, v78
    v_exp_f32 v79, v79
    v_add_f32 v72, 1.0, v72
    v_add_f32 v73, 1.0, v73
    v_add_f32 v74, 1.0, v74
    v_add_f32 v75, 1.0, v75
    v_add_f32 v76, 1.0, v76
    v_add_f32 v77, 1.0, v77
    v_add_f32 v78, 1.0, v78
    v_add_f32 v79, 1.0, v79
    v_rcp_f32 v72, v72
    v_rcp_f32 v73, v73
    v_rcp_f32 v74, v74
    v_rcp_f32 v75, v75
    v_rcp_f32 v76, v76
    v_rcp_f32 v77, v77
    v_rcp_f32 v78, v78
    v_rcp_f32 v79, v79
    v_mul_f32 v64, v64, v72
    v_mul_f32 v65, v65, v73
    v_mul_f32 v66, v66, v74
    v_mul_f32 v67, v67, v75
    v_mul_f32 v68, v68, v76
    v_mul_f32 v69, v69, v77
    v_mul_f32 v70, v70, v78
    v_mul_f32 v71, v71, v79
    v_cvt_pk_bf16_f32 v80, v64, v65
    v_cvt_pk_bf16_f32 v81, v66, v67
    v_cvt_pk_bf16_f32 v82, v68, v69
    v_cvt_pk_bf16_f32 v83, v70, v71
    ds_write_b128 v43, v[80:83] offset:2048
    s_waitcnt lgkmcnt(1)
    v_mfma_f32_16x16x32_bf16 v[100:103], v[84:87], v[16:19], 0
    v_mfma_f32_16x16x32_bf16 v[104:107], v[92:95], v[16:19], 0
    v_mfma_f32_16x16x32_bf16 v[100:103], v[88:91], v[20:23], v[100:103]
    v_mfma_f32_16x16x32_bf16 v[104:107], v[96:99], v[20:23], v[104:107]
    s_nop 7
    v_mul_f32 v72, v100, v100
    v_mul_f32 v73, v101, v101
    v_mul_f32 v74, v102, v102
    v_mul_f32 v75, v103, v103
    v_mul_f32 v76, v104, v104
    v_mul_f32 v77, v105, v105
    v_mul_f32 v78, v106, v106
    v_mul_f32 v79, v107, v107
    v_fma_f32 v72, v72, s40, v44
    v_fma_f32 v73, v73, s40, v44
    v_fma_f32 v74, v74, s40, v44
    v_fma_f32 v75, v75, s40, v44
    v_fma_f32 v76, v76, s40, v44
    v_fma_f32 v77, v77, s40, v44
    v_fma_f32 v78, v78, s40, v44
    v_fma_f32 v79, v79, s40, v44
    v_mul_f32 v72, v72, v100
    v_mul_f32 v73, v73, v101
    v_mul_f32 v74, v74, v102
    v_mul_f32 v75, v75, v103
    v_mul_f32 v76, v76, v104
    v_mul_f32 v77, v77, v105
    v_mul_f32 v78, v78, v106
    v_mul_f32 v79, v79, v107
    v_exp_f32 v72, v72
    v_exp_f32 v73, v73
    v_exp_f32 v74, v74
    v_exp_f32 v75, v75
    v_exp_f32 v76, v76
    v_exp_f32 v77, v77
    v_exp_f32 v78, v78
    v_exp_f32 v79, v79
    v_add_f32 v72, 1.0, v72
    v_add_f32 v73, 1.0, v73
    v_add_f32 v74, 1.0, v74
    v_add_f32 v75, 1.0, v75
    v_add_f32 v76, 1.0, v76
    v_add_f32 v77, 1.0, v77
    v_add_f32 v78, 1.0, v78
    v_add_f32 v79, 1.0, v79
    v_rcp_f32 v72, v72
    v_rcp_f32 v73, v73
    v_rcp_f32 v74, v74
    v_rcp_f32 v75, v75
    v_rcp_f32 v76, v76
    v_rcp_f32 v77, v77
    v_rcp_f32 v78, v78
    v_rcp_f32 v79, v79
    v_mul_f32 v100, v100, v72
    v_mul_f32 v101, v101, v73
    v_mul_f32 v102, v102, v74
    v_mul_f32 v103, v103, v75
    v_mul_f32 v104, v104, v76
    v_mul_f32 v105, v105, v77
    v_mul_f32 v106, v106, v78
    v_mul_f32 v107, v107, v79
    v_cvt_pk_bf16_f32 v108, v100, v101
    v_cvt_pk_bf16_f32 v109, v102, v103
    v_cvt_pk_bf16_f32 v110, v104, v105
    v_cvt_pk_bf16_f32 v111, v106, v107
    ds_write_b128 v43, v[108:111] offset:2304
    s_waitcnt lgkmcnt(0)
    s_barrier
    s_add_u32 s36, s38, 163840
    buffer_load_dwordx4 a[0:3], v5, s[12:15], s36 offen
    s_add_u32 s36, s38, 180224
    buffer_load_dwordx4 a[64:67], v5, s[12:15], s36 offen
    s_add_u32 s36, s38, 164864
    buffer_load_dwordx4 a[4:7], v5, s[12:15], s36 offen
    s_add_u32 s36, s38, 181248
    buffer_load_dwordx4 a[68:71], v5, s[12:15], s36 offen
    s_add_u32 s36, s38, 165888
    buffer_load_dwordx4 a[8:11], v5, s[12:15], s36 offen
    s_add_u32 s36, s38, 182272
    buffer_load_dwordx4 a[72:75], v5, s[12:15], s36 offen
    s_add_u32 s36, s38, 166912
    buffer_load_dwordx4 a[12:15], v5, s[12:15], s36 offen
    s_add_u32 s36, s38, 183296
    buffer_load_dwordx4 a[76:79], v5, s[12:15], s36 offen
    s_add_u32 s36, s38, 167936
    buffer_load_dwordx4 a[16:19], v5, s[12:15], s36 offen
    s_add_u32 s36, s38, 184320
    buffer_load_dwordx4 a[80:83], v5, s[12:15], s36 offen
    s_add_u32 s36, s38, 168960
    buffer_load_dwordx4 a[20:23], v5, s[12:15], s36 offen
    s_add_u32 s36, s38, 185344
    buffer_load_dwordx4 a[84:87], v5, s[12:15], s36 offen
    s_add_u32 s36, s38, 169984
    buffer_load_dwordx4 a[24:27], v5, s[12:15], s36 offen
    s_add_u32 s36, s38, 186368
    buffer_load_dwordx4 a[88:91], v5, s[12:15], s36 offen
    s_add_u32 s36, s38, 171008
    buffer_load_dwordx4 a[28:31], v5, s[12:15], s36 offen
    s_add_u32 s36, s38, 187392
    buffer_load_dwordx4 a[92:95], v5, s[12:15], s36 offen
    s_add_u32 s36, s38, 172032
    buffer_load_dwordx4 a[32:35], v5, s[12:15], s36 offen
    s_add_u32 s36, s38, 188416
    buffer_load_dwordx4 a[96:99], v5, s[12:15], s36 offen
    s_add_u32 s36, s38, 173056
    buffer_load_dwordx4 a[36:39], v5, s[12:15], s36 offen
    s_add_u32 s36, s38, 189440
    buffer_load_dwordx4 a[100:103], v5, s[12:15], s36 offen
    s_add_u32 s36, s38, 174080
    buffer_load_dwordx4 a[40:43], v5, s[12:15], s36 offen
    s_add_u32 s36, s38, 190464
    buffer_load_dwordx4 a[104:107], v5, s[12:15], s36 offen
    s_add_u32 s36, s38, 175104
    buffer_load_dwordx4 a[44:47], v5, s[12:15], s36 offen
    s_add_u32 s36, s38, 191488
    buffer_load_dwordx4 a[108:111], v5, s[12:15], s36 offen
    s_add_u32 s36, s38, 176128
    buffer_load_dwordx4 a[48:51], v5, s[12:15], s36 offen
    s_add_u32 s36, s38, 192512
    buffer_load_dwordx4 a[112:115], v5, s[12:15], s36 offen
    s_add_u32 s36, s38, 177152
    buffer_load_dwordx4 a[52:55], v5, s[12:15], s36 offen
    s_add_u32 s36, s38, 193536
    buffer_load_dwordx4 a[116:119], v5, s[12:15], s36 offen
    s_add_u32 s36, s38, 178176
    buffer_load_dwordx4 a[56:59], v5, s[12:15], s36 offen
    s_add_u32 s36, s38, 194560
    buffer_load_dwordx4 a[120:123], v5, s[12:15], s36 offen
    s_add_u32 s36, s38, 179200
    buffer_load_dwordx4 a[60:63], v5, s[12:15], s36 offen
    s_add_u32 s36, s38, 195584
    buffer_load_dwordx4 a[124:127], v5, s[12:15], s36 offen
    v_and_b32 v46, 31, v1
    v_mul_u32_u24 v47, 528, v46
    v_lshrrev_b32 v45, 5, v1
    v_lshl_add_u32 v47, v45, 4, v47
    s_lshl_b32 s36, s21, 7
    s_add_u32 s36, s36, 115712
    v_add_u32 v6, s36, v47
    v_lshlrev_b32 v7, 6, v45
    s_lshl_b32 s36, s21, 8
    s_add_u32 s36, s36, 14336
    buffer_load_dwordx4 v[72:75], v7, s[12:15], s36 offen offset:0
    buffer_load_dwordx4 v[76:79], v7, s[12:15], s36 offen offset:16
    buffer_load_dwordx4 v[80:83], v7, s[12:15], s36 offen offset:32
    buffer_load_dwordx4 v[84:87], v7, s[12:15], s36 offen offset:48
    buffer_load_dwordx4 v[88:91], v7, s[12:15], s36 offen offset:128
    buffer_load_dwordx4 v[92:95], v7, s[12:15], s36 offen offset:144
    buffer_load_dwordx4 v[96:99], v7, s[12:15], s36 offen offset:160
    buffer_load_dwordx4 v[100:103], v7, s[12:15], s36 offen offset:176
    s_setprio 1
    s_waitcnt vmcnt(0)
    s_barrier
    ds_read_b128 v[104:107], v5 offset:0
    ds_read_b128 v[108:111], v5 offset:1024
    ds_read_b128 v[112:115], v5 offset:2048
    s_waitcnt lgkmcnt(2)
    v_mfma_f32_32x32x16_bf16 v[8:23], a[0:3], v[104:107], v[72:87]
    ds_read_b128 v[116:119], v5 offset:3072
    v_mfma_f32_32x32x16_bf16 v[24:39], a[64:67], v[104:107], v[88:103]
    s_waitcnt lgkmcnt(2)
    v_mfma_f32_32x32x16_bf16 v[8:23], a[4:7], v[108:111], v[8:23]
    ds_read_b128 v[104:107], v5 offset:4096
    v_mfma_f32_32x32x16_bf16 v[24:39], a[68:71], v[108:111], v[24:39]
    s_waitcnt lgkmcnt(2)
    v_mfma_f32_32x32x16_bf16 v[8:23], a[8:11], v[112:115], v[8:23]
    ds_read_b128 v[108:111], v5 offset:5120
    v_mfma_f32_32x32x16_bf16 v[24:39], a[72:75], v[112:115], v[24:39]
    s_waitcnt lgkmcnt(2)
    v_mfma_f32_32x32x16_bf16 v[8:23], a[12:15], v[116:119], v[8:23]
    ds_read_b128 v[112:115], v5 offset:6144
    v_mfma_f32_32x32x16_bf16 v[24:39], a[76:79], v[116:119], v[24:39]
    s_waitcnt lgkmcnt(2)
    v_mfma_f32_32x32x16_bf16 v[8:23], a[16:19], v[104:107], v[8:23]
    ds_read_b128 v[116:119], v5 offset:7168
    v_mfma_f32_32x32x16_bf16 v[24:39], a[80:83], v[104:107], v[24:39]
    s_waitcnt lgkmcnt(2)
    v_mfma_f32_32x32x16_bf16 v[8:23], a[20:23], v[108:111], v[8:23]
    ds_read_b128 v[104:107], v5 offset:8192
    v_mfma_f32_32x32x16_bf16 v[24:39], a[84:87], v[108:111], v[24:39]
    s_waitcnt lgkmcnt(2)
    v_mfma_f32_32x32x16_bf16 v[8:23], a[24:27], v[112:115], v[8:23]
    ds_read_b128 v[108:111], v5 offset:9216
    v_mfma_f32_32x32x16_bf16 v[24:39], a[88:91], v[112:115], v[24:39]
    s_waitcnt lgkmcnt(2)
    v_mfma_f32_32x32x16_bf16 v[8:23], a[28:31], v[116:119], v[8:23]
    ds_read_b128 v[112:115], v5 offset:10240
    v_mfma_f32_32x32x16_bf16 v[24:39], a[92:95], v[116:119], v[24:39]
    s_waitcnt lgkmcnt(2)
    v_mfma_f32_32x32x16_bf16 v[8:23], a[32:35], v[104:107], v[8:23]
    ds_read_b128 v[116:119], v5 offset:11264
    v_mfma_f32_32x32x16_bf16 v[24:39], a[96:99], v[104:107], v[24:39]
    s_waitcnt lgkmcnt(2)
    v_mfma_f32_32x32x16_bf16 v[8:23], a[36:39], v[108:111], v[8:23]
    ds_read_b128 v[104:107], v5 offset:12288
    v_mfma_f32_32x32x16_bf16 v[24:39], a[100:103], v[108:111], v[24:39]
    s_waitcnt lgkmcnt(2)
    v_mfma_f32_32x32x16_bf16 v[8:23], a[40:43], v[112:115], v[8:23]
    ds_read_b128 v[108:111], v5 offset:13312
    v_mfma_f32_32x32x16_bf16 v[24:39], a[104:107], v[112:115], v[24:39]
    s_waitcnt lgkmcnt(2)
    v_mfma_f32_32x32x16_bf16 v[8:23], a[44:47], v[116:119], v[8:23]
    ds_read_b128 v[112:115], v5 offset:14336
    v_mfma_f32_32x32x16_bf16 v[24:39], a[108:111], v[116:119], v[24:39]
    s_waitcnt lgkmcnt(2)
    v_mfma_f32_32x32x16_bf16 v[8:23], a[48:51], v[104:107], v[8:23]
    ds_read_b128 v[116:119], v5 offset:15360
    v_mfma_f32_32x32x16_bf16 v[24:39], a[112:115], v[104:107], v[24:39]
    s_waitcnt lgkmcnt(2)
    v_mfma_f32_32x32x16_bf16 v[8:23], a[52:55], v[108:111], v[8:23]
    ds_read_b128 v[104:107], v5 offset:16384
    v_mfma_f32_32x32x16_bf16 v[24:39], a[116:119], v[108:111], v[24:39]
    s_waitcnt lgkmcnt(2)
    v_mfma_f32_32x32x16_bf16 v[8:23], a[56:59], v[112:115], v[8:23]
    ds_read_b128 v[108:111], v5 offset:17408
    v_mfma_f32_32x32x16_bf16 v[24:39], a[120:123], v[112:115], v[24:39]
    s_waitcnt lgkmcnt(2)
    v_mfma_f32_32x32x16_bf16 v[8:23], a[60:63], v[116:119], v[8:23]
    ds_read_b128 v[112:115], v5 offset:18432
    v_mfma_f32_32x32x16_bf16 v[24:39], a[124:127], v[116:119], v[24:39]
    s_barrier
    s_waitcnt lgkmcnt(2)
    v_mfma_f32_32x32x16_bf16 v[40:55], a[0:3], v[104:107], v[72:87]
    ds_read_b128 v[116:119], v5 offset:19456
    v_mfma_f32_32x32x16_bf16 v[56:71], a[64:67], v[104:107], v[88:103]
    s_waitcnt lgkmcnt(2)
    v_mfma_f32_32x32x16_bf16 v[40:55], a[4:7], v[108:111], v[40:55]
    ds_read_b128 v[104:107], v5 offset:20480
    v_mfma_f32_32x32x16_bf16 v[56:71], a[68:71], v[108:111], v[56:71]
    s_waitcnt lgkmcnt(2)
    v_mfma_f32_32x32x16_bf16 v[40:55], a[8:11], v[112:115], v[40:55]
    ds_read_b128 v[108:111], v5 offset:21504
    v_cvt_pk_bf16_f32 v120, v8, v9
    v_mfma_f32_32x32x16_bf16 v[56:71], a[72:75], v[112:115], v[56:71]
    v_cvt_pk_bf16_f32 v121, v10, v11
    s_waitcnt lgkmcnt(2)
    v_mfma_f32_32x32x16_bf16 v[40:55], a[12:15], v[116:119], v[40:55]
    ds_read_b128 v[112:115], v5 offset:22528
    v_cvt_pk_bf16_f32 v122, v12, v13
    v_mfma_f32_32x32x16_bf16 v[56:71], a[76:79], v[116:119], v[56:71]
    v_cvt_pk_bf16_f32 v123, v14, v15
    s_waitcnt lgkmcnt(2)
    v_mfma_f32_32x32x16_bf16 v[40:55], a[16:19], v[104:107], v[40:55]
    ds_read_b128 v[116:119], v5 offset:23552
    ds_write_b128 v6, v[120:123] offset:0
    v_mfma_f32_32x32x16_bf16 v[56:71], a[80:83], v[104:107], v[56:71]
    v_cvt_pk_bf16_f32 v124, v16, v17
    s_waitcnt lgkmcnt(3)
    v_mfma_f32_32x32x16_bf16 v[40:55], a[20:23], v[108:111], v[40:55]
    ds_read_b128 v[104:107], v5 offset:24576
    v_cvt_pk_bf16_f32 v125, v18, v19
    v_mfma_f32_32x32x16_bf16 v[56:71], a[84:87], v[108:111], v[56:71]
    v_cvt_pk_bf16_f32 v126, v20, v21
    s_waitcnt lgkmcnt(3)
    v_mfma_f32_32x32x16_bf16 v[40:55], a[24:27], v[112:115], v[40:55]
    ds_read_b128 v[108:111], v5 offset:25600
    v_cvt_pk_bf16_f32 v127, v22, v23
    v_mfma_f32_32x32x16_bf16 v[56:71], a[88:91], v[112:115], v[56:71]
    ds_write_b128 v6, v[124:127] offset:32
    s_waitcnt lgkmcnt(4)
    v_mfma_f32_32x32x16_bf16 v[40:55], a[28:31], v[116:119], v[40:55]
    ds_read_b128 v[112:115], v5 offset:26624
    v_cvt_pk_bf16_f32 v120, v24, v25
    v_mfma_f32_32x32x16_bf16 v[56:71], a[92:95], v[116:119], v[56:71]
    v_cvt_pk_bf16_f32 v121, v26, v27
    s_waitcnt lgkmcnt(3)
    v_mfma_f32_32x32x16_bf16 v[40:55], a[32:35], v[104:107], v[40:55]
    ds_read_b128 v[116:119], v5 offset:27648
    v_cvt_pk_bf16_f32 v122, v28, v29
    v_mfma_f32_32x32x16_bf16 v[56:71], a[96:99], v[104:107], v[56:71]
    v_cvt_pk_bf16_f32 v123, v30, v31
    s_waitcnt lgkmcnt(3)
    v_mfma_f32_32x32x16_bf16 v[40:55], a[36:39], v[108:111], v[40:55]
    ds_read_b128 v[104:107], v5 offset:28672
    ds_write_b128 v6, v[120:123] offset:64
    v_mfma_f32_32x32x16_bf16 v[56:71], a[100:103], v[108:111], v[56:71]
    v_cvt_pk_bf16_f32 v124, v32, v33
    s_waitcnt lgkmcnt(3)
    v_mfma_f32_32x32x16_bf16 v[40:55], a[40:43], v[112:115], v[40:55]
    ds_read_b128 v[108:111], v5 offset:29696
    v_cvt_pk_bf16_f32 v125, v34, v35
    v_mfma_f32_32x32x16_bf16 v[56:71], a[104:107], v[112:115], v[56:71]
    v_cvt_pk_bf16_f32 v126, v36, v37
    s_waitcnt lgkmcnt(3)
    v_mfma_f32_32x32x16_bf16 v[40:55], a[44:47], v[116:119], v[40:55]
    ds_read_b128 v[112:115], v5 offset:30720
    v_cvt_pk_bf16_f32 v127, v38, v39
    v_mfma_f32_32x32x16_bf16 v[56:71], a[108:111], v[116:119], v[56:71]
    ds_write_b128 v6, v[124:127] offset:96
    s_waitcnt lgkmcnt(4)
    v_mfma_f32_32x32x16_bf16 v[40:55], a[48:51], v[104:107], v[40:55]
    ds_read_b128 v[116:119], v5 offset:31744
    v_mfma_f32_32x32x16_bf16 v[56:71], a[112:115], v[104:107], v[56:71]
    s_waitcnt lgkmcnt(3)
    v_mfma_f32_32x32x16_bf16 v[40:55], a[52:55], v[108:111], v[40:55]
    ds_read_b128 v[104:107], v5 offset:32768
    v_mfma_f32_32x32x16_bf16 v[56:71], a[116:119], v[108:111], v[56:71]
    s_waitcnt lgkmcnt(3)
    v_mfma_f32_32x32x16_bf16 v[40:55], a[56:59], v[112:115], v[40:55]
    ds_read_b128 v[108:111], v5 offset:33792
    v_mfma_f32_32x32x16_bf16 v[56:71], a[120:123], v[112:115], v[56:71]
    s_waitcnt lgkmcnt(2)
    v_mfma_f32_32x32x16_bf16 v[40:55], a[60:63], v[116:119], v[40:55]
    ds_read_b128 v[112:115], v5 offset:34816
    v_mfma_f32_32x32x16_bf16 v[56:71], a[124:127], v[116:119], v[56:71]
    s_barrier
    s_waitcnt lgkmcnt(2)
    v_mfma_f32_32x32x16_bf16 v[8:23], a[0:3], v[104:107], v[72:87]
    ds_read_b128 v[116:119], v5 offset:35840
    v_mfma_f32_32x32x16_bf16 v[24:39], a[64:67], v[104:107], v[88:103]
    s_waitcnt lgkmcnt(2)
    v_mfma_f32_32x32x16_bf16 v[8:23], a[4:7], v[108:111], v[8:23]
    ds_read_b128 v[104:107], v5 offset:36864
    v_mfma_f32_32x32x16_bf16 v[24:39], a[68:71], v[108:111], v[24:39]
    s_waitcnt lgkmcnt(2)
    v_mfma_f32_32x32x16_bf16 v[8:23], a[8:11], v[112:115], v[8:23]
    ds_read_b128 v[108:111], v5 offset:37888
    v_cvt_pk_bf16_f32 v120, v40, v41
    v_mfma_f32_32x32x16_bf16 v[24:39], a[72:75], v[112:115], v[24:39]
    v_cvt_pk_bf16_f32 v121, v42, v43
    s_waitcnt lgkmcnt(2)
    v_mfma_f32_32x32x16_bf16 v[8:23], a[12:15], v[116:119], v[8:23]
    ds_read_b128 v[112:115], v5 offset:38912
    v_cvt_pk_bf16_f32 v122, v44, v45
    v_mfma_f32_32x32x16_bf16 v[24:39], a[76:79], v[116:119], v[24:39]
    v_cvt_pk_bf16_f32 v123, v46, v47
    s_waitcnt lgkmcnt(2)
    v_mfma_f32_32x32x16_bf16 v[8:23], a[16:19], v[104:107], v[8:23]
    ds_read_b128 v[116:119], v5 offset:39936
    ds_write_b128 v6, v[120:123] offset:16896
    v_mfma_f32_32x32x16_bf16 v[24:39], a[80:83], v[104:107], v[24:39]
    v_cvt_pk_bf16_f32 v124, v48, v49
    s_waitcnt lgkmcnt(3)
    v_mfma_f32_32x32x16_bf16 v[8:23], a[20:23], v[108:111], v[8:23]
    ds_read_b128 v[104:107], v5 offset:40960
    v_cvt_pk_bf16_f32 v125, v50, v51
    v_mfma_f32_32x32x16_bf16 v[24:39], a[84:87], v[108:111], v[24:39]
    v_cvt_pk_bf16_f32 v126, v52, v53
    s_waitcnt lgkmcnt(3)
    v_mfma_f32_32x32x16_bf16 v[8:23], a[24:27], v[112:115], v[8:23]
    ds_read_b128 v[108:111], v5 offset:41984
    v_cvt_pk_bf16_f32 v127, v54, v55
    v_mfma_f32_32x32x16_bf16 v[24:39], a[88:91], v[112:115], v[24:39]
    ds_write_b128 v6, v[124:127] offset:16928
    s_waitcnt lgkmcnt(4)
    v_mfma_f32_32x32x16_bf16 v[8:23], a[28:31], v[116:119], v[8:23]
    ds_read_b128 v[112:115], v5 offset:43008
    v_cvt_pk_bf16_f32 v120, v56, v57
    v_mfma_f32_32x32x16_bf16 v[24:39], a[92:95], v[116:119], v[24:39]
    v_cvt_pk_bf16_f32 v121, v58, v59
    s_waitcnt lgkmcnt(3)
    v_mfma_f32_32x32x16_bf16 v[8:23], a[32:35], v[104:107], v[8:23]
    ds_read_b128 v[116:119], v5 offset:44032
    v_cvt_pk_bf16_f32 v122, v60, v61
    v_mfma_f32_32x32x16_bf16 v[24:39], a[96:99], v[104:107], v[24:39]
    v_cvt_pk_bf16_f32 v123, v62, v63
    s_waitcnt lgkmcnt(3)
    v_mfma_f32_32x32x16_bf16 v[8:23], a[36:39], v[108:111], v[8:23]
    ds_read_b128 v[104:107], v5 offset:45056
    ds_write_b128 v6, v[120:123] offset:16960
    v_mfma_f32_32x32x16_bf16 v[24:39], a[100:103], v[108:111], v[24:39]
    v_cvt_pk_bf16_f32 v124, v64, v65
    s_waitcnt lgkmcnt(3)
    v_mfma_f32_32x32x16_bf16 v[8:23], a[40:43], v[112:115], v[8:23]
    ds_read_b128 v[108:111], v5 offset:46080
    v_cvt_pk_bf16_f32 v125, v66, v67
    v_mfma_f32_32x32x16_bf16 v[24:39], a[104:107], v[112:115], v[24:39]
    v_cvt_pk_bf16_f32 v126, v68, v69
    s_waitcnt lgkmcnt(3)
    v_mfma_f32_32x32x16_bf16 v[8:23], a[44:47], v[116:119], v[8:23]
    ds_read_b128 v[112:115], v5 offset:47104
    v_cvt_pk_bf16_f32 v127, v70, v71
    v_mfma_f32_32x32x16_bf16 v[24:39], a[108:111], v[116:119], v[24:39]
    ds_write_b128 v6, v[124:127] offset:16992
    s_waitcnt lgkmcnt(4)
    v_mfma_f32_32x32x16_bf16 v[8:23], a[48:51], v[104:107], v[8:23]
    ds_read_b128 v[116:119], v5 offset:48128
    v_mfma_f32_32x32x16_bf16 v[24:39], a[112:115], v[104:107], v[24:39]
    s_waitcnt lgkmcnt(3)
    v_mfma_f32_32x32x16_bf16 v[8:23], a[52:55], v[108:111], v[8:23]
    ds_read_b128 v[104:107], v5 offset:0
    v_mfma_f32_32x32x16_bf16 v[24:39], a[116:119], v[108:111], v[24:39]
    s_waitcnt lgkmcnt(3)
    v_mfma_f32_32x32x16_bf16 v[8:23], a[56:59], v[112:115], v[8:23]
    ds_read_b128 v[108:111], v5 offset:1024
    v_mfma_f32_32x32x16_bf16 v[24:39], a[120:123], v[112:115], v[24:39]
    s_waitcnt lgkmcnt(2)
    v_mfma_f32_32x32x16_bf16 v[8:23], a[60:63], v[116:119], v[8:23]
    ds_read_b128 v[112:115], v5 offset:2048
    v_mfma_f32_32x32x16_bf16 v[24:39], a[124:127], v[116:119], v[24:39]
    s_barrier
    s_waitcnt lgkmcnt(2)
    v_mfma_f32_32x32x16_bf16 v[40:55], a[0:3], v[104:107], v[72:87]
    ds_read_b128 v[116:119], v5 offset:3072
    v_mfma_f32_32x32x16_bf16 v[56:71], a[64:67], v[104:107], v[88:103]
    s_waitcnt lgkmcnt(2)
    v_mfma_f32_32x32x16_bf16 v[40:55], a[4:7], v[108:111], v[40:55]
    ds_read_b128 v[104:107], v5 offset:4096
    v_mfma_f32_32x32x16_bf16 v[56:71], a[68:71], v[108:111], v[56:71]
    s_waitcnt lgkmcnt(2)
    v_mfma_f32_32x32x16_bf16 v[40:55], a[8:11], v[112:115], v[40:55]
    ds_read_b128 v[108:111], v5 offset:5120
    v_cvt_pk_bf16_f32 v120, v8, v9
    v_mfma_f32_32x32x16_bf16 v[56:71], a[72:75], v[112:115], v[56:71]
    v_cvt_pk_bf16_f32 v121, v10, v11
    s_waitcnt lgkmcnt(2)
    v_mfma_f32_32x32x16_bf16 v[40:55], a[12:15], v[116:119], v[40:55]
    ds_read_b128 v[112:115], v5 offset:6144
    v_cvt_pk_bf16_f32 v122, v12, v13
    v_mfma_f32_32x32x16_bf16 v[56:71], a[76:79], v[116:119], v[56:71]
    v_cvt_pk_bf16_f32 v123, v14, v15
    s_waitcnt lgkmcnt(2)
    v_mfma_f32_32x32x16_bf16 v[40:55], a[16:19], v[104:107], v[40:55]
    ds_read_b128 v[116:119], v5 offset:7168
    ds_write_b128 v6, v[120:123] offset:0
    v_mfma_f32_32x32x16_bf16 v[56:71], a[80:83], v[104:107], v[56:71]
    v_cvt_pk_bf16_f32 v124, v16, v17
    s_waitcnt lgkmcnt(3)
    v_mfma_f32_32x32x16_bf16 v[40:55], a[20:23], v[108:111], v[40:55]
    ds_read_b128 v[104:107], v5 offset:8192
    v_cvt_pk_bf16_f32 v125, v18, v19
    v_mfma_f32_32x32x16_bf16 v[56:71], a[84:87], v[108:111], v[56:71]
    v_cvt_pk_bf16_f32 v126, v20, v21
    s_waitcnt lgkmcnt(3)
    v_mfma_f32_32x32x16_bf16 v[40:55], a[24:27], v[112:115], v[40:55]
    ds_read_b128 v[108:111], v5 offset:9216
    v_cvt_pk_bf16_f32 v127, v22, v23
    v_mfma_f32_32x32x16_bf16 v[56:71], a[88:91], v[112:115], v[56:71]
    ds_write_b128 v6, v[124:127] offset:32
    s_waitcnt lgkmcnt(4)
    v_mfma_f32_32x32x16_bf16 v[40:55], a[28:31], v[116:119], v[40:55]
    ds_read_b128 v[112:115], v5 offset:10240
    v_cvt_pk_bf16_f32 v120, v24, v25
    v_mfma_f32_32x32x16_bf16 v[56:71], a[92:95], v[116:119], v[56:71]
    v_cvt_pk_bf16_f32 v121, v26, v27
    s_waitcnt lgkmcnt(3)
    v_mfma_f32_32x32x16_bf16 v[40:55], a[32:35], v[104:107], v[40:55]
    ds_read_b128 v[116:119], v5 offset:11264
    v_cvt_pk_bf16_f32 v122, v28, v29
    v_mfma_f32_32x32x16_bf16 v[56:71], a[96:99], v[104:107], v[56:71]
    v_cvt_pk_bf16_f32 v123, v30, v31
    s_waitcnt lgkmcnt(3)
    v_mfma_f32_32x32x16_bf16 v[40:55], a[36:39], v[108:111], v[40:55]
    ds_read_b128 v[104:107], v5 offset:12288
    ds_write_b128 v6, v[120:123] offset:64
    v_mfma_f32_32x32x16_bf16 v[56:71], a[100:103], v[108:111], v[56:71]
    v_cvt_pk_bf16_f32 v124, v32, v33
    s_waitcnt lgkmcnt(3)
    v_mfma_f32_32x32x16_bf16 v[40:55], a[40:43], v[112:115], v[40:55]
    ds_read_b128 v[108:111], v5 offset:13312
    v_cvt_pk_bf16_f32 v125, v34, v35
    v_mfma_f32_32x32x16_bf16 v[56:71], a[104:107], v[112:115], v[56:71]
    v_cvt_pk_bf16_f32 v126, v36, v37
    s_waitcnt lgkmcnt(3)
    v_mfma_f32_32x32x16_bf16 v[40:55], a[44:47], v[116:119], v[40:55]
    ds_read_b128 v[112:115], v5 offset:14336
    v_cvt_pk_bf16_f32 v127, v38, v39
    v_mfma_f32_32x32x16_bf16 v[56:71], a[108:111], v[116:119], v[56:71]
    ds_write_b128 v6, v[124:127] offset:96
    s_waitcnt lgkmcnt(4)
    v_mfma_f32_32x32x16_bf16 v[40:55], a[48:51], v[104:107], v[40:55]
    ds_read_b128 v[116:119], v5 offset:15360
    v_mfma_f32_32x32x16_bf16 v[56:71], a[112:115], v[104:107], v[56:71]
    s_waitcnt lgkmcnt(3)
    v_mfma_f32_32x32x16_bf16 v[40:55], a[52:55], v[108:111], v[40:55]
    ds_read_b128 v[104:107], v5 offset:16384
    v_mfma_f32_32x32x16_bf16 v[56:71], a[116:119], v[108:111], v[56:71]
    s_waitcnt lgkmcnt(3)
    v_mfma_f32_32x32x16_bf16 v[40:55], a[56:59], v[112:115], v[40:55]
    ds_read_b128 v[108:111], v5 offset:17408
    v_mfma_f32_32x32x16_bf16 v[56:71], a[120:123], v[112:115], v[56:71]
    s_waitcnt lgkmcnt(2)
    v_mfma_f32_32x32x16_bf16 v[40:55], a[60:63], v[116:119], v[40:55]
    ds_read_b128 v[112:115], v5 offset:18432
    v_mfma_f32_32x32x16_bf16 v[56:71], a[124:127], v[116:119], v[56:71]
    s_barrier
    s_waitcnt lgkmcnt(2)
    v_mfma_f32_32x32x16_bf16 v[8:23], a[0:3], v[104:107], v[72:87]
    ds_read_b128 v[116:119], v5 offset:19456
    v_mfma_f32_32x32x16_bf16 v[24:39], a[64:67], v[104:107], v[88:103]
    s_waitcnt lgkmcnt(2)
    v_mfma_f32_32x32x16_bf16 v[8:23], a[4:7], v[108:111], v[8:23]
    ds_read_b128 v[104:107], v5 offset:20480
    v_mfma_f32_32x32x16_bf16 v[24:39], a[68:71], v[108:111], v[24:39]
    s_waitcnt lgkmcnt(2)
    v_mfma_f32_32x32x16_bf16 v[8:23], a[8:11], v[112:115], v[8:23]
    ds_read_b128 v[108:111], v5 offset:21504
    v_cvt_pk_bf16_f32 v120, v40, v41
    v_mfma_f32_32x32x16_bf16 v[24:39], a[72:75], v[112:115], v[24:39]
    v_cvt_pk_bf16_f32 v121, v42, v43
    s_waitcnt lgkmcnt(2)
    v_mfma_f32_32x32x16_bf16 v[8:23], a[12:15], v[116:119], v[8:23]
    ds_read_b128 v[112:115], v5 offset:22528
    v_cvt_pk_bf16_f32 v122, v44, v45
    v_mfma_f32_32x32x16_bf16 v[24:39], a[76:79], v[116:119], v[24:39]
    v_cvt_pk_bf16_f32 v123, v46, v47
    s_waitcnt lgkmcnt(2)
    v_mfma_f32_32x32x16_bf16 v[8:23], a[16:19], v[104:107], v[8:23]
    ds_read_b128 v[116:119], v5 offset:23552
    ds_write_b128 v6, v[120:123] offset:16896
    v_mfma_f32_32x32x16_bf16 v[24:39], a[80:83], v[104:107], v[24:39]
    v_cvt_pk_bf16_f32 v124, v48, v49
    s_waitcnt lgkmcnt(3)
    v_mfma_f32_32x32x16_bf16 v[8:23], a[20:23], v[108:111], v[8:23]
    ds_read_b128 v[104:107], v5 offset:24576
    v_cvt_pk_bf16_f32 v125, v50, v51
    v_mfma_f32_32x32x16_bf16 v[24:39], a[84:87], v[108:111], v[24:39]
    v_cvt_pk_bf16_f32 v126, v52, v53
    s_waitcnt lgkmcnt(3)
    v_mfma_f32_32x32x16_bf16 v[8:23], a[24:27], v[112:115], v[8:23]
    ds_read_b128 v[108:111], v5 offset:25600
    v_cvt_pk_bf16_f32 v127, v54, v55
    v_mfma_f32_32x32x16_bf16 v[24:39], a[88:91], v[112:115], v[24:39]
    ds_write_b128 v6, v[124:127] offset:16928
    s_waitcnt lgkmcnt(4)
    v_mfma_f32_32x32x16_bf16 v[8:23], a[28:31], v[116:119], v[8:23]
    ds_read_b128 v[112:115], v5 offset:26624
    v_cvt_pk_bf16_f32 v120, v56, v57
    v_mfma_f32_32x32x16_bf16 v[24:39], a[92:95], v[116:119], v[24:39]
    v_cvt_pk_bf16_f32 v121, v58, v59
    s_waitcnt lgkmcnt(3)
    v_mfma_f32_32x32x16_bf16 v[8:23], a[32:35], v[104:107], v[8:23]
    ds_read_b128 v[116:119], v5 offset:27648
    v_cvt_pk_bf16_f32 v122, v60, v61
    v_mfma_f32_32x32x16_bf16 v[24:39], a[96:99], v[104:107], v[24:39]
    v_cvt_pk_bf16_f32 v123, v62, v63
    s_waitcnt lgkmcnt(3)
    v_mfma_f32_32x32x16_bf16 v[8:23], a[36:39], v[108:111], v[8:23]
    ds_read_b128 v[104:107], v5 offset:28672
    ds_write_b128 v6, v[120:123] offset:16960
    v_mfma_f32_32x32x16_bf16 v[24:39], a[100:103], v[108:111], v[24:39]
    v_cvt_pk_bf16_f32 v124, v64, v65
    s_waitcnt lgkmcnt(3)
    v_mfma_f32_32x32x16_bf16 v[8:23], a[40:43], v[112:115], v[8:23]
    ds_read_b128 v[108:111], v5 offset:29696
    v_cvt_pk_bf16_f32 v125, v66, v67
    v_mfma_f32_32x32x16_bf16 v[24:39], a[104:107], v[112:115], v[24:39]
    v_cvt_pk_bf16_f32 v126, v68, v69
    s_waitcnt lgkmcnt(3)
    v_mfma_f32_32x32x16_bf16 v[8:23], a[44:47], v[116:119], v[8:23]
    ds_read_b128 v[112:115], v5 offset:30720
    v_cvt_pk_bf16_f32 v127, v70, v71
    v_mfma_f32_32x32x16_bf16 v[24:39], a[108:111], v[116:119], v[24:39]
    ds_write_b128 v6, v[124:127] offset:16992
    s_waitcnt lgkmcnt(4)
    v_mfma_f32_32x32x16_bf16 v[8:23], a[48:51], v[104:107], v[8:23]
    ds_read_b128 v[116:119], v5 offset:31744
    v_mfma_f32_32x32x16_bf16 v[24:39], a[112:115], v[104:107], v[24:39]
    s_waitcnt lgkmcnt(3)
    v_mfma_f32_32x32x16_bf16 v[8:23], a[52:55], v[108:111], v[8:23]
    ds_read_b128 v[104:107], v5 offset:32768
    v_mfma_f32_32x32x16_bf16 v[24:39], a[116:119], v[108:111], v[24:39]
    s_waitcnt lgkmcnt(3)
    v_mfma_f32_32x32x16_bf16 v[8:23], a[56:59], v[112:115], v[8:23]
    ds_read_b128 v[108:111], v5 offset:33792
    v_mfma_f32_32x32x16_bf16 v[24:39], a[120:123], v[112:115], v[24:39]
    s_waitcnt lgkmcnt(2)
    v_mfma_f32_32x32x16_bf16 v[8:23], a[60:63], v[116:119], v[8:23]
    ds_read_b128 v[112:115], v5 offset:34816
    v_mfma_f32_32x32x16_bf16 v[24:39], a[124:127], v[116:119], v[24:39]
    s_barrier
    s_waitcnt lgkmcnt(2)
    v_mfma_f32_32x32x16_bf16 v[40:55], a[0:3], v[104:107], v[72:87]
    ds_read_b128 v[116:119], v5 offset:35840
    v_mfma_f32_32x32x16_bf16 v[56:71], a[64:67], v[104:107], v[88:103]
    s_waitcnt lgkmcnt(2)
    v_mfma_f32_32x32x16_bf16 v[40:55], a[4:7], v[108:111], v[40:55]
    ds_read_b128 v[104:107], v5 offset:36864
    v_mfma_f32_32x32x16_bf16 v[56:71], a[68:71], v[108:111], v[56:71]
    s_waitcnt lgkmcnt(2)
    v_mfma_f32_32x32x16_bf16 v[40:55], a[8:11], v[112:115], v[40:55]
    ds_read_b128 v[108:111], v5 offset:37888
    v_cvt_pk_bf16_f32 v120, v8, v9
    v_mfma_f32_32x32x16_bf16 v[56:71], a[72:75], v[112:115], v[56:71]
    v_cvt_pk_bf16_f32 v121, v10, v11
    s_waitcnt lgkmcnt(2)
    v_mfma_f32_32x32x16_bf16 v[40:55], a[12:15], v[116:119], v[40:55]
    ds_read_b128 v[112:115], v5 offset:38912
    v_cvt_pk_bf16_f32 v122, v12, v13
    v_mfma_f32_32x32x16_bf16 v[56:71], a[76:79], v[116:119], v[56:71]
    v_cvt_pk_bf16_f32 v123, v14, v15
    s_waitcnt lgkmcnt(2)
    v_mfma_f32_32x32x16_bf16 v[40:55], a[16:19], v[104:107], v[40:55]
    ds_read_b128 v[116:119], v5 offset:39936
    ds_write_b128 v6, v[120:123] offset:0
    v_mfma_f32_32x32x16_bf16 v[56:71], a[80:83], v[104:107], v[56:71]
    v_cvt_pk_bf16_f32 v124, v16, v17
    s_waitcnt lgkmcnt(3)
    v_mfma_f32_32x32x16_bf16 v[40:55], a[20:23], v[108:111], v[40:55]
    ds_read_b128 v[104:107], v5 offset:40960
    v_cvt_pk_bf16_f32 v125, v18, v19
    v_mfma_f32_32x32x16_bf16 v[56:71], a[84:87], v[108:111], v[56:71]
    v_cvt_pk_bf16_f32 v126, v20, v21
    s_waitcnt lgkmcnt(3)
    v_mfma_f32_32x32x16_bf16 v[40:55], a[24:27], v[112:115], v[40:55]
    ds_read_b128 v[108:111], v5 offset:41984
    v_cvt_pk_bf16_f32 v127, v22, v23
    v_mfma_f32_32x32x16_bf16 v[56:71], a[88:91], v[112:115], v[56:71]
    ds_write_b128 v6, v[124:127] offset:32
    s_waitcnt lgkmcnt(4)
    v_mfma_f32_32x32x16_bf16 v[40:55], a[28:31], v[116:119], v[40:55]
    ds_read_b128 v[112:115], v5 offset:43008
    v_cvt_pk_bf16_f32 v120, v24, v25
    v_mfma_f32_32x32x16_bf16 v[56:71], a[92:95], v[116:119], v[56:71]
    v_cvt_pk_bf16_f32 v121, v26, v27
    s_waitcnt lgkmcnt(3)
    v_mfma_f32_32x32x16_bf16 v[40:55], a[32:35], v[104:107], v[40:55]
    ds_read_b128 v[116:119], v5 offset:44032
    v_cvt_pk_bf16_f32 v122, v28, v29
    v_mfma_f32_32x32x16_bf16 v[56:71], a[96:99], v[104:107], v[56:71]
    v_cvt_pk_bf16_f32 v123, v30, v31
    s_waitcnt lgkmcnt(3)
    v_mfma_f32_32x32x16_bf16 v[40:55], a[36:39], v[108:111], v[40:55]
    ds_read_b128 v[104:107], v5 offset:45056
    ds_write_b128 v6, v[120:123] offset:64
    v_mfma_f32_32x32x16_bf16 v[56:71], a[100:103], v[108:111], v[56:71]
    v_cvt_pk_bf16_f32 v124, v32, v33
    s_waitcnt lgkmcnt(3)
    v_mfma_f32_32x32x16_bf16 v[40:55], a[40:43], v[112:115], v[40:55]
    ds_read_b128 v[108:111], v5 offset:46080
    v_cvt_pk_bf16_f32 v125, v34, v35
    v_mfma_f32_32x32x16_bf16 v[56:71], a[104:107], v[112:115], v[56:71]
    v_cvt_pk_bf16_f32 v126, v36, v37
    s_waitcnt lgkmcnt(3)
    v_mfma_f32_32x32x16_bf16 v[40:55], a[44:47], v[116:119], v[40:55]
    ds_read_b128 v[112:115], v5 offset:47104
    v_cvt_pk_bf16_f32 v127, v38, v39
    v_mfma_f32_32x32x16_bf16 v[56:71], a[108:111], v[116:119], v[56:71]
    ds_write_b128 v6, v[124:127] offset:96
    s_waitcnt lgkmcnt(4)
    v_mfma_f32_32x32x16_bf16 v[40:55], a[48:51], v[104:107], v[40:55]
    ds_read_b128 v[116:119], v5 offset:48128
    v_mfma_f32_32x32x16_bf16 v[56:71], a[112:115], v[104:107], v[56:71]
    s_waitcnt lgkmcnt(3)
    v_mfma_f32_32x32x16_bf16 v[40:55], a[52:55], v[108:111], v[40:55]
    ds_read_b128 v[104:107], v5 offset:0
    v_mfma_f32_32x32x16_bf16 v[56:71], a[116:119], v[108:111], v[56:71]
    s_waitcnt lgkmcnt(3)
    v_mfma_f32_32x32x16_bf16 v[40:55], a[56:59], v[112:115], v[40:55]
    ds_read_b128 v[108:111], v5 offset:1024
    v_mfma_f32_32x32x16_bf16 v[56:71], a[120:123], v[112:115], v[56:71]
    s_waitcnt lgkmcnt(2)
    v_mfma_f32_32x32x16_bf16 v[40:55], a[60:63], v[116:119], v[40:55]
    ds_read_b128 v[112:115], v5 offset:2048
    v_mfma_f32_32x32x16_bf16 v[56:71], a[124:127], v[116:119], v[56:71]
    s_barrier
    s_waitcnt lgkmcnt(2)
    v_mfma_f32_32x32x16_bf16 v[8:23], a[0:3], v[104:107], v[72:87]
    ds_read_b128 v[116:119], v5 offset:3072
    v_mfma_f32_32x32x16_bf16 v[24:39], a[64:67], v[104:107], v[88:103]
    s_waitcnt lgkmcnt(2)
    v_mfma_f32_32x32x16_bf16 v[8:23], a[4:7], v[108:111], v[8:23]
    ds_read_b128 v[104:107], v5 offset:4096
    v_mfma_f32_32x32x16_bf16 v[24:39], a[68:71], v[108:111], v[24:39]
    s_waitcnt lgkmcnt(2)
    v_mfma_f32_32x32x16_bf16 v[8:23], a[8:11], v[112:115], v[8:23]
    ds_read_b128 v[108:111], v5 offset:5120
    v_cvt_pk_bf16_f32 v120, v40, v41
    v_mfma_f32_32x32x16_bf16 v[24:39], a[72:75], v[112:115], v[24:39]
    v_cvt_pk_bf16_f32 v121, v42, v43
    s_waitcnt lgkmcnt(2)
    v_mfma_f32_32x32x16_bf16 v[8:23], a[12:15], v[116:119], v[8:23]
    ds_read_b128 v[112:115], v5 offset:6144
    v_cvt_pk_bf16_f32 v122, v44, v45
    v_mfma_f32_32x32x16_bf16 v[24:39], a[76:79], v[116:119], v[24:39]
    v_cvt_pk_bf16_f32 v123, v46, v47
    s_waitcnt lgkmcnt(2)
    v_mfma_f32_32x32x16_bf16 v[8:23], a[16:19], v[104:107], v[8:23]
    ds_read_b128 v[116:119], v5 offset:7168
    ds_write_b128 v6, v[120:123] offset:16896
    v_mfma_f32_32x32x16_bf16 v[24:39], a[80:83], v[104:107], v[24:39]
    v_cvt_pk_bf16_f32 v124, v48, v49
    s_waitcnt lgkmcnt(3)
    v_mfma_f32_32x32x16_bf16 v[8:23], a[20:23], v[108:111], v[8:23]
    ds_read_b128 v[104:107], v5 offset:8192
    v_cvt_pk_bf16_f32 v125, v50, v51
    v_mfma_f32_32x32x16_bf16 v[24:39], a[84:87], v[108:111], v[24:39]
    v_cvt_pk_bf16_f32 v126, v52, v53
    s_waitcnt lgkmcnt(3)
    v_mfma_f32_32x32x16_bf16 v[8:23], a[24:27], v[112:115], v[8:23]
    ds_read_b128 v[108:111], v5 offset:9216
    v_cvt_pk_bf16_f32 v127, v54, v55
    v_mfma_f32_32x32x16_bf16 v[24:39], a[88:91], v[112:115], v[24:39]
    ds_write_b128 v6, v[124:127] offset:16928
    s_waitcnt lgkmcnt(4)
    v_mfma_f32_32x32x16_bf16 v[8:23], a[28:31], v[116:119], v[8:23]
    ds_read_b128 v[112:115], v5 offset:10240
    v_cvt_pk_bf16_f32 v120, v56, v57
    v_mfma_f32_32x32x16_bf16 v[24:39], a[92:95], v[116:119], v[24:39]
    v_cvt_pk_bf16_f32 v121, v58, v59
    s_waitcnt lgkmcnt(3)
    v_mfma_f32_32x32x16_bf16 v[8:23], a[32:35], v[104:107], v[8:23]
    ds_read_b128 v[116:119], v5 offset:11264
    v_cvt_pk_bf16_f32 v122, v60, v61
    v_mfma_f32_32x32x16_bf16 v[24:39], a[96:99], v[104:107], v[24:39]
    v_cvt_pk_bf16_f32 v123, v62, v63
    s_waitcnt lgkmcnt(3)
    v_mfma_f32_32x32x16_bf16 v[8:23], a[36:39], v[108:111], v[8:23]
    ds_read_b128 v[104:107], v5 offset:12288
    ds_write_b128 v6, v[120:123] offset:16960
    v_mfma_f32_32x32x16_bf16 v[24:39], a[100:103], v[108:111], v[24:39]
    v_cvt_pk_bf16_f32 v124, v64, v65
    s_waitcnt lgkmcnt(3)
    v_mfma_f32_32x32x16_bf16 v[8:23], a[40:43], v[112:115], v[8:23]
    ds_read_b128 v[108:111], v5 offset:13312
    v_cvt_pk_bf16_f32 v125, v66, v67
    v_mfma_f32_32x32x16_bf16 v[24:39], a[104:107], v[112:115], v[24:39]
    v_cvt_pk_bf16_f32 v126, v68, v69
    s_waitcnt lgkmcnt(3)
    v_mfma_f32_32x32x16_bf16 v[8:23], a[44:47], v[116:119], v[8:23]
    ds_read_b128 v[112:115], v5 offset:14336
    v_cvt_pk_bf16_f32 v127, v70, v71
    v_mfma_f32_32x32x16_bf16 v[24:39], a[108:111], v[116:119], v[24:39]
    ds_write_b128 v6, v[124:127] offset:16992
    s_waitcnt lgkmcnt(4)
    v_mfma_f32_32x32x16_bf16 v[8:23], a[48:51], v[104:107], v[8:23]
    ds_read_b128 v[116:119], v5 offset:15360
    v_mfma_f32_32x32x16_bf16 v[24:39], a[112:115], v[104:107], v[24:39]
    s_waitcnt lgkmcnt(3)
    v_mfma_f32_32x32x16_bf16 v[8:23], a[52:55], v[108:111], v[8:23]
    ds_read_b128 v[104:107], v5 offset:16384
    v_mfma_f32_32x32x16_bf16 v[24:39], a[116:119], v[108:111], v[24:39]
    s_waitcnt lgkmcnt(3)
    v_mfma_f32_32x32x16_bf16 v[8:23], a[56:59], v[112:115], v[8:23]
    ds_read_b128 v[108:111], v5 offset:17408
    v_mfma_f32_32x32x16_bf16 v[24:39], a[120:123], v[112:115], v[24:39]
    s_waitcnt lgkmcnt(2)
    v_mfma_f32_32x32x16_bf16 v[8:23], a[60:63], v[116:119], v[8:23]
    ds_read_b128 v[112:115], v5 offset:18432
    v_mfma_f32_32x32x16_bf16 v[24:39], a[124:127], v[116:119], v[24:39]
    s_barrier
    s_waitcnt lgkmcnt(2)
    v_mfma_f32_32x32x16_bf16 v[40:55], a[0:3], v[104:107], v[72:87]
    ds_read_b128 v[116:119], v5 offset:19456
    v_mfma_f32_32x32x16_bf16 v[56:71], a[64:67], v[104:107], v[88:103]
    s_waitcnt lgkmcnt(2)
    v_mfma_f32_32x32x16_bf16 v[40:55], a[4:7], v[108:111], v[40:55]
    ds_read_b128 v[104:107], v5 offset:20480
    v_mfma_f32_32x32x16_bf16 v[56:71], a[68:71], v[108:111], v[56:71]
    s_waitcnt lgkmcnt(2)
    v_mfma_f32_32x32x16_bf16 v[40:55], a[8:11], v[112:115], v[40:55]
    ds_read_b128 v[108:111], v5 offset:21504
    v_cvt_pk_bf16_f32 v120, v8, v9
    v_mfma_f32_32x32x16_bf16 v[56:71], a[72:75], v[112:115], v[56:71]
    v_cvt_pk_bf16_f32 v121, v10, v11
    s_waitcnt lgkmcnt(2)
    v_mfma_f32_32x32x16_bf16 v[40:55], a[12:15], v[116:119], v[40:55]
    ds_read_b128 v[112:115], v5 offset:22528
    v_cvt_pk_bf16_f32 v122, v12, v13
    v_mfma_f32_32x32x16_bf16 v[56:71], a[76:79], v[116:119], v[56:71]
    v_cvt_pk_bf16_f32 v123, v14, v15
    s_waitcnt lgkmcnt(2)
    v_mfma_f32_32x32x16_bf16 v[40:55], a[16:19], v[104:107], v[40:55]
    ds_read_b128 v[116:119], v5 offset:23552
    ds_write_b128 v6, v[120:123] offset:0
    v_mfma_f32_32x32x16_bf16 v[56:71], a[80:83], v[104:107], v[56:71]
    v_cvt_pk_bf16_f32 v124, v16, v17
    s_waitcnt lgkmcnt(3)
    v_mfma_f32_32x32x16_bf16 v[40:55], a[20:23], v[108:111], v[40:55]
    ds_read_b128 v[104:107], v5 offset:24576
    v_cvt_pk_bf16_f32 v125, v18, v19
    v_mfma_f32_32x32x16_bf16 v[56:71], a[84:87], v[108:111], v[56:71]
    v_cvt_pk_bf16_f32 v126, v20, v21
    s_waitcnt lgkmcnt(3)
    v_mfma_f32_32x32x16_bf16 v[40:55], a[24:27], v[112:115], v[40:55]
    ds_read_b128 v[108:111], v5 offset:25600
    v_cvt_pk_bf16_f32 v127, v22, v23
    v_mfma_f32_32x32x16_bf16 v[56:71], a[88:91], v[112:115], v[56:71]
    ds_write_b128 v6, v[124:127] offset:32
    s_waitcnt lgkmcnt(4)
    v_mfma_f32_32x32x16_bf16 v[40:55], a[28:31], v[116:119], v[40:55]
    ds_read_b128 v[112:115], v5 offset:26624
    v_cvt_pk_bf16_f32 v120, v24, v25
    v_mfma_f32_32x32x16_bf16 v[56:71], a[92:95], v[116:119], v[56:71]
    v_cvt_pk_bf16_f32 v121, v26, v27
    s_waitcnt lgkmcnt(3)
    v_mfma_f32_32x32x16_bf16 v[40:55], a[32:35], v[104:107], v[40:55]
    ds_read_b128 v[116:119], v5 offset:27648
    v_cvt_pk_bf16_f32 v122, v28, v29
    v_mfma_f32_32x32x16_bf16 v[56:71], a[96:99], v[104:107], v[56:71]
    v_cvt_pk_bf16_f32 v123, v30, v31
    s_waitcnt lgkmcnt(3)
    v_mfma_f32_32x32x16_bf16 v[40:55], a[36:39], v[108:111], v[40:55]
    ds_read_b128 v[104:107], v5 offset:28672
    ds_write_b128 v6, v[120:123] offset:64
    v_mfma_f32_32x32x16_bf16 v[56:71], a[100:103], v[108:111], v[56:71]
    v_cvt_pk_bf16_f32 v124, v32, v33
    s_waitcnt lgkmcnt(3)
    v_mfma_f32_32x32x16_bf16 v[40:55], a[40:43], v[112:115], v[40:55]
    ds_read_b128 v[108:111], v5 offset:29696
    v_cvt_pk_bf16_f32 v125, v34, v35
    v_mfma_f32_32x32x16_bf16 v[56:71], a[104:107], v[112:115], v[56:71]
    v_cvt_pk_bf16_f32 v126, v36, v37
    s_waitcnt lgkmcnt(3)
    v_mfma_f32_32x32x16_bf16 v[40:55], a[44:47], v[116:119], v[40:55]
    ds_read_b128 v[112:115], v5 offset:30720
    v_cvt_pk_bf16_f32 v127, v38, v39
    v_mfma_f32_32x32x16_bf16 v[56:71], a[108:111], v[116:119], v[56:71]
    ds_write_b128 v6, v[124:127] offset:96
    s_waitcnt lgkmcnt(4)
    v_mfma_f32_32x32x16_bf16 v[40:55], a[48:51], v[104:107], v[40:55]
    ds_read_b128 v[116:119], v5 offset:31744
    v_mfma_f32_32x32x16_bf16 v[56:71], a[112:115], v[104:107], v[56:71]
    s_waitcnt lgkmcnt(3)
    v_mfma_f32_32x32x16_bf16 v[40:55], a[52:55], v[108:111], v[40:55]
    v_mfma_f32_32x32x16_bf16 v[56:71], a[116:119], v[108:111], v[56:71]
    s_waitcnt lgkmcnt(2)
    v_mfma_f32_32x32x16_bf16 v[40:55], a[56:59], v[112:115], v[40:55]
    v_mfma_f32_32x32x16_bf16 v[56:71], a[120:123], v[112:115], v[56:71]
    s_waitcnt lgkmcnt(0)
    v_mfma_f32_32x32x16_bf16 v[40:55], a[60:63], v[116:119], v[40:55]
    v_mfma_f32_32x32x16_bf16 v[56:71], a[124:127], v[116:119], v[56:71]
    s_barrier
    s_nop 7
    s_nop 7
    v_cvt_pk_bf16_f32 v120, v40, v41
    v_cvt_pk_bf16_f32 v121, v42, v43
    v_cvt_pk_bf16_f32 v122, v44, v45
    v_cvt_pk_bf16_f32 v123, v46, v47
    ds_write_b128 v6, v[120:123] offset:16896
    v_cvt_pk_bf16_f32 v124, v48, v49
    v_cvt_pk_bf16_f32 v125, v50, v51
    v_cvt_pk_bf16_f32 v126, v52, v53
    v_cvt_pk_bf16_f32 v127, v54, v55
    ds_write_b128 v6, v[124:127] offset:16928
    v_cvt_pk_bf16_f32 v120, v56, v57
    v_cvt_pk_bf16_f32 v121, v58, v59
    v_cvt_pk_bf16_f32 v122, v60, v61
    v_cvt_pk_bf16_f32 v123, v62, v63
    ds_write_b128 v6, v[120:123] offset:16960
    v_cvt_pk_bf16_f32 v124, v64, v65
    v_cvt_pk_bf16_f32 v125, v66, v67
    v_cvt_pk_bf16_f32 v126, v68, v69
    v_cvt_pk_bf16_f32 v127, v70, v71
    ds_write_b128 v6, v[124:127] offset:16992
    s_waitcnt lgkmcnt(0)
    s_barrier
    s_endpgm
L_joint_kernel_helper:
    v_and_b32 v14, 7, v1
    v_lshlrev_b32 v14, 10, v14
    v_lshrrev_b32 v15, 5, v1
    v_lshl_add_u32 v14, v15, 4, v14
    s_lshl_b32 s36, s24, 13
    s_lshl_b32 s37, s21, 8
    s_add_u32 s36, s36, s37
    s_add_u32 s37, s36, 16384
    s_add_u32 s36, s38, 32768
    buffer_load_dwordx4 a[0:3], v5, s[12:15], s36 offen
    s_add_u32 s36, s38, 49152
    buffer_load_dwordx4 a[64:67], v5, s[12:15], s36 offen
    s_add_u32 s36, s38, 33792
    buffer_load_dwordx4 a[4:7], v5, s[12:15], s36 offen
    s_add_u32 s36, s38, 50176
    buffer_load_dwordx4 a[68:71], v5, s[12:15], s36 offen
    s_add_u32 s36, s38, 34816
    buffer_load_dwordx4 a[8:11], v5, s[12:15], s36 offen
    s_add_u32 s36, s38, 51200
    buffer_load_dwordx4 a[72:75], v5, s[12:15], s36 offen
    s_add_u32 s36, s38, 35840
    buffer_load_dwordx4 a[12:15], v5, s[12:15], s36 offen
    s_add_u32 s36, s38, 52224
    buffer_load_dwordx4 a[76:79], v5, s[12:15], s36 offen
    s_add_u32 s36, s38, 36864
    buffer_load_dwordx4 a[16:19], v5, s[12:15], s36 offen
    s_add_u32 s36, s38, 53248
    buffer_load_dwordx4 a[80:83], v5, s[12:15], s36 offen
    s_add_u32 s36, s38, 37888
    buffer_load_dwordx4 a[20:23], v5, s[12:15], s36 offen
    s_add_u32 s36, s38, 54272
    buffer_load_dwordx4 a[84:87], v5, s[12:15], s36 offen
    s_add_u32 s36, s38, 38912
    buffer_load_dwordx4 a[24:27], v5, s[12:15], s36 offen
    s_add_u32 s36, s38, 55296
    buffer_load_dwordx4 a[88:91], v5, s[12:15], s36 offen
    s_add_u32 s36, s38, 39936
    buffer_load_dwordx4 a[28:31], v5, s[12:15], s36 offen
    s_add_u32 s36, s38, 56320
    buffer_load_dwordx4 a[92:95], v5, s[12:15], s36 offen
    s_add_u32 s36, s38, 40960
    buffer_load_dwordx4 a[32:35], v5, s[12:15], s36 offen
    s_add_u32 s36, s38, 57344
    buffer_load_dwordx4 a[96:99], v5, s[12:15], s36 offen
    s_add_u32 s36, s38, 41984
    buffer_load_dwordx4 a[36:39], v5, s[12:15], s36 offen
    s_add_u32 s36, s38, 58368
    buffer_load_dwordx4 a[100:103], v5, s[12:15], s36 offen
    s_add_u32 s36, s38, 43008
    buffer_load_dwordx4 a[40:43], v5, s[12:15], s36 offen
    s_add_u32 s36, s38, 59392
    buffer_load_dwordx4 a[104:107], v5, s[12:15], s36 offen
    s_add_u32 s36, s38, 44032
    buffer_load_dwordx4 a[44:47], v5, s[12:15], s36 offen
    s_add_u32 s36, s38, 60416
    buffer_load_dwordx4 a[108:111], v5, s[12:15], s36 offen
    s_add_u32 s36, s38, 45056
    buffer_load_dwordx4 a[48:51], v5, s[12:15], s36 offen
    s_add_u32 s36, s38, 61440
    buffer_load_dwordx4 a[112:115], v5, s[12:15], s36 offen
    s_add_u32 s36, s38, 46080
    buffer_load_dwordx4 a[52:55], v5, s[12:15], s36 offen
    s_add_u32 s36, s38, 62464
    buffer_load_dwordx4 a[116:119], v5, s[12:15], s36 offen
    s_add_u32 s36, s38, 47104
    buffer_load_dwordx4 a[56:59], v5, s[12:15], s36 offen
    s_add_u32 s36, s38, 63488
    buffer_load_dwordx4 a[120:123], v5, s[12:15], s36 offen
    s_add_u32 s36, s38, 48128
    buffer_load_dwordx4 a[60:63], v5, s[12:15], s36 offen
    s_add_u32 s36, s38, 64512
    buffer_load_dwordx4 a[124:127], v5, s[12:15], s36 offen
    buffer_load_dwordx4 v[96:99], v14, s[12:15], s37 offen offset:0
    buffer_load_dwordx4 v[100:103], v14, s[12:15], s37 offen offset:32
    buffer_load_dwordx4 v[104:107], v14, s[12:15], s37 offen offset:64
    buffer_load_dwordx4 v[108:111], v14, s[12:15], s37 offen offset:96
    buffer_load_dwordx4 v[112:115], v14, s[12:15], s37 offen offset:128
    buffer_load_dwordx4 v[116:119], v14, s[12:15], s37 offen offset:160
    buffer_load_dwordx4 v[120:123], v14, s[12:15], s37 offen offset:192
    buffer_load_dwordx4 v[124:127], v14, s[12:15], s37 offen offset:224
    s_barrier
    v_add_u32 v7, 65536, v5
    ds_read_b128 v[64:67], v7 offset:0
    ds_read_b128 v[68:71], v7 offset:1024
    ds_read_b128 v[72:75], v7 offset:2048
    ds_read_b128 v[76:79], v7 offset:3072
    ds_read_b128 v[80:83], v7 offset:4096
    ds_read_b128 v[84:87], v7 offset:5120
    ds_read_b128 v[88:91], v7 offset:6144
    ds_read_b128 v[92:95], v7 offset:7168
    s_waitcnt vmcnt(38) lgkmcnt(7)
    v_mfma_f32_32x32x16_bf16 v[32:47], a[0:3], v[64:67], 0
    v_mfma_f32_32x32x16_bf16 v[48:63], a[64:67], v[64:67], 0
    s_waitcnt vmcnt(36) lgkmcnt(6)
    v_mfma_f32_32x32x16_bf16 v[32:47], a[4:7], v[68:71], v[32:47]
    v_mfma_f32_32x32x16_bf16 v[48:63], a[68:71], v[68:71], v[48:63]
    ds_read_b128 v[64:67], v7 offset:8192
    s_waitcnt vmcnt(34) lgkmcnt(6)
    v_mfma_f32_32x32x16_bf16 v[32:47], a[8:11], v[72:75], v[32:47]
    v_mfma_f32_32x32x16_bf16 v[48:63], a[72:75], v[72:75], v[48:63]
    ds_read_b128 v[68:71], v7 offset:9216
    s_waitcnt vmcnt(32) lgkmcnt(6)
    v_mfma_f32_32x32x16_bf16 v[32:47], a[12:15], v[76:79], v[32:47]
    v_mfma_f32_32x32x16_bf16 v[48:63], a[76:79], v[76:79], v[48:63]
    ds_read_b128 v[72:75], v7 offset:10240
    s_waitcnt vmcnt(30) lgkmcnt(6)
    v_mfma_f32_32x32x16_bf16 v[32:47], a[16:19], v[80:83], v[32:47]
    v_mfma_f32_32x32x16_bf16 v[48:63], a[80:83], v[80:83], v[48:63]
    ds_read_b128 v[76:79], v7 offset:11264
    s_waitcnt vmcnt(28) lgkmcnt(6)
    v_mfma_f32_32x32x16_bf16 v[32:47], a[20:23], v[84:87], v[32:47]
    v_mfma_f32_32x32x16_bf16 v[48:63], a[84:87], v[84:87], v[48:63]
    ds_read_b128 v[80:83], v7 offset:12288
    s_waitcnt vmcnt(26) lgkmcnt(6)
    v_mfma_f32_32x32x16_bf16 v[32:47], a[24:27], v[88:91], v[32:47]
    v_mfma_f32_32x32x16_bf16 v[48:63], a[88:91], v[88:91], v[48:63]
    ds_read_b128 v[84:87], v7 offset:13312
    s_waitcnt vmcnt(24) lgkmcnt(6)
    v_mfma_f32_32x32x16_bf16 v[32:47], a[28:31], v[92:95], v[32:47]
    v_mfma_f32_32x32x16_bf16 v[48:63], a[92:95], v[92:95], v[48:63]
    ds_read_b128 v[88:91], v7 offset:14336
    s_waitcnt vmcnt(22) lgkmcnt(6)
    v_mfma_f32_32x32x16_bf16 v[32:47], a[32:35], v[64:67], v[32:47]
    v_mfma_f32_32x32x16_bf16 v[48:63], a[96:99], v[64:67], v[48:63]
    ds_read_b128 v[92:95], v7 offset:15360
    s_waitcnt vmcnt(20) lgkmcnt(6)
    v_mfma_f32_32x32x16_bf16 v[32:47], a[36:39], v[68:71], v[32:47]
    v_mfma_f32_32x32x16_bf16 v[48:63], a[100:103], v[68:71], v[48:63]
    s_waitcnt vmcnt(0)
    v_max3_f32 v8, |v96|, |v97|, |v98|
    v_max3_f32 v8, v8, |v99|, |v100|
    v_max3_f32 v8, v8, |v101|, |v102|
    v_max3_f32 v8, v8, |v103|, |v104|
    v_max3_f32 v8, v8, |v105|, |v106|
    v_max3_f32 v8, v8, |v107|, |v108|
    v_max3_f32 v8, v8, |v109|, |v110|
    v_max3_f32 v8, v8, |v111|, |v112|
    s_waitcnt lgkmcnt(5)
    v_mfma_f32_32x32x16_bf16 v[32:47], a[40:43], v[72:75], v[32:47]
    v_mfma_f32_32x32x16_bf16 v[48:63], a[104:107], v[72:75], v[48:63]
    v_max3_f32 v8, v8, |v113|, |v114|
    v_max3_f32 v8, v8, |v115|, |v116|
    v_max3_f32 v8, v8, |v117|, |v118|
    v_max3_f32 v8, v8, |v119|, |v120|
    v_max3_f32 v8, v8, |v121|, |v122|
    v_max3_f32 v8, v8, |v123|, |v124|
    v_max3_f32 v8, v8, |v125|, |v126|
    v_max_f32 v8, v8, |v127|
    s_waitcnt lgkmcnt(4)
    v_mfma_f32_32x32x16_bf16 v[32:47], a[44:47], v[76:79], v[32:47]
    v_mfma_f32_32x32x16_bf16 v[48:63], a[108:111], v[76:79], v[48:63]
    s_mov_b32 s41, 0x42a80000
    v_cmp_lt_f32 s[42:43], s41, v8
    v_exp_f32 v96, v96
    v_exp_f32 v97, v97
    v_exp_f32 v98, v98
    v_exp_f32 v99, v99
    v_exp_f32 v100, v100
    v_exp_f32 v101, v101
    s_waitcnt lgkmcnt(3)
    v_mfma_f32_32x32x16_bf16 v[32:47], a[48:51], v[80:83], v[32:47]
    v_mfma_f32_32x32x16_bf16 v[48:63], a[112:115], v[80:83], v[48:63]
    v_exp_f32 v102, v102
    v_exp_f32 v103, v103
    v_exp_f32 v104, v104
    v_exp_f32 v105, v105
    v_exp_f32 v106, v106
    v_exp_f32 v107, v107
    v_exp_f32 v108, v108
    v_exp_f32 v109, v109
    s_waitcnt lgkmcnt(2)
    v_mfma_f32_32x32x16_bf16 v[32:47], a[52:55], v[84:87], v[32:47]
    v_mfma_f32_32x32x16_bf16 v[48:63], a[116:119], v[84:87], v[48:63]
    v_exp_f32 v110, v110
    v_exp_f32 v111, v111
    v_exp_f32 v112, v112
    v_exp_f32 v113, v113
    v_exp_f32 v114, v114
    v_exp_f32 v115, v115
    v_exp_f32 v116, v116
    v_exp_f32 v117, v117
    s_waitcnt lgkmcnt(1)
    v_mfma_f32_32x32x16_bf16 v[32:47], a[56:59], v[88:91], v[32:47]
    v_mfma_f32_32x32x16_bf16 v[48:63], a[120:123], v[88:91], v[48:63]
    v_exp_f32 v118, v118
    v_exp_f32 v119, v119
    v_exp_f32 v120, v120
    v_exp_f32 v121, v121
    v_exp_f32 v122, v122
    v_exp_f32 v123, v123
    v_exp_f32 v124, v124
    v_exp_f32 v125, v125
    s_waitcnt lgkmcnt(0)
    v_mfma_f32_32x32x16_bf16 v[32:47], a[60:63], v[92:95], v[32:47]
    v_mfma_f32_32x32x16_bf16 v[48:63], a[124:127], v[92:95], v[48:63]
    v_exp_f32 v126, v126
    v_exp_f32 v127, v127
    s_lshl_b32 s36, s21, 12
    v_add_u32 v2, s36, v5
    v_lshrrev_b32 v10, 5, v1
    v_lshlrev_b32 v11, 4, v10
    s_lshl_b32 s36, s21, 8
    s_add_u32 s36, s36, 81920
    v_add_u32 v11, s36, v11
    v_and_b32 v12, 31, v1
    v_mul_u32_u24 v13, 1056, v12
    v_add_u32 v9, v11, v13
    v_lshrrev_b32 v13, 3, v12
    v_mul_u32_u24 v13, 1056, v13
    v_add_u32 v4, v11, v13
    s_lshl_b32 s36, s21, 3
    v_add_u32 v10, s36, v10
    v_mul_u32_u24 v13, 528, v10
    v_lshl_add_u32 v13, v12, 4, v13
    v_add_u32 v6, 115712, v13
    v_lshlrev_b32 v13, 9, v10
    v_lshl_add_u32 v7, v12, 4, v13
    s_mov_b32 s41, 0x4038aa3b
    v_mul_f32 v64, s41, v32
    v_mul_f32 v65, s41, v33
    v_mul_f32 v66, s41, v34
    v_mul_f32 v67, s41, v35
    v_mul_f32 v68, s41, v36
    v_mul_f32 v69, s41, v37
    v_mul_f32 v70, s41, v38
    v_mul_f32 v71, s41, v39
    v_mul_f32 v72, s41, v40
    v_mul_f32 v73, s41, v41
    v_mul_f32 v74, s41, v42
    v_mul_f32 v75, s41, v43
    v_mul_f32 v76, s41, v44
    v_mul_f32 v77, s41, v45
    v_mul_f32 v78, s41, v46
    v_mul_f32 v79, s41, v47
    v_mul_f32 v80, s41, v48
    v_mul_f32 v81, s41, v49
    v_mul_f32 v82, s41, v50
    v_mul_f32 v83, s41, v51
    v_mul_f32 v84, s41, v52
    v_mul_f32 v85, s41, v53
    v_mul_f32 v86, s41, v54
    v_mul_f32 v87, s41, v55
    v_mul_f32 v88, s41, v56
    v_mul_f32 v89, s41, v57
    v_mul_f32 v90, s41, v58
    v_mul_f32 v91, s41, v59
    v_mul_f32 v92, s41, v60
    v_mul_f32 v93, s41, v61
    v_mul_f32 v94, s41, v62
    v_mul_f32 v95, s41, v63
    v_max3_f32 v8, |v64|, |v65|, |v66|
    v_max3_f32 v8, v8, |v67|, |v68|
    v_max3_f32 v8, v8, |v69|, |v70|
    v_max3_f32 v8, v8, |v71|, |v72|
    v_max3_f32 v8, v8, |v73|, |v74|
    v_max3_f32 v8, v8, |v75|, |v76|
    v_max3_f32 v8, v8, |v77|, |v78|
    v_max3_f32 v8, v8, |v79|, |v80|
    v_max3_f32 v8, v8, |v81|, |v82|
    v_max3_f32 v8, v8, |v83|, |v84|
    v_max3_f32 v8, v8, |v85|, |v86|
    v_max3_f32 v8, v8, |v87|, |v88|
    v_max3_f32 v8, v8, |v89|, |v90|
    v_max3_f32 v8, v8, |v91|, |v92|
    v_max3_f32 v8, v8, |v93|, |v94|
    v_max_f32 v8, v8, |v95|
    s_mov_b32 s41, 0x42200000
    v_cmp_lt_f32 vcc, s41, v8
    s_nop 3
    s_or_b64 s[42:43], s[42:43], vcc
    s_cmp_lg_u64 s[42:43], 0
    s_cselect_b32 s44, 1, 0
    s_cmp_lg_u32 s44, 0
    s_cbranch_scc1 L_joint_kernel_slow
    v_exp_f32 v32, v64
    v_exp_f32 v33, v65
    v_exp_f32 v34, v66
    v_exp_f32 v35, v67
    v_exp_f32 v36, v68
    v_exp_f32 v37, v69
    v_exp_f32 v38, v70
    v_exp_f32 v39, v71
    v_exp_f32 v40, v72
    v_exp_f32 v41, v73
    v_exp_f32 v42, v74
    v_exp_f32 v43, v75
    v_exp_f32 v44, v76
    v_exp_f32 v45, v77
    v_exp_f32 v46, v78
    v_exp_f32 v47, v79
    v_exp_f32 v48, v80
    v_exp_f32 v49, v81
    v_exp_f32 v50, v82
    v_exp_f32 v51, v83
    v_exp_f32 v52, v84
    v_exp_f32 v53, v85
    v_exp_f32 v54, v86
    v_exp_f32 v55, v87
    v_exp_f32 v56, v88
    v_exp_f32 v57, v89
    v_exp_f32 v58, v90
    v_exp_f32 v59, v91
    v_exp_f32 v60, v92
    v_exp_f32 v61, v93
    v_exp_f32 v62, v94
    v_exp_f32 v63, v95
    ds_write_b128 v9, v[32:35] offset:0
    ds_write_b128 v9, v[36:39] offset:32
    ds_write_b128 v9, v[40:43] offset:64
    ds_write_b128 v9, v[44:47] offset:96
    ds_write_b128 v9, v[48:51] offset:128
    ds_write_b128 v9, v[52:55] offset:160
    ds_write_b128 v9, v[56:59] offset:192
    ds_write_b128 v9, v[60:63] offset:224
    s_waitcnt lgkmcnt(0)
    ds_read_b128 v[32:35], v4 offset:0
    ds_read_b128 v[36:39], v4 offset:32
    ds_read_b128 v[40:43], v4 offset:64
    ds_read_b128 v[44:47], v4 offset:96
    ds_read_b128 v[48:51], v4 offset:128
    ds_read_b128 v[52:55], v4 offset:160
    ds_read_b128 v[56:59], v4 offset:192
    ds_read_b128 v[60:63], v4 offset:224
    s_waitcnt lgkmcnt(6)
    v_fma_f32 v64, v32, v96, 1.0
    v_fma_f32 v65, v33, v97, 1.0
    v_fma_f32 v66, v34, v98, 1.0
    v_fma_f32 v67, v35, v99, 1.0
    v_fma_f32 v68, v36, v100, 1.0
    v_fma_f32 v69, v37, v101, 1.0
    v_fma_f32 v70, v38, v102, 1.0
    v_fma_f32 v71, v39, v103, 1.0
    ds_read_b128 v[32:35], v4 offset:4224
    ds_read_b128 v[36:39], v4 offset:4256
    v_rcp_f32 v64, v64
    v_rcp_f32 v65, v65
    v_rcp_f32 v66, v66
    v_rcp_f32 v67, v67
    v_rcp_f32 v68, v68
    v_rcp_f32 v69, v69
    v_rcp_f32 v70, v70
    v_rcp_f32 v71, v71
    s_nop 0
    v_cvt_pk_bf16_f32 v80, v64, v65
    v_cvt_pk_bf16_f32 v81, v66, v67
    v_cvt_pk_bf16_f32 v82, v68, v69
    v_cvt_pk_bf16_f32 v83, v70, v71
    ds_write_b128 v2, v[80:83] offset:0
    s_waitcnt lgkmcnt(7)
    v_fma_f32 v72, v40, v104, 1.0
    v_fma_f32 v73, v41, v105, 1.0
    v_fma_f32 v74, v42, v106, 1.0
    v_fma_f32 v75, v43, v107, 1.0
    v_fma_f32 v76, v44, v108, 1.0
    v_fma_f32 v77, v45, v109, 1.0
    v_fma_f32 v78, v46, v110, 1.0
    v_fma_f32 v79, v47, v111, 1.0
    ds_read_b128 v[40:43], v4 offset:4288
    ds_read_b128 v[44:47], v4 offset:4320
    v_rcp_f32 v72, v72
    v_rcp_f32 v73, v73
    v_rcp_f32 v74, v74
    v_rcp_f32 v75, v75
    v_rcp_f32 v76, v76
    v_rcp_f32 v77, v77
    v_rcp_f32 v78, v78
    v_rcp_f32 v79, v79
    s_nop 0
    v_cvt_pk_bf16_f32 v84, v72, v73
    v_cvt_pk_bf16_f32 v85, v74, v75
    v_cvt_pk_bf16_f32 v86, v76, v77
    v_cvt_pk_bf16_f32 v87, v78, v79
    ds_write_b128 v2, v[84:87] offset:1024
    s_waitcnt lgkmcnt(8)
    v_fma_f32 v64, v48, v112, 1.0
    v_fma_f32 v65, v49, v113, 1.0
    v_fma_f32 v66, v50, v114, 1.0
    v_fma_f32 v67, v51, v115, 1.0
    v_fma_f32 v68, v52, v116, 1.0
    v_fma_f32 v69, v53, v117, 1.0
    v_fma_f32 v70, v54, v118, 1.0
    v_fma_f32 v71, v55, v119, 1.0
    ds_read_b128 v[48:51], v4 offset:4352
    ds_read_b128 v[52:55], v4 offset:4384
    v_rcp_f32 v64, v64
    v_rcp_f32 v65, v65
    v_rcp_f32 v66, v66
    v_rcp_f32 v67, v67
    v_rcp_f32 v68, v68
    v_rcp_f32 v69, v69
    v_rcp_f32 v70, v70
    v_rcp_f32 v71, v71
    s_nop 0
    v_cvt_pk_bf16_f32 v80, v64, v65
    v_cvt_pk_bf16_f32 v81, v66, v67
    v_cvt_pk_bf16_f32 v82, v68, v69
    v_cvt_pk_bf16_f32 v83, v70, v71
    ds_write_b128 v2, v[80:83] offset:2048
    s_waitcnt lgkmcnt(9)
    v_fma_f32 v72, v56, v120, 1.0
    v_fma_f32 v73, v57, v121, 1.0
    v_fma_f32 v74, v58, v122, 1.0
    v_fma_f32 v75, v59, v123, 1.0
    v_fma_f32 v76, v60, v124, 1.0
    v_fma_f32 v77, v61, v125, 1.0
    v_fma_f32 v78, v62, v126, 1.0
    v_fma_f32 v79, v63, v127, 1.0
    ds_read_b128 v[56:59], v4 offset:4416
    ds_read_b128 v[60:63], v4 offset:4448
    v_rcp_f32 v72, v72
    v_rcp_f32 v73, v73
    v_rcp_f32 v74, v74
    v_rcp_f32 v75, v75
    v_rcp_f32 v76, v76
    v_rcp_f32 v77, v77
    v_rcp_f32 v78, v78
    v_rcp_f32 v79, v79
    s_nop 0
    v_cvt_pk_bf16_f32 v84, v72, v73
    v_cvt_pk_bf16_f32 v85, v74, v75
    v_cvt_pk_bf16_f32 v86, v76, v77
    v_cvt_pk_bf16_f32 v87, v78, v79
    ds_write_b128 v2, v[84:87] offset:3072
    s_waitcnt lgkmcnt(10)
    v_fma_f32 v64, v32, v96, 1.0
    v_fma_f32 v65, v33, v97, 1.0
    v_fma_f32 v66, v34, v98, 1.0
    v_fma_f32 v67, v35, v99, 1.0
    v_fma_f32 v68, v36, v100, 1.0
    v_fma_f32 v69, v37, v101, 1.0
    v_fma_f32 v70, v38, v102, 1.0
    v_fma_f32 v71, v39, v103, 1.0
    ds_read_b128 v[32:35], v4 offset:8448
    ds_read_b128 v[36:39], v4 offset:8480
    v_rcp_f32 v64, v64
    v_rcp_f32 v65, v65
    v_rcp_f32 v66, v66
    v_rcp_f32 v67, v67
    v_rcp_f32 v68, v68
    v_rcp_f32 v69, v69
    v_rcp_f32 v70, v70
    v_rcp_f32 v71, v71
    s_nop 0
    v_cvt_pk_bf16_f32 v80, v64, v65
    v_cvt_pk_bf16_f32 v81, v66, v67
    v_cvt_pk_bf16_f32 v82, v68, v69
    v_cvt_pk_bf16_f32 v83, v70, v71
    ds_write_b128 v2, v[80:83] offset:16384
    s_waitcnt lgkmcnt(10)
    v_fma_f32 v72, v40, v104, 1.0
    v_fma_f32 v73, v41, v105, 1.0
    v_fma_f32 v74, v42, v106, 1.0
    v_fma_f32 v75, v43, v107, 1.0
    v_fma_f32 v76, v44, v108, 1.0
    v_fma_f32 v77, v45, v109, 1.0
    v_fma_f32 v78, v46, v110, 1.0
    v_fma_f32 v79, v47, v111, 1.0
    ds_read_b128 v[40:43], v4 offset:8512
    ds_read_b128 v[44:47], v4 offset:8544
    v_rcp_f32 v72, v72
    v_rcp_f32 v73, v73
    v_rcp_f32 v74, v74
    v_rcp_f32 v75, v75
    v_rcp_f32 v76, v76
    v_rcp_f32 v77, v77
    v_rcp_f32 v78, v78
    v_rcp_f32 v79, v79
    s_nop 0
    v_cvt_pk_bf16_f32 v84, v72, v73
    v_cvt_pk_bf16_f32 v85, v74, v75
    v_cvt_pk_bf16_f32 v86, v76, v77
    v_cvt_pk_bf16_f32 v87, v78, v79
    ds_write_b128 v2, v[84:87] offset:17408
    s_waitcnt lgkmcnt(10)
    v_fma_f32 v64, v48, v112, 1.0
    v_fma_f32 v65, v49, v113, 1.0
    v_fma_f32 v66, v50, v114, 1.0
    v_fma_f32 v67, v51, v115, 1.0
    v_fma_f32 v68, v52, v116, 1.0
    v_fma_f32 v69, v53, v117, 1.0
    v_fma_f32 v70, v54, v118, 1.0
    v_fma_f32 v71, v55, v119, 1.0
    ds_read_b128 v[48:51], v4 offset:8576
    ds_read_b128 v[52:55], v4 offset:8608
    v_rcp_f32 v64, v64
    v_rcp_f32 v65, v65
    v_rcp_f32 v66, v66
    v_rcp_f32 v67, v67
    v_rcp_f32 v68, v68
    v_rcp_f32 v69, v69
    v_rcp_f32 v70, v70
    v_rcp_f32 v71, v71
    s_nop 0
    v_cvt_pk_bf16_f32 v80, v64, v65
    v_cvt_pk_bf16_f32 v81, v66, v67
    v_cvt_pk_bf16_f32 v82, v68, v69
    v_cvt_pk_bf16_f32 v83, v70, v71
    ds_write_b128 v2, v[80:83] offset:18432
    s_waitcnt lgkmcnt(10)
    v_fma_f32 v72, v56, v120, 1.0
    v_fma_f32 v73, v57, v121, 1.0
    v_fma_f32 v74, v58, v122, 1.0
    v_fma_f32 v75, v59, v123, 1.0
    v_fma_f32 v76, v60, v124, 1.0
    v_fma_f32 v77, v61, v125, 1.0
    v_fma_f32 v78, v62, v126, 1.0
    v_fma_f32 v79, v63, v127, 1.0
    ds_read_b128 v[56:59], v4 offset:8640
    ds_read_b128 v[60:63], v4 offset:8672
    v_rcp_f32 v72, v72
    v_rcp_f32 v73, v73
    v_rcp_f32 v74, v74
    v_rcp_f32 v75, v75
    v_rcp_f32 v76, v76
    v_rcp_f32 v77, v77
    v_rcp_f32 v78, v78
    v_rcp_f32 v79, v79
    s_nop 0
    v_cvt_pk_bf16_f32 v84, v72, v73
    v_cvt_pk_bf16_f32 v85, v74, v75
    v_cvt_pk_bf16_f32 v86, v76, v77
    v_cvt_pk_bf16_f32 v87, v78, v79
    ds_write_b128 v2, v[84:87] offset:19456
    s_waitcnt lgkmcnt(0)
    s_barrier
    v_fma_f32 v64, v32, v96, 1.0
    v_fma_f32 v65, v33, v97, 1.0
    v_fma_f32 v66, v34, v98, 1.0
    v_fma_f32 v67, v35, v99, 1.0
    v_fma_f32 v68, v36, v100, 1.0
    v_fma_f32 v69, v37, v101, 1.0
    v_fma_f32 v70, v38, v102, 1.0
    v_fma_f32 v71, v39, v103, 1.0
    ds_read_b128 v[32:35], v4 offset:12672
    ds_read_b128 v[36:39], v4 offset:12704
    v_rcp_f32 v64, v64
    v_rcp_f32 v65, v65
    v_rcp_f32 v66, v66
    v_rcp_f32 v67, v67
    v_rcp_f32 v68, v68
    v_rcp_f32 v69, v69
    v_rcp_f32 v70, v70
    v_rcp_f32 v71, v71
    s_nop 0
    v_cvt_pk_bf16_f32 v80, v64, v65
    v_cvt_pk_bf16_f32 v81, v66, v67
    v_cvt_pk_bf16_f32 v82, v68, v69
    v_cvt_pk_bf16_f32 v83, v70, v71
    ds_write_b128 v2, v[80:83] offset:32768
    v_fma_f32 v72, v40, v104, 1.0
    v_fma_f32 v73, v41, v105, 1.0
    v_fma_f32 v74, v42, v106, 1.0
    v_fma_f32 v75, v43, v107, 1.0
    v_fma_f32 v76, v44, v108, 1.0
    v_fma_f32 v77, v45, v109, 1.0
    v_fma_f32 v78, v46, v110, 1.0
    v_fma_f32 v79, v47, v111, 1.0
    ds_read_b128 v[40:43], v4 offset:12736
    ds_read_b128 v[44:47], v4 offset:12768
    v_rcp_f32 v72, v72
    v_rcp_f32 v73, v73
    v_rcp_f32 v74, v74
    v_rcp_f32 v75, v75
    v_rcp_f32 v76, v76
    v_rcp_f32 v77, v77
    v_rcp_f32 v78, v78
    v_rcp_f32 v79, v79
    s_nop 0
    v_cvt_pk_bf16_f32 v84, v72, v73
    v_cvt_pk_bf16_f32 v85, v74, v75
    v_cvt_pk_bf16_f32 v86, v76, v77
    v_cvt_pk_bf16_f32 v87, v78, v79
    ds_write_b128 v2, v[84:87] offset:33792
    v_fma_f32 v64, v48, v112, 1.0
    v_fma_f32 v65, v49, v113, 1.0
    v_fma_f32 v66, v50, v114, 1.0
    v_fma_f32 v67, v51, v115, 1.0
    v_fma_f32 v68, v52, v116, 1.0
    v_fma_f32 v69, v53, v117, 1.0
    v_fma_f32 v70, v54, v118, 1.0
    v_fma_f32 v71, v55, v119, 1.0
    ds_read_b128 v[48:51], v4 offset:12800
    ds_read_b128 v[52:55], v4 offset:12832
    v_rcp_f32 v64, v64
    v_rcp_f32 v65, v65
    v_rcp_f32 v66, v66
    v_rcp_f32 v67, v67
    v_rcp_f32 v68, v68
    v_rcp_f32 v69, v69
    v_rcp_f32 v70, v70
    v_rcp_f32 v71, v71
    s_nop 0
    v_cvt_pk_bf16_f32 v80, v64, v65
    v_cvt_pk_bf16_f32 v81, v66, v67
    v_cvt_pk_bf16_f32 v82, v68, v69
    v_cvt_pk_bf16_f32 v83, v70, v71
    ds_write_b128 v2, v[80:83] offset:34816
    v_fma_f32 v72, v56, v120, 1.0
    v_fma_f32 v73, v57, v121, 1.0
    v_fma_f32 v74, v58, v122, 1.0
    v_fma_f32 v75, v59, v123, 1.0
    v_fma_f32 v76, v60, v124, 1.0
    v_fma_f32 v77, v61, v125, 1.0
    v_fma_f32 v78, v62, v126, 1.0
    v_fma_f32 v79, v63, v127, 1.0
    ds_read_b128 v[56:59], v4 offset:12864
    ds_read_b128 v[60:63], v4 offset:12896
    v_rcp_f32 v72, v72
    v_rcp_f32 v73, v73
    v_rcp_f32 v74, v74
    v_rcp_f32 v75, v75
    v_rcp_f32 v76, v76
    v_rcp_f32 v77, v77
    v_rcp_f32 v78, v78
    v_rcp_f32 v79, v79
    s_nop 0
    v_cvt_pk_bf16_f32 v84, v72, v73
    v_cvt_pk_bf16_f32 v85, v74, v75
    v_cvt_pk_bf16_f32 v86, v76, v77
    v_cvt_pk_bf16_f32 v87, v78, v79
    ds_write_b128 v2, v[84:87] offset:35840
    s_waitcnt lgkmcnt(0)
    s_barrier
    v_fma_f32 v64, v32, v96, 1.0
    v_fma_f32 v65, v33, v97, 1.0
    v_fma_f32 v66, v34, v98, 1.0
    v_fma_f32 v67, v35, v99, 1.0
    v_fma_f32 v68, v36, v100, 1.0
    v_fma_f32 v69, v37, v101, 1.0
    v_fma_f32 v70, v38, v102, 1.0
    v_fma_f32 v71, v39, v103, 1.0
    ds_read_b128 v[32:35], v4 offset:16896
    ds_read_b128 v[36:39], v4 offset:16928
    v_rcp_f32 v64, v64
    v_rcp_f32 v65, v65
    v_rcp_f32 v66, v66
    v_rcp_f32 v67, v67
    v_rcp_f32 v68, v68
    v_rcp_f32 v69, v69
    v_rcp_f32 v70, v70
    v_rcp_f32 v71, v71
    s_nop 0
    v_cvt_pk_bf16_f32 v80, v64, v65
    v_cvt_pk_bf16_f32 v81, v66, v67
    v_cvt_pk_bf16_f32 v82, v68, v69
    v_cvt_pk_bf16_f32 v83, v70, v71
    ds_write_b128 v2, v[80:83] offset:0
    v_fma_f32 v72, v40, v104, 1.0
    v_fma_f32 v73, v41, v105, 1.0
    v_fma_f32 v74, v42, v106, 1.0
    v_fma_f32 v75, v43, v107, 1.0
    v_fma_f32 v76, v44, v108, 1.0
    v_fma_f32 v77, v45, v109, 1.0
    v_fma_f32 v78, v46, v110, 1.0
    v_fma_f32 v79, v47, v111, 1.0
    ds_read_b128 v[40:43], v4 offset:16960
    ds_read_b128 v[44:47], v4 offset:16992
    v_rcp_f32 v72, v72
    v_rcp_f32 v73, v73
    v_rcp_f32 v74, v74
    v_rcp_f32 v75, v75
    v_rcp_f32 v76, v76
    v_rcp_f32 v77, v77
    v_rcp_f32 v78, v78
    v_rcp_f32 v79, v79
    s_nop 0
    v_cvt_pk_bf16_f32 v84, v72, v73
    v_cvt_pk_bf16_f32 v85, v74, v75
    v_cvt_pk_bf16_f32 v86, v76, v77
    v_cvt_pk_bf16_f32 v87, v78, v79
    ds_write_b128 v2, v[84:87] offset:1024
    v_fma_f32 v64, v48, v112, 1.0
    v_fma_f32 v65, v49, v113, 1.0
    v_fma_f32 v66, v50, v114, 1.0
    v_fma_f32 v67, v51, v115, 1.0
    v_fma_f32 v68, v52, v116, 1.0
    v_fma_f32 v69, v53, v117, 1.0
    v_fma_f32 v70, v54, v118, 1.0
    v_fma_f32 v71, v55, v119, 1.0
    ds_read_b128 v[48:51], v4 offset:17024
    ds_read_b128 v[52:55], v4 offset:17056
    v_rcp_f32 v64, v64
    v_rcp_f32 v65, v65
    v_rcp_f32 v66, v66
    v_rcp_f32 v67, v67
    v_rcp_f32 v68, v68
    v_rcp_f32 v69, v69
    v_rcp_f32 v70, v70
    v_rcp_f32 v71, v71
    s_nop 0
    v_cvt_pk_bf16_f32 v80, v64, v65
    v_cvt_pk_bf16_f32 v81, v66, v67
    v_cvt_pk_bf16_f32 v82, v68, v69
    v_cvt_pk_bf16_f32 v83, v70, v71
    ds_write_b128 v2, v[80:83] offset:2048
    v_fma_f32 v72, v56, v120, 1.0
    v_fma_f32 v73, v57, v121, 1.0
    v_fma_f32 v74, v58, v122, 1.0
    v_fma_f32 v75, v59, v123, 1.0
    v_fma_f32 v76, v60, v124, 1.0
    v_fma_f32 v77, v61, v125, 1.0
    v_fma_f32 v78, v62, v126, 1.0
    v_fma_f32 v79, v63, v127, 1.0
    ds_read_b128 v[56:59], v4 offset:17088
    ds_read_b128 v[60:63], v4 offset:17120
    v_rcp_f32 v72, v72
    v_rcp_f32 v73, v73
    v_rcp_f32 v74, v74
    v_rcp_f32 v75, v75
    v_rcp_f32 v76, v76
    v_rcp_f32 v77, v77
    v_rcp_f32 v78, v78
    v_rcp_f32 v79, v79
    s_nop 0
    v_cvt_pk_bf16_f32 v84, v72, v73
    v_cvt_pk_bf16_f32 v85, v74, v75
    v_cvt_pk_bf16_f32 v86, v76, v77
    v_cvt_pk_bf16_f32 v87, v78, v79
    ds_write_b128 v2, v[84:87] offset:3072
    s_waitcnt lgkmcnt(0)
    s_barrier
    ds_read_b128 a[0:3], v6 offset:0
    ds_read_b128 a[4:7], v6 offset:1056
    ds_read_b128 a[8:11], v6 offset:2112
    ds_read_b128 a[12:15], v6 offset:3168
    v_fma_f32 v64, v32, v96, 1.0
    v_fma_f32 v65, v33, v97, 1.0
    v_fma_f32 v66, v34, v98, 1.0
    v_fma_f32 v67, v35, v99, 1.0
    v_fma_f32 v68, v36, v100, 1.0
    v_fma_f32 v69, v37, v101, 1.0
    v_fma_f32 v70, v38, v102, 1.0
    v_fma_f32 v71, v39, v103, 1.0
    ds_read_b128 v[32:35], v4 offset:21120
    ds_read_b128 v[36:39], v4 offset:21152
    v_rcp_f32 v64, v64
    v_rcp_f32 v65, v65
    v_rcp_f32 v66, v66
    v_rcp_f32 v67, v67
    v_rcp_f32 v68, v68
    v_rcp_f32 v69, v69
    v_rcp_f32 v70, v70
    v_rcp_f32 v71, v71
    s_waitcnt lgkmcnt(5)
    s_mov_b32 s36, 0
    buffer_store_dwordx4 a[0:3], v7, s[16:19], s36 offen sc1
    s_waitcnt lgkmcnt(4)
    s_mov_b32 s36, 1024
    buffer_store_dwordx4 a[4:7], v7, s[16:19], s36 offen sc1
    v_cvt_pk_bf16_f32 v80, v64, v65
    v_cvt_pk_bf16_f32 v81, v66, v67
    v_cvt_pk_bf16_f32 v82, v68, v69
    v_cvt_pk_bf16_f32 v83, v70, v71
    ds_write_b128 v2, v[80:83] offset:16384
    v_fma_f32 v72, v40, v104, 1.0
    v_fma_f32 v73, v41, v105, 1.0
    v_fma_f32 v74, v42, v106, 1.0
    v_fma_f32 v75, v43, v107, 1.0
    v_fma_f32 v76, v44, v108, 1.0
    v_fma_f32 v77, v45, v109, 1.0
    v_fma_f32 v78, v46, v110, 1.0
    v_fma_f32 v79, v47, v111, 1.0
    ds_read_b128 v[40:43], v4 offset:21184
    ds_read_b128 v[44:47], v4 offset:21216
    v_rcp_f32 v72, v72
    v_rcp_f32 v73, v73
    v_rcp_f32 v74, v74
    v_rcp_f32 v75, v75
    v_rcp_f32 v76, v76
    v_rcp_f32 v77, v77
    v_rcp_f32 v78, v78
    v_rcp_f32 v79, v79
    s_waitcnt lgkmcnt(6)
    s_mov_b32 s36, 2048
    buffer_store_dwordx4 a[8:11], v7, s[16:19], s36 offen sc1
    s_waitcnt lgkmcnt(5)
    s_mov_b32 s36, 3072
    buffer_store_dwordx4 a[12:15], v7, s[16:19], s36 offen sc1
    v_cvt_pk_bf16_f32 v84, v72, v73
    v_cvt_pk_bf16_f32 v85, v74, v75
    v_cvt_pk_bf16_f32 v86, v76, v77
    v_cvt_pk_bf16_f32 v87, v78, v79
    ds_write_b128 v2, v[84:87] offset:17408
    v_fma_f32 v64, v48, v112, 1.0
    v_fma_f32 v65, v49, v113, 1.0
    v_fma_f32 v66, v50, v114, 1.0
    v_fma_f32 v67, v51, v115, 1.0
    v_fma_f32 v68, v52, v116, 1.0
    v_fma_f32 v69, v53, v117, 1.0
    v_fma_f32 v70, v54, v118, 1.0
    v_fma_f32 v71, v55, v119, 1.0
    ds_read_b128 v[48:51], v4 offset:21248
    ds_read_b128 v[52:55], v4 offset:21280
    v_rcp_f32 v64, v64
    v_rcp_f32 v65, v65
    v_rcp_f32 v66, v66
    v_rcp_f32 v67, v67
    v_rcp_f32 v68, v68
    v_rcp_f32 v69, v69
    v_rcp_f32 v70, v70
    v_rcp_f32 v71, v71
    s_nop 0
    v_cvt_pk_bf16_f32 v80, v64, v65
    v_cvt_pk_bf16_f32 v81, v66, v67
    v_cvt_pk_bf16_f32 v82, v68, v69
    v_cvt_pk_bf16_f32 v83, v70, v71
    ds_write_b128 v2, v[80:83] offset:18432
    v_fma_f32 v72, v56, v120, 1.0
    v_fma_f32 v73, v57, v121, 1.0
    v_fma_f32 v74, v58, v122, 1.0
    v_fma_f32 v75, v59, v123, 1.0
    v_fma_f32 v76, v60, v124, 1.0
    v_fma_f32 v77, v61, v125, 1.0
    v_fma_f32 v78, v62, v126, 1.0
    v_fma_f32 v79, v63, v127, 1.0
    ds_read_b128 v[56:59], v4 offset:21312
    ds_read_b128 v[60:63], v4 offset:21344
    v_rcp_f32 v72, v72
    v_rcp_f32 v73, v73
    v_rcp_f32 v74, v74
    v_rcp_f32 v75, v75
    v_rcp_f32 v76, v76
    v_rcp_f32 v77, v77
    v_rcp_f32 v78, v78
    v_rcp_f32 v79, v79
    s_nop 0
    v_cvt_pk_bf16_f32 v84, v72, v73
    v_cvt_pk_bf16_f32 v85, v74, v75
    v_cvt_pk_bf16_f32 v86, v76, v77
    v_cvt_pk_bf16_f32 v87, v78, v79
    ds_write_b128 v2, v[84:87] offset:19456
    s_waitcnt lgkmcnt(0)
    s_barrier
    ds_read_b128 a[0:3], v6 offset:16896
    ds_read_b128 a[4:7], v6 offset:17952
    ds_read_b128 a[8:11], v6 offset:19008
    ds_read_b128 a[12:15], v6 offset:20064
    v_fma_f32 v64, v32, v96, 1.0
    v_fma_f32 v65, v33, v97, 1.0
    v_fma_f32 v66, v34, v98, 1.0
    v_fma_f32 v67, v35, v99, 1.0
    v_fma_f32 v68, v36, v100, 1.0
    v_fma_f32 v69, v37, v101, 1.0
    v_fma_f32 v70, v38, v102, 1.0
    v_fma_f32 v71, v39, v103, 1.0
    ds_read_b128 v[32:35], v4 offset:25344
    ds_read_b128 v[36:39], v4 offset:25376
    v_rcp_f32 v64, v64
    v_rcp_f32 v65, v65
    v_rcp_f32 v66, v66
    v_rcp_f32 v67, v67
    v_rcp_f32 v68, v68
    v_rcp_f32 v69, v69
    v_rcp_f32 v70, v70
    v_rcp_f32 v71, v71
    s_waitcnt lgkmcnt(5)
    s_mov_b32 s36, 16384
    buffer_store_dwordx4 a[0:3], v7, s[16:19], s36 offen sc1
    s_waitcnt lgkmcnt(4)
    s_mov_b32 s36, 17408
    buffer_store_dwordx4 a[4:7], v7, s[16:19], s36 offen sc1
    v_cvt_pk_bf16_f32 v80, v64, v65
    v_cvt_pk_bf16_f32 v81, v66, v67
    v_cvt_pk_bf16_f32 v82, v68, v69
    v_cvt_pk_bf16_f32 v83, v70, v71
    ds_write_b128 v2, v[80:83] offset:32768
    v_fma_f32 v72, v40, v104, 1.0
    v_fma_f32 v73, v41, v105, 1.0
    v_fma_f32 v74, v42, v106, 1.0
    v_fma_f32 v75, v43, v107, 1.0
    v_fma_f32 v76, v44, v108, 1.0
    v_fma_f32 v77, v45, v109, 1.0
    v_fma_f32 v78, v46, v110, 1.0
    v_fma_f32 v79, v47, v111, 1.0
    ds_read_b128 v[40:43], v4 offset:25408
    ds_read_b128 v[44:47], v4 offset:25440
    v_rcp_f32 v72, v72
    v_rcp_f32 v73, v73
    v_rcp_f32 v74, v74
    v_rcp_f32 v75, v75
    v_rcp_f32 v76, v76
    v_rcp_f32 v77, v77
    v_rcp_f32 v78, v78
    v_rcp_f32 v79, v79
    s_waitcnt lgkmcnt(6)
    s_mov_b32 s36, 18432
    buffer_store_dwordx4 a[8:11], v7, s[16:19], s36 offen sc1
    s_waitcnt lgkmcnt(5)
    s_mov_b32 s36, 19456
    buffer_store_dwordx4 a[12:15], v7, s[16:19], s36 offen sc1
    v_cvt_pk_bf16_f32 v84, v72, v73
    v_cvt_pk_bf16_f32 v85, v74, v75
    v_cvt_pk_bf16_f32 v86, v76, v77
    v_cvt_pk_bf16_f32 v87, v78, v79
    ds_write_b128 v2, v[84:87] offset:33792
    v_fma_f32 v64, v48, v112, 1.0
    v_fma_f32 v65, v49, v113, 1.0
    v_fma_f32 v66, v50, v114, 1.0
    v_fma_f32 v67, v51, v115, 1.0
    v_fma_f32 v68, v52, v116, 1.0
    v_fma_f32 v69, v53, v117, 1.0
    v_fma_f32 v70, v54, v118, 1.0
    v_fma_f32 v71, v55, v119, 1.0
    ds_read_b128 v[48:51], v4 offset:25472
    ds_read_b128 v[52:55], v4 offset:25504
    v_rcp_f32 v64, v64
    v_rcp_f32 v65, v65
    v_rcp_f32 v66, v66
    v_rcp_f32 v67, v67
    v_rcp_f32 v68, v68
    v_rcp_f32 v69, v69
    v_rcp_f32 v70, v70
    v_rcp_f32 v71, v71
    s_nop 0
    v_cvt_pk_bf16_f32 v80, v64, v65
    v_cvt_pk_bf16_f32 v81, v66, v67
    v_cvt_pk_bf16_f32 v82, v68, v69
    v_cvt_pk_bf16_f32 v83, v70, v71
    ds_write_b128 v2, v[80:83] offset:34816
    v_fma_f32 v72, v56, v120, 1.0
    v_fma_f32 v73, v57, v121, 1.0
    v_fma_f32 v74, v58, v122, 1.0
    v_fma_f32 v75, v59, v123, 1.0
    v_fma_f32 v76, v60, v124, 1.0
    v_fma_f32 v77, v61, v125, 1.0
    v_fma_f32 v78, v62, v126, 1.0
    v_fma_f32 v79, v63, v127, 1.0
    ds_read_b128 v[56:59], v4 offset:25536
    ds_read_b128 v[60:63], v4 offset:25568
    v_rcp_f32 v72, v72
    v_rcp_f32 v73, v73
    v_rcp_f32 v74, v74
    v_rcp_f32 v75, v75
    v_rcp_f32 v76, v76
    v_rcp_f32 v77, v77
    v_rcp_f32 v78, v78
    v_rcp_f32 v79, v79
    s_nop 0
    v_cvt_pk_bf16_f32 v84, v72, v73
    v_cvt_pk_bf16_f32 v85, v74, v75
    v_cvt_pk_bf16_f32 v86, v76, v77
    v_cvt_pk_bf16_f32 v87, v78, v79
    ds_write_b128 v2, v[84:87] offset:35840
    s_waitcnt lgkmcnt(0)
    s_barrier
    ds_read_b128 a[0:3], v6 offset:0
    ds_read_b128 a[4:7], v6 offset:1056
    ds_read_b128 a[8:11], v6 offset:2112
    ds_read_b128 a[12:15], v6 offset:3168
    v_fma_f32 v64, v32, v96, 1.0
    v_fma_f32 v65, v33, v97, 1.0
    v_fma_f32 v66, v34, v98, 1.0
    v_fma_f32 v67, v35, v99, 1.0
    v_fma_f32 v68, v36, v100, 1.0
    v_fma_f32 v69, v37, v101, 1.0
    v_fma_f32 v70, v38, v102, 1.0
    v_fma_f32 v71, v39, v103, 1.0
    ds_read_b128 v[32:35], v4 offset:29568
    ds_read_b128 v[36:39], v4 offset:29600
    v_rcp_f32 v64, v64
    v_rcp_f32 v65, v65
    v_rcp_f32 v66, v66
    v_rcp_f32 v67, v67
    v_rcp_f32 v68, v68
    v_rcp_f32 v69, v69
    v_rcp_f32 v70, v70
    v_rcp_f32 v71, v71
    s_waitcnt lgkmcnt(5)
    s_mov_b32 s36, 32768
    buffer_store_dwordx4 a[0:3], v7, s[16:19], s36 offen sc1
    s_waitcnt lgkmcnt(4)
    s_mov_b32 s36, 33792
    buffer_store_dwordx4 a[4:7], v7, s[16:19], s36 offen sc1
    v_cvt_pk_bf16_f32 v80, v64, v65
    v_cvt_pk_bf16_f32 v81, v66, v67
    v_cvt_pk_bf16_f32 v82, v68, v69
    v_cvt_pk_bf16_f32 v83, v70, v71
    ds_write_b128 v2, v[80:83] offset:0
    v_fma_f32 v72, v40, v104, 1.0
    v_fma_f32 v73, v41, v105, 1.0
    v_fma_f32 v74, v42, v106, 1.0
    v_fma_f32 v75, v43, v107, 1.0
    v_fma_f32 v76, v44, v108, 1.0
    v_fma_f32 v77, v45, v109, 1.0
    v_fma_f32 v78, v46, v110, 1.0
    v_fma_f32 v79, v47, v111, 1.0
    ds_read_b128 v[40:43], v4 offset:29632
    ds_read_b128 v[44:47], v4 offset:29664
    v_rcp_f32 v72, v72
    v_rcp_f32 v73, v73
    v_rcp_f32 v74, v74
    v_rcp_f32 v75, v75
    v_rcp_f32 v76, v76
    v_rcp_f32 v77, v77
    v_rcp_f32 v78, v78
    v_rcp_f32 v79, v79
    s_waitcnt lgkmcnt(6)
    s_mov_b32 s36, 34816
    buffer_store_dwordx4 a[8:11], v7, s[16:19], s36 offen sc1
    s_waitcnt lgkmcnt(5)
    s_mov_b32 s36, 35840
    buffer_store_dwordx4 a[12:15], v7, s[16:19], s36 offen sc1
    v_cvt_pk_bf16_f32 v84, v72, v73
    v_cvt_pk_bf16_f32 v85, v74, v75
    v_cvt_pk_bf16_f32 v86, v76, v77
    v_cvt_pk_bf16_f32 v87, v78, v79
    ds_write_b128 v2, v[84:87] offset:1024
    v_fma_f32 v64, v48, v112, 1.0
    v_fma_f32 v65, v49, v113, 1.0
    v_fma_f32 v66, v50, v114, 1.0
    v_fma_f32 v67, v51, v115, 1.0
    v_fma_f32 v68, v52, v116, 1.0
    v_fma_f32 v69, v53, v117, 1.0
    v_fma_f32 v70, v54, v118, 1.0
    v_fma_f32 v71, v55, v119, 1.0
    ds_read_b128 v[48:51], v4 offset:29696
    ds_read_b128 v[52:55], v4 offset:29728
    v_rcp_f32 v64, v64
    v_rcp_f32 v65, v65
    v_rcp_f32 v66, v66
    v_rcp_f32 v67, v67
    v_rcp_f32 v68, v68
    v_rcp_f32 v69, v69
    v_rcp_f32 v70, v70
    v_rcp_f32 v71, v71
    s_nop 0
    v_cvt_pk_bf16_f32 v80, v64, v65
    v_cvt_pk_bf16_f32 v81, v66, v67
    v_cvt_pk_bf16_f32 v82, v68, v69
    v_cvt_pk_bf16_f32 v83, v70, v71
    ds_write_b128 v2, v[80:83] offset:2048
    v_fma_f32 v72, v56, v120, 1.0
    v_fma_f32 v73, v57, v121, 1.0
    v_fma_f32 v74, v58, v122, 1.0
    v_fma_f32 v75, v59, v123, 1.0
    v_fma_f32 v76, v60, v124, 1.0
    v_fma_f32 v77, v61, v125, 1.0
    v_fma_f32 v78, v62, v126, 1.0
    v_fma_f32 v79, v63, v127, 1.0
    ds_read_b128 v[56:59], v4 offset:29760
    ds_read_b128 v[60:63], v4 offset:29792
    v_rcp_f32 v72, v72
    v_rcp_f32 v73, v73
    v_rcp_f32 v74, v74
    v_rcp_f32 v75, v75
    v_rcp_f32 v76, v76
    v_rcp_f32 v77, v77
    v_rcp_f32 v78, v78
    v_rcp_f32 v79, v79
    s_nop 0
    v_cvt_pk_bf16_f32 v84, v72, v73
    v_cvt_pk_bf16_f32 v85, v74, v75
    v_cvt_pk_bf16_f32 v86, v76, v77
    v_cvt_pk_bf16_f32 v87, v78, v79
    ds_write_b128 v2, v[84:87] offset:3072
    s_waitcnt lgkmcnt(0)
    s_barrier
    ds_read_b128 a[0:3], v6 offset:16896
    ds_read_b128 a[4:7], v6 offset:17952
    ds_read_b128 a[8:11], v6 offset:19008
    ds_read_b128 a[12:15], v6 offset:20064
    v_fma_f32 v64, v32, v96, 1.0
    v_fma_f32 v65, v33, v97, 1.0
    v_fma_f32 v66, v34, v98, 1.0
    v_fma_f32 v67, v35, v99, 1.0
    v_fma_f32 v68, v36, v100, 1.0
    v_fma_f32 v69, v37, v101, 1.0
    v_fma_f32 v70, v38, v102, 1.0
    v_fma_f32 v71, v39, v103, 1.0
    v_rcp_f32 v64, v64
    v_rcp_f32 v65, v65
    v_rcp_f32 v66, v66
    v_rcp_f32 v67, v67
    v_rcp_f32 v68, v68
    v_rcp_f32 v69, v69
    v_rcp_f32 v70, v70
    v_rcp_f32 v71, v71
    s_waitcnt lgkmcnt(3)
    s_mov_b32 s36, 49152
    buffer_store_dwordx4 a[0:3], v7, s[16:19], s36 offen sc1
    s_waitcnt lgkmcnt(2)
    s_mov_b32 s36, 50176
    buffer_store_dwordx4 a[4:7], v7, s[16:19], s36 offen sc1
    v_cvt_pk_bf16_f32 v80, v64, v65
    v_cvt_pk_bf16_f32 v81, v66, v67
    v_cvt_pk_bf16_f32 v82, v68, v69
    v_cvt_pk_bf16_f32 v83, v70, v71
    ds_write_b128 v2, v[80:83] offset:16384
    v_fma_f32 v72, v40, v104, 1.0
    v_fma_f32 v73, v41, v105, 1.0
    v_fma_f32 v74, v42, v106, 1.0
    v_fma_f32 v75, v43, v107, 1.0
    v_fma_f32 v76, v44, v108, 1.0
    v_fma_f32 v77, v45, v109, 1.0
    v_fma_f32 v78, v46, v110, 1.0
    v_fma_f32 v79, v47, v111, 1.0
    v_rcp_f32 v72, v72
    v_rcp_f32 v73, v73
    v_rcp_f32 v74, v74
    v_rcp_f32 v75, v75
    v_rcp_f32 v76, v76
    v_rcp_f32 v77, v77
    v_rcp_f32 v78, v78
    v_rcp_f32 v79, v79
    s_waitcnt lgkmcnt(2)
    s_mov_b32 s36, 51200
    buffer_store_dwordx4 a[8:11], v7, s[16:19], s36 offen sc1
    s_waitcnt lgkmcnt(1)
    s_mov_b32 s36, 52224
    buffer_store_dwordx4 a[12:15], v7, s[16:19], s36 offen sc1
    v_cvt_pk_bf16_f32 v84, v72, v73
    v_cvt_pk_bf16_f32 v85, v74, v75
    v_cvt_pk_bf16_f32 v86, v76, v77
    v_cvt_pk_bf16_f32 v87, v78, v79
    ds_write_b128 v2, v[84:87] offset:17408
    v_fma_f32 v64, v48, v112, 1.0
    v_fma_f32 v65, v49, v113, 1.0
    v_fma_f32 v66, v50, v114, 1.0
    v_fma_f32 v67, v51, v115, 1.0
    v_fma_f32 v68, v52, v116, 1.0
    v_fma_f32 v69, v53, v117, 1.0
    v_fma_f32 v70, v54, v118, 1.0
    v_fma_f32 v71, v55, v119, 1.0
    v_rcp_f32 v64, v64
    v_rcp_f32 v65, v65
    v_rcp_f32 v66, v66
    v_rcp_f32 v67, v67
    v_rcp_f32 v68, v68
    v_rcp_f32 v69, v69
    v_rcp_f32 v70, v70
    v_rcp_f32 v71, v71
    s_nop 0
    v_cvt_pk_bf16_f32 v80, v64, v65
    v_cvt_pk_bf16_f32 v81, v66, v67
    v_cvt_pk_bf16_f32 v82, v68, v69
    v_cvt_pk_bf16_f32 v83, v70, v71
    ds_write_b128 v2, v[80:83] offset:18432
    v_fma_f32 v72, v56, v120, 1.0
    v_fma_f32 v73, v57, v121, 1.0
    v_fma_f32 v74, v58, v122, 1.0
    v_fma_f32 v75, v59, v123, 1.0
    v_fma_f32 v76, v60, v124, 1.0
    v_fma_f32 v77, v61, v125, 1.0
    v_fma_f32 v78, v62, v126, 1.0
    v_fma_f32 v79, v63, v127, 1.0
    v_rcp_f32 v72, v72
    v_rcp_f32 v73, v73
    v_rcp_f32 v74, v74
    v_rcp_f32 v75, v75
    v_rcp_f32 v76, v76
    v_rcp_f32 v77, v77
    v_rcp_f32 v78, v78
    v_rcp_f32 v79, v79
    s_nop 0
    v_cvt_pk_bf16_f32 v84, v72, v73
    v_cvt_pk_bf16_f32 v85, v74, v75
    v_cvt_pk_bf16_f32 v86, v76, v77
    v_cvt_pk_bf16_f32 v87, v78, v79
    ds_write_b128 v2, v[84:87] offset:19456
    s_waitcnt lgkmcnt(0)
    s_barrier
    ds_read_b128 a[0:3], v6 offset:0
    ds_read_b128 a[4:7], v6 offset:1056
    ds_read_b128 a[8:11], v6 offset:2112
    ds_read_b128 a[12:15], v6 offset:3168
    s_waitcnt lgkmcnt(3)
    s_mov_b32 s36, 65536
    buffer_store_dwordx4 a[0:3], v7, s[16:19], s36 offen sc1
    s_waitcnt lgkmcnt(2)
    s_mov_b32 s36, 66560
    buffer_store_dwordx4 a[4:7], v7, s[16:19], s36 offen sc1
    s_waitcnt lgkmcnt(1)
    s_mov_b32 s36, 67584
    buffer_store_dwordx4 a[8:11], v7, s[16:19], s36 offen sc1
    s_waitcnt lgkmcnt(0)
    s_mov_b32 s36, 68608
    buffer_store_dwordx4 a[12:15], v7, s[16:19], s36 offen sc1
    s_barrier
    ds_read_b128 a[0:3], v6 offset:16896
    ds_read_b128 a[4:7], v6 offset:17952
    ds_read_b128 a[8:11], v6 offset:19008
    ds_read_b128 a[12:15], v6 offset:20064
    s_waitcnt lgkmcnt(3)
    s_mov_b32 s36, 81920
    buffer_store_dwordx4 a[0:3], v7, s[16:19], s36 offen sc1
    s_waitcnt lgkmcnt(2)
    s_mov_b32 s36, 82944
    buffer_store_dwordx4 a[4:7], v7, s[16:19], s36 offen sc1
    s_waitcnt lgkmcnt(1)
    s_mov_b32 s36, 83968
    buffer_store_dwordx4 a[8:11], v7, s[16:19], s36 offen sc1
    s_waitcnt lgkmcnt(0)
    s_mov_b32 s36, 84992
    buffer_store_dwordx4 a[12:15], v7, s[16:19], s36 offen sc1
    s_barrier
    ds_read_b128 a[0:3], v6 offset:0
    ds_read_b128 a[4:7], v6 offset:1056
    ds_read_b128 a[8:11], v6 offset:2112
    ds_read_b128 a[12:15], v6 offset:3168
    s_waitcnt lgkmcnt(3)
    s_mov_b32 s36, 98304
    buffer_store_dwordx4 a[0:3], v7, s[16:19], s36 offen sc1
    s_waitcnt lgkmcnt(2)
    s_mov_b32 s36, 99328
    buffer_store_dwordx4 a[4:7], v7, s[16:19], s36 offen sc1
    s_waitcnt lgkmcnt(1)
    s_mov_b32 s36, 100352
    buffer_store_dwordx4 a[8:11], v7, s[16:19], s36 offen sc1
    s_waitcnt lgkmcnt(0)
    s_mov_b32 s36, 101376
    buffer_store_dwordx4 a[12:15], v7, s[16:19], s36 offen sc1
    s_barrier
    ds_read_b128 a[0:3], v6 offset:16896
    ds_read_b128 a[4:7], v6 offset:17952
    ds_read_b128 a[8:11], v6 offset:19008
    ds_read_b128 a[12:15], v6 offset:20064
    s_waitcnt lgkmcnt(3)
    s_mov_b32 s36, 114688
    buffer_store_dwordx4 a[0:3], v7, s[16:19], s36 offen sc1
    s_waitcnt lgkmcnt(2)
    s_mov_b32 s36, 115712
    buffer_store_dwordx4 a[4:7], v7, s[16:19], s36 offen sc1
    s_waitcnt lgkmcnt(1)
    s_mov_b32 s36, 116736
    buffer_store_dwordx4 a[8:11], v7, s[16:19], s36 offen sc1
    s_waitcnt lgkmcnt(0)
    s_mov_b32 s36, 117760
    buffer_store_dwordx4 a[12:15], v7, s[16:19], s36 offen sc1
    s_endpgm
L_joint_kernel_slow:
    buffer_load_dwordx4 v[96:99], v14, s[12:15], s37 offen offset:0
    buffer_load_dwordx4 v[100:103], v14, s[12:15], s37 offen offset:32
    buffer_load_dwordx4 v[104:107], v14, s[12:15], s37 offen offset:64
    buffer_load_dwordx4 v[108:111], v14, s[12:15], s37 offen offset:96
    buffer_load_dwordx4 v[112:115], v14, s[12:15], s37 offen offset:128
    buffer_load_dwordx4 v[116:119], v14, s[12:15], s37 offen offset:160
    buffer_load_dwordx4 v[120:123], v14, s[12:15], s37 offen offset:192
    buffer_load_dwordx4 v[124:127], v14, s[12:15], s37 offen offset:224
    s_waitcnt vmcnt(0)
    ds_write_b128 v9, v[64:67] offset:0
    ds_write_b128 v9, v[68:71] offset:32
    ds_write_b128 v9, v[72:75] offset:64
    ds_write_b128 v9, v[76:79] offset:96
    ds_write_b128 v9, v[80:83] offset:128
    ds_write_b128 v9, v[84:87] offset:160
    ds_write_b128 v9, v[88:91] offset:192
    ds_write_b128 v9, v[92:95] offset:224
    s_waitcnt lgkmcnt(0)
    ds_read_b128 v[32:35], v4 offset:0
    ds_read_b128 v[36:39], v4 offset:32
    ds_read_b128 v[40:43], v4 offset:64
    ds_read_b128 v[44:47], v4 offset:96
    ds_read_b128 v[48:51], v4 offset:128
    ds_read_b128 v[52:55], v4 offset:160
    ds_read_b128 v[56:59], v4 offset:192
    ds_read_b128 v[60:63], v4 offset:224
    s_waitcnt lgkmcnt(6)
    v_add_f32 v64, v32, v96
    v_add_f32 v65, v33, v97
    v_add_f32 v66, v34, v98
    v_add_f32 v67, v35, v99
    v_add_f32 v68, v36, v100
    v_add_f32 v69, v37, v101
    v_add_f32 v70, v38, v102
    v_add_f32 v71, v39, v103
    ds_read_b128 v[32:35], v4 offset:4224
    ds_read_b128 v[36:39], v4 offset:4256
    v_exp_f32 v64, v64
    v_exp_f32 v65, v65
    v_exp_f32 v66, v66
    v_exp_f32 v67, v67
    v_exp_f32 v68, v68
    v_exp_f32 v69, v69
    v_exp_f32 v70, v70
    v_exp_f32 v71, v71
    v_add_f32 v64, 1.0, v64
    v_add_f32 v65, 1.0, v65
    v_add_f32 v66, 1.0, v66
    v_add_f32 v67, 1.0, v67
    v_add_f32 v68, 1.0, v68
    v_add_f32 v69, 1.0, v69
    v_add_f32 v70, 1.0, v70
    v_add_f32 v71, 1.0, v71
    v_rcp_f32 v64, v64
    v_rcp_f32 v65, v65
    v_rcp_f32 v66, v66
    v_rcp_f32 v67, v67
    v_rcp_f32 v68, v68
    v_rcp_f32 v69, v69
    v_rcp_f32 v70, v70
    v_rcp_f32 v71, v71
    s_nop 0
    v_cvt_pk_bf16_f32 v80, v64, v65
    v_cvt_pk_bf16_f32 v81, v66, v67
    v_cvt_pk_bf16_f32 v82, v68, v69
    v_cvt_pk_bf16_f32 v83, v70, v71
    ds_write_b128 v2, v[80:83] offset:0
    s_waitcnt lgkmcnt(7)
    v_add_f32 v72, v40, v104
    v_add_f32 v73, v41, v105
    v_add_f32 v74, v42, v106
    v_add_f32 v75, v43, v107
    v_add_f32 v76, v44, v108
    v_add_f32 v77, v45, v109
    v_add_f32 v78, v46, v110
    v_add_f32 v79, v47, v111
    ds_read_b128 v[40:43], v4 offset:4288
    ds_read_b128 v[44:47], v4 offset:4320
    v_exp_f32 v72, v72
    v_exp_f32 v73, v73
    v_exp_f32 v74, v74
    v_exp_f32 v75, v75
    v_exp_f32 v76, v76
    v_exp_f32 v77, v77
    v_exp_f32 v78, v78
    v_exp_f32 v79, v79
    v_add_f32 v72, 1.0, v72
    v_add_f32 v73, 1.0, v73
    v_add_f32 v74, 1.0, v74
    v_add_f32 v75, 1.0, v75
    v_add_f32 v76, 1.0, v76
    v_add_f32 v77, 1.0, v77
    v_add_f32 v78, 1.0, v78
    v_add_f32 v79, 1.0, v79
    v_rcp_f32 v72, v72
    v_rcp_f32 v73, v73
    v_rcp_f32 v74, v74
    v_rcp_f32 v75, v75
    v_rcp_f32 v76, v76
    v_rcp_f32 v77, v77
    v_rcp_f32 v78, v78
    v_rcp_f32 v79, v79
    s_nop 0
    v_cvt_pk_bf16_f32 v84, v72, v73
    v_cvt_pk_bf16_f32 v85, v74, v75
    v_cvt_pk_bf16_f32 v86, v76, v77
    v_cvt_pk_bf16_f32 v87, v78, v79
    ds_write_b128 v2, v[84:87] offset:1024
    s_waitcnt lgkmcnt(8)
    v_add_f32 v64, v48, v112
    v_add_f32 v65, v49, v113
    v_add_f32 v66, v50, v114
    v_add_f32 v67, v51, v115
    v_add_f32 v68, v52, v116
    v_add_f32 v69, v53, v117
    v_add_f32 v70, v54, v118
    v_add_f32 v71, v55, v119
    ds_read_b128 v[48:51], v4 offset:4352
    ds_read_b128 v[52:55], v4 offset:4384
    v_exp_f32 v64, v64
    v_exp_f32 v65, v65
    v_exp_f32 v66, v66
    v_exp_f32 v67, v67
    v_exp_f32 v68, v68
    v_exp_f32 v69, v69
    v_exp_f32 v70, v70
    v_exp_f32 v71, v71
    v_add_f32 v64, 1.0, v64
    v_add_f32 v65, 1.0, v65
    v_add_f32 v66, 1.0, v66
    v_add_f32 v67, 1.0, v67
    v_add_f32 v68, 1.0, v68
    v_add_f32 v69, 1.0, v69
    v_add_f32 v70, 1.0, v70
    v_add_f32 v71, 1.0, v71
    v_rcp_f32 v64, v64
    v_rcp_f32 v65, v65
    v_rcp_f32 v66, v66
    v_rcp_f32 v67, v67
    v_rcp_f32 v68, v68
    v_rcp_f32 v69, v69
    v_rcp_f32 v70, v70
    v_rcp_f32 v71, v71
    s_nop 0
    v_cvt_pk_bf16_f32 v80, v64, v65
    v_cvt_pk_bf16_f32 v81, v66, v67
    v_cvt_pk_bf16_f32 v82, v68, v69
    v_cvt_pk_bf16_f32 v83, v70, v71
    ds_write_b128 v2, v[80:83] offset:2048
    s_waitcnt lgkmcnt(9)
    v_add_f32 v72, v56, v120
    v_add_f32 v73, v57, v121
    v_add_f32 v74, v58, v122
    v_add_f32 v75, v59, v123
    v_add_f32 v76, v60, v124
    v_add_f32 v77, v61, v125
    v_add_f32 v78, v62, v126
    v_add_f32 v79, v63, v127
    ds_read_b128 v[56:59], v4 offset:4416
    ds_read_b128 v[60:63], v4 offset:4448
    v_exp_f32 v72, v72
    v_exp_f32 v73, v73
    v_exp_f32 v74, v74
    v_exp_f32 v75, v75
    v_exp_f32 v76, v76
    v_exp_f32 v77, v77
    v_exp_f32 v78, v78
    v_exp_f32 v79, v79
    v_add_f32 v72, 1.0, v72
    v_add_f32 v73, 1.0, v73
    v_add_f32 v74, 1.0, v74
    v_add_f32 v75, 1.0, v75
    v_add_f32 v76, 1.0, v76
    v_add_f32 v77, 1.0, v77
    v_add_f32 v78, 1.0, v78
    v_add_f32 v79, 1.0, v79
    v_rcp_f32 v72, v72
    v_rcp_f32 v73, v73
    v_rcp_f32 v74, v74
    v_rcp_f32 v75, v75
    v_rcp_f32 v76, v76
    v_rcp_f32 v77, v77
    v_rcp_f32 v78, v78
    v_rcp_f32 v79, v79
    s_nop 0
    v_cvt_pk_bf16_f32 v84, v72, v73
    v_cvt_pk_bf16_f32 v85, v74, v75
    v_cvt_pk_bf16_f32 v86, v76, v77
    v_cvt_pk_bf16_f32 v87, v78, v79
    ds_write_b128 v2, v[84:87] offset:3072
    s_waitcnt lgkmcnt(10)
    v_add_f32 v64, v32, v96
    v_add_f32 v65, v33, v97
    v_add_f32 v66, v34, v98
    v_add_f32 v67, v35, v99
    v_add_f32 v68, v36, v100
    v_add_f32 v69, v37, v101
    v_add_f32 v70, v38, v102
    v_add_f32 v71, v39, v103
    ds_read_b128 v[32:35], v4 offset:8448
    ds_read_b128 v[36:39], v4 offset:8480
    v_exp_f32 v64, v64
    v_exp_f32 v65, v65
    v_exp_f32 v66, v66
    v_exp_f32 v67, v67
    v_exp_f32 v68, v68
    v_exp_f32 v69, v69
    v_exp_f32 v70, v70
    v_exp_f32 v71, v71
    v_add_f32 v64, 1.0, v64
    v_add_f32 v65, 1.0, v65
    v_add_f32 v66, 1.0, v66
    v_add_f32 v67, 1.0, v67
    v_add_f32 v68, 1.0, v68
    v_add_f32 v69, 1.0, v69
    v_add_f32 v70, 1.0, v70
    v_add_f32 v71, 1.0, v71
    v_rcp_f32 v64, v64
    v_rcp_f32 v65, v65
    v_rcp_f32 v66, v66
    v_rcp_f32 v67, v67
    v_rcp_f32 v68, v68
    v_rcp_f32 v69, v69
    v_rcp_f32 v70, v70
    v_rcp_f32 v71, v71
    s_nop 0
    v_cvt_pk_bf16_f32 v80, v64, v65
    v_cvt_pk_bf16_f32 v81, v66, v67
    v_cvt_pk_bf16_f32 v82, v68, v69
    v_cvt_pk_bf16_f32 v83, v70, v71
    ds_write_b128 v2, v[80:83] offset:16384
    s_waitcnt lgkmcnt(10)
    v_add_f32 v72, v40, v104
    v_add_f32 v73, v41, v105
    v_add_f32 v74, v42, v106
    v_add_f32 v75, v43, v107
    v_add_f32 v76, v44, v108
    v_add_f32 v77, v45, v109
    v_add_f32 v78, v46, v110
    v_add_f32 v79, v47, v111
    ds_read_b128 v[40:43], v4 offset:8512
    ds_read_b128 v[44:47], v4 offset:8544
    v_exp_f32 v72, v72
    v_exp_f32 v73, v73
    v_exp_f32 v74, v74
    v_exp_f32 v75, v75
    v_exp_f32 v76, v76
    v_exp_f32 v77, v77
    v_exp_f32 v78, v78
    v_exp_f32 v79, v79
    v_add_f32 v72, 1.0, v72
    v_add_f32 v73, 1.0, v73
    v_add_f32 v74, 1.0, v74
    v_add_f32 v75, 1.0, v75
    v_add_f32 v76, 1.0, v76
    v_add_f32 v77, 1.0, v77
    v_add_f32 v78, 1.0, v78
    v_add_f32 v79, 1.0, v79
    v_rcp_f32 v72, v72
    v_rcp_f32 v73, v73
    v_rcp_f32 v74, v74
    v_rcp_f32 v75, v75
    v_rcp_f32 v76, v76
    v_rcp_f32 v77, v77
    v_rcp_f32 v78, v78
    v_rcp_f32 v79, v79
    s_nop 0
    v_cvt_pk_bf16_f32 v84, v72, v73
    v_cvt_pk_bf16_f32 v85, v74, v75
    v_cvt_pk_bf16_f32 v86, v76, v77
    v_cvt_pk_bf16_f32 v87, v78, v79
    ds_write_b128 v2, v[84:87] offset:17408
    s_waitcnt lgkmcnt(10)
    v_add_f32 v64, v48, v112
    v_add_f32 v65, v49, v113
    v_add_f32 v66, v50, v114
    v_add_f32 v67, v51, v115
    v_add_f32 v68, v52, v116
    v_add_f32 v69, v53, v117
    v_add_f32 v70, v54, v118
    v_add_f32 v71, v55, v119
    ds_read_b128 v[48:51], v4 offset:8576
    ds_read_b128 v[52:55], v4 offset:8608
    v_exp_f32 v64, v64
    v_exp_f32 v65, v65
    v_exp_f32 v66, v66
    v_exp_f32 v67, v67
    v_exp_f32 v68, v68
    v_exp_f32 v69, v69
    v_exp_f32 v70, v70
    v_exp_f32 v71, v71
    v_add_f32 v64, 1.0, v64
    v_add_f32 v65, 1.0, v65
    v_add_f32 v66, 1.0, v66
    v_add_f32 v67, 1.0, v67
    v_add_f32 v68, 1.0, v68
    v_add_f32 v69, 1.0, v69
    v_add_f32 v70, 1.0, v70
    v_add_f32 v71, 1.0, v71
    v_rcp_f32 v64, v64
    v_rcp_f32 v65, v65
    v_rcp_f32 v66, v66
    v_rcp_f32 v67, v67
    v_rcp_f32 v68, v68
    v_rcp_f32 v69, v69
    v_rcp_f32 v70, v70
    v_rcp_f32 v71, v71
    s_nop 0
    v_cvt_pk_bf16_f32 v80, v64, v65
    v_cvt_pk_bf16_f32 v81, v66, v67
    v_cvt_pk_bf16_f32 v82, v68, v69
    v_cvt_pk_bf16_f32 v83, v70, v71
    ds_write_b128 v2, v[80:83] offset:18432
    s_waitcnt lgkmcnt(10)
    v_add_f32 v72, v56, v120
    v_add_f32 v73, v57, v121
    v_add_f32 v74, v58, v122
    v_add_f32 v75, v59, v123
    v_add_f32 v76, v60, v124
    v_add_f32 v77, v61, v125
    v_add_f32 v78, v62, v126
    v_add_f32 v79, v63, v127
    ds_read_b128 v[56:59], v4 offset:8640
    ds_read_b128 v[60:63], v4 offset:8672
    v_exp_f32 v72, v72
    v_exp_f32 v73, v73
    v_exp_f32 v74, v74
    v_exp_f32 v75, v75
    v_exp_f32 v76, v76
    v_exp_f32 v77, v77
    v_exp_f32 v78, v78
    v_exp_f32 v79, v79
    v_add_f32 v72, 1.0, v72
    v_add_f32 v73, 1.0, v73
    v_add_f32 v74, 1.0, v74
    v_add_f32 v75, 1.0, v75
    v_add_f32 v76, 1.0, v76
    v_add_f32 v77, 1.0, v77
    v_add_f32 v78, 1.0, v78
    v_add_f32 v79, 1.0, v79
    v_rcp_f32 v72, v72
    v_rcp_f32 v73, v73
    v_rcp_f32 v74, v74
    v_rcp_f32 v75, v75
    v_rcp_f32 v76, v76
    v_rcp_f32 v77, v77
    v_rcp_f32 v78, v78
    v_rcp_f32 v79, v79
    s_nop 0
    v_cvt_pk_bf16_f32 v84, v72, v73
    v_cvt_pk_bf16_f32 v85, v74, v75
    v_cvt_pk_bf16_f32 v86, v76, v77
    v_cvt_pk_bf16_f32 v87, v78, v79
    ds_write_b128 v2, v[84:87] offset:19456
    s_waitcnt lgkmcnt(0)
    s_barrier
    v_add_f32 v64, v32, v96
    v_add_f32 v65, v33, v97
    v_add_f32 v66, v34, v98
    v_add_f32 v67, v35, v99
    v_add_f32 v68, v36, v100
    v_add_f32 v69, v37, v101
    v_add_f32 v70, v38, v102
    v_add_f32 v71, v39, v103
    ds_read_b128 v[32:35], v4 offset:12672
    ds_read_b128 v[36:39], v4 offset:12704
    v_exp_f32 v64, v64
    v_exp_f32 v65, v65
    v_exp_f32 v66, v66
    v_exp_f32 v67, v67
    v_exp_f32 v68, v68
    v_exp_f32 v69, v69
    v_exp_f32 v70, v70
    v_exp_f32 v71, v71
    v_add_f32 v64, 1.0, v64
    v_add_f32 v65, 1.0, v65
    v_add_f32 v66, 1.0, v66
    v_add_f32 v67, 1.0, v67
    v_add_f32 v68, 1.0, v68
    v_add_f32 v69, 1.0, v69
    v_add_f32 v70, 1.0, v70
    v_add_f32 v71, 1.0, v71
    v_rcp_f32 v64, v64
    v_rcp_f32 v65, v65
    v_rcp_f32 v66, v66
    v_rcp_f32 v67, v67
    v_rcp_f32 v68, v68
    v_rcp_f32 v69, v69
    v_rcp_f32 v70, v70
    v_rcp_f32 v71, v71
    s_nop 0
    v_cvt_pk_bf16_f32 v80, v64, v65
    v_cvt_pk_bf16_f32 v81, v66, v67
    v_cvt_pk_bf16_f32 v82, v68, v69
    v_cvt_pk_bf16_f32 v83, v70, v71
    ds_write_b128 v2, v[80:83] offset:32768
    v_add_f32 v72, v40, v104
    v_add_f32 v73, v41, v105
    v_add_f32 v74, v42, v106
    v_add_f32 v75, v43, v107
    v_add_f32 v76, v44, v108
    v_add_f32 v77, v45, v109
    v_add_f32 v78, v46, v110
    v_add_f32 v79, v47, v111
    ds_read_b128 v[40:43], v4 offset:12736
    ds_read_b128 v[44:47], v4 offset:12768
    v_exp_f32 v72, v72
    v_exp_f32 v73, v73
    v_exp_f32 v74, v74
    v_exp_f32 v75, v75
    v_exp_f32 v76, v76
    v_exp_f32 v77, v77
    v_exp_f32 v78, v78
    v_exp_f32 v79, v79
    v_add_f32 v72, 1.0, v72
    v_add_f32 v73, 1.0, v73
    v_add_f32 v74, 1.0, v74
    v_add_f32 v75, 1.0, v75
    v_add_f32 v76, 1.0, v76
    v_add_f32 v77, 1.0, v77
    v_add_f32 v78, 1.0, v78
    v_add_f32 v79, 1.0, v79
    v_rcp_f32 v72, v72
    v_rcp_f32 v73, v73
    v_rcp_f32 v74, v74
    v_rcp_f32 v75, v75
    v_rcp_f32 v76, v76
    v_rcp_f32 v77, v77
    v_rcp_f32 v78, v78
    v_rcp_f32 v79, v79
    s_nop 0
    v_cvt_pk_bf16_f32 v84, v72, v73
    v_cvt_pk_bf16_f32 v85, v74, v75
    v_cvt_pk_bf16_f32 v86, v76, v77
    v_cvt_pk_bf16_f32 v87, v78, v79
    ds_write_b128 v2, v[84:87] offset:33792
    v_add_f32 v64, v48, v112
    v_add_f32 v65, v49, v113
    v_add_f32 v66, v50, v114
    v_add_f32 v67, v51, v115
    v_add_f32 v68, v52, v116
    v_add_f32 v69, v53, v117
    v_add_f32 v70, v54, v118
    v_add_f32 v71, v55, v119
    ds_read_b128 v[48:51], v4 offset:12800
    ds_read_b128 v[52:55], v4 offset:12832
    v_exp_f32 v64, v64
    v_exp_f32 v65, v65
    v_exp_f32 v66, v66
    v_exp_f32 v67, v67
    v_exp_f32 v68, v68
    v_exp_f32 v69, v69
    v_exp_f32 v70, v70
    v_exp_f32 v71, v71
    v_add_f32 v64, 1.0, v64
    v_add_f32 v65, 1.0, v65
    v_add_f32 v66, 1.0, v66
    v_add_f32 v67, 1.0, v67
    v_add_f32 v68, 1.0, v68
    v_add_f32 v69, 1.0, v69
    v_add_f32 v70, 1.0, v70
    v_add_f32 v71, 1.0, v71
    v_rcp_f32 v64, v64
    v_rcp_f32 v65, v65
    v_rcp_f32 v66, v66
    v_rcp_f32 v67, v67
    v_rcp_f32 v68, v68
    v_rcp_f32 v69, v69
    v_rcp_f32 v70, v70
    v_rcp_f32 v71, v71
    s_nop 0
    v_cvt_pk_bf16_f32 v80, v64, v65
    v_cvt_pk_bf16_f32 v81, v66, v67
    v_cvt_pk_bf16_f32 v82, v68, v69
    v_cvt_pk_bf16_f32 v83, v70, v71
    ds_write_b128 v2, v[80:83] offset:34816
    v_add_f32 v72, v56, v120
    v_add_f32 v73, v57, v121
    v_add_f32 v74, v58, v122
    v_add_f32 v75, v59, v123
    v_add_f32 v76, v60, v124
    v_add_f32 v77, v61, v125
    v_add_f32 v78, v62, v126
    v_add_f32 v79, v63, v127
    ds_read_b128 v[56:59], v4 offset:12864
    ds_read_b128 v[60:63], v4 offset:12896
    v_exp_f32 v72, v72
    v_exp_f32 v73, v73
    v_exp_f32 v74, v74
    v_exp_f32 v75, v75
    v_exp_f32 v76, v76
    v_exp_f32 v77, v77
    v_exp_f32 v78, v78
    v_exp_f32 v79, v79
    v_add_f32 v72, 1.0, v72
    v_add_f32 v73, 1.0, v73
    v_add_f32 v74, 1.0, v74
    v_add_f32 v75, 1.0, v75
    v_add_f32 v76, 1.0, v76
    v_add_f32 v77, 1.0, v77
    v_add_f32 v78, 1.0, v78
    v_add_f32 v79, 1.0, v79
    v_rcp_f32 v72, v72
    v_rcp_f32 v73, v73
    v_rcp_f32 v74, v74
    v_rcp_f32 v75, v75
    v_rcp_f32 v76, v76
    v_rcp_f32 v77, v77
    v_rcp_f32 v78, v78
    v_rcp_f32 v79, v79
    s_nop 0
    v_cvt_pk_bf16_f32 v84, v72, v73
    v_cvt_pk_bf16_f32 v85, v74, v75
    v_cvt_pk_bf16_f32 v86, v76, v77
    v_cvt_pk_bf16_f32 v87, v78, v79
    ds_write_b128 v2, v[84:87] offset:35840
    s_waitcnt lgkmcnt(0)
    s_barrier
    v_add_f32 v64, v32, v96
    v_add_f32 v65, v33, v97
    v_add_f32 v66, v34, v98
    v_add_f32 v67, v35, v99
    v_add_f32 v68, v36, v100
    v_add_f32 v69, v37, v101
    v_add_f32 v70, v38, v102
    v_add_f32 v71, v39, v103
    ds_read_b128 v[32:35], v4 offset:16896
    ds_read_b128 v[36:39], v4 offset:16928
    v_exp_f32 v64, v64
    v_exp_f32 v65, v65
    v_exp_f32 v66, v66
    v_exp_f32 v67, v67
    v_exp_f32 v68, v68
    v_exp_f32 v69, v69
    v_exp_f32 v70, v70
    v_exp_f32 v71, v71
    v_add_f32 v64, 1.0, v64
    v_add_f32 v65, 1.0, v65
    v_add_f32 v66, 1.0, v66
    v_add_f32 v67, 1.0, v67
    v_add_f32 v68, 1.0, v68
    v_add_f32 v69, 1.0, v69
    v_add_f32 v70, 1.0, v70
    v_add_f32 v71, 1.0, v71
    v_rcp_f32 v64, v64
    v_rcp_f32 v65, v65
    v_rcp_f32 v66, v66
    v_rcp_f32 v67, v67
    v_rcp_f32 v68, v68
    v_rcp_f32 v69, v69
    v_rcp_f32 v70, v70
    v_rcp_f32 v71, v71
    s_nop 0
    v_cvt_pk_bf16_f32 v80, v64, v65
    v_cvt_pk_bf16_f32 v81, v66, v67
    v_cvt_pk_bf16_f32 v82, v68, v69
    v_cvt_pk_bf16_f32 v83, v70, v71
    ds_write_b128 v2, v[80:83] offset:0
    v_add_f32 v72, v40, v104
    v_add_f32 v73, v41, v105
    v_add_f32 v74, v42, v106
    v_add_f32 v75, v43, v107
    v_add_f32 v76, v44, v108
    v_add_f32 v77, v45, v109
    v_add_f32 v78, v46, v110
    v_add_f32 v79, v47, v111
    ds_read_b128 v[40:43], v4 offset:16960
    ds_read_b128 v[44:47], v4 offset:16992
    v_exp_f32 v72, v72
    v_exp_f32 v73, v73
    v_exp_f32 v74, v74
    v_exp_f32 v75, v75
    v_exp_f32 v76, v76
    v_exp_f32 v77, v77
    v_exp_f32 v78, v78
    v_exp_f32 v79, v79
    v_add_f32 v72, 1.0, v72
    v_add_f32 v73, 1.0, v73
    v_add_f32 v74, 1.0, v74
    v_add_f32 v75, 1.0, v75
    v_add_f32 v76, 1.0, v76
    v_add_f32 v77, 1.0, v77
    v_add_f32 v78, 1.0, v78
    v_add_f32 v79, 1.0, v79
    v_rcp_f32 v72, v72
    v_rcp_f32 v73, v73
    v_rcp_f32 v74, v74
    v_rcp_f32 v75, v75
    v_rcp_f32 v76, v76
    v_rcp_f32 v77, v77
    v_rcp_f32 v78, v78
    v_rcp_f32 v79, v79
    s_nop 0
    v_cvt_pk_bf16_f32 v84, v72, v73
    v_cvt_pk_bf16_f32 v85, v74, v75
    v_cvt_pk_bf16_f32 v86, v76, v77
    v_cvt_pk_bf16_f32 v87, v78, v79
    ds_write_b128 v2, v[84:87] offset:1024
    v_add_f32 v64, v48, v112
    v_add_f32 v65, v49, v113
    v_add_f32 v66, v50, v114
    v_add_f32 v67, v51, v115
    v_add_f32 v68, v52, v116
    v_add_f32 v69, v53, v117
    v_add_f32 v70, v54, v118
    v_add_f32 v71, v55, v119
    ds_read_b128 v[48:51], v4 offset:17024
    ds_read_b128 v[52:55], v4 offset:17056
    v_exp_f32 v64, v64
    v_exp_f32 v65, v65
    v_exp_f32 v66, v66
    v_exp_f32 v67, v67
    v_exp_f32 v68, v68
    v_exp_f32 v69, v69
    v_exp_f32 v70, v70
    v_exp_f32 v71, v71
    v_add_f32 v64, 1.0, v64
    v_add_f32 v65, 1.0, v65
    v_add_f32 v66, 1.0, v66
    v_add_f32 v67, 1.0, v67
    v_add_f32 v68, 1.0, v68
    v_add_f32 v69, 1.0, v69
    v_add_f32 v70, 1.0, v70
    v_add_f32 v71, 1.0, v71
    v_rcp_f32 v64, v64
    v_rcp_f32 v65, v65
    v_rcp_f32 v66, v66
    v_rcp_f32 v67, v67
    v_rcp_f32 v68, v68
    v_rcp_f32 v69, v69
    v_rcp_f32 v70, v70
    v_rcp_f32 v71, v71
    s_nop 0
    v_cvt_pk_bf16_f32 v80, v64, v65
    v_cvt_pk_bf16_f32 v81, v66, v67
    v_cvt_pk_bf16_f32 v82, v68, v69
    v_cvt_pk_bf16_f32 v83, v70, v71
    ds_write_b128 v2, v[80:83] offset:2048
    v_add_f32 v72, v56, v120
    v_add_f32 v73, v57, v121
    v_add_f32 v74, v58, v122
    v_add_f32 v75, v59, v123
    v_add_f32 v76, v60, v124
    v_add_f32 v77, v61, v125
    v_add_f32 v78, v62, v126
    v_add_f32 v79, v63, v127
    ds_read_b128 v[56:59], v4 offset:17088
    ds_read_b128 v[60:63], v4 offset:17120
    v_exp_f32 v72, v72
    v_exp_f32 v73, v73
    v_exp_f32 v74, v74
    v_exp_f32 v75, v75
    v_exp_f32 v76, v76
    v_exp_f32 v77, v77
    v_exp_f32 v78, v78
    v_exp_f32 v79, v79
    v_add_f32 v72, 1.0, v72
    v_add_f32 v73, 1.0, v73
    v_add_f32 v74, 1.0, v74
    v_add_f32 v75, 1.0, v75
    v_add_f32 v76, 1.0, v76
    v_add_f32 v77, 1.0, v77
    v_add_f32 v78, 1.0, v78
    v_add_f32 v79, 1.0, v79
    v_rcp_f32 v72, v72
    v_rcp_f32 v73, v73
    v_rcp_f32 v74, v74
    v_rcp_f32 v75, v75
    v_rcp_f32 v76, v76
    v_rcp_f32 v77, v77
    v_rcp_f32 v78, v78
    v_rcp_f32 v79, v79
    s_nop 0
    v_cvt_pk_bf16_f32 v84, v72, v73
    v_cvt_pk_bf16_f32 v85, v74, v75
    v_cvt_pk_bf16_f32 v86, v76, v77
    v_cvt_pk_bf16_f32 v87, v78, v79
    ds_write_b128 v2, v[84:87] offset:3072
    s_waitcnt lgkmcnt(0)
    s_barrier
    ds_read_b128 a[0:3], v6 offset:0
    ds_read_b128 a[4:7], v6 offset:1056
    ds_read_b128 a[8:11], v6 offset:2112
    ds_read_b128 a[12:15], v6 offset:3168
    v_add_f32 v64, v32, v96
    v_add_f32 v65, v33, v97
    v_add_f32 v66, v34, v98
    v_add_f32 v67, v35, v99
    v_add_f32 v68, v36, v100
    v_add_f32 v69, v37, v101
    v_add_f32 v70, v38, v102
    v_add_f32 v71, v39, v103
    ds_read_b128 v[32:35], v4 offset:21120
    ds_read_b128 v[36:39], v4 offset:21152
    v_exp_f32 v64, v64
    v_exp_f32 v65, v65
    v_exp_f32 v66, v66
    v_exp_f32 v67, v67
    v_exp_f32 v68, v68
    v_exp_f32 v69, v69
    v_exp_f32 v70, v70
    v_exp_f32 v71, v71
    v_add_f32 v64, 1.0, v64
    v_add_f32 v65, 1.0, v65
    v_add_f32 v66, 1.0, v66
    v_add_f32 v67, 1.0, v67
    v_add_f32 v68, 1.0, v68
    v_add_f32 v69, 1.0, v69
    v_add_f32 v70, 1.0, v70
    v_add_f32 v71, 1.0, v71
    v_rcp_f32 v64, v64
    v_rcp_f32 v65, v65
    v_rcp_f32 v66, v66
    v_rcp_f32 v67, v67
    v_rcp_f32 v68, v68
    v_rcp_f32 v69, v69
    v_rcp_f32 v70, v70
    v_rcp_f32 v71, v71
    s_waitcnt lgkmcnt(5)
    s_mov_b32 s36, 0
    buffer_store_dwordx4 a[0:3], v7, s[16:19], s36 offen sc1
    s_waitcnt lgkmcnt(4)
    s_mov_b32 s36, 1024
    buffer_store_dwordx4 a[4:7], v7, s[16:19], s36 offen sc1
    v_cvt_pk_bf16_f32 v80, v64, v65
    v_cvt_pk_bf16_f32 v81, v66, v67
    v_cvt_pk_bf16_f32 v82, v68, v69
    v_cvt_pk_bf16_f32 v83, v70, v71
    ds_write_b128 v2, v[80:83] offset:16384
    v_add_f32 v72, v40, v104
    v_add_f32 v73, v41, v105
    v_add_f32 v74, v42, v106
    v_add_f32 v75, v43, v107
    v_add_f32 v76, v44, v108
    v_add_f32 v77, v45, v109
    v_add_f32 v78, v46, v110
    v_add_f32 v79, v47, v111
    ds_read_b128 v[40:43], v4 offset:21184
    ds_read_b128 v[44:47], v4 offset:21216
    v_exp_f32 v72, v72
    v_exp_f32 v73, v73
    v_exp_f32 v74, v74
    v_exp_f32 v75, v75
    v_exp_f32 v76, v76
    v_exp_f32 v77, v77
    v_exp_f32 v78, v78
    v_exp_f32 v79, v79
    v_add_f32 v72, 1.0, v72
    v_add_f32 v73, 1.0, v73
    v_add_f32 v74, 1.0, v74
    v_add_f32 v75, 1.0, v75
    v_add_f32 v76, 1.0, v76
    v_add_f32 v77, 1.0, v77
    v_add_f32 v78, 1.0, v78
    v_add_f32 v79, 1.0, v79
    v_rcp_f32 v72, v72
    v_rcp_f32 v73, v73
    v_rcp_f32 v74, v74
    v_rcp_f32 v75, v75
    v_rcp_f32 v76, v76
    v_rcp_f32 v77, v77
    v_rcp_f32 v78, v78
    v_rcp_f32 v79, v79
    s_waitcnt lgkmcnt(6)
    s_mov_b32 s36, 2048
    buffer_store_dwordx4 a[8:11], v7, s[16:19], s36 offen sc1
    s_waitcnt lgkmcnt(5)
    s_mov_b32 s36, 3072
    buffer_store_dwordx4 a[12:15], v7, s[16:19], s36 offen sc1
    v_cvt_pk_bf16_f32 v84, v72, v73
    v_cvt_pk_bf16_f32 v85, v74, v75
    v_cvt_pk_bf16_f32 v86, v76, v77
    v_cvt_pk_bf16_f32 v87, v78, v79
    ds_write_b128 v2, v[84:87] offset:17408
    v_add_f32 v64, v48, v112
    v_add_f32 v65, v49, v113
    v_add_f32 v66, v50, v114
    v_add_f32 v67, v51, v115
    v_add_f32 v68, v52, v116
    v_add_f32 v69, v53, v117
    v_add_f32 v70, v54, v118
    v_add_f32 v71, v55, v119
    ds_read_b128 v[48:51], v4 offset:21248
    ds_read_b128 v[52:55], v4 offset:21280
    v_exp_f32 v64, v64
    v_exp_f32 v65, v65
    v_exp_f32 v66, v66
    v_exp_f32 v67, v67
    v_exp_f32 v68, v68
    v_exp_f32 v69, v69
    v_exp_f32 v70, v70
    v_exp_f32 v71, v71
    v_add_f32 v64, 1.0, v64
    v_add_f32 v65, 1.0, v65
    v_add_f32 v66, 1.0, v66
    v_add_f32 v67, 1.0, v67
    v_add_f32 v68, 1.0, v68
    v_add_f32 v69, 1.0, v69
    v_add_f32 v70, 1.0, v70
    v_add_f32 v71, 1.0, v71
    v_rcp_f32 v64, v64
    v_rcp_f32 v65, v65
    v_rcp_f32 v66, v66
    v_rcp_f32 v67, v67
    v_rcp_f32 v68, v68
    v_rcp_f32 v69, v69
    v_rcp_f32 v70, v70
    v_rcp_f32 v71, v71
    s_nop 0
    v_cvt_pk_bf16_f32 v80, v64, v65
    v_cvt_pk_bf16_f32 v81, v66, v67
    v_cvt_pk_bf16_f32 v82, v68, v69
    v_cvt_pk_bf16_f32 v83, v70, v71
    ds_write_b128 v2, v[80:83] offset:18432
    v_add_f32 v72, v56, v120
    v_add_f32 v73, v57, v121
    v_add_f32 v74, v58, v122
    v_add_f32 v75, v59, v123
    v_add_f32 v76, v60, v124
    v_add_f32 v77, v61, v125
    v_add_f32 v78, v62, v126
    v_add_f32 v79, v63, v127
    ds_read_b128 v[56:59], v4 offset:21312
    ds_read_b128 v[60:63], v4 offset:21344
    v_exp_f32 v72, v72
    v_exp_f32 v73, v73
    v_exp_f32 v74, v74
    v_exp_f32 v75, v75
    v_exp_f32 v76, v76
    v_exp_f32 v77, v77
    v_exp_f32 v78, v78
    v_exp_f32 v79, v79
    v_add_f32 v72, 1.0, v72
    v_add_f32 v73, 1.0, v73
    v_add_f32 v74, 1.0, v74
    v_add_f32 v75, 1.0, v75
    v_add_f32 v76, 1.0, v76
    v_add_f32 v77, 1.0, v77
    v_add_f32 v78, 1.0, v78
    v_add_f32 v79, 1.0, v79
    v_rcp_f32 v72, v72
    v_rcp_f32 v73, v73
    v_rcp_f32 v74, v74
    v_rcp_f32 v75, v75
    v_rcp_f32 v76, v76
    v_rcp_f32 v77, v77
    v_rcp_f32 v78, v78
    v_rcp_f32 v79, v79
    s_nop 0
    v_cvt_pk_bf16_f32 v84, v72, v73
    v_cvt_pk_bf16_f32 v85, v74, v75
    v_cvt_pk_bf16_f32 v86, v76, v77
    v_cvt_pk_bf16_f32 v87, v78, v79
    ds_write_b128 v2, v[84:87] offset:19456
    s_waitcnt lgkmcnt(0)
    s_barrier
    ds_read_b128 a[0:3], v6 offset:16896
    ds_read_b128 a[4:7], v6 offset:17952
    ds_read_b128 a[8:11], v6 offset:19008
    ds_read_b128 a[12:15], v6 offset:20064
    v_add_f32 v64, v32, v96
    v_add_f32 v65, v33, v97
    v_add_f32 v66, v34, v98
    v_add_f32 v67, v35, v99
    v_add_f32 v68, v36, v100
    v_add_f32 v69, v37, v101
    v_add_f32 v70, v38, v102
    v_add_f32 v71, v39, v103
    ds_read_b128 v[32:35], v4 offset:25344
    ds_read_b128 v[36:39], v4 offset:25376
    v_exp_f32 v64, v64
    v_exp_f32 v65, v65
    v_exp_f32 v66, v66
    v_exp_f32 v67, v67
    v_exp_f32 v68, v68
    v_exp_f32 v69, v69
    v_exp_f32 v70, v70
    v_exp_f32 v71, v71
    v_add_f32 v64, 1.0, v64
    v_add_f32 v65, 1.0, v65
    v_add_f32 v66, 1.0, v66
    v_add_f32 v67, 1.0, v67
    v_add_f32 v68, 1.0, v68
    v_add_f32 v69, 1.0, v69
    v_add_f32 v70, 1.0, v70
    v_add_f32 v71, 1.0, v71
    v_rcp_f32 v64, v64
    v_rcp_f32 v65, v65
    v_rcp_f32 v66, v66
    v_rcp_f32 v67, v67
    v_rcp_f32 v68, v68
    v_rcp_f32 v69, v69
    v_rcp_f32 v70, v70
    v_rcp_f32 v71, v71
    s_waitcnt lgkmcnt(5)
    s_mov_b32 s36, 16384
    buffer_store_dwordx4 a[0:3], v7, s[16:19], s36 offen sc1
    s_waitcnt lgkmcnt(4)
    s_mov_b32 s36, 17408
    buffer_store_dwordx4 a[4:7], v7, s[16:19], s36 offen sc1
    v_cvt_pk_bf16_f32 v80, v64, v65
    v_cvt_pk_bf16_f32 v81, v66, v67
    v_cvt_pk_bf16_f32 v82, v68, v69
    v_cvt_pk_bf16_f32 v83, v70, v71
    ds_write_b128 v2, v[80:83] offset:32768
    v_add_f32 v72, v40, v104
    v_add_f32 v73, v41, v105
    v_add_f32 v74, v42, v106
    v_add_f32 v75, v43, v107
    v_add_f32 v76, v44, v108
    v_add_f32 v77, v45, v109
    v_add_f32 v78, v46, v110
    v_add_f32 v79, v47, v111
    ds_read_b128 v[40:43], v4 offset:25408
    ds_read_b128 v[44:47], v4 offset:25440
    v_exp_f32 v72, v72
    v_exp_f32 v73, v73
    v_exp_f32 v74, v74
    v_exp_f32 v75, v75
    v_exp_f32 v76, v76
    v_exp_f32 v77, v77
    v_exp_f32 v78, v78
    v_exp_f32 v79, v79
    v_add_f32 v72, 1.0, v72
    v_add_f32 v73, 1.0, v73
    v_add_f32 v74, 1.0, v74
    v_add_f32 v75, 1.0, v75
    v_add_f32 v76, 1.0, v76
    v_add_f32 v77, 1.0, v77
    v_add_f32 v78, 1.0, v78
    v_add_f32 v79, 1.0, v79
    v_rcp_f32 v72, v72
    v_rcp_f32 v73, v73
    v_rcp_f32 v74, v74
    v_rcp_f32 v75, v75
    v_rcp_f32 v76, v76
    v_rcp_f32 v77, v77
    v_rcp_f32 v78, v78
    v_rcp_f32 v79, v79
    s_waitcnt lgkmcnt(6)
    s_mov_b32 s36, 18432
    buffer_store_dwordx4 a[8:11], v7, s[16:19], s36 offen sc1
    s_waitcnt lgkmcnt(5)
    s_mov_b32 s36, 19456
    buffer_store_dwordx4 a[12:15], v7, s[16:19], s36 offen sc1
    v_cvt_pk_bf16_f32 v84, v72, v73
    v_cvt_pk_bf16_f32 v85, v74, v75
    v_cvt_pk_bf16_f32 v86, v76, v77
    v_cvt_pk_bf16_f32 v87, v78, v79
    ds_write_b128 v2, v[84:87] offset:33792
    v_add_f32 v64, v48, v112
    v_add_f32 v65, v49, v113
    v_add_f32 v66, v50, v114
    v_add_f32 v67, v51, v115
    v_add_f32 v68, v52, v116
    v_add_f32 v69, v53, v117
    v_add_f32 v70, v54, v118
    v_add_f32 v71, v55, v119
    ds_read_b128 v[48:51], v4 offset:25472
    ds_read_b128 v[52:55], v4 offset:25504
    v_exp_f32 v64, v64
    v_exp_f32 v65, v65
    v_exp_f32 v66, v66
    v_exp_f32 v67, v67
    v_exp_f32 v68, v68
    v_exp_f32 v69, v69
    v_exp_f32 v70, v70
    v_exp_f32 v71, v71
    v_add_f32 v64, 1.0, v64
    v_add_f32 v65, 1.0, v65
    v_add_f32 v66, 1.0, v66
    v_add_f32 v67, 1.0, v67
    v_add_f32 v68, 1.0, v68
    v_add_f32 v69, 1.0, v69
    v_add_f32 v70, 1.0, v70
    v_add_f32 v71, 1.0, v71
    v_rcp_f32 v64, v64
    v_rcp_f32 v65, v65
    v_rcp_f32 v66, v66
    v_rcp_f32 v67, v67
    v_rcp_f32 v68, v68
    v_rcp_f32 v69, v69
    v_rcp_f32 v70, v70
    v_rcp_f32 v71, v71
    s_nop 0
    v_cvt_pk_bf16_f32 v80, v64, v65
    v_cvt_pk_bf16_f32 v81, v66, v67
    v_cvt_pk_bf16_f32 v82, v68, v69
    v_cvt_pk_bf16_f32 v83, v70, v71
    ds_write_b128 v2, v[80:83] offset:34816
    v_add_f32 v72, v56, v120
    v_add_f32 v73, v57, v121
    v_add_f32 v74, v58, v122
    v_add_f32 v75, v59, v123
    v_add_f32 v76, v60, v124
    v_add_f32 v77, v61, v125
    v_add_f32 v78, v62, v126
    v_add_f32 v79, v63, v127
    ds_read_b128 v[56:59], v4 offset:25536
    ds_read_b128 v[60:63], v4 offset:25568
    v_exp_f32 v72, v72
    v_exp_f32 v73, v73
    v_exp_f32 v74, v74
    v_exp_f32 v75, v75
    v_exp_f32 v76, v76
    v_exp_f32 v77, v77
    v_exp_f32 v78, v78
    v_exp_f32 v79, v79
    v_add_f32 v72, 1.0, v72
    v_add_f32 v73, 1.0, v73
    v_add_f32 v74, 1.0, v74
    v_add_f32 v75, 1.0, v75
    v_add_f32 v76, 1.0, v76
    v_add_f32 v77, 1.0, v77
    v_add_f32 v78, 1.0, v78
    v_add_f32 v79, 1.0, v79
    v_rcp_f32 v72, v72
    v_rcp_f32 v73, v73
    v_rcp_f32 v74, v74
    v_rcp_f32 v75, v75
    v_rcp_f32 v76, v76
    v_rcp_f32 v77, v77
    v_rcp_f32 v78, v78
    v_rcp_f32 v79, v79
    s_nop 0
    v_cvt_pk_bf16_f32 v84, v72, v73
    v_cvt_pk_bf16_f32 v85, v74, v75
    v_cvt_pk_bf16_f32 v86, v76, v77
    v_cvt_pk_bf16_f32 v87, v78, v79
    ds_write_b128 v2, v[84:87] offset:35840
    s_waitcnt lgkmcnt(0)
    s_barrier
    ds_read_b128 a[0:3], v6 offset:0
    ds_read_b128 a[4:7], v6 offset:1056
    ds_read_b128 a[8:11], v6 offset:2112
    ds_read_b128 a[12:15], v6 offset:3168
    v_add_f32 v64, v32, v96
    v_add_f32 v65, v33, v97
    v_add_f32 v66, v34, v98
    v_add_f32 v67, v35, v99
    v_add_f32 v68, v36, v100
    v_add_f32 v69, v37, v101
    v_add_f32 v70, v38, v102
    v_add_f32 v71, v39, v103
    ds_read_b128 v[32:35], v4 offset:29568
    ds_read_b128 v[36:39], v4 offset:29600
    v_exp_f32 v64, v64
    v_exp_f32 v65, v65
    v_exp_f32 v66, v66
    v_exp_f32 v67, v67
    v_exp_f32 v68, v68
    v_exp_f32 v69, v69
    v_exp_f32 v70, v70
    v_exp_f32 v71, v71
    v_add_f32 v64, 1.0, v64
    v_add_f32 v65, 1.0, v65
    v_add_f32 v66, 1.0, v66
    v_add_f32 v67, 1.0, v67
    v_add_f32 v68, 1.0, v68
    v_add_f32 v69, 1.0, v69
    v_add_f32 v70, 1.0, v70
    v_add_f32 v71, 1.0, v71
    v_rcp_f32 v64, v64
    v_rcp_f32 v65, v65
    v_rcp_f32 v66, v66
    v_rcp_f32 v67, v67
    v_rcp_f32 v68, v68
    v_rcp_f32 v69, v69
    v_rcp_f32 v70, v70
    v_rcp_f32 v71, v71
    s_waitcnt lgkmcnt(5)
    s_mov_b32 s36, 32768
    buffer_store_dwordx4 a[0:3], v7, s[16:19], s36 offen sc1
    s_waitcnt lgkmcnt(4)
    s_mov_b32 s36, 33792
    buffer_store_dwordx4 a[4:7], v7, s[16:19], s36 offen sc1
    v_cvt_pk_bf16_f32 v80, v64, v65
    v_cvt_pk_bf16_f32 v81, v66, v67
    v_cvt_pk_bf16_f32 v82, v68, v69
    v_cvt_pk_bf16_f32 v83, v70, v71
    ds_write_b128 v2, v[80:83] offset:0
    v_add_f32 v72, v40, v104
    v_add_f32 v73, v41, v105
    v_add_f32 v74, v42, v106
    v_add_f32 v75, v43, v107
    v_add_f32 v76, v44, v108
    v_add_f32 v77, v45, v109
    v_add_f32 v78, v46, v110
    v_add_f32 v79, v47, v111
    ds_read_b128 v[40:43], v4 offset:29632
    ds_read_b128 v[44:47], v4 offset:29664
    v_exp_f32 v72, v72
    v_exp_f32 v73, v73
    v_exp_f32 v74, v74
    v_exp_f32 v75, v75
    v_exp_f32 v76, v76
    v_exp_f32 v77, v77
    v_exp_f32 v78, v78
    v_exp_f32 v79, v79
    v_add_f32 v72, 1.0, v72
    v_add_f32 v73, 1.0, v73
    v_add_f32 v74, 1.0, v74
    v_add_f32 v75, 1.0, v75
    v_add_f32 v76, 1.0, v76
    v_add_f32 v77, 1.0, v77
    v_add_f32 v78, 1.0, v78
    v_add_f32 v79, 1.0, v79
    v_rcp_f32 v72, v72
    v_rcp_f32 v73, v73
    v_rcp_f32 v74, v74
    v_rcp_f32 v75, v75
    v_rcp_f32 v76, v76
    v_rcp_f32 v77, v77
    v_rcp_f32 v78, v78
    v_rcp_f32 v79, v79
    s_waitcnt lgkmcnt(6)
    s_mov_b32 s36, 34816
    buffer_store_dwordx4 a[8:11], v7, s[16:19], s36 offen sc1
    s_waitcnt lgkmcnt(5)
    s_mov_b32 s36, 35840
    buffer_store_dwordx4 a[12:15], v7, s[16:19], s36 offen sc1
    v_cvt_pk_bf16_f32 v84, v72, v73
    v_cvt_pk_bf16_f32 v85, v74, v75
    v_cvt_pk_bf16_f32 v86, v76, v77
    v_cvt_pk_bf16_f32 v87, v78, v79
    ds_write_b128 v2, v[84:87] offset:1024
    v_add_f32 v64, v48, v112
    v_add_f32 v65, v49, v113
    v_add_f32 v66, v50, v114
    v_add_f32 v67, v51, v115
    v_add_f32 v68, v52, v116
    v_add_f32 v69, v53, v117
    v_add_f32 v70, v54, v118
    v_add_f32 v71, v55, v119
    ds_read_b128 v[48:51], v4 offset:29696
    ds_read_b128 v[52:55], v4 offset:29728
    v_exp_f32 v64, v64
    v_exp_f32 v65, v65
    v_exp_f32 v66, v66
    v_exp_f32 v67, v67
    v_exp_f32 v68, v68
    v_exp_f32 v69, v69
    v_exp_f32 v70, v70
    v_exp_f32 v71, v71
    v_add_f32 v64, 1.0, v64
    v_add_f32 v65, 1.0, v65
    v_add_f32 v66, 1.0, v66
    v_add_f32 v67, 1.0, v67
    v_add_f32 v68, 1.0, v68
    v_add_f32 v69, 1.0, v69
    v_add_f32 v70, 1.0, v70
    v_add_f32 v71, 1.0, v71
    v_rcp_f32 v64, v64
    v_rcp_f32 v65, v65
    v_rcp_f32 v66, v66
    v_rcp_f32 v67, v67
    v_rcp_f32 v68, v68
    v_rcp_f32 v69, v69
    v_rcp_f32 v70, v70
    v_rcp_f32 v71, v71
    s_nop 0
    v_cvt_pk_bf16_f32 v80, v64, v65
    v_cvt_pk_bf16_f32 v81, v66, v67
    v_cvt_pk_bf16_f32 v82, v68, v69
    v_cvt_pk_bf16_f32 v83, v70, v71
    ds_write_b128 v2, v[80:83] offset:2048
    v_add_f32 v72, v56, v120
    v_add_f32 v73, v57, v121
    v_add_f32 v74, v58, v122
    v_add_f32 v75, v59, v123
    v_add_f32 v76, v60, v124
    v_add_f32 v77, v61, v125
    v_add_f32 v78, v62, v126
    v_add_f32 v79, v63, v127
    ds_read_b128 v[56:59], v4 offset:29760
    ds_read_b128 v[60:63], v4 offset:29792
    v_exp_f32 v72, v72
    v_exp_f32 v73, v73
    v_exp_f32 v74, v74
    v_exp_f32 v75, v75
    v_exp_f32 v76, v76
    v_exp_f32 v77, v77
    v_exp_f32 v78, v78
    v_exp_f32 v79, v79
    v_add_f32 v72, 1.0, v72
    v_add_f32 v73, 1.0, v73
    v_add_f32 v74, 1.0, v74
    v_add_f32 v75, 1.0, v75
    v_add_f32 v76, 1.0, v76
    v_add_f32 v77, 1.0, v77
    v_add_f32 v78, 1.0, v78
    v_add_f32 v79, 1.0, v79
    v_rcp_f32 v72, v72
    v_rcp_f32 v73, v73
    v_rcp_f32 v74, v74
    v_rcp_f32 v75, v75
    v_rcp_f32 v76, v76
    v_rcp_f32 v77, v77
    v_rcp_f32 v78, v78
    v_rcp_f32 v79, v79
    s_nop 0
    v_cvt_pk_bf16_f32 v84, v72, v73
    v_cvt_pk_bf16_f32 v85, v74, v75
    v_cvt_pk_bf16_f32 v86, v76, v77
    v_cvt_pk_bf16_f32 v87, v78, v79
    ds_write_b128 v2, v[84:87] offset:3072
    s_waitcnt lgkmcnt(0)
    s_barrier
    ds_read_b128 a[0:3], v6 offset:16896
    ds_read_b128 a[4:7], v6 offset:17952
    ds_read_b128 a[8:11], v6 offset:19008
    ds_read_b128 a[12:15], v6 offset:20064
    v_add_f32 v64, v32, v96
    v_add_f32 v65, v33, v97
    v_add_f32 v66, v34, v98
    v_add_f32 v67, v35, v99
    v_add_f32 v68, v36, v100
    v_add_f32 v69, v37, v101
    v_add_f32 v70, v38, v102
    v_add_f32 v71, v39, v103
    v_exp_f32 v64, v64
    v_exp_f32 v65, v65
    v_exp_f32 v66, v66
    v_exp_f32 v67, v67
    v_exp_f32 v68, v68
    v_exp_f32 v69, v69
    v_exp_f32 v70, v70
    v_exp_f32 v71, v71
    v_add_f32 v64, 1.0, v64
    v_add_f32 v65, 1.0, v65
    v_add_f32 v66, 1.0, v66
    v_add_f32 v67, 1.0, v67
    v_add_f32 v68, 1.0, v68
    v_add_f32 v69, 1.0, v69
    v_add_f32 v70, 1.0, v70
    v_add_f32 v71, 1.0, v71
    v_rcp_f32 v64, v64
    v_rcp_f32 v65, v65
    v_rcp_f32 v66, v66
    v_rcp_f32 v67, v67
    v_rcp_f32 v68, v68
    v_rcp_f32 v69, v69
    v_rcp_f32 v70, v70
    v_rcp_f32 v71, v71
    s_waitcnt lgkmcnt(3)
    s_mov_b32 s36, 49152
    buffer_store_dwordx4 a[0:3], v7, s[16:19], s36 offen sc1
    s_waitcnt lgkmcnt(2)
    s_mov_b32 s36, 50176
    buffer_store_dwordx4 a[4:7], v7, s[16:19], s36 offen sc1
    v_cvt_pk_bf16_f32 v80, v64, v65
    v_cvt_pk_bf16_f32 v81, v66, v67
    v_cvt_pk_bf16_f32 v82, v68, v69
    v_cvt_pk_bf16_f32 v83, v70, v71
    ds_write_b128 v2, v[80:83] offset:16384
    v_add_f32 v72, v40, v104
    v_add_f32 v73, v41, v105
    v_add_f32 v74, v42, v106
    v_add_f32 v75, v43, v107
    v_add_f32 v76, v44, v108
    v_add_f32 v77, v45, v109
    v_add_f32 v78, v46, v110
    v_add_f32 v79, v47, v111
    v_exp_f32 v72, v72
    v_exp_f32 v73, v73
    v_exp_f32 v74, v74
    v_exp_f32 v75, v75
    v_exp_f32 v76, v76
    v_exp_f32 v77, v77
    v_exp_f32 v78, v78
    v_exp_f32 v79, v79
    v_add_f32 v72, 1.0, v72
    v_add_f32 v73, 1.0, v73
    v_add_f32 v74, 1.0, v74
    v_add_f32 v75, 1.0, v75
    v_add_f32 v76, 1.0, v76
    v_add_f32 v77, 1.0, v77
    v_add_f32 v78, 1.0, v78
    v_add_f32 v79, 1.0, v79
    v_rcp_f32 v72, v72
    v_rcp_f32 v73, v73
    v_rcp_f32 v74, v74
    v_rcp_f32 v75, v75
    v_rcp_f32 v76, v76
    v_rcp_f32 v77, v77
    v_rcp_f32 v78, v78
    v_rcp_f32 v79, v79
    s_waitcnt lgkmcnt(2)
    s_mov_b32 s36, 51200
    buffer_store_dwordx4 a[8:11], v7, s[16:19], s36 offen sc1
    s_waitcnt lgkmcnt(1)
    s_mov_b32 s36, 52224
    buffer_store_dwordx4 a[12:15], v7, s[16:19], s36 offen sc1
    v_cvt_pk_bf16_f32 v84, v72, v73
    v_cvt_pk_bf16_f32 v85, v74, v75
    v_cvt_pk_bf16_f32 v86, v76, v77
    v_cvt_pk_bf16_f32 v87, v78, v79
    ds_write_b128 v2, v[84:87] offset:17408
    v_add_f32 v64, v48, v112
    v_add_f32 v65, v49, v113
    v_add_f32 v66, v50, v114
    v_add_f32 v67, v51, v115
    v_add_f32 v68, v52, v116
    v_add_f32 v69, v53, v117
    v_add_f32 v70, v54, v118
    v_add_f32 v71, v55, v119
    v_exp_f32 v64, v64
    v_exp_f32 v65, v65
    v_exp_f32 v66, v66
    v_exp_f32 v67, v67
    v_exp_f32 v68, v68
    v_exp_f32 v69, v69
    v_exp_f32 v70, v70
    v_exp_f32 v71, v71
    v_add_f32 v64, 1.0, v64
    v_add_f32 v65, 1.0, v65
    v_add_f32 v66, 1.0, v66
    v_add_f32 v67, 1.0, v67
    v_add_f32 v68, 1.0, v68
    v_add_f32 v69, 1.0, v69
    v_add_f32 v70, 1.0, v70
    v_add_f32 v71, 1.0, v71
    v_rcp_f32 v64, v64
    v_rcp_f32 v65, v65
    v_rcp_f32 v66, v66
    v_rcp_f32 v67, v67
    v_rcp_f32 v68, v68
    v_rcp_f32 v69, v69
    v_rcp_f32 v70, v70
    v_rcp_f32 v71, v71
    s_nop 0
    v_cvt_pk_bf16_f32 v80, v64, v65
    v_cvt_pk_bf16_f32 v81, v66, v67
    v_cvt_pk_bf16_f32 v82, v68, v69
    v_cvt_pk_bf16_f32 v83, v70, v71
    ds_write_b128 v2, v[80:83] offset:18432
    v_add_f32 v72, v56, v120
    v_add_f32 v73, v57, v121
    v_add_f32 v74, v58, v122
    v_add_f32 v75, v59, v123
    v_add_f32 v76, v60, v124
    v_add_f32 v77, v61, v125
    v_add_f32 v78, v62, v126
    v_add_f32 v79, v63, v127
    v_exp_f32 v72, v72
    v_exp_f32 v73, v73
    v_exp_f32 v74, v74
    v_exp_f32 v75, v75
    v_exp_f32 v76, v76
    v_exp_f32 v77, v77
    v_exp_f32 v78, v78
    v_exp_f32 v79, v79
    v_add_f32 v72, 1.0, v72
    v_add_f32 v73, 1.0, v73
    v_add_f32 v74, 1.0, v74
    v_add_f32 v75, 1.0, v75
    v_add_f32 v76, 1.0, v76
    v_add_f32 v77, 1.0, v77
    v_add_f32 v78, 1.0, v78
    v_add_f32 v79, 1.0, v79
    v_rcp_f32 v72, v72
    v_rcp_f32 v73, v73
    v_rcp_f32 v74, v74
    v_rcp_f32 v75, v75
    v_rcp_f32 v76, v76
    v_rcp_f32 v77, v77
    v_rcp_f32 v78, v78
    v_rcp_f32 v79, v79
    s_nop 0
    v_cvt_pk_bf16_f32 v84, v72, v73
    v_cvt_pk_bf16_f32 v85, v74, v75
    v_cvt_pk_bf16_f32 v86, v76, v77
    v_cvt_pk_bf16_f32 v87, v78, v79
    ds_write_b128 v2, v[84:87] offset:19456
    s_waitcnt lgkmcnt(0)
    s_barrier
    ds_read_b128 a[0:3], v6 offset:0
    ds_read_b128 a[4:7], v6 offset:1056
    ds_read_b128 a[8:11], v6 offset:2112
    ds_read_b128 a[12:15], v6 offset:3168
    s_waitcnt lgkmcnt(3)
    s_mov_b32 s36, 65536
    buffer_store_dwordx4 a[0:3], v7, s[16:19], s36 offen sc1
    s_waitcnt lgkmcnt(2)
    s_mov_b32 s36, 66560
    buffer_store_dwordx4 a[4:7], v7, s[16:19], s36 offen sc1
    s_waitcnt lgkmcnt(1)
    s_mov_b32 s36, 67584
    buffer_store_dwordx4 a[8:11], v7, s[16:19], s36 offen sc1
    s_waitcnt lgkmcnt(0)
    s_mov_b32 s36, 68608
    buffer_store_dwordx4 a[12:15], v7, s[16:19], s36 offen sc1
    s_barrier
    ds_read_b128 a[0:3], v6 offset:16896
    ds_read_b128 a[4:7], v6 offset:17952
    ds_read_b128 a[8:11], v6 offset:19008
    ds_read_b128 a[12:15], v6 offset:20064
    s_waitcnt lgkmcnt(3)
    s_mov_b32 s36, 81920
    buffer_store_dwordx4 a[0:3], v7, s[16:19], s36 offen sc1
    s_waitcnt lgkmcnt(2)
    s_mov_b32 s36, 82944
    buffer_store_dwordx4 a[4:7], v7, s[16:19], s36 offen sc1
    s_waitcnt lgkmcnt(1)
    s_mov_b32 s36, 83968
    buffer_store_dwordx4 a[8:11], v7, s[16:19], s36 offen sc1
    s_waitcnt lgkmcnt(0)
    s_mov_b32 s36, 84992
    buffer_store_dwordx4 a[12:15], v7, s[16:19], s36 offen sc1
    s_barrier
    ds_read_b128 a[0:3], v6 offset:0
    ds_read_b128 a[4:7], v6 offset:1056
    ds_read_b128 a[8:11], v6 offset:2112
    ds_read_b128 a[12:15], v6 offset:3168
    s_waitcnt lgkmcnt(3)
    s_mov_b32 s36, 98304
    buffer_store_dwordx4 a[0:3], v7, s[16:19], s36 offen sc1
    s_waitcnt lgkmcnt(2)
    s_mov_b32 s36, 99328
    buffer_store_dwordx4 a[4:7], v7, s[16:19], s36 offen sc1
    s_waitcnt lgkmcnt(1)
    s_mov_b32 s36, 100352
    buffer_store_dwordx4 a[8:11], v7, s[16:19], s36 offen sc1
    s_waitcnt lgkmcnt(0)
    s_mov_b32 s36, 101376
    buffer_store_dwordx4 a[12:15], v7, s[16:19], s36 offen sc1
    s_barrier
    ds_read_b128 a[0:3], v6 offset:16896
    ds_read_b128 a[4:7], v6 offset:17952
    ds_read_b128 a[8:11], v6 offset:19008
    ds_read_b128 a[12:15], v6 offset:20064
    s_waitcnt lgkmcnt(3)
    s_mov_b32 s36, 114688
    buffer_store_dwordx4 a[0:3], v7, s[16:19], s36 offen sc1
    s_waitcnt lgkmcnt(2)
    s_mov_b32 s36, 115712
    buffer_store_dwordx4 a[4:7], v7, s[16:19], s36 offen sc1
    s_waitcnt lgkmcnt(1)
    s_mov_b32 s36, 116736
    buffer_store_dwordx4 a[8:11], v7, s[16:19], s36 offen sc1
    s_waitcnt lgkmcnt(0)
    s_mov_b32 s36, 117760
    buffer_store_dwordx4 a[12:15], v7, s[16:19], s36 offen sc1
    s_endpgm
L_joint_kernel_done:
    s_endpgm
.section .rodata,"a"
.p2align 6
.amdhsa_kernel prep_kernel
  .amdhsa_next_free_vgpr 128
  .amdhsa_next_free_sgpr 102
  .amdhsa_accum_offset 128
  .amdhsa_group_segment_fixed_size 0
  .amdhsa_kernarg_size 80
  .amdhsa_user_sgpr_count 2
  .amdhsa_user_sgpr_kernarg_segment_ptr 1
  .amdhsa_system_sgpr_workgroup_id_x 1
.end_amdhsa_kernel
.p2align 6
.amdhsa_kernel gemm1_kernel
  .amdhsa_next_free_vgpr 232
  .amdhsa_next_free_sgpr 102
  .amdhsa_accum_offset 232
  .amdhsa_group_segment_fixed_size 0
  .amdhsa_kernarg_size 80
  .amdhsa_user_sgpr_count 2
  .amdhsa_user_sgpr_kernarg_segment_ptr 1
  .amdhsa_system_sgpr_workgroup_id_x 1
.end_amdhsa_kernel
.p2align 6
.amdhsa_kernel mid_kernel
  .amdhsa_next_free_vgpr 128
  .amdhsa_next_free_sgpr 102
  .amdhsa_accum_offset 128
  .amdhsa_group_segment_fixed_size 0
  .amdhsa_kernarg_size 80
  .amdhsa_user_sgpr_count 2
  .amdhsa_user_sgpr_kernarg_segment_ptr 1
  .amdhsa_system_sgpr_workgroup_id_x 1
.end_amdhsa_kernel
.p2align 6
.amdhsa_kernel gemm2_kernel
  .amdhsa_next_free_vgpr 152
  .amdhsa_next_free_sgpr 102
  .amdhsa_accum_offset 152
  .amdhsa_group_segment_fixed_size 0
  .amdhsa_kernarg_size 80
  .amdhsa_user_sgpr_count 2
  .amdhsa_user_sgpr_kernarg_segment_ptr 1
  .amdhsa_system_sgpr_workgroup_id_x 1
.end_amdhsa_kernel
.p2align 6
.amdhsa_kernel joint_kernel
  .amdhsa_next_free_vgpr 256
  .amdhsa_next_free_sgpr 102
  .amdhsa_accum_offset 128
  .amdhsa_group_segment_fixed_size 0
  .amdhsa_kernarg_size 80
  .amdhsa_user_sgpr_count 2
  .amdhsa_user_sgpr_kernarg_segment_ptr 1
  .amdhsa_system_sgpr_workgroup_id_x 1
.end_amdhsa_kernel
```

```asm
; @launch kernel=prep_kernel grid=(941,1,1) block=(256,1,1) lds=40960
; @launch kernel=gemm1_kernel grid=(256,1,1) block=(512,1,1) lds=143360
; @launch kernel=mid_kernel grid=(704,1,1) block=(256,1,1) lds=53248
; @launch kernel=gemm2_kernel grid=(256,1,1) block=(512,1,1) lds=143360
; @launch kernel=joint_kernel grid=(256,1,1) block=(512,1,1) lds=149504
.amdgcn_target "amdgcn-amd-amdhsa--gfx950"
.text
.globl prep_kernel
.p2align 8
.type prep_kernel,@function
prep_kernel:
    s_cmp_ge_u32 s2, 941
    s_cbranch_scc1 L_prep_kernel_done
    v_readfirstlane_b32 s20, v0
    s_lshr_b32 s20, s20, 6
    s_cmp_lt_u32 s2, 13
    s_cbranch_scc1 L_prep_kernel_slab
    s_cmp_lt_u32 s2, 269
    s_cbranch_scc1 L_prep_kernel_g
    s_load_dwordx2 s[4:5], s[0:1], 0
    s_load_dwordx2 s[6:7], s[0:1], 72
    s_sub_u32 s24, s2, 269
    s_and_b32 s25, s24, 7
    s_mul_i32 s25, s25, 84
    s_lshr_b32 s24, s24, 3
    s_add_u32 s24, s24, s25
    s_cmp_ge_u32 s24, 668
    s_cbranch_scc1 L_prep_kernel_done
    s_mul_hi_u32 s25, s24, 25718368
    s_mul_i32 s26, s25, 167
    s_sub_u32 s26, s24, s26
    s_and_b32 s27, s25, 1
    s_lshr_b32 s25, s25, 1
    v_and_b32 v1, 63, v0
    v_lshrrev_b32 v2, 3, v1
    s_mul_i32 s28, s26, 96
    s_add_u32 s28, s28, s27
    s_sub_u32 s28, s28, 15
    v_lshlrev_b32 v3, 1, v2
    v_add_u32 v3, s28, v3
    v_lshlrev_b32 v3, 9, v3
    s_lshl_b32 s29, s20, 7
    v_add_u32 v3, s29, v3
    v_bfe_u32 v4, v2, 1, 1
    v_lshlrev_b32 v4, 1, v4
    v_and_b32 v5, 7, v1
    v_xor_b32 v4, v4, v5
    v_lshl_add_u32 v3, v4, 4, v3
    v_xor_b32 v4, 64, v3
    s_waitcnt lgkmcnt(0)
    s_mul_i32 s30, s25, 8192000
    s_add_u32 s8, s4, s30
    s_addc_u32 s9, s5, 0
    s_mov_b32 s10, 8192000
    s_mov_b32 s11, 0x00020000
    s_lshl_b32 s31, s20, 13
    s_add_u32 m0, s31, 0
    v_add_u32 v5, 0, v3
    buffer_load_dwordx4 v5, s[8:11], 0 offen nt lds
    s_add_u32 m0, s31, 1024
    v_add_u32 v5, 8192, v4
    buffer_load_dwordx4 v5, s[8:11], 0 offen nt lds
    s_add_u32 m0, s31, 2048
    v_add_u32 v5, 16384, v3
    buffer_load_dwordx4 v5, s[8:11], 0 offen nt lds
    s_add_u32 m0, s31, 3072
    v_add_u32 v5, 24576, v4
    buffer_load_dwordx4 v5, s[8:11], 0 offen nt lds
    s_add_u32 m0, s31, 4096
    v_add_u32 v5, 32768, v3
    buffer_load_dwordx4 v5, s[8:11], 0 offen nt lds
    s_add_u32 m0, s31, 5120
    v_add_u32 v5, 40960, v4
    buffer_load_dwordx4 v5, s[8:11], 0 offen nt lds
    s_add_u32 m0, s31, 6144
    v_add_u32 v5, 49152, v3
    buffer_load_dwordx4 v5, s[8:11], 0 offen nt lds
    s_add_u32 m0, s31, 7168
    v_add_u32 v5, 57344, v4
    buffer_load_dwordx4 v5, s[8:11], 0 offen nt lds
    s_add_u32 s12, s6, 0
    s_addc_u32 s13, s7, 0
    s_mov_b32 s14, 21889024
    s_mov_b32 s15, 0x00020000
    v_mov_b32 v8, v1
    s_lshl_b32 s32, s20, 4
    v_lshlrev_b32 v6, 4, v1
    s_lshl_b32 s33, s20, 11
    v_add_u32 v7, s33, v6
    v_and_b32 v9, 15, v8
    v_lshrrev_b32 v10, 4, v8
    v_or_b32 v11, 1, v9
    v_add_u32 v11, s32, v11
    v_cvt_f32_u32 v11, v11
    v_mul_f32 v11, 0x3c000000, v11
    v_lshlrev_b32 v10, 3, v10
    v_add_u32 v10, 0, v10
    v_cvt_f32_u32 v10, v10
    v_and_b32 v9, 1, v9
    v_cvt_f32_u32 v9, v9
    v_mul_f32 v9, 0x3e800000, v9
    v_fma_f32 v12, v11, v10, v9
    v_fract_f32 v13, v12
    v_add_f32 v12, v12, v11
    v_fract_f32 v14, v12
    v_add_f32 v12, v12, v11
    v_fract_f32 v15, v12
    v_add_f32 v12, v12, v11
    v_fract_f32 v16, v12
    v_add_f32 v12, v12, v11
    v_fract_f32 v17, v12
    v_add_f32 v12, v12, v11
    v_fract_f32 v18, v12
    v_add_f32 v12, v12, v11
    v_fract_f32 v19, v12
    v_add_f32 v12, v12, v11
    v_fract_f32 v20, v12
    v_cos_f32 v13, v13
    v_cos_f32 v14, v14
    v_cos_f32 v15, v15
    v_cos_f32 v16, v16
    v_cos_f32 v17, v17
    v_cos_f32 v18, v18
    v_cos_f32 v19, v19
    v_cos_f32 v20, v20
    s_nop 0
    v_cvt_pk_bf16_f32 v24, v13, v14
    v_cvt_pk_bf16_f32 v25, v15, v16
    v_cvt_pk_bf16_f32 v26, v17, v18
    v_cvt_pk_bf16_f32 v27, v19, v20
    ds_write_b128 v7, v[24:27] offset:32768
    v_and_b32 v9, 15, v8
    v_lshrrev_b32 v10, 4, v8
    v_or_b32 v11, 1, v9
    v_add_u32 v11, s32, v11
    v_cvt_f32_u32 v11, v11
    v_mul_f32 v11, 0x3c000000, v11
    v_lshlrev_b32 v10, 3, v10
    v_add_u32 v10, 32, v10
    v_cvt_f32_u32 v10, v10
    v_and_b32 v9, 1, v9
    v_cvt_f32_u32 v9, v9
    v_mul_f32 v9, 0x3e800000, v9
    v_fma_f32 v12, v11, v10, v9
    v_fract_f32 v13, v12
    v_add_f32 v12, v12, v11
    v_fract_f32 v14, v12
    v_add_f32 v12, v12, v11
    v_fract_f32 v15, v12
    v_add_f32 v12, v12, v11
    v_fract_f32 v16, v12
    v_add_f32 v12, v12, v11
    v_fract_f32 v17, v12
    v_add_f32 v12, v12, v11
    v_fract_f32 v18, v12
    v_add_f32 v12, v12, v11
    v_fract_f32 v19, v12
    v_add_f32 v12, v12, v11
    v_fract_f32 v20, v12
    v_cos_f32 v13, v13
    v_cos_f32 v14, v14
    v_cos_f32 v15, v15
    v_cos_f32 v16, v16
    v_cos_f32 v17, v17
    v_cos_f32 v18, v18
    v_cos_f32 v19, v19
    v_cos_f32 v20, v20
    s_nop 0
    v_cvt_pk_bf16_f32 v28, v13, v14
    v_cvt_pk_bf16_f32 v29, v15, v16
    v_cvt_pk_bf16_f32 v30, v17, v18
    v_cvt_pk_bf16_f32 v31, v19, v20
    ds_write_b128 v7, v[28:31] offset:33792
    v_bfe_u32 v8, v1, 2, 2
    v_lshrrev_b32 v9, 4, v1
    v_lshl_add_u32 v10, v9, 3, v8
    v_lshlrev_b32 v10, 7, v10
    v_lshrrev_b32 v8, 1, v8
    v_and_b32 v11, 1, v9
    v_lshl_add_u32 v8, v11, 1, v8
    v_lshlrev_b32 v8, 1, v8
    v_bfe_u32 v11, v1, 1, 1
    v_xor_b32 v8, v8, v11
    v_lshl_add_u32 v10, v8, 4, v10
    v_and_b32 v11, 1, v1
    v_lshl_add_u32 v10, v11, 3, v10
    v_add_u32 v10, s31, v10
    v_xor_b32 v12, 0, v10
    v_xor_b32 v13, 32, v10
    v_xor_b32 v14, 64, v10
    v_xor_b32 v15, 96, v10
    v_bfe_u32 v8, v1, 1, 3
    s_mov_b32 s33, 684032
    v_mul_lo_u32 v8, v8, s33
    v_and_b32 v11, 1, v1
    v_lshl_add_u32 v8, v11, 6, v8
    v_lshl_add_u32 v16, v9, 4, v8
    s_mul_i32 s34, s25, 167
    s_add_u32 s34, s34, s26
    s_lshl_b32 s34, s34, 11
    s_lshl_b32 s35, s27, 3
    s_lshl_b32 s36, s20, 1
    s_add_u32 s35, s35, s36
    s_lshl_b32 s35, s35, 7
    s_add_u32 s34, s34, s35
    s_waitcnt lgkmcnt(0)
    s_barrier
    ds_read_b128 v[24:27], v6 offset:32768
    ds_read_b128 v[28:31], v6 offset:33792
    ds_read_b128 v[32:35], v6 offset:34816
    ds_read_b128 v[36:39], v6 offset:35840
    ds_read_b128 v[40:43], v6 offset:36864
    ds_read_b128 v[44:47], v6 offset:37888
    ds_read_b128 v[48:51], v6 offset:38912
    ds_read_b128 v[52:55], v6 offset:39936
    s_waitcnt vmcnt(0)
    ds_read_b64_tr_b16 v[56:57], v12 offset:0
    ds_read_b64_tr_b16 v[58:59], v12 offset:512
    ds_read_b64_tr_b16 v[60:61], v12 offset:4096
    ds_read_b64_tr_b16 v[62:63], v12 offset:4608
    ds_read_b64_tr_b16 v[64:65], v13 offset:0
    ds_read_b64_tr_b16 v[66:67], v13 offset:512
    ds_read_b64_tr_b16 v[68:69], v13 offset:4096
    ds_read_b64_tr_b16 v[70:71], v13 offset:4608
    s_waitcnt lgkmcnt(0)
    v_mfma_f32_16x16x32_bf16 v[72:75], v[56:59], v[24:27], 0
    v_mfma_f32_16x16x32_bf16 v[76:79], v[56:59], v[32:35], 0
    v_mfma_f32_16x16x32_bf16 v[80:83], v[56:59], v[40:43], 0
    v_mfma_f32_16x16x32_bf16 v[84:87], v[56:59], v[48:51], 0
    v_mfma_f32_16x16x32_bf16 v[88:91], v[64:67], v[24:27], 0
    v_mfma_f32_16x16x32_bf16 v[92:95], v[64:67], v[32:35], 0
    v_mfma_f32_16x16x32_bf16 v[96:99], v[64:67], v[40:43], 0
    v_mfma_f32_16x16x32_bf16 v[100:103], v[64:67], v[48:51], 0
    v_mfma_f32_16x16x32_bf16 v[72:75], v[60:63], v[28:31], v[72:75]
    v_mfma_f32_16x16x32_bf16 v[76:79], v[60:63], v[36:39], v[76:79]
    v_mfma_f32_16x16x32_bf16 v[80:83], v[60:63], v[44:47], v[80:83]
    v_mfma_f32_16x16x32_bf16 v[84:87], v[60:63], v[52:55], v[84:87]
    v_mfma_f32_16x16x32_bf16 v[88:91], v[68:71], v[28:31], v[88:91]
    v_mfma_f32_16x16x32_bf16 v[92:95], v[68:71], v[36:39], v[92:95]
    v_mfma_f32_16x16x32_bf16 v[96:99], v[68:71], v[44:47], v[96:99]
    v_mfma_f32_16x16x32_bf16 v[100:103], v[68:71], v[52:55], v[100:103]
    s_nop 7
    v_cvt_pk_bf16_f32 v104, v72, v73
    v_cvt_pk_bf16_f32 v105, v74, v75
    v_cvt_pk_bf16_f32 v106, v88, v89
    v_cvt_pk_bf16_f32 v107, v90, v91
    s_add_u32 s35, s34, 0
    buffer_store_dwordx4 v[104:107], v16, s[12:15], s35 offen sc1
    s_nop 1
    v_cvt_pk_bf16_f32 v108, v76, v77
    v_cvt_pk_bf16_f32 v109, v78, v79
    v_cvt_pk_bf16_f32 v110, v92, v93
    v_cvt_pk_bf16_f32 v111, v94, v95
    s_add_u32 s35, s34, 5472256
    buffer_store_dwordx4 v[108:111], v16, s[12:15], s35 offen sc1
    s_nop 1
    v_cvt_pk_bf16_f32 v104, v80, v81
    v_cvt_pk_bf16_f32 v105, v82, v83
    v_cvt_pk_bf16_f32 v106, v96, v97
    v_cvt_pk_bf16_f32 v107, v98, v99
    s_add_u32 s35, s34, 10944512
    buffer_store_dwordx4 v[104:107], v16, s[12:15], s35 offen sc1
    s_nop 1
    v_cvt_pk_bf16_f32 v108, v84, v85
    v_cvt_pk_bf16_f32 v109, v86, v87
    v_cvt_pk_bf16_f32 v110, v100, v101
    v_cvt_pk_bf16_f32 v111, v102, v103
    s_add_u32 s35, s34, 16416768
    buffer_store_dwordx4 v[108:111], v16, s[12:15], s35 offen sc1
    s_nop 1
    ds_read_b64_tr_b16 v[56:57], v14 offset:0
    ds_read_b64_tr_b16 v[58:59], v14 offset:512
    ds_read_b64_tr_b16 v[60:61], v14 offset:4096
    ds_read_b64_tr_b16 v[62:63], v14 offset:4608
    ds_read_b64_tr_b16 v[64:65], v15 offset:0
    ds_read_b64_tr_b16 v[66:67], v15 offset:512
    ds_read_b64_tr_b16 v[68:69], v15 offset:4096
    ds_read_b64_tr_b16 v[70:71], v15 offset:4608
    s_waitcnt lgkmcnt(0)
    v_mfma_f32_16x16x32_bf16 v[72:75], v[56:59], v[24:27], 0
    v_mfma_f32_16x16x32_bf16 v[76:79], v[56:59], v[32:35], 0
    v_mfma_f32_16x16x32_bf16 v[80:83], v[56:59], v[40:43], 0
    v_mfma_f32_16x16x32_bf16 v[84:87], v[56:59], v[48:51], 0
    v_mfma_f32_16x16x32_bf16 v[88:91], v[64:67], v[24:27], 0
    v_mfma_f32_16x16x32_bf16 v[92:95], v[64:67], v[32:35], 0
    v_mfma_f32_16x16x32_bf16 v[96:99], v[64:67], v[40:43], 0
    v_mfma_f32_16x16x32_bf16 v[100:103], v[64:67], v[48:51], 0
    v_mfma_f32_16x16x32_bf16 v[72:75], v[60:63], v[28:31], v[72:75]
    v_mfma_f32_16x16x32_bf16 v[76:79], v[60:63], v[36:39], v[76:79]
    v_mfma_f32_16x16x32_bf16 v[80:83], v[60:63], v[44:47], v[80:83]
    v_mfma_f32_16x16x32_bf16 v[84:87], v[60:63], v[52:55], v[84:87]
    v_mfma_f32_16x16x32_bf16 v[88:91], v[68:71], v[28:31], v[88:91]
    v_mfma_f32_16x16x32_bf16 v[92:95], v[68:71], v[36:39], v[92:95]
    v_mfma_f32_16x16x32_bf16 v[96:99], v[68:71], v[44:47], v[96:99]
    v_mfma_f32_16x16x32_bf16 v[100:103], v[68:71], v[52:55], v[100:103]
    s_nop 7
    v_cvt_pk_bf16_f32 v104, v72, v73
    v_cvt_pk_bf16_f32 v105, v74, v75
    v_cvt_pk_bf16_f32 v106, v88, v89
    v_cvt_pk_bf16_f32 v107, v90, v91
    s_add_u32 s35, s34, 128
    buffer_store_dwordx4 v[104:107], v16, s[12:15], s35 offen sc1
    s_nop 1
    v_cvt_pk_bf16_f32 v108, v76, v77
    v_cvt_pk_bf16_f32 v109, v78, v79
    v_cvt_pk_bf16_f32 v110, v92, v93
    v_cvt_pk_bf16_f32 v111, v94, v95
    s_add_u32 s35, s34, 5472384
    buffer_store_dwordx4 v[108:111], v16, s[12:15], s35 offen sc1
    s_nop 1
    v_cvt_pk_bf16_f32 v104, v80, v81
    v_cvt_pk_bf16_f32 v105, v82, v83
    v_cvt_pk_bf16_f32 v106, v96, v97
    v_cvt_pk_bf16_f32 v107, v98, v99
    s_add_u32 s35, s34, 10944640
    buffer_store_dwordx4 v[104:107], v16, s[12:15], s35 offen sc1
    s_nop 1
    v_cvt_pk_bf16_f32 v108, v84, v85
    v_cvt_pk_bf16_f32 v109, v86, v87
    v_cvt_pk_bf16_f32 v110, v100, v101
    v_cvt_pk_bf16_f32 v111, v102, v103
    s_add_u32 s35, s34, 16416896
    buffer_store_dwordx4 v[108:111], v16, s[12:15], s35 offen sc1
    s_nop 1
    s_endpgm
L_prep_kernel_g:
    s_sub_u32 s3, s2, 13
    s_load_dwordx2 s[4:5], s[0:1], 8
    s_load_dwordx2 s[6:7], s[0:1], 72
    s_lshr_b32 s24, s3, 4
    s_bfe_u32 s25, s3, 0x20002
    s_and_b32 s26, s3, 3
    s_lshr_b32 s27, s24, 3
    s_and_b32 s28, s24, 7
    v_and_b32 v1, 63, v0
    v_lshrrev_b32 v2, 3, v1
    v_lshrrev_b32 v3, 2, v2
    v_lshlrev_b32 v3, 4, v3
    v_and_b32 v4, 3, v2
    v_add_u32 v3, v3, v4
    s_lshl_b32 s29, s25, 2
    s_lshl_b32 s30, s28, 5
    s_add_u32 s29, s29, s30
    v_add_u32 v3, s29, v3
    v_lshlrev_b32 v3, 9, v3
    v_and_b32 v4, 7, v1
    s_lshr_b32 s30, s20, 1
    s_lshl_b32 s30, s30, 2
    v_xor_b32 v4, s30, v4
    v_lshl_add_u32 v3, v4, 4, v3
    s_lshl_b32 s30, s26, 7
    v_add_u32 v3, s30, v3
    v_xor_b32 v4, 32, v3
    s_waitcnt lgkmcnt(0)
    s_mov_b32 s8, s4
    s_mov_b32 s9, s5
    s_mov_b32 s10, 4063232
    s_mov_b32 s11, 0x00020000
    s_add_u32 s12, s6, 21954560
    s_addc_u32 s13, s7, 0
    s_mov_b32 s14, 16916480
    s_mov_b32 s15, 0x00020000
    s_lshl_b32 s30, s20, 3
    s_add_u32 s30, s30, s27
    s_lshl_b32 s30, s30, 17
    s_mul_i32 s31, s20, 4608
    s_add_u32 m0, s31, 0
    s_add_u32 s32, s30, 0
    buffer_load_dwordx4 v3, s[8:11], s32 offen nt lds
    s_add_u32 m0, s31, 1152
    s_add_u32 s32, s30, 262144
    buffer_load_dwordx4 v3, s[8:11], s32 offen nt lds
    s_add_u32 m0, s31, 2304
    s_add_u32 s32, s30, 524288
    buffer_load_dwordx4 v4, s[8:11], s32 offen nt lds
    s_add_u32 m0, s31, 3456
    s_add_u32 s32, s30, 786432
    buffer_load_dwordx4 v4, s[8:11], s32 offen nt lds
    v_and_b32 v8, 15, v1
    v_or_b32 v9, 1, v8
    s_lshl_b32 s33, s20, 4
    v_add_u32 v9, s33, v9
    v_cvt_f32_u32 v9, v9
    v_mul_f32 v9, 0x3c000000, v9
    v_bfe_u32 v10, v1, 4, 1
    v_lshlrev_b32 v10, 3, v10
    v_cvt_f32_u32 v10, v10
    v_and_b32 v8, 1, v8
    v_cvt_f32_u32 v8, v8
    v_mul_f32 v8, 0x3f400000, v8
    v_fma_f32 v11, v9, v10, v8
    v_fract_f32 v12, v11
    v_add_f32 v11, v11, v9
    v_fract_f32 v13, v11
    v_add_f32 v11, v11, v9
    v_fract_f32 v14, v11
    v_add_f32 v11, v11, v9
    v_fract_f32 v15, v11
    v_add_f32 v11, v11, v9
    v_fract_f32 v16, v11
    v_add_f32 v11, v11, v9
    v_fract_f32 v17, v11
    v_add_f32 v11, v11, v9
    v_fract_f32 v18, v11
    v_add_f32 v11, v11, v9
    v_fract_f32 v19, v11
    v_cos_f32 v12, v12
    v_cos_f32 v13, v13
    v_cos_f32 v14, v14
    v_cos_f32 v15, v15
    v_cos_f32 v16, v16
    v_cos_f32 v17, v17
    v_cos_f32 v18, v18
    v_cos_f32 v19, v19
    s_nop 0
    v_mul_f32 v12, 0x3d000000, v12
    v_mul_f32 v13, 0x3d000000, v13
    v_mul_f32 v14, 0x3d000000, v14
    v_mul_f32 v15, 0x3d000000, v15
    v_mul_f32 v16, 0x3d000000, v16
    v_mul_f32 v17, 0x3d000000, v17
    v_mul_f32 v18, 0x3d000000, v18
    v_mul_f32 v19, 0x3d000000, v19
    v_cvt_pk_bf16_f32 v20, v12, v13
    v_cvt_pk_bf16_f32 v21, v14, v15
    v_cvt_pk_bf16_f32 v22, v16, v17
    v_cvt_pk_bf16_f32 v23, v18, v19
    v_lshlrev_b32 v28, 16, v20
    v_and_b32 v29, 0xffff0000, v20
    v_sub_f32 v28, v12, v28
    v_sub_f32 v29, v13, v29
    v_cvt_pk_bf16_f32 v24, v28, v29
    v_lshlrev_b32 v28, 16, v21
    v_and_b32 v29, 0xffff0000, v21
    v_sub_f32 v28, v14, v28
    v_sub_f32 v29, v15, v29
    v_cvt_pk_bf16_f32 v25, v28, v29
    v_lshlrev_b32 v28, 16, v22
    v_and_b32 v29, 0xffff0000, v22
    v_sub_f32 v28, v16, v28
    v_sub_f32 v29, v17, v29
    v_cvt_pk_bf16_f32 v26, v28, v29
    v_lshlrev_b32 v28, 16, v23
    v_and_b32 v29, 0xffff0000, v23
    v_sub_f32 v28, v18, v28
    v_sub_f32 v29, v19, v29
    v_cvt_pk_bf16_f32 v27, v28, v29
    v_cmp_gt_u32 vcc, 32, v1
    s_nop 1
    v_cndmask_b32 v20, v24, v20, vcc
    v_cndmask_b32 v21, v25, v21, vcc
    v_cndmask_b32 v22, v26, v22, vcc
    v_cndmask_b32 v23, v27, v23, vcc
    v_lshlrev_b32 v28, 4, v1
    s_lshl_b32 s33, s20, 10
    v_add_u32 v29, s33, v28
    ds_write_b128 v29, v[20:23] offset:18432
    v_bfe_u32 v30, v1, 2, 2
    v_bfe_u32 v31, v1, 4, 1
    v_lshl_add_u32 v32, v31, 3, v30
    v_mul_u32_u24 v32, 1152, v32
    v_lshrrev_b32 v30, 1, v30
    v_lshl_add_u32 v30, v31, 1, v30
    v_lshlrev_b32 v30, 1, v30
    v_bfe_u32 v31, v1, 1, 1
    s_lshl_b32 s33, s20, 1
    v_add_u32 v31, s33, v31
    v_xor_b32 v30, v30, v31
    v_lshl_add_u32 v32, v30, 4, v32
    v_and_b32 v30, 1, v1
    v_lshl_add_u32 v32, v30, 3, v32
    v_lshrrev_b32 v30, 4, v1
    s_mov_b32 s33, 1057280
    v_mul_lo_u32 v30, v30, s33
    v_and_b32 v31, 15, v1
    v_lshl_add_u32 v33, v31, 4, v30
    s_lshl_b32 s34, s24, 15
    s_lshl_b32 s35, s26, 2
    s_add_u32 s35, s35, s20
    s_lshl_b32 s35, s35, 11
    s_add_u32 s34, s34, s35
    s_lshl_b32 s35, s25, 8
    s_add_u32 s34, s34, s35
    s_waitcnt vmcnt(0) lgkmcnt(0)
    s_barrier
    ds_read_b128 v[36:39], v28 offset:18432
    ds_read_b128 v[40:43], v28 offset:19456
    ds_read_b128 v[44:47], v28 offset:20480
    ds_read_b128 v[48:51], v28 offset:21504
    ds_read_b64_tr_b16 v[52:53], v32 offset:0
    ds_read_b64_tr_b16 v[54:55], v32 offset:4608
    ds_read_b64_tr_b16 v[56:57], v32 offset:128
    ds_read_b64_tr_b16 v[58:59], v32 offset:4736
    ds_read_b64_tr_b16 v[60:61], v32 offset:256
    ds_read_b64_tr_b16 v[62:63], v32 offset:4864
    ds_read_b64_tr_b16 v[64:65], v32 offset:384
    ds_read_b64_tr_b16 v[66:67], v32 offset:4992
    ds_read_b64_tr_b16 v[68:69], v32 offset:512
    ds_read_b64_tr_b16 v[70:71], v32 offset:5120
    s_waitcnt lgkmcnt(8)
    ds_read_b64_tr_b16 v[72:73], v32 offset:640
    ds_read_b64_tr_b16 v[74:75], v32 offset:5248
    ds_read_b64_tr_b16 v[76:77], v32 offset:768
    ds_read_b64_tr_b16 v[78:79], v32 offset:5376
    ds_read_b64_tr_b16 v[80:81], v32 offset:896
    ds_read_b64_tr_b16 v[82:83], v32 offset:5504
    s_waitcnt lgkmcnt(0)
    v_mfma_f32_16x16x32_bf16 v[84:87], v[36:39], v[52:55], 0
    v_mfma_f32_16x16x32_bf16 v[88:91], v[36:39], v[56:59], 0
    v_mfma_f32_16x16x32_bf16 v[92:95], v[36:39], v[60:63], 0
    v_mfma_f32_16x16x32_bf16 v[96:99], v[36:39], v[64:67], 0
    v_mfma_f32_16x16x32_bf16 v[100:103], v[36:39], v[68:71], 0
    v_mfma_f32_16x16x32_bf16 v[104:107], v[36:39], v[72:75], 0
    v_mfma_f32_16x16x32_bf16 v[108:111], v[36:39], v[76:79], 0
    v_mfma_f32_16x16x32_bf16 v[112:115], v[36:39], v[80:83], 0
    s_nop 7
    v_cvt_pk_bf16_f32 v116, v84, v88
    v_cvt_pk_bf16_f32 v117, v92, v96
    v_cvt_pk_bf16_f32 v118, v100, v104
    v_cvt_pk_bf16_f32 v119, v108, v112
    s_add_u32 s35, s34, 0
    buffer_store_dwordx4 v[116:119], v33, s[12:15], s35 offen sc1
    s_nop 1
    v_cvt_pk_bf16_f32 v120, v85, v89
    v_cvt_pk_bf16_f32 v121, v93, v97
    v_cvt_pk_bf16_f32 v122, v101, v105
    v_cvt_pk_bf16_f32 v123, v109, v113
    s_add_u32 s35, s34, 1024
    buffer_store_dwordx4 v[120:123], v33, s[12:15], s35 offen sc1
    s_nop 1
    v_cvt_pk_bf16_f32 v116, v86, v90
    v_cvt_pk_bf16_f32 v117, v94, v98
    v_cvt_pk_bf16_f32 v118, v102, v106
    v_cvt_pk_bf16_f32 v119, v110, v114
    s_add_u32 s35, s34, 528640
    buffer_store_dwordx4 v[116:119], v33, s[12:15], s35 offen sc1
    s_nop 1
    v_cvt_pk_bf16_f32 v120, v87, v91
    v_cvt_pk_bf16_f32 v121, v95, v99
    v_cvt_pk_bf16_f32 v122, v103, v107
    v_cvt_pk_bf16_f32 v123, v111, v115
    s_add_u32 s35, s34, 529664
    buffer_store_dwordx4 v[120:123], v33, s[12:15], s35 offen sc1
    s_nop 1
    v_mfma_f32_16x16x32_bf16 v[84:87], v[40:43], v[52:55], 0
    v_mfma_f32_16x16x32_bf16 v[88:91], v[40:43], v[56:59], 0
    v_mfma_f32_16x16x32_bf16 v[92:95], v[40:43], v[60:63], 0
    v_mfma_f32_16x16x32_bf16 v[96:99], v[40:43], v[64:67], 0
    v_mfma_f32_16x16x32_bf16 v[100:103], v[40:43], v[68:71], 0
    v_mfma_f32_16x16x32_bf16 v[104:107], v[40:43], v[72:75], 0
    v_mfma_f32_16x16x32_bf16 v[108:111], v[40:43], v[76:79], 0
    v_mfma_f32_16x16x32_bf16 v[112:115], v[40:43], v[80:83], 0
    s_nop 7
    v_cvt_pk_bf16_f32 v116, v84, v88
    v_cvt_pk_bf16_f32 v117, v92, v96
    v_cvt_pk_bf16_f32 v118, v100, v104
    v_cvt_pk_bf16_f32 v119, v108, v112
    s_add_u32 s35, s34, 4229120
    buffer_store_dwordx4 v[116:119], v33, s[12:15], s35 offen sc1
    s_nop 1
    v_cvt_pk_bf16_f32 v120, v85, v89
    v_cvt_pk_bf16_f32 v121, v93, v97
    v_cvt_pk_bf16_f32 v122, v101, v105
    v_cvt_pk_bf16_f32 v123, v109, v113
    s_add_u32 s35, s34, 4230144
    buffer_store_dwordx4 v[120:123], v33, s[12:15], s35 offen sc1
    s_nop 1
    v_cvt_pk_bf16_f32 v116, v86, v90
    v_cvt_pk_bf16_f32 v117, v94, v98
    v_cvt_pk_bf16_f32 v118, v102, v106
    v_cvt_pk_bf16_f32 v119, v110, v114
    s_add_u32 s35, s34, 4757760
    buffer_store_dwordx4 v[116:119], v33, s[12:15], s35 offen sc1
    s_nop 1
    v_cvt_pk_bf16_f32 v120, v87, v91
    v_cvt_pk_bf16_f32 v121, v95, v99
    v_cvt_pk_bf16_f32 v122, v103, v107
    v_cvt_pk_bf16_f32 v123, v111, v115
    s_add_u32 s35, s34, 4758784
    buffer_store_dwordx4 v[120:123], v33, s[12:15], s35 offen sc1
    s_nop 1
    v_mfma_f32_16x16x32_bf16 v[84:87], v[44:47], v[52:55], 0
    v_mfma_f32_16x16x32_bf16 v[88:91], v[44:47], v[56:59], 0
    v_mfma_f32_16x16x32_bf16 v[92:95], v[44:47], v[60:63], 0
    v_mfma_f32_16x16x32_bf16 v[96:99], v[44:47], v[64:67], 0
    v_mfma_f32_16x16x32_bf16 v[100:103], v[44:47], v[68:71], 0
    v_mfma_f32_16x16x32_bf16 v[104:107], v[44:47], v[72:75], 0
    v_mfma_f32_16x16x32_bf16 v[108:111], v[44:47], v[76:79], 0
    v_mfma_f32_16x16x32_bf16 v[112:115], v[44:47], v[80:83], 0
    s_nop 7
    v_cvt_pk_bf16_f32 v116, v84, v88
    v_cvt_pk_bf16_f32 v117, v92, v96
    v_cvt_pk_bf16_f32 v118, v100, v104
    v_cvt_pk_bf16_f32 v119, v108, v112
    s_add_u32 s35, s34, 8458240
    buffer_store_dwordx4 v[116:119], v33, s[12:15], s35 offen sc1
    s_nop 1
    v_cvt_pk_bf16_f32 v120, v85, v89
    v_cvt_pk_bf16_f32 v121, v93, v97
    v_cvt_pk_bf16_f32 v122, v101, v105
    v_cvt_pk_bf16_f32 v123, v109, v113
    s_add_u32 s35, s34, 8459264
    buffer_store_dwordx4 v[120:123], v33, s[12:15], s35 offen sc1
    s_nop 1
    v_cvt_pk_bf16_f32 v116, v86, v90
    v_cvt_pk_bf16_f32 v117, v94, v98
    v_cvt_pk_bf16_f32 v118, v102, v106
    v_cvt_pk_bf16_f32 v119, v110, v114
    s_add_u32 s35, s34, 8986880
    buffer_store_dwordx4 v[116:119], v33, s[12:15], s35 offen sc1
    s_nop 1
    v_cvt_pk_bf16_f32 v120, v87, v91
    v_cvt_pk_bf16_f32 v121, v95, v99
    v_cvt_pk_bf16_f32 v122, v103, v107
    v_cvt_pk_bf16_f32 v123, v111, v115
    s_add_u32 s35, s34, 8987904
    buffer_store_dwordx4 v[120:123], v33, s[12:15], s35 offen sc1
    s_nop 1
    v_mfma_f32_16x16x32_bf16 v[84:87], v[48:51], v[52:55], 0
    v_mfma_f32_16x16x32_bf16 v[88:91], v[48:51], v[56:59], 0
    v_mfma_f32_16x16x32_bf16 v[92:95], v[48:51], v[60:63], 0
    v_mfma_f32_16x16x32_bf16 v[96:99], v[48:51], v[64:67], 0
    v_mfma_f32_16x16x32_bf16 v[100:103], v[48:51], v[68:71], 0
    v_mfma_f32_16x16x32_bf16 v[104:107], v[48:51], v[72:75], 0
    v_mfma_f32_16x16x32_bf16 v[108:111], v[48:51], v[76:79], 0
    v_mfma_f32_16x16x32_bf16 v[112:115], v[48:51], v[80:83], 0
    s_nop 7
    v_cvt_pk_bf16_f32 v116, v84, v88
    v_cvt_pk_bf16_f32 v117, v92, v96
    v_cvt_pk_bf16_f32 v118, v100, v104
    v_cvt_pk_bf16_f32 v119, v108, v112
    s_add_u32 s35, s34, 12687360
    buffer_store_dwordx4 v[116:119], v33, s[12:15], s35 offen sc1
    s_nop 1
    v_cvt_pk_bf16_f32 v120, v85, v89
    v_cvt_pk_bf16_f32 v121, v93, v97
    v_cvt_pk_bf16_f32 v122, v101, v105
    v_cvt_pk_bf16_f32 v123, v109, v113
    s_add_u32 s35, s34, 12688384
    buffer_store_dwordx4 v[120:123], v33, s[12:15], s35 offen sc1
    s_nop 1
    v_cvt_pk_bf16_f32 v116, v86, v90
    v_cvt_pk_bf16_f32 v117, v94, v98
    v_cvt_pk_bf16_f32 v118, v102, v106
    v_cvt_pk_bf16_f32 v119, v110, v114
    s_add_u32 s35, s34, 13216000
    buffer_store_dwordx4 v[116:119], v33, s[12:15], s35 offen sc1
    s_nop 1
    v_cvt_pk_bf16_f32 v120, v87, v91
    v_cvt_pk_bf16_f32 v121, v95, v99
    v_cvt_pk_bf16_f32 v122, v103, v107
    v_cvt_pk_bf16_f32 v123, v111, v115
    s_add_u32 s35, s34, 13217024
    buffer_store_dwordx4 v[120:123], v33, s[12:15], s35 offen sc1
    s_nop 1
    s_endpgm
L_prep_kernel_slab:
    s_load_dwordx2 s[6:7], s[0:1], 72
    s_cmp_eq_u32 s2, 12
    s_cbranch_scc1 L_prep_kernel_tab
    s_lshr_b32 s24, s2, 2
    s_and_b32 s26, s2, 3
    s_mov_b32 s25, 40
    s_cmp_eq_u32 s24, 1
    s_cselect_b32 s25, 32, s25
    s_cmp_eq_u32 s24, 2
    s_cselect_b32 s25, 48, s25
    s_load_dwordx2 s[4:5], s[0:1], s25
    s_load_dwordx2 s[28:29], s[0:1], 24
    v_and_b32 v1, 63, v0
    v_lshrrev_b32 v2, 3, v1
    s_lshl_b32 s27, s20, 6
    v_add_u32 v2, s27, v2
    v_lshlrev_b32 v2, 9, v2
    v_and_b32 v3, 7, v1
    v_lshl_add_u32 v2, v3, 4, v2
    s_lshl_b32 s27, s26, 7
    v_add_u32 v2, s27, v2
    s_waitcnt lgkmcnt(0)
    s_mov_b32 s8, s4
    s_mov_b32 s9, s5
    s_mov_b32 s10, 131072
    s_mov_b32 s11, 0x00020000
    s_add_u32 s12, s6, 85499904
    s_addc_u32 s13, s7, 0
    s_mov_b32 s14, 294912
    s_mov_b32 s15, 0x00020000
    s_lshl_b32 s31, s20, 13
    s_add_u32 m0, s31, 0
    s_mov_b32 s32, 0
    buffer_load_dwordx4 v2, s[8:11], s32 offen nt lds
    s_add_u32 m0, s31, 1024
    s_mov_b32 s32, 4096
    buffer_load_dwordx4 v2, s[8:11], s32 offen nt lds
    s_add_u32 m0, s31, 2048
    s_mov_b32 s32, 8192
    buffer_load_dwordx4 v2, s[8:11], s32 offen nt lds
    s_add_u32 m0, s31, 3072
    s_mov_b32 s32, 12288
    buffer_load_dwordx4 v2, s[8:11], s32 offen nt lds
    s_add_u32 m0, s31, 4096
    s_mov_b32 s32, 16384
    buffer_load_dwordx4 v2, s[8:11], s32 offen nt lds
    s_add_u32 m0, s31, 5120
    s_mov_b32 s32, 20480
    buffer_load_dwordx4 v2, s[8:11], s32 offen nt lds
    s_add_u32 m0, s31, 6144
    s_mov_b32 s32, 24576
    buffer_load_dwordx4 v2, s[8:11], s32 offen nt lds
    s_add_u32 m0, s31, 7168
    s_mov_b32 s32, 28672
    buffer_load_dwordx4 v2, s[8:11], s32 offen nt lds
    s_cmp_eq_u32 s24, 0
    s_cbranch_scc1 L_prep_kernel_ge
    v_bfe_u32 v4, v1, 2, 2
    v_lshrrev_b32 v5, 5, v1
    v_bfe_u32 v6, v1, 4, 1
    v_and_b32 v7, 3, v1
    s_cmp_eq_u32 s24, 1
    s_cbranch_scc0 L_prep_kernel_wo
    v_lshl_add_u32 v8, v5, 4, v4
    v_lshlrev_b32 v8, 7, v8
    v_lshl_add_u32 v8, v6, 5, v8
    v_lshl_add_u32 v8, v7, 3, v8
    s_lshl_b32 s33, s20, 13
    v_add_u32 v8, s33, v8
    s_mov_b32 s34, 32768
    s_lshl_b32 s35, s26, 15
    s_add_u32 s34, s34, s35
    s_lshl_b32 s35, s20, 12
    s_add_u32 s34, s34, s35
    v_lshlrev_b32 v9, 4, v1
    s_waitcnt vmcnt(0)
    s_barrier
    ds_read_b64_tr_b16 v[16:17], v8 offset:0
    ds_read_b64_tr_b16 v[18:19], v8 offset:1024
    ds_read_b64_tr_b16 v[20:21], v8 offset:512
    ds_read_b64_tr_b16 v[22:23], v8 offset:1536
    ds_read_b64_tr_b16 v[24:25], v8 offset:4096
    ds_read_b64_tr_b16 v[26:27], v8 offset:5120
    ds_read_b64_tr_b16 v[28:29], v8 offset:4608
    ds_read_b64_tr_b16 v[30:31], v8 offset:5632
    s_waitcnt lgkmcnt(0)
    s_add_u32 s35, s34, 0
    buffer_store_dwordx4 v[16:19], v9, s[12:15], s35 offen sc1
    s_add_u32 s35, s34, 1024
    buffer_store_dwordx4 v[20:23], v9, s[12:15], s35 offen sc1
    s_add_u32 s35, s34, 2048
    buffer_store_dwordx4 v[24:27], v9, s[12:15], s35 offen sc1
    s_add_u32 s35, s34, 3072
    buffer_store_dwordx4 v[28:31], v9, s[12:15], s35 offen sc1
    ds_read_b64_tr_b16 v[32:33], v8 offset:64
    ds_read_b64_tr_b16 v[34:35], v8 offset:1088
    ds_read_b64_tr_b16 v[36:37], v8 offset:576
    ds_read_b64_tr_b16 v[38:39], v8 offset:1600
    ds_read_b64_tr_b16 v[40:41], v8 offset:4160
    ds_read_b64_tr_b16 v[42:43], v8 offset:5184
    ds_read_b64_tr_b16 v[44:45], v8 offset:4672
    ds_read_b64_tr_b16 v[46:47], v8 offset:5696
    s_waitcnt lgkmcnt(0)
    s_add_u32 s35, s34, 16384
    buffer_store_dwordx4 v[32:35], v9, s[12:15], s35 offen sc1
    s_add_u32 s35, s34, 17408
    buffer_store_dwordx4 v[36:39], v9, s[12:15], s35 offen sc1
    s_add_u32 s35, s34, 18432
    buffer_store_dwordx4 v[40:43], v9, s[12:15], s35 offen sc1
    s_add_u32 s35, s34, 19456
    buffer_store_dwordx4 v[44:47], v9, s[12:15], s35 offen sc1
    s_endpgm
L_prep_kernel_wo:
    v_lshl_add_u32 v8, v5, 2, v4
    v_lshlrev_b32 v8, 7, v8
    v_lshl_add_u32 v8, v6, 5, v8
    v_and_b32 v10, 1, v7
    v_lshl_add_u32 v8, v10, 4, v8
    v_lshrrev_b32 v10, 1, v7
    v_lshl_add_u32 v8, v10, 3, v8
    s_lshl_b32 s33, s20, 13
    v_add_u32 v8, s33, v8
    s_mov_b32 s34, 163840
    s_lshl_b32 s35, s26, 15
    s_add_u32 s34, s34, s35
    s_lshl_b32 s35, s20, 12
    s_add_u32 s34, s34, s35
    v_lshlrev_b32 v9, 4, v1
    s_waitcnt vmcnt(0)
    s_barrier
    ds_read_b64_tr_b16 v[16:17], v8 offset:0
    ds_read_b64_tr_b16 v[18:19], v8 offset:1024
    ds_read_b64_tr_b16 v[20:21], v8 offset:2048
    ds_read_b64_tr_b16 v[22:23], v8 offset:3072
    ds_read_b64_tr_b16 v[24:25], v8 offset:4096
    ds_read_b64_tr_b16 v[26:27], v8 offset:5120
    ds_read_b64_tr_b16 v[28:29], v8 offset:6144
    ds_read_b64_tr_b16 v[30:31], v8 offset:7168
    s_waitcnt lgkmcnt(0)
    v_mov_b32 v48, 0x3f803f80
    v_mov_b32 v49, 0x3f803f80
    v_mov_b32 v50, 0x3f803f80
    v_mov_b32 v51, 0x3f803f80
    s_nop 1
    v_mfma_f32_32x32x16_bf16 v[64:79], v[16:19], v[48:51], 0
    v_mfma_f32_32x32x16_bf16 v[64:79], v[20:23], v[48:51], v[64:79]
    v_mfma_f32_32x32x16_bf16 v[64:79], v[24:27], v[48:51], v[64:79]
    v_mfma_f32_32x32x16_bf16 v[64:79], v[28:31], v[48:51], v[64:79]
    v_lshlrev_b32 v52, 16, v16
    v_and_b32 v53, 0xffff0000, v16
    v_mul_f32 v52, -2.0, v52
    v_mul_f32 v53, -2.0, v53
    v_cvt_pk_bf16_f32 v16, v52, v53
    v_lshlrev_b32 v52, 16, v17
    v_and_b32 v53, 0xffff0000, v17
    v_mul_f32 v52, -2.0, v52
    v_mul_f32 v53, -2.0, v53
    v_cvt_pk_bf16_f32 v17, v52, v53
    v_lshlrev_b32 v52, 16, v18
    v_and_b32 v53, 0xffff0000, v18
    v_mul_f32 v52, -2.0, v52
    v_mul_f32 v53, -2.0, v53
    v_cvt_pk_bf16_f32 v18, v52, v53
    v_lshlrev_b32 v52, 16, v19
    v_and_b32 v53, 0xffff0000, v19
    v_mul_f32 v52, -2.0, v52
    v_mul_f32 v53, -2.0, v53
    v_cvt_pk_bf16_f32 v19, v52, v53
    v_lshlrev_b32 v52, 16, v20
    v_and_b32 v53, 0xffff0000, v20
    v_mul_f32 v52, -2.0, v52
    v_mul_f32 v53, -2.0, v53
    v_cvt_pk_bf16_f32 v20, v52, v53
    v_lshlrev_b32 v52, 16, v21
    v_and_b32 v53, 0xffff0000, v21
    v_mul_f32 v52, -2.0, v52
    v_mul_f32 v53, -2.0, v53
    v_cvt_pk_bf16_f32 v21, v52, v53
    v_lshlrev_b32 v52, 16, v22
    v_and_b32 v53, 0xffff0000, v22
    v_mul_f32 v52, -2.0, v52
    v_mul_f32 v53, -2.0, v53
    v_cvt_pk_bf16_f32 v22, v52, v53
    v_lshlrev_b32 v52, 16, v23
    v_and_b32 v53, 0xffff0000, v23
    v_mul_f32 v52, -2.0, v52
    v_mul_f32 v53, -2.0, v53
    v_cvt_pk_bf16_f32 v23, v52, v53
    v_lshlrev_b32 v52, 16, v24
    v_and_b32 v53, 0xffff0000, v24
    v_mul_f32 v52, -2.0, v52
    v_mul_f32 v53, -2.0, v53
    v_cvt_pk_bf16_f32 v24, v52, v53
    v_lshlrev_b32 v52, 16, v25
    v_and_b32 v53, 0xffff0000, v25
    v_mul_f32 v52, -2.0, v52
    v_mul_f32 v53, -2.0, v53
    v_cvt_pk_bf16_f32 v25, v52, v53
    v_lshlrev_b32 v52, 16, v26
    v_and_b32 v53, 0xffff0000, v26
    v_mul_f32 v52, -2.0, v52
    v_mul_f32 v53, -2.0, v53
    v_cvt_pk_bf16_f32 v26, v52, v53
    v_lshlrev_b32 v52, 16, v27
    v_and_b32 v53, 0xffff0000, v27
    v_mul_f32 v52, -2.0, v52
    v_mul_f32 v53, -2.0, v53
    v_cvt_pk_bf16_f32 v27, v52, v53
    v_lshlrev_b32 v52, 16, v28
    v_and_b32 v53, 0xffff0000, v28
    v_mul_f32 v52, -2.0, v52
    v_mul_f32 v53, -2.0, v53
    v_cvt_pk_bf16_f32 v28, v52, v53
    v_lshlrev_b32 v52, 16, v29
    v_and_b32 v53, 0xffff0000, v29
    v_mul_f32 v52, -2.0, v52
    v_mul_f32 v53, -2.0, v53
    v_cvt_pk_bf16_f32 v29, v52, v53
    v_lshlrev_b32 v52, 16, v30
    v_and_b32 v53, 0xffff0000, v30
    v_mul_f32 v52, -2.0, v52
    v_mul_f32 v53, -2.0, v53
    v_cvt_pk_bf16_f32 v30, v52, v53
    v_lshlrev_b32 v52, 16, v31
    v_and_b32 v53, 0xffff0000, v31
    v_mul_f32 v52, -2.0, v52
    v_mul_f32 v53, -2.0, v53
    v_cvt_pk_bf16_f32 v31, v52, v53
    s_add_u32 s35, s34, 0
    buffer_store_dwordx4 v[16:19], v9, s[12:15], s35 offen sc1
    s_add_u32 s35, s34, 1024
    buffer_store_dwordx4 v[20:23], v9, s[12:15], s35 offen sc1
    s_add_u32 s35, s34, 2048
    buffer_store_dwordx4 v[24:27], v9, s[12:15], s35 offen sc1
    s_add_u32 s35, s34, 3072
    buffer_store_dwordx4 v[28:31], v9, s[12:15], s35 offen sc1
    ds_read_b64_tr_b16 v[32:33], v8 offset:64
    ds_read_b64_tr_b16 v[34:35], v8 offset:1088
    ds_read_b64_tr_b16 v[36:37], v8 offset:2112
    ds_read_b64_tr_b16 v[38:39], v8 offset:3136
    ds_read_b64_tr_b16 v[40:41], v8 offset:4160
    ds_read_b64_tr_b16 v[42:43], v8 offset:5184
    ds_read_b64_tr_b16 v[44:45], v8 offset:6208
    ds_read_b64_tr_b16 v[46:47], v8 offset:7232
    s_waitcnt lgkmcnt(0)
    v_mfma_f32_32x32x16_bf16 v[80:95], v[32:35], v[48:51], 0
    v_mfma_f32_32x32x16_bf16 v[80:95], v[36:39], v[48:51], v[80:95]
    v_mfma_f32_32x32x16_bf16 v[80:95], v[40:43], v[48:51], v[80:95]
    v_mfma_f32_32x32x16_bf16 v[80:95], v[44:47], v[48:51], v[80:95]
    v_lshlrev_b32 v52, 16, v32
    v_and_b32 v53, 0xffff0000, v32
    v_mul_f32 v52, -2.0, v52
    v_mul_f32 v53, -2.0, v53
    v_cvt_pk_bf16_f32 v32, v52, v53
    v_lshlrev_b32 v52, 16, v33
    v_and_b32 v53, 0xffff0000, v33
    v_mul_f32 v52, -2.0, v52
    v_mul_f32 v53, -2.0, v53
    v_cvt_pk_bf16_f32 v33, v52, v53
    v_lshlrev_b32 v52, 16, v34
    v_and_b32 v53, 0xffff0000, v34
    v_mul_f32 v52, -2.0, v52
    v_mul_f32 v53, -2.0, v53
    v_cvt_pk_bf16_f32 v34, v52, v53
    v_lshlrev_b32 v52, 16, v35
    v_and_b32 v53, 0xffff0000, v35
    v_mul_f32 v52, -2.0, v52
    v_mul_f32 v53, -2.0, v53
    v_cvt_pk_bf16_f32 v35, v52, v53
    v_lshlrev_b32 v52, 16, v36
    v_and_b32 v53, 0xffff0000, v36
    v_mul_f32 v52, -2.0, v52
    v_mul_f32 v53, -2.0, v53
    v_cvt_pk_bf16_f32 v36, v52, v53
    v_lshlrev_b32 v52, 16, v37
    v_and_b32 v53, 0xffff0000, v37
    v_mul_f32 v52, -2.0, v52
    v_mul_f32 v53, -2.0, v53
    v_cvt_pk_bf16_f32 v37, v52, v53
    v_lshlrev_b32 v52, 16, v38
    v_and_b32 v53, 0xffff0000, v38
    v_mul_f32 v52, -2.0, v52
    v_mul_f32 v53, -2.0, v53
    v_cvt_pk_bf16_f32 v38, v52, v53
    v_lshlrev_b32 v52, 16, v39
    v_and_b32 v53, 0xffff0000, v39
    v_mul_f32 v52, -2.0, v52
    v_mul_f32 v53, -2.0, v53
    v_cvt_pk_bf16_f32 v39, v52, v53
    v_lshlrev_b32 v52, 16, v40
    v_and_b32 v53, 0xffff0000, v40
    v_mul_f32 v52, -2.0, v52
    v_mul_f32 v53, -2.0, v53
    v_cvt_pk_bf16_f32 v40, v52, v53
    v_lshlrev_b32 v52, 16, v41
    v_and_b32 v53, 0xffff0000, v41
    v_mul_f32 v52, -2.0, v52
    v_mul_f32 v53, -2.0, v53
    v_cvt_pk_bf16_f32 v41, v52, v53
    v_lshlrev_b32 v52, 16, v42
    v_and_b32 v53, 0xffff0000, v42
    v_mul_f32 v52, -2.0, v52
    v_mul_f32 v53, -2.0, v53
    v_cvt_pk_bf16_f32 v42, v52, v53
    v_lshlrev_b32 v52, 16, v43
    v_and_b32 v53, 0xffff0000, v43
    v_mul_f32 v52, -2.0, v52
    v_mul_f32 v53, -2.0, v53
    v_cvt_pk_bf16_f32 v43, v52, v53
    v_lshlrev_b32 v52, 16, v44
    v_and_b32 v53, 0xffff0000, v44
    v_mul_f32 v52, -2.0, v52
    v_mul_f32 v53, -2.0, v53
    v_cvt_pk_bf16_f32 v44, v52, v53
    v_lshlrev_b32 v52, 16, v45
    v_and_b32 v53, 0xffff0000, v45
    v_mul_f32 v52, -2.0, v52
    v_mul_f32 v53, -2.0, v53
    v_cvt_pk_bf16_f32 v45, v52, v53
    v_lshlrev_b32 v52, 16, v46
    v_and_b32 v53, 0xffff0000, v46
    v_mul_f32 v52, -2.0, v52
    v_mul_f32 v53, -2.0, v53
    v_cvt_pk_bf16_f32 v46, v52, v53
    v_lshlrev_b32 v52, 16, v47
    v_and_b32 v53, 0xffff0000, v47
    v_mul_f32 v52, -2.0, v52
    v_mul_f32 v53, -2.0, v53
    v_cvt_pk_bf16_f32 v47, v52, v53
    s_add_u32 s35, s34, 16384
    buffer_store_dwordx4 v[32:35], v9, s[12:15], s35 offen sc1
    s_add_u32 s35, s34, 17408
    buffer_store_dwordx4 v[36:39], v9, s[12:15], s35 offen sc1
    s_add_u32 s35, s34, 18432
    buffer_store_dwordx4 v[40:43], v9, s[12:15], s35 offen sc1
    s_add_u32 s35, s34, 19456
    buffer_store_dwordx4 v[44:47], v9, s[12:15], s35 offen sc1
    s_nop 7
    s_barrier
    v_lshlrev_b32 v10, 6, v1
    s_lshl_b32 s35, s20, 13
    v_add_u32 v11, s35, v10
    ds_write_b128 v11, v[64:67] offset:0
    ds_write_b128 v11, v[68:71] offset:16
    ds_write_b128 v11, v[72:75] offset:32
    ds_write_b128 v11, v[76:79] offset:48
    ds_write_b128 v11, v[80:83] offset:4096
    ds_write_b128 v11, v[84:87] offset:4112
    ds_write_b128 v11, v[88:91] offset:4128
    ds_write_b128 v11, v[92:95] offset:4144
    s_waitcnt lgkmcnt(0)
    s_barrier
    s_cmp_ge_u32 s20, 2
    s_cbranch_scc1 L_prep_kernel_done
    s_lshl_b32 s35, s20, 12
    v_add_u32 v11, s35, v10
    ds_read_b128 v[16:19], v11 offset:0
    ds_read_b128 v[20:23], v11 offset:16
    ds_read_b128 v[24:27], v11 offset:32
    ds_read_b128 v[28:31], v11 offset:48
    ds_read_b128 v[32:35], v11 offset:8192
    ds_read_b128 v[36:39], v11 offset:8208
    ds_read_b128 v[40:43], v11 offset:8224
    ds_read_b128 v[44:47], v11 offset:8240
    s_waitcnt lgkmcnt(0)
    ds_read_b128 v[48:51], v11 offset:16384
    ds_read_b128 v[52:55], v11 offset:16400
    ds_read_b128 v[56:59], v11 offset:16416
    ds_read_b128 v[60:63], v11 offset:16432
    ds_read_b128 v[64:67], v11 offset:24576
    ds_read_b128 v[68:71], v11 offset:24592
    ds_read_b128 v[72:75], v11 offset:24608
    ds_read_b128 v[76:79], v11 offset:24624
    s_waitcnt lgkmcnt(0)
    v_add_f32 v16, v16, v32
    v_add_f32 v48, v48, v64
    v_add_f32 v17, v17, v33
    v_add_f32 v49, v49, v65
    v_add_f32 v18, v18, v34
    v_add_f32 v50, v50, v66
    v_add_f32 v19, v19, v35
    v_add_f32 v51, v51, v67
    v_add_f32 v20, v20, v36
    v_add_f32 v52, v52, v68
    v_add_f32 v21, v21, v37
    v_add_f32 v53, v53, v69
    v_add_f32 v22, v22, v38
    v_add_f32 v54, v54, v70
    v_add_f32 v23, v23, v39
    v_add_f32 v55, v55, v71
    v_add_f32 v24, v24, v40
    v_add_f32 v56, v56, v72
    v_add_f32 v25, v25, v41
    v_add_f32 v57, v57, v73
    v_add_f32 v26, v26, v42
    v_add_f32 v58, v58, v74
    v_add_f32 v27, v27, v43
    v_add_f32 v59, v59, v75
    v_add_f32 v28, v28, v44
    v_add_f32 v60, v60, v76
    v_add_f32 v29, v29, v45
    v_add_f32 v61, v61, v77
    v_add_f32 v30, v30, v46
    v_add_f32 v62, v62, v78
    v_add_f32 v31, v31, v47
    v_add_f32 v63, v63, v79
    v_add_f32 v16, v16, v48
    v_add_f32 v17, v17, v49
    v_add_f32 v18, v18, v50
    v_add_f32 v19, v19, v51
    v_add_f32 v20, v20, v52
    v_add_f32 v21, v21, v53
    v_add_f32 v22, v22, v54
    v_add_f32 v23, v23, v55
    v_add_f32 v24, v24, v56
    v_add_f32 v25, v25, v57
    v_add_f32 v26, v26, v58
    v_add_f32 v27, v27, v59
    v_add_f32 v28, v28, v60
    v_add_f32 v29, v29, v61
    v_add_f32 v30, v30, v62
    v_add_f32 v31, v31, v63
    v_and_b32 v10, 31, v1
    v_cmp_eq_u32 vcc, 0, v10
    v_lshrrev_b32 v10, 5, v1
    v_lshlrev_b32 v10, 6, v10
    s_lshl_b32 s35, s26, 8
    s_lshl_b32 s36, s20, 7
    s_add_u32 s35, s35, s36
    s_add_u32 s35, s35, 14336
    s_and_saveexec_b64 s[38:39], vcc
    buffer_store_dwordx4 v[16:19], v10, s[12:15], s35 offen offset:0 sc1
    buffer_store_dwordx4 v[20:23], v10, s[12:15], s35 offen offset:16 sc1
    buffer_store_dwordx4 v[24:27], v10, s[12:15], s35 offen offset:32 sc1
    buffer_store_dwordx4 v[28:31], v10, s[12:15], s35 offen offset:48 sc1
    s_endpgm
L_prep_kernel_ge:
    s_mov_b32 s36, s28
    s_mov_b32 s37, s29
    s_mov_b32 s38, 8192
    s_mov_b32 s39, 0x00020000
    v_and_b32 v4, 15, v1
    v_lshrrev_b32 v5, 4, v1
    v_lshlrev_b32 v6, 9, v4
    v_lshl_add_u32 v6, v5, 4, v6
    buffer_load_dwordx4 v[16:19], v6, s[36:39], 0 offen offset:0
    buffer_load_dwordx4 v[20:23], v6, s[36:39], 0 offen offset:64
    buffer_load_dwordx4 v[24:27], v6, s[36:39], 0 offen offset:128
    buffer_load_dwordx4 v[28:31], v6, s[36:39], 0 offen offset:192
    buffer_load_dwordx4 v[32:35], v6, s[36:39], 0 offen offset:256
    buffer_load_dwordx4 v[36:39], v6, s[36:39], 0 offen offset:320
    buffer_load_dwordx4 v[40:43], v6, s[36:39], 0 offen offset:384
    buffer_load_dwordx4 v[44:47], v6, s[36:39], 0 offen offset:448
    v_bfe_u32 v7, v1, 2, 2
    v_lshl_add_u32 v7, v5, 3, v7
    v_lshlrev_b32 v7, 7, v7
    v_and_b32 v8, 3, v1
    v_lshl_add_u32 v7, v8, 3, v7
    s_lshl_b32 s33, s20, 5
    v_add_u32 v7, s33, v7
    s_waitcnt vmcnt(0)
    s_barrier
    ds_read_b64_tr_b16 v[48:49], v7 offset:0
    ds_read_b64_tr_b16 v[50:51], v7 offset:512
    ds_read_b64_tr_b16 v[52:53], v7 offset:4096
    ds_read_b64_tr_b16 v[54:55], v7 offset:4608
    ds_read_b64_tr_b16 v[56:57], v7 offset:8192
    ds_read_b64_tr_b16 v[58:59], v7 offset:8704
    ds_read_b64_tr_b16 v[60:61], v7 offset:12288
    ds_read_b64_tr_b16 v[62:63], v7 offset:12800
    s_waitcnt lgkmcnt(0)
    ds_read_b64_tr_b16 v[64:65], v7 offset:16384
    ds_read_b64_tr_b16 v[66:67], v7 offset:16896
    ds_read_b64_tr_b16 v[68:69], v7 offset:20480
    ds_read_b64_tr_b16 v[70:71], v7 offset:20992
    ds_read_b64_tr_b16 v[72:73], v7 offset:24576
    ds_read_b64_tr_b16 v[74:75], v7 offset:25088
    ds_read_b64_tr_b16 v[76:77], v7 offset:28672
    ds_read_b64_tr_b16 v[78:79], v7 offset:29184
    s_waitcnt lgkmcnt(0)
    v_mfma_f32_16x16x32_bf16 v[80:83], v[48:51], v[16:19], 0
    v_mfma_f32_16x16x32_bf16 v[80:83], v[52:55], v[20:23], v[80:83]
    v_mfma_f32_16x16x32_bf16 v[80:83], v[56:59], v[24:27], v[80:83]
    v_mfma_f32_16x16x32_bf16 v[80:83], v[60:63], v[28:31], v[80:83]
    v_mfma_f32_16x16x32_bf16 v[80:83], v[64:67], v[32:35], v[80:83]
    v_mfma_f32_16x16x32_bf16 v[80:83], v[68:71], v[36:39], v[80:83]
    v_mfma_f32_16x16x32_bf16 v[80:83], v[72:75], v[40:43], v[80:83]
    v_mfma_f32_16x16x32_bf16 v[80:83], v[76:79], v[44:47], v[80:83]
    s_nop 7
    v_cvt_pk_bf16_f32 v84, v80, v81
    v_cvt_pk_bf16_f32 v85, v82, v83
    s_mov_b32 s33, 0x4038aa3b
    v_lshlrev_b32 v80, 16, v84
    v_and_b32 v81, 0xffff0000, v84
    v_lshlrev_b32 v82, 16, v85
    v_and_b32 v83, 0xffff0000, v85
    v_mul_f32 v80, s33, v80
    v_mul_f32 v81, s33, v81
    v_mul_f32 v82, s33, v82
    v_mul_f32 v83, s33, v83
    v_lshlrev_b32 v6, 10, v4
    v_lshl_add_u32 v6, v5, 4, v6
    s_lshl_b32 s33, s26, 8
    s_lshl_b32 s34, s20, 6
    s_add_u32 s33, s33, s34
    s_add_u32 s33, s33, 16384
    buffer_store_dwordx4 v[80:83], v6, s[12:15], s33 offen sc1
    s_endpgm
L_prep_kernel_tab:
    v_and_b32 v8, 63, v0
    v_lshlrev_b32 v6, 4, v8
    s_waitcnt lgkmcnt(0)
    s_add_u32 s12, s6, 85499904
    s_addc_u32 s13, s7, 0
    s_mov_b32 s14, 294912
    s_mov_b32 s15, 0x00020000
    s_lshl_b32 s32, s20, 4
    s_lshl_b32 s33, s20, 11
    v_and_b32 v9, 15, v8
    v_lshrrev_b32 v10, 4, v8
    v_or_b32 v11, 1, v9
    v_add_u32 v11, s32, v11
    v_cvt_f32_u32 v11, v11
    v_mul_f32 v11, 0x3c000000, v11
    v_lshlrev_b32 v10, 3, v10
    v_add_u32 v10, 0, v10
    v_cvt_f32_u32 v10, v10
    v_and_b32 v9, 1, v9
    v_cvt_f32_u32 v9, v9
    v_mul_f32 v9, 0x3e800000, v9
    v_fma_f32 v12, v11, v10, v9
    v_fract_f32 v13, v12
    v_add_f32 v12, v12, v11
    v_fract_f32 v14, v12
    v_add_f32 v12, v12, v11
    v_fract_f32 v15, v12
    v_add_f32 v12, v12, v11
    v_fract_f32 v16, v12
    v_add_f32 v12, v12, v11
    v_fract_f32 v17, v12
    v_add_f32 v12, v12, v11
    v_fract_f32 v18, v12
    v_add_f32 v12, v12, v11
    v_fract_f32 v19, v12
    v_add_f32 v12, v12, v11
    v_fract_f32 v20, v12
    v_cos_f32 v13, v13
    v_cos_f32 v14, v14
    v_cos_f32 v15, v15
    v_cos_f32 v16, v16
    v_cos_f32 v17, v17
    v_cos_f32 v18, v18
    v_cos_f32 v19, v19
    v_cos_f32 v20, v20
    s_nop 0
    v_cvt_pk_bf16_f32 v24, v13, v14
    v_cvt_pk_bf16_f32 v25, v15, v16
    v_cvt_pk_bf16_f32 v26, v17, v18
    v_cvt_pk_bf16_f32 v27, v19, v20
    s_add_u32 s34, s33, 0
    buffer_store_dwordx4 v[24:27], v6, s[12:15], s34 offen sc1
    v_and_b32 v9, 15, v8
    v_lshrrev_b32 v10, 4, v8
    v_or_b32 v11, 1, v9
    v_add_u32 v11, s32, v11
    v_cvt_f32_u32 v11, v11
    v_mul_f32 v11, 0x3c000000, v11
    v_lshlrev_b32 v10, 3, v10
    v_add_u32 v10, 32, v10
    v_cvt_f32_u32 v10, v10
    v_and_b32 v9, 1, v9
    v_cvt_f32_u32 v9, v9
    v_mul_f32 v9, 0x3e800000, v9
    v_fma_f32 v12, v11, v10, v9
    v_fract_f32 v13, v12
    v_add_f32 v12, v12, v11
    v_fract_f32 v14, v12
    v_add_f32 v12, v12, v11
    v_fract_f32 v15, v12
    v_add_f32 v12, v12, v11
    v_fract_f32 v16, v12
    v_add_f32 v12, v12, v11
    v_fract_f32 v17, v12
    v_add_f32 v12, v12, v11
    v_fract_f32 v18, v12
    v_add_f32 v12, v12, v11
    v_fract_f32 v19, v12
    v_add_f32 v12, v12, v11
    v_fract_f32 v20, v12
    v_cos_f32 v13, v13
    v_cos_f32 v14, v14
    v_cos_f32 v15, v15
    v_cos_f32 v16, v16
    v_cos_f32 v17, v17
    v_cos_f32 v18, v18
    v_cos_f32 v19, v19
    v_cos_f32 v20, v20
    s_nop 0
    v_cvt_pk_bf16_f32 v28, v13, v14
    v_cvt_pk_bf16_f32 v29, v15, v16
    v_cvt_pk_bf16_f32 v30, v17, v18
    v_cvt_pk_bf16_f32 v31, v19, v20
    s_add_u32 s34, s33, 1024
    buffer_store_dwordx4 v[28:31], v6, s[12:15], s34 offen sc1
    s_cmp_ge_u32 s20, 3
    s_cbranch_scc1 L_prep_kernel_done
    v_and_b32 v9, 15, v8
    v_add_u32 v9, s32, v9
    v_cvt_f32_u32 v9, v9
    v_mul_f32 v9, 0x3c000000, v9
    v_lshrrev_b32 v10, 4, v8
    v_lshlrev_b32 v10, 3, v10
    v_add_u32 v11, 1, v10
    v_cvt_f32_u32 v11, v11
    v_mul_f32 v11, v11, v9
    v_fract_f32 v12, v11
    v_add_u32 v11, 1, v10
    v_cvt_f32_u32 v11, v11
    v_mul_f32 v11, v11, v9
    v_add_f32 v11, 0x3e800000, v11
    v_fract_f32 v13, v11
    v_add_u32 v11, 3, v10
    v_cvt_f32_u32 v11, v11
    v_mul_f32 v11, v11, v9
    v_fract_f32 v14, v11
    v_add_u32 v11, 3, v10
    v_cvt_f32_u32 v11, v11
    v_mul_f32 v11, v11, v9
    v_add_f32 v11, 0x3e800000, v11
    v_fract_f32 v15, v11
    v_add_u32 v11, 5, v10
    v_cvt_f32_u32 v11, v11
    v_mul_f32 v11, v11, v9
    v_fract_f32 v16, v11
    v_add_u32 v11, 5, v10
    v_cvt_f32_u32 v11, v11
    v_mul_f32 v11, v11, v9
    v_add_f32 v11, 0x3e800000, v11
    v_fract_f32 v17, v11
    v_add_u32 v11, 7, v10
    v_cvt_f32_u32 v11, v11
    v_mul_f32 v11, v11, v9
    v_fract_f32 v18, v11
    v_add_u32 v11, 7, v10
    v_cvt_f32_u32 v11, v11
    v_mul_f32 v11, v11, v9
    v_add_f32 v11, 0x3e800000, v11
    v_fract_f32 v19, v11
    v_cos_f32 v12, v12
    v_cos_f32 v13, v13
    v_cos_f32 v14, v14
    v_cos_f32 v15, v15
    v_cos_f32 v16, v16
    v_cos_f32 v17, v17
    v_cos_f32 v18, v18
    v_cos_f32 v19, v19
    s_nop 0
    v_cvt_pk_bf16_f32 v24, v12, v13
    v_cvt_pk_bf16_f32 v25, v14, v15
    v_cvt_pk_bf16_f32 v26, v16, v17
    v_cvt_pk_bf16_f32 v27, v18, v19
    s_add_u32 s34, s33, 8192
    buffer_store_dwordx4 v[24:27], v6, s[12:15], s34 offen sc1
    s_nop 1
    v_add_u32 v11, 33, v10
    v_cvt_f32_u32 v11, v11
    v_mul_f32 v11, v11, v9
    v_fract_f32 v12, v11
    v_add_u32 v11, 33, v10
    v_cvt_f32_u32 v11, v11
    v_mul_f32 v11, v11, v9
    v_add_f32 v11, 0x3e800000, v11
    v_fract_f32 v13, v11
    v_add_u32 v11, 35, v10
    v_cvt_f32_u32 v11, v11
    v_mul_f32 v11, v11, v9
    v_fract_f32 v14, v11
    v_add_u32 v11, 35, v10
    v_cvt_f32_u32 v11, v11
    v_mul_f32 v11, v11, v9
    v_add_f32 v11, 0x3e800000, v11
    v_fract_f32 v15, v11
    v_add_u32 v11, 37, v10
    v_cvt_f32_u32 v11, v11
    v_mul_f32 v11, v11, v9
    v_fract_f32 v16, v11
    v_add_u32 v11, 37, v10
    v_cvt_f32_u32 v11, v11
    v_mul_f32 v11, v11, v9
    v_add_f32 v11, 0x3e800000, v11
    v_fract_f32 v17, v11
    v_add_u32 v11, 39, v10
    v_cvt_f32_u32 v11, v11
    v_mul_f32 v11, v11, v9
    v_fract_f32 v18, v11
    v_add_u32 v11, 39, v10
    v_cvt_f32_u32 v11, v11
    v_mul_f32 v11, v11, v9
    v_add_f32 v11, 0x3e800000, v11
    v_fract_f32 v19, v11
    v_cos_f32 v12, v12
    v_cos_f32 v13, v13
    v_cos_f32 v14, v14
    v_cos_f32 v15, v15
    v_cos_f32 v16, v16
    v_cos_f32 v17, v17
    v_cos_f32 v18, v18
    v_cos_f32 v19, v19
    s_nop 0
    v_cvt_pk_bf16_f32 v24, v12, v13
    v_cvt_pk_bf16_f32 v25, v14, v15
    v_cvt_pk_bf16_f32 v26, v16, v17
    v_cvt_pk_bf16_f32 v27, v18, v19
    s_add_u32 s34, s33, 9216
    buffer_store_dwordx4 v[24:27], v6, s[12:15], s34 offen sc1
    s_nop 1
L_prep_kernel_done:
    s_endpgm
.globl gemm1_kernel
.p2align 8
.type gemm1_kernel,@function
gemm1_kernel:
    s_cmp_ge_u32 s2, 256
    s_cbranch_scc1 L_gemm1_kernel_done
    s_load_dwordx2 s[4:5], s[0:1], 72
    s_load_dwordx2 s[6:7], s[0:1], 72
    v_readfirstlane_b32 s20, v0
    s_lshr_b32 s20, s20, 6
    s_and_b32 s24, s2, 7
    s_lshr_b32 s25, s2, 3
    s_lshr_b32 s26, s25, 3
    s_lshl_b32 s24, s24, 2
    s_add_u32 s21, s24, s26
    s_and_b32 s25, s25, 7
    s_lshr_b32 s26, s25, 1
    s_and_b32 s27, s25, 1
    s_mul_i32 s22, s26, 84
    s_sub_u32 s28, 334, s22
    s_min_u32 s28, s28, 84
    s_waitcnt lgkmcnt(0)
    s_mul_i32 s29, s21, 684032
    s_lshl_b32 s30, s22, 11
    s_add_u32 s29, s29, s30
    s_add_u32 s29, s29, 0
    s_add_u32 s8, s6, s29
    s_addc_u32 s9, s7, 0
    s_lshl_b32 s10, s28, 11
    s_mov_b32 s11, 0x00020000
    s_mul_i32 s29, s21, 528640
    s_mul_i32 s30, s27, 16384
    s_add_u32 s29, s29, s30
    s_add_u32 s29, s29, 21954560
    s_add_u32 s12, s4, s29
    s_addc_u32 s13, s5, 0
    s_mov_b32 s14, 507904
    s_mov_b32 s15, 0x00020000
    s_cmp_ge_u32 s20, 4
    s_cbranch_scc1 L_gemm1_kernel_loader
    s_mul_i32 s29, s22, 37120
    s_add_u32 s29, s29, 38871040
    s_add_u32 s16, s4, s29
    s_addc_u32 s17, s5, 0
    s_mul_i32 s18, s28, 37120
    s_mov_b32 s19, 0x00020000
    s_lshr_b32 s29, s20, 1
    s_and_b32 s30, s20, 1
    v_and_b32 v217, 15, v0
    v_bfe_u32 v218, v0, 4, 2
    v_and_b32 v219, 63, v0
    s_mul_i32 s31, s29, 6144
    v_and_b32 v220, 7, v217
    v_xor_b32 v220, v218, v220
    v_lshlrev_b32 v220, 4, v220
    v_lshl_add_u32 v220, v217, 7, v220
    v_add_u32 v220, s31, v220
    v_add_u32 v208, 0, v220
    v_xor_b32 v211, 64, v208
    v_add_u32 v209, 57344, v220
    v_xor_b32 v212, 64, v209
    v_add_u32 v210, 114688, v220
    v_xor_b32 v213, 64, v210
    s_mul_i32 s31, s30, 8192
    s_add_u32 s31, s31, 12288
    v_lshlrev_b32 v220, 4, v219
    v_add_u32 v220, s31, v220
    v_add_u32 v214, 0, v220
    v_add_u32 v215, 57344, v220
    v_add_u32 v216, 114688, v220
    v_and_b32 v224, 7, v217
    v_lshrrev_b32 v225, 3, v217
    v_mul_u32_u24 v222, 37120, v224
    v_lshl_add_u32 v222, v218, 4, v222
    s_mul_i32 s31, s29, 1781760
    v_add_u32 v222, s31, v222
    v_lshl_add_u32 v222, v225, 6, v222
    v_xor_b32 v225, 64, v222
    v_add_u32 v223, 296960, v225
    s_mul_i32 s31, s27, 4
    s_mul_i32 s29, s30, 2
    s_add_u32 s31, s31, s29
    s_mul_i32 s31, s31, 128
    s_mul_i32 s29, s21, 1024
    s_add_u32 s33, s31, s29
    s_mov_b32 s34, 0x80008000
    s_barrier
    ds_read_b128 v[96:99], v214 offset:0
    ds_read_b128 v[128:131], v208 offset:0
    ds_read_b128 v[136:139], v208 offset:2048
    ds_read_b128 v[144:147], v208 offset:4096
    ds_read_b128 v[104:107], v214 offset:2048
    ds_read_b128 v[112:115], v214 offset:4096
    ds_read_b128 v[120:123], v214 offset:6144
    ds_read_b128 v[132:135], v211 offset:0
    ds_read_b128 v[140:143], v211 offset:2048
    ds_read_b128 v[148:151], v211 offset:4096
    ds_read_b128 v[100:103], v214 offset:1024
    ds_read_b128 v[108:111], v214 offset:3072
    ds_read_b128 v[116:119], v214 offset:5120
    ds_read_b128 v[124:127], v214 offset:7168
    s_waitcnt lgkmcnt(0)
    s_barrier
    v_mfma_f32_16x16x32_bf16 v[0:3], v[96:99], v[128:131], 0
    ds_read_b128 v[152:155], v214 offset:28672
    v_mfma_f32_16x16x32_bf16 v[4:7], v[96:99], v[136:139], 0
    v_mfma_f32_16x16x32_bf16 v[8:11], v[96:99], v[144:147], 0
    ds_read_b128 v[184:187], v208 offset:28672
    v_mfma_f32_16x16x32_bf16 v[12:15], v[104:107], v[128:131], 0
    v_mfma_f32_16x16x32_bf16 v[16:19], v[104:107], v[136:139], 0
    ds_read_b128 v[192:195], v208 offset:30720
    v_mfma_f32_16x16x32_bf16 v[20:23], v[104:107], v[144:147], 0
    v_mfma_f32_16x16x32_bf16 v[24:27], v[112:115], v[128:131], 0
    ds_read_b128 v[200:203], v208 offset:32768
    v_mfma_f32_16x16x32_bf16 v[28:31], v[112:115], v[136:139], 0
    v_mfma_f32_16x16x32_bf16 v[32:35], v[112:115], v[144:147], 0
    ds_read_b128 v[160:163], v214 offset:30720
    v_mfma_f32_16x16x32_bf16 v[36:39], v[120:123], v[128:131], 0
    v_mfma_f32_16x16x32_bf16 v[40:43], v[120:123], v[136:139], 0
    ds_read_b128 v[168:171], v214 offset:32768
    v_mfma_f32_16x16x32_bf16 v[44:47], v[120:123], v[144:147], 0
    v_mfma_f32_16x16x32_bf16 v[48:51], v[96:99], v[132:135], 0
    ds_read_b128 v[176:179], v214 offset:34816
    v_mfma_f32_16x16x32_bf16 v[52:55], v[96:99], v[140:143], 0
    v_mfma_f32_16x16x32_bf16 v[56:59], v[96:99], v[148:151], 0
    ds_read_b128 v[188:191], v211 offset:28672
    v_mfma_f32_16x16x32_bf16 v[60:63], v[104:107], v[132:135], 0
    v_mfma_f32_16x16x32_bf16 v[64:67], v[104:107], v[140:143], 0
    ds_read_b128 v[196:199], v211 offset:30720
    v_mfma_f32_16x16x32_bf16 v[68:71], v[104:107], v[148:151], 0
    v_mfma_f32_16x16x32_bf16 v[72:75], v[112:115], v[132:135], 0
    ds_read_b128 v[204:207], v211 offset:32768
    v_mfma_f32_16x16x32_bf16 v[76:79], v[112:115], v[140:143], 0
    v_mfma_f32_16x16x32_bf16 v[80:83], v[112:115], v[148:151], 0
    ds_read_b128 v[156:159], v214 offset:29696
    v_mfma_f32_16x16x32_bf16 v[84:87], v[120:123], v[132:135], 0
    v_mfma_f32_16x16x32_bf16 v[88:91], v[120:123], v[140:143], 0
    ds_read_b128 v[164:167], v214 offset:31744
    v_mfma_f32_16x16x32_bf16 v[92:95], v[120:123], v[148:151], 0
    v_mfma_f32_16x16x32_bf16 v[48:51], v[100:103], v[128:131], v[48:51]
    ds_read_b128 v[172:175], v214 offset:33792
    v_xor_b32 v132, s34, v132
    v_xor_b32 v133, s34, v133
    v_mfma_f32_16x16x32_bf16 v[52:55], v[100:103], v[136:139], v[52:55]
    v_xor_b32 v134, s34, v134
    v_xor_b32 v135, s34, v135
    v_mfma_f32_16x16x32_bf16 v[56:59], v[100:103], v[144:147], v[56:59]
    ds_read_b128 v[180:183], v214 offset:35840
    v_xor_b32 v140, s34, v140
    v_xor_b32 v141, s34, v141
    v_mfma_f32_16x16x32_bf16 v[60:63], v[108:111], v[128:131], v[60:63]
    v_xor_b32 v142, s34, v142
    v_xor_b32 v143, s34, v143
    v_mfma_f32_16x16x32_bf16 v[64:67], v[108:111], v[136:139], v[64:67]
    v_xor_b32 v148, s34, v148
    v_xor_b32 v149, s34, v149
    v_mfma_f32_16x16x32_bf16 v[68:71], v[108:111], v[144:147], v[68:71]
    v_xor_b32 v150, s34, v150
    v_xor_b32 v151, s34, v151
    v_mfma_f32_16x16x32_bf16 v[72:75], v[116:119], v[128:131], v[72:75]
    v_mfma_f32_16x16x32_bf16 v[76:79], v[116:119], v[136:139], v[76:79]
    v_mfma_f32_16x16x32_bf16 v[80:83], v[116:119], v[144:147], v[80:83]
    v_mfma_f32_16x16x32_bf16 v[84:87], v[124:127], v[128:131], v[84:87]
    v_mfma_f32_16x16x32_bf16 v[88:91], v[124:127], v[136:139], v[88:91]
    v_mfma_f32_16x16x32_bf16 v[92:95], v[124:127], v[144:147], v[92:95]
    v_mfma_f32_16x16x32_bf16 v[0:3], v[100:103], v[132:135], v[0:3]
    v_mfma_f32_16x16x32_bf16 v[4:7], v[100:103], v[140:143], v[4:7]
    v_mfma_f32_16x16x32_bf16 v[8:11], v[100:103], v[148:151], v[8:11]
    v_mfma_f32_16x16x32_bf16 v[12:15], v[108:111], v[132:135], v[12:15]
    v_mfma_f32_16x16x32_bf16 v[16:19], v[108:111], v[140:143], v[16:19]
    s_waitcnt lgkmcnt(0)
    s_barrier
    v_mfma_f32_16x16x32_bf16 v[20:23], v[108:111], v[148:151], v[20:23]
    v_mfma_f32_16x16x32_bf16 v[24:27], v[116:119], v[132:135], v[24:27]
    v_mfma_f32_16x16x32_bf16 v[28:31], v[116:119], v[140:143], v[28:31]
    v_mfma_f32_16x16x32_bf16 v[32:35], v[116:119], v[148:151], v[32:35]
    v_mfma_f32_16x16x32_bf16 v[36:39], v[124:127], v[132:135], v[36:39]
    v_mfma_f32_16x16x32_bf16 v[40:43], v[124:127], v[140:143], v[40:43]
    v_mfma_f32_16x16x32_bf16 v[44:47], v[124:127], v[148:151], v[44:47]
    v_mfma_f32_16x16x32_bf16 v[0:3], v[152:155], v[184:187], v[0:3]
    ds_read_b128 v[96:99], v215 offset:0
    v_mfma_f32_16x16x32_bf16 v[4:7], v[152:155], v[192:195], v[4:7]
    v_mfma_f32_16x16x32_bf16 v[8:11], v[152:155], v[200:203], v[8:11]
    ds_read_b128 v[128:131], v209 offset:0
    v_mfma_f32_16x16x32_bf16 v[12:15], v[160:163], v[184:187], v[12:15]
    v_mfma_f32_16x16x32_bf16 v[16:19], v[160:163], v[192:195], v[16:19]
    ds_read_b128 v[136:139], v209 offset:2048
    v_mfma_f32_16x16x32_bf16 v[20:23], v[160:163], v[200:203], v[20:23]
    v_mfma_f32_16x16x32_bf16 v[24:27], v[168:171], v[184:187], v[24:27]
    ds_read_b128 v[144:147], v209 offset:4096
    v_mfma_f32_16x16x32_bf16 v[28:31], v[168:171], v[192:195], v[28:31]
    v_mfma_f32_16x16x32_bf16 v[32:35], v[168:171], v[200:203], v[32:35]
    ds_read_b128 v[104:107], v215 offset:2048
    v_mfma_f32_16x16x32_bf16 v[36:39], v[176:179], v[184:187], v[36:39]
    v_mfma_f32_16x16x32_bf16 v[40:43], v[176:179], v[192:195], v[40:43]
    ds_read_b128 v[112:115], v215 offset:4096
    v_mfma_f32_16x16x32_bf16 v[44:47], v[176:179], v[200:203], v[44:47]
    v_mfma_f32_16x16x32_bf16 v[48:51], v[152:155], v[188:191], v[48:51]
    ds_read_b128 v[120:123], v215 offset:6144
    v_mfma_f32_16x16x32_bf16 v[52:55], v[152:155], v[196:199], v[52:55]
    v_mfma_f32_16x16x32_bf16 v[56:59], v[152:155], v[204:207], v[56:59]
    ds_read_b128 v[132:135], v212 offset:0
    v_mfma_f32_16x16x32_bf16 v[60:63], v[160:163], v[188:191], v[60:63]
    v_mfma_f32_16x16x32_bf16 v[64:67], v[160:163], v[196:199], v[64:67]
    ds_read_b128 v[140:143], v212 offset:2048
    v_mfma_f32_16x16x32_bf16 v[68:71], v[160:163], v[204:207], v[68:71]
    v_mfma_f32_16x16x32_bf16 v[72:75], v[168:171], v[188:191], v[72:75]
    ds_read_b128 v[148:151], v212 offset:4096
    v_mfma_f32_16x16x32_bf16 v[76:79], v[168:171], v[196:199], v[76:79]
    v_mfma_f32_16x16x32_bf16 v[80:83], v[168:171], v[204:207], v[80:83]
    ds_read_b128 v[100:103], v215 offset:1024
    v_mfma_f32_16x16x32_bf16 v[84:87], v[176:179], v[188:191], v[84:87]
    v_mfma_f32_16x16x32_bf16 v[88:91], v[176:179], v[196:199], v[88:91]
    ds_read_b128 v[108:111], v215 offset:3072
    v_mfma_f32_16x16x32_bf16 v[92:95], v[176:179], v[204:207], v[92:95]
    v_mfma_f32_16x16x32_bf16 v[48:51], v[156:159], v[184:187], v[48:51]
    ds_read_b128 v[116:119], v215 offset:5120
    v_xor_b32 v188, s34, v188
    v_xor_b32 v189, s34, v189
    v_mfma_f32_16x16x32_bf16 v[52:55], v[156:159], v[192:195], v[52:55]
    v_xor_b32 v190, s34, v190
    v_xor_b32 v191, s34, v191
    v_mfma_f32_16x16x32_bf16 v[56:59], v[156:159], v[200:203], v[56:59]
    ds_read_b128 v[124:127], v215 offset:7168
    v_xor_b32 v196, s34, v196
    v_xor_b32 v197, s34, v197
    v_mfma_f32_16x16x32_bf16 v[60:63], v[164:167], v[184:187], v[60:63]
    v_xor_b32 v198, s34, v198
    v_xor_b32 v199, s34, v199
    v_mfma_f32_16x16x32_bf16 v[64:67], v[164:167], v[192:195], v[64:67]
    v_xor_b32 v204, s34, v204
    v_xor_b32 v205, s34, v205
    v_mfma_f32_16x16x32_bf16 v[68:71], v[164:167], v[200:203], v[68:71]
    v_xor_b32 v206, s34, v206
    v_xor_b32 v207, s34, v207
    v_mfma_f32_16x16x32_bf16 v[72:75], v[172:175], v[184:187], v[72:75]
    v_mfma_f32_16x16x32_bf16 v[76:79], v[172:175], v[192:195], v[76:79]
    v_mfma_f32_16x16x32_bf16 v[80:83], v[172:175], v[200:203], v[80:83]
    v_mfma_f32_16x16x32_bf16 v[84:87], v[180:183], v[184:187], v[84:87]
    v_mfma_f32_16x16x32_bf16 v[88:91], v[180:183], v[192:195], v[88:91]
    v_mfma_f32_16x16x32_bf16 v[92:95], v[180:183], v[200:203], v[92:95]
    v_mfma_f32_16x16x32_bf16 v[0:3], v[156:159], v[188:191], v[0:3]
    v_mfma_f32_16x16x32_bf16 v[4:7], v[156:159], v[196:199], v[4:7]
    v_mfma_f32_16x16x32_bf16 v[8:11], v[156:159], v[204:207], v[8:11]
    v_mfma_f32_16x16x32_bf16 v[12:15], v[164:167], v[188:191], v[12:15]
    v_mfma_f32_16x16x32_bf16 v[16:19], v[164:167], v[196:199], v[16:19]
    s_waitcnt lgkmcnt(0)
    s_barrier
    v_mfma_f32_16x16x32_bf16 v[20:23], v[164:167], v[204:207], v[20:23]
    v_mfma_f32_16x16x32_bf16 v[24:27], v[172:175], v[188:191], v[24:27]
    v_mfma_f32_16x16x32_bf16 v[28:31], v[172:175], v[196:199], v[28:31]
    v_mfma_f32_16x16x32_bf16 v[32:35], v[172:175], v[204:207], v[32:35]
    v_mfma_f32_16x16x32_bf16 v[36:39], v[180:183], v[188:191], v[36:39]
    v_mfma_f32_16x16x32_bf16 v[40:43], v[180:183], v[196:199], v[40:43]
    v_mfma_f32_16x16x32_bf16 v[44:47], v[180:183], v[204:207], v[44:47]
    v_mfma_f32_16x16x32_bf16 v[0:3], v[96:99], v[128:131], v[0:3]
    ds_read_b128 v[152:155], v215 offset:28672
    v_mfma_f32_16x16x32_bf16 v[4:7], v[96:99], v[136:139], v[4:7]
    v_mfma_f32_16x16x32_bf16 v[8:11], v[96:99], v[144:147], v[8:11]
    ds_read_b128 v[184:187], v209 offset:28672
    v_mfma_f32_16x16x32_bf16 v[12:15], v[104:107], v[128:131], v[12:15]
    v_mfma_f32_16x16x32_bf16 v[16:19], v[104:107], v[136:139], v[16:19]
    ds_read_b128 v[192:195], v209 offset:30720
    v_mfma_f32_16x16x32_bf16 v[20:23], v[104:107], v[144:147], v[20:23]
    v_mfma_f32_16x16x32_bf16 v[24:27], v[112:115], v[128:131], v[24:27]
    ds_read_b128 v[200:203], v209 offset:32768
    v_mfma_f32_16x16x32_bf16 v[28:31], v[112:115], v[136:139], v[28:31]
    v_mfma_f32_16x16x32_bf16 v[32:35], v[112:115], v[144:147], v[32:35]
    ds_read_b128 v[160:163], v215 offset:30720
    v_mfma_f32_16x16x32_bf16 v[36:39], v[120:123], v[128:131], v[36:39]
    v_mfma_f32_16x16x32_bf16 v[40:43], v[120:123], v[136:139], v[40:43]
    ds_read_b128 v[168:171], v215 offset:32768
    v_mfma_f32_16x16x32_bf16 v[44:47], v[120:123], v[144:147], v[44:47]
    v_mfma_f32_16x16x32_bf16 v[48:51], v[96:99], v[132:135], v[48:51]
    ds_read_b128 v[176:179], v215 offset:34816
    v_mfma_f32_16x16x32_bf16 v[52:55], v[96:99], v[140:143], v[52:55]
    v_mfma_f32_16x16x32_bf16 v[56:59], v[96:99], v[148:151], v[56:59]
    ds_read_b128 v[188:191], v212 offset:28672
    v_mfma_f32_16x16x32_bf16 v[60:63], v[104:107], v[132:135], v[60:63]
    v_mfma_f32_16x16x32_bf16 v[64:67], v[104:107], v[140:143], v[64:67]
    ds_read_b128 v[196:199], v212 offset:30720
    v_mfma_f32_16x16x32_bf16 v[68:71], v[104:107], v[148:151], v[68:71]
    v_mfma_f32_16x16x32_bf16 v[72:75], v[112:115], v[132:135], v[72:75]
    ds_read_b128 v[204:207], v212 offset:32768
    v_mfma_f32_16x16x32_bf16 v[76:79], v[112:115], v[140:143], v[76:79]
    v_mfma_f32_16x16x32_bf16 v[80:83], v[112:115], v[148:151], v[80:83]
    ds_read_b128 v[156:159], v215 offset:29696
    v_mfma_f32_16x16x32_bf16 v[84:87], v[120:123], v[132:135], v[84:87]
    v_mfma_f32_16x16x32_bf16 v[88:91], v[120:123], v[140:143], v[88:91]
    ds_read_b128 v[164:167], v215 offset:31744
    v_mfma_f32_16x16x32_bf16 v[92:95], v[120:123], v[148:151], v[92:95]
    v_mfma_f32_16x16x32_bf16 v[48:51], v[100:103], v[128:131], v[48:51]
    ds_read_b128 v[172:175], v215 offset:33792
    v_xor_b32 v132, s34, v132
    v_xor_b32 v133, s34, v133
    v_mfma_f32_16x16x32_bf16 v[52:55], v[100:103], v[136:139], v[52:55]
    v_xor_b32 v134, s34, v134
    v_xor_b32 v135, s34, v135
    v_mfma_f32_16x16x32_bf16 v[56:59], v[100:103], v[144:147], v[56:59]
    ds_read_b128 v[180:183], v215 offset:35840
    v_xor_b32 v140, s34, v140
    v_xor_b32 v141, s34, v141
    v_mfma_f32_16x16x32_bf16 v[60:63], v[108:111], v[128:131], v[60:63]
    v_xor_b32 v142, s34, v142
    v_xor_b32 v143, s34, v143
    v_mfma_f32_16x16x32_bf16 v[64:67], v[108:111], v[136:139], v[64:67]
    v_xor_b32 v148, s34, v148
    v_xor_b32 v149, s34, v149
    v_mfma_f32_16x16x32_bf16 v[68:71], v[108:111], v[144:147], v[68:71]
    v_xor_b32 v150, s34, v150
    v_xor_b32 v151, s34, v151
    v_mfma_f32_16x16x32_bf16 v[72:75], v[116:119], v[128:131], v[72:75]
    v_mfma_f32_16x16x32_bf16 v[76:79], v[116:119], v[136:139], v[76:79]
    v_mfma_f32_16x16x32_bf16 v[80:83], v[116:119], v[144:147], v[80:83]
    v_mfma_f32_16x16x32_bf16 v[84:87], v[124:127], v[128:131], v[84:87]
    v_mfma_f32_16x16x32_bf16 v[88:91], v[124:127], v[136:139], v[88:91]
    v_mfma_f32_16x16x32_bf16 v[92:95], v[124:127], v[144:147], v[92:95]
    v_mfma_f32_16x16x32_bf16 v[0:3], v[100:103], v[132:135], v[0:3]
    v_mfma_f32_16x16x32_bf16 v[4:7], v[100:103], v[140:143], v[4:7]
    v_mfma_f32_16x16x32_bf16 v[8:11], v[100:103], v[148:151], v[8:11]
    v_mfma_f32_16x16x32_bf16 v[12:15], v[108:111], v[132:135], v[12:15]
    v_mfma_f32_16x16x32_bf16 v[16:19], v[108:111], v[140:143], v[16:19]
    s_waitcnt lgkmcnt(0)
    s_barrier
    v_mfma_f32_16x16x32_bf16 v[20:23], v[108:111], v[148:151], v[20:23]
    v_mfma_f32_16x16x32_bf16 v[24:27], v[116:119], v[132:135], v[24:27]
    v_mfma_f32_16x16x32_bf16 v[28:31], v[116:119], v[140:143], v[28:31]
    v_mfma_f32_16x16x32_bf16 v[32:35], v[116:119], v[148:151], v[32:35]
    v_mfma_f32_16x16x32_bf16 v[36:39], v[124:127], v[132:135], v[36:39]
    v_mfma_f32_16x16x32_bf16 v[40:43], v[124:127], v[140:143], v[40:43]
    v_mfma_f32_16x16x32_bf16 v[44:47], v[124:127], v[148:151], v[44:47]
    v_mfma_f32_16x16x32_bf16 v[0:3], v[152:155], v[184:187], v[0:3]
    ds_read_b128 v[96:99], v216 offset:0
    v_mfma_f32_16x16x32_bf16 v[4:7], v[152:155], v[192:195], v[4:7]
    v_mfma_f32_16x16x32_bf16 v[8:11], v[152:155], v[200:203], v[8:11]
    ds_read_b128 v[128:131], v210 offset:0
    v_mfma_f32_16x16x32_bf16 v[12:15], v[160:163], v[184:187], v[12:15]
    v_mfma_f32_16x16x32_bf16 v[16:19], v[160:163], v[192:195], v[16:19]
    ds_read_b128 v[136:139], v210 offset:2048
    v_mfma_f32_16x16x32_bf16 v[20:23], v[160:163], v[200:203], v[20:23]
    v_mfma_f32_16x16x32_bf16 v[24:27], v[168:171], v[184:187], v[24:27]
    ds_read_b128 v[144:147], v210 offset:4096
    v_mfma_f32_16x16x32_bf16 v[28:31], v[168:171], v[192:195], v[28:31]
    v_mfma_f32_16x16x32_bf16 v[32:35], v[168:171], v[200:203], v[32:35]
    ds_read_b128 v[104:107], v216 offset:2048
    v_mfma_f32_16x16x32_bf16 v[36:39], v[176:179], v[184:187], v[36:39]
    v_mfma_f32_16x16x32_bf16 v[40:43], v[176:179], v[192:195], v[40:43]
    ds_read_b128 v[112:115], v216 offset:4096
    v_mfma_f32_16x16x32_bf16 v[44:47], v[176:179], v[200:203], v[44:47]
    v_mfma_f32_16x16x32_bf16 v[48:51], v[152:155], v[188:191], v[48:51]
    ds_read_b128 v[120:123], v216 offset:6144
    v_mfma_f32_16x16x32_bf16 v[52:55], v[152:155], v[196:199], v[52:55]
    v_mfma_f32_16x16x32_bf16 v[56:59], v[152:155], v[204:207], v[56:59]
    ds_read_b128 v[132:135], v213 offset:0
    v_mfma_f32_16x16x32_bf16 v[60:63], v[160:163], v[188:191], v[60:63]
    v_mfma_f32_16x16x32_bf16 v[64:67], v[160:163], v[196:199], v[64:67]
    ds_read_b128 v[140:143], v213 offset:2048
    v_mfma_f32_16x16x32_bf16 v[68:71], v[160:163], v[204:207], v[68:71]
    v_mfma_f32_16x16x32_bf16 v[72:75], v[168:171], v[188:191], v[72:75]
    ds_read_b128 v[148:151], v213 offset:4096
    v_mfma_f32_16x16x32_bf16 v[76:79], v[168:171], v[196:199], v[76:79]
    v_mfma_f32_16x16x32_bf16 v[80:83], v[168:171], v[204:207], v[80:83]
    ds_read_b128 v[100:103], v216 offset:1024
    v_mfma_f32_16x16x32_bf16 v[84:87], v[176:179], v[188:191], v[84:87]
    v_mfma_f32_16x16x32_bf16 v[88:91], v[176:179], v[196:199], v[88:91]
    ds_read_b128 v[108:111], v216 offset:3072
    v_mfma_f32_16x16x32_bf16 v[92:95], v[176:179], v[204:207], v[92:95]
    v_mfma_f32_16x16x32_bf16 v[48:51], v[156:159], v[184:187], v[48:51]
    ds_read_b128 v[116:119], v216 offset:5120
    v_xor_b32 v188, s34, v188
    v_xor_b32 v189, s34, v189
    v_mfma_f32_16x16x32_bf16 v[52:55], v[156:159], v[192:195], v[52:55]
    v_xor_b32 v190, s34, v190
    v_xor_b32 v191, s34, v191
    v_mfma_f32_16x16x32_bf16 v[56:59], v[156:159], v[200:203], v[56:59]
    ds_read_b128 v[124:127], v216 offset:7168
    v_xor_b32 v196, s34, v196
    v_xor_b32 v197, s34, v197
    v_mfma_f32_16x16x32_bf16 v[60:63], v[164:167], v[184:187], v[60:63]
    v_xor_b32 v198, s34, v198
    v_xor_b32 v199, s34, v199
    v_mfma_f32_16x16x32_bf16 v[64:67], v[164:167], v[192:195], v[64:67]
    v_xor_b32 v204, s34, v204
    v_xor_b32 v205, s34, v205
    v_mfma_f32_16x16x32_bf16 v[68:71], v[164:167], v[200:203], v[68:71]
    v_xor_b32 v206, s34, v206
    v_xor_b32 v207, s34, v207
    v_mfma_f32_16x16x32_bf16 v[72:75], v[172:175], v[184:187], v[72:75]
    v_mfma_f32_16x16x32_bf16 v[76:79], v[172:175], v[192:195], v[76:79]
    v_mfma_f32_16x16x32_bf16 v[80:83], v[172:175], v[200:203], v[80:83]
    v_mfma_f32_16x16x32_bf16 v[84:87], v[180:183], v[184:187], v[84:87]
    v_mfma_f32_16x16x32_bf16 v[88:91], v[180:183], v[192:195], v[88:91]
    v_mfma_f32_16x16x32_bf16 v[92:95], v[180:183], v[200:203], v[92:95]
    v_mfma_f32_16x16x32_bf16 v[0:3], v[156:159], v[188:191], v[0:3]
    v_mfma_f32_16x16x32_bf16 v[4:7], v[156:159], v[196:199], v[4:7]
    v_mfma_f32_16x16x32_bf16 v[8:11], v[156:159], v[204:207], v[8:11]
    v_mfma_f32_16x16x32_bf16 v[12:15], v[164:167], v[188:191], v[12:15]
    v_mfma_f32_16x16x32_bf16 v[16:19], v[164:167], v[196:199], v[16:19]
    s_waitcnt lgkmcnt(0)
    s_barrier
    v_mfma_f32_16x16x32_bf16 v[20:23], v[164:167], v[204:207], v[20:23]
    v_mfma_f32_16x16x32_bf16 v[24:27], v[172:175], v[188:191], v[24:27]
    v_mfma_f32_16x16x32_bf16 v[28:31], v[172:175], v[196:199], v[28:31]
    v_mfma_f32_16x16x32_bf16 v[32:35], v[172:175], v[204:207], v[32:35]
    v_mfma_f32_16x16x32_bf16 v[36:39], v[180:183], v[188:191], v[36:39]
    v_mfma_f32_16x16x32_bf16 v[40:43], v[180:183], v[196:199], v[40:43]
    v_mfma_f32_16x16x32_bf16 v[44:47], v[180:183], v[204:207], v[44:47]
    v_mfma_f32_16x16x32_bf16 v[0:3], v[96:99], v[128:131], v[0:3]
    ds_read_b128 v[152:155], v214 offset:0
    v_mfma_f32_16x16x32_bf16 v[4:7], v[96:99], v[136:139], v[4:7]
    v_mfma_f32_16x16x32_bf16 v[8:11], v[96:99], v[144:147], v[8:11]
    ds_read_b128 v[184:187], v208 offset:0
    v_mfma_f32_16x16x32_bf16 v[12:15], v[104:107], v[128:131], v[12:15]
    v_mfma_f32_16x16x32_bf16 v[16:19], v[104:107], v[136:139], v[16:19]
    ds_read_b128 v[192:195], v208 offset:2048
    v_mfma_f32_16x16x32_bf16 v[20:23], v[104:107], v[144:147], v[20:23]
    v_mfma_f32_16x16x32_bf16 v[24:27], v[112:115], v[128:131], v[24:27]
    ds_read_b128 v[200:203], v208 offset:4096
    v_mfma_f32_16x16x32_bf16 v[28:31], v[112:115], v[136:139], v[28:31]
    v_mfma_f32_16x16x32_bf16 v[32:35], v[112:115], v[144:147], v[32:35]
    ds_read_b128 v[160:163], v214 offset:2048
    v_mfma_f32_16x16x32_bf16 v[36:39], v[120:123], v[128:131], v[36:39]
    v_mfma_f32_16x16x32_bf16 v[40:43], v[120:123], v[136:139], v[40:43]
    ds_read_b128 v[168:171], v214 offset:4096
    v_mfma_f32_16x16x32_bf16 v[44:47], v[120:123], v[144:147], v[44:47]
    v_mfma_f32_16x16x32_bf16 v[48:51], v[96:99], v[132:135], v[48:51]
    ds_read_b128 v[176:179], v214 offset:6144
    v_mfma_f32_16x16x32_bf16 v[52:55], v[96:99], v[140:143], v[52:55]
    v_mfma_f32_16x16x32_bf16 v[56:59], v[96:99], v[148:151], v[56:59]
    ds_read_b128 v[188:191], v211 offset:0
    v_mfma_f32_16x16x32_bf16 v[60:63], v[104:107], v[132:135], v[60:63]
    v_mfma_f32_16x16x32_bf16 v[64:67], v[104:107], v[140:143], v[64:67]
    ds_read_b128 v[196:199], v211 offset:2048
    v_mfma_f32_16x16x32_bf16 v[68:71], v[104:107], v[148:151], v[68:71]
    v_mfma_f32_16x16x32_bf16 v[72:75], v[112:115], v[132:135], v[72:75]
    ds_read_b128 v[204:207], v211 offset:4096
    v_mfma_f32_16x16x32_bf16 v[76:79], v[112:115], v[140:143], v[76:79]
    v_mfma_f32_16x16x32_bf16 v[80:83], v[112:115], v[148:151], v[80:83]
    ds_read_b128 v[156:159], v214 offset:1024
    v_mfma_f32_16x16x32_bf16 v[84:87], v[120:123], v[132:135], v[84:87]
    v_mfma_f32_16x16x32_bf16 v[88:91], v[120:123], v[140:143], v[88:91]
    ds_read_b128 v[164:167], v214 offset:3072
    v_mfma_f32_16x16x32_bf16 v[92:95], v[120:123], v[148:151], v[92:95]
    v_mfma_f32_16x16x32_bf16 v[48:51], v[100:103], v[128:131], v[48:51]
    ds_read_b128 v[172:175], v214 offset:5120
    v_xor_b32 v132, s34, v132
    v_xor_b32 v133, s34, v133
    v_mfma_f32_16x16x32_bf16 v[52:55], v[100:103], v[136:139], v[52:55]
    v_xor_b32 v134, s34, v134
    v_xor_b32 v135, s34, v135
    v_mfma_f32_16x16x32_bf16 v[56:59], v[100:103], v[144:147], v[56:59]
    ds_read_b128 v[180:183], v214 offset:7168
    v_xor_b32 v140, s34, v140
    v_xor_b32 v141, s34, v141
    v_mfma_f32_16x16x32_bf16 v[60:63], v[108:111], v[128:131], v[60:63]
    v_xor_b32 v142, s34, v142
    v_xor_b32 v143, s34, v143
    v_mfma_f32_16x16x32_bf16 v[64:67], v[108:111], v[136:139], v[64:67]
    v_xor_b32 v148, s34, v148
    v_xor_b32 v149, s34, v149
    v_mfma_f32_16x16x32_bf16 v[68:71], v[108:111], v[144:147], v[68:71]
    v_xor_b32 v150, s34, v150
    v_xor_b32 v151, s34, v151
    v_mfma_f32_16x16x32_bf16 v[72:75], v[116:119], v[128:131], v[72:75]
    v_mfma_f32_16x16x32_bf16 v[76:79], v[116:119], v[136:139], v[76:79]
    v_mfma_f32_16x16x32_bf16 v[80:83], v[116:119], v[144:147], v[80:83]
    v_mfma_f32_16x16x32_bf16 v[84:87], v[124:127], v[128:131], v[84:87]
    v_mfma_f32_16x16x32_bf16 v[88:91], v[124:127], v[136:139], v[88:91]
    v_mfma_f32_16x16x32_bf16 v[92:95], v[124:127], v[144:147], v[92:95]
    v_mfma_f32_16x16x32_bf16 v[0:3], v[100:103], v[132:135], v[0:3]
    v_mfma_f32_16x16x32_bf16 v[4:7], v[100:103], v[140:143], v[4:7]
    v_mfma_f32_16x16x32_bf16 v[8:11], v[100:103], v[148:151], v[8:11]
    v_mfma_f32_16x16x32_bf16 v[12:15], v[108:111], v[132:135], v[12:15]
    v_mfma_f32_16x16x32_bf16 v[16:19], v[108:111], v[140:143], v[16:19]
    s_waitcnt lgkmcnt(0)
    s_barrier
    v_mfma_f32_16x16x32_bf16 v[20:23], v[108:111], v[148:151], v[20:23]
    v_mfma_f32_16x16x32_bf16 v[24:27], v[116:119], v[132:135], v[24:27]
    v_mfma_f32_16x16x32_bf16 v[28:31], v[116:119], v[140:143], v[28:31]
    v_mfma_f32_16x16x32_bf16 v[32:35], v[116:119], v[148:151], v[32:35]
    v_mfma_f32_16x16x32_bf16 v[36:39], v[124:127], v[132:135], v[36:39]
    v_mfma_f32_16x16x32_bf16 v[40:43], v[124:127], v[140:143], v[40:43]
    v_mfma_f32_16x16x32_bf16 v[44:47], v[124:127], v[148:151], v[44:47]
    v_mfma_f32_16x16x32_bf16 v[0:3], v[152:155], v[184:187], v[0:3]
    ds_read_b128 v[96:99], v214 offset:28672
    v_mfma_f32_16x16x32_bf16 v[4:7], v[152:155], v[192:195], v[4:7]
    v_mfma_f32_16x16x32_bf16 v[8:11], v[152:155], v[200:203], v[8:11]
    ds_read_b128 v[128:131], v208 offset:28672
    v_mfma_f32_16x16x32_bf16 v[12:15], v[160:163], v[184:187], v[12:15]
    v_mfma_f32_16x16x32_bf16 v[16:19], v[160:163], v[192:195], v[16:19]
    ds_read_b128 v[136:139], v208 offset:30720
    v_mfma_f32_16x16x32_bf16 v[20:23], v[160:163], v[200:203], v[20:23]
    v_mfma_f32_16x16x32_bf16 v[24:27], v[168:171], v[184:187], v[24:27]
    ds_read_b128 v[144:147], v208 offset:32768
    v_mfma_f32_16x16x32_bf16 v[28:31], v[168:171], v[192:195], v[28:31]
    v_mfma_f32_16x16x32_bf16 v[32:35], v[168:171], v[200:203], v[32:35]
    ds_read_b128 v[104:107], v214 offset:30720
    v_mfma_f32_16x16x32_bf16 v[36:39], v[176:179], v[184:187], v[36:39]
    v_mfma_f32_16x16x32_bf16 v[40:43], v[176:179], v[192:195], v[40:43]
    ds_read_b128 v[112:115], v214 offset:32768
    v_mfma_f32_16x16x32_bf16 v[44:47], v[176:179], v[200:203], v[44:47]
    v_mfma_f32_16x16x32_bf16 v[48:51], v[152:155], v[188:191], v[48:51]
    ds_read_b128 v[120:123], v214 offset:34816
    v_mfma_f32_16x16x32_bf16 v[52:55], v[152:155], v[196:199], v[52:55]
    v_mfma_f32_16x16x32_bf16 v[56:59], v[152:155], v[204:207], v[56:59]
    ds_read_b128 v[132:135], v211 offset:28672
    v_mfma_f32_16x16x32_bf16 v[60:63], v[160:163], v[188:191], v[60:63]
    v_mfma_f32_16x16x32_bf16 v[64:67], v[160:163], v[196:199], v[64:67]
    ds_read_b128 v[140:143], v211 offset:30720
    v_mfma_f32_16x16x32_bf16 v[68:71], v[160:163], v[204:207], v[68:71]
    v_mfma_f32_16x16x32_bf16 v[72:75], v[168:171], v[188:191], v[72:75]
    ds_read_b128 v[148:151], v211 offset:32768
    v_mfma_f32_16x16x32_bf16 v[76:79], v[168:171], v[196:199], v[76:79]
    v_mfma_f32_16x16x32_bf16 v[80:83], v[168:171], v[204:207], v[80:83]
    ds_read_b128 v[100:103], v214 offset:29696
    v_mfma_f32_16x16x32_bf16 v[84:87], v[176:179], v[188:191], v[84:87]
    v_mfma_f32_16x16x32_bf16 v[88:91], v[176:179], v[196:199], v[88:91]
    ds_read_b128 v[108:111], v214 offset:31744
    v_mfma_f32_16x16x32_bf16 v[92:95], v[176:179], v[204:207], v[92:95]
    v_mfma_f32_16x16x32_bf16 v[48:51], v[156:159], v[184:187], v[48:51]
    ds_read_b128 v[116:119], v214 offset:33792
    v_xor_b32 v188, s34, v188
    v_xor_b32 v189, s34, v189
    v_mfma_f32_16x16x32_bf16 v[52:55], v[156:159], v[192:195], v[52:55]
    v_xor_b32 v190, s34, v190
    v_xor_b32 v191, s34, v191
    v_mfma_f32_16x16x32_bf16 v[56:59], v[156:159], v[200:203], v[56:59]
    ds_read_b128 v[124:127], v214 offset:35840
    v_xor_b32 v196, s34, v196
    v_xor_b32 v197, s34, v197
    v_mfma_f32_16x16x32_bf16 v[60:63], v[164:167], v[184:187], v[60:63]
    v_xor_b32 v198, s34, v198
    v_xor_b32 v199, s34, v199
    v_mfma_f32_16x16x32_bf16 v[64:67], v[164:167], v[192:195], v[64:67]
    v_xor_b32 v204, s34, v204
    v_xor_b32 v205, s34, v205
    v_mfma_f32_16x16x32_bf16 v[68:71], v[164:167], v[200:203], v[68:71]
    v_xor_b32 v206, s34, v206
    v_xor_b32 v207, s34, v207
    v_mfma_f32_16x16x32_bf16 v[72:75], v[172:175], v[184:187], v[72:75]
    v_mfma_f32_16x16x32_bf16 v[76:79], v[172:175], v[192:195], v[76:79]
    v_mfma_f32_16x16x32_bf16 v[80:83], v[172:175], v[200:203], v[80:83]
    v_mfma_f32_16x16x32_bf16 v[84:87], v[180:183], v[184:187], v[84:87]
    v_mfma_f32_16x16x32_bf16 v[88:91], v[180:183], v[192:195], v[88:91]
    v_mfma_f32_16x16x32_bf16 v[92:95], v[180:183], v[200:203], v[92:95]
    v_mfma_f32_16x16x32_bf16 v[0:3], v[156:159], v[188:191], v[0:3]
    v_mfma_f32_16x16x32_bf16 v[4:7], v[156:159], v[196:199], v[4:7]
    v_mfma_f32_16x16x32_bf16 v[8:11], v[156:159], v[204:207], v[8:11]
    v_mfma_f32_16x16x32_bf16 v[12:15], v[164:167], v[188:191], v[12:15]
    v_mfma_f32_16x16x32_bf16 v[16:19], v[164:167], v[196:199], v[16:19]
    s_waitcnt lgkmcnt(0)
    s_barrier
    v_mfma_f32_16x16x32_bf16 v[20:23], v[164:167], v[204:207], v[20:23]
    v_mfma_f32_16x16x32_bf16 v[24:27], v[172:175], v[188:191], v[24:27]
    v_mfma_f32_16x16x32_bf16 v[28:31], v[172:175], v[196:199], v[28:31]
    v_mfma_f32_16x16x32_bf16 v[32:35], v[172:175], v[204:207], v[32:35]
    v_mfma_f32_16x16x32_bf16 v[36:39], v[180:183], v[188:191], v[36:39]
    v_mfma_f32_16x16x32_bf16 v[40:43], v[180:183], v[196:199], v[40:43]
    v_mfma_f32_16x16x32_bf16 v[44:47], v[180:183], v[204:207], v[44:47]
    v_mfma_f32_16x16x32_bf16 v[0:3], v[96:99], v[128:131], v[0:3]
    ds_read_b128 v[152:155], v215 offset:0
    v_mfma_f32_16x16x32_bf16 v[4:7], v[96:99], v[136:139], v[4:7]
    v_mfma_f32_16x16x32_bf16 v[8:11], v[96:99], v[144:147], v[8:11]
    ds_read_b128 v[184:187], v209 offset:0
    v_mfma_f32_16x16x32_bf16 v[12:15], v[104:107], v[128:131], v[12:15]
    v_mfma_f32_16x16x32_bf16 v[16:19], v[104:107], v[136:139], v[16:19]
    ds_read_b128 v[192:195], v209 offset:2048
    v_mfma_f32_16x16x32_bf16 v[20:23], v[104:107], v[144:147], v[20:23]
    v_mfma_f32_16x16x32_bf16 v[24:27], v[112:115], v[128:131], v[24:27]
    ds_read_b128 v[200:203], v209 offset:4096
    v_mfma_f32_16x16x32_bf16 v[28:31], v[112:115], v[136:139], v[28:31]
    v_mfma_f32_16x16x32_bf16 v[32:35], v[112:115], v[144:147], v[32:35]
    ds_read_b128 v[160:163], v215 offset:2048
    v_mfma_f32_16x16x32_bf16 v[36:39], v[120:123], v[128:131], v[36:39]
    v_mfma_f32_16x16x32_bf16 v[40:43], v[120:123], v[136:139], v[40:43]
    ds_read_b128 v[168:171], v215 offset:4096
    v_mfma_f32_16x16x32_bf16 v[44:47], v[120:123], v[144:147], v[44:47]
    v_mfma_f32_16x16x32_bf16 v[48:51], v[96:99], v[132:135], v[48:51]
    ds_read_b128 v[176:179], v215 offset:6144
    v_mfma_f32_16x16x32_bf16 v[52:55], v[96:99], v[140:143], v[52:55]
    v_mfma_f32_16x16x32_bf16 v[56:59], v[96:99], v[148:151], v[56:59]
    ds_read_b128 v[188:191], v212 offset:0
    v_mfma_f32_16x16x32_bf16 v[60:63], v[104:107], v[132:135], v[60:63]
    v_mfma_f32_16x16x32_bf16 v[64:67], v[104:107], v[140:143], v[64:67]
    ds_read_b128 v[196:199], v212 offset:2048
    v_mfma_f32_16x16x32_bf16 v[68:71], v[104:107], v[148:151], v[68:71]
    v_mfma_f32_16x16x32_bf16 v[72:75], v[112:115], v[132:135], v[72:75]
    ds_read_b128 v[204:207], v212 offset:4096
    v_mfma_f32_16x16x32_bf16 v[76:79], v[112:115], v[140:143], v[76:79]
    v_mfma_f32_16x16x32_bf16 v[80:83], v[112:115], v[148:151], v[80:83]
    ds_read_b128 v[156:159], v215 offset:1024
    v_mfma_f32_16x16x32_bf16 v[84:87], v[120:123], v[132:135], v[84:87]
    v_mfma_f32_16x16x32_bf16 v[88:91], v[120:123], v[140:143], v[88:91]
    ds_read_b128 v[164:167], v215 offset:3072
    v_mfma_f32_16x16x32_bf16 v[92:95], v[120:123], v[148:151], v[92:95]
    v_mfma_f32_16x16x32_bf16 v[48:51], v[100:103], v[128:131], v[48:51]
    ds_read_b128 v[172:175], v215 offset:5120
    v_xor_b32 v132, s34, v132
    v_xor_b32 v133, s34, v133
    v_mfma_f32_16x16x32_bf16 v[52:55], v[100:103], v[136:139], v[52:55]
    v_xor_b32 v134, s34, v134
    v_xor_b32 v135, s34, v135
    v_mfma_f32_16x16x32_bf16 v[56:59], v[100:103], v[144:147], v[56:59]
    ds_read_b128 v[180:183], v215 offset:7168
    v_xor_b32 v140, s34, v140
    v_xor_b32 v141, s34, v141
    v_mfma_f32_16x16x32_bf16 v[60:63], v[108:111], v[128:131], v[60:63]
    v_xor_b32 v142, s34, v142
    v_xor_b32 v143, s34, v143
    v_mfma_f32_16x16x32_bf16 v[64:67], v[108:111], v[136:139], v[64:67]
    v_xor_b32 v148, s34, v148
    v_xor_b32 v149, s34, v149
    v_mfma_f32_16x16x32_bf16 v[68:71], v[108:111], v[144:147], v[68:71]
    v_xor_b32 v150, s34, v150
    v_xor_b32 v151, s34, v151
    v_mfma_f32_16x16x32_bf16 v[72:75], v[116:119], v[128:131], v[72:75]
    v_mfma_f32_16x16x32_bf16 v[76:79], v[116:119], v[136:139], v[76:79]
    v_mfma_f32_16x16x32_bf16 v[80:83], v[116:119], v[144:147], v[80:83]
    v_mfma_f32_16x16x32_bf16 v[84:87], v[124:127], v[128:131], v[84:87]
    v_mfma_f32_16x16x32_bf16 v[88:91], v[124:127], v[136:139], v[88:91]
    v_mfma_f32_16x16x32_bf16 v[92:95], v[124:127], v[144:147], v[92:95]
    v_mfma_f32_16x16x32_bf16 v[0:3], v[100:103], v[132:135], v[0:3]
    v_mfma_f32_16x16x32_bf16 v[4:7], v[100:103], v[140:143], v[4:7]
    v_mfma_f32_16x16x32_bf16 v[8:11], v[100:103], v[148:151], v[8:11]
    v_mfma_f32_16x16x32_bf16 v[12:15], v[108:111], v[132:135], v[12:15]
    v_mfma_f32_16x16x32_bf16 v[16:19], v[108:111], v[140:143], v[16:19]
    s_waitcnt lgkmcnt(0)
    s_barrier
    v_mfma_f32_16x16x32_bf16 v[20:23], v[108:111], v[148:151], v[20:23]
    v_mfma_f32_16x16x32_bf16 v[24:27], v[116:119], v[132:135], v[24:27]
    v_mfma_f32_16x16x32_bf16 v[28:31], v[116:119], v[140:143], v[28:31]
    v_mfma_f32_16x16x32_bf16 v[32:35], v[116:119], v[148:151], v[32:35]
    v_mfma_f32_16x16x32_bf16 v[36:39], v[124:127], v[132:135], v[36:39]
    v_mfma_f32_16x16x32_bf16 v[40:43], v[124:127], v[140:143], v[40:43]
    v_mfma_f32_16x16x32_bf16 v[44:47], v[124:127], v[148:151], v[44:47]
    v_mfma_f32_16x16x32_bf16 v[0:3], v[152:155], v[184:187], v[0:3]
    ds_read_b128 v[96:99], v215 offset:28672
    v_mfma_f32_16x16x32_bf16 v[4:7], v[152:155], v[192:195], v[4:7]
    v_mfma_f32_16x16x32_bf16 v[8:11], v[152:155], v[200:203], v[8:11]
    ds_read_b128 v[128:131], v209 offset:28672
    v_mfma_f32_16x16x32_bf16 v[12:15], v[160:163], v[184:187], v[12:15]
    v_mfma_f32_16x16x32_bf16 v[16:19], v[160:163], v[192:195], v[16:19]
    ds_read_b128 v[136:139], v209 offset:30720
    v_mfma_f32_16x16x32_bf16 v[20:23], v[160:163], v[200:203], v[20:23]
    v_mfma_f32_16x16x32_bf16 v[24:27], v[168:171], v[184:187], v[24:27]
    ds_read_b128 v[144:147], v209 offset:32768
    v_mfma_f32_16x16x32_bf16 v[28:31], v[168:171], v[192:195], v[28:31]
    v_mfma_f32_16x16x32_bf16 v[32:35], v[168:171], v[200:203], v[32:35]
    ds_read_b128 v[104:107], v215 offset:30720
    v_mfma_f32_16x16x32_bf16 v[36:39], v[176:179], v[184:187], v[36:39]
    v_mfma_f32_16x16x32_bf16 v[40:43], v[176:179], v[192:195], v[40:43]
    ds_read_b128 v[112:115], v215 offset:32768
    v_mfma_f32_16x16x32_bf16 v[44:47], v[176:179], v[200:203], v[44:47]
    v_mfma_f32_16x16x32_bf16 v[48:51], v[152:155], v[188:191], v[48:51]
    ds_read_b128 v[120:123], v215 offset:34816
    v_mfma_f32_16x16x32_bf16 v[52:55], v[152:155], v[196:199], v[52:55]
    v_mfma_f32_16x16x32_bf16 v[56:59], v[152:155], v[204:207], v[56:59]
    ds_read_b128 v[132:135], v212 offset:28672
    v_mfma_f32_16x16x32_bf16 v[60:63], v[160:163], v[188:191], v[60:63]
    v_mfma_f32_16x16x32_bf16 v[64:67], v[160:163], v[196:199], v[64:67]
    ds_read_b128 v[140:143], v212 offset:30720
    v_mfma_f32_16x16x32_bf16 v[68:71], v[160:163], v[204:207], v[68:71]
    v_mfma_f32_16x16x32_bf16 v[72:75], v[168:171], v[188:191], v[72:75]
    ds_read_b128 v[148:151], v212 offset:32768
    v_mfma_f32_16x16x32_bf16 v[76:79], v[168:171], v[196:199], v[76:79]
    v_mfma_f32_16x16x32_bf16 v[80:83], v[168:171], v[204:207], v[80:83]
    ds_read_b128 v[100:103], v215 offset:29696
    v_mfma_f32_16x16x32_bf16 v[84:87], v[176:179], v[188:191], v[84:87]
    v_mfma_f32_16x16x32_bf16 v[88:91], v[176:179], v[196:199], v[88:91]
    ds_read_b128 v[108:111], v215 offset:31744
    v_mfma_f32_16x16x32_bf16 v[92:95], v[176:179], v[204:207], v[92:95]
    v_mfma_f32_16x16x32_bf16 v[48:51], v[156:159], v[184:187], v[48:51]
    ds_read_b128 v[116:119], v215 offset:33792
    v_xor_b32 v188, s34, v188
    v_xor_b32 v189, s34, v189
    v_mfma_f32_16x16x32_bf16 v[52:55], v[156:159], v[192:195], v[52:55]
    v_xor_b32 v190, s34, v190
    v_xor_b32 v191, s34, v191
    v_mfma_f32_16x16x32_bf16 v[56:59], v[156:159], v[200:203], v[56:59]
    ds_read_b128 v[124:127], v215 offset:35840
    v_xor_b32 v196, s34, v196
    v_xor_b32 v197, s34, v197
    v_mfma_f32_16x16x32_bf16 v[60:63], v[164:167], v[184:187], v[60:63]
    v_xor_b32 v198, s34, v198
    v_xor_b32 v199, s34, v199
    v_mfma_f32_16x16x32_bf16 v[64:67], v[164:167], v[192:195], v[64:67]
    v_xor_b32 v204, s34, v204
    v_xor_b32 v205, s34, v205
    v_mfma_f32_16x16x32_bf16 v[68:71], v[164:167], v[200:203], v[68:71]
    v_xor_b32 v206, s34, v206
    v_xor_b32 v207, s34, v207
    v_mfma_f32_16x16x32_bf16 v[72:75], v[172:175], v[184:187], v[72:75]
    v_mfma_f32_16x16x32_bf16 v[76:79], v[172:175], v[192:195], v[76:79]
    v_mfma_f32_16x16x32_bf16 v[80:83], v[172:175], v[200:203], v[80:83]
    v_mfma_f32_16x16x32_bf16 v[84:87], v[180:183], v[184:187], v[84:87]
    v_mfma_f32_16x16x32_bf16 v[88:91], v[180:183], v[192:195], v[88:91]
    v_mfma_f32_16x16x32_bf16 v[92:95], v[180:183], v[200:203], v[92:95]
    v_mfma_f32_16x16x32_bf16 v[0:3], v[156:159], v[188:191], v[0:3]
    v_mfma_f32_16x16x32_bf16 v[4:7], v[156:159], v[196:199], v[4:7]
    v_mfma_f32_16x16x32_bf16 v[8:11], v[156:159], v[204:207], v[8:11]
    v_mfma_f32_16x16x32_bf16 v[12:15], v[164:167], v[188:191], v[12:15]
    v_mfma_f32_16x16x32_bf16 v[16:19], v[164:167], v[196:199], v[16:19]
    s_waitcnt lgkmcnt(0)
    s_barrier
    v_mfma_f32_16x16x32_bf16 v[20:23], v[164:167], v[204:207], v[20:23]
    v_mfma_f32_16x16x32_bf16 v[24:27], v[172:175], v[188:191], v[24:27]
    v_mfma_f32_16x16x32_bf16 v[28:31], v[172:175], v[196:199], v[28:31]
    v_mfma_f32_16x16x32_bf16 v[32:35], v[172:175], v[204:207], v[32:35]
    v_mfma_f32_16x16x32_bf16 v[36:39], v[180:183], v[188:191], v[36:39]
    v_mfma_f32_16x16x32_bf16 v[40:43], v[180:183], v[196:199], v[40:43]
    v_mfma_f32_16x16x32_bf16 v[44:47], v[180:183], v[204:207], v[44:47]
    v_mfma_f32_16x16x32_bf16 v[0:3], v[96:99], v[128:131], v[0:3]
    ds_read_b128 v[152:155], v216 offset:0
    v_mfma_f32_16x16x32_bf16 v[4:7], v[96:99], v[136:139], v[4:7]
    v_mfma_f32_16x16x32_bf16 v[8:11], v[96:99], v[144:147], v[8:11]
    ds_read_b128 v[184:187], v210 offset:0
    v_mfma_f32_16x16x32_bf16 v[12:15], v[104:107], v[128:131], v[12:15]
    v_mfma_f32_16x16x32_bf16 v[16:19], v[104:107], v[136:139], v[16:19]
    ds_read_b128 v[192:195], v210 offset:2048
    v_mfma_f32_16x16x32_bf16 v[20:23], v[104:107], v[144:147], v[20:23]
    v_mfma_f32_16x16x32_bf16 v[24:27], v[112:115], v[128:131], v[24:27]
    ds_read_b128 v[200:203], v210 offset:4096
    v_mfma_f32_16x16x32_bf16 v[28:31], v[112:115], v[136:139], v[28:31]
    v_mfma_f32_16x16x32_bf16 v[32:35], v[112:115], v[144:147], v[32:35]
    ds_read_b128 v[160:163], v216 offset:2048
    v_mfma_f32_16x16x32_bf16 v[36:39], v[120:123], v[128:131], v[36:39]
    v_mfma_f32_16x16x32_bf16 v[40:43], v[120:123], v[136:139], v[40:43]
    ds_read_b128 v[168:171], v216 offset:4096
    v_mfma_f32_16x16x32_bf16 v[44:47], v[120:123], v[144:147], v[44:47]
    v_mfma_f32_16x16x32_bf16 v[48:51], v[96:99], v[132:135], v[48:51]
    ds_read_b128 v[176:179], v216 offset:6144
    v_mfma_f32_16x16x32_bf16 v[52:55], v[96:99], v[140:143], v[52:55]
    v_mfma_f32_16x16x32_bf16 v[56:59], v[96:99], v[148:151], v[56:59]
    ds_read_b128 v[188:191], v213 offset:0
    v_mfma_f32_16x16x32_bf16 v[60:63], v[104:107], v[132:135], v[60:63]
    v_mfma_f32_16x16x32_bf16 v[64:67], v[104:107], v[140:143], v[64:67]
    ds_read_b128 v[196:199], v213 offset:2048
    v_mfma_f32_16x16x32_bf16 v[68:71], v[104:107], v[148:151], v[68:71]
    v_mfma_f32_16x16x32_bf16 v[72:75], v[112:115], v[132:135], v[72:75]
    ds_read_b128 v[204:207], v213 offset:4096
    v_mfma_f32_16x16x32_bf16 v[76:79], v[112:115], v[140:143], v[76:79]
    v_mfma_f32_16x16x32_bf16 v[80:83], v[112:115], v[148:151], v[80:83]
    ds_read_b128 v[156:159], v216 offset:1024
    v_mfma_f32_16x16x32_bf16 v[84:87], v[120:123], v[132:135], v[84:87]
    v_mfma_f32_16x16x32_bf16 v[88:91], v[120:123], v[140:143], v[88:91]
    ds_read_b128 v[164:167], v216 offset:3072
    v_mfma_f32_16x16x32_bf16 v[92:95], v[120:123], v[148:151], v[92:95]
    v_mfma_f32_16x16x32_bf16 v[48:51], v[100:103], v[128:131], v[48:51]
    ds_read_b128 v[172:175], v216 offset:5120
    v_xor_b32 v132, s34, v132
    v_xor_b32 v133, s34, v133
    v_mfma_f32_16x16x32_bf16 v[52:55], v[100:103], v[136:139], v[52:55]
    v_xor_b32 v134, s34, v134
    v_xor_b32 v135, s34, v135
    v_mfma_f32_16x16x32_bf16 v[56:59], v[100:103], v[144:147], v[56:59]
    ds_read_b128 v[180:183], v216 offset:7168
    v_xor_b32 v140, s34, v140
    v_xor_b32 v141, s34, v141
    v_mfma_f32_16x16x32_bf16 v[60:63], v[108:111], v[128:131], v[60:63]
    v_xor_b32 v142, s34, v142
    v_xor_b32 v143, s34, v143
    v_mfma_f32_16x16x32_bf16 v[64:67], v[108:111], v[136:139], v[64:67]
    v_xor_b32 v148, s34, v148
    v_xor_b32 v149, s34, v149
    v_mfma_f32_16x16x32_bf16 v[68:71], v[108:111], v[144:147], v[68:71]
    v_xor_b32 v150, s34, v150
    v_xor_b32 v151, s34, v151
    v_mfma_f32_16x16x32_bf16 v[72:75], v[116:119], v[128:131], v[72:75]
    v_mfma_f32_16x16x32_bf16 v[76:79], v[116:119], v[136:139], v[76:79]
    v_mfma_f32_16x16x32_bf16 v[80:83], v[116:119], v[144:147], v[80:83]
    v_mfma_f32_16x16x32_bf16 v[84:87], v[124:127], v[128:131], v[84:87]
    v_mfma_f32_16x16x32_bf16 v[88:91], v[124:127], v[136:139], v[88:91]
    v_mfma_f32_16x16x32_bf16 v[92:95], v[124:127], v[144:147], v[92:95]
    v_mfma_f32_16x16x32_bf16 v[0:3], v[100:103], v[132:135], v[0:3]
    v_mfma_f32_16x16x32_bf16 v[4:7], v[100:103], v[140:143], v[4:7]
    v_mfma_f32_16x16x32_bf16 v[8:11], v[100:103], v[148:151], v[8:11]
    v_mfma_f32_16x16x32_bf16 v[12:15], v[108:111], v[132:135], v[12:15]
    v_mfma_f32_16x16x32_bf16 v[16:19], v[108:111], v[140:143], v[16:19]
    s_waitcnt lgkmcnt(0)
    s_barrier
    v_mfma_f32_16x16x32_bf16 v[20:23], v[108:111], v[148:151], v[20:23]
    v_mfma_f32_16x16x32_bf16 v[24:27], v[116:119], v[132:135], v[24:27]
    v_mfma_f32_16x16x32_bf16 v[28:31], v[116:119], v[140:143], v[28:31]
    v_mfma_f32_16x16x32_bf16 v[32:35], v[116:119], v[148:151], v[32:35]
    v_mfma_f32_16x16x32_bf16 v[36:39], v[124:127], v[132:135], v[36:39]
    v_mfma_f32_16x16x32_bf16 v[40:43], v[124:127], v[140:143], v[40:43]
    v_mfma_f32_16x16x32_bf16 v[44:47], v[124:127], v[148:151], v[44:47]
    v_mfma_f32_16x16x32_bf16 v[0:3], v[152:155], v[184:187], v[0:3]
    ds_read_b128 v[96:99], v214 offset:0
    v_mfma_f32_16x16x32_bf16 v[4:7], v[152:155], v[192:195], v[4:7]
    v_mfma_f32_16x16x32_bf16 v[8:11], v[152:155], v[200:203], v[8:11]
    ds_read_b128 v[128:131], v208 offset:0
    v_mfma_f32_16x16x32_bf16 v[12:15], v[160:163], v[184:187], v[12:15]
    v_mfma_f32_16x16x32_bf16 v[16:19], v[160:163], v[192:195], v[16:19]
    ds_read_b128 v[136:139], v208 offset:2048
    v_mfma_f32_16x16x32_bf16 v[20:23], v[160:163], v[200:203], v[20:23]
    v_mfma_f32_16x16x32_bf16 v[24:27], v[168:171], v[184:187], v[24:27]
    ds_read_b128 v[144:147], v208 offset:4096
    v_mfma_f32_16x16x32_bf16 v[28:31], v[168:171], v[192:195], v[28:31]
    v_mfma_f32_16x16x32_bf16 v[32:35], v[168:171], v[200:203], v[32:35]
    ds_read_b128 v[104:107], v214 offset:2048
    v_mfma_f32_16x16x32_bf16 v[36:39], v[176:179], v[184:187], v[36:39]
    v_mfma_f32_16x16x32_bf16 v[40:43], v[176:179], v[192:195], v[40:43]
    ds_read_b128 v[112:115], v214 offset:4096
    v_mfma_f32_16x16x32_bf16 v[44:47], v[176:179], v[200:203], v[44:47]
    v_mfma_f32_16x16x32_bf16 v[48:51], v[152:155], v[188:191], v[48:51]
    ds_read_b128 v[120:123], v214 offset:6144
    v_mfma_f32_16x16x32_bf16 v[52:55], v[152:155], v[196:199], v[52:55]
    v_mfma_f32_16x16x32_bf16 v[56:59], v[152:155], v[204:207], v[56:59]
    ds_read_b128 v[132:135], v211 offset:0
    v_mfma_f32_16x16x32_bf16 v[60:63], v[160:163], v[188:191], v[60:63]
    v_mfma_f32_16x16x32_bf16 v[64:67], v[160:163], v[196:199], v[64:67]
    ds_read_b128 v[140:143], v211 offset:2048
    v_mfma_f32_16x16x32_bf16 v[68:71], v[160:163], v[204:207], v[68:71]
    v_mfma_f32_16x16x32_bf16 v[72:75], v[168:171], v[188:191], v[72:75]
    ds_read_b128 v[148:151], v211 offset:4096
    v_mfma_f32_16x16x32_bf16 v[76:79], v[168:171], v[196:199], v[76:79]
    v_mfma_f32_16x16x32_bf16 v[80:83], v[168:171], v[204:207], v[80:83]
    ds_read_b128 v[100:103], v214 offset:1024
    v_mfma_f32_16x16x32_bf16 v[84:87], v[176:179], v[188:191], v[84:87]
    v_mfma_f32_16x16x32_bf16 v[88:91], v[176:179], v[196:199], v[88:91]
    ds_read_b128 v[108:111], v214 offset:3072
    v_mfma_f32_16x16x32_bf16 v[92:95], v[176:179], v[204:207], v[92:95]
    v_mfma_f32_16x16x32_bf16 v[48:51], v[156:159], v[184:187], v[48:51]
    ds_read_b128 v[116:119], v214 offset:5120
    v_xor_b32 v188, s34, v188
    v_xor_b32 v189, s34, v189
    v_mfma_f32_16x16x32_bf16 v[52:55], v[156:159], v[192:195], v[52:55]
    v_xor_b32 v190, s34, v190
    v_xor_b32 v191, s34, v191
    v_mfma_f32_16x16x32_bf16 v[56:59], v[156:159], v[200:203], v[56:59]
    ds_read_b128 v[124:127], v214 offset:7168
    v_xor_b32 v196, s34, v196
    v_xor_b32 v197, s34, v197
    v_mfma_f32_16x16x32_bf16 v[60:63], v[164:167], v[184:187], v[60:63]
    v_xor_b32 v198, s34, v198
    v_xor_b32 v199, s34, v199
    v_mfma_f32_16x16x32_bf16 v[64:67], v[164:167], v[192:195], v[64:67]
    v_xor_b32 v204, s34, v204
    v_xor_b32 v205, s34, v205
    v_mfma_f32_16x16x32_bf16 v[68:71], v[164:167], v[200:203], v[68:71]
    v_xor_b32 v206, s34, v206
    v_xor_b32 v207, s34, v207
    v_mfma_f32_16x16x32_bf16 v[72:75], v[172:175], v[184:187], v[72:75]
    v_mfma_f32_16x16x32_bf16 v[76:79], v[172:175], v[192:195], v[76:79]
    v_mfma_f32_16x16x32_bf16 v[80:83], v[172:175], v[200:203], v[80:83]
    v_mfma_f32_16x16x32_bf16 v[84:87], v[180:183], v[184:187], v[84:87]
    v_mfma_f32_16x16x32_bf16 v[88:91], v[180:183], v[192:195], v[88:91]
    v_mfma_f32_16x16x32_bf16 v[92:95], v[180:183], v[200:203], v[92:95]
    v_mfma_f32_16x16x32_bf16 v[0:3], v[156:159], v[188:191], v[0:3]
    v_mfma_f32_16x16x32_bf16 v[4:7], v[156:159], v[196:199], v[4:7]
    v_mfma_f32_16x16x32_bf16 v[8:11], v[156:159], v[204:207], v[8:11]
    v_mfma_f32_16x16x32_bf16 v[12:15], v[164:167], v[188:191], v[12:15]
    v_mfma_f32_16x16x32_bf16 v[16:19], v[164:167], v[196:199], v[16:19]
    s_waitcnt lgkmcnt(0)
    s_barrier
    v_mfma_f32_16x16x32_bf16 v[20:23], v[164:167], v[204:207], v[20:23]
    v_mfma_f32_16x16x32_bf16 v[24:27], v[172:175], v[188:191], v[24:27]
    v_mfma_f32_16x16x32_bf16 v[28:31], v[172:175], v[196:199], v[28:31]
    v_mfma_f32_16x16x32_bf16 v[32:35], v[172:175], v[204:207], v[32:35]
    v_mfma_f32_16x16x32_bf16 v[36:39], v[180:183], v[188:191], v[36:39]
    v_mfma_f32_16x16x32_bf16 v[40:43], v[180:183], v[196:199], v[40:43]
    v_mfma_f32_16x16x32_bf16 v[44:47], v[180:183], v[204:207], v[44:47]
    v_mfma_f32_16x16x32_bf16 v[0:3], v[96:99], v[128:131], v[0:3]
    ds_read_b128 v[152:155], v214 offset:28672
    v_mfma_f32_16x16x32_bf16 v[4:7], v[96:99], v[136:139], v[4:7]
    v_mfma_f32_16x16x32_bf16 v[8:11], v[96:99], v[144:147], v[8:11]
    ds_read_b128 v[184:187], v208 offset:28672
    v_mfma_f32_16x16x32_bf16 v[12:15], v[104:107], v[128:131], v[12:15]
    v_mfma_f32_16x16x32_bf16 v[16:19], v[104:107], v[136:139], v[16:19]
    ds_read_b128 v[192:195], v208 offset:30720
    v_mfma_f32_16x16x32_bf16 v[20:23], v[104:107], v[144:147], v[20:23]
    v_mfma_f32_16x16x32_bf16 v[24:27], v[112:115], v[128:131], v[24:27]
    ds_read_b128 v[200:203], v208 offset:32768
    v_mfma_f32_16x16x32_bf16 v[28:31], v[112:115], v[136:139], v[28:31]
    v_mfma_f32_16x16x32_bf16 v[32:35], v[112:115], v[144:147], v[32:35]
    ds_read_b128 v[160:163], v214 offset:30720
    v_mfma_f32_16x16x32_bf16 v[36:39], v[120:123], v[128:131], v[36:39]
    v_mfma_f32_16x16x32_bf16 v[40:43], v[120:123], v[136:139], v[40:43]
    ds_read_b128 v[168:171], v214 offset:32768
    v_mfma_f32_16x16x32_bf16 v[44:47], v[120:123], v[144:147], v[44:47]
    v_mfma_f32_16x16x32_bf16 v[48:51], v[96:99], v[132:135], v[48:51]
    ds_read_b128 v[176:179], v214 offset:34816
    v_mfma_f32_16x16x32_bf16 v[52:55], v[96:99], v[140:143], v[52:55]
    v_mfma_f32_16x16x32_bf16 v[56:59], v[96:99], v[148:151], v[56:59]
    ds_read_b128 v[188:191], v211 offset:28672
    v_mfma_f32_16x16x32_bf16 v[60:63], v[104:107], v[132:135], v[60:63]
    v_mfma_f32_16x16x32_bf16 v[64:67], v[104:107], v[140:143], v[64:67]
    ds_read_b128 v[196:199], v211 offset:30720
    v_mfma_f32_16x16x32_bf16 v[68:71], v[104:107], v[148:151], v[68:71]
    v_mfma_f32_16x16x32_bf16 v[72:75], v[112:115], v[132:135], v[72:75]
    ds_read_b128 v[204:207], v211 offset:32768
    v_mfma_f32_16x16x32_bf16 v[76:79], v[112:115], v[140:143], v[76:79]
    v_mfma_f32_16x16x32_bf16 v[80:83], v[112:115], v[148:151], v[80:83]
    ds_read_b128 v[156:159], v214 offset:29696
    v_mfma_f32_16x16x32_bf16 v[84:87], v[120:123], v[132:135], v[84:87]
    v_mfma_f32_16x16x32_bf16 v[88:91], v[120:123], v[140:143], v[88:91]
    ds_read_b128 v[164:167], v214 offset:31744
    v_mfma_f32_16x16x32_bf16 v[92:95], v[120:123], v[148:151], v[92:95]
    v_mfma_f32_16x16x32_bf16 v[48:51], v[100:103], v[128:131], v[48:51]
    ds_read_b128 v[172:175], v214 offset:33792
    v_xor_b32 v132, s34, v132
    v_xor_b32 v133, s34, v133
    v_mfma_f32_16x16x32_bf16 v[52:55], v[100:103], v[136:139], v[52:55]
    v_xor_b32 v134, s34, v134
    v_xor_b32 v135, s34, v135
    v_mfma_f32_16x16x32_bf16 v[56:59], v[100:103], v[144:147], v[56:59]
    ds_read_b128 v[180:183], v214 offset:35840
    v_xor_b32 v140, s34, v140
    v_xor_b32 v141, s34, v141
    v_mfma_f32_16x16x32_bf16 v[60:63], v[108:111], v[128:131], v[60:63]
    v_xor_b32 v142, s34, v142
    v_xor_b32 v143, s34, v143
    v_mfma_f32_16x16x32_bf16 v[64:67], v[108:111], v[136:139], v[64:67]
    v_xor_b32 v148, s34, v148
    v_xor_b32 v149, s34, v149
    v_mfma_f32_16x16x32_bf16 v[68:71], v[108:111], v[144:147], v[68:71]
    v_xor_b32 v150, s34, v150
    v_xor_b32 v151, s34, v151
    v_mfma_f32_16x16x32_bf16 v[72:75], v[116:119], v[128:131], v[72:75]
    v_mfma_f32_16x16x32_bf16 v[76:79], v[116:119], v[136:139], v[76:79]
    v_mfma_f32_16x16x32_bf16 v[80:83], v[116:119], v[144:147], v[80:83]
    v_mfma_f32_16x16x32_bf16 v[84:87], v[124:127], v[128:131], v[84:87]
    v_mfma_f32_16x16x32_bf16 v[88:91], v[124:127], v[136:139], v[88:91]
    v_mfma_f32_16x16x32_bf16 v[92:95], v[124:127], v[144:147], v[92:95]
    v_mfma_f32_16x16x32_bf16 v[0:3], v[100:103], v[132:135], v[0:3]
    v_mfma_f32_16x16x32_bf16 v[4:7], v[100:103], v[140:143], v[4:7]
    v_mfma_f32_16x16x32_bf16 v[8:11], v[100:103], v[148:151], v[8:11]
    v_mfma_f32_16x16x32_bf16 v[12:15], v[108:111], v[132:135], v[12:15]
    v_mfma_f32_16x16x32_bf16 v[16:19], v[108:111], v[140:143], v[16:19]
    s_waitcnt lgkmcnt(0)
    s_barrier
    v_mfma_f32_16x16x32_bf16 v[20:23], v[108:111], v[148:151], v[20:23]
    v_mfma_f32_16x16x32_bf16 v[24:27], v[116:119], v[132:135], v[24:27]
    v_mfma_f32_16x16x32_bf16 v[28:31], v[116:119], v[140:143], v[28:31]
    v_mfma_f32_16x16x32_bf16 v[32:35], v[116:119], v[148:151], v[32:35]
    v_mfma_f32_16x16x32_bf16 v[36:39], v[124:127], v[132:135], v[36:39]
    v_mfma_f32_16x16x32_bf16 v[40:43], v[124:127], v[140:143], v[40:43]
    v_mfma_f32_16x16x32_bf16 v[44:47], v[124:127], v[148:151], v[44:47]
    v_mfma_f32_16x16x32_bf16 v[0:3], v[152:155], v[184:187], v[0:3]
    ds_read_b128 v[96:99], v215 offset:0
    v_mfma_f32_16x16x32_bf16 v[4:7], v[152:155], v[192:195], v[4:7]
    v_mfma_f32_16x16x32_bf16 v[8:11], v[152:155], v[200:203], v[8:11]
    ds_read_b128 v[128:131], v209 offset:0
    v_mfma_f32_16x16x32_bf16 v[12:15], v[160:163], v[184:187], v[12:15]
    v_mfma_f32_16x16x32_bf16 v[16:19], v[160:163], v[192:195], v[16:19]
    ds_read_b128 v[136:139], v209 offset:2048
    v_mfma_f32_16x16x32_bf16 v[20:23], v[160:163], v[200:203], v[20:23]
    v_mfma_f32_16x16x32_bf16 v[24:27], v[168:171], v[184:187], v[24:27]
    ds_read_b128 v[144:147], v209 offset:4096
    v_mfma_f32_16x16x32_bf16 v[28:31], v[168:171], v[192:195], v[28:31]
    v_mfma_f32_16x16x32_bf16 v[32:35], v[168:171], v[200:203], v[32:35]
    ds_read_b128 v[104:107], v215 offset:2048
    v_mfma_f32_16x16x32_bf16 v[36:39], v[176:179], v[184:187], v[36:39]
    v_mfma_f32_16x16x32_bf16 v[40:43], v[176:179], v[192:195], v[40:43]
    ds_read_b128 v[112:115], v215 offset:4096
    v_mfma_f32_16x16x32_bf16 v[44:47], v[176:179], v[200:203], v[44:47]
    v_mfma_f32_16x16x32_bf16 v[48:51], v[152:155], v[188:191], v[48:51]
    ds_read_b128 v[120:123], v215 offset:6144
    v_mfma_f32_16x16x32_bf16 v[52:55], v[152:155], v[196:199], v[52:55]
    v_mfma_f32_16x16x32_bf16 v[56:59], v[152:155], v[204:207], v[56:59]
    ds_read_b128 v[132:135], v212 offset:0
    v_mfma_f32_16x16x32_bf16 v[60:63], v[160:163], v[188:191], v[60:63]
    v_mfma_f32_16x16x32_bf16 v[64:67], v[160:163], v[196:199], v[64:67]
    ds_read_b128 v[140:143], v212 offset:2048
    v_mfma_f32_16x16x32_bf16 v[68:71], v[160:163], v[204:207], v[68:71]
    v_mfma_f32_16x16x32_bf16 v[72:75], v[168:171], v[188:191], v[72:75]
    ds_read_b128 v[148:151], v212 offset:4096
    v_mfma_f32_16x16x32_bf16 v[76:79], v[168:171], v[196:199], v[76:79]
    v_mfma_f32_16x16x32_bf16 v[80:83], v[168:171], v[204:207], v[80:83]
    ds_read_b128 v[100:103], v215 offset:1024
    v_mfma_f32_16x16x32_bf16 v[84:87], v[176:179], v[188:191], v[84:87]
    v_mfma_f32_16x16x32_bf16 v[88:91], v[176:179], v[196:199], v[88:91]
    ds_read_b128 v[108:111], v215 offset:3072
    v_mfma_f32_16x16x32_bf16 v[92:95], v[176:179], v[204:207], v[92:95]
    v_mfma_f32_16x16x32_bf16 v[48:51], v[156:159], v[184:187], v[48:51]
    ds_read_b128 v[116:119], v215 offset:5120
    v_xor_b32 v188, s34, v188
    v_xor_b32 v189, s34, v189
    v_mfma_f32_16x16x32_bf16 v[52:55], v[156:159], v[192:195], v[52:55]
    v_xor_b32 v190, s34, v190
    v_xor_b32 v191, s34, v191
    v_mfma_f32_16x16x32_bf16 v[56:59], v[156:159], v[200:203], v[56:59]
    ds_read_b128 v[124:127], v215 offset:7168
    v_xor_b32 v196, s34, v196
    v_xor_b32 v197, s34, v197
    v_mfma_f32_16x16x32_bf16 v[60:63], v[164:167], v[184:187], v[60:63]
    v_xor_b32 v198, s34, v198
    v_xor_b32 v199, s34, v199
    v_mfma_f32_16x16x32_bf16 v[64:67], v[164:167], v[192:195], v[64:67]
    v_xor_b32 v204, s34, v204
    v_xor_b32 v205, s34, v205
    v_mfma_f32_16x16x32_bf16 v[68:71], v[164:167], v[200:203], v[68:71]
    v_xor_b32 v206, s34, v206
    v_xor_b32 v207, s34, v207
    v_mfma_f32_16x16x32_bf16 v[72:75], v[172:175], v[184:187], v[72:75]
    v_mfma_f32_16x16x32_bf16 v[76:79], v[172:175], v[192:195], v[76:79]
    v_mfma_f32_16x16x32_bf16 v[80:83], v[172:175], v[200:203], v[80:83]
    v_mfma_f32_16x16x32_bf16 v[84:87], v[180:183], v[184:187], v[84:87]
    v_mfma_f32_16x16x32_bf16 v[88:91], v[180:183], v[192:195], v[88:91]
    v_mfma_f32_16x16x32_bf16 v[92:95], v[180:183], v[200:203], v[92:95]
    v_mfma_f32_16x16x32_bf16 v[0:3], v[156:159], v[188:191], v[0:3]
    v_mfma_f32_16x16x32_bf16 v[4:7], v[156:159], v[196:199], v[4:7]
    v_mfma_f32_16x16x32_bf16 v[8:11], v[156:159], v[204:207], v[8:11]
    v_mfma_f32_16x16x32_bf16 v[12:15], v[164:167], v[188:191], v[12:15]
    v_mfma_f32_16x16x32_bf16 v[16:19], v[164:167], v[196:199], v[16:19]
    s_waitcnt lgkmcnt(0)
    s_barrier
    v_mfma_f32_16x16x32_bf16 v[20:23], v[164:167], v[204:207], v[20:23]
    v_mfma_f32_16x16x32_bf16 v[24:27], v[172:175], v[188:191], v[24:27]
    v_mfma_f32_16x16x32_bf16 v[28:31], v[172:175], v[196:199], v[28:31]
    v_mfma_f32_16x16x32_bf16 v[32:35], v[172:175], v[204:207], v[32:35]
    v_mfma_f32_16x16x32_bf16 v[36:39], v[180:183], v[188:191], v[36:39]
    v_mfma_f32_16x16x32_bf16 v[40:43], v[180:183], v[196:199], v[40:43]
    v_mfma_f32_16x16x32_bf16 v[44:47], v[180:183], v[204:207], v[44:47]
    v_mfma_f32_16x16x32_bf16 v[0:3], v[96:99], v[128:131], v[0:3]
    ds_read_b128 v[152:155], v215 offset:28672
    v_mfma_f32_16x16x32_bf16 v[4:7], v[96:99], v[136:139], v[4:7]
    v_mfma_f32_16x16x32_bf16 v[8:11], v[96:99], v[144:147], v[8:11]
    ds_read_b128 v[184:187], v209 offset:28672
    v_mfma_f32_16x16x32_bf16 v[12:15], v[104:107], v[128:131], v[12:15]
    v_mfma_f32_16x16x32_bf16 v[16:19], v[104:107], v[136:139], v[16:19]
    ds_read_b128 v[192:195], v209 offset:30720
    v_mfma_f32_16x16x32_bf16 v[20:23], v[104:107], v[144:147], v[20:23]
    v_mfma_f32_16x16x32_bf16 v[24:27], v[112:115], v[128:131], v[24:27]
    ds_read_b128 v[200:203], v209 offset:32768
    v_mfma_f32_16x16x32_bf16 v[28:31], v[112:115], v[136:139], v[28:31]
    v_mfma_f32_16x16x32_bf16 v[32:35], v[112:115], v[144:147], v[32:35]
    ds_read_b128 v[160:163], v215 offset:30720
    v_mfma_f32_16x16x32_bf16 v[36:39], v[120:123], v[128:131], v[36:39]
    v_mfma_f32_16x16x32_bf16 v[40:43], v[120:123], v[136:139], v[40:43]
    ds_read_b128 v[168:171], v215 offset:32768
    v_mfma_f32_16x16x32_bf16 v[44:47], v[120:123], v[144:147], v[44:47]
    v_mfma_f32_16x16x32_bf16 v[48:51], v[96:99], v[132:135], v[48:51]
    ds_read_b128 v[176:179], v215 offset:34816
    v_mfma_f32_16x16x32_bf16 v[52:55], v[96:99], v[140:143], v[52:55]
    v_mfma_f32_16x16x32_bf16 v[56:59], v[96:99], v[148:151], v[56:59]
    ds_read_b128 v[188:191], v212 offset:28672
    v_mfma_f32_16x16x32_bf16 v[60:63], v[104:107], v[132:135], v[60:63]
    v_mfma_f32_16x16x32_bf16 v[64:67], v[104:107], v[140:143], v[64:67]
    ds_read_b128 v[196:199], v212 offset:30720
    v_mfma_f32_16x16x32_bf16 v[68:71], v[104:107], v[148:151], v[68:71]
    v_mfma_f32_16x16x32_bf16 v[72:75], v[112:115], v[132:135], v[72:75]
    ds_read_b128 v[204:207], v212 offset:32768
    v_mfma_f32_16x16x32_bf16 v[76:79], v[112:115], v[140:143], v[76:79]
    v_mfma_f32_16x16x32_bf16 v[80:83], v[112:115], v[148:151], v[80:83]
    ds_read_b128 v[156:159], v215 offset:29696
    v_mfma_f32_16x16x32_bf16 v[84:87], v[120:123], v[132:135], v[84:87]
    v_mfma_f32_16x16x32_bf16 v[88:91], v[120:123], v[140:143], v[88:91]
    ds_read_b128 v[164:167], v215 offset:31744
    v_mfma_f32_16x16x32_bf16 v[92:95], v[120:123], v[148:151], v[92:95]
    v_mfma_f32_16x16x32_bf16 v[48:51], v[100:103], v[128:131], v[48:51]
    ds_read_b128 v[172:175], v215 offset:33792
    v_xor_b32 v132, s34, v132
    v_xor_b32 v133, s34, v133
    v_mfma_f32_16x16x32_bf16 v[52:55], v[100:103], v[136:139], v[52:55]
    v_xor_b32 v134, s34, v134
    v_xor_b32 v135, s34, v135
    v_mfma_f32_16x16x32_bf16 v[56:59], v[100:103], v[144:147], v[56:59]
    ds_read_b128 v[180:183], v215 offset:35840
    v_xor_b32 v140, s34, v140
    v_xor_b32 v141, s34, v141
    v_mfma_f32_16x16x32_bf16 v[60:63], v[108:111], v[128:131], v[60:63]
    v_xor_b32 v142, s34, v142
    v_xor_b32 v143, s34, v143
    v_mfma_f32_16x16x32_bf16 v[64:67], v[108:111], v[136:139], v[64:67]
    v_xor_b32 v148, s34, v148
    v_xor_b32 v149, s34, v149
    v_mfma_f32_16x16x32_bf16 v[68:71], v[108:111], v[144:147], v[68:71]
    v_xor_b32 v150, s34, v150
    v_xor_b32 v151, s34, v151
    v_mfma_f32_16x16x32_bf16 v[72:75], v[116:119], v[128:131], v[72:75]
    v_mfma_f32_16x16x32_bf16 v[76:79], v[116:119], v[136:139], v[76:79]
    v_mfma_f32_16x16x32_bf16 v[80:83], v[116:119], v[144:147], v[80:83]
    v_mfma_f32_16x16x32_bf16 v[84:87], v[124:127], v[128:131], v[84:87]
    v_mfma_f32_16x16x32_bf16 v[88:91], v[124:127], v[136:139], v[88:91]
    v_mfma_f32_16x16x32_bf16 v[92:95], v[124:127], v[144:147], v[92:95]
    v_mfma_f32_16x16x32_bf16 v[0:3], v[100:103], v[132:135], v[0:3]
    v_mfma_f32_16x16x32_bf16 v[4:7], v[100:103], v[140:143], v[4:7]
    v_mfma_f32_16x16x32_bf16 v[8:11], v[100:103], v[148:151], v[8:11]
    v_mfma_f32_16x16x32_bf16 v[12:15], v[108:111], v[132:135], v[12:15]
    v_mfma_f32_16x16x32_bf16 v[16:19], v[108:111], v[140:143], v[16:19]
    s_waitcnt lgkmcnt(0)
    s_barrier
    v_mfma_f32_16x16x32_bf16 v[20:23], v[108:111], v[148:151], v[20:23]
    v_mfma_f32_16x16x32_bf16 v[24:27], v[116:119], v[132:135], v[24:27]
    v_mfma_f32_16x16x32_bf16 v[28:31], v[116:119], v[140:143], v[28:31]
    v_mfma_f32_16x16x32_bf16 v[32:35], v[116:119], v[148:151], v[32:35]
    v_mfma_f32_16x16x32_bf16 v[36:39], v[124:127], v[132:135], v[36:39]
    v_mfma_f32_16x16x32_bf16 v[40:43], v[124:127], v[140:143], v[40:43]
    v_mfma_f32_16x16x32_bf16 v[44:47], v[124:127], v[148:151], v[44:47]
    v_mfma_f32_16x16x32_bf16 v[0:3], v[152:155], v[184:187], v[0:3]
    ds_read_b128 v[96:99], v216 offset:0
    v_mfma_f32_16x16x32_bf16 v[4:7], v[152:155], v[192:195], v[4:7]
    v_mfma_f32_16x16x32_bf16 v[8:11], v[152:155], v[200:203], v[8:11]
    ds_read_b128 v[128:131], v210 offset:0
    v_mfma_f32_16x16x32_bf16 v[12:15], v[160:163], v[184:187], v[12:15]
    v_mfma_f32_16x16x32_bf16 v[16:19], v[160:163], v[192:195], v[16:19]
    ds_read_b128 v[136:139], v210 offset:2048
    v_mfma_f32_16x16x32_bf16 v[20:23], v[160:163], v[200:203], v[20:23]
    v_mfma_f32_16x16x32_bf16 v[24:27], v[168:171], v[184:187], v[24:27]
    ds_read_b128 v[144:147], v210 offset:4096
    v_mfma_f32_16x16x32_bf16 v[28:31], v[168:171], v[192:195], v[28:31]
    v_mfma_f32_16x16x32_bf16 v[32:35], v[168:171], v[200:203], v[32:35]
    ds_read_b128 v[104:107], v216 offset:2048
    v_mfma_f32_16x16x32_bf16 v[36:39], v[176:179], v[184:187], v[36:39]
    v_mfma_f32_16x16x32_bf16 v[40:43], v[176:179], v[192:195], v[40:43]
    ds_read_b128 v[112:115], v216 offset:4096
    v_mfma_f32_16x16x32_bf16 v[44:47], v[176:179], v[200:203], v[44:47]
    v_mfma_f32_16x16x32_bf16 v[48:51], v[152:155], v[188:191], v[48:51]
    ds_read_b128 v[120:123], v216 offset:6144
    v_mfma_f32_16x16x32_bf16 v[52:55], v[152:155], v[196:199], v[52:55]
    v_mfma_f32_16x16x32_bf16 v[56:59], v[152:155], v[204:207], v[56:59]
    ds_read_b128 v[132:135], v213 offset:0
    v_mfma_f32_16x16x32_bf16 v[60:63], v[160:163], v[188:191], v[60:63]
    v_mfma_f32_16x16x32_bf16 v[64:67], v[160:163], v[196:199], v[64:67]
    ds_read_b128 v[140:143], v213 offset:2048
    v_mfma_f32_16x16x32_bf16 v[68:71], v[160:163], v[204:207], v[68:71]
    v_mfma_f32_16x16x32_bf16 v[72:75], v[168:171], v[188:191], v[72:75]
    ds_read_b128 v[148:151], v213 offset:4096
    v_mfma_f32_16x16x32_bf16 v[76:79], v[168:171], v[196:199], v[76:79]
    v_mfma_f32_16x16x32_bf16 v[80:83], v[168:171], v[204:207], v[80:83]
    ds_read_b128 v[100:103], v216 offset:1024
    v_mfma_f32_16x16x32_bf16 v[84:87], v[176:179], v[188:191], v[84:87]
    v_mfma_f32_16x16x32_bf16 v[88:91], v[176:179], v[196:199], v[88:91]
    ds_read_b128 v[108:111], v216 offset:3072
    v_mfma_f32_16x16x32_bf16 v[92:95], v[176:179], v[204:207], v[92:95]
    v_mfma_f32_16x16x32_bf16 v[48:51], v[156:159], v[184:187], v[48:51]
    ds_read_b128 v[116:119], v216 offset:5120
    v_xor_b32 v188, s34, v188
    v_xor_b32 v189, s34, v189
    v_mfma_f32_16x16x32_bf16 v[52:55], v[156:159], v[192:195], v[52:55]
    v_xor_b32 v190, s34, v190
    v_xor_b32 v191, s34, v191
    v_mfma_f32_16x16x32_bf16 v[56:59], v[156:159], v[200:203], v[56:59]
    ds_read_b128 v[124:127], v216 offset:7168
    v_xor_b32 v196, s34, v196
    v_xor_b32 v197, s34, v197
    v_mfma_f32_16x16x32_bf16 v[60:63], v[164:167], v[184:187], v[60:63]
    v_xor_b32 v198, s34, v198
    v_xor_b32 v199, s34, v199
    v_mfma_f32_16x16x32_bf16 v[64:67], v[164:167], v[192:195], v[64:67]
    v_xor_b32 v204, s34, v204
    v_xor_b32 v205, s34, v205
    v_mfma_f32_16x16x32_bf16 v[68:71], v[164:167], v[200:203], v[68:71]
    v_xor_b32 v206, s34, v206
    v_xor_b32 v207, s34, v207
    v_mfma_f32_16x16x32_bf16 v[72:75], v[172:175], v[184:187], v[72:75]
    v_mfma_f32_16x16x32_bf16 v[76:79], v[172:175], v[192:195], v[76:79]
    v_mfma_f32_16x16x32_bf16 v[80:83], v[172:175], v[200:203], v[80:83]
    v_mfma_f32_16x16x32_bf16 v[84:87], v[180:183], v[184:187], v[84:87]
    v_mfma_f32_16x16x32_bf16 v[88:91], v[180:183], v[192:195], v[88:91]
    v_mfma_f32_16x16x32_bf16 v[92:95], v[180:183], v[200:203], v[92:95]
    v_mfma_f32_16x16x32_bf16 v[0:3], v[156:159], v[188:191], v[0:3]
    v_mfma_f32_16x16x32_bf16 v[4:7], v[156:159], v[196:199], v[4:7]
    v_mfma_f32_16x16x32_bf16 v[8:11], v[156:159], v[204:207], v[8:11]
    v_mfma_f32_16x16x32_bf16 v[12:15], v[164:167], v[188:191], v[12:15]
    v_mfma_f32_16x16x32_bf16 v[16:19], v[164:167], v[196:199], v[16:19]
    s_waitcnt lgkmcnt(0)
    s_barrier
    v_mfma_f32_16x16x32_bf16 v[20:23], v[164:167], v[204:207], v[20:23]
    v_mfma_f32_16x16x32_bf16 v[24:27], v[172:175], v[188:191], v[24:27]
    v_mfma_f32_16x16x32_bf16 v[28:31], v[172:175], v[196:199], v[28:31]
    v_mfma_f32_16x16x32_bf16 v[32:35], v[172:175], v[204:207], v[32:35]
    v_mfma_f32_16x16x32_bf16 v[36:39], v[180:183], v[188:191], v[36:39]
    v_mfma_f32_16x16x32_bf16 v[40:43], v[180:183], v[196:199], v[40:43]
    v_mfma_f32_16x16x32_bf16 v[44:47], v[180:183], v[204:207], v[44:47]
    v_mfma_f32_16x16x32_bf16 v[0:3], v[96:99], v[128:131], v[0:3]
    ds_read_b128 v[152:155], v214 offset:0
    v_mfma_f32_16x16x32_bf16 v[4:7], v[96:99], v[136:139], v[4:7]
    v_mfma_f32_16x16x32_bf16 v[8:11], v[96:99], v[144:147], v[8:11]
    ds_read_b128 v[184:187], v208 offset:0
    v_mfma_f32_16x16x32_bf16 v[12:15], v[104:107], v[128:131], v[12:15]
    v_mfma_f32_16x16x32_bf16 v[16:19], v[104:107], v[136:139], v[16:19]
    ds_read_b128 v[192:195], v208 offset:2048
    v_mfma_f32_16x16x32_bf16 v[20:23], v[104:107], v[144:147], v[20:23]
    v_mfma_f32_16x16x32_bf16 v[24:27], v[112:115], v[128:131], v[24:27]
    ds_read_b128 v[200:203], v208 offset:4096
    v_mfma_f32_16x16x32_bf16 v[28:31], v[112:115], v[136:139], v[28:31]
    v_mfma_f32_16x16x32_bf16 v[32:35], v[112:115], v[144:147], v[32:35]
    ds_read_b128 v[160:163], v214 offset:2048
    v_mfma_f32_16x16x32_bf16 v[36:39], v[120:123], v[128:131], v[36:39]
    v_mfma_f32_16x16x32_bf16 v[40:43], v[120:123], v[136:139], v[40:43]
    ds_read_b128 v[168:171], v214 offset:4096
    v_mfma_f32_16x16x32_bf16 v[44:47], v[120:123], v[144:147], v[44:47]
    v_mfma_f32_16x16x32_bf16 v[48:51], v[96:99], v[132:135], v[48:51]
    ds_read_b128 v[176:179], v214 offset:6144
    v_mfma_f32_16x16x32_bf16 v[52:55], v[96:99], v[140:143], v[52:55]
    v_mfma_f32_16x16x32_bf16 v[56:59], v[96:99], v[148:151], v[56:59]
    ds_read_b128 v[188:191], v211 offset:0
    v_mfma_f32_16x16x32_bf16 v[60:63], v[104:107], v[132:135], v[60:63]
    v_mfma_f32_16x16x32_bf16 v[64:67], v[104:107], v[140:143], v[64:67]
    ds_read_b128 v[196:199], v211 offset:2048
    v_mfma_f32_16x16x32_bf16 v[68:71], v[104:107], v[148:151], v[68:71]
    v_mfma_f32_16x16x32_bf16 v[72:75], v[112:115], v[132:135], v[72:75]
    ds_read_b128 v[204:207], v211 offset:4096
    v_mfma_f32_16x16x32_bf16 v[76:79], v[112:115], v[140:143], v[76:79]
    v_mfma_f32_16x16x32_bf16 v[80:83], v[112:115], v[148:151], v[80:83]
    ds_read_b128 v[156:159], v214 offset:1024
    v_mfma_f32_16x16x32_bf16 v[84:87], v[120:123], v[132:135], v[84:87]
    v_mfma_f32_16x16x32_bf16 v[88:91], v[120:123], v[140:143], v[88:91]
    ds_read_b128 v[164:167], v214 offset:3072
    v_mfma_f32_16x16x32_bf16 v[92:95], v[120:123], v[148:151], v[92:95]
    v_mfma_f32_16x16x32_bf16 v[48:51], v[100:103], v[128:131], v[48:51]
    ds_read_b128 v[172:175], v214 offset:5120
    v_xor_b32 v132, s34, v132
    v_xor_b32 v133, s34, v133
    v_mfma_f32_16x16x32_bf16 v[52:55], v[100:103], v[136:139], v[52:55]
    v_xor_b32 v134, s34, v134
    v_xor_b32 v135, s34, v135
    v_mfma_f32_16x16x32_bf16 v[56:59], v[100:103], v[144:147], v[56:59]
    ds_read_b128 v[180:183], v214 offset:7168
    v_xor_b32 v140, s34, v140
    v_xor_b32 v141, s34, v141
    v_mfma_f32_16x16x32_bf16 v[60:63], v[108:111], v[128:131], v[60:63]
    v_xor_b32 v142, s34, v142
    v_xor_b32 v143, s34, v143
    v_mfma_f32_16x16x32_bf16 v[64:67], v[108:111], v[136:139], v[64:67]
    v_xor_b32 v148, s34, v148
    v_xor_b32 v149, s34, v149
    v_mfma_f32_16x16x32_bf16 v[68:71], v[108:111], v[144:147], v[68:71]
    v_xor_b32 v150, s34, v150
    v_xor_b32 v151, s34, v151
    v_mfma_f32_16x16x32_bf16 v[72:75], v[116:119], v[128:131], v[72:75]
    v_mfma_f32_16x16x32_bf16 v[76:79], v[116:119], v[136:139], v[76:79]
    v_mfma_f32_16x16x32_bf16 v[80:83], v[116:119], v[144:147], v[80:83]
    v_mfma_f32_16x16x32_bf16 v[84:87], v[124:127], v[128:131], v[84:87]
    v_mfma_f32_16x16x32_bf16 v[88:91], v[124:127], v[136:139], v[88:91]
    v_mfma_f32_16x16x32_bf16 v[92:95], v[124:127], v[144:147], v[92:95]
    v_mfma_f32_16x16x32_bf16 v[0:3], v[100:103], v[132:135], v[0:3]
    v_mfma_f32_16x16x32_bf16 v[4:7], v[100:103], v[140:143], v[4:7]
    v_mfma_f32_16x16x32_bf16 v[8:11], v[100:103], v[148:151], v[8:11]
    v_mfma_f32_16x16x32_bf16 v[12:15], v[108:111], v[132:135], v[12:15]
    v_mfma_f32_16x16x32_bf16 v[16:19], v[108:111], v[140:143], v[16:19]
    s_waitcnt lgkmcnt(0)
    v_mfma_f32_16x16x32_bf16 v[20:23], v[108:111], v[148:151], v[20:23]
    v_mfma_f32_16x16x32_bf16 v[24:27], v[116:119], v[132:135], v[24:27]
    v_mfma_f32_16x16x32_bf16 v[28:31], v[116:119], v[140:143], v[28:31]
    v_mfma_f32_16x16x32_bf16 v[32:35], v[116:119], v[148:151], v[32:35]
    v_mfma_f32_16x16x32_bf16 v[36:39], v[124:127], v[132:135], v[36:39]
    v_mfma_f32_16x16x32_bf16 v[40:43], v[124:127], v[140:143], v[40:43]
    v_mfma_f32_16x16x32_bf16 v[44:47], v[124:127], v[148:151], v[44:47]
    v_mfma_f32_16x16x32_bf16 v[0:3], v[152:155], v[184:187], v[0:3]
    v_mfma_f32_16x16x32_bf16 v[4:7], v[152:155], v[192:195], v[4:7]
    v_mfma_f32_16x16x32_bf16 v[8:11], v[152:155], v[200:203], v[8:11]
    v_mfma_f32_16x16x32_bf16 v[12:15], v[160:163], v[184:187], v[12:15]
    v_mfma_f32_16x16x32_bf16 v[16:19], v[160:163], v[192:195], v[16:19]
    v_mfma_f32_16x16x32_bf16 v[20:23], v[160:163], v[200:203], v[20:23]
    v_mfma_f32_16x16x32_bf16 v[24:27], v[168:171], v[184:187], v[24:27]
    v_mfma_f32_16x16x32_bf16 v[28:31], v[168:171], v[192:195], v[28:31]
    v_mfma_f32_16x16x32_bf16 v[32:35], v[168:171], v[200:203], v[32:35]
    v_mfma_f32_16x16x32_bf16 v[36:39], v[176:179], v[184:187], v[36:39]
    v_mfma_f32_16x16x32_bf16 v[40:43], v[176:179], v[192:195], v[40:43]
    v_mfma_f32_16x16x32_bf16 v[44:47], v[176:179], v[200:203], v[44:47]
    v_mfma_f32_16x16x32_bf16 v[48:51], v[152:155], v[188:191], v[48:51]
    v_mfma_f32_16x16x32_bf16 v[52:55], v[152:155], v[196:199], v[52:55]
    v_mfma_f32_16x16x32_bf16 v[56:59], v[152:155], v[204:207], v[56:59]
    v_mfma_f32_16x16x32_bf16 v[60:63], v[160:163], v[188:191], v[60:63]
    v_mfma_f32_16x16x32_bf16 v[64:67], v[160:163], v[196:199], v[64:67]
    v_mfma_f32_16x16x32_bf16 v[68:71], v[160:163], v[204:207], v[68:71]
    v_mfma_f32_16x16x32_bf16 v[72:75], v[168:171], v[188:191], v[72:75]
    v_mfma_f32_16x16x32_bf16 v[76:79], v[168:171], v[196:199], v[76:79]
    v_mfma_f32_16x16x32_bf16 v[80:83], v[168:171], v[204:207], v[80:83]
    v_mfma_f32_16x16x32_bf16 v[84:87], v[176:179], v[188:191], v[84:87]
    v_mfma_f32_16x16x32_bf16 v[88:91], v[176:179], v[196:199], v[88:91]
    v_mfma_f32_16x16x32_bf16 v[92:95], v[176:179], v[204:207], v[92:95]
    v_mfma_f32_16x16x32_bf16 v[48:51], v[156:159], v[184:187], v[48:51]
    v_xor_b32 v188, s34, v188
    v_xor_b32 v189, s34, v189
    v_mfma_f32_16x16x32_bf16 v[52:55], v[156:159], v[192:195], v[52:55]
    v_xor_b32 v190, s34, v190
    v_xor_b32 v191, s34, v191
    v_mfma_f32_16x16x32_bf16 v[56:59], v[156:159], v[200:203], v[56:59]
    v_xor_b32 v196, s34, v196
    v_xor_b32 v197, s34, v197
    v_mfma_f32_16x16x32_bf16 v[60:63], v[164:167], v[184:187], v[60:63]
    v_xor_b32 v198, s34, v198
    v_xor_b32 v199, s34, v199
    v_mfma_f32_16x16x32_bf16 v[64:67], v[164:167], v[192:195], v[64:67]
    v_xor_b32 v204, s34, v204
    v_xor_b32 v205, s34, v205
    v_mfma_f32_16x16x32_bf16 v[68:71], v[164:167], v[200:203], v[68:71]
    v_xor_b32 v206, s34, v206
    v_xor_b32 v207, s34, v207
    v_mfma_f32_16x16x32_bf16 v[72:75], v[172:175], v[184:187], v[72:75]
    v_mfma_f32_16x16x32_bf16 v[76:79], v[172:175], v[192:195], v[76:79]
    v_mfma_f32_16x16x32_bf16 v[80:83], v[172:175], v[200:203], v[80:83]
    v_mfma_f32_16x16x32_bf16 v[84:87], v[180:183], v[184:187], v[84:87]
    v_mfma_f32_16x16x32_bf16 v[88:91], v[180:183], v[192:195], v[88:91]
    v_mfma_f32_16x16x32_bf16 v[92:95], v[180:183], v[200:203], v[92:95]
    v_mfma_f32_16x16x32_bf16 v[0:3], v[156:159], v[188:191], v[0:3]
    v_mfma_f32_16x16x32_bf16 v[4:7], v[156:159], v[196:199], v[4:7]
    v_mfma_f32_16x16x32_bf16 v[8:11], v[156:159], v[204:207], v[8:11]
    v_mfma_f32_16x16x32_bf16 v[12:15], v[164:167], v[188:191], v[12:15]
    v_mfma_f32_16x16x32_bf16 v[16:19], v[164:167], v[196:199], v[16:19]
    v_mfma_f32_16x16x32_bf16 v[20:23], v[164:167], v[204:207], v[20:23]
    v_mfma_f32_16x16x32_bf16 v[24:27], v[172:175], v[188:191], v[24:27]
    v_mfma_f32_16x16x32_bf16 v[28:31], v[172:175], v[196:199], v[28:31]
    v_mfma_f32_16x16x32_bf16 v[32:35], v[172:175], v[204:207], v[32:35]
    v_mfma_f32_16x16x32_bf16 v[36:39], v[180:183], v[188:191], v[36:39]
    v_mfma_f32_16x16x32_bf16 v[40:43], v[180:183], v[196:199], v[40:43]
    v_mfma_f32_16x16x32_bf16 v[44:47], v[180:183], v[204:207], v[44:47]
    s_nop 7
    s_nop 7
    v_cvt_pk_bf16_f32 v96, v0, v1
    v_cvt_pk_bf16_f32 v97, v2, v3
    v_cvt_pk_bf16_f32 v98, v12, v13
    v_cvt_pk_bf16_f32 v99, v14, v15
    v_cvt_pk_bf16_f32 v100, v48, v49
    v_cvt_pk_bf16_f32 v101, v50, v51
    v_cvt_pk_bf16_f32 v102, v60, v61
    v_cvt_pk_bf16_f32 v103, v62, v63
    v_mov_b32 v104, v96
    v_mov_b32 v105, v97
    v_mov_b32 v106, v98
    v_mov_b32 v107, v99
    s_add_u32 s35, s33, 0
    v_mov_b32_dpp v104, v100 row_ror:8 row_mask:0xf bank_mask:0x3
    v_mov_b32_dpp v105, v101 row_ror:8 row_mask:0xf bank_mask:0x3
    v_mov_b32_dpp v106, v102 row_ror:8 row_mask:0xf bank_mask:0x3
    v_mov_b32_dpp v107, v103 row_ror:8 row_mask:0xf bank_mask:0x3
    v_mov_b32_dpp v96, v100 row_ror:8 row_mask:0xf bank_mask:0xc
    v_mov_b32_dpp v97, v101 row_ror:8 row_mask:0xf bank_mask:0xc
    v_mov_b32_dpp v98, v102 row_ror:8 row_mask:0xf bank_mask:0xc
    v_mov_b32_dpp v99, v103 row_ror:8 row_mask:0xf bank_mask:0xc
    buffer_store_dwordx4 v[96:99], v222, s[16:19], s35 offen sc1
    buffer_store_dwordx4 v[104:107], v223, s[16:19], s35 offen sc1
    v_cvt_pk_bf16_f32 v108, v4, v5
    v_cvt_pk_bf16_f32 v109, v6, v7
    v_cvt_pk_bf16_f32 v110, v16, v17
    v_cvt_pk_bf16_f32 v111, v18, v19
    v_cvt_pk_bf16_f32 v112, v52, v53
    v_cvt_pk_bf16_f32 v113, v54, v55
    v_cvt_pk_bf16_f32 v114, v64, v65
    v_cvt_pk_bf16_f32 v115, v66, v67
    v_mov_b32 v116, v108
    v_mov_b32 v117, v109
    v_mov_b32 v118, v110
    v_mov_b32 v119, v111
    s_add_u32 s35, s33, 593920
    v_mov_b32_dpp v116, v112 row_ror:8 row_mask:0xf bank_mask:0x3
    v_mov_b32_dpp v117, v113 row_ror:8 row_mask:0xf bank_mask:0x3
    v_mov_b32_dpp v118, v114 row_ror:8 row_mask:0xf bank_mask:0x3
    v_mov_b32_dpp v119, v115 row_ror:8 row_mask:0xf bank_mask:0x3
    v_mov_b32_dpp v108, v112 row_ror:8 row_mask:0xf bank_mask:0xc
    v_mov_b32_dpp v109, v113 row_ror:8 row_mask:0xf bank_mask:0xc
    v_mov_b32_dpp v110, v114 row_ror:8 row_mask:0xf bank_mask:0xc
    v_mov_b32_dpp v111, v115 row_ror:8 row_mask:0xf bank_mask:0xc
    buffer_store_dwordx4 v[108:111], v222, s[16:19], s35 offen sc1
    buffer_store_dwordx4 v[116:119], v223, s[16:19], s35 offen sc1
    v_cvt_pk_bf16_f32 v120, v8, v9
    v_cvt_pk_bf16_f32 v121, v10, v11
    v_cvt_pk_bf16_f32 v122, v20, v21
    v_cvt_pk_bf16_f32 v123, v22, v23
    v_cvt_pk_bf16_f32 v124, v56, v57
    v_cvt_pk_bf16_f32 v125, v58, v59
    v_cvt_pk_bf16_f32 v126, v68, v69
    v_cvt_pk_bf16_f32 v127, v70, v71
    v_mov_b32 v128, v120
    v_mov_b32 v129, v121
    v_mov_b32 v130, v122
    v_mov_b32 v131, v123
    s_add_u32 s35, s33, 1187840
    v_mov_b32_dpp v128, v124 row_ror:8 row_mask:0xf bank_mask:0x3
    v_mov_b32_dpp v129, v125 row_ror:8 row_mask:0xf bank_mask:0x3
    v_mov_b32_dpp v130, v126 row_ror:8 row_mask:0xf bank_mask:0x3
    v_mov_b32_dpp v131, v127 row_ror:8 row_mask:0xf bank_mask:0x3
    v_mov_b32_dpp v120, v124 row_ror:8 row_mask:0xf bank_mask:0xc
    v_mov_b32_dpp v121, v125 row_ror:8 row_mask:0xf bank_mask:0xc
    v_mov_b32_dpp v122, v126 row_ror:8 row_mask:0xf bank_mask:0xc
    v_mov_b32_dpp v123, v127 row_ror:8 row_mask:0xf bank_mask:0xc
    buffer_store_dwordx4 v[120:123], v222, s[16:19], s35 offen sc1
    buffer_store_dwordx4 v[128:131], v223, s[16:19], s35 offen sc1
    v_cvt_pk_bf16_f32 v96, v24, v25
    v_cvt_pk_bf16_f32 v97, v26, v27
    v_cvt_pk_bf16_f32 v98, v36, v37
    v_cvt_pk_bf16_f32 v99, v38, v39
    v_cvt_pk_bf16_f32 v100, v72, v73
    v_cvt_pk_bf16_f32 v101, v74, v75
    v_cvt_pk_bf16_f32 v102, v84, v85
    v_cvt_pk_bf16_f32 v103, v86, v87
    v_mov_b32 v104, v96
    v_mov_b32 v105, v97
    v_mov_b32 v106, v98
    v_mov_b32 v107, v99
    s_add_u32 s35, s33, 128
    v_mov_b32_dpp v104, v100 row_ror:8 row_mask:0xf bank_mask:0x3
    v_mov_b32_dpp v105, v101 row_ror:8 row_mask:0xf bank_mask:0x3
    v_mov_b32_dpp v106, v102 row_ror:8 row_mask:0xf bank_mask:0x3
    v_mov_b32_dpp v107, v103 row_ror:8 row_mask:0xf bank_mask:0x3
    v_mov_b32_dpp v96, v100 row_ror:8 row_mask:0xf bank_mask:0xc
    v_mov_b32_dpp v97, v101 row_ror:8 row_mask:0xf bank_mask:0xc
    v_mov_b32_dpp v98, v102 row_ror:8 row_mask:0xf bank_mask:0xc
    v_mov_b32_dpp v99, v103 row_ror:8 row_mask:0xf bank_mask:0xc
    buffer_store_dwordx4 v[96:99], v222, s[16:19], s35 offen sc1
    buffer_store_dwordx4 v[104:107], v223, s[16:19], s35 offen sc1
    v_cvt_pk_bf16_f32 v108, v28, v29
    v_cvt_pk_bf16_f32 v109, v30, v31
    v_cvt_pk_bf16_f32 v110, v40, v41
    v_cvt_pk_bf16_f32 v111, v42, v43
    v_cvt_pk_bf16_f32 v112, v76, v77
    v_cvt_pk_bf16_f32 v113, v78, v79
    v_cvt_pk_bf16_f32 v114, v88, v89
    v_cvt_pk_bf16_f32 v115, v90, v91
    v_mov_b32 v116, v108
    v_mov_b32 v117, v109
    v_mov_b32 v118, v110
    v_mov_b32 v119, v111
    s_add_u32 s35, s33, 594048
    v_mov_b32_dpp v116, v112 row_ror:8 row_mask:0xf bank_mask:0x3
    v_mov_b32_dpp v117, v113 row_ror:8 row_mask:0xf bank_mask:0x3
    v_mov_b32_dpp v118, v114 row_ror:8 row_mask:0xf bank_mask:0x3
    v_mov_b32_dpp v119, v115 row_ror:8 row_mask:0xf bank_mask:0x3
    v_mov_b32_dpp v108, v112 row_ror:8 row_mask:0xf bank_mask:0xc
    v_mov_b32_dpp v109, v113 row_ror:8 row_mask:0xf bank_mask:0xc
    v_mov_b32_dpp v110, v114 row_ror:8 row_mask:0xf bank_mask:0xc
    v_mov_b32_dpp v111, v115 row_ror:8 row_mask:0xf bank_mask:0xc
    buffer_store_dwordx4 v[108:111], v222, s[16:19], s35 offen sc1
    buffer_store_dwordx4 v[116:119], v223, s[16:19], s35 offen sc1
    v_cvt_pk_bf16_f32 v120, v32, v33
    v_cvt_pk_bf16_f32 v121, v34, v35
    v_cvt_pk_bf16_f32 v122, v44, v45
    v_cvt_pk_bf16_f32 v123, v46, v47
    v_cvt_pk_bf16_f32 v124, v80, v81
    v_cvt_pk_bf16_f32 v125, v82, v83
    v_cvt_pk_bf16_f32 v126, v92, v93
    v_cvt_pk_bf16_f32 v127, v94, v95
    v_mov_b32 v128, v120
    v_mov_b32 v129, v121
    v_mov_b32 v130, v122
    v_mov_b32 v131, v123
    s_add_u32 s35, s33, 1187968
    v_mov_b32_dpp v128, v124 row_ror:8 row_mask:0xf bank_mask:0x3
    v_mov_b32_dpp v129, v125 row_ror:8 row_mask:0xf bank_mask:0x3
    v_mov_b32_dpp v130, v126 row_ror:8 row_mask:0xf bank_mask:0x3
    v_mov_b32_dpp v131, v127 row_ror:8 row_mask:0xf bank_mask:0x3
    v_mov_b32_dpp v120, v124 row_ror:8 row_mask:0xf bank_mask:0xc
    v_mov_b32_dpp v121, v125 row_ror:8 row_mask:0xf bank_mask:0xc
    v_mov_b32_dpp v122, v126 row_ror:8 row_mask:0xf bank_mask:0xc
    v_mov_b32_dpp v123, v127 row_ror:8 row_mask:0xf bank_mask:0xc
    buffer_store_dwordx4 v[120:123], v222, s[16:19], s35 offen sc1
    buffer_store_dwordx4 v[128:131], v223, s[16:19], s35 offen sc1
    s_endpgm
L_gemm1_kernel_loader:
    s_sub_u32 s20, s20, 4
    v_and_b32 v1, 63, v0
    v_lshrrev_b32 v4, 3, v1
    v_and_b32 v5, 7, v1
    v_xor_b32 v5, v5, v4
    v_lshlrev_b32 v5, 4, v5
    v_lshl_add_u32 v2, v4, 11, v5
    v_lshlrev_b32 v3, 4, v1
    s_add_u32 s24, s20, 0
    s_lshl_b32 s40, s24, 10
    s_lshl_b32 s43, s24, 14
    s_add_u32 s24, s20, 4
    s_lshl_b32 s41, s24, 10
    s_lshl_b32 s44, s24, 14
    s_add_u32 s24, s20, 8
    s_lshl_b32 s42, s24, 10
    s_lshl_b32 s45, s24, 14
    s_mul_i32 s46, s20, 4096
    s_add_u32 s47, s46, 12288
    s_add_u32 m0, s40, 0
    s_add_u32 s24, s43, 0
    buffer_load_dwordx4 v2, s[8:11], s24 offen lds
    s_add_u32 m0, s41, 0
    s_add_u32 s24, s44, 0
    buffer_load_dwordx4 v2, s[8:11], s24 offen lds
    s_add_u32 m0, s42, 0
    s_add_u32 s24, s45, 0
    buffer_load_dwordx4 v2, s[8:11], s24 offen lds
    s_add_u32 m0, s47, 0
    s_add_u32 s24, s46, 0
    buffer_load_dwordx4 v3, s[12:15], s24 offen offset:0 lds
    buffer_load_dwordx4 v3, s[12:15], s24 offen offset:1024 lds
    buffer_load_dwordx4 v3, s[12:15], s24 offen offset:2048 lds
    buffer_load_dwordx4 v3, s[12:15], s24 offen offset:3072 lds
    s_add_u32 m0, s40, 28672
    s_add_u32 s24, s43, 128
    buffer_load_dwordx4 v2, s[8:11], s24 offen lds
    s_add_u32 m0, s41, 28672
    s_add_u32 s24, s44, 128
    buffer_load_dwordx4 v2, s[8:11], s24 offen lds
    s_add_u32 m0, s42, 28672
    s_add_u32 s24, s45, 128
    buffer_load_dwordx4 v2, s[8:11], s24 offen lds
    s_add_u32 m0, s47, 28672
    s_add_u32 s24, s46, 32768
    buffer_load_dwordx4 v3, s[12:15], s24 offen offset:0 lds
    buffer_load_dwordx4 v3, s[12:15], s24 offen offset:1024 lds
    buffer_load_dwordx4 v3, s[12:15], s24 offen offset:2048 lds
    buffer_load_dwordx4 v3, s[12:15], s24 offen offset:3072 lds
    s_waitcnt vmcnt(7)
    s_barrier
    s_add_u32 m0, s40, 57344
    s_add_u32 s24, s43, 256
    buffer_load_dwordx4 v2, s[8:11], s24 offen lds
    s_add_u32 m0, s41, 57344
    s_add_u32 s24, s44, 256
    buffer_load_dwordx4 v2, s[8:11], s24 offen lds
    s_add_u32 m0, s42, 57344
    s_add_u32 s24, s45, 256
    buffer_load_dwordx4 v2, s[8:11], s24 offen lds
    s_add_u32 m0, s47, 57344
    s_add_u32 s24, s46, 65536
    buffer_load_dwordx4 v3, s[12:15], s24 offen offset:0 lds
    buffer_load_dwordx4 v3, s[12:15], s24 offen offset:1024 lds
    buffer_load_dwordx4 v3, s[12:15], s24 offen offset:2048 lds
    buffer_load_dwordx4 v3, s[12:15], s24 offen offset:3072 lds
    s_waitcnt vmcnt(7)
    s_barrier
    s_add_u32 m0, s40, 86016
    s_add_u32 s24, s43, 384
    buffer_load_dwordx4 v2, s[8:11], s24 offen lds
    s_add_u32 m0, s41, 86016
    s_add_u32 s24, s44, 384
    buffer_load_dwordx4 v2, s[8:11], s24 offen lds
    s_add_u32 m0, s42, 86016
    s_add_u32 s24, s45, 384
    buffer_load_dwordx4 v2, s[8:11], s24 offen lds
    s_add_u32 m0, s47, 86016
    s_add_u32 s24, s46, 98304
    buffer_load_dwordx4 v3, s[12:15], s24 offen offset:0 lds
    buffer_load_dwordx4 v3, s[12:15], s24 offen offset:1024 lds
    buffer_load_dwordx4 v3, s[12:15], s24 offen offset:2048 lds
    buffer_load_dwordx4 v3, s[12:15], s24 offen offset:3072 lds
    s_add_u32 m0, s40, 114688
    s_add_u32 s24, s43, 512
    buffer_load_dwordx4 v2, s[8:11], s24 offen lds
    s_add_u32 m0, s41, 114688
    s_add_u32 s24, s44, 512
    buffer_load_dwordx4 v2, s[8:11], s24 offen lds
    s_add_u32 m0, s42, 114688
    s_add_u32 s24, s45, 512
    buffer_load_dwordx4 v2, s[8:11], s24 offen lds
    s_add_u32 m0, s47, 114688
    s_add_u32 s24, s46, 131072
    buffer_load_dwordx4 v3, s[12:15], s24 offen offset:0 lds
    buffer_load_dwordx4 v3, s[12:15], s24 offen offset:1024 lds
    buffer_load_dwordx4 v3, s[12:15], s24 offen offset:2048 lds
    buffer_load_dwordx4 v3, s[12:15], s24 offen offset:3072 lds
    s_waitcnt vmcnt(14)
    s_barrier
    s_add_u32 m0, s40, 0
    s_add_u32 s24, s43, 640
    buffer_load_dwordx4 v2, s[8:11], s24 offen lds
    s_add_u32 m0, s41, 0
    s_add_u32 s24, s44, 640
    buffer_load_dwordx4 v2, s[8:11], s24 offen lds
    s_add_u32 m0, s42, 0
    s_add_u32 s24, s45, 640
    buffer_load_dwordx4 v2, s[8:11], s24 offen lds
    s_add_u32 m0, s47, 0
    s_add_u32 s24, s46, 163840
    buffer_load_dwordx4 v3, s[12:15], s24 offen offset:0 lds
    buffer_load_dwordx4 v3, s[12:15], s24 offen offset:1024 lds
    buffer_load_dwordx4 v3, s[12:15], s24 offen offset:2048 lds
    buffer_load_dwordx4 v3, s[12:15], s24 offen offset:3072 lds
    s_add_u32 m0, s40, 28672
    s_add_u32 s24, s43, 768
    buffer_load_dwordx4 v2, s[8:11], s24 offen lds
    s_add_u32 m0, s41, 28672
    s_add_u32 s24, s44, 768
    buffer_load_dwordx4 v2, s[8:11], s24 offen lds
    s_add_u32 m0, s42, 28672
    s_add_u32 s24, s45, 768
    buffer_load_dwordx4 v2, s[8:11], s24 offen lds
    s_add_u32 m0, s47, 28672
    s_add_u32 s24, s46, 196608
    buffer_load_dwordx4 v3, s[12:15], s24 offen offset:0 lds
    buffer_load_dwordx4 v3, s[12:15], s24 offen offset:1024 lds
    buffer_load_dwordx4 v3, s[12:15], s24 offen offset:2048 lds
    buffer_load_dwordx4 v3, s[12:15], s24 offen offset:3072 lds
    s_waitcnt vmcnt(21)
    s_barrier
    s_add_u32 m0, s40, 57344
    s_add_u32 s24, s43, 896
    buffer_load_dwordx4 v2, s[8:11], s24 offen lds
    s_add_u32 m0, s41, 57344
    s_add_u32 s24, s44, 896
    buffer_load_dwordx4 v2, s[8:11], s24 offen lds
    s_add_u32 m0, s42, 57344
    s_add_u32 s24, s45, 896
    buffer_load_dwordx4 v2, s[8:11], s24 offen lds
    s_add_u32 m0, s47, 57344
    s_add_u32 s24, s46, 229376
    buffer_load_dwordx4 v3, s[12:15], s24 offen offset:0 lds
    buffer_load_dwordx4 v3, s[12:15], s24 offen offset:1024 lds
    buffer_load_dwordx4 v3, s[12:15], s24 offen offset:2048 lds
    buffer_load_dwordx4 v3, s[12:15], s24 offen offset:3072 lds
    s_waitcnt vmcnt(21)
    s_barrier
    s_add_u32 m0, s40, 86016
    s_add_u32 s24, s43, 1024
    buffer_load_dwordx4 v2, s[8:11], s24 offen lds
    s_add_u32 m0, s41, 86016
    s_add_u32 s24, s44, 1024
    buffer_load_dwordx4 v2, s[8:11], s24 offen lds
    s_add_u32 m0, s42, 86016
    s_add_u32 s24, s45, 1024
    buffer_load_dwordx4 v2, s[8:11], s24 offen lds
    s_add_u32 m0, s47, 86016
    s_add_u32 s24, s46, 262144
    buffer_load_dwordx4 v3, s[12:15], s24 offen offset:0 lds
    buffer_load_dwordx4 v3, s[12:15], s24 offen offset:1024 lds
    buffer_load_dwordx4 v3, s[12:15], s24 offen offset:2048 lds
    buffer_load_dwordx4 v3, s[12:15], s24 offen offset:3072 lds
    s_waitcnt vmcnt(21)
    s_barrier
    s_add_u32 m0, s40, 114688
    s_add_u32 s24, s43, 1152
    buffer_load_dwordx4 v2, s[8:11], s24 offen lds
    s_add_u32 m0, s41, 114688
    s_add_u32 s24, s44, 1152
    buffer_load_dwordx4 v2, s[8:11], s24 offen lds
    s_add_u32 m0, s42, 114688
    s_add_u32 s24, s45, 1152
    buffer_load_dwordx4 v2, s[8:11], s24 offen lds
    s_add_u32 m0, s47, 114688
    s_add_u32 s24, s46, 294912
    buffer_load_dwordx4 v3, s[12:15], s24 offen offset:0 lds
    buffer_load_dwordx4 v3, s[12:15], s24 offen offset:1024 lds
    buffer_load_dwordx4 v3, s[12:15], s24 offen offset:2048 lds
    buffer_load_dwordx4 v3, s[12:15], s24 offen offset:3072 lds
    s_waitcnt vmcnt(21)
    s_barrier
    s_add_u32 m0, s40, 0
    s_add_u32 s24, s43, 1280
    buffer_load_dwordx4 v2, s[8:11], s24 offen lds
    s_add_u32 m0, s41, 0
    s_add_u32 s24, s44, 1280
    buffer_load_dwordx4 v2, s[8:11], s24 offen lds
    s_add_u32 m0, s42, 0
    s_add_u32 s24, s45, 1280
    buffer_load_dwordx4 v2, s[8:11], s24 offen lds
    s_add_u32 m0, s47, 0
    s_add_u32 s24, s46, 327680
    buffer_load_dwordx4 v3, s[12:15], s24 offen offset:0 lds
    buffer_load_dwordx4 v3, s[12:15], s24 offen offset:1024 lds
    buffer_load_dwordx4 v3, s[12:15], s24 offen offset:2048 lds
    buffer_load_dwordx4 v3, s[12:15], s24 offen offset:3072 lds
    s_waitcnt vmcnt(21)
    s_barrier
    s_add_u32 m0, s40, 28672
    s_add_u32 s24, s43, 1408
    buffer_load_dwordx4 v2, s[8:11], s24 offen lds
    s_add_u32 m0, s41, 28672
    s_add_u32 s24, s44, 1408
    buffer_load_dwordx4 v2, s[8:11], s24 offen lds
    s_add_u32 m0, s42, 28672
    s_add_u32 s24, s45, 1408
    buffer_load_dwordx4 v2, s[8:11], s24 offen lds
    s_add_u32 m0, s47, 28672
    s_add_u32 s24, s46, 360448
    buffer_load_dwordx4 v3, s[12:15], s24 offen offset:0 lds
    buffer_load_dwordx4 v3, s[12:15], s24 offen offset:1024 lds
    buffer_load_dwordx4 v3, s[12:15], s24 offen offset:2048 lds
    buffer_load_dwordx4 v3, s[12:15], s24 offen offset:3072 lds
    s_waitcnt vmcnt(21)
    s_barrier
    s_add_u32 m0, s40, 57344
    s_add_u32 s24, s43, 1536
    buffer_load_dwordx4 v2, s[8:11], s24 offen lds
    s_add_u32 m0, s41, 57344
    s_add_u32 s24, s44, 1536
    buffer_load_dwordx4 v2, s[8:11], s24 offen lds
    s_add_u32 m0, s42, 57344
    s_add_u32 s24, s45, 1536
    buffer_load_dwordx4 v2, s[8:11], s24 offen lds
    s_add_u32 m0, s47, 57344
    s_add_u32 s24, s46, 393216
    buffer_load_dwordx4 v3, s[12:15], s24 offen offset:0 lds
    buffer_load_dwordx4 v3, s[12:15], s24 offen offset:1024 lds
    buffer_load_dwordx4 v3, s[12:15], s24 offen offset:2048 lds
    buffer_load_dwordx4 v3, s[12:15], s24 offen offset:3072 lds
    s_waitcnt vmcnt(21)
    s_barrier
    s_add_u32 m0, s40, 86016
    s_add_u32 s24, s43, 1664
    buffer_load_dwordx4 v2, s[8:11], s24 offen lds
    s_add_u32 m0, s41, 86016
    s_add_u32 s24, s44, 1664
    buffer_load_dwordx4 v2, s[8:11], s24 offen lds
    s_add_u32 m0, s42, 86016
    s_add_u32 s24, s45, 1664
    buffer_load_dwordx4 v2, s[8:11], s24 offen lds
    s_add_u32 m0, s47, 86016
    s_add_u32 s24, s46, 425984
    buffer_load_dwordx4 v3, s[12:15], s24 offen offset:0 lds
    buffer_load_dwordx4 v3, s[12:15], s24 offen offset:1024 lds
    buffer_load_dwordx4 v3, s[12:15], s24 offen offset:2048 lds
    buffer_load_dwordx4 v3, s[12:15], s24 offen offset:3072 lds
    s_waitcnt vmcnt(21)
    s_barrier
    s_add_u32 m0, s40, 114688
    s_add_u32 s24, s43, 1792
    buffer_load_dwordx4 v2, s[8:11], s24 offen lds
    s_add_u32 m0, s41, 114688
    s_add_u32 s24, s44, 1792
    buffer_load_dwordx4 v2, s[8:11], s24 offen lds
    s_add_u32 m0, s42, 114688
    s_add_u32 s24, s45, 1792
    buffer_load_dwordx4 v2, s[8:11], s24 offen lds
    s_add_u32 m0, s47, 114688
    s_add_u32 s24, s46, 458752
    buffer_load_dwordx4 v3, s[12:15], s24 offen offset:0 lds
    buffer_load_dwordx4 v3, s[12:15], s24 offen offset:1024 lds
    buffer_load_dwordx4 v3, s[12:15], s24 offen offset:2048 lds
    buffer_load_dwordx4 v3, s[12:15], s24 offen offset:3072 lds
    s_waitcnt vmcnt(21)
    s_barrier
    s_add_u32 m0, s40, 0
    s_add_u32 s24, s43, 1920
    buffer_load_dwordx4 v2, s[8:11], s24 offen lds
    s_add_u32 m0, s41, 0
    s_add_u32 s24, s44, 1920
    buffer_load_dwordx4 v2, s[8:11], s24 offen lds
    s_add_u32 m0, s42, 0
    s_add_u32 s24, s45, 1920
    buffer_load_dwordx4 v2, s[8:11], s24 offen lds
    s_add_u32 m0, s47, 0
    s_add_u32 s24, s46, 491520
    buffer_load_dwordx4 v3, s[12:15], s24 offen offset:0 lds
    buffer_load_dwordx4 v3, s[12:15], s24 offen offset:1024 lds
    buffer_load_dwordx4 v3, s[12:15], s24 offen offset:2048 lds
    buffer_load_dwordx4 v3, s[12:15], s24 offen offset:3072 lds
    s_waitcnt vmcnt(21)
    s_barrier
    s_waitcnt vmcnt(14)
    s_barrier
    s_waitcnt vmcnt(7)
    s_barrier
    s_waitcnt vmcnt(0)
    s_barrier
L_gemm1_kernel_done:
    s_endpgm
.globl mid_kernel
.p2align 8
.type mid_kernel,@function
mid_kernel:
    s_cmp_ge_u32 s2, 704
    s_cbranch_scc1 L_mid_kernel_done
    v_readfirstlane_b32 s20, v0
    s_lshr_b32 s20, s20, 6
    s_cmp_ge_u32 s2, 448
    s_cbranch_scc1 L_mid_kernel_g
    s_mov_b32 s3, s2
    s_load_dwordx2 s[6:7], s[0:1], 72
    s_load_dwordx2 s[4:5], s[0:1], 72
    s_cmp_ge_u32 s3, 224
    s_cselect_b32 s24, 1, 0
    s_mul_i32 s25, s24, 224
    s_sub_u32 s25, s3, s25
    s_lshr_b32 s26, s25, 3
    s_and_b32 s27, s25, 7
    v_and_b32 v1, 63, v0
    v_lshrrev_b32 v2, 3, v1
    v_mul_u32_u24 v2, 1024, v2
    v_bfe_u32 v3, v1, 2, 1
    v_lshl_add_u32 v2, v3, 6, v2
    v_lshrrev_b32 v3, 5, v1
    v_lshlrev_b32 v3, 1, v3
    v_and_b32 v4, 3, v1
    v_xor_b32 v3, v3, v4
    v_lshl_add_u32 v2, v3, 4, v2
    s_mul_i32 s28, s26, 6
    s_lshl_b32 s29, s20, 1
    s_add_u32 s28, s28, s29
    s_sub_u32 s28, s28, 1
    s_mul_i32 s30, s27, 128
    s_add_u32 s31, s28, 0
    s_mul_i32 s32, s31, 37120
    s_add_u32 s32, s32, s30
    s_cmp_lt_i32 s31, 0
    s_cselect_b32 s32, 0x7f000000, s32
    v_add_u32 v3, s32, v2
    s_add_u32 s31, s28, 1
    s_mul_i32 s32, s31, 37120
    s_add_u32 s32, s32, s30
    s_cmp_lt_i32 s31, 0
    s_cselect_b32 s32, 0x7f000000, s32
    v_add_u32 v4, s32, v2
    s_waitcnt lgkmcnt(0)
    s_mul_i32 s33, s24, 6199040
    s_add_u32 s33, s33, 38871040
    s_add_u32 s8, s6, s33
    s_addc_u32 s9, s7, 0
    s_mov_b32 s10, 6199040
    s_mov_b32 s11, 0x00020000
    s_add_u32 s12, s6, 85499904
    s_addc_u32 s13, s7, 0
    s_mov_b32 s14, 16384
    s_mov_b32 s15, 0x00020000
    s_lshl_b32 s34, s20, 13
    s_add_u32 m0, s34, 0
    s_mov_b32 s35, 0
    buffer_load_dwordx4 v3, s[8:11], s35 offen lds
    s_add_u32 m0, s34, 1024
    s_mov_b32 s35, 8192
    buffer_load_dwordx4 v3, s[8:11], s35 offen lds
    s_add_u32 m0, s34, 2048
    s_mov_b32 s35, 16384
    buffer_load_dwordx4 v3, s[8:11], s35 offen lds
    s_add_u32 m0, s34, 3072
    s_mov_b32 s35, 24576
    buffer_load_dwordx4 v3, s[8:11], s35 offen lds
    s_add_u32 m0, s34, 4096
    s_mov_b32 s35, 0
    buffer_load_dwordx4 v4, s[8:11], s35 offen lds
    s_add_u32 m0, s34, 5120
    s_mov_b32 s35, 8192
    buffer_load_dwordx4 v4, s[8:11], s35 offen lds
    s_add_u32 m0, s34, 6144
    s_mov_b32 s35, 16384
    buffer_load_dwordx4 v4, s[8:11], s35 offen lds
    s_add_u32 m0, s34, 7168
    s_mov_b32 s35, 24576
    buffer_load_dwordx4 v4, s[8:11], s35 offen lds
    v_lshlrev_b32 v5, 4, v1
    s_mov_b32 s35, 8192
    buffer_load_dwordx4 v[8:11], v5, s[12:15], s35 offen
    s_mov_b32 s35, 9216
    buffer_load_dwordx4 v[12:15], v5, s[12:15], s35 offen
    s_mov_b32 s35, 10240
    buffer_load_dwordx4 v[16:19], v5, s[12:15], s35 offen
    s_mov_b32 s35, 11264
    buffer_load_dwordx4 v[20:23], v5, s[12:15], s35 offen
    s_mov_b32 s35, 12288
    buffer_load_dwordx4 v[24:27], v5, s[12:15], s35 offen
    s_mov_b32 s35, 13312
    buffer_load_dwordx4 v[28:31], v5, s[12:15], s35 offen
    s_lshl_b32 s35, s20, 11
    buffer_load_dwordx4 v[32:35], v5, s[12:15], s35 offen offset:0
    buffer_load_dwordx4 v[36:39], v5, s[12:15], s35 offen offset:1024
    v_bfe_u32 v40, v1, 2, 2
    v_lshrrev_b32 v41, 4, v1
    v_and_b32 v42, 3, v1
    v_lshl_add_u32 v43, v41, 3, v40
    v_lshlrev_b32 v46, 6, v43
    v_and_b32 v47, 1, v41
    v_lshlrev_b32 v47, 1, v47
    v_lshrrev_b32 v48, 1, v42
    v_xor_b32 v47, v47, v48
    v_lshl_add_u32 v46, v47, 4, v46
    v_and_b32 v48, 1, v42
    v_lshl_add_u32 v46, v48, 3, v46
    v_add_u32 v44, s34, v46
    v_xor_b32 v45, 32, v44
    v_add_u32 v49, 43008, v46
    v_xor_b32 v50, 32, v49
    v_add_u32 v47, 1, v43
    v_bfe_u32 v48, v47, 3, 1
    v_lshlrev_b32 v48, 1, v48
    v_lshrrev_b32 v55, 1, v42
    v_xor_b32 v48, v48, v55
    v_lshlrev_b32 v47, 6, v47
    v_lshl_add_u32 v47, v48, 4, v47
    v_and_b32 v48, 1, v42
    v_lshl_add_u32 v47, v48, 3, v47
    v_add_u32 v51, 32704, v47
    v_xor_b32 v52, 32, v51
    v_add_u32 v47, 5, v43
    v_bfe_u32 v48, v47, 3, 1
    v_lshlrev_b32 v48, 1, v48
    v_lshrrev_b32 v55, 1, v42
    v_xor_b32 v48, v48, v55
    v_lshlrev_b32 v47, 6, v47
    v_lshl_add_u32 v47, v48, 4, v47
    v_and_b32 v48, 1, v42
    v_lshl_add_u32 v47, v48, 3, v47
    v_add_u32 v53, 32704, v47
    v_xor_b32 v54, 32, v53
    v_and_b32 v47, 1, v1
    v_mul_u32_u24 v55, 10304, v47
    v_bfe_u32 v48, v1, 1, 3
    v_lshl_add_u32 v55, v48, 6, v55
    v_lshl_add_u32 v55, v41, 4, v55
    s_mul_i32 s35, s20, 3072
    s_add_u32 s35, s35, 31680
    v_add_u32 v56, s35, v55
    v_xor_b32 v57, 32, v56
    s_mul_i32 s35, s20, 48
    s_sub_u32 s35, s35, 17
    v_add_u32 v122, v48, v47
    v_add_u32 v122, s35, v122
    s_mov_b32 s35, 344064
    v_mul_lo_u32 v58, v48, s35
    v_and_b32 v47, 1, v1
    v_lshl_add_u32 v58, v47, 6, v58
    v_lshl_add_u32 v58, v41, 4, v58
    s_mov_b32 s36, 0xbdd2d3e8
    v_mov_b32 v59, 0xc0135761
    s_mov_b32 s42, 0xbdd2d3e8
    s_mov_b32 s43, 0xbdd2d3e8
    v_mov_b32 v120, 0xc0135761
    v_mov_b32 v121, 0xc0135761
    s_add_u32 s16, s4, 51269632
    s_addc_u32 s17, s5, 0
    s_mov_b32 s18, 11010048
    s_mov_b32 s19, 0x00020000
    s_mul_i32 s37, s20, 2752512
    s_mul_i32 s38, s24, 84
    s_mul_i32 s39, s26, 3
    s_add_u32 s38, s38, s39
    s_lshl_b32 s38, s38, 11
    s_add_u32 s37, s37, s38
    s_lshl_b32 s38, s27, 7
    s_add_u32 s37, s37, s38
    s_waitcnt vmcnt(2)
    ds_read_b64_tr_b16 v[60:61], v44 offset:0
    ds_read_b64_tr_b16 v[62:63], v44 offset:256
    ds_read_b64_tr_b16 v[64:65], v44 offset:2048
    ds_read_b64_tr_b16 v[66:67], v44 offset:2304
    ds_read_b64_tr_b16 v[68:69], v45 offset:0
    ds_read_b64_tr_b16 v[70:71], v45 offset:256
    ds_read_b64_tr_b16 v[72:73], v45 offset:2048
    ds_read_b64_tr_b16 v[74:75], v45 offset:2304
    s_waitcnt lgkmcnt(0)
    v_mfma_f32_16x16x32_bf16 v[76:79], v[60:63], v[8:11], 0
    v_mfma_f32_16x16x32_bf16 v[80:83], v[68:71], v[8:11], 0
    v_mfma_f32_16x16x32_bf16 v[84:87], v[60:63], v[16:19], 0
    v_mfma_f32_16x16x32_bf16 v[88:91], v[68:71], v[16:19], 0
    v_mfma_f32_16x16x32_bf16 v[92:95], v[60:63], v[24:27], 0
    v_mfma_f32_16x16x32_bf16 v[96:99], v[68:71], v[24:27], 0
    v_mfma_f32_16x16x32_bf16 v[76:79], v[64:67], v[12:15], v[76:79]
    v_mfma_f32_16x16x32_bf16 v[80:83], v[72:75], v[12:15], v[80:83]
    v_mfma_f32_16x16x32_bf16 v[84:87], v[64:67], v[20:23], v[84:87]
    v_mfma_f32_16x16x32_bf16 v[88:91], v[72:75], v[20:23], v[88:91]
    v_mfma_f32_16x16x32_bf16 v[92:95], v[64:67], v[28:31], v[92:95]
    v_mfma_f32_16x16x32_bf16 v[96:99], v[72:75], v[28:31], v[96:99]
    s_add_u32 s31, s28, 0
    s_cmp_eq_u32 s31, 166
    s_cselect_b32 s39, 0, -1
    s_nop 4
    v_mul_f32 v100, v76, v76
    v_mul_f32 v101, v77, v77
    v_mul_f32 v102, v78, v78
    v_mul_f32 v103, v79, v79
    v_mul_f32 v104, v80, v80
    v_mul_f32 v105, v81, v81
    v_mul_f32 v106, v82, v82
    v_mul_f32 v107, v83, v83
    v_fma_f32 v100, v100, s36, v59
    v_fma_f32 v101, v101, s36, v59
    v_fma_f32 v102, v102, s36, v59
    v_fma_f32 v103, v103, s36, v59
    v_fma_f32 v104, v104, s36, v59
    v_fma_f32 v105, v105, s36, v59
    v_fma_f32 v106, v106, s36, v59
    v_fma_f32 v107, v107, s36, v59
    v_mul_f32 v100, v100, v76
    v_mul_f32 v101, v101, v77
    v_mul_f32 v102, v102, v78
    v_mul_f32 v103, v103, v79
    v_mul_f32 v104, v104, v80
    v_mul_f32 v105, v105, v81
    v_mul_f32 v106, v106, v82
    v_mul_f32 v107, v107, v83
    v_exp_f32 v100, v100
    v_exp_f32 v101, v101
    v_exp_f32 v102, v102
    v_exp_f32 v103, v103
    v_exp_f32 v104, v104
    v_exp_f32 v105, v105
    v_exp_f32 v106, v106
    v_exp_f32 v107, v107
    v_add_f32 v100, 1.0, v100
    v_add_f32 v101, 1.0, v101
    v_add_f32 v102, 1.0, v102
    v_add_f32 v103, 1.0, v103
    v_add_f32 v104, 1.0, v104
    v_add_f32 v105, 1.0, v105
    v_add_f32 v106, 1.0, v106
    v_add_f32 v107, 1.0, v107
    v_rcp_f32 v100, v100
    v_rcp_f32 v101, v101
    v_rcp_f32 v102, v102
    v_rcp_f32 v103, v103
    v_rcp_f32 v104, v104
    v_rcp_f32 v105, v105
    v_rcp_f32 v106, v106
    v_rcp_f32 v107, v107
    v_mul_f32 v76, v76, v100
    v_mul_f32 v77, v77, v101
    v_mul_f32 v78, v78, v102
    v_mul_f32 v79, v79, v103
    v_mul_f32 v80, v80, v104
    v_mul_f32 v81, v81, v105
    v_mul_f32 v82, v82, v106
    v_mul_f32 v83, v83, v107
    v_cvt_pk_bf16_f32 v108, v76, v77
    v_cvt_pk_bf16_f32 v109, v78, v79
    v_cvt_pk_bf16_f32 v110, v80, v81
    v_cvt_pk_bf16_f32 v111, v82, v83
    v_add_u32 v123, 0, v122
    v_cmp_gt_u32 vcc, 160, v123
    s_nop 0
    s_and_saveexec_b64 s[40:41], vcc
    ds_write_b128 v56, v[108:111] offset:0
    s_mov_b64 exec, s[40:41]
    v_mul_f32 v100, v84, v84
    v_mul_f32 v101, v85, v85
    v_mul_f32 v102, v86, v86
    v_mul_f32 v103, v87, v87
    v_mul_f32 v104, v88, v88
    v_mul_f32 v105, v89, v89
    v_mul_f32 v106, v90, v90
    v_mul_f32 v107, v91, v91
    v_fma_f32 v100, v100, s36, v59
    v_fma_f32 v101, v101, s36, v59
    v_fma_f32 v102, v102, s36, v59
    v_fma_f32 v103, v103, s36, v59
    v_fma_f32 v104, v104, s36, v59
    v_fma_f32 v105, v105, s36, v59
    v_fma_f32 v106, v106, s36, v59
    v_fma_f32 v107, v107, s36, v59
    v_mul_f32 v100, v100, v84
    v_mul_f32 v101, v101, v85
    v_mul_f32 v102, v102, v86
    v_mul_f32 v103, v103, v87
    v_mul_f32 v104, v104, v88
    v_mul_f32 v105, v105, v89
    v_mul_f32 v106, v106, v90
    v_mul_f32 v107, v107, v91
    v_exp_f32 v100, v100
    v_exp_f32 v101, v101
    v_exp_f32 v102, v102
    v_exp_f32 v103, v103
    v_exp_f32 v104, v104
    v_exp_f32 v105, v105
    v_exp_f32 v106, v106
    v_exp_f32 v107, v107
    v_add_f32 v100, 1.0, v100
    v_add_f32 v101, 1.0, v101
    v_add_f32 v102, 1.0, v102
    v_add_f32 v103, 1.0, v103
    v_add_f32 v104, 1.0, v104
    v_add_f32 v105, 1.0, v105
    v_add_f32 v106, 1.0, v106
    v_add_f32 v107, 1.0, v107
    v_rcp_f32 v100, v100
    v_rcp_f32 v101, v101
    v_rcp_f32 v102, v102
    v_rcp_f32 v103, v103
    v_rcp_f32 v104, v104
    v_rcp_f32 v105, v105
    v_rcp_f32 v106, v106
    v_rcp_f32 v107, v107
    v_mul_f32 v84, v84, v100
    v_mul_f32 v85, v85, v101
    v_mul_f32 v86, v86, v102
    v_mul_f32 v87, v87, v103
    v_mul_f32 v88, v88, v104
    v_mul_f32 v89, v89, v105
    v_mul_f32 v90, v90, v106
    v_mul_f32 v91, v91, v107
    v_cvt_pk_bf16_f32 v112, v84, v85
    v_cvt_pk_bf16_f32 v113, v86, v87
    v_cvt_pk_bf16_f32 v114, v88, v89
    v_cvt_pk_bf16_f32 v115, v90, v91
    v_add_u32 v123, 8, v122
    v_cmp_gt_u32 vcc, 160, v123
    s_nop 0
    s_and_saveexec_b64 s[40:41], vcc
    ds_write_b128 v57, v[112:115] offset:512
    s_mov_b64 exec, s[40:41]
    v_mul_f32 v100, v92, v92
    v_mul_f32 v101, v93, v93
    v_mul_f32 v102, v94, v94
    v_mul_f32 v103, v95, v95
    v_mul_f32 v104, v96, v96
    v_mul_f32 v105, v97, v97
    v_mul_f32 v106, v98, v98
    v_mul_f32 v107, v99, v99
    v_fma_f32 v100, v100, s36, v59
    v_fma_f32 v101, v101, s36, v59
    v_fma_f32 v102, v102, s36, v59
    v_fma_f32 v103, v103, s36, v59
    v_fma_f32 v104, v104, s36, v59
    v_fma_f32 v105, v105, s36, v59
    v_fma_f32 v106, v106, s36, v59
    v_fma_f32 v107, v107, s36, v59
    v_mul_f32 v100, v100, v92
    v_mul_f32 v101, v101, v93
    v_mul_f32 v102, v102, v94
    v_mul_f32 v103, v103, v95
    v_mul_f32 v104, v104, v96
    v_mul_f32 v105, v105, v97
    v_mul_f32 v106, v106, v98
    v_mul_f32 v107, v107, v99
    v_exp_f32 v100, v100
    v_exp_f32 v101, v101
    v_exp_f32 v102, v102
    v_exp_f32 v103, v103
    v_exp_f32 v104, v104
    v_exp_f32 v105, v105
    v_exp_f32 v106, v106
    v_exp_f32 v107, v107
    v_add_f32 v100, 1.0, v100
    v_add_f32 v101, 1.0, v101
    v_add_f32 v102, 1.0, v102
    v_add_f32 v103, 1.0, v103
    v_add_f32 v104, 1.0, v104
    v_add_f32 v105, 1.0, v105
    v_add_f32 v106, 1.0, v106
    v_add_f32 v107, 1.0, v107
    v_rcp_f32 v100, v100
    v_rcp_f32 v101, v101
    v_rcp_f32 v102, v102
    v_rcp_f32 v103, v103
    v_rcp_f32 v104, v104
    v_rcp_f32 v105, v105
    v_rcp_f32 v106, v106
    v_rcp_f32 v107, v107
    v_mul_f32 v92, v92, v100
    v_mul_f32 v93, v93, v101
    v_mul_f32 v94, v94, v102
    v_mul_f32 v95, v95, v103
    v_mul_f32 v96, v96, v104
    v_mul_f32 v97, v97, v105
    v_mul_f32 v98, v98, v106
    v_mul_f32 v99, v99, v107
    v_cvt_pk_bf16_f32 v116, v92, v93
    v_cvt_pk_bf16_f32 v117, v94, v95
    v_cvt_pk_bf16_f32 v118, v96, v97
    v_cvt_pk_bf16_f32 v119, v98, v99
    v_and_b32 v116, s39, v116
    v_and_b32 v117, s39, v117
    v_and_b32 v118, s39, v118
    v_and_b32 v119, s39, v119
    v_add_u32 v123, 16, v122
    v_cmp_gt_u32 vcc, 160, v123
    s_nop 0
    s_and_saveexec_b64 s[40:41], vcc
    ds_write_b128 v56, v[116:119] offset:1024
    s_mov_b64 exec, s[40:41]
    ds_read_b64_tr_b16 v[60:61], v44 offset:4096
    ds_read_b64_tr_b16 v[62:63], v44 offset:4352
    ds_read_b64_tr_b16 v[64:65], v44 offset:6144
    ds_read_b64_tr_b16 v[66:67], v44 offset:6400
    ds_read_b64_tr_b16 v[68:69], v45 offset:4096
    ds_read_b64_tr_b16 v[70:71], v45 offset:4352
    ds_read_b64_tr_b16 v[72:73], v45 offset:6144
    ds_read_b64_tr_b16 v[74:75], v45 offset:6400
    s_waitcnt lgkmcnt(0)
    v_mfma_f32_16x16x32_bf16 v[76:79], v[60:63], v[8:11], 0
    v_mfma_f32_16x16x32_bf16 v[80:83], v[68:71], v[8:11], 0
    v_mfma_f32_16x16x32_bf16 v[84:87], v[60:63], v[16:19], 0
    v_mfma_f32_16x16x32_bf16 v[88:91], v[68:71], v[16:19], 0
    v_mfma_f32_16x16x32_bf16 v[92:95], v[60:63], v[24:27], 0
    v_mfma_f32_16x16x32_bf16 v[96:99], v[68:71], v[24:27], 0
    v_mfma_f32_16x16x32_bf16 v[76:79], v[64:67], v[12:15], v[76:79]
    v_mfma_f32_16x16x32_bf16 v[80:83], v[72:75], v[12:15], v[80:83]
    v_mfma_f32_16x16x32_bf16 v[84:87], v[64:67], v[20:23], v[84:87]
    v_mfma_f32_16x16x32_bf16 v[88:91], v[72:75], v[20:23], v[88:91]
    v_mfma_f32_16x16x32_bf16 v[92:95], v[64:67], v[28:31], v[92:95]
    v_mfma_f32_16x16x32_bf16 v[96:99], v[72:75], v[28:31], v[96:99]
    s_add_u32 s31, s28, 1
    s_cmp_eq_u32 s31, 166
    s_cselect_b32 s39, 0, -1
    s_nop 4
    v_mul_f32 v100, v76, v76
    v_mul_f32 v101, v77, v77
    v_mul_f32 v102, v78, v78
    v_mul_f32 v103, v79, v79
    v_mul_f32 v104, v80, v80
    v_mul_f32 v105, v81, v81
    v_mul_f32 v106, v82, v82
    v_mul_f32 v107, v83, v83
    v_fma_f32 v100, v100, s36, v59
    v_fma_f32 v101, v101, s36, v59
    v_fma_f32 v102, v102, s36, v59
    v_fma_f32 v103, v103, s36, v59
    v_fma_f32 v104, v104, s36, v59
    v_fma_f32 v105, v105, s36, v59
    v_fma_f32 v106, v106, s36, v59
    v_fma_f32 v107, v107, s36, v59
    v_mul_f32 v100, v100, v76
    v_mul_f32 v101, v101, v77
    v_mul_f32 v102, v102, v78
    v_mul_f32 v103, v103, v79
    v_mul_f32 v104, v104, v80
    v_mul_f32 v105, v105, v81
    v_mul_f32 v106, v106, v82
    v_mul_f32 v107, v107, v83
    v_exp_f32 v100, v100
    v_exp_f32 v101, v101
    v_exp_f32 v102, v102
    v_exp_f32 v103, v103
    v_exp_f32 v104, v104
    v_exp_f32 v105, v105
    v_exp_f32 v106, v106
    v_exp_f32 v107, v107
    v_add_f32 v100, 1.0, v100
    v_add_f32 v101, 1.0, v101
    v_add_f32 v102, 1.0, v102
    v_add_f32 v103, 1.0, v103
    v_add_f32 v104, 1.0, v104
    v_add_f32 v105, 1.0, v105
    v_add_f32 v106, 1.0, v106
    v_add_f32 v107, 1.0, v107
    v_rcp_f32 v100, v100
    v_rcp_f32 v101, v101
    v_rcp_f32 v102, v102
    v_rcp_f32 v103, v103
    v_rcp_f32 v104, v104
    v_rcp_f32 v105, v105
    v_rcp_f32 v106, v106
    v_rcp_f32 v107, v107
    v_mul_f32 v76, v76, v100
    v_mul_f32 v77, v77, v101
    v_mul_f32 v78, v78, v102
    v_mul_f32 v79, v79, v103
    v_mul_f32 v80, v80, v104
    v_mul_f32 v81, v81, v105
    v_mul_f32 v82, v82, v106
    v_mul_f32 v83, v83, v107
    v_cvt_pk_bf16_f32 v108, v76, v77
    v_cvt_pk_bf16_f32 v109, v78, v79
    v_cvt_pk_bf16_f32 v110, v80, v81
    v_cvt_pk_bf16_f32 v111, v82, v83
    v_add_u32 v123, 24, v122
    v_cmp_gt_u32 vcc, 160, v123
    s_nop 0
    s_and_saveexec_b64 s[40:41], vcc
    ds_write_b128 v57, v[108:111] offset:1536
    s_mov_b64 exec, s[40:41]
    v_mul_f32 v100, v84, v84
    v_mul_f32 v101, v85, v85
    v_mul_f32 v102, v86, v86
    v_mul_f32 v103, v87, v87
    v_mul_f32 v104, v88, v88
    v_mul_f32 v105, v89, v89
    v_mul_f32 v106, v90, v90
    v_mul_f32 v107, v91, v91
    v_fma_f32 v100, v100, s36, v59
    v_fma_f32 v101, v101, s36, v59
    v_fma_f32 v102, v102, s36, v59
    v_fma_f32 v103, v103, s36, v59
    v_fma_f32 v104, v104, s36, v59
    v_fma_f32 v105, v105, s36, v59
    v_fma_f32 v106, v106, s36, v59
    v_fma_f32 v107, v107, s36, v59
    v_mul_f32 v100, v100, v84
    v_mul_f32 v101, v101, v85
    v_mul_f32 v102, v102, v86
    v_mul_f32 v103, v103, v87
    v_mul_f32 v104, v104, v88
    v_mul_f32 v105, v105, v89
    v_mul_f32 v106, v106, v90
    v_mul_f32 v107, v107, v91
    v_exp_f32 v100, v100
    v_exp_f32 v101, v101
    v_exp_f32 v102, v102
    v_exp_f32 v103, v103
    v_exp_f32 v104, v104
    v_exp_f32 v105, v105
    v_exp_f32 v106, v106
    v_exp_f32 v107, v107
    v_add_f32 v100, 1.0, v100
    v_add_f32 v101, 1.0, v101
    v_add_f32 v102, 1.0, v102
    v_add_f32 v103, 1.0, v103
    v_add_f32 v104, 1.0, v104
    v_add_f32 v105, 1.0, v105
    v_add_f32 v106, 1.0, v106
    v_add_f32 v107, 1.0, v107
    v_rcp_f32 v100, v100
    v_rcp_f32 v101, v101
    v_rcp_f32 v102, v102
    v_rcp_f32 v103, v103
    v_rcp_f32 v104, v104
    v_rcp_f32 v105, v105
    v_rcp_f32 v106, v106
    v_rcp_f32 v107, v107
    v_mul_f32 v84, v84, v100
    v_mul_f32 v85, v85, v101
    v_mul_f32 v86, v86, v102
    v_mul_f32 v87, v87, v103
    v_mul_f32 v88, v88, v104
    v_mul_f32 v89, v89, v105
    v_mul_f32 v90, v90, v106
    v_mul_f32 v91, v91, v107
    v_cvt_pk_bf16_f32 v112, v84, v85
    v_cvt_pk_bf16_f32 v113, v86, v87
    v_cvt_pk_bf16_f32 v114, v88, v89
    v_cvt_pk_bf16_f32 v115, v90, v91
    v_add_u32 v123, 32, v122
    v_cmp_gt_u32 vcc, 160, v123
    s_nop 0
    s_and_saveexec_b64 s[40:41], vcc
    ds_write_b128 v56, v[112:115] offset:2048
    s_mov_b64 exec, s[40:41]
    v_mul_f32 v100, v92, v92
    v_mul_f32 v101, v93, v93
    v_mul_f32 v102, v94, v94
    v_mul_f32 v103, v95, v95
    v_mul_f32 v104, v96, v96
    v_mul_f32 v105, v97, v97
    v_mul_f32 v106, v98, v98
    v_mul_f32 v107, v99, v99
    v_fma_f32 v100, v100, s36, v59
    v_fma_f32 v101, v101, s36, v59
    v_fma_f32 v102, v102, s36, v59
    v_fma_f32 v103, v103, s36, v59
    v_fma_f32 v104, v104, s36, v59
    v_fma_f32 v105, v105, s36, v59
    v_fma_f32 v106, v106, s36, v59
    v_fma_f32 v107, v107, s36, v59
    v_mul_f32 v100, v100, v92
    v_mul_f32 v101, v101, v93
    v_mul_f32 v102, v102, v94
    v_mul_f32 v103, v103, v95
    v_mul_f32 v104, v104, v96
    v_mul_f32 v105, v105, v97
    v_mul_f32 v106, v106, v98
    v_mul_f32 v107, v107, v99
    v_exp_f32 v100, v100
    v_exp_f32 v101, v101
    v_exp_f32 v102, v102
    v_exp_f32 v103, v103
    v_exp_f32 v104, v104
    v_exp_f32 v105, v105
    v_exp_f32 v106, v106
    v_exp_f32 v107, v107
    v_add_f32 v100, 1.0, v100
    v_add_f32 v101, 1.0, v101
    v_add_f32 v102, 1.0, v102
    v_add_f32 v103, 1.0, v103
    v_add_f32 v104, 1.0, v104
    v_add_f32 v105, 1.0, v105
    v_add_f32 v106, 1.0, v106
    v_add_f32 v107, 1.0, v107
    v_rcp_f32 v100, v100
    v_rcp_f32 v101, v101
    v_rcp_f32 v102, v102
    v_rcp_f32 v103, v103
    v_rcp_f32 v104, v104
    v_rcp_f32 v105, v105
    v_rcp_f32 v106, v106
    v_rcp_f32 v107, v107
    v_mul_f32 v92, v92, v100
    v_mul_f32 v93, v93, v101
    v_mul_f32 v94, v94, v102
    v_mul_f32 v95, v95, v103
    v_mul_f32 v96, v96, v104
    v_mul_f32 v97, v97, v105
    v_mul_f32 v98, v98, v106
    v_mul_f32 v99, v99, v107
    v_cvt_pk_bf16_f32 v116, v92, v93
    v_cvt_pk_bf16_f32 v117, v94, v95
    v_cvt_pk_bf16_f32 v118, v96, v97
    v_cvt_pk_bf16_f32 v119, v98, v99
    v_and_b32 v116, s39, v116
    v_and_b32 v117, s39, v117
    v_and_b32 v118, s39, v118
    v_and_b32 v119, s39, v119
    v_add_u32 v123, 40, v122
    v_cmp_gt_u32 vcc, 160, v123
    s_nop 0
    s_and_saveexec_b64 s[40:41], vcc
    ds_write_b128 v57, v[116:119] offset:2560
    s_mov_b64 exec, s[40:41]
    s_waitcnt vmcnt(0)
    s_waitcnt lgkmcnt(0)
    s_barrier
    ds_read_b64_tr_b16 v[60:61], v49 offset:0
    ds_read_b64_tr_b16 v[62:63], v49 offset:256
    ds_read_b64_tr_b16 v[64:65], v49 offset:2048
    ds_read_b64_tr_b16 v[66:67], v49 offset:2304
    ds_read_b64_tr_b16 v[68:69], v50 offset:0
    ds_read_b64_tr_b16 v[70:71], v50 offset:256
    ds_read_b64_tr_b16 v[72:73], v50 offset:2048
    ds_read_b64_tr_b16 v[74:75], v50 offset:2304
    s_waitcnt lgkmcnt(0)
    v_mfma_f32_16x16x32_bf16 v[92:95], v[60:63], v[32:35], 0
    v_mfma_f32_16x16x32_bf16 v[96:99], v[68:71], v[32:35], 0
    v_mfma_f32_16x16x32_bf16 v[92:95], v[64:67], v[36:39], v[92:95]
    v_mfma_f32_16x16x32_bf16 v[96:99], v[72:75], v[36:39], v[96:99]
    ds_read_b64_tr_b16 v[76:77], v51 offset:0
    ds_read_b64_tr_b16 v[78:79], v53 offset:0
    ds_read_b64_tr_b16 v[80:81], v51 offset:2048
    ds_read_b64_tr_b16 v[82:83], v53 offset:2048
    ds_read_b64_tr_b16 v[84:85], v52 offset:0
    ds_read_b64_tr_b16 v[86:87], v54 offset:0
    ds_read_b64_tr_b16 v[88:89], v52 offset:2048
    ds_read_b64_tr_b16 v[90:91], v54 offset:2048
    v_cvt_pk_bf16_f32 v108, v92, v93
    v_cvt_pk_bf16_f32 v109, v94, v95
    v_cvt_pk_bf16_f32 v110, v96, v97
    v_cvt_pk_bf16_f32 v111, v98, v99
    s_add_u32 s38, s37, 0
    buffer_store_dwordx4 v[108:111], v58, s[16:19], s38 offen sc1
    s_waitcnt lgkmcnt(0)
    v_mfma_f32_16x16x32_bf16 v[100:103], v[76:79], v[32:35], 0
    v_mfma_f32_16x16x32_bf16 v[104:107], v[84:87], v[32:35], 0
    v_mfma_f32_16x16x32_bf16 v[100:103], v[80:83], v[36:39], v[100:103]
    v_mfma_f32_16x16x32_bf16 v[104:107], v[88:91], v[36:39], v[104:107]
    ds_read_b64_tr_b16 v[60:61], v49 offset:3072
    ds_read_b64_tr_b16 v[62:63], v49 offset:3328
    ds_read_b64_tr_b16 v[64:65], v49 offset:5120
    ds_read_b64_tr_b16 v[66:67], v49 offset:5376
    ds_read_b64_tr_b16 v[68:69], v50 offset:3072
    ds_read_b64_tr_b16 v[70:71], v50 offset:3328
    ds_read_b64_tr_b16 v[72:73], v50 offset:5120
    ds_read_b64_tr_b16 v[74:75], v50 offset:5376
    v_cvt_pk_bf16_f32 v112, v100, v101
    v_cvt_pk_bf16_f32 v113, v102, v103
    v_cvt_pk_bf16_f32 v114, v104, v105
    v_cvt_pk_bf16_f32 v115, v106, v107
    s_add_u32 s38, s37, 1024
    buffer_store_dwordx4 v[112:115], v58, s[16:19], s38 offen sc1
    s_waitcnt lgkmcnt(0)
    v_mfma_f32_16x16x32_bf16 v[92:95], v[60:63], v[32:35], 0
    v_mfma_f32_16x16x32_bf16 v[96:99], v[68:71], v[32:35], 0
    v_mfma_f32_16x16x32_bf16 v[92:95], v[64:67], v[36:39], v[92:95]
    v_mfma_f32_16x16x32_bf16 v[96:99], v[72:75], v[36:39], v[96:99]
    ds_read_b64_tr_b16 v[76:77], v51 offset:3072
    ds_read_b64_tr_b16 v[78:79], v53 offset:3072
    ds_read_b64_tr_b16 v[80:81], v51 offset:5120
    ds_read_b64_tr_b16 v[82:83], v53 offset:5120
    ds_read_b64_tr_b16 v[84:85], v52 offset:3072
    ds_read_b64_tr_b16 v[86:87], v54 offset:3072
    ds_read_b64_tr_b16 v[88:89], v52 offset:5120
    ds_read_b64_tr_b16 v[90:91], v54 offset:5120
    v_cvt_pk_bf16_f32 v108, v92, v93
    v_cvt_pk_bf16_f32 v109, v94, v95
    v_cvt_pk_bf16_f32 v110, v96, v97
    v_cvt_pk_bf16_f32 v111, v98, v99
    s_add_u32 s38, s37, 2048
    buffer_store_dwordx4 v[108:111], v58, s[16:19], s38 offen sc1
    s_waitcnt lgkmcnt(0)
    v_mfma_f32_16x16x32_bf16 v[100:103], v[76:79], v[32:35], 0
    v_mfma_f32_16x16x32_bf16 v[104:107], v[84:87], v[32:35], 0
    v_mfma_f32_16x16x32_bf16 v[100:103], v[80:83], v[36:39], v[100:103]
    v_mfma_f32_16x16x32_bf16 v[104:107], v[88:91], v[36:39], v[104:107]
    ds_read_b64_tr_b16 v[60:61], v49 offset:6144
    ds_read_b64_tr_b16 v[62:63], v49 offset:6400
    ds_read_b64_tr_b16 v[64:65], v49 offset:8192
    ds_read_b64_tr_b16 v[66:67], v49 offset:8448
    ds_read_b64_tr_b16 v[68:69], v50 offset:6144
    ds_read_b64_tr_b16 v[70:71], v50 offset:6400
    ds_read_b64_tr_b16 v[72:73], v50 offset:8192
    ds_read_b64_tr_b16 v[74:75], v50 offset:8448
    v_cvt_pk_bf16_f32 v112, v100, v101
    v_cvt_pk_bf16_f32 v113, v102, v103
    v_cvt_pk_bf16_f32 v114, v104, v105
    v_cvt_pk_bf16_f32 v115, v106, v107
    s_add_u32 s38, s37, 3072
    buffer_store_dwordx4 v[112:115], v58, s[16:19], s38 offen sc1
    s_waitcnt lgkmcnt(0)
    v_mfma_f32_16x16x32_bf16 v[92:95], v[60:63], v[32:35], 0
    v_mfma_f32_16x16x32_bf16 v[96:99], v[68:71], v[32:35], 0
    v_mfma_f32_16x16x32_bf16 v[92:95], v[64:67], v[36:39], v[92:95]
    v_mfma_f32_16x16x32_bf16 v[96:99], v[72:75], v[36:39], v[96:99]
    ds_read_b64_tr_b16 v[76:77], v51 offset:6144
    ds_read_b64_tr_b16 v[78:79], v53 offset:6144
    ds_read_b64_tr_b16 v[80:81], v51 offset:8192
    ds_read_b64_tr_b16 v[82:83], v53 offset:8192
    ds_read_b64_tr_b16 v[84:85], v52 offset:6144
    ds_read_b64_tr_b16 v[86:87], v54 offset:6144
    ds_read_b64_tr_b16 v[88:89], v52 offset:8192
    ds_read_b64_tr_b16 v[90:91], v54 offset:8192
    v_cvt_pk_bf16_f32 v108, v92, v93
    v_cvt_pk_bf16_f32 v109, v94, v95
    v_cvt_pk_bf16_f32 v110, v96, v97
    v_cvt_pk_bf16_f32 v111, v98, v99
    s_add_u32 s38, s37, 4096
    buffer_store_dwordx4 v[108:111], v58, s[16:19], s38 offen sc1
    s_waitcnt lgkmcnt(0)
    v_mfma_f32_16x16x32_bf16 v[100:103], v[76:79], v[32:35], 0
    v_mfma_f32_16x16x32_bf16 v[104:107], v[84:87], v[32:35], 0
    v_mfma_f32_16x16x32_bf16 v[100:103], v[80:83], v[36:39], v[100:103]
    v_mfma_f32_16x16x32_bf16 v[104:107], v[88:91], v[36:39], v[104:107]
    s_nop 7
    v_cvt_pk_bf16_f32 v112, v100, v101
    v_cvt_pk_bf16_f32 v113, v102, v103
    v_cvt_pk_bf16_f32 v114, v104, v105
    v_cvt_pk_bf16_f32 v115, v106, v107
    s_add_u32 s38, s37, 5120
    buffer_store_dwordx4 v[112:115], v58, s[16:19], s38 offen sc1
    s_endpgm
L_mid_kernel_g:
    s_sub_u32 s3, s2, 448
    s_load_dwordx2 s[4:5], s[0:1], 16
    s_load_dwordx2 s[6:7], s[0:1], 72
    s_lshr_b32 s24, s3, 4
    s_bfe_u32 s25, s3, 0x20002
    s_and_b32 s26, s3, 3
    s_lshr_b32 s27, s24, 3
    s_and_b32 s28, s24, 7
    v_and_b32 v1, 63, v0
    v_lshrrev_b32 v2, 3, v1
    v_mov_b32 v3, v2
    s_lshl_b32 s29, s25, 3
    s_lshl_b32 s30, s28, 5
    s_add_u32 s29, s29, s30
    v_add_u32 v3, s29, v3
    v_lshlrev_b32 v3, 9, v3
    v_and_b32 v4, 7, v1
    s_lshr_b32 s30, s20, 1
    s_lshl_b32 s30, s30, 2
    v_xor_b32 v4, s30, v4
    v_lshl_add_u32 v3, v4, 4, v3
    s_lshl_b32 s30, s26, 7
    v_add_u32 v3, s30, v3
    v_xor_b32 v4, 32, v3
    s_waitcnt lgkmcnt(0)
    s_mov_b32 s8, s4
    s_mov_b32 s9, s5
    s_mov_b32 s10, 4063232
    s_mov_b32 s11, 0x00020000
    s_add_u32 s12, s6, 62345216
    s_addc_u32 s13, s7, 0
    s_mov_b32 s14, 16916480
    s_mov_b32 s15, 0x00020000
    s_lshl_b32 s30, s20, 3
    s_add_u32 s30, s30, s27
    s_lshl_b32 s30, s30, 17
    s_mul_i32 s31, s20, 4608
    s_add_u32 m0, s31, 0
    s_add_u32 s32, s30, 0
    buffer_load_dwordx4 v3, s[8:11], s32 offen nt lds
    s_add_u32 m0, s31, 1152
    s_add_u32 s32, s30, 262144
    buffer_load_dwordx4 v3, s[8:11], s32 offen nt lds
    s_add_u32 m0, s31, 2304
    s_add_u32 s32, s30, 524288
    buffer_load_dwordx4 v4, s[8:11], s32 offen nt lds
    s_add_u32 m0, s31, 3456
    s_add_u32 s32, s30, 786432
    buffer_load_dwordx4 v4, s[8:11], s32 offen nt lds
    v_and_b32 v8, 15, v1
    v_or_b32 v9, 1, v8
    s_lshl_b32 s33, s20, 4
    v_add_u32 v9, s33, v9
    v_cvt_f32_u32 v9, v9
    v_mul_f32 v9, 0x3c000000, v9
    v_bfe_u32 v10, v1, 4, 1
    v_lshlrev_b32 v10, 3, v10
    v_cvt_f32_u32 v10, v10
    v_and_b32 v8, 1, v8
    v_cvt_f32_u32 v8, v8
    v_mul_f32 v8, 0x3f400000, v8
    v_fma_f32 v11, v9, v10, v8
    v_fract_f32 v12, v11
    v_add_f32 v11, v11, v9
    v_fract_f32 v13, v11
    v_add_f32 v11, v11, v9
    v_fract_f32 v14, v11
    v_add_f32 v11, v11, v9
    v_fract_f32 v15, v11
    v_add_f32 v11, v11, v9
    v_fract_f32 v16, v11
    v_add_f32 v11, v11, v9
    v_fract_f32 v17, v11
    v_add_f32 v11, v11, v9
    v_fract_f32 v18, v11
    v_add_f32 v11, v11, v9
    v_fract_f32 v19, v11
    v_cos_f32 v12, v12
    v_cos_f32 v13, v13
    v_cos_f32 v14, v14
    v_cos_f32 v15, v15
    v_cos_f32 v16, v16
    v_cos_f32 v17, v17
    v_cos_f32 v18, v18
    v_cos_f32 v19, v19
    s_nop 0
    v_mul_f32 v12, 0x3d000000, v12
    v_mul_f32 v13, 0x3d000000, v13
    v_mul_f32 v14, 0x3d000000, v14
    v_mul_f32 v15, 0x3d000000, v15
    v_mul_f32 v16, 0x3d000000, v16
    v_mul_f32 v17, 0x3d000000, v17
    v_mul_f32 v18, 0x3d000000, v18
    v_mul_f32 v19, 0x3d000000, v19
    v_cvt_pk_bf16_f32 v20, v12, v13
    v_cvt_pk_bf16_f32 v21, v14, v15
    v_cvt_pk_bf16_f32 v22, v16, v17
    v_cvt_pk_bf16_f32 v23, v18, v19
    v_lshlrev_b32 v28, 16, v20
    v_and_b32 v29, 0xffff0000, v20
    v_sub_f32 v28, v12, v28
    v_sub_f32 v29, v13, v29
    v_cvt_pk_bf16_f32 v24, v28, v29
    v_lshlrev_b32 v28, 16, v21
    v_and_b32 v29, 0xffff0000, v21
    v_sub_f32 v28, v14, v28
    v_sub_f32 v29, v15, v29
    v_cvt_pk_bf16_f32 v25, v28, v29
    v_lshlrev_b32 v28, 16, v22
    v_and_b32 v29, 0xffff0000, v22
    v_sub_f32 v28, v16, v28
    v_sub_f32 v29, v17, v29
    v_cvt_pk_bf16_f32 v26, v28, v29
    v_lshlrev_b32 v28, 16, v23
    v_and_b32 v29, 0xffff0000, v23
    v_sub_f32 v28, v18, v28
    v_sub_f32 v29, v19, v29
    v_cvt_pk_bf16_f32 v27, v28, v29
    v_cmp_gt_u32 vcc, 32, v1
    s_nop 1
    v_cndmask_b32 v20, v24, v20, vcc
    v_cndmask_b32 v21, v25, v21, vcc
    v_cndmask_b32 v22, v26, v22, vcc
    v_cndmask_b32 v23, v27, v23, vcc
    v_lshlrev_b32 v28, 4, v1
    s_lshl_b32 s33, s20, 10
    v_add_u32 v29, s33, v28
    ds_write_b128 v29, v[20:23] offset:18432
    v_bfe_u32 v30, v1, 2, 2
    v_bfe_u32 v31, v1, 4, 1
    v_lshl_add_u32 v32, v31, 3, v30
    v_mul_u32_u24 v32, 1152, v32
    v_lshrrev_b32 v30, 1, v30
    v_lshl_add_u32 v30, v31, 1, v30
    v_lshlrev_b32 v30, 1, v30
    v_bfe_u32 v31, v1, 1, 1
    s_lshl_b32 s33, s20, 1
    v_add_u32 v31, s33, v31
    v_xor_b32 v30, v30, v31
    v_lshl_add_u32 v32, v30, 4, v32
    v_and_b32 v30, 1, v1
    v_lshl_add_u32 v32, v30, 3, v32
    v_lshrrev_b32 v30, 4, v1
    s_mov_b32 s33, 1057280
    v_mul_lo_u32 v30, v30, s33
    v_and_b32 v31, 15, v1
    v_lshl_add_u32 v33, v31, 4, v30
    s_lshl_b32 s34, s24, 15
    s_lshl_b32 s35, s26, 2
    s_add_u32 s35, s35, s20
    s_lshl_b32 s35, s35, 11
    s_add_u32 s34, s34, s35
    s_lshl_b32 s35, s25, 8
    s_add_u32 s34, s34, s35
    s_waitcnt vmcnt(0) lgkmcnt(0)
    s_barrier
    ds_read_b128 v[36:39], v28 offset:18432
    ds_read_b128 v[40:43], v28 offset:19456
    ds_read_b128 v[44:47], v28 offset:20480
    ds_read_b128 v[48:51], v28 offset:21504
    ds_read_b64_tr_b16 v[52:53], v32 offset:0
    ds_read_b64_tr_b16 v[54:55], v32 offset:4608
    ds_read_b64_tr_b16 v[56:57], v32 offset:128
    ds_read_b64_tr_b16 v[58:59], v32 offset:4736
    ds_read_b64_tr_b16 v[60:61], v32 offset:256
    ds_read_b64_tr_b16 v[62:63], v32 offset:4864
    ds_read_b64_tr_b16 v[64:65], v32 offset:384
    ds_read_b64_tr_b16 v[66:67], v32 offset:4992
    ds_read_b64_tr_b16 v[68:69], v32 offset:512
    ds_read_b64_tr_b16 v[70:71], v32 offset:5120
    s_waitcnt lgkmcnt(8)
    ds_read_b64_tr_b16 v[72:73], v32 offset:640
    ds_read_b64_tr_b16 v[74:75], v32 offset:5248
    ds_read_b64_tr_b16 v[76:77], v32 offset:768
    ds_read_b64_tr_b16 v[78:79], v32 offset:5376
    ds_read_b64_tr_b16 v[80:81], v32 offset:896
    ds_read_b64_tr_b16 v[82:83], v32 offset:5504
    s_waitcnt lgkmcnt(0)
    v_mfma_f32_16x16x32_bf16 v[84:87], v[36:39], v[52:55], 0
    v_mfma_f32_16x16x32_bf16 v[88:91], v[36:39], v[56:59], 0
    v_mfma_f32_16x16x32_bf16 v[92:95], v[36:39], v[60:63], 0
    v_mfma_f32_16x16x32_bf16 v[96:99], v[36:39], v[64:67], 0
    v_mfma_f32_16x16x32_bf16 v[100:103], v[36:39], v[68:71], 0
    v_mfma_f32_16x16x32_bf16 v[104:107], v[36:39], v[72:75], 0
    v_mfma_f32_16x16x32_bf16 v[108:111], v[36:39], v[76:79], 0
    v_mfma_f32_16x16x32_bf16 v[112:115], v[36:39], v[80:83], 0
    s_nop 7
    v_cvt_pk_bf16_f32 v116, v84, v88
    v_cvt_pk_bf16_f32 v117, v92, v96
    v_cvt_pk_bf16_f32 v118, v100, v104
    v_cvt_pk_bf16_f32 v119, v108, v112
    s_add_u32 s35, s34, 0
    buffer_store_dwordx4 v[116:119], v33, s[12:15], s35 offen sc1
    s_nop 1
    v_cvt_pk_bf16_f32 v120, v85, v89
    v_cvt_pk_bf16_f32 v121, v93, v97
    v_cvt_pk_bf16_f32 v122, v101, v105
    v_cvt_pk_bf16_f32 v123, v109, v113
    s_add_u32 s35, s34, 1024
    buffer_store_dwordx4 v[120:123], v33, s[12:15], s35 offen sc1
    s_nop 1
    v_cvt_pk_bf16_f32 v116, v86, v90
    v_cvt_pk_bf16_f32 v117, v94, v98
    v_cvt_pk_bf16_f32 v118, v102, v106
    v_cvt_pk_bf16_f32 v119, v110, v114
    s_add_u32 s35, s34, 528640
    buffer_store_dwordx4 v[116:119], v33, s[12:15], s35 offen sc1
    s_nop 1
    v_cvt_pk_bf16_f32 v120, v87, v91
    v_cvt_pk_bf16_f32 v121, v95, v99
    v_cvt_pk_bf16_f32 v122, v103, v107
    v_cvt_pk_bf16_f32 v123, v111, v115
    s_add_u32 s35, s34, 529664
    buffer_store_dwordx4 v[120:123], v33, s[12:15], s35 offen sc1
    s_nop 1
    v_mfma_f32_16x16x32_bf16 v[84:87], v[40:43], v[52:55], 0
    v_mfma_f32_16x16x32_bf16 v[88:91], v[40:43], v[56:59], 0
    v_mfma_f32_16x16x32_bf16 v[92:95], v[40:43], v[60:63], 0
    v_mfma_f32_16x16x32_bf16 v[96:99], v[40:43], v[64:67], 0
    v_mfma_f32_16x16x32_bf16 v[100:103], v[40:43], v[68:71], 0
    v_mfma_f32_16x16x32_bf16 v[104:107], v[40:43], v[72:75], 0
    v_mfma_f32_16x16x32_bf16 v[108:111], v[40:43], v[76:79], 0
    v_mfma_f32_16x16x32_bf16 v[112:115], v[40:43], v[80:83], 0
    s_nop 7
    v_cvt_pk_bf16_f32 v116, v84, v88
    v_cvt_pk_bf16_f32 v117, v92, v96
    v_cvt_pk_bf16_f32 v118, v100, v104
    v_cvt_pk_bf16_f32 v119, v108, v112
    s_add_u32 s35, s34, 4229120
    buffer_store_dwordx4 v[116:119], v33, s[12:15], s35 offen sc1
    s_nop 1
    v_cvt_pk_bf16_f32 v120, v85, v89
    v_cvt_pk_bf16_f32 v121, v93, v97
    v_cvt_pk_bf16_f32 v122, v101, v105
    v_cvt_pk_bf16_f32 v123, v109, v113
    s_add_u32 s35, s34, 4230144
    buffer_store_dwordx4 v[120:123], v33, s[12:15], s35 offen sc1
    s_nop 1
    v_cvt_pk_bf16_f32 v116, v86, v90
    v_cvt_pk_bf16_f32 v117, v94, v98
    v_cvt_pk_bf16_f32 v118, v102, v106
    v_cvt_pk_bf16_f32 v119, v110, v114
    s_add_u32 s35, s34, 4757760
    buffer_store_dwordx4 v[116:119], v33, s[12:15], s35 offen sc1
    s_nop 1
    v_cvt_pk_bf16_f32 v120, v87, v91
    v_cvt_pk_bf16_f32 v121, v95, v99
    v_cvt_pk_bf16_f32 v122, v103, v107
    v_cvt_pk_bf16_f32 v123, v111, v115
    s_add_u32 s35, s34, 4758784
    buffer_store_dwordx4 v[120:123], v33, s[12:15], s35 offen sc1
    s_nop 1
    v_mfma_f32_16x16x32_bf16 v[84:87], v[44:47], v[52:55], 0
    v_mfma_f32_16x16x32_bf16 v[88:91], v[44:47], v[56:59], 0
    v_mfma_f32_16x16x32_bf16 v[92:95], v[44:47], v[60:63], 0
    v_mfma_f32_16x16x32_bf16 v[96:99], v[44:47], v[64:67], 0
    v_mfma_f32_16x16x32_bf16 v[100:103], v[44:47], v[68:71], 0
    v_mfma_f32_16x16x32_bf16 v[104:107], v[44:47], v[72:75], 0
    v_mfma_f32_16x16x32_bf16 v[108:111], v[44:47], v[76:79], 0
    v_mfma_f32_16x16x32_bf16 v[112:115], v[44:47], v[80:83], 0
    s_nop 7
    v_cvt_pk_bf16_f32 v116, v84, v88
    v_cvt_pk_bf16_f32 v117, v92, v96
    v_cvt_pk_bf16_f32 v118, v100, v104
    v_cvt_pk_bf16_f32 v119, v108, v112
    s_add_u32 s35, s34, 8458240
    buffer_store_dwordx4 v[116:119], v33, s[12:15], s35 offen sc1
    s_nop 1
    v_cvt_pk_bf16_f32 v120, v85, v89
    v_cvt_pk_bf16_f32 v121, v93, v97
    v_cvt_pk_bf16_f32 v122, v101, v105
    v_cvt_pk_bf16_f32 v123, v109, v113
    s_add_u32 s35, s34, 8459264
    buffer_store_dwordx4 v[120:123], v33, s[12:15], s35 offen sc1
    s_nop 1
    v_cvt_pk_bf16_f32 v116, v86, v90
    v_cvt_pk_bf16_f32 v117, v94, v98
    v_cvt_pk_bf16_f32 v118, v102, v106
    v_cvt_pk_bf16_f32 v119, v110, v114
    s_add_u32 s35, s34, 8986880
    buffer_store_dwordx4 v[116:119], v33, s[12:15], s35 offen sc1
    s_nop 1
    v_cvt_pk_bf16_f32 v120, v87, v91
    v_cvt_pk_bf16_f32 v121, v95, v99
    v_cvt_pk_bf16_f32 v122, v103, v107
    v_cvt_pk_bf16_f32 v123, v111, v115
    s_add_u32 s35, s34, 8987904
    buffer_store_dwordx4 v[120:123], v33, s[12:15], s35 offen sc1
    s_nop 1
    v_mfma_f32_16x16x32_bf16 v[84:87], v[48:51], v[52:55], 0
    v_mfma_f32_16x16x32_bf16 v[88:91], v[48:51], v[56:59], 0
    v_mfma_f32_16x16x32_bf16 v[92:95], v[48:51], v[60:63], 0
    v_mfma_f32_16x16x32_bf16 v[96:99], v[48:51], v[64:67], 0
    v_mfma_f32_16x16x32_bf16 v[100:103], v[48:51], v[68:71], 0
    v_mfma_f32_16x16x32_bf16 v[104:107], v[48:51], v[72:75], 0
    v_mfma_f32_16x16x32_bf16 v[108:111], v[48:51], v[76:79], 0
    v_mfma_f32_16x16x32_bf16 v[112:115], v[48:51], v[80:83], 0
    s_nop 7
    v_cvt_pk_bf16_f32 v116, v84, v88
    v_cvt_pk_bf16_f32 v117, v92, v96
    v_cvt_pk_bf16_f32 v118, v100, v104
    v_cvt_pk_bf16_f32 v119, v108, v112
    s_add_u32 s35, s34, 12687360
    buffer_store_dwordx4 v[116:119], v33, s[12:15], s35 offen sc1
    s_nop 1
    v_cvt_pk_bf16_f32 v120, v85, v89
    v_cvt_pk_bf16_f32 v121, v93, v97
    v_cvt_pk_bf16_f32 v122, v101, v105
    v_cvt_pk_bf16_f32 v123, v109, v113
    s_add_u32 s35, s34, 12688384
    buffer_store_dwordx4 v[120:123], v33, s[12:15], s35 offen sc1
    s_nop 1
    v_cvt_pk_bf16_f32 v116, v86, v90
    v_cvt_pk_bf16_f32 v117, v94, v98
    v_cvt_pk_bf16_f32 v118, v102, v106
    v_cvt_pk_bf16_f32 v119, v110, v114
    s_add_u32 s35, s34, 13216000
    buffer_store_dwordx4 v[116:119], v33, s[12:15], s35 offen sc1
    s_nop 1
    v_cvt_pk_bf16_f32 v120, v87, v91
    v_cvt_pk_bf16_f32 v121, v95, v99
    v_cvt_pk_bf16_f32 v122, v103, v107
    v_cvt_pk_bf16_f32 v123, v111, v115
    s_add_u32 s35, s34, 13217024
    buffer_store_dwordx4 v[120:123], v33, s[12:15], s35 offen sc1
    s_nop 1
    s_endpgm
L_mid_kernel_done:
    s_endpgm
.globl gemm2_kernel
.p2align 8
.type gemm2_kernel,@function
gemm2_kernel:
    s_cmp_ge_u32 s2, 256
    s_cbranch_scc1 L_gemm2_kernel_done
    s_load_dwordx2 s[4:5], s[0:1], 72
    s_load_dwordx2 s[6:7], s[0:1], 72
    v_readfirstlane_b32 s20, v0
    s_lshr_b32 s20, s20, 6
    s_and_b32 s24, s2, 7
    s_lshr_b32 s25, s2, 3
    s_lshr_b32 s26, s25, 3
    s_lshl_b32 s24, s24, 2
    s_add_u32 s21, s24, s26
    s_and_b32 s25, s25, 7
    s_lshr_b32 s26, s25, 2
    s_and_b32 s27, s25, 3
    s_mul_i32 s22, s26, 84
    s_sub_u32 s28, 168, s22
    s_min_u32 s28, s28, 84
    s_waitcnt lgkmcnt(0)
    s_mul_i32 s29, s21, 344064
    s_lshl_b32 s30, s22, 11
    s_add_u32 s29, s29, s30
    s_add_u32 s29, s29, 51269632
    s_add_u32 s8, s6, s29
    s_addc_u32 s9, s7, 0
    s_lshl_b32 s10, s28, 11
    s_mov_b32 s11, 0x00020000
    s_mul_i32 s29, s21, 528640
    s_mul_i32 s30, s27, 8192
    s_add_u32 s29, s29, s30
    s_add_u32 s29, s29, 62345216
    s_add_u32 s12, s4, s29
    s_addc_u32 s13, s5, 0
    s_mov_b32 s14, 499712
    s_mov_b32 s15, 0x00020000
    s_cmp_ge_u32 s20, 4
    s_cbranch_scc1 L_gemm2_kernel_loader
    s_mul_i32 s29, s22, 37120
    s_add_u32 s29, s29, 79261696
    s_add_u32 s16, s4, s29
    s_addc_u32 s17, s5, 0
    s_mul_i32 s18, s28, 37120
    s_mov_b32 s19, 0x00020000
    s_lshr_b32 s29, s20, 1
    s_and_b32 s30, s20, 1
    v_and_b32 v137, 15, v0
    v_bfe_u32 v138, v0, 4, 2
    v_and_b32 v139, 63, v0
    s_mul_i32 s31, s29, 6144
    v_and_b32 v140, 7, v137
    v_xor_b32 v140, v138, v140
    v_lshlrev_b32 v140, 4, v140
    v_lshl_add_u32 v140, v137, 7, v140
    v_add_u32 v140, s31, v140
    v_add_u32 v128, 0, v140
    v_xor_b32 v131, 64, v128
    v_add_u32 v129, 61440, v140
    v_xor_b32 v132, 64, v129
    v_add_u32 v130, 122880, v140
    v_xor_b32 v133, 64, v130
    s_mul_i32 s31, s30, 4096
    s_add_u32 s31, s31, 12288
    v_lshlrev_b32 v140, 4, v139
    v_add_u32 v140, s31, v140
    v_add_u32 v134, 0, v140
    v_add_u32 v135, 61440, v140
    v_add_u32 v136, 122880, v140
    v_and_b32 v144, 7, v137
    v_lshrrev_b32 v145, 3, v137
    v_mul_u32_u24 v142, 37120, v144
    v_lshl_add_u32 v142, v138, 4, v142
    s_mul_i32 s31, s29, 1781760
    v_add_u32 v142, s31, v142
    v_lshl_add_u32 v142, v145, 6, v142
    v_xor_b32 v145, 64, v142
    v_add_u32 v143, 296960, v145
    s_mul_i32 s31, s27, 2
    s_mul_i32 s29, s30, 1
    s_add_u32 s31, s31, s29
    s_mul_i32 s31, s31, 128
    s_mul_i32 s29, s21, 1024
    s_add_u32 s33, s31, s29
    s_mov_b32 s34, 0x80008000
    s_barrier
    ds_read_b128 v[48:51], v134 offset:0
    ds_read_b128 v[64:67], v128 offset:0
    ds_read_b128 v[72:75], v128 offset:2048
    ds_read_b128 v[80:83], v128 offset:4096
    ds_read_b128 v[56:59], v134 offset:2048
    ds_read_b128 v[68:71], v131 offset:0
    ds_read_b128 v[76:79], v131 offset:2048
    ds_read_b128 v[84:87], v131 offset:4096
    ds_read_b128 v[52:55], v134 offset:1024
    ds_read_b128 v[60:63], v134 offset:3072
    s_waitcnt lgkmcnt(0)
    s_barrier
    v_mfma_f32_16x16x32_bf16 v[0:3], v[48:51], v[64:67], 0
    ds_read_b128 v[88:91], v134 offset:20480
    v_mfma_f32_16x16x32_bf16 v[4:7], v[48:51], v[72:75], 0
    ds_read_b128 v[104:107], v128 offset:20480
    v_mfma_f32_16x16x32_bf16 v[8:11], v[48:51], v[80:83], 0
    ds_read_b128 v[112:115], v128 offset:22528
    v_mfma_f32_16x16x32_bf16 v[12:15], v[56:59], v[64:67], 0
    ds_read_b128 v[120:123], v128 offset:24576
    v_mfma_f32_16x16x32_bf16 v[16:19], v[56:59], v[72:75], 0
    ds_read_b128 v[96:99], v134 offset:22528
    v_mfma_f32_16x16x32_bf16 v[20:23], v[56:59], v[80:83], 0
    ds_read_b128 v[108:111], v131 offset:20480
    v_mfma_f32_16x16x32_bf16 v[24:27], v[48:51], v[68:71], 0
    ds_read_b128 v[116:119], v131 offset:22528
    v_mfma_f32_16x16x32_bf16 v[28:31], v[48:51], v[76:79], 0
    ds_read_b128 v[124:127], v131 offset:24576
    v_mfma_f32_16x16x32_bf16 v[32:35], v[48:51], v[84:87], 0
    ds_read_b128 v[92:95], v134 offset:21504
    v_mfma_f32_16x16x32_bf16 v[36:39], v[56:59], v[68:71], 0
    ds_read_b128 v[100:103], v134 offset:23552
    v_mfma_f32_16x16x32_bf16 v[40:43], v[56:59], v[76:79], 0
    v_mfma_f32_16x16x32_bf16 v[44:47], v[56:59], v[84:87], 0
    v_mfma_f32_16x16x32_bf16 v[24:27], v[52:55], v[64:67], v[24:27]
    v_xor_b32 v68, s34, v68
    v_xor_b32 v69, s34, v69
    v_mfma_f32_16x16x32_bf16 v[28:31], v[52:55], v[72:75], v[28:31]
    v_xor_b32 v70, s34, v70
    v_xor_b32 v71, s34, v71
    v_mfma_f32_16x16x32_bf16 v[32:35], v[52:55], v[80:83], v[32:35]
    v_xor_b32 v76, s34, v76
    v_xor_b32 v77, s34, v77
    v_mfma_f32_16x16x32_bf16 v[36:39], v[60:63], v[64:67], v[36:39]
    v_xor_b32 v78, s34, v78
    v_xor_b32 v79, s34, v79
    v_mfma_f32_16x16x32_bf16 v[40:43], v[60:63], v[72:75], v[40:43]
    v_xor_b32 v84, s34, v84
    v_xor_b32 v85, s34, v85
    v_mfma_f32_16x16x32_bf16 v[44:47], v[60:63], v[80:83], v[44:47]
    v_xor_b32 v86, s34, v86
    v_xor_b32 v87, s34, v87
    v_mfma_f32_16x16x32_bf16 v[0:3], v[52:55], v[68:71], v[0:3]
    v_mfma_f32_16x16x32_bf16 v[4:7], v[52:55], v[76:79], v[4:7]
    v_mfma_f32_16x16x32_bf16 v[8:11], v[52:55], v[84:87], v[8:11]
    s_waitcnt lgkmcnt(0)
    s_barrier
    v_mfma_f32_16x16x32_bf16 v[12:15], v[60:63], v[68:71], v[12:15]
    v_mfma_f32_16x16x32_bf16 v[16:19], v[60:63], v[76:79], v[16:19]
    v_mfma_f32_16x16x32_bf16 v[20:23], v[60:63], v[84:87], v[20:23]
    v_mfma_f32_16x16x32_bf16 v[0:3], v[88:91], v[104:107], v[0:3]
    ds_read_b128 v[48:51], v134 offset:40960
    v_mfma_f32_16x16x32_bf16 v[4:7], v[88:91], v[112:115], v[4:7]
    ds_read_b128 v[64:67], v128 offset:40960
    v_mfma_f32_16x16x32_bf16 v[8:11], v[88:91], v[120:123], v[8:11]
    ds_read_b128 v[72:75], v128 offset:43008
    v_mfma_f32_16x16x32_bf16 v[12:15], v[96:99], v[104:107], v[12:15]
    ds_read_b128 v[80:83], v128 offset:45056
    v_mfma_f32_16x16x32_bf16 v[16:19], v[96:99], v[112:115], v[16:19]
    ds_read_b128 v[56:59], v134 offset:43008
    v_mfma_f32_16x16x32_bf16 v[20:23], v[96:99], v[120:123], v[20:23]
    ds_read_b128 v[68:71], v131 offset:40960
    v_mfma_f32_16x16x32_bf16 v[24:27], v[88:91], v[108:111], v[24:27]
    ds_read_b128 v[76:79], v131 offset:43008
    v_mfma_f32_16x16x32_bf16 v[28:31], v[88:91], v[116:119], v[28:31]
    ds_read_b128 v[84:87], v131 offset:45056
    v_mfma_f32_16x16x32_bf16 v[32:35], v[88:91], v[124:127], v[32:35]
    ds_read_b128 v[52:55], v134 offset:41984
    v_mfma_f32_16x16x32_bf16 v[36:39], v[96:99], v[108:111], v[36:39]
    ds_read_b128 v[60:63], v134 offset:44032
    v_mfma_f32_16x16x32_bf16 v[40:43], v[96:99], v[116:119], v[40:43]
    v_mfma_f32_16x16x32_bf16 v[44:47], v[96:99], v[124:127], v[44:47]
    v_mfma_f32_16x16x32_bf16 v[24:27], v[92:95], v[104:107], v[24:27]
    v_xor_b32 v108, s34, v108
    v_xor_b32 v109, s34, v109
    v_mfma_f32_16x16x32_bf16 v[28:31], v[92:95], v[112:115], v[28:31]
    v_xor_b32 v110, s34, v110
    v_xor_b32 v111, s34, v111
    v_mfma_f32_16x16x32_bf16 v[32:35], v[92:95], v[120:123], v[32:35]
    v_xor_b32 v116, s34, v116
    v_xor_b32 v117, s34, v117
    v_mfma_f32_16x16x32_bf16 v[36:39], v[100:103], v[104:107], v[36:39]
    v_xor_b32 v118, s34, v118
    v_xor_b32 v119, s34, v119
    v_mfma_f32_16x16x32_bf16 v[40:43], v[100:103], v[112:115], v[40:43]
    v_xor_b32 v124, s34, v124
    v_xor_b32 v125, s34, v125
    v_mfma_f32_16x16x32_bf16 v[44:47], v[100:103], v[120:123], v[44:47]
    v_xor_b32 v126, s34, v126
    v_xor_b32 v127, s34, v127
    v_mfma_f32_16x16x32_bf16 v[0:3], v[92:95], v[108:111], v[0:3]
    v_mfma_f32_16x16x32_bf16 v[4:7], v[92:95], v[116:119], v[4:7]
    v_mfma_f32_16x16x32_bf16 v[8:11], v[92:95], v[124:127], v[8:11]
    s_waitcnt lgkmcnt(0)
    s_barrier
    v_mfma_f32_16x16x32_bf16 v[12:15], v[100:103], v[108:111], v[12:15]
    v_mfma_f32_16x16x32_bf16 v[16:19], v[100:103], v[116:119], v[16:19]
    v_mfma_f32_16x16x32_bf16 v[20:23], v[100:103], v[124:127], v[20:23]
    v_mfma_f32_16x16x32_bf16 v[0:3], v[48:51], v[64:67], v[0:3]
    ds_read_b128 v[88:91], v135 offset:0
    v_mfma_f32_16x16x32_bf16 v[4:7], v[48:51], v[72:75], v[4:7]
    ds_read_b128 v[104:107], v129 offset:0
    v_mfma_f32_16x16x32_bf16 v[8:11], v[48:51], v[80:83], v[8:11]
    ds_read_b128 v[112:115], v129 offset:2048
    v_mfma_f32_16x16x32_bf16 v[12:15], v[56:59], v[64:67], v[12:15]
    ds_read_b128 v[120:123], v129 offset:4096
    v_mfma_f32_16x16x32_bf16 v[16:19], v[56:59], v[72:75], v[16:19]
    ds_read_b128 v[96:99], v135 offset:2048
    v_mfma_f32_16x16x32_bf16 v[20:23], v[56:59], v[80:83], v[20:23]
    ds_read_b128 v[108:111], v132 offset:0
    v_mfma_f32_16x16x32_bf16 v[24:27], v[48:51], v[68:71], v[24:27]
    ds_read_b128 v[116:119], v132 offset:2048
    v_mfma_f32_16x16x32_bf16 v[28:31], v[48:51], v[76:79], v[28:31]
    ds_read_b128 v[124:127], v132 offset:4096
    v_mfma_f32_16x16x32_bf16 v[32:35], v[48:51], v[84:87], v[32:35]
    ds_read_b128 v[92:95], v135 offset:1024
    v_mfma_f32_16x16x32_bf16 v[36:39], v[56:59], v[68:71], v[36:39]
    ds_read_b128 v[100:103], v135 offset:3072
    v_mfma_f32_16x16x32_bf16 v[40:43], v[56:59], v[76:79], v[40:43]
    v_mfma_f32_16x16x32_bf16 v[44:47], v[56:59], v[84:87], v[44:47]
    v_mfma_f32_16x16x32_bf16 v[24:27], v[52:55], v[64:67], v[24:27]
    v_xor_b32 v68, s34, v68
    v_xor_b32 v69, s34, v69
    v_mfma_f32_16x16x32_bf16 v[28:31], v[52:55], v[72:75], v[28:31]
    v_xor_b32 v70, s34, v70
    v_xor_b32 v71, s34, v71
    v_mfma_f32_16x16x32_bf16 v[32:35], v[52:55], v[80:83], v[32:35]
    v_xor_b32 v76, s34, v76
    v_xor_b32 v77, s34, v77
    v_mfma_f32_16x16x32_bf16 v[36:39], v[60:63], v[64:67], v[36:39]
    v_xor_b32 v78, s34, v78
    v_xor_b32 v79, s34, v79
    v_mfma_f32_16x16x32_bf16 v[40:43], v[60:63], v[72:75], v[40:43]
    v_xor_b32 v84, s34, v84
    v_xor_b32 v85, s34, v85
    v_mfma_f32_16x16x32_bf16 v[44:47], v[60:63], v[80:83], v[44:47]
    v_xor_b32 v86, s34, v86
    v_xor_b32 v87, s34, v87
    v_mfma_f32_16x16x32_bf16 v[0:3], v[52:55], v[68:71], v[0:3]
    v_mfma_f32_16x16x32_bf16 v[4:7], v[52:55], v[76:79], v[4:7]
    v_mfma_f32_16x16x32_bf16 v[8:11], v[52:55], v[84:87], v[8:11]
    s_waitcnt lgkmcnt(0)
    s_barrier
    v_mfma_f32_16x16x32_bf16 v[12:15], v[60:63], v[68:71], v[12:15]
    v_mfma_f32_16x16x32_bf16 v[16:19], v[60:63], v[76:79], v[16:19]
    v_mfma_f32_16x16x32_bf16 v[20:23], v[60:63], v[84:87], v[20:23]
    v_mfma_f32_16x16x32_bf16 v[0:3], v[88:91], v[104:107], v[0:3]
    ds_read_b128 v[48:51], v135 offset:20480
    v_mfma_f32_16x16x32_bf16 v[4:7], v[88:91], v[112:115], v[4:7]
    ds_read_b128 v[64:67], v129 offset:20480
    v_mfma_f32_16x16x32_bf16 v[8:11], v[88:91], v[120:123], v[8:11]
    ds_read_b128 v[72:75], v129 offset:22528
    v_mfma_f32_16x16x32_bf16 v[12:15], v[96:99], v[104:107], v[12:15]
    ds_read_b128 v[80:83], v129 offset:24576
    v_mfma_f32_16x16x32_bf16 v[16:19], v[96:99], v[112:115], v[16:19]
    ds_read_b128 v[56:59], v135 offset:22528
    v_mfma_f32_16x16x32_bf16 v[20:23], v[96:99], v[120:123], v[20:23]
    ds_read_b128 v[68:71], v132 offset:20480
    v_mfma_f32_16x16x32_bf16 v[24:27], v[88:91], v[108:111], v[24:27]
    ds_read_b128 v[76:79], v132 offset:22528
    v_mfma_f32_16x16x32_bf16 v[28:31], v[88:91], v[116:119], v[28:31]
    ds_read_b128 v[84:87], v132 offset:24576
    v_mfma_f32_16x16x32_bf16 v[32:35], v[88:91], v[124:127], v[32:35]
    ds_read_b128 v[52:55], v135 offset:21504
    v_mfma_f32_16x16x32_bf16 v[36:39], v[96:99], v[108:111], v[36:39]
    ds_read_b128 v[60:63], v135 offset:23552
    v_mfma_f32_16x16x32_bf16 v[40:43], v[96:99], v[116:119], v[40:43]
    v_mfma_f32_16x16x32_bf16 v[44:47], v[96:99], v[124:127], v[44:47]
    v_mfma_f32_16x16x32_bf16 v[24:27], v[92:95], v[104:107], v[24:27]
    v_xor_b32 v108, s34, v108
    v_xor_b32 v109, s34, v109
    v_mfma_f32_16x16x32_bf16 v[28:31], v[92:95], v[112:115], v[28:31]
    v_xor_b32 v110, s34, v110
    v_xor_b32 v111, s34, v111
    v_mfma_f32_16x16x32_bf16 v[32:35], v[92:95], v[120:123], v[32:35]
    v_xor_b32 v116, s34, v116
    v_xor_b32 v117, s34, v117
    v_mfma_f32_16x16x32_bf16 v[36:39], v[100:103], v[104:107], v[36:39]
    v_xor_b32 v118, s34, v118
    v_xor_b32 v119, s34, v119
    v_mfma_f32_16x16x32_bf16 v[40:43], v[100:103], v[112:115], v[40:43]
    v_xor_b32 v124, s34, v124
    v_xor_b32 v125, s34, v125
    v_mfma_f32_16x16x32_bf16 v[44:47], v[100:103], v[120:123], v[44:47]
    v_xor_b32 v126, s34, v126
    v_xor_b32 v127, s34, v127
    v_mfma_f32_16x16x32_bf16 v[0:3], v[92:95], v[108:111], v[0:3]
    v_mfma_f32_16x16x32_bf16 v[4:7], v[92:95], v[116:119], v[4:7]
    v_mfma_f32_16x16x32_bf16 v[8:11], v[92:95], v[124:127], v[8:11]
    s_waitcnt lgkmcnt(0)
    s_barrier
    v_mfma_f32_16x16x32_bf16 v[12:15], v[100:103], v[108:111], v[12:15]
    v_mfma_f32_16x16x32_bf16 v[16:19], v[100:103], v[116:119], v[16:19]
    v_mfma_f32_16x16x32_bf16 v[20:23], v[100:103], v[124:127], v[20:23]
    v_mfma_f32_16x16x32_bf16 v[0:3], v[48:51], v[64:67], v[0:3]
    ds_read_b128 v[88:91], v135 offset:40960
    v_mfma_f32_16x16x32_bf16 v[4:7], v[48:51], v[72:75], v[4:7]
    ds_read_b128 v[104:107], v129 offset:40960
    v_mfma_f32_16x16x32_bf16 v[8:11], v[48:51], v[80:83], v[8:11]
    ds_read_b128 v[112:115], v129 offset:43008
    v_mfma_f32_16x16x32_bf16 v[12:15], v[56:59], v[64:67], v[12:15]
    ds_read_b128 v[120:123], v129 offset:45056
    v_mfma_f32_16x16x32_bf16 v[16:19], v[56:59], v[72:75], v[16:19]
    ds_read_b128 v[96:99], v135 offset:43008
    v_mfma_f32_16x16x32_bf16 v[20:23], v[56:59], v[80:83], v[20:23]
    ds_read_b128 v[108:111], v132 offset:40960
    v_mfma_f32_16x16x32_bf16 v[24:27], v[48:51], v[68:71], v[24:27]
    ds_read_b128 v[116:119], v132 offset:43008
    v_mfma_f32_16x16x32_bf16 v[28:31], v[48:51], v[76:79], v[28:31]
    ds_read_b128 v[124:127], v132 offset:45056
    v_mfma_f32_16x16x32_bf16 v[32:35], v[48:51], v[84:87], v[32:35]
    ds_read_b128 v[92:95], v135 offset:41984
    v_mfma_f32_16x16x32_bf16 v[36:39], v[56:59], v[68:71], v[36:39]
    ds_read_b128 v[100:103], v135 offset:44032
    v_mfma_f32_16x16x32_bf16 v[40:43], v[56:59], v[76:79], v[40:43]
    v_mfma_f32_16x16x32_bf16 v[44:47], v[56:59], v[84:87], v[44:47]
    v_mfma_f32_16x16x32_bf16 v[24:27], v[52:55], v[64:67], v[24:27]
    v_xor_b32 v68, s34, v68
    v_xor_b32 v69, s34, v69
    v_mfma_f32_16x16x32_bf16 v[28:31], v[52:55], v[72:75], v[28:31]
    v_xor_b32 v70, s34, v70
    v_xor_b32 v71, s34, v71
    v_mfma_f32_16x16x32_bf16 v[32:35], v[52:55], v[80:83], v[32:35]
    v_xor_b32 v76, s34, v76
    v_xor_b32 v77, s34, v77
    v_mfma_f32_16x16x32_bf16 v[36:39], v[60:63], v[64:67], v[36:39]
    v_xor_b32 v78, s34, v78
    v_xor_b32 v79, s34, v79
    v_mfma_f32_16x16x32_bf16 v[40:43], v[60:63], v[72:75], v[40:43]
    v_xor_b32 v84, s34, v84
    v_xor_b32 v85, s34, v85
    v_mfma_f32_16x16x32_bf16 v[44:47], v[60:63], v[80:83], v[44:47]
    v_xor_b32 v86, s34, v86
    v_xor_b32 v87, s34, v87
    v_mfma_f32_16x16x32_bf16 v[0:3], v[52:55], v[68:71], v[0:3]
    v_mfma_f32_16x16x32_bf16 v[4:7], v[52:55], v[76:79], v[4:7]
    v_mfma_f32_16x16x32_bf16 v[8:11], v[52:55], v[84:87], v[8:11]
    s_waitcnt lgkmcnt(0)
    s_barrier
    v_mfma_f32_16x16x32_bf16 v[12:15], v[60:63], v[68:71], v[12:15]
    v_mfma_f32_16x16x32_bf16 v[16:19], v[60:63], v[76:79], v[16:19]
    v_mfma_f32_16x16x32_bf16 v[20:23], v[60:63], v[84:87], v[20:23]
    v_mfma_f32_16x16x32_bf16 v[0:3], v[88:91], v[104:107], v[0:3]
    ds_read_b128 v[48:51], v136 offset:0
    v_mfma_f32_16x16x32_bf16 v[4:7], v[88:91], v[112:115], v[4:7]
    ds_read_b128 v[64:67], v130 offset:0
    v_mfma_f32_16x16x32_bf16 v[8:11], v[88:91], v[120:123], v[8:11]
    ds_read_b128 v[72:75], v130 offset:2048
    v_mfma_f32_16x16x32_bf16 v[12:15], v[96:99], v[104:107], v[12:15]
    ds_read_b128 v[80:83], v130 offset:4096
    v_mfma_f32_16x16x32_bf16 v[16:19], v[96:99], v[112:115], v[16:19]
    ds_read_b128 v[56:59], v136 offset:2048
    v_mfma_f32_16x16x32_bf16 v[20:23], v[96:99], v[120:123], v[20:23]
    ds_read_b128 v[68:71], v133 offset:0
    v_mfma_f32_16x16x32_bf16 v[24:27], v[88:91], v[108:111], v[24:27]
    ds_read_b128 v[76:79], v133 offset:2048
    v_mfma_f32_16x16x32_bf16 v[28:31], v[88:91], v[116:119], v[28:31]
    ds_read_b128 v[84:87], v133 offset:4096
    v_mfma_f32_16x16x32_bf16 v[32:35], v[88:91], v[124:127], v[32:35]
    ds_read_b128 v[52:55], v136 offset:1024
    v_mfma_f32_16x16x32_bf16 v[36:39], v[96:99], v[108:111], v[36:39]
    ds_read_b128 v[60:63], v136 offset:3072
    v_mfma_f32_16x16x32_bf16 v[40:43], v[96:99], v[116:119], v[40:43]
    v_mfma_f32_16x16x32_bf16 v[44:47], v[96:99], v[124:127], v[44:47]
    v_mfma_f32_16x16x32_bf16 v[24:27], v[92:95], v[104:107], v[24:27]
    v_xor_b32 v108, s34, v108
    v_xor_b32 v109, s34, v109
    v_mfma_f32_16x16x32_bf16 v[28:31], v[92:95], v[112:115], v[28:31]
    v_xor_b32 v110, s34, v110
    v_xor_b32 v111, s34, v111
    v_mfma_f32_16x16x32_bf16 v[32:35], v[92:95], v[120:123], v[32:35]
    v_xor_b32 v116, s34, v116
    v_xor_b32 v117, s34, v117
    v_mfma_f32_16x16x32_bf16 v[36:39], v[100:103], v[104:107], v[36:39]
    v_xor_b32 v118, s34, v118
    v_xor_b32 v119, s34, v119
    v_mfma_f32_16x16x32_bf16 v[40:43], v[100:103], v[112:115], v[40:43]
    v_xor_b32 v124, s34, v124
    v_xor_b32 v125, s34, v125
    v_mfma_f32_16x16x32_bf16 v[44:47], v[100:103], v[120:123], v[44:47]
    v_xor_b32 v126, s34, v126
    v_xor_b32 v127, s34, v127
    v_mfma_f32_16x16x32_bf16 v[0:3], v[92:95], v[108:111], v[0:3]
    v_mfma_f32_16x16x32_bf16 v[4:7], v[92:95], v[116:119], v[4:7]
    v_mfma_f32_16x16x32_bf16 v[8:11], v[92:95], v[124:127], v[8:11]
    s_waitcnt lgkmcnt(0)
    s_barrier
    v_mfma_f32_16x16x32_bf16 v[12:15], v[100:103], v[108:111], v[12:15]
    v_mfma_f32_16x16x32_bf16 v[16:19], v[100:103], v[116:119], v[16:19]
    v_mfma_f32_16x16x32_bf16 v[20:23], v[100:103], v[124:127], v[20:23]
    v_mfma_f32_16x16x32_bf16 v[0:3], v[48:51], v[64:67], v[0:3]
    ds_read_b128 v[88:91], v134 offset:0
    v_mfma_f32_16x16x32_bf16 v[4:7], v[48:51], v[72:75], v[4:7]
    ds_read_b128 v[104:107], v128 offset:0
    v_mfma_f32_16x16x32_bf16 v[8:11], v[48:51], v[80:83], v[8:11]
    ds_read_b128 v[112:115], v128 offset:2048
    v_mfma_f32_16x16x32_bf16 v[12:15], v[56:59], v[64:67], v[12:15]
    ds_read_b128 v[120:123], v128 offset:4096
    v_mfma_f32_16x16x32_bf16 v[16:19], v[56:59], v[72:75], v[16:19]
    ds_read_b128 v[96:99], v134 offset:2048
    v_mfma_f32_16x16x32_bf16 v[20:23], v[56:59], v[80:83], v[20:23]
    ds_read_b128 v[108:111], v131 offset:0
    v_mfma_f32_16x16x32_bf16 v[24:27], v[48:51], v[68:71], v[24:27]
    ds_read_b128 v[116:119], v131 offset:2048
    v_mfma_f32_16x16x32_bf16 v[28:31], v[48:51], v[76:79], v[28:31]
    ds_read_b128 v[124:127], v131 offset:4096
    v_mfma_f32_16x16x32_bf16 v[32:35], v[48:51], v[84:87], v[32:35]
    ds_read_b128 v[92:95], v134 offset:1024
    v_mfma_f32_16x16x32_bf16 v[36:39], v[56:59], v[68:71], v[36:39]
    ds_read_b128 v[100:103], v134 offset:3072
    v_mfma_f32_16x16x32_bf16 v[40:43], v[56:59], v[76:79], v[40:43]
    v_mfma_f32_16x16x32_bf16 v[44:47], v[56:59], v[84:87], v[44:47]
    v_mfma_f32_16x16x32_bf16 v[24:27], v[52:55], v[64:67], v[24:27]
    v_xor_b32 v68, s34, v68
    v_xor_b32 v69, s34, v69
    v_mfma_f32_16x16x32_bf16 v[28:31], v[52:55], v[72:75], v[28:31]
    v_xor_b32 v70, s34, v70
    v_xor_b32 v71, s34, v71
    v_mfma_f32_16x16x32_bf16 v[32:35], v[52:55], v[80:83], v[32:35]
    v_xor_b32 v76, s34, v76
    v_xor_b32 v77, s34, v77
    v_mfma_f32_16x16x32_bf16 v[36:39], v[60:63], v[64:67], v[36:39]
    v_xor_b32 v78, s34, v78
    v_xor_b32 v79, s34, v79
    v_mfma_f32_16x16x32_bf16 v[40:43], v[60:63], v[72:75], v[40:43]
    v_xor_b32 v84, s34, v84
    v_xor_b32 v85, s34, v85
    v_mfma_f32_16x16x32_bf16 v[44:47], v[60:63], v[80:83], v[44:47]
    v_xor_b32 v86, s34, v86
    v_xor_b32 v87, s34, v87
    v_mfma_f32_16x16x32_bf16 v[0:3], v[52:55], v[68:71], v[0:3]
    v_mfma_f32_16x16x32_bf16 v[4:7], v[52:55], v[76:79], v[4:7]
    v_mfma_f32_16x16x32_bf16 v[8:11], v[52:55], v[84:87], v[8:11]
    s_waitcnt lgkmcnt(0)
    s_barrier
    v_mfma_f32_16x16x32_bf16 v[12:15], v[60:63], v[68:71], v[12:15]
    v_mfma_f32_16x16x32_bf16 v[16:19], v[60:63], v[76:79], v[16:19]
    v_mfma_f32_16x16x32_bf16 v[20:23], v[60:63], v[84:87], v[20:23]
    v_mfma_f32_16x16x32_bf16 v[0:3], v[88:91], v[104:107], v[0:3]
    ds_read_b128 v[48:51], v134 offset:20480
    v_mfma_f32_16x16x32_bf16 v[4:7], v[88:91], v[112:115], v[4:7]
    ds_read_b128 v[64:67], v128 offset:20480
    v_mfma_f32_16x16x32_bf16 v[8:11], v[88:91], v[120:123], v[8:11]
    ds_read_b128 v[72:75], v128 offset:22528
    v_mfma_f32_16x16x32_bf16 v[12:15], v[96:99], v[104:107], v[12:15]
    ds_read_b128 v[80:83], v128 offset:24576
    v_mfma_f32_16x16x32_bf16 v[16:19], v[96:99], v[112:115], v[16:19]
    ds_read_b128 v[56:59], v134 offset:22528
    v_mfma_f32_16x16x32_bf16 v[20:23], v[96:99], v[120:123], v[20:23]
    ds_read_b128 v[68:71], v131 offset:20480
    v_mfma_f32_16x16x32_bf16 v[24:27], v[88:91], v[108:111], v[24:27]
    ds_read_b128 v[76:79], v131 offset:22528
    v_mfma_f32_16x16x32_bf16 v[28:31], v[88:91], v[116:119], v[28:31]
    ds_read_b128 v[84:87], v131 offset:24576
    v_mfma_f32_16x16x32_bf16 v[32:35], v[88:91], v[124:127], v[32:35]
    ds_read_b128 v[52:55], v134 offset:21504
    v_mfma_f32_16x16x32_bf16 v[36:39], v[96:99], v[108:111], v[36:39]
    ds_read_b128 v[60:63], v134 offset:23552
    v_mfma_f32_16x16x32_bf16 v[40:43], v[96:99], v[116:119], v[40:43]
    v_mfma_f32_16x16x32_bf16 v[44:47], v[96:99], v[124:127], v[44:47]
    v_mfma_f32_16x16x32_bf16 v[24:27], v[92:95], v[104:107], v[24:27]
    v_xor_b32 v108, s34, v108
    v_xor_b32 v109, s34, v109
    v_mfma_f32_16x16x32_bf16 v[28:31], v[92:95], v[112:115], v[28:31]
    v_xor_b32 v110, s34, v110
    v_xor_b32 v111, s34, v111
    v_mfma_f32_16x16x32_bf16 v[32:35], v[92:95], v[120:123], v[32:35]
    v_xor_b32 v116, s34, v116
    v_xor_b32 v117, s34, v117
    v_mfma_f32_16x16x32_bf16 v[36:39], v[100:103], v[104:107], v[36:39]
    v_xor_b32 v118, s34, v118
    v_xor_b32 v119, s34, v119
    v_mfma_f32_16x16x32_bf16 v[40:43], v[100:103], v[112:115], v[40:43]
    v_xor_b32 v124, s34, v124
    v_xor_b32 v125, s34, v125
    v_mfma_f32_16x16x32_bf16 v[44:47], v[100:103], v[120:123], v[44:47]
    v_xor_b32 v126, s34, v126
    v_xor_b32 v127, s34, v127
    v_mfma_f32_16x16x32_bf16 v[0:3], v[92:95], v[108:111], v[0:3]
    v_mfma_f32_16x16x32_bf16 v[4:7], v[92:95], v[116:119], v[4:7]
    v_mfma_f32_16x16x32_bf16 v[8:11], v[92:95], v[124:127], v[8:11]
    s_waitcnt lgkmcnt(0)
    s_barrier
    v_mfma_f32_16x16x32_bf16 v[12:15], v[100:103], v[108:111], v[12:15]
    v_mfma_f32_16x16x32_bf16 v[16:19], v[100:103], v[116:119], v[16:19]
    v_mfma_f32_16x16x32_bf16 v[20:23], v[100:103], v[124:127], v[20:23]
    v_mfma_f32_16x16x32_bf16 v[0:3], v[48:51], v[64:67], v[0:3]
    ds_read_b128 v[88:91], v134 offset:40960
    v_mfma_f32_16x16x32_bf16 v[4:7], v[48:51], v[72:75], v[4:7]
    ds_read_b128 v[104:107], v128 offset:40960
    v_mfma_f32_16x16x32_bf16 v[8:11], v[48:51], v[80:83], v[8:11]
    ds_read_b128 v[112:115], v128 offset:43008
    v_mfma_f32_16x16x32_bf16 v[12:15], v[56:59], v[64:67], v[12:15]
    ds_read_b128 v[120:123], v128 offset:45056
    v_mfma_f32_16x16x32_bf16 v[16:19], v[56:59], v[72:75], v[16:19]
    ds_read_b128 v[96:99], v134 offset:43008
    v_mfma_f32_16x16x32_bf16 v[20:23], v[56:59], v[80:83], v[20:23]
    ds_read_b128 v[108:111], v131 offset:40960
    v_mfma_f32_16x16x32_bf16 v[24:27], v[48:51], v[68:71], v[24:27]
    ds_read_b128 v[116:119], v131 offset:43008
    v_mfma_f32_16x16x32_bf16 v[28:31], v[48:51], v[76:79], v[28:31]
    ds_read_b128 v[124:127], v131 offset:45056
    v_mfma_f32_16x16x32_bf16 v[32:35], v[48:51], v[84:87], v[32:35]
    ds_read_b128 v[92:95], v134 offset:41984
    v_mfma_f32_16x16x32_bf16 v[36:39], v[56:59], v[68:71], v[36:39]
    ds_read_b128 v[100:103], v134 offset:44032
    v_mfma_f32_16x16x32_bf16 v[40:43], v[56:59], v[76:79], v[40:43]
    v_mfma_f32_16x16x32_bf16 v[44:47], v[56:59], v[84:87], v[44:47]
    v_mfma_f32_16x16x32_bf16 v[24:27], v[52:55], v[64:67], v[24:27]
    v_xor_b32 v68, s34, v68
    v_xor_b32 v69, s34, v69
    v_mfma_f32_16x16x32_bf16 v[28:31], v[52:55], v[72:75], v[28:31]
    v_xor_b32 v70, s34, v70
    v_xor_b32 v71, s34, v71
    v_mfma_f32_16x16x32_bf16 v[32:35], v[52:55], v[80:83], v[32:35]
    v_xor_b32 v76, s34, v76
    v_xor_b32 v77, s34, v77
    v_mfma_f32_16x16x32_bf16 v[36:39], v[60:63], v[64:67], v[36:39]
    v_xor_b32 v78, s34, v78
    v_xor_b32 v79, s34, v79
    v_mfma_f32_16x16x32_bf16 v[40:43], v[60:63], v[72:75], v[40:43]
    v_xor_b32 v84, s34, v84
    v_xor_b32 v85, s34, v85
    v_mfma_f32_16x16x32_bf16 v[44:47], v[60:63], v[80:83], v[44:47]
    v_xor_b32 v86, s34, v86
    v_xor_b32 v87, s34, v87
    v_mfma_f32_16x16x32_bf16 v[0:3], v[52:55], v[68:71], v[0:3]
    v_mfma_f32_16x16x32_bf16 v[4:7], v[52:55], v[76:79], v[4:7]
    v_mfma_f32_16x16x32_bf16 v[8:11], v[52:55], v[84:87], v[8:11]
    s_waitcnt lgkmcnt(0)
    s_barrier
    v_mfma_f32_16x16x32_bf16 v[12:15], v[60:63], v[68:71], v[12:15]
    v_mfma_f32_16x16x32_bf16 v[16:19], v[60:63], v[76:79], v[16:19]
    v_mfma_f32_16x16x32_bf16 v[20:23], v[60:63], v[84:87], v[20:23]
    v_mfma_f32_16x16x32_bf16 v[0:3], v[88:91], v[104:107], v[0:3]
    ds_read_b128 v[48:51], v135 offset:0
    v_mfma_f32_16x16x32_bf16 v[4:7], v[88:91], v[112:115], v[4:7]
    ds_read_b128 v[64:67], v129 offset:0
    v_mfma_f32_16x16x32_bf16 v[8:11], v[88:91], v[120:123], v[8:11]
    ds_read_b128 v[72:75], v129 offset:2048
    v_mfma_f32_16x16x32_bf16 v[12:15], v[96:99], v[104:107], v[12:15]
    ds_read_b128 v[80:83], v129 offset:4096
    v_mfma_f32_16x16x32_bf16 v[16:19], v[96:99], v[112:115], v[16:19]
    ds_read_b128 v[56:59], v135 offset:2048
    v_mfma_f32_16x16x32_bf16 v[20:23], v[96:99], v[120:123], v[20:23]
    ds_read_b128 v[68:71], v132 offset:0
    v_mfma_f32_16x16x32_bf16 v[24:27], v[88:91], v[108:111], v[24:27]
    ds_read_b128 v[76:79], v132 offset:2048
    v_mfma_f32_16x16x32_bf16 v[28:31], v[88:91], v[116:119], v[28:31]
    ds_read_b128 v[84:87], v132 offset:4096
    v_mfma_f32_16x16x32_bf16 v[32:35], v[88:91], v[124:127], v[32:35]
    ds_read_b128 v[52:55], v135 offset:1024
    v_mfma_f32_16x16x32_bf16 v[36:39], v[96:99], v[108:111], v[36:39]
    ds_read_b128 v[60:63], v135 offset:3072
    v_mfma_f32_16x16x32_bf16 v[40:43], v[96:99], v[116:119], v[40:43]
    v_mfma_f32_16x16x32_bf16 v[44:47], v[96:99], v[124:127], v[44:47]
    v_mfma_f32_16x16x32_bf16 v[24:27], v[92:95], v[104:107], v[24:27]
    v_xor_b32 v108, s34, v108
    v_xor_b32 v109, s34, v109
    v_mfma_f32_16x16x32_bf16 v[28:31], v[92:95], v[112:115], v[28:31]
    v_xor_b32 v110, s34, v110
    v_xor_b32 v111, s34, v111
    v_mfma_f32_16x16x32_bf16 v[32:35], v[92:95], v[120:123], v[32:35]
    v_xor_b32 v116, s34, v116
    v_xor_b32 v117, s34, v117
    v_mfma_f32_16x16x32_bf16 v[36:39], v[100:103], v[104:107], v[36:39]
    v_xor_b32 v118, s34, v118
    v_xor_b32 v119, s34, v119
    v_mfma_f32_16x16x32_bf16 v[40:43], v[100:103], v[112:115], v[40:43]
    v_xor_b32 v124, s34, v124
    v_xor_b32 v125, s34, v125
    v_mfma_f32_16x16x32_bf16 v[44:47], v[100:103], v[120:123], v[44:47]
    v_xor_b32 v126, s34, v126
    v_xor_b32 v127, s34, v127
    v_mfma_f32_16x16x32_bf16 v[0:3], v[92:95], v[108:111], v[0:3]
    v_mfma_f32_16x16x32_bf16 v[4:7], v[92:95], v[116:119], v[4:7]
    v_mfma_f32_16x16x32_bf16 v[8:11], v[92:95], v[124:127], v[8:11]
    s_waitcnt lgkmcnt(0)
    s_barrier
    v_mfma_f32_16x16x32_bf16 v[12:15], v[100:103], v[108:111], v[12:15]
    v_mfma_f32_16x16x32_bf16 v[16:19], v[100:103], v[116:119], v[16:19]
    v_mfma_f32_16x16x32_bf16 v[20:23], v[100:103], v[124:127], v[20:23]
    v_mfma_f32_16x16x32_bf16 v[0:3], v[48:51], v[64:67], v[0:3]
    ds_read_b128 v[88:91], v135 offset:20480
    v_mfma_f32_16x16x32_bf16 v[4:7], v[48:51], v[72:75], v[4:7]
    ds_read_b128 v[104:107], v129 offset:20480
    v_mfma_f32_16x16x32_bf16 v[8:11], v[48:51], v[80:83], v[8:11]
    ds_read_b128 v[112:115], v129 offset:22528
    v_mfma_f32_16x16x32_bf16 v[12:15], v[56:59], v[64:67], v[12:15]
    ds_read_b128 v[120:123], v129 offset:24576
    v_mfma_f32_16x16x32_bf16 v[16:19], v[56:59], v[72:75], v[16:19]
    ds_read_b128 v[96:99], v135 offset:22528
    v_mfma_f32_16x16x32_bf16 v[20:23], v[56:59], v[80:83], v[20:23]
    ds_read_b128 v[108:111], v132 offset:20480
    v_mfma_f32_16x16x32_bf16 v[24:27], v[48:51], v[68:71], v[24:27]
    ds_read_b128 v[116:119], v132 offset:22528
    v_mfma_f32_16x16x32_bf16 v[28:31], v[48:51], v[76:79], v[28:31]
    ds_read_b128 v[124:127], v132 offset:24576
    v_mfma_f32_16x16x32_bf16 v[32:35], v[48:51], v[84:87], v[32:35]
    ds_read_b128 v[92:95], v135 offset:21504
    v_mfma_f32_16x16x32_bf16 v[36:39], v[56:59], v[68:71], v[36:39]
    ds_read_b128 v[100:103], v135 offset:23552
    v_mfma_f32_16x16x32_bf16 v[40:43], v[56:59], v[76:79], v[40:43]
    v_mfma_f32_16x16x32_bf16 v[44:47], v[56:59], v[84:87], v[44:47]
    v_mfma_f32_16x16x32_bf16 v[24:27], v[52:55], v[64:67], v[24:27]
    v_xor_b32 v68, s34, v68
    v_xor_b32 v69, s34, v69
    v_mfma_f32_16x16x32_bf16 v[28:31], v[52:55], v[72:75], v[28:31]
    v_xor_b32 v70, s34, v70
    v_xor_b32 v71, s34, v71
    v_mfma_f32_16x16x32_bf16 v[32:35], v[52:55], v[80:83], v[32:35]
    v_xor_b32 v76, s34, v76
    v_xor_b32 v77, s34, v77
    v_mfma_f32_16x16x32_bf16 v[36:39], v[60:63], v[64:67], v[36:39]
    v_xor_b32 v78, s34, v78
    v_xor_b32 v79, s34, v79
    v_mfma_f32_16x16x32_bf16 v[40:43], v[60:63], v[72:75], v[40:43]
    v_xor_b32 v84, s34, v84
    v_xor_b32 v85, s34, v85
    v_mfma_f32_16x16x32_bf16 v[44:47], v[60:63], v[80:83], v[44:47]
    v_xor_b32 v86, s34, v86
    v_xor_b32 v87, s34, v87
    v_mfma_f32_16x16x32_bf16 v[0:3], v[52:55], v[68:71], v[0:3]
    v_mfma_f32_16x16x32_bf16 v[4:7], v[52:55], v[76:79], v[4:7]
    v_mfma_f32_16x16x32_bf16 v[8:11], v[52:55], v[84:87], v[8:11]
    s_waitcnt lgkmcnt(0)
    s_barrier
    v_mfma_f32_16x16x32_bf16 v[12:15], v[60:63], v[68:71], v[12:15]
    v_mfma_f32_16x16x32_bf16 v[16:19], v[60:63], v[76:79], v[16:19]
    v_mfma_f32_16x16x32_bf16 v[20:23], v[60:63], v[84:87], v[20:23]
    v_mfma_f32_16x16x32_bf16 v[0:3], v[88:91], v[104:107], v[0:3]
    ds_read_b128 v[48:51], v135 offset:40960
    v_mfma_f32_16x16x32_bf16 v[4:7], v[88:91], v[112:115], v[4:7]
    ds_read_b128 v[64:67], v129 offset:40960
    v_mfma_f32_16x16x32_bf16 v[8:11], v[88:91], v[120:123], v[8:11]
    ds_read_b128 v[72:75], v129 offset:43008
    v_mfma_f32_16x16x32_bf16 v[12:15], v[96:99], v[104:107], v[12:15]
    ds_read_b128 v[80:83], v129 offset:45056
    v_mfma_f32_16x16x32_bf16 v[16:19], v[96:99], v[112:115], v[16:19]
    ds_read_b128 v[56:59], v135 offset:43008
    v_mfma_f32_16x16x32_bf16 v[20:23], v[96:99], v[120:123], v[20:23]
    ds_read_b128 v[68:71], v132 offset:40960
    v_mfma_f32_16x16x32_bf16 v[24:27], v[88:91], v[108:111], v[24:27]
    ds_read_b128 v[76:79], v132 offset:43008
    v_mfma_f32_16x16x32_bf16 v[28:31], v[88:91], v[116:119], v[28:31]
    ds_read_b128 v[84:87], v132 offset:45056
    v_mfma_f32_16x16x32_bf16 v[32:35], v[88:91], v[124:127], v[32:35]
    ds_read_b128 v[52:55], v135 offset:41984
    v_mfma_f32_16x16x32_bf16 v[36:39], v[96:99], v[108:111], v[36:39]
    ds_read_b128 v[60:63], v135 offset:44032
    v_mfma_f32_16x16x32_bf16 v[40:43], v[96:99], v[116:119], v[40:43]
    v_mfma_f32_16x16x32_bf16 v[44:47], v[96:99], v[124:127], v[44:47]
    v_mfma_f32_16x16x32_bf16 v[24:27], v[92:95], v[104:107], v[24:27]
    v_xor_b32 v108, s34, v108
    v_xor_b32 v109, s34, v109
    v_mfma_f32_16x16x32_bf16 v[28:31], v[92:95], v[112:115], v[28:31]
    v_xor_b32 v110, s34, v110
    v_xor_b32 v111, s34, v111
    v_mfma_f32_16x16x32_bf16 v[32:35], v[92:95], v[120:123], v[32:35]
    v_xor_b32 v116, s34, v116
    v_xor_b32 v117, s34, v117
    v_mfma_f32_16x16x32_bf16 v[36:39], v[100:103], v[104:107], v[36:39]
    v_xor_b32 v118, s34, v118
    v_xor_b32 v119, s34, v119
    v_mfma_f32_16x16x32_bf16 v[40:43], v[100:103], v[112:115], v[40:43]
    v_xor_b32 v124, s34, v124
    v_xor_b32 v125, s34, v125
    v_mfma_f32_16x16x32_bf16 v[44:47], v[100:103], v[120:123], v[44:47]
    v_xor_b32 v126, s34, v126
    v_xor_b32 v127, s34, v127
    v_mfma_f32_16x16x32_bf16 v[0:3], v[92:95], v[108:111], v[0:3]
    v_mfma_f32_16x16x32_bf16 v[4:7], v[92:95], v[116:119], v[4:7]
    v_mfma_f32_16x16x32_bf16 v[8:11], v[92:95], v[124:127], v[8:11]
    s_waitcnt lgkmcnt(0)
    s_barrier
    v_mfma_f32_16x16x32_bf16 v[12:15], v[100:103], v[108:111], v[12:15]
    v_mfma_f32_16x16x32_bf16 v[16:19], v[100:103], v[116:119], v[16:19]
    v_mfma_f32_16x16x32_bf16 v[20:23], v[100:103], v[124:127], v[20:23]
    v_mfma_f32_16x16x32_bf16 v[0:3], v[48:51], v[64:67], v[0:3]
    ds_read_b128 v[88:91], v136 offset:0
    v_mfma_f32_16x16x32_bf16 v[4:7], v[48:51], v[72:75], v[4:7]
    ds_read_b128 v[104:107], v130 offset:0
    v_mfma_f32_16x16x32_bf16 v[8:11], v[48:51], v[80:83], v[8:11]
    ds_read_b128 v[112:115], v130 offset:2048
    v_mfma_f32_16x16x32_bf16 v[12:15], v[56:59], v[64:67], v[12:15]
    ds_read_b128 v[120:123], v130 offset:4096
    v_mfma_f32_16x16x32_bf16 v[16:19], v[56:59], v[72:75], v[16:19]
    ds_read_b128 v[96:99], v136 offset:2048
    v_mfma_f32_16x16x32_bf16 v[20:23], v[56:59], v[80:83], v[20:23]
    ds_read_b128 v[108:111], v133 offset:0
    v_mfma_f32_16x16x32_bf16 v[24:27], v[48:51], v[68:71], v[24:27]
    ds_read_b128 v[116:119], v133 offset:2048
    v_mfma_f32_16x16x32_bf16 v[28:31], v[48:51], v[76:79], v[28:31]
    ds_read_b128 v[124:127], v133 offset:4096
    v_mfma_f32_16x16x32_bf16 v[32:35], v[48:51], v[84:87], v[32:35]
    ds_read_b128 v[92:95], v136 offset:1024
    v_mfma_f32_16x16x32_bf16 v[36:39], v[56:59], v[68:71], v[36:39]
    ds_read_b128 v[100:103], v136 offset:3072
    v_mfma_f32_16x16x32_bf16 v[40:43], v[56:59], v[76:79], v[40:43]
    v_mfma_f32_16x16x32_bf16 v[44:47], v[56:59], v[84:87], v[44:47]
    v_mfma_f32_16x16x32_bf16 v[24:27], v[52:55], v[64:67], v[24:27]
    v_xor_b32 v68, s34, v68
    v_xor_b32 v69, s34, v69
    v_mfma_f32_16x16x32_bf16 v[28:31], v[52:55], v[72:75], v[28:31]
    v_xor_b32 v70, s34, v70
    v_xor_b32 v71, s34, v71
    v_mfma_f32_16x16x32_bf16 v[32:35], v[52:55], v[80:83], v[32:35]
    v_xor_b32 v76, s34, v76
    v_xor_b32 v77, s34, v77
    v_mfma_f32_16x16x32_bf16 v[36:39], v[60:63], v[64:67], v[36:39]
    v_xor_b32 v78, s34, v78
    v_xor_b32 v79, s34, v79
    v_mfma_f32_16x16x32_bf16 v[40:43], v[60:63], v[72:75], v[40:43]
    v_xor_b32 v84, s34, v84
    v_xor_b32 v85, s34, v85
    v_mfma_f32_16x16x32_bf16 v[44:47], v[60:63], v[80:83], v[44:47]
    v_xor_b32 v86, s34, v86
    v_xor_b32 v87, s34, v87
    v_mfma_f32_16x16x32_bf16 v[0:3], v[52:55], v[68:71], v[0:3]
    v_mfma_f32_16x16x32_bf16 v[4:7], v[52:55], v[76:79], v[4:7]
    v_mfma_f32_16x16x32_bf16 v[8:11], v[52:55], v[84:87], v[8:11]
    s_waitcnt lgkmcnt(0)
    s_barrier
    v_mfma_f32_16x16x32_bf16 v[12:15], v[60:63], v[68:71], v[12:15]
    v_mfma_f32_16x16x32_bf16 v[16:19], v[60:63], v[76:79], v[16:19]
    v_mfma_f32_16x16x32_bf16 v[20:23], v[60:63], v[84:87], v[20:23]
    v_mfma_f32_16x16x32_bf16 v[0:3], v[88:91], v[104:107], v[0:3]
    ds_read_b128 v[48:51], v134 offset:0
    v_mfma_f32_16x16x32_bf16 v[4:7], v[88:91], v[112:115], v[4:7]
    ds_read_b128 v[64:67], v128 offset:0
    v_mfma_f32_16x16x32_bf16 v[8:11], v[88:91], v[120:123], v[8:11]
    ds_read_b128 v[72:75], v128 offset:2048
    v_mfma_f32_16x16x32_bf16 v[12:15], v[96:99], v[104:107], v[12:15]
    ds_read_b128 v[80:83], v128 offset:4096
    v_mfma_f32_16x16x32_bf16 v[16:19], v[96:99], v[112:115], v[16:19]
    ds_read_b128 v[56:59], v134 offset:2048
    v_mfma_f32_16x16x32_bf16 v[20:23], v[96:99], v[120:123], v[20:23]
    ds_read_b128 v[68:71], v131 offset:0
    v_mfma_f32_16x16x32_bf16 v[24:27], v[88:91], v[108:111], v[24:27]
    ds_read_b128 v[76:79], v131 offset:2048
    v_mfma_f32_16x16x32_bf16 v[28:31], v[88:91], v[116:119], v[28:31]
    ds_read_b128 v[84:87], v131 offset:4096
    v_mfma_f32_16x16x32_bf16 v[32:35], v[88:91], v[124:127], v[32:35]
    ds_read_b128 v[52:55], v134 offset:1024
    v_mfma_f32_16x16x32_bf16 v[36:39], v[96:99], v[108:111], v[36:39]
    ds_read_b128 v[60:63], v134 offset:3072
    v_mfma_f32_16x16x32_bf16 v[40:43], v[96:99], v[116:119], v[40:43]
    v_mfma_f32_16x16x32_bf16 v[44:47], v[96:99], v[124:127], v[44:47]
    v_mfma_f32_16x16x32_bf16 v[24:27], v[92:95], v[104:107], v[24:27]
    v_xor_b32 v108, s34, v108
    v_xor_b32 v109, s34, v109
    v_mfma_f32_16x16x32_bf16 v[28:31], v[92:95], v[112:115], v[28:31]
    v_xor_b32 v110, s34, v110
    v_xor_b32 v111, s34, v111
    v_mfma_f32_16x16x32_bf16 v[32:35], v[92:95], v[120:123], v[32:35]
    v_xor_b32 v116, s34, v116
    v_xor_b32 v117, s34, v117
    v_mfma_f32_16x16x32_bf16 v[36:39], v[100:103], v[104:107], v[36:39]
    v_xor_b32 v118, s34, v118
    v_xor_b32 v119, s34, v119
    v_mfma_f32_16x16x32_bf16 v[40:43], v[100:103], v[112:115], v[40:43]
    v_xor_b32 v124, s34, v124
    v_xor_b32 v125, s34, v125
    v_mfma_f32_16x16x32_bf16 v[44:47], v[100:103], v[120:123], v[44:47]
    v_xor_b32 v126, s34, v126
    v_xor_b32 v127, s34, v127
    v_mfma_f32_16x16x32_bf16 v[0:3], v[92:95], v[108:111], v[0:3]
    v_mfma_f32_16x16x32_bf16 v[4:7], v[92:95], v[116:119], v[4:7]
    v_mfma_f32_16x16x32_bf16 v[8:11], v[92:95], v[124:127], v[8:11]
    s_waitcnt lgkmcnt(0)
    s_barrier
    v_mfma_f32_16x16x32_bf16 v[12:15], v[100:103], v[108:111], v[12:15]
    v_mfma_f32_16x16x32_bf16 v[16:19], v[100:103], v[116:119], v[16:19]
    v_mfma_f32_16x16x32_bf16 v[20:23], v[100:103], v[124:127], v[20:23]
    v_mfma_f32_16x16x32_bf16 v[0:3], v[48:51], v[64:67], v[0:3]
    ds_read_b128 v[88:91], v134 offset:20480
    v_mfma_f32_16x16x32_bf16 v[4:7], v[48:51], v[72:75], v[4:7]
    ds_read_b128 v[104:107], v128 offset:20480
    v_mfma_f32_16x16x32_bf16 v[8:11], v[48:51], v[80:83], v[8:11]
    ds_read_b128 v[112:115], v128 offset:22528
    v_mfma_f32_16x16x32_bf16 v[12:15], v[56:59], v[64:67], v[12:15]
    ds_read_b128 v[120:123], v128 offset:24576
    v_mfma_f32_16x16x32_bf16 v[16:19], v[56:59], v[72:75], v[16:19]
    ds_read_b128 v[96:99], v134 offset:22528
    v_mfma_f32_16x16x32_bf16 v[20:23], v[56:59], v[80:83], v[20:23]
    ds_read_b128 v[108:111], v131 offset:20480
    v_mfma_f32_16x16x32_bf16 v[24:27], v[48:51], v[68:71], v[24:27]
    ds_read_b128 v[116:119], v131 offset:22528
    v_mfma_f32_16x16x32_bf16 v[28:31], v[48:51], v[76:79], v[28:31]
    ds_read_b128 v[124:127], v131 offset:24576
    v_mfma_f32_16x16x32_bf16 v[32:35], v[48:51], v[84:87], v[32:35]
    ds_read_b128 v[92:95], v134 offset:21504
    v_mfma_f32_16x16x32_bf16 v[36:39], v[56:59], v[68:71], v[36:39]
    ds_read_b128 v[100:103], v134 offset:23552
    v_mfma_f32_16x16x32_bf16 v[40:43], v[56:59], v[76:79], v[40:43]
    v_mfma_f32_16x16x32_bf16 v[44:47], v[56:59], v[84:87], v[44:47]
    v_mfma_f32_16x16x32_bf16 v[24:27], v[52:55], v[64:67], v[24:27]
    v_xor_b32 v68, s34, v68
    v_xor_b32 v69, s34, v69
    v_mfma_f32_16x16x32_bf16 v[28:31], v[52:55], v[72:75], v[28:31]
    v_xor_b32 v70, s34, v70
    v_xor_b32 v71, s34, v71
    v_mfma_f32_16x16x32_bf16 v[32:35], v[52:55], v[80:83], v[32:35]
    v_xor_b32 v76, s34, v76
    v_xor_b32 v77, s34, v77
    v_mfma_f32_16x16x32_bf16 v[36:39], v[60:63], v[64:67], v[36:39]
    v_xor_b32 v78, s34, v78
    v_xor_b32 v79, s34, v79
    v_mfma_f32_16x16x32_bf16 v[40:43], v[60:63], v[72:75], v[40:43]
    v_xor_b32 v84, s34, v84
    v_xor_b32 v85, s34, v85
    v_mfma_f32_16x16x32_bf16 v[44:47], v[60:63], v[80:83], v[44:47]
    v_xor_b32 v86, s34, v86
    v_xor_b32 v87, s34, v87
    v_mfma_f32_16x16x32_bf16 v[0:3], v[52:55], v[68:71], v[0:3]
    v_mfma_f32_16x16x32_bf16 v[4:7], v[52:55], v[76:79], v[4:7]
    v_mfma_f32_16x16x32_bf16 v[8:11], v[52:55], v[84:87], v[8:11]
    s_waitcnt lgkmcnt(0)
    v_mfma_f32_16x16x32_bf16 v[12:15], v[60:63], v[68:71], v[12:15]
    v_mfma_f32_16x16x32_bf16 v[16:19], v[60:63], v[76:79], v[16:19]
    v_mfma_f32_16x16x32_bf16 v[20:23], v[60:63], v[84:87], v[20:23]
    v_mfma_f32_16x16x32_bf16 v[0:3], v[88:91], v[104:107], v[0:3]
    v_mfma_f32_16x16x32_bf16 v[4:7], v[88:91], v[112:115], v[4:7]
    v_mfma_f32_16x16x32_bf16 v[8:11], v[88:91], v[120:123], v[8:11]
    v_mfma_f32_16x16x32_bf16 v[12:15], v[96:99], v[104:107], v[12:15]
    v_mfma_f32_16x16x32_bf16 v[16:19], v[96:99], v[112:115], v[16:19]
    v_mfma_f32_16x16x32_bf16 v[20:23], v[96:99], v[120:123], v[20:23]
    v_mfma_f32_16x16x32_bf16 v[24:27], v[88:91], v[108:111], v[24:27]
    v_mfma_f32_16x16x32_bf16 v[28:31], v[88:91], v[116:119], v[28:31]
    v_mfma_f32_16x16x32_bf16 v[32:35], v[88:91], v[124:127], v[32:35]
    v_mfma_f32_16x16x32_bf16 v[36:39], v[96:99], v[108:111], v[36:39]
    v_mfma_f32_16x16x32_bf16 v[40:43], v[96:99], v[116:119], v[40:43]
    v_mfma_f32_16x16x32_bf16 v[44:47], v[96:99], v[124:127], v[44:47]
    v_mfma_f32_16x16x32_bf16 v[24:27], v[92:95], v[104:107], v[24:27]
    v_xor_b32 v108, s34, v108
    v_xor_b32 v109, s34, v109
    v_mfma_f32_16x16x32_bf16 v[28:31], v[92:95], v[112:115], v[28:31]
    v_xor_b32 v110, s34, v110
    v_xor_b32 v111, s34, v111
    v_mfma_f32_16x16x32_bf16 v[32:35], v[92:95], v[120:123], v[32:35]
    v_xor_b32 v116, s34, v116
    v_xor_b32 v117, s34, v117
    v_mfma_f32_16x16x32_bf16 v[36:39], v[100:103], v[104:107], v[36:39]
    v_xor_b32 v118, s34, v118
    v_xor_b32 v119, s34, v119
    v_mfma_f32_16x16x32_bf16 v[40:43], v[100:103], v[112:115], v[40:43]
    v_xor_b32 v124, s34, v124
    v_xor_b32 v125, s34, v125
    v_mfma_f32_16x16x32_bf16 v[44:47], v[100:103], v[120:123], v[44:47]
    v_xor_b32 v126, s34, v126
    v_xor_b32 v127, s34, v127
    v_mfma_f32_16x16x32_bf16 v[0:3], v[92:95], v[108:111], v[0:3]
    v_mfma_f32_16x16x32_bf16 v[4:7], v[92:95], v[116:119], v[4:7]
    v_mfma_f32_16x16x32_bf16 v[8:11], v[92:95], v[124:127], v[8:11]
    v_mfma_f32_16x16x32_bf16 v[12:15], v[100:103], v[108:111], v[12:15]
    v_mfma_f32_16x16x32_bf16 v[16:19], v[100:103], v[116:119], v[16:19]
    v_mfma_f32_16x16x32_bf16 v[20:23], v[100:103], v[124:127], v[20:23]
    s_nop 7
    s_nop 7
    v_cvt_pk_bf16_f32 v48, v0, v1
    v_cvt_pk_bf16_f32 v49, v2, v3
    v_cvt_pk_bf16_f32 v50, v12, v13
    v_cvt_pk_bf16_f32 v51, v14, v15
    v_cvt_pk_bf16_f32 v52, v24, v25
    v_cvt_pk_bf16_f32 v53, v26, v27
    v_cvt_pk_bf16_f32 v54, v36, v37
    v_cvt_pk_bf16_f32 v55, v38, v39
    v_mov_b32 v56, v48
    v_mov_b32 v57, v49
    v_mov_b32 v58, v50
    v_mov_b32 v59, v51
    s_add_u32 s35, s33, 0
    v_mov_b32_dpp v56, v52 row_ror:8 row_mask:0xf bank_mask:0x3
    v_mov_b32_dpp v57, v53 row_ror:8 row_mask:0xf bank_mask:0x3
    v_mov_b32_dpp v58, v54 row_ror:8 row_mask:0xf bank_mask:0x3
    v_mov_b32_dpp v59, v55 row_ror:8 row_mask:0xf bank_mask:0x3
    v_mov_b32_dpp v48, v52 row_ror:8 row_mask:0xf bank_mask:0xc
    v_mov_b32_dpp v49, v53 row_ror:8 row_mask:0xf bank_mask:0xc
    v_mov_b32_dpp v50, v54 row_ror:8 row_mask:0xf bank_mask:0xc
    v_mov_b32_dpp v51, v55 row_ror:8 row_mask:0xf bank_mask:0xc
    buffer_store_dwordx4 v[48:51], v142, s[16:19], s35 offen sc1
    buffer_store_dwordx4 v[56:59], v143, s[16:19], s35 offen sc1
    v_cvt_pk_bf16_f32 v60, v4, v5
    v_cvt_pk_bf16_f32 v61, v6, v7
    v_cvt_pk_bf16_f32 v62, v16, v17
    v_cvt_pk_bf16_f32 v63, v18, v19
    v_cvt_pk_bf16_f32 v64, v28, v29
    v_cvt_pk_bf16_f32 v65, v30, v31
    v_cvt_pk_bf16_f32 v66, v40, v41
    v_cvt_pk_bf16_f32 v67, v42, v43
    v_mov_b32 v68, v60
    v_mov_b32 v69, v61
    v_mov_b32 v70, v62
    v_mov_b32 v71, v63
    s_add_u32 s35, s33, 593920
    v_mov_b32_dpp v68, v64 row_ror:8 row_mask:0xf bank_mask:0x3
    v_mov_b32_dpp v69, v65 row_ror:8 row_mask:0xf bank_mask:0x3
    v_mov_b32_dpp v70, v66 row_ror:8 row_mask:0xf bank_mask:0x3
    v_mov_b32_dpp v71, v67 row_ror:8 row_mask:0xf bank_mask:0x3
    v_mov_b32_dpp v60, v64 row_ror:8 row_mask:0xf bank_mask:0xc
    v_mov_b32_dpp v61, v65 row_ror:8 row_mask:0xf bank_mask:0xc
    v_mov_b32_dpp v62, v66 row_ror:8 row_mask:0xf bank_mask:0xc
    v_mov_b32_dpp v63, v67 row_ror:8 row_mask:0xf bank_mask:0xc
    buffer_store_dwordx4 v[60:63], v142, s[16:19], s35 offen sc1
    buffer_store_dwordx4 v[68:71], v143, s[16:19], s35 offen sc1
    v_cvt_pk_bf16_f32 v72, v8, v9
    v_cvt_pk_bf16_f32 v73, v10, v11
    v_cvt_pk_bf16_f32 v74, v20, v21
    v_cvt_pk_bf16_f32 v75, v22, v23
    v_cvt_pk_bf16_f32 v76, v32, v33
    v_cvt_pk_bf16_f32 v77, v34, v35
    v_cvt_pk_bf16_f32 v78, v44, v45
    v_cvt_pk_bf16_f32 v79, v46, v47
    v_mov_b32 v80, v72
    v_mov_b32 v81, v73
    v_mov_b32 v82, v74
    v_mov_b32 v83, v75
    s_add_u32 s35, s33, 1187840
    v_mov_b32_dpp v80, v76 row_ror:8 row_mask:0xf bank_mask:0x3
    v_mov_b32_dpp v81, v77 row_ror:8 row_mask:0xf bank_mask:0x3
    v_mov_b32_dpp v82, v78 row_ror:8 row_mask:0xf bank_mask:0x3
    v_mov_b32_dpp v83, v79 row_ror:8 row_mask:0xf bank_mask:0x3
    v_mov_b32_dpp v72, v76 row_ror:8 row_mask:0xf bank_mask:0xc
    v_mov_b32_dpp v73, v77 row_ror:8 row_mask:0xf bank_mask:0xc
    v_mov_b32_dpp v74, v78 row_ror:8 row_mask:0xf bank_mask:0xc
    v_mov_b32_dpp v75, v79 row_ror:8 row_mask:0xf bank_mask:0xc
    buffer_store_dwordx4 v[72:75], v142, s[16:19], s35 offen sc1
    buffer_store_dwordx4 v[80:83], v143, s[16:19], s35 offen sc1
    s_endpgm
L_gemm2_kernel_loader:
    s_sub_u32 s20, s20, 4
    v_and_b32 v1, 63, v0
    v_lshrrev_b32 v4, 3, v1
    v_and_b32 v5, 7, v1
    v_xor_b32 v5, v5, v4
    v_lshlrev_b32 v5, 4, v5
    v_lshl_add_u32 v2, v4, 11, v5
    v_lshlrev_b32 v3, 4, v1
    s_add_u32 s24, s20, 0
    s_lshl_b32 s40, s24, 10
    s_lshl_b32 s43, s24, 14
    s_add_u32 s24, s20, 4
    s_lshl_b32 s41, s24, 10
    s_lshl_b32 s44, s24, 14
    s_add_u32 s24, s20, 8
    s_lshl_b32 s42, s24, 10
    s_lshl_b32 s45, s24, 14
    s_mul_i32 s46, s20, 2048
    s_add_u32 s47, s46, 12288
    s_add_u32 m0, s40, 0
    s_add_u32 s24, s43, 0
    buffer_load_dwordx4 v2, s[8:11], s24 offen lds
    s_add_u32 m0, s41, 0
    s_add_u32 s24, s44, 0
    buffer_load_dwordx4 v2, s[8:11], s24 offen lds
    s_add_u32 m0, s42, 0
    s_add_u32 s24, s45, 0
    buffer_load_dwordx4 v2, s[8:11], s24 offen lds
    s_add_u32 m0, s47, 0
    s_add_u32 s24, s46, 0
    buffer_load_dwordx4 v3, s[12:15], s24 offen offset:0 lds
    buffer_load_dwordx4 v3, s[12:15], s24 offen offset:1024 lds
    s_add_u32 m0, s40, 20480
    s_add_u32 s24, s43, 128
    buffer_load_dwordx4 v2, s[8:11], s24 offen lds
    s_add_u32 m0, s41, 20480
    s_add_u32 s24, s44, 128
    buffer_load_dwordx4 v2, s[8:11], s24 offen lds
    s_add_u32 m0, s42, 20480
    s_add_u32 s24, s45, 128
    buffer_load_dwordx4 v2, s[8:11], s24 offen lds
    s_add_u32 m0, s47, 20480
    s_add_u32 s24, s46, 32768
    buffer_load_dwordx4 v3, s[12:15], s24 offen offset:0 lds
    buffer_load_dwordx4 v3, s[12:15], s24 offen offset:1024 lds
    s_waitcnt vmcnt(5)
    s_barrier
    s_add_u32 m0, s40, 40960
    s_add_u32 s24, s43, 256
    buffer_load_dwordx4 v2, s[8:11], s24 offen lds
    s_add_u32 m0, s41, 40960
    s_add_u32 s24, s44, 256
    buffer_load_dwordx4 v2, s[8:11], s24 offen lds
    s_add_u32 m0, s42, 40960
    s_add_u32 s24, s45, 256
    buffer_load_dwordx4 v2, s[8:11], s24 offen lds
    s_add_u32 m0, s47, 40960
    s_add_u32 s24, s46, 65536
    buffer_load_dwordx4 v3, s[12:15], s24 offen offset:0 lds
    buffer_load_dwordx4 v3, s[12:15], s24 offen offset:1024 lds
    s_waitcnt vmcnt(5)
    s_barrier
    s_add_u32 m0, s40, 61440
    s_add_u32 s24, s43, 384
    buffer_load_dwordx4 v2, s[8:11], s24 offen lds
    s_add_u32 m0, s41, 61440
    s_add_u32 s24, s44, 384
    buffer_load_dwordx4 v2, s[8:11], s24 offen lds
    s_add_u32 m0, s42, 61440
    s_add_u32 s24, s45, 384
    buffer_load_dwordx4 v2, s[8:11], s24 offen lds
    s_add_u32 m0, s47, 61440
    s_add_u32 s24, s46, 98304
    buffer_load_dwordx4 v3, s[12:15], s24 offen offset:0 lds
    buffer_load_dwordx4 v3, s[12:15], s24 offen offset:1024 lds
    s_add_u32 m0, s40, 81920
    s_add_u32 s24, s43, 512
    buffer_load_dwordx4 v2, s[8:11], s24 offen lds
    s_add_u32 m0, s41, 81920
    s_add_u32 s24, s44, 512
    buffer_load_dwordx4 v2, s[8:11], s24 offen lds
    s_add_u32 m0, s42, 81920
    s_add_u32 s24, s45, 512
    buffer_load_dwordx4 v2, s[8:11], s24 offen lds
    s_add_u32 m0, s47, 81920
    s_add_u32 s24, s46, 131072
    buffer_load_dwordx4 v3, s[12:15], s24 offen offset:0 lds
    buffer_load_dwordx4 v3, s[12:15], s24 offen offset:1024 lds
    s_waitcnt vmcnt(10)
    s_barrier
    s_add_u32 m0, s40, 102400
    s_add_u32 s24, s43, 640
    buffer_load_dwordx4 v2, s[8:11], s24 offen lds
    s_add_u32 m0, s41, 102400
    s_add_u32 s24, s44, 640
    buffer_load_dwordx4 v2, s[8:11], s24 offen lds
    s_add_u32 m0, s42, 102400
    s_add_u32 s24, s45, 640
    buffer_load_dwordx4 v2, s[8:11], s24 offen lds
    s_add_u32 m0, s47, 102400
    s_add_u32 s24, s46, 163840
    buffer_load_dwordx4 v3, s[12:15], s24 offen offset:0 lds
    buffer_load_dwordx4 v3, s[12:15], s24 offen offset:1024 lds
    s_add_u32 m0, s40, 122880
    s_add_u32 s24, s43, 768
    buffer_load_dwordx4 v2, s[8:11], s24 offen lds
    s_add_u32 m0, s41, 122880
    s_add_u32 s24, s44, 768
    buffer_load_dwordx4 v2, s[8:11], s24 offen lds
    s_add_u32 m0, s42, 122880
    s_add_u32 s24, s45, 768
    buffer_load_dwordx4 v2, s[8:11], s24 offen lds
    s_add_u32 m0, s47, 122880
    s_add_u32 s24, s46, 196608
    buffer_load_dwordx4 v3, s[12:15], s24 offen offset:0 lds
    buffer_load_dwordx4 v3, s[12:15], s24 offen offset:1024 lds
    s_waitcnt vmcnt(15)
    s_barrier
    s_add_u32 m0, s40, 0
    s_add_u32 s24, s43, 896
    buffer_load_dwordx4 v2, s[8:11], s24 offen lds
    s_add_u32 m0, s41, 0
    s_add_u32 s24, s44, 896
    buffer_load_dwordx4 v2, s[8:11], s24 offen lds
    s_add_u32 m0, s42, 0
    s_add_u32 s24, s45, 896
    buffer_load_dwordx4 v2, s[8:11], s24 offen lds
    s_add_u32 m0, s47, 0
    s_add_u32 s24, s46, 229376
    buffer_load_dwordx4 v3, s[12:15], s24 offen offset:0 lds
    buffer_load_dwordx4 v3, s[12:15], s24 offen offset:1024 lds
    s_add_u32 m0, s40, 20480
    s_add_u32 s24, s43, 1024
    buffer_load_dwordx4 v2, s[8:11], s24 offen lds
    s_add_u32 m0, s41, 20480
    s_add_u32 s24, s44, 1024
    buffer_load_dwordx4 v2, s[8:11], s24 offen lds
    s_add_u32 m0, s42, 20480
    s_add_u32 s24, s45, 1024
    buffer_load_dwordx4 v2, s[8:11], s24 offen lds
    s_add_u32 m0, s47, 20480
    s_add_u32 s24, s46, 262144
    buffer_load_dwordx4 v3, s[12:15], s24 offen offset:0 lds
    buffer_load_dwordx4 v3, s[12:15], s24 offen offset:1024 lds
    s_waitcnt vmcnt(20)
    s_barrier
    s_add_u32 m0, s40, 40960
    s_add_u32 s24, s43, 1152
    buffer_load_dwordx4 v2, s[8:11], s24 offen lds
    s_add_u32 m0, s41, 40960
    s_add_u32 s24, s44, 1152
    buffer_load_dwordx4 v2, s[8:11], s24 offen lds
    s_add_u32 m0, s42, 40960
    s_add_u32 s24, s45, 1152
    buffer_load_dwordx4 v2, s[8:11], s24 offen lds
    s_add_u32 m0, s47, 40960
    s_add_u32 s24, s46, 294912
    buffer_load_dwordx4 v3, s[12:15], s24 offen offset:0 lds
    buffer_load_dwordx4 v3, s[12:15], s24 offen offset:1024 lds
    s_add_u32 m0, s40, 61440
    s_add_u32 s24, s43, 1280
    buffer_load_dwordx4 v2, s[8:11], s24 offen lds
    s_add_u32 m0, s41, 61440
    s_add_u32 s24, s44, 1280
    buffer_load_dwordx4 v2, s[8:11], s24 offen lds
    s_add_u32 m0, s42, 61440
    s_add_u32 s24, s45, 1280
    buffer_load_dwordx4 v2, s[8:11], s24 offen lds
    s_add_u32 m0, s47, 61440
    s_add_u32 s24, s46, 327680
    buffer_load_dwordx4 v3, s[12:15], s24 offen offset:0 lds
    buffer_load_dwordx4 v3, s[12:15], s24 offen offset:1024 lds
    s_waitcnt vmcnt(25)
    s_barrier
    s_add_u32 m0, s40, 81920
    s_add_u32 s24, s43, 1408
    buffer_load_dwordx4 v2, s[8:11], s24 offen lds
    s_add_u32 m0, s41, 81920
    s_add_u32 s24, s44, 1408
    buffer_load_dwordx4 v2, s[8:11], s24 offen lds
    s_add_u32 m0, s42, 81920
    s_add_u32 s24, s45, 1408
    buffer_load_dwordx4 v2, s[8:11], s24 offen lds
    s_add_u32 m0, s47, 81920
    s_add_u32 s24, s46, 360448
    buffer_load_dwordx4 v3, s[12:15], s24 offen offset:0 lds
    buffer_load_dwordx4 v3, s[12:15], s24 offen offset:1024 lds
    s_waitcnt vmcnt(25)
    s_barrier
    s_add_u32 m0, s40, 102400
    s_add_u32 s24, s43, 1536
    buffer_load_dwordx4 v2, s[8:11], s24 offen lds
    s_add_u32 m0, s41, 102400
    s_add_u32 s24, s44, 1536
    buffer_load_dwordx4 v2, s[8:11], s24 offen lds
    s_add_u32 m0, s42, 102400
    s_add_u32 s24, s45, 1536
    buffer_load_dwordx4 v2, s[8:11], s24 offen lds
    s_add_u32 m0, s47, 102400
    s_add_u32 s24, s46, 393216
    buffer_load_dwordx4 v3, s[12:15], s24 offen offset:0 lds
    buffer_load_dwordx4 v3, s[12:15], s24 offen offset:1024 lds
    s_waitcnt vmcnt(25)
    s_barrier
    s_add_u32 m0, s40, 122880
    s_add_u32 s24, s43, 1664
    buffer_load_dwordx4 v2, s[8:11], s24 offen lds
    s_add_u32 m0, s41, 122880
    s_add_u32 s24, s44, 1664
    buffer_load_dwordx4 v2, s[8:11], s24 offen lds
    s_add_u32 m0, s42, 122880
    s_add_u32 s24, s45, 1664
    buffer_load_dwordx4 v2, s[8:11], s24 offen lds
    s_add_u32 m0, s47, 122880
    s_add_u32 s24, s46, 425984
    buffer_load_dwordx4 v3, s[12:15], s24 offen offset:0 lds
    buffer_load_dwordx4 v3, s[12:15], s24 offen offset:1024 lds
    s_waitcnt vmcnt(25)
    s_barrier
    s_add_u32 m0, s40, 0
    s_add_u32 s24, s43, 1792
    buffer_load_dwordx4 v2, s[8:11], s24 offen lds
    s_add_u32 m0, s41, 0
    s_add_u32 s24, s44, 1792
    buffer_load_dwordx4 v2, s[8:11], s24 offen lds
    s_add_u32 m0, s42, 0
    s_add_u32 s24, s45, 1792
    buffer_load_dwordx4 v2, s[8:11], s24 offen lds
    s_add_u32 m0, s47, 0
    s_add_u32 s24, s46, 458752
    buffer_load_dwordx4 v3, s[12:15], s24 offen offset:0 lds
    buffer_load_dwordx4 v3, s[12:15], s24 offen offset:1024 lds
    s_waitcnt vmcnt(25)
    s_barrier
    s_add_u32 m0, s40, 20480
    s_add_u32 s24, s43, 1920
    buffer_load_dwordx4 v2, s[8:11], s24 offen lds
    s_add_u32 m0, s41, 20480
    s_add_u32 s24, s44, 1920
    buffer_load_dwordx4 v2, s[8:11], s24 offen lds
    s_add_u32 m0, s42, 20480
    s_add_u32 s24, s45, 1920
    buffer_load_dwordx4 v2, s[8:11], s24 offen lds
    s_add_u32 m0, s47, 20480
    s_add_u32 s24, s46, 491520
    buffer_load_dwordx4 v3, s[12:15], s24 offen offset:0 lds
    buffer_load_dwordx4 v3, s[12:15], s24 offen offset:1024 lds
    s_waitcnt vmcnt(25)
    s_barrier
    s_waitcnt vmcnt(20)
    s_barrier
    s_waitcnt vmcnt(15)
    s_barrier
    s_waitcnt vmcnt(10)
    s_barrier
    s_waitcnt vmcnt(5)
    s_barrier
    s_waitcnt vmcnt(0)
    s_barrier
L_gemm2_kernel_done:
    s_endpgm
.globl joint_kernel
.p2align 8
.type joint_kernel,@function
joint_kernel:
    s_cmp_ge_u32 s2, 256
    s_cbranch_scc1 L_joint_kernel_done
    s_load_dwordx2 s[6:7], s[0:1], 72
    s_load_dwordx2 s[4:5], s[0:1], 56
    v_readfirstlane_b32 s20, v0
    s_lshr_b32 s20, s20, 6
    s_and_b32 s21, s20, 3
    s_and_b32 s23, s2, 7
    s_lshl_b32 s23, s23, 5
    s_lshr_b32 s22, s2, 3
    s_add_u32 s23, s23, s22
    s_cmp_ge_u32 s23, 250
    s_cbranch_scc1 L_joint_kernel_done
    s_cmp_ge_u32 s23, 125
    s_cselect_b32 s24, 1, 0
    s_mul_i32 s25, s24, 125
    s_sub_u32 s25, s23, s25
    s_lshl_b32 s26, s25, 1
    s_add_u32 s26, s26, 0
    s_mul_i32 s27, s26, 171
    s_lshr_b32 s28, s27, 9
    s_mul_i32 s27, s28, 3
    s_sub_u32 s30, s26, s27
    s_lshl_b32 s26, s25, 1
    s_add_u32 s26, s26, 1
    s_mul_i32 s27, s26, 171
    s_lshr_b32 s29, s27, 9
    s_mul_i32 s27, s29, 3
    s_sub_u32 s31, s26, s27
    v_and_b32 v1, 63, v0
    v_lshlrev_b32 v5, 4, v1
    s_waitcnt lgkmcnt(0)
    s_add_u32 s12, s6, 85499904
    s_addc_u32 s13, s7, 0
    s_mov_b32 s14, 295936
    s_mov_b32 s15, 0x00020000
    s_mul_i32 s36, s24, 4000
    s_lshl_b32 s37, s25, 5
    s_add_u32 s36, s36, s37
    s_lshl_b32 s36, s36, 12
    s_add_u32 s16, s4, s36
    s_addc_u32 s17, s5, 0
    s_mov_b32 s18, 131072
    s_mov_b32 s19, 0x00020000
    s_lshl_b32 s38, s21, 15
    s_cmp_ge_u32 s20, 4
    s_cbranch_scc1 L_joint_kernel_helper
    s_lshr_b32 s36, s2, 3
    s_and_b32 s36, s36, 31
    s_lshl_b32 s36, s36, 13
    s_add_u32 s36, s36, 32768
    v_lshlrev_b32 v6, 7, v1
    s_cmp_lg_u32 s20, 0
    s_cbranch_scc1 L_joint_kernel_nopf
    buffer_load_dword v7, v6, s[12:15], s36 offen
L_joint_kernel_nopf:
    v_lshrrev_b32 v2, 3, v1
    v_mul_u32_u24 v2, 1024, v2
    v_bfe_u32 v3, v1, 2, 1
    v_lshl_add_u32 v2, v3, 6, v2
    v_lshrrev_b32 v3, 5, v1
    v_lshlrev_b32 v3, 1, v3
    v_and_b32 v4, 3, v1
    v_xor_b32 v3, v3, v4
    v_lshl_add_u32 v2, v3, 4, v2
    s_lshl_b32 s34, s21, 14
    s_mul_i32 s35, s21, 256
    s_mul_i32 s33, s24, 3118080
    s_add_u32 s33, s33, 79261696
    s_add_u32 s8, s6, s33
    s_addc_u32 s9, s7, 0
    s_mov_b32 s10, 3118080
    s_mov_b32 s11, 0x00020000
    s_mov_b32 s46, 0
    s_cmp_eq_u32 s28, s29
    s_cbranch_scc1 L_joint_kernel_same
    s_mul_i32 s36, s29, 37120
    s_add_u32 s36, s36, s35
    s_add_u32 m0, s34, 8192
    s_add_u32 s37, s36, 0
    buffer_load_dwordx4 v2, s[8:11], s37 offen lds
    s_add_u32 m0, s34, 9216
    s_add_u32 s37, s36, 8192
    buffer_load_dwordx4 v2, s[8:11], s37 offen lds
    s_add_u32 m0, s34, 10240
    s_add_u32 s37, s36, 16384
    buffer_load_dwordx4 v2, s[8:11], s37 offen lds
    s_add_u32 m0, s34, 11264
    s_add_u32 s37, s36, 24576
    buffer_load_dwordx4 v2, s[8:11], s37 offen lds
    s_add_u32 m0, s34, 12288
    s_add_u32 s37, s36, 128
    buffer_load_dwordx4 v2, s[8:11], s37 offen lds
    s_add_u32 m0, s34, 13312
    s_add_u32 s37, s36, 8320
    buffer_load_dwordx4 v2, s[8:11], s37 offen lds
    s_add_u32 m0, s34, 14336
    s_add_u32 s37, s36, 16512
    buffer_load_dwordx4 v2, s[8:11], s37 offen lds
    s_add_u32 m0, s34, 15360
    s_add_u32 s37, s36, 24704
    buffer_load_dwordx4 v2, s[8:11], s37 offen lds
    s_mov_b32 s46, 8192
L_joint_kernel_same:
    s_lshl_b32 s36, s30, 11
    s_add_u32 s36, s36, 8192
    buffer_load_dwordx4 v[8:11], v5, s[12:15], s36 offen offset:0
    buffer_load_dwordx4 v[12:15], v5, s[12:15], s36 offen offset:1024
    s_lshl_b32 s36, s31, 11
    s_add_u32 s36, s36, 8192
    buffer_load_dwordx4 v[16:19], v5, s[12:15], s36 offen offset:0
    buffer_load_dwordx4 v[20:23], v5, s[12:15], s36 offen offset:1024
    s_mul_i32 s36, s28, 37120
    s_add_u32 s36, s36, s35
    s_add_u32 m0, s34, 0
    s_add_u32 s37, s36, 0
    buffer_load_dwordx4 v2, s[8:11], s37 offen lds
    s_add_u32 m0, s34, 1024
    s_add_u32 s37, s36, 8192
    buffer_load_dwordx4 v2, s[8:11], s37 offen lds
    s_add_u32 m0, s34, 2048
    s_add_u32 s37, s36, 16384
    buffer_load_dwordx4 v2, s[8:11], s37 offen lds
    s_add_u32 m0, s34, 3072
    s_add_u32 s37, s36, 24576
    buffer_load_dwordx4 v2, s[8:11], s37 offen lds
    s_add_u32 m0, s34, 4096
    s_add_u32 s37, s36, 128
    buffer_load_dwordx4 v2, s[8:11], s37 offen lds
    s_add_u32 m0, s34, 5120
    s_add_u32 s37, s36, 8320
    buffer_load_dwordx4 v2, s[8:11], s37 offen lds
    s_add_u32 m0, s34, 6144
    s_add_u32 s37, s36, 16512
    buffer_load_dwordx4 v2, s[8:11], s37 offen lds
    s_add_u32 m0, s34, 7168
    s_add_u32 s37, s36, 24704
    buffer_load_dwordx4 v2, s[8:11], s37 offen lds
    v_bfe_u32 v32, v1, 2, 2
    v_lshrrev_b32 v33, 4, v1
    v_and_b32 v34, 3, v1
    v_lshl_add_u32 v35, v33, 3, v32
    v_lshlrev_b32 v40, 6, v35
    v_and_b32 v41, 1, v33
    v_lshlrev_b32 v41, 1, v41
    v_lshrrev_b32 v42, 1, v34
    v_xor_b32 v41, v41, v42
    v_lshl_add_u32 v40, v41, 4, v40
    v_and_b32 v42, 1, v34
    v_lshl_add_u32 v40, v42, 3, v40
    v_add_u32 v36, s34, v40
    v_xor_b32 v37, 32, v36
    v_add_u32 v38, s46, v36
    v_add_u32 v39, s46, v37
    v_lshrrev_b32 v41, 1, v33
    v_lshlrev_b32 v41, 10, v41
    v_and_b32 v42, 1, v33
    v_lshl_add_u32 v41, v42, 9, v41
    v_and_b32 v42, 15, v1
    v_lshl_add_u32 v41, v42, 4, v41
    s_lshl_b32 s36, s21, 12
    s_add_u32 s36, s36, 65536
    v_add_u32 v43, s36, v41
    s_mov_b32 s40, 0xbdd2d3e8
    v_mov_b32 v44, 0xc0135761
    s_mov_b32 s41, 0xbdd2d3e8
    v_mov_b32 v45, 0xc0135761
    s_waitcnt vmcnt(4)
    ds_read_b64_tr_b16 v[48:49], v36 offset:0
    ds_read_b64_tr_b16 v[50:51], v36 offset:256
    ds_read_b64_tr_b16 v[52:53], v36 offset:2048
    ds_read_b64_tr_b16 v[54:55], v36 offset:2304
    ds_read_b64_tr_b16 v[56:57], v37 offset:0
    ds_read_b64_tr_b16 v[58:59], v37 offset:256
    ds_read_b64_tr_b16 v[60:61], v37 offset:2048
    ds_read_b64_tr_b16 v[62:63], v37 offset:2304
    s_waitcnt lgkmcnt(0)
    v_mfma_f32_16x16x32_bf16 v[64:67], v[48:51], v[8:11], 0
    v_mfma_f32_16x16x32_bf16 v[68:71], v[56:59], v[8:11], 0
    v_mfma_f32_16x16x32_bf16 v[64:67], v[52:55], v[12:15], v[64:67]
    v_mfma_f32_16x16x32_bf16 v[68:71], v[60:63], v[12:15], v[68:71]
    ds_read_b64_tr_b16 v[84:85], v38 offset:0
    ds_read_b64_tr_b16 v[86:87], v38 offset:256
    ds_read_b64_tr_b16 v[88:89], v38 offset:2048
    ds_read_b64_tr_b16 v[90:91], v38 offset:2304
    ds_read_b64_tr_b16 v[92:93], v39 offset:0
    ds_read_b64_tr_b16 v[94:95], v39 offset:256
    ds_read_b64_tr_b16 v[96:97], v39 offset:2048
    ds_read_b64_tr_b16 v[98:99], v39 offset:2304
    v_mul_f32 v72, v64, v64
    v_mul_f32 v73, v65, v65
    v_mul_f32 v74, v66, v66
    v_mul_f32 v75, v67, v67
    v_mul_f32 v76, v68, v68
    v_mul_f32 v77, v69, v69
    v_mul_f32 v78, v70, v70
    v_mul_f32 v79, v71, v71
    v_fma_f32 v72, v72, s40, v44
    v_fma_f32 v73, v73, s40, v44
    v_fma_f32 v74, v74, s40, v44
    v_fma_f32 v75, v75, s40, v44
    v_fma_f32 v76, v76, s40, v44
    v_fma_f32 v77, v77, s40, v44
    v_fma_f32 v78, v78, s40, v44
    v_fma_f32 v79, v79, s40, v44
    v_mul_f32 v72, v72, v64
    v_mul_f32 v73, v73, v65
    v_mul_f32 v74, v74, v66
    v_mul_f32 v75, v75, v67
    v_mul_f32 v76, v76, v68
    v_mul_f32 v77, v77, v69
    v_mul_f32 v78, v78, v70
    v_mul_f32 v79, v79, v71
    v_exp_f32 v72, v72
    v_exp_f32 v73, v73
    v_exp_f32 v74, v74
    v_exp_f32 v75, v75
    v_exp_f32 v76, v76
    v_exp_f32 v77, v77
    v_exp_f32 v78, v78
    v_exp_f32 v79, v79
    v_add_f32 v72, 1.0, v72
    v_add_f32 v73, 1.0, v73
    v_add_f32 v74, 1.0, v74
    v_add_f32 v75, 1.0, v75
    v_add_f32 v76, 1.0, v76
    v_add_f32 v77, 1.0, v77
    v_add_f32 v78, 1.0, v78
    v_add_f32 v79, 1.0, v79
    v_rcp_f32 v72, v72
    v_rcp_f32 v73, v73
    v_rcp_f32 v74, v74
    v_rcp_f32 v75, v75
    v_rcp_f32 v76, v76
    v_rcp_f32 v77, v77
    v_rcp_f32 v78, v78
    v_rcp_f32 v79, v79
    v_mul_f32 v64, v64, v72
    v_mul_f32 v65, v65, v73
    v_mul_f32 v66, v66, v74
    v_mul_f32 v67, v67, v75
    v_mul_f32 v68, v68, v76
    v_mul_f32 v69, v69, v77
    v_mul_f32 v70, v70, v78
    v_mul_f32 v71, v71, v79
    v_cvt_pk_bf16_f32 v80, v64, v65
    v_cvt_pk_bf16_f32 v81, v66, v67
    v_cvt_pk_bf16_f32 v82, v68, v69
    v_cvt_pk_bf16_f32 v83, v70, v71
    ds_write_b128 v43, v[80:83] offset:0
    s_waitcnt vmcnt(0)
    s_waitcnt lgkmcnt(1)
    v_mfma_f32_16x16x32_bf16 v[100:103], v[84:87], v[16:19], 0
    v_mfma_f32_16x16x32_bf16 v[104:107], v[92:95], v[16:19], 0
    v_mfma_f32_16x16x32_bf16 v[100:103], v[88:91], v[20:23], v[100:103]
    v_mfma_f32_16x16x32_bf16 v[104:107], v[96:99], v[20:23], v[104:107]
    ds_read_b64_tr_b16 v[48:49], v36 offset:4096
    ds_read_b64_tr_b16 v[50:51], v36 offset:4352
    ds_read_b64_tr_b16 v[52:53], v36 offset:6144
    ds_read_b64_tr_b16 v[54:55], v36 offset:6400
    ds_read_b64_tr_b16 v[56:57], v37 offset:4096
    ds_read_b64_tr_b16 v[58:59], v37 offset:4352
    ds_read_b64_tr_b16 v[60:61], v37 offset:6144
    ds_read_b64_tr_b16 v[62:63], v37 offset:6400
    v_mul_f32 v72, v100, v100
    v_mul_f32 v73, v101, v101
    v_mul_f32 v74, v102, v102
    v_mul_f32 v75, v103, v103
    v_mul_f32 v76, v104, v104
    v_mul_f32 v77, v105, v105
    v_mul_f32 v78, v106, v106
    v_mul_f32 v79, v107, v107
    v_fma_f32 v72, v72, s40, v44
    v_fma_f32 v73, v73, s40, v44
    v_fma_f32 v74, v74, s40, v44
    v_fma_f32 v75, v75, s40, v44
    v_fma_f32 v76, v76, s40, v44
    v_fma_f32 v77, v77, s40, v44
    v_fma_f32 v78, v78, s40, v44
    v_fma_f32 v79, v79, s40, v44
    v_mul_f32 v72, v72, v100
    v_mul_f32 v73, v73, v101
    v_mul_f32 v74, v74, v102
    v_mul_f32 v75, v75, v103
    v_mul_f32 v76, v76, v104
    v_mul_f32 v77, v77, v105
    v_mul_f32 v78, v78, v106
    v_mul_f32 v79, v79, v107
    v_exp_f32 v72, v72
    v_exp_f32 v73, v73
    v_exp_f32 v74, v74
    v_exp_f32 v75, v75
    v_exp_f32 v76, v76
    v_exp_f32 v77, v77
    v_exp_f32 v78, v78
    v_exp_f32 v79, v79
    v_add_f32 v72, 1.0, v72
    v_add_f32 v73, 1.0, v73
    v_add_f32 v74, 1.0, v74
    v_add_f32 v75, 1.0, v75
    v_add_f32 v76, 1.0, v76
    v_add_f32 v77, 1.0, v77
    v_add_f32 v78, 1.0, v78
    v_add_f32 v79, 1.0, v79
    v_rcp_f32 v72, v72
    v_rcp_f32 v73, v73
    v_rcp_f32 v74, v74
    v_rcp_f32 v75, v75
    v_rcp_f32 v76, v76
    v_rcp_f32 v77, v77
    v_rcp_f32 v78, v78
    v_rcp_f32 v79, v79
    v_mul_f32 v100, v100, v72
    v_mul_f32 v101, v101, v73
    v_mul_f32 v102, v102, v74
    v_mul_f32 v103, v103, v75
    v_mul_f32 v104, v104, v76
    v_mul_f32 v105, v105, v77
    v_mul_f32 v106, v106, v78
    v_mul_f32 v107, v107, v79
    v_cvt_pk_bf16_f32 v108, v100, v101
    v_cvt_pk_bf16_f32 v109, v102, v103
    v_cvt_pk_bf16_f32 v110, v104, v105
    v_cvt_pk_bf16_f32 v111, v106, v107
    ds_write_b128 v43, v[108:111] offset:256
    s_waitcnt lgkmcnt(1)
    v_mfma_f32_16x16x32_bf16 v[64:67], v[48:51], v[8:11], 0
    v_mfma_f32_16x16x32_bf16 v[68:71], v[56:59], v[8:11], 0
    v_mfma_f32_16x16x32_bf16 v[64:67], v[52:55], v[12:15], v[64:67]
    v_mfma_f32_16x16x32_bf16 v[68:71], v[60:63], v[12:15], v[68:71]
    ds_read_b64_tr_b16 v[84:85], v38 offset:4096
    ds_read_b64_tr_b16 v[86:87], v38 offset:4352
    ds_read_b64_tr_b16 v[88:89], v38 offset:6144
    ds_read_b64_tr_b16 v[90:91], v38 offset:6400
    ds_read_b64_tr_b16 v[92:93], v39 offset:4096
    ds_read_b64_tr_b16 v[94:95], v39 offset:4352
    ds_read_b64_tr_b16 v[96:97], v39 offset:6144
    ds_read_b64_tr_b16 v[98:99], v39 offset:6400
    v_mul_f32 v72, v64, v64
    v_mul_f32 v73, v65, v65
    v_mul_f32 v74, v66, v66
    v_mul_f32 v75, v67, v67
    v_mul_f32 v76, v68, v68
    v_mul_f32 v77, v69, v69
    v_mul_f32 v78, v70, v70
    v_mul_f32 v79, v71, v71
    v_fma_f32 v72, v72, s40, v44
    v_fma_f32 v73, v73, s40, v44
    v_fma_f32 v74, v74, s40, v44
    v_fma_f32 v75, v75, s40, v44
    v_fma_f32 v76, v76, s40, v44
    v_fma_f32 v77, v77, s40, v44
    v_fma_f32 v78, v78, s40, v44
    v_fma_f32 v79, v79, s40, v44
    v_mul_f32 v72, v72, v64
    v_mul_f32 v73, v73, v65
    v_mul_f32 v74, v74, v66
    v_mul_f32 v75, v75, v67
    v_mul_f32 v76, v76, v68
    v_mul_f32 v77, v77, v69
    v_mul_f32 v78, v78, v70
    v_mul_f32 v79, v79, v71
    v_exp_f32 v72, v72
    v_exp_f32 v73, v73
    v_exp_f32 v74, v74
    v_exp_f32 v75, v75
    v_exp_f32 v76, v76
    v_exp_f32 v77, v77
    v_exp_f32 v78, v78
    v_exp_f32 v79, v79
    v_add_f32 v72, 1.0, v72
    v_add_f32 v73, 1.0, v73
    v_add_f32 v74, 1.0, v74
    v_add_f32 v75, 1.0, v75
    v_add_f32 v76, 1.0, v76
    v_add_f32 v77, 1.0, v77
    v_add_f32 v78, 1.0, v78
    v_add_f32 v79, 1.0, v79
    v_rcp_f32 v72, v72
    v_rcp_f32 v73, v73
    v_rcp_f32 v74, v74
    v_rcp_f32 v75, v75
    v_rcp_f32 v76, v76
    v_rcp_f32 v77, v77
    v_rcp_f32 v78, v78
    v_rcp_f32 v79, v79
    v_mul_f32 v64, v64, v72
    v_mul_f32 v65, v65, v73
    v_mul_f32 v66, v66, v74
    v_mul_f32 v67, v67, v75
    v_mul_f32 v68, v68, v76
    v_mul_f32 v69, v69, v77
    v_mul_f32 v70, v70, v78
    v_mul_f32 v71, v71, v79
    v_cvt_pk_bf16_f32 v80, v64, v65
    v_cvt_pk_bf16_f32 v81, v66, v67
    v_cvt_pk_bf16_f32 v82, v68, v69
    v_cvt_pk_bf16_f32 v83, v70, v71
    ds_write_b128 v43, v[80:83] offset:2048
    s_waitcnt lgkmcnt(1)
    v_mfma_f32_16x16x32_bf16 v[100:103], v[84:87], v[16:19], 0
    v_mfma_f32_16x16x32_bf16 v[104:107], v[92:95], v[16:19], 0
    v_mfma_f32_16x16x32_bf16 v[100:103], v[88:91], v[20:23], v[100:103]
    v_mfma_f32_16x16x32_bf16 v[104:107], v[96:99], v[20:23], v[104:107]
    s_nop 7
    v_mul_f32 v72, v100, v100
    v_mul_f32 v73, v101, v101
    v_mul_f32 v74, v102, v102
    v_mul_f32 v75, v103, v103
    v_mul_f32 v76, v104, v104
    v_mul_f32 v77, v105, v105
    v_mul_f32 v78, v106, v106
    v_mul_f32 v79, v107, v107
    v_fma_f32 v72, v72, s40, v44
    v_fma_f32 v73, v73, s40, v44
    v_fma_f32 v74, v74, s40, v44
    v_fma_f32 v75, v75, s40, v44
    v_fma_f32 v76, v76, s40, v44
    v_fma_f32 v77, v77, s40, v44
    v_fma_f32 v78, v78, s40, v44
    v_fma_f32 v79, v79, s40, v44
    v_mul_f32 v72, v72, v100
    v_mul_f32 v73, v73, v101
    v_mul_f32 v74, v74, v102
    v_mul_f32 v75, v75, v103
    v_mul_f32 v76, v76, v104
    v_mul_f32 v77, v77, v105
    v_mul_f32 v78, v78, v106
    v_mul_f32 v79, v79, v107
    v_exp_f32 v72, v72
    v_exp_f32 v73, v73
    v_exp_f32 v74, v74
    v_exp_f32 v75, v75
    v_exp_f32 v76, v76
    v_exp_f32 v77, v77
    v_exp_f32 v78, v78
    v_exp_f32 v79, v79
    v_add_f32 v72, 1.0, v72
    v_add_f32 v73, 1.0, v73
    v_add_f32 v74, 1.0, v74
    v_add_f32 v75, 1.0, v75
    v_add_f32 v76, 1.0, v76
    v_add_f32 v77, 1.0, v77
    v_add_f32 v78, 1.0, v78
    v_add_f32 v79, 1.0, v79
    v_rcp_f32 v72, v72
    v_rcp_f32 v73, v73
    v_rcp_f32 v74, v74
    v_rcp_f32 v75, v75
    v_rcp_f32 v76, v76
    v_rcp_f32 v77, v77
    v_rcp_f32 v78, v78
    v_rcp_f32 v79, v79
    v_mul_f32 v100, v100, v72
    v_mul_f32 v101, v101, v73
    v_mul_f32 v102, v102, v74
    v_mul_f32 v103, v103, v75
    v_mul_f32 v104, v104, v76
    v_mul_f32 v105, v105, v77
    v_mul_f32 v106, v106, v78
    v_mul_f32 v107, v107, v79
    v_cvt_pk_bf16_f32 v108, v100, v101
    v_cvt_pk_bf16_f32 v109, v102, v103
    v_cvt_pk_bf16_f32 v110, v104, v105
    v_cvt_pk_bf16_f32 v111, v106, v107
    ds_write_b128 v43, v[108:111] offset:2304
    s_waitcnt lgkmcnt(0)
    s_barrier
    v_and_b32 v46, 31, v1
    v_mul_u32_u24 v47, 528, v46
    v_lshrrev_b32 v45, 5, v1
    v_lshl_add_u32 v47, v45, 4, v47
    s_lshl_b32 s36, s21, 7
    s_add_u32 s36, s36, 115712
    v_add_u32 v6, s36, v47
    v_lshlrev_b32 v7, 6, v45
    s_lshl_b32 s36, s21, 8
    s_add_u32 s36, s36, 14336
    buffer_load_dwordx4 v[72:75], v7, s[12:15], s36 offen offset:0
    buffer_load_dwordx4 v[76:79], v7, s[12:15], s36 offen offset:16
    buffer_load_dwordx4 v[80:83], v7, s[12:15], s36 offen offset:32
    buffer_load_dwordx4 v[84:87], v7, s[12:15], s36 offen offset:48
    buffer_load_dwordx4 v[88:91], v7, s[12:15], s36 offen offset:128
    buffer_load_dwordx4 v[92:95], v7, s[12:15], s36 offen offset:144
    buffer_load_dwordx4 v[96:99], v7, s[12:15], s36 offen offset:160
    buffer_load_dwordx4 v[100:103], v7, s[12:15], s36 offen offset:176
    s_add_u32 s36, s38, 163840
    buffer_load_dwordx4 a[0:3], v5, s[12:15], s36 offen
    s_add_u32 s36, s38, 180224
    buffer_load_dwordx4 a[64:67], v5, s[12:15], s36 offen
    s_add_u32 s36, s38, 164864
    buffer_load_dwordx4 a[4:7], v5, s[12:15], s36 offen
    s_add_u32 s36, s38, 181248
    buffer_load_dwordx4 a[68:71], v5, s[12:15], s36 offen
    s_add_u32 s36, s38, 165888
    buffer_load_dwordx4 a[8:11], v5, s[12:15], s36 offen
    s_add_u32 s36, s38, 182272
    buffer_load_dwordx4 a[72:75], v5, s[12:15], s36 offen
    s_add_u32 s36, s38, 166912
    buffer_load_dwordx4 a[12:15], v5, s[12:15], s36 offen
    s_add_u32 s36, s38, 183296
    buffer_load_dwordx4 a[76:79], v5, s[12:15], s36 offen
    s_add_u32 s36, s38, 167936
    buffer_load_dwordx4 a[16:19], v5, s[12:15], s36 offen
    s_add_u32 s36, s38, 184320
    buffer_load_dwordx4 a[80:83], v5, s[12:15], s36 offen
    s_add_u32 s36, s38, 168960
    buffer_load_dwordx4 a[20:23], v5, s[12:15], s36 offen
    s_add_u32 s36, s38, 185344
    buffer_load_dwordx4 a[84:87], v5, s[12:15], s36 offen
    s_add_u32 s36, s38, 169984
    buffer_load_dwordx4 a[24:27], v5, s[12:15], s36 offen
    s_add_u32 s36, s38, 186368
    buffer_load_dwordx4 a[88:91], v5, s[12:15], s36 offen
    s_add_u32 s36, s38, 171008
    buffer_load_dwordx4 a[28:31], v5, s[12:15], s36 offen
    s_add_u32 s36, s38, 187392
    buffer_load_dwordx4 a[92:95], v5, s[12:15], s36 offen
    s_add_u32 s36, s38, 172032
    buffer_load_dwordx4 a[32:35], v5, s[12:15], s36 offen
    s_add_u32 s36, s38, 188416
    buffer_load_dwordx4 a[96:99], v5, s[12:15], s36 offen
    s_add_u32 s36, s38, 173056
    buffer_load_dwordx4 a[36:39], v5, s[12:15], s36 offen
    s_add_u32 s36, s38, 189440
    buffer_load_dwordx4 a[100:103], v5, s[12:15], s36 offen
    s_add_u32 s36, s38, 174080
    buffer_load_dwordx4 a[40:43], v5, s[12:15], s36 offen
    s_add_u32 s36, s38, 190464
    buffer_load_dwordx4 a[104:107], v5, s[12:15], s36 offen
    s_add_u32 s36, s38, 175104
    buffer_load_dwordx4 a[44:47], v5, s[12:15], s36 offen
    s_add_u32 s36, s38, 191488
    buffer_load_dwordx4 a[108:111], v5, s[12:15], s36 offen
    s_add_u32 s36, s38, 176128
    buffer_load_dwordx4 a[48:51], v5, s[12:15], s36 offen
    s_add_u32 s36, s38, 192512
    buffer_load_dwordx4 a[112:115], v5, s[12:15], s36 offen
    s_add_u32 s36, s38, 177152
    buffer_load_dwordx4 a[52:55], v5, s[12:15], s36 offen
    s_add_u32 s36, s38, 193536
    buffer_load_dwordx4 a[116:119], v5, s[12:15], s36 offen
    s_add_u32 s36, s38, 178176
    buffer_load_dwordx4 a[56:59], v5, s[12:15], s36 offen
    s_add_u32 s36, s38, 194560
    buffer_load_dwordx4 a[120:123], v5, s[12:15], s36 offen
    s_add_u32 s36, s38, 179200
    buffer_load_dwordx4 a[60:63], v5, s[12:15], s36 offen
    s_add_u32 s36, s38, 195584
    buffer_load_dwordx4 a[124:127], v5, s[12:15], s36 offen
    s_setprio 1
    s_barrier
    ds_read_b128 v[104:107], v5 offset:0
    ds_read_b128 v[108:111], v5 offset:1024
    ds_read_b128 v[112:115], v5 offset:2048
    s_waitcnt lgkmcnt(2)
    s_waitcnt vmcnt(30)
    v_mfma_f32_32x32x16_bf16 v[8:23], a[0:3], v[104:107], v[72:87]
    ds_read_b128 v[116:119], v5 offset:3072
    v_mfma_f32_32x32x16_bf16 v[24:39], a[64:67], v[104:107], v[88:103]
    s_waitcnt lgkmcnt(2)
    s_waitcnt vmcnt(28)
    v_mfma_f32_32x32x16_bf16 v[8:23], a[4:7], v[108:111], v[8:23]
    ds_read_b128 v[104:107], v5 offset:4096
    v_mfma_f32_32x32x16_bf16 v[24:39], a[68:71], v[108:111], v[24:39]
    s_waitcnt lgkmcnt(2)
    s_waitcnt vmcnt(26)
    v_mfma_f32_32x32x16_bf16 v[8:23], a[8:11], v[112:115], v[8:23]
    ds_read_b128 v[108:111], v5 offset:5120
    v_mfma_f32_32x32x16_bf16 v[24:39], a[72:75], v[112:115], v[24:39]
    s_waitcnt lgkmcnt(2)
    s_waitcnt vmcnt(24)
    v_mfma_f32_32x32x16_bf16 v[8:23], a[12:15], v[116:119], v[8:23]
    ds_read_b128 v[112:115], v5 offset:6144
    v_mfma_f32_32x32x16_bf16 v[24:39], a[76:79], v[116:119], v[24:39]
    s_waitcnt lgkmcnt(2)
    s_waitcnt vmcnt(22)
    v_mfma_f32_32x32x16_bf16 v[8:23], a[16:19], v[104:107], v[8:23]
    ds_read_b128 v[116:119], v5 offset:7168
    v_mfma_f32_32x32x16_bf16 v[24:39], a[80:83], v[104:107], v[24:39]
    s_waitcnt lgkmcnt(2)
    s_waitcnt vmcnt(20)
    v_mfma_f32_32x32x16_bf16 v[8:23], a[20:23], v[108:111], v[8:23]
    ds_read_b128 v[104:107], v5 offset:8192
    v_mfma_f32_32x32x16_bf16 v[24:39], a[84:87], v[108:111], v[24:39]
    s_waitcnt lgkmcnt(2)
    s_waitcnt vmcnt(18)
    v_mfma_f32_32x32x16_bf16 v[8:23], a[24:27], v[112:115], v[8:23]
    ds_read_b128 v[108:111], v5 offset:9216
    v_mfma_f32_32x32x16_bf16 v[24:39], a[88:91], v[112:115], v[24:39]
    s_waitcnt lgkmcnt(2)
    s_waitcnt vmcnt(16)
    v_mfma_f32_32x32x16_bf16 v[8:23], a[28:31], v[116:119], v[8:23]
    ds_read_b128 v[112:115], v5 offset:10240
    v_mfma_f32_32x32x16_bf16 v[24:39], a[92:95], v[116:119], v[24:39]
    s_waitcnt lgkmcnt(2)
    s_waitcnt vmcnt(14)
    v_mfma_f32_32x32x16_bf16 v[8:23], a[32:35], v[104:107], v[8:23]
    ds_read_b128 v[116:119], v5 offset:11264
    v_mfma_f32_32x32x16_bf16 v[24:39], a[96:99], v[104:107], v[24:39]
    s_waitcnt lgkmcnt(2)
    s_waitcnt vmcnt(12)
    v_mfma_f32_32x32x16_bf16 v[8:23], a[36:39], v[108:111], v[8:23]
    ds_read_b128 v[104:107], v5 offset:12288
    v_mfma_f32_32x32x16_bf16 v[24:39], a[100:103], v[108:111], v[24:39]
    s_waitcnt lgkmcnt(2)
    s_waitcnt vmcnt(10)
    v_mfma_f32_32x32x16_bf16 v[8:23], a[40:43], v[112:115], v[8:23]
    ds_read_b128 v[108:111], v5 offset:13312
    v_mfma_f32_32x32x16_bf16 v[24:39], a[104:107], v[112:115], v[24:39]
    s_waitcnt lgkmcnt(2)
    s_waitcnt vmcnt(8)
    v_mfma_f32_32x32x16_bf16 v[8:23], a[44:47], v[116:119], v[8:23]
    ds_read_b128 v[112:115], v5 offset:14336
    v_mfma_f32_32x32x16_bf16 v[24:39], a[108:111], v[116:119], v[24:39]
    s_waitcnt lgkmcnt(2)
    s_waitcnt vmcnt(6)
    v_mfma_f32_32x32x16_bf16 v[8:23], a[48:51], v[104:107], v[8:23]
    ds_read_b128 v[116:119], v5 offset:15360
    v_mfma_f32_32x32x16_bf16 v[24:39], a[112:115], v[104:107], v[24:39]
    s_waitcnt lgkmcnt(2)
    s_waitcnt vmcnt(4)
    v_mfma_f32_32x32x16_bf16 v[8:23], a[52:55], v[108:111], v[8:23]
    ds_read_b128 v[104:107], v5 offset:16384
    v_mfma_f32_32x32x16_bf16 v[24:39], a[116:119], v[108:111], v[24:39]
    s_waitcnt lgkmcnt(2)
    s_waitcnt vmcnt(2)
    v_mfma_f32_32x32x16_bf16 v[8:23], a[56:59], v[112:115], v[8:23]
    ds_read_b128 v[108:111], v5 offset:17408
    v_mfma_f32_32x32x16_bf16 v[24:39], a[120:123], v[112:115], v[24:39]
    s_waitcnt lgkmcnt(2)
    s_waitcnt vmcnt(0)
    v_mfma_f32_32x32x16_bf16 v[8:23], a[60:63], v[116:119], v[8:23]
    ds_read_b128 v[112:115], v5 offset:18432
    v_mfma_f32_32x32x16_bf16 v[24:39], a[124:127], v[116:119], v[24:39]
    s_barrier
    s_waitcnt lgkmcnt(2)
    v_mfma_f32_32x32x16_bf16 v[40:55], a[0:3], v[104:107], v[72:87]
    ds_read_b128 v[116:119], v5 offset:19456
    v_mfma_f32_32x32x16_bf16 v[56:71], a[64:67], v[104:107], v[88:103]
    s_waitcnt lgkmcnt(2)
    v_mfma_f32_32x32x16_bf16 v[40:55], a[4:7], v[108:111], v[40:55]
    ds_read_b128 v[104:107], v5 offset:20480
    v_mfma_f32_32x32x16_bf16 v[56:71], a[68:71], v[108:111], v[56:71]
    s_waitcnt lgkmcnt(2)
    v_mfma_f32_32x32x16_bf16 v[40:55], a[8:11], v[112:115], v[40:55]
    ds_read_b128 v[108:111], v5 offset:21504
    v_cvt_pk_bf16_f32 v120, v8, v9
    v_mfma_f32_32x32x16_bf16 v[56:71], a[72:75], v[112:115], v[56:71]
    v_cvt_pk_bf16_f32 v121, v10, v11
    s_waitcnt lgkmcnt(2)
    v_mfma_f32_32x32x16_bf16 v[40:55], a[12:15], v[116:119], v[40:55]
    ds_read_b128 v[112:115], v5 offset:22528
    v_cvt_pk_bf16_f32 v122, v12, v13
    v_mfma_f32_32x32x16_bf16 v[56:71], a[76:79], v[116:119], v[56:71]
    v_cvt_pk_bf16_f32 v123, v14, v15
    s_waitcnt lgkmcnt(2)
    v_mfma_f32_32x32x16_bf16 v[40:55], a[16:19], v[104:107], v[40:55]
    ds_read_b128 v[116:119], v5 offset:23552
    ds_write_b128 v6, v[120:123] offset:0
    v_mfma_f32_32x32x16_bf16 v[56:71], a[80:83], v[104:107], v[56:71]
    v_cvt_pk_bf16_f32 v124, v16, v17
    s_waitcnt lgkmcnt(3)
    v_mfma_f32_32x32x16_bf16 v[40:55], a[20:23], v[108:111], v[40:55]
    ds_read_b128 v[104:107], v5 offset:24576
    v_cvt_pk_bf16_f32 v125, v18, v19
    v_mfma_f32_32x32x16_bf16 v[56:71], a[84:87], v[108:111], v[56:71]
    v_cvt_pk_bf16_f32 v126, v20, v21
    s_waitcnt lgkmcnt(3)
    v_mfma_f32_32x32x16_bf16 v[40:55], a[24:27], v[112:115], v[40:55]
    ds_read_b128 v[108:111], v5 offset:25600
    v_cvt_pk_bf16_f32 v127, v22, v23
    v_mfma_f32_32x32x16_bf16 v[56:71], a[88:91], v[112:115], v[56:71]
    ds_write_b128 v6, v[124:127] offset:32
    s_waitcnt lgkmcnt(4)
    v_mfma_f32_32x32x16_bf16 v[40:55], a[28:31], v[116:119], v[40:55]
    ds_read_b128 v[112:115], v5 offset:26624
    v_cvt_pk_bf16_f32 v120, v24, v25
    v_mfma_f32_32x32x16_bf16 v[56:71], a[92:95], v[116:119], v[56:71]
    v_cvt_pk_bf16_f32 v121, v26, v27
    s_waitcnt lgkmcnt(3)
    v_mfma_f32_32x32x16_bf16 v[40:55], a[32:35], v[104:107], v[40:55]
    ds_read_b128 v[116:119], v5 offset:27648
    v_cvt_pk_bf16_f32 v122, v28, v29
    v_mfma_f32_32x32x16_bf16 v[56:71], a[96:99], v[104:107], v[56:71]
    v_cvt_pk_bf16_f32 v123, v30, v31
    s_waitcnt lgkmcnt(3)
    v_mfma_f32_32x32x16_bf16 v[40:55], a[36:39], v[108:111], v[40:55]
    ds_read_b128 v[104:107], v5 offset:28672
    ds_write_b128 v6, v[120:123] offset:64
    v_mfma_f32_32x32x16_bf16 v[56:71], a[100:103], v[108:111], v[56:71]
    v_cvt_pk_bf16_f32 v124, v32, v33
    s_waitcnt lgkmcnt(3)
    v_mfma_f32_32x32x16_bf16 v[40:55], a[40:43], v[112:115], v[40:55]
    ds_read_b128 v[108:111], v5 offset:29696
    v_cvt_pk_bf16_f32 v125, v34, v35
    v_mfma_f32_32x32x16_bf16 v[56:71], a[104:107], v[112:115], v[56:71]
    v_cvt_pk_bf16_f32 v126, v36, v37
    s_waitcnt lgkmcnt(3)
    v_mfma_f32_32x32x16_bf16 v[40:55], a[44:47], v[116:119], v[40:55]
    ds_read_b128 v[112:115], v5 offset:30720
    v_cvt_pk_bf16_f32 v127, v38, v39
    v_mfma_f32_32x32x16_bf16 v[56:71], a[108:111], v[116:119], v[56:71]
    ds_write_b128 v6, v[124:127] offset:96
    s_waitcnt lgkmcnt(4)
    v_mfma_f32_32x32x16_bf16 v[40:55], a[48:51], v[104:107], v[40:55]
    ds_read_b128 v[116:119], v5 offset:31744
    v_mfma_f32_32x32x16_bf16 v[56:71], a[112:115], v[104:107], v[56:71]
    s_waitcnt lgkmcnt(3)
    v_mfma_f32_32x32x16_bf16 v[40:55], a[52:55], v[108:111], v[40:55]
    ds_read_b128 v[104:107], v5 offset:32768
    v_mfma_f32_32x32x16_bf16 v[56:71], a[116:119], v[108:111], v[56:71]
    s_waitcnt lgkmcnt(3)
    v_mfma_f32_32x32x16_bf16 v[40:55], a[56:59], v[112:115], v[40:55]
    ds_read_b128 v[108:111], v5 offset:33792
    v_mfma_f32_32x32x16_bf16 v[56:71], a[120:123], v[112:115], v[56:71]
    s_waitcnt lgkmcnt(2)
    v_mfma_f32_32x32x16_bf16 v[40:55], a[60:63], v[116:119], v[40:55]
    ds_read_b128 v[112:115], v5 offset:34816
    v_mfma_f32_32x32x16_bf16 v[56:71], a[124:127], v[116:119], v[56:71]
    s_barrier
    s_waitcnt lgkmcnt(2)
    v_mfma_f32_32x32x16_bf16 v[8:23], a[0:3], v[104:107], v[72:87]
    ds_read_b128 v[116:119], v5 offset:35840
    v_mfma_f32_32x32x16_bf16 v[24:39], a[64:67], v[104:107], v[88:103]
    s_waitcnt lgkmcnt(2)
    v_mfma_f32_32x32x16_bf16 v[8:23], a[4:7], v[108:111], v[8:23]
    ds_read_b128 v[104:107], v5 offset:36864
    v_mfma_f32_32x32x16_bf16 v[24:39], a[68:71], v[108:111], v[24:39]
    s_waitcnt lgkmcnt(2)
    v_mfma_f32_32x32x16_bf16 v[8:23], a[8:11], v[112:115], v[8:23]
    ds_read_b128 v[108:111], v5 offset:37888
    v_cvt_pk_bf16_f32 v120, v40, v41
    v_mfma_f32_32x32x16_bf16 v[24:39], a[72:75], v[112:115], v[24:39]
    v_cvt_pk_bf16_f32 v121, v42, v43
    s_waitcnt lgkmcnt(2)
    v_mfma_f32_32x32x16_bf16 v[8:23], a[12:15], v[116:119], v[8:23]
    ds_read_b128 v[112:115], v5 offset:38912
    v_cvt_pk_bf16_f32 v122, v44, v45
    v_mfma_f32_32x32x16_bf16 v[24:39], a[76:79], v[116:119], v[24:39]
    v_cvt_pk_bf16_f32 v123, v46, v47
    s_waitcnt lgkmcnt(2)
    v_mfma_f32_32x32x16_bf16 v[8:23], a[16:19], v[104:107], v[8:23]
    ds_read_b128 v[116:119], v5 offset:39936
    ds_write_b128 v6, v[120:123] offset:16896
    v_mfma_f32_32x32x16_bf16 v[24:39], a[80:83], v[104:107], v[24:39]
    v_cvt_pk_bf16_f32 v124, v48, v49
    s_waitcnt lgkmcnt(3)
    v_mfma_f32_32x32x16_bf16 v[8:23], a[20:23], v[108:111], v[8:23]
    ds_read_b128 v[104:107], v5 offset:40960
    v_cvt_pk_bf16_f32 v125, v50, v51
    v_mfma_f32_32x32x16_bf16 v[24:39], a[84:87], v[108:111], v[24:39]
    v_cvt_pk_bf16_f32 v126, v52, v53
    s_waitcnt lgkmcnt(3)
    v_mfma_f32_32x32x16_bf16 v[8:23], a[24:27], v[112:115], v[8:23]
    ds_read_b128 v[108:111], v5 offset:41984
    v_cvt_pk_bf16_f32 v127, v54, v55
    v_mfma_f32_32x32x16_bf16 v[24:39], a[88:91], v[112:115], v[24:39]
    ds_write_b128 v6, v[124:127] offset:16928
    s_waitcnt lgkmcnt(4)
    v_mfma_f32_32x32x16_bf16 v[8:23], a[28:31], v[116:119], v[8:23]
    ds_read_b128 v[112:115], v5 offset:43008
    v_cvt_pk_bf16_f32 v120, v56, v57
    v_mfma_f32_32x32x16_bf16 v[24:39], a[92:95], v[116:119], v[24:39]
    v_cvt_pk_bf16_f32 v121, v58, v59
    s_waitcnt lgkmcnt(3)
    v_mfma_f32_32x32x16_bf16 v[8:23], a[32:35], v[104:107], v[8:23]
    ds_read_b128 v[116:119], v5 offset:44032
    v_cvt_pk_bf16_f32 v122, v60, v61
    v_mfma_f32_32x32x16_bf16 v[24:39], a[96:99], v[104:107], v[24:39]
    v_cvt_pk_bf16_f32 v123, v62, v63
    s_waitcnt lgkmcnt(3)
    v_mfma_f32_32x32x16_bf16 v[8:23], a[36:39], v[108:111], v[8:23]
    ds_read_b128 v[104:107], v5 offset:45056
    ds_write_b128 v6, v[120:123] offset:16960
    v_mfma_f32_32x32x16_bf16 v[24:39], a[100:103], v[108:111], v[24:39]
    v_cvt_pk_bf16_f32 v124, v64, v65
    s_waitcnt lgkmcnt(3)
    v_mfma_f32_32x32x16_bf16 v[8:23], a[40:43], v[112:115], v[8:23]
    ds_read_b128 v[108:111], v5 offset:46080
    v_cvt_pk_bf16_f32 v125, v66, v67
    v_mfma_f32_32x32x16_bf16 v[24:39], a[104:107], v[112:115], v[24:39]
    v_cvt_pk_bf16_f32 v126, v68, v69
    s_waitcnt lgkmcnt(3)
    v_mfma_f32_32x32x16_bf16 v[8:23], a[44:47], v[116:119], v[8:23]
    ds_read_b128 v[112:115], v5 offset:47104
    v_cvt_pk_bf16_f32 v127, v70, v71
    v_mfma_f32_32x32x16_bf16 v[24:39], a[108:111], v[116:119], v[24:39]
    ds_write_b128 v6, v[124:127] offset:16992
    s_waitcnt lgkmcnt(4)
    v_mfma_f32_32x32x16_bf16 v[8:23], a[48:51], v[104:107], v[8:23]
    ds_read_b128 v[116:119], v5 offset:48128
    v_mfma_f32_32x32x16_bf16 v[24:39], a[112:115], v[104:107], v[24:39]
    s_waitcnt lgkmcnt(3)
    v_mfma_f32_32x32x16_bf16 v[8:23], a[52:55], v[108:111], v[8:23]
    ds_read_b128 v[104:107], v5 offset:0
    v_mfma_f32_32x32x16_bf16 v[24:39], a[116:119], v[108:111], v[24:39]
    s_waitcnt lgkmcnt(3)
    v_mfma_f32_32x32x16_bf16 v[8:23], a[56:59], v[112:115], v[8:23]
    ds_read_b128 v[108:111], v5 offset:1024
    v_mfma_f32_32x32x16_bf16 v[24:39], a[120:123], v[112:115], v[24:39]
    s_waitcnt lgkmcnt(2)
    v_mfma_f32_32x32x16_bf16 v[8:23], a[60:63], v[116:119], v[8:23]
    ds_read_b128 v[112:115], v5 offset:2048
    v_mfma_f32_32x32x16_bf16 v[24:39], a[124:127], v[116:119], v[24:39]
    s_barrier
    s_waitcnt lgkmcnt(2)
    v_mfma_f32_32x32x16_bf16 v[40:55], a[0:3], v[104:107], v[72:87]
    ds_read_b128 v[116:119], v5 offset:3072
    v_mfma_f32_32x32x16_bf16 v[56:71], a[64:67], v[104:107], v[88:103]
    s_waitcnt lgkmcnt(2)
    v_mfma_f32_32x32x16_bf16 v[40:55], a[4:7], v[108:111], v[40:55]
    ds_read_b128 v[104:107], v5 offset:4096
    v_mfma_f32_32x32x16_bf16 v[56:71], a[68:71], v[108:111], v[56:71]
    s_waitcnt lgkmcnt(2)
    v_mfma_f32_32x32x16_bf16 v[40:55], a[8:11], v[112:115], v[40:55]
    ds_read_b128 v[108:111], v5 offset:5120
    v_cvt_pk_bf16_f32 v120, v8, v9
    v_mfma_f32_32x32x16_bf16 v[56:71], a[72:75], v[112:115], v[56:71]
    v_cvt_pk_bf16_f32 v121, v10, v11
    s_waitcnt lgkmcnt(2)
    v_mfma_f32_32x32x16_bf16 v[40:55], a[12:15], v[116:119], v[40:55]
    ds_read_b128 v[112:115], v5 offset:6144
    v_cvt_pk_bf16_f32 v122, v12, v13
    v_mfma_f32_32x32x16_bf16 v[56:71], a[76:79], v[116:119], v[56:71]
    v_cvt_pk_bf16_f32 v123, v14, v15
    s_waitcnt lgkmcnt(2)
    v_mfma_f32_32x32x16_bf16 v[40:55], a[16:19], v[104:107], v[40:55]
    ds_read_b128 v[116:119], v5 offset:7168
    ds_write_b128 v6, v[120:123] offset:0
    v_mfma_f32_32x32x16_bf16 v[56:71], a[80:83], v[104:107], v[56:71]
    v_cvt_pk_bf16_f32 v124, v16, v17
    s_waitcnt lgkmcnt(3)
    v_mfma_f32_32x32x16_bf16 v[40:55], a[20:23], v[108:111], v[40:55]
    ds_read_b128 v[104:107], v5 offset:8192
    v_cvt_pk_bf16_f32 v125, v18, v19
    v_mfma_f32_32x32x16_bf16 v[56:71], a[84:87], v[108:111], v[56:71]
    v_cvt_pk_bf16_f32 v126, v20, v21
    s_waitcnt lgkmcnt(3)
    v_mfma_f32_32x32x16_bf16 v[40:55], a[24:27], v[112:115], v[40:55]
    ds_read_b128 v[108:111], v5 offset:9216
    v_cvt_pk_bf16_f32 v127, v22, v23
    v_mfma_f32_32x32x16_bf16 v[56:71], a[88:91], v[112:115], v[56:71]
    ds_write_b128 v6, v[124:127] offset:32
    s_waitcnt lgkmcnt(4)
    v_mfma_f32_32x32x16_bf16 v[40:55], a[28:31], v[116:119], v[40:55]
    ds_read_b128 v[112:115], v5 offset:10240
    v_cvt_pk_bf16_f32 v120, v24, v25
    v_mfma_f32_32x32x16_bf16 v[56:71], a[92:95], v[116:119], v[56:71]
    v_cvt_pk_bf16_f32 v121, v26, v27
    s_waitcnt lgkmcnt(3)
    v_mfma_f32_32x32x16_bf16 v[40:55], a[32:35], v[104:107], v[40:55]
    ds_read_b128 v[116:119], v5 offset:11264
    v_cvt_pk_bf16_f32 v122, v28, v29
    v_mfma_f32_32x32x16_bf16 v[56:71], a[96:99], v[104:107], v[56:71]
    v_cvt_pk_bf16_f32 v123, v30, v31
    s_waitcnt lgkmcnt(3)
    v_mfma_f32_32x32x16_bf16 v[40:55], a[36:39], v[108:111], v[40:55]
    ds_read_b128 v[104:107], v5 offset:12288
    ds_write_b128 v6, v[120:123] offset:64
    v_mfma_f32_32x32x16_bf16 v[56:71], a[100:103], v[108:111], v[56:71]
    v_cvt_pk_bf16_f32 v124, v32, v33
    s_waitcnt lgkmcnt(3)
    v_mfma_f32_32x32x16_bf16 v[40:55], a[40:43], v[112:115], v[40:55]
    ds_read_b128 v[108:111], v5 offset:13312
    v_cvt_pk_bf16_f32 v125, v34, v35
    v_mfma_f32_32x32x16_bf16 v[56:71], a[104:107], v[112:115], v[56:71]
    v_cvt_pk_bf16_f32 v126, v36, v37
    s_waitcnt lgkmcnt(3)
    v_mfma_f32_32x32x16_bf16 v[40:55], a[44:47], v[116:119], v[40:55]
    ds_read_b128 v[112:115], v5 offset:14336
    v_cvt_pk_bf16_f32 v127, v38, v39
    v_mfma_f32_32x32x16_bf16 v[56:71], a[108:111], v[116:119], v[56:71]
    ds_write_b128 v6, v[124:127] offset:96
    s_waitcnt lgkmcnt(4)
    v_mfma_f32_32x32x16_bf16 v[40:55], a[48:51], v[104:107], v[40:55]
    ds_read_b128 v[116:119], v5 offset:15360
    v_mfma_f32_32x32x16_bf16 v[56:71], a[112:115], v[104:107], v[56:71]
    s_waitcnt lgkmcnt(3)
    v_mfma_f32_32x32x16_bf16 v[40:55], a[52:55], v[108:111], v[40:55]
    ds_read_b128 v[104:107], v5 offset:16384
    v_mfma_f32_32x32x16_bf16 v[56:71], a[116:119], v[108:111], v[56:71]
    s_waitcnt lgkmcnt(3)
    v_mfma_f32_32x32x16_bf16 v[40:55], a[56:59], v[112:115], v[40:55]
    ds_read_b128 v[108:111], v5 offset:17408
    v_mfma_f32_32x32x16_bf16 v[56:71], a[120:123], v[112:115], v[56:71]
    s_waitcnt lgkmcnt(2)
    v_mfma_f32_32x32x16_bf16 v[40:55], a[60:63], v[116:119], v[40:55]
    ds_read_b128 v[112:115], v5 offset:18432
    v_mfma_f32_32x32x16_bf16 v[56:71], a[124:127], v[116:119], v[56:71]
    s_barrier
    s_waitcnt lgkmcnt(2)
    v_mfma_f32_32x32x16_bf16 v[8:23], a[0:3], v[104:107], v[72:87]
    ds_read_b128 v[116:119], v5 offset:19456
    v_mfma_f32_32x32x16_bf16 v[24:39], a[64:67], v[104:107], v[88:103]
    s_waitcnt lgkmcnt(2)
    v_mfma_f32_32x32x16_bf16 v[8:23], a[4:7], v[108:111], v[8:23]
    ds_read_b128 v[104:107], v5 offset:20480
    v_mfma_f32_32x32x16_bf16 v[24:39], a[68:71], v[108:111], v[24:39]
    s_waitcnt lgkmcnt(2)
    v_mfma_f32_32x32x16_bf16 v[8:23], a[8:11], v[112:115], v[8:23]
    ds_read_b128 v[108:111], v5 offset:21504
    v_cvt_pk_bf16_f32 v120, v40, v41
    v_mfma_f32_32x32x16_bf16 v[24:39], a[72:75], v[112:115], v[24:39]
    v_cvt_pk_bf16_f32 v121, v42, v43
    s_waitcnt lgkmcnt(2)
    v_mfma_f32_32x32x16_bf16 v[8:23], a[12:15], v[116:119], v[8:23]
    ds_read_b128 v[112:115], v5 offset:22528
    v_cvt_pk_bf16_f32 v122, v44, v45
    v_mfma_f32_32x32x16_bf16 v[24:39], a[76:79], v[116:119], v[24:39]
    v_cvt_pk_bf16_f32 v123, v46, v47
    s_waitcnt lgkmcnt(2)
    v_mfma_f32_32x32x16_bf16 v[8:23], a[16:19], v[104:107], v[8:23]
    ds_read_b128 v[116:119], v5 offset:23552
    ds_write_b128 v6, v[120:123] offset:16896
    v_mfma_f32_32x32x16_bf16 v[24:39], a[80:83], v[104:107], v[24:39]
    v_cvt_pk_bf16_f32 v124, v48, v49
    s_waitcnt lgkmcnt(3)
    v_mfma_f32_32x32x16_bf16 v[8:23], a[20:23], v[108:111], v[8:23]
    ds_read_b128 v[104:107], v5 offset:24576
    v_cvt_pk_bf16_f32 v125, v50, v51
    v_mfma_f32_32x32x16_bf16 v[24:39], a[84:87], v[108:111], v[24:39]
    v_cvt_pk_bf16_f32 v126, v52, v53
    s_waitcnt lgkmcnt(3)
    v_mfma_f32_32x32x16_bf16 v[8:23], a[24:27], v[112:115], v[8:23]
    ds_read_b128 v[108:111], v5 offset:25600
    v_cvt_pk_bf16_f32 v127, v54, v55
    v_mfma_f32_32x32x16_bf16 v[24:39], a[88:91], v[112:115], v[24:39]
    ds_write_b128 v6, v[124:127] offset:16928
    s_waitcnt lgkmcnt(4)
    v_mfma_f32_32x32x16_bf16 v[8:23], a[28:31], v[116:119], v[8:23]
    ds_read_b128 v[112:115], v5 offset:26624
    v_cvt_pk_bf16_f32 v120, v56, v57
    v_mfma_f32_32x32x16_bf16 v[24:39], a[92:95], v[116:119], v[24:39]
    v_cvt_pk_bf16_f32 v121, v58, v59
    s_waitcnt lgkmcnt(3)
    v_mfma_f32_32x32x16_bf16 v[8:23], a[32:35], v[104:107], v[8:23]
    ds_read_b128 v[116:119], v5 offset:27648
    v_cvt_pk_bf16_f32 v122, v60, v61
    v_mfma_f32_32x32x16_bf16 v[24:39], a[96:99], v[104:107], v[24:39]
    v_cvt_pk_bf16_f32 v123, v62, v63
    s_waitcnt lgkmcnt(3)
    v_mfma_f32_32x32x16_bf16 v[8:23], a[36:39], v[108:111], v[8:23]
    ds_read_b128 v[104:107], v5 offset:28672
    ds_write_b128 v6, v[120:123] offset:16960
    v_mfma_f32_32x32x16_bf16 v[24:39], a[100:103], v[108:111], v[24:39]
    v_cvt_pk_bf16_f32 v124, v64, v65
    s_waitcnt lgkmcnt(3)
    v_mfma_f32_32x32x16_bf16 v[8:23], a[40:43], v[112:115], v[8:23]
    ds_read_b128 v[108:111], v5 offset:29696
    v_cvt_pk_bf16_f32 v125, v66, v67
    v_mfma_f32_32x32x16_bf16 v[24:39], a[104:107], v[112:115], v[24:39]
    v_cvt_pk_bf16_f32 v126, v68, v69
    s_waitcnt lgkmcnt(3)
    v_mfma_f32_32x32x16_bf16 v[8:23], a[44:47], v[116:119], v[8:23]
    ds_read_b128 v[112:115], v5 offset:30720
    v_cvt_pk_bf16_f32 v127, v70, v71
    v_mfma_f32_32x32x16_bf16 v[24:39], a[108:111], v[116:119], v[24:39]
    ds_write_b128 v6, v[124:127] offset:16992
    s_waitcnt lgkmcnt(4)
    v_mfma_f32_32x32x16_bf16 v[8:23], a[48:51], v[104:107], v[8:23]
    ds_read_b128 v[116:119], v5 offset:31744
    v_mfma_f32_32x32x16_bf16 v[24:39], a[112:115], v[104:107], v[24:39]
    s_waitcnt lgkmcnt(3)
    v_mfma_f32_32x32x16_bf16 v[8:23], a[52:55], v[108:111], v[8:23]
    ds_read_b128 v[104:107], v5 offset:32768
    v_mfma_f32_32x32x16_bf16 v[24:39], a[116:119], v[108:111], v[24:39]
    s_waitcnt lgkmcnt(3)
    v_mfma_f32_32x32x16_bf16 v[8:23], a[56:59], v[112:115], v[8:23]
    ds_read_b128 v[108:111], v5 offset:33792
    v_mfma_f32_32x32x16_bf16 v[24:39], a[120:123], v[112:115], v[24:39]
    s_waitcnt lgkmcnt(2)
    v_mfma_f32_32x32x16_bf16 v[8:23], a[60:63], v[116:119], v[8:23]
    ds_read_b128 v[112:115], v5 offset:34816
    v_mfma_f32_32x32x16_bf16 v[24:39], a[124:127], v[116:119], v[24:39]
    s_barrier
    s_waitcnt lgkmcnt(2)
    v_mfma_f32_32x32x16_bf16 v[40:55], a[0:3], v[104:107], v[72:87]
    ds_read_b128 v[116:119], v5 offset:35840
    v_mfma_f32_32x32x16_bf16 v[56:71], a[64:67], v[104:107], v[88:103]
    s_waitcnt lgkmcnt(2)
    v_mfma_f32_32x32x16_bf16 v[40:55], a[4:7], v[108:111], v[40:55]
    ds_read_b128 v[104:107], v5 offset:36864
    v_mfma_f32_32x32x16_bf16 v[56:71], a[68:71], v[108:111], v[56:71]
    s_waitcnt lgkmcnt(2)
    v_mfma_f32_32x32x16_bf16 v[40:55], a[8:11], v[112:115], v[40:55]
    ds_read_b128 v[108:111], v5 offset:37888
    v_cvt_pk_bf16_f32 v120, v8, v9
    v_mfma_f32_32x32x16_bf16 v[56:71], a[72:75], v[112:115], v[56:71]
    v_cvt_pk_bf16_f32 v121, v10, v11
    s_waitcnt lgkmcnt(2)
    v_mfma_f32_32x32x16_bf16 v[40:55], a[12:15], v[116:119], v[40:55]
    ds_read_b128 v[112:115], v5 offset:38912
    v_cvt_pk_bf16_f32 v122, v12, v13
    v_mfma_f32_32x32x16_bf16 v[56:71], a[76:79], v[116:119], v[56:71]
    v_cvt_pk_bf16_f32 v123, v14, v15
    s_waitcnt lgkmcnt(2)
    v_mfma_f32_32x32x16_bf16 v[40:55], a[16:19], v[104:107], v[40:55]
    ds_read_b128 v[116:119], v5 offset:39936
    ds_write_b128 v6, v[120:123] offset:0
    v_mfma_f32_32x32x16_bf16 v[56:71], a[80:83], v[104:107], v[56:71]
    v_cvt_pk_bf16_f32 v124, v16, v17
    s_waitcnt lgkmcnt(3)
    v_mfma_f32_32x32x16_bf16 v[40:55], a[20:23], v[108:111], v[40:55]
    ds_read_b128 v[104:107], v5 offset:40960
    v_cvt_pk_bf16_f32 v125, v18, v19
    v_mfma_f32_32x32x16_bf16 v[56:71], a[84:87], v[108:111], v[56:71]
    v_cvt_pk_bf16_f32 v126, v20, v21
    s_waitcnt lgkmcnt(3)
    v_mfma_f32_32x32x16_bf16 v[40:55], a[24:27], v[112:115], v[40:55]
    ds_read_b128 v[108:111], v5 offset:41984
    v_cvt_pk_bf16_f32 v127, v22, v23
    v_mfma_f32_32x32x16_bf16 v[56:71], a[88:91], v[112:115], v[56:71]
    ds_write_b128 v6, v[124:127] offset:32
    s_waitcnt lgkmcnt(4)
    v_mfma_f32_32x32x16_bf16 v[40:55], a[28:31], v[116:119], v[40:55]
    ds_read_b128 v[112:115], v5 offset:43008
    v_cvt_pk_bf16_f32 v120, v24, v25
    v_mfma_f32_32x32x16_bf16 v[56:71], a[92:95], v[116:119], v[56:71]
    v_cvt_pk_bf16_f32 v121, v26, v27
    s_waitcnt lgkmcnt(3)
    v_mfma_f32_32x32x16_bf16 v[40:55], a[32:35], v[104:107], v[40:55]
    ds_read_b128 v[116:119], v5 offset:44032
    v_cvt_pk_bf16_f32 v122, v28, v29
    v_mfma_f32_32x32x16_bf16 v[56:71], a[96:99], v[104:107], v[56:71]
    v_cvt_pk_bf16_f32 v123, v30, v31
    s_waitcnt lgkmcnt(3)
    v_mfma_f32_32x32x16_bf16 v[40:55], a[36:39], v[108:111], v[40:55]
    ds_read_b128 v[104:107], v5 offset:45056
    ds_write_b128 v6, v[120:123] offset:64
    v_mfma_f32_32x32x16_bf16 v[56:71], a[100:103], v[108:111], v[56:71]
    v_cvt_pk_bf16_f32 v124, v32, v33
    s_waitcnt lgkmcnt(3)
    v_mfma_f32_32x32x16_bf16 v[40:55], a[40:43], v[112:115], v[40:55]
    ds_read_b128 v[108:111], v5 offset:46080
    v_cvt_pk_bf16_f32 v125, v34, v35
    v_mfma_f32_32x32x16_bf16 v[56:71], a[104:107], v[112:115], v[56:71]
    v_cvt_pk_bf16_f32 v126, v36, v37
    s_waitcnt lgkmcnt(3)
    v_mfma_f32_32x32x16_bf16 v[40:55], a[44:47], v[116:119], v[40:55]
    ds_read_b128 v[112:115], v5 offset:47104
    v_cvt_pk_bf16_f32 v127, v38, v39
    v_mfma_f32_32x32x16_bf16 v[56:71], a[108:111], v[116:119], v[56:71]
    ds_write_b128 v6, v[124:127] offset:96
    s_waitcnt lgkmcnt(4)
    v_mfma_f32_32x32x16_bf16 v[40:55], a[48:51], v[104:107], v[40:55]
    ds_read_b128 v[116:119], v5 offset:48128
    v_mfma_f32_32x32x16_bf16 v[56:71], a[112:115], v[104:107], v[56:71]
    s_waitcnt lgkmcnt(3)
    v_mfma_f32_32x32x16_bf16 v[40:55], a[52:55], v[108:111], v[40:55]
    ds_read_b128 v[104:107], v5 offset:0
    v_mfma_f32_32x32x16_bf16 v[56:71], a[116:119], v[108:111], v[56:71]
    s_waitcnt lgkmcnt(3)
    v_mfma_f32_32x32x16_bf16 v[40:55], a[56:59], v[112:115], v[40:55]
    ds_read_b128 v[108:111], v5 offset:1024
    v_mfma_f32_32x32x16_bf16 v[56:71], a[120:123], v[112:115], v[56:71]
    s_waitcnt lgkmcnt(2)
    v_mfma_f32_32x32x16_bf16 v[40:55], a[60:63], v[116:119], v[40:55]
    ds_read_b128 v[112:115], v5 offset:2048
    v_mfma_f32_32x32x16_bf16 v[56:71], a[124:127], v[116:119], v[56:71]
    s_barrier
    s_waitcnt lgkmcnt(2)
    v_mfma_f32_32x32x16_bf16 v[8:23], a[0:3], v[104:107], v[72:87]
    ds_read_b128 v[116:119], v5 offset:3072
    v_mfma_f32_32x32x16_bf16 v[24:39], a[64:67], v[104:107], v[88:103]
    s_waitcnt lgkmcnt(2)
    v_mfma_f32_32x32x16_bf16 v[8:23], a[4:7], v[108:111], v[8:23]
    ds_read_b128 v[104:107], v5 offset:4096
    v_mfma_f32_32x32x16_bf16 v[24:39], a[68:71], v[108:111], v[24:39]
    s_waitcnt lgkmcnt(2)
    v_mfma_f32_32x32x16_bf16 v[8:23], a[8:11], v[112:115], v[8:23]
    ds_read_b128 v[108:111], v5 offset:5120
    v_cvt_pk_bf16_f32 v120, v40, v41
    v_mfma_f32_32x32x16_bf16 v[24:39], a[72:75], v[112:115], v[24:39]
    v_cvt_pk_bf16_f32 v121, v42, v43
    s_waitcnt lgkmcnt(2)
    v_mfma_f32_32x32x16_bf16 v[8:23], a[12:15], v[116:119], v[8:23]
    ds_read_b128 v[112:115], v5 offset:6144
    v_cvt_pk_bf16_f32 v122, v44, v45
    v_mfma_f32_32x32x16_bf16 v[24:39], a[76:79], v[116:119], v[24:39]
    v_cvt_pk_bf16_f32 v123, v46, v47
    s_waitcnt lgkmcnt(2)
    v_mfma_f32_32x32x16_bf16 v[8:23], a[16:19], v[104:107], v[8:23]
    ds_read_b128 v[116:119], v5 offset:7168
    ds_write_b128 v6, v[120:123] offset:16896
    v_mfma_f32_32x32x16_bf16 v[24:39], a[80:83], v[104:107], v[24:39]
    v_cvt_pk_bf16_f32 v124, v48, v49
    s_waitcnt lgkmcnt(3)
    v_mfma_f32_32x32x16_bf16 v[8:23], a[20:23], v[108:111], v[8:23]
    ds_read_b128 v[104:107], v5 offset:8192
    v_cvt_pk_bf16_f32 v125, v50, v51
    v_mfma_f32_32x32x16_bf16 v[24:39], a[84:87], v[108:111], v[24:39]
    v_cvt_pk_bf16_f32 v126, v52, v53
    s_waitcnt lgkmcnt(3)
    v_mfma_f32_32x32x16_bf16 v[8:23], a[24:27], v[112:115], v[8:23]
    ds_read_b128 v[108:111], v5 offset:9216
    v_cvt_pk_bf16_f32 v127, v54, v55
    v_mfma_f32_32x32x16_bf16 v[24:39], a[88:91], v[112:115], v[24:39]
    ds_write_b128 v6, v[124:127] offset:16928
    s_waitcnt lgkmcnt(4)
    v_mfma_f32_32x32x16_bf16 v[8:23], a[28:31], v[116:119], v[8:23]
    ds_read_b128 v[112:115], v5 offset:10240
    v_cvt_pk_bf16_f32 v120, v56, v57
    v_mfma_f32_32x32x16_bf16 v[24:39], a[92:95], v[116:119], v[24:39]
    v_cvt_pk_bf16_f32 v121, v58, v59
    s_waitcnt lgkmcnt(3)
    v_mfma_f32_32x32x16_bf16 v[8:23], a[32:35], v[104:107], v[8:23]
    ds_read_b128 v[116:119], v5 offset:11264
    v_cvt_pk_bf16_f32 v122, v60, v61
    v_mfma_f32_32x32x16_bf16 v[24:39], a[96:99], v[104:107], v[24:39]
    v_cvt_pk_bf16_f32 v123, v62, v63
    s_waitcnt lgkmcnt(3)
    v_mfma_f32_32x32x16_bf16 v[8:23], a[36:39], v[108:111], v[8:23]
    ds_read_b128 v[104:107], v5 offset:12288
    ds_write_b128 v6, v[120:123] offset:16960
    v_mfma_f32_32x32x16_bf16 v[24:39], a[100:103], v[108:111], v[24:39]
    v_cvt_pk_bf16_f32 v124, v64, v65
    s_waitcnt lgkmcnt(3)
    v_mfma_f32_32x32x16_bf16 v[8:23], a[40:43], v[112:115], v[8:23]
    ds_read_b128 v[108:111], v5 offset:13312
    v_cvt_pk_bf16_f32 v125, v66, v67
    v_mfma_f32_32x32x16_bf16 v[24:39], a[104:107], v[112:115], v[24:39]
    v_cvt_pk_bf16_f32 v126, v68, v69
    s_waitcnt lgkmcnt(3)
    v_mfma_f32_32x32x16_bf16 v[8:23], a[44:47], v[116:119], v[8:23]
    ds_read_b128 v[112:115], v5 offset:14336
    v_cvt_pk_bf16_f32 v127, v70, v71
    v_mfma_f32_32x32x16_bf16 v[24:39], a[108:111], v[116:119], v[24:39]
    ds_write_b128 v6, v[124:127] offset:16992
    s_waitcnt lgkmcnt(4)
    v_mfma_f32_32x32x16_bf16 v[8:23], a[48:51], v[104:107], v[8:23]
    ds_read_b128 v[116:119], v5 offset:15360
    v_mfma_f32_32x32x16_bf16 v[24:39], a[112:115], v[104:107], v[24:39]
    s_waitcnt lgkmcnt(3)
    v_mfma_f32_32x32x16_bf16 v[8:23], a[52:55], v[108:111], v[8:23]
    ds_read_b128 v[104:107], v5 offset:16384
    v_mfma_f32_32x32x16_bf16 v[24:39], a[116:119], v[108:111], v[24:39]
    s_waitcnt lgkmcnt(3)
    v_mfma_f32_32x32x16_bf16 v[8:23], a[56:59], v[112:115], v[8:23]
    ds_read_b128 v[108:111], v5 offset:17408
    v_mfma_f32_32x32x16_bf16 v[24:39], a[120:123], v[112:115], v[24:39]
    s_waitcnt lgkmcnt(2)
    v_mfma_f32_32x32x16_bf16 v[8:23], a[60:63], v[116:119], v[8:23]
    ds_read_b128 v[112:115], v5 offset:18432
    v_mfma_f32_32x32x16_bf16 v[24:39], a[124:127], v[116:119], v[24:39]
    s_barrier
    s_waitcnt lgkmcnt(2)
    v_mfma_f32_32x32x16_bf16 v[40:55], a[0:3], v[104:107], v[72:87]
    ds_read_b128 v[116:119], v5 offset:19456
    v_mfma_f32_32x32x16_bf16 v[56:71], a[64:67], v[104:107], v[88:103]
    s_waitcnt lgkmcnt(2)
    v_mfma_f32_32x32x16_bf16 v[40:55], a[4:7], v[108:111], v[40:55]
    ds_read_b128 v[104:107], v5 offset:20480
    v_mfma_f32_32x32x16_bf16 v[56:71], a[68:71], v[108:111], v[56:71]
    s_waitcnt lgkmcnt(2)
    v_mfma_f32_32x32x16_bf16 v[40:55], a[8:11], v[112:115], v[40:55]
    ds_read_b128 v[108:111], v5 offset:21504
    v_cvt_pk_bf16_f32 v120, v8, v9
    v_mfma_f32_32x32x16_bf16 v[56:71], a[72:75], v[112:115], v[56:71]
    v_cvt_pk_bf16_f32 v121, v10, v11
    s_waitcnt lgkmcnt(2)
    v_mfma_f32_32x32x16_bf16 v[40:55], a[12:15], v[116:119], v[40:55]
    ds_read_b128 v[112:115], v5 offset:22528
    v_cvt_pk_bf16_f32 v122, v12, v13
    v_mfma_f32_32x32x16_bf16 v[56:71], a[76:79], v[116:119], v[56:71]
    v_cvt_pk_bf16_f32 v123, v14, v15
    s_waitcnt lgkmcnt(2)
    v_mfma_f32_32x32x16_bf16 v[40:55], a[16:19], v[104:107], v[40:55]
    ds_read_b128 v[116:119], v5 offset:23552
    ds_write_b128 v6, v[120:123] offset:0
    v_mfma_f32_32x32x16_bf16 v[56:71], a[80:83], v[104:107], v[56:71]
    v_cvt_pk_bf16_f32 v124, v16, v17
    s_waitcnt lgkmcnt(3)
    v_mfma_f32_32x32x16_bf16 v[40:55], a[20:23], v[108:111], v[40:55]
    ds_read_b128 v[104:107], v5 offset:24576
    v_cvt_pk_bf16_f32 v125, v18, v19
    v_mfma_f32_32x32x16_bf16 v[56:71], a[84:87], v[108:111], v[56:71]
    v_cvt_pk_bf16_f32 v126, v20, v21
    s_waitcnt lgkmcnt(3)
    v_mfma_f32_32x32x16_bf16 v[40:55], a[24:27], v[112:115], v[40:55]
    ds_read_b128 v[108:111], v5 offset:25600
    v_cvt_pk_bf16_f32 v127, v22, v23
    v_mfma_f32_32x32x16_bf16 v[56:71], a[88:91], v[112:115], v[56:71]
    ds_write_b128 v6, v[124:127] offset:32
    s_waitcnt lgkmcnt(4)
    v_mfma_f32_32x32x16_bf16 v[40:55], a[28:31], v[116:119], v[40:55]
    ds_read_b128 v[112:115], v5 offset:26624
    v_cvt_pk_bf16_f32 v120, v24, v25
    v_mfma_f32_32x32x16_bf16 v[56:71], a[92:95], v[116:119], v[56:71]
    v_cvt_pk_bf16_f32 v121, v26, v27
    s_waitcnt lgkmcnt(3)
    v_mfma_f32_32x32x16_bf16 v[40:55], a[32:35], v[104:107], v[40:55]
    ds_read_b128 v[116:119], v5 offset:27648
    v_cvt_pk_bf16_f32 v122, v28, v29
    v_mfma_f32_32x32x16_bf16 v[56:71], a[96:99], v[104:107], v[56:71]
    v_cvt_pk_bf16_f32 v123, v30, v31
    s_waitcnt lgkmcnt(3)
    v_mfma_f32_32x32x16_bf16 v[40:55], a[36:39], v[108:111], v[40:55]
    ds_read_b128 v[104:107], v5 offset:28672
    ds_write_b128 v6, v[120:123] offset:64
    v_mfma_f32_32x32x16_bf16 v[56:71], a[100:103], v[108:111], v[56:71]
    v_cvt_pk_bf16_f32 v124, v32, v33
    s_waitcnt lgkmcnt(3)
    v_mfma_f32_32x32x16_bf16 v[40:55], a[40:43], v[112:115], v[40:55]
    ds_read_b128 v[108:111], v5 offset:29696
    v_cvt_pk_bf16_f32 v125, v34, v35
    v_mfma_f32_32x32x16_bf16 v[56:71], a[104:107], v[112:115], v[56:71]
    v_cvt_pk_bf16_f32 v126, v36, v37
    s_waitcnt lgkmcnt(3)
    v_mfma_f32_32x32x16_bf16 v[40:55], a[44:47], v[116:119], v[40:55]
    ds_read_b128 v[112:115], v5 offset:30720
    v_cvt_pk_bf16_f32 v127, v38, v39
    v_mfma_f32_32x32x16_bf16 v[56:71], a[108:111], v[116:119], v[56:71]
    ds_write_b128 v6, v[124:127] offset:96
    s_waitcnt lgkmcnt(4)
    v_mfma_f32_32x32x16_bf16 v[40:55], a[48:51], v[104:107], v[40:55]
    ds_read_b128 v[116:119], v5 offset:31744
    v_mfma_f32_32x32x16_bf16 v[56:71], a[112:115], v[104:107], v[56:71]
    s_waitcnt lgkmcnt(3)
    v_mfma_f32_32x32x16_bf16 v[40:55], a[52:55], v[108:111], v[40:55]
    v_mfma_f32_32x32x16_bf16 v[56:71], a[116:119], v[108:111], v[56:71]
    s_waitcnt lgkmcnt(2)
    v_mfma_f32_32x32x16_bf16 v[40:55], a[56:59], v[112:115], v[40:55]
    v_mfma_f32_32x32x16_bf16 v[56:71], a[120:123], v[112:115], v[56:71]
    s_waitcnt lgkmcnt(0)
    v_mfma_f32_32x32x16_bf16 v[40:55], a[60:63], v[116:119], v[40:55]
    v_mfma_f32_32x32x16_bf16 v[56:71], a[124:127], v[116:119], v[56:71]
    s_barrier
    s_nop 7
    s_nop 7
    v_cvt_pk_bf16_f32 v120, v40, v41
    v_cvt_pk_bf16_f32 v121, v42, v43
    v_cvt_pk_bf16_f32 v122, v44, v45
    v_cvt_pk_bf16_f32 v123, v46, v47
    ds_write_b128 v6, v[120:123] offset:16896
    v_cvt_pk_bf16_f32 v124, v48, v49
    v_cvt_pk_bf16_f32 v125, v50, v51
    v_cvt_pk_bf16_f32 v126, v52, v53
    v_cvt_pk_bf16_f32 v127, v54, v55
    ds_write_b128 v6, v[124:127] offset:16928
    v_cvt_pk_bf16_f32 v120, v56, v57
    v_cvt_pk_bf16_f32 v121, v58, v59
    v_cvt_pk_bf16_f32 v122, v60, v61
    v_cvt_pk_bf16_f32 v123, v62, v63
    ds_write_b128 v6, v[120:123] offset:16960
    v_cvt_pk_bf16_f32 v124, v64, v65
    v_cvt_pk_bf16_f32 v125, v66, v67
    v_cvt_pk_bf16_f32 v126, v68, v69
    v_cvt_pk_bf16_f32 v127, v70, v71
    ds_write_b128 v6, v[124:127] offset:16992
    s_waitcnt lgkmcnt(0)
    s_barrier
    s_endpgm
L_joint_kernel_helper:
    v_and_b32 v14, 7, v1
    v_lshlrev_b32 v14, 10, v14
    v_lshrrev_b32 v15, 5, v1
    v_lshl_add_u32 v14, v15, 4, v14
    s_lshl_b32 s36, s24, 13
    s_lshl_b32 s37, s21, 8
    s_add_u32 s36, s36, s37
    s_add_u32 s37, s36, 16384
    s_add_u32 s36, s38, 32768
    buffer_load_dwordx4 a[0:3], v5, s[12:15], s36 offen
    s_add_u32 s36, s38, 49152
    buffer_load_dwordx4 a[64:67], v5, s[12:15], s36 offen
    s_add_u32 s36, s38, 33792
    buffer_load_dwordx4 a[4:7], v5, s[12:15], s36 offen
    s_add_u32 s36, s38, 50176
    buffer_load_dwordx4 a[68:71], v5, s[12:15], s36 offen
    s_add_u32 s36, s38, 34816
    buffer_load_dwordx4 a[8:11], v5, s[12:15], s36 offen
    s_add_u32 s36, s38, 51200
    buffer_load_dwordx4 a[72:75], v5, s[12:15], s36 offen
    s_add_u32 s36, s38, 35840
    buffer_load_dwordx4 a[12:15], v5, s[12:15], s36 offen
    s_add_u32 s36, s38, 52224
    buffer_load_dwordx4 a[76:79], v5, s[12:15], s36 offen
    s_add_u32 s36, s38, 36864
    buffer_load_dwordx4 a[16:19], v5, s[12:15], s36 offen
    s_add_u32 s36, s38, 53248
    buffer_load_dwordx4 a[80:83], v5, s[12:15], s36 offen
    s_add_u32 s36, s38, 37888
    buffer_load_dwordx4 a[20:23], v5, s[12:15], s36 offen
    s_add_u32 s36, s38, 54272
    buffer_load_dwordx4 a[84:87], v5, s[12:15], s36 offen
    s_add_u32 s36, s38, 38912
    buffer_load_dwordx4 a[24:27], v5, s[12:15], s36 offen
    s_add_u32 s36, s38, 55296
    buffer_load_dwordx4 a[88:91], v5, s[12:15], s36 offen
    s_add_u32 s36, s38, 39936
    buffer_load_dwordx4 a[28:31], v5, s[12:15], s36 offen
    s_add_u32 s36, s38, 56320
    buffer_load_dwordx4 a[92:95], v5, s[12:15], s36 offen
    s_add_u32 s36, s38, 40960
    buffer_load_dwordx4 a[32:35], v5, s[12:15], s36 offen
    s_add_u32 s36, s38, 57344
    buffer_load_dwordx4 a[96:99], v5, s[12:15], s36 offen
    s_add_u32 s36, s38, 41984
    buffer_load_dwordx4 a[36:39], v5, s[12:15], s36 offen
    s_add_u32 s36, s38, 58368
    buffer_load_dwordx4 a[100:103], v5, s[12:15], s36 offen
    s_add_u32 s36, s38, 43008
    buffer_load_dwordx4 a[40:43], v5, s[12:15], s36 offen
    s_add_u32 s36, s38, 59392
    buffer_load_dwordx4 a[104:107], v5, s[12:15], s36 offen
    s_add_u32 s36, s38, 44032
    buffer_load_dwordx4 a[44:47], v5, s[12:15], s36 offen
    s_add_u32 s36, s38, 60416
    buffer_load_dwordx4 a[108:111], v5, s[12:15], s36 offen
    s_add_u32 s36, s38, 45056
    buffer_load_dwordx4 a[48:51], v5, s[12:15], s36 offen
    s_add_u32 s36, s38, 61440
    buffer_load_dwordx4 a[112:115], v5, s[12:15], s36 offen
    s_add_u32 s36, s38, 46080
    buffer_load_dwordx4 a[52:55], v5, s[12:15], s36 offen
    s_add_u32 s36, s38, 62464
    buffer_load_dwordx4 a[116:119], v5, s[12:15], s36 offen
    s_add_u32 s36, s38, 47104
    buffer_load_dwordx4 a[56:59], v5, s[12:15], s36 offen
    s_add_u32 s36, s38, 63488
    buffer_load_dwordx4 a[120:123], v5, s[12:15], s36 offen
    s_add_u32 s36, s38, 48128
    buffer_load_dwordx4 a[60:63], v5, s[12:15], s36 offen
    s_add_u32 s36, s38, 64512
    buffer_load_dwordx4 a[124:127], v5, s[12:15], s36 offen
    buffer_load_dwordx4 v[96:99], v14, s[12:15], s37 offen offset:0
    buffer_load_dwordx4 v[100:103], v14, s[12:15], s37 offen offset:32
    buffer_load_dwordx4 v[104:107], v14, s[12:15], s37 offen offset:64
    buffer_load_dwordx4 v[108:111], v14, s[12:15], s37 offen offset:96
    buffer_load_dwordx4 v[112:115], v14, s[12:15], s37 offen offset:128
    buffer_load_dwordx4 v[116:119], v14, s[12:15], s37 offen offset:160
    buffer_load_dwordx4 v[120:123], v14, s[12:15], s37 offen offset:192
    buffer_load_dwordx4 v[124:127], v14, s[12:15], s37 offen offset:224
    s_barrier
    v_add_u32 v7, 65536, v5
    ds_read_b128 v[64:67], v7 offset:0
    ds_read_b128 v[68:71], v7 offset:1024
    ds_read_b128 v[72:75], v7 offset:2048
    ds_read_b128 v[76:79], v7 offset:3072
    ds_read_b128 v[80:83], v7 offset:4096
    ds_read_b128 v[84:87], v7 offset:5120
    ds_read_b128 v[88:91], v7 offset:6144
    ds_read_b128 v[92:95], v7 offset:7168
    s_waitcnt vmcnt(38) lgkmcnt(7)
    v_mfma_f32_32x32x16_bf16 v[32:47], a[0:3], v[64:67], 0
    v_mfma_f32_32x32x16_bf16 v[48:63], a[64:67], v[64:67], 0
    s_waitcnt vmcnt(36) lgkmcnt(6)
    v_mfma_f32_32x32x16_bf16 v[32:47], a[4:7], v[68:71], v[32:47]
    v_mfma_f32_32x32x16_bf16 v[48:63], a[68:71], v[68:71], v[48:63]
    ds_read_b128 v[64:67], v7 offset:8192
    s_waitcnt vmcnt(34) lgkmcnt(6)
    v_mfma_f32_32x32x16_bf16 v[32:47], a[8:11], v[72:75], v[32:47]
    v_mfma_f32_32x32x16_bf16 v[48:63], a[72:75], v[72:75], v[48:63]
    ds_read_b128 v[68:71], v7 offset:9216
    s_waitcnt vmcnt(32) lgkmcnt(6)
    v_mfma_f32_32x32x16_bf16 v[32:47], a[12:15], v[76:79], v[32:47]
    v_mfma_f32_32x32x16_bf16 v[48:63], a[76:79], v[76:79], v[48:63]
    ds_read_b128 v[72:75], v7 offset:10240
    s_waitcnt vmcnt(30) lgkmcnt(6)
    v_mfma_f32_32x32x16_bf16 v[32:47], a[16:19], v[80:83], v[32:47]
    v_mfma_f32_32x32x16_bf16 v[48:63], a[80:83], v[80:83], v[48:63]
    ds_read_b128 v[76:79], v7 offset:11264
    s_waitcnt vmcnt(28) lgkmcnt(6)
    v_mfma_f32_32x32x16_bf16 v[32:47], a[20:23], v[84:87], v[32:47]
    v_mfma_f32_32x32x16_bf16 v[48:63], a[84:87], v[84:87], v[48:63]
    ds_read_b128 v[80:83], v7 offset:12288
    s_waitcnt vmcnt(26) lgkmcnt(6)
    v_mfma_f32_32x32x16_bf16 v[32:47], a[24:27], v[88:91], v[32:47]
    v_mfma_f32_32x32x16_bf16 v[48:63], a[88:91], v[88:91], v[48:63]
    ds_read_b128 v[84:87], v7 offset:13312
    s_waitcnt vmcnt(24) lgkmcnt(6)
    v_mfma_f32_32x32x16_bf16 v[32:47], a[28:31], v[92:95], v[32:47]
    v_mfma_f32_32x32x16_bf16 v[48:63], a[92:95], v[92:95], v[48:63]
    ds_read_b128 v[88:91], v7 offset:14336
    s_waitcnt vmcnt(22) lgkmcnt(6)
    v_mfma_f32_32x32x16_bf16 v[32:47], a[32:35], v[64:67], v[32:47]
    v_mfma_f32_32x32x16_bf16 v[48:63], a[96:99], v[64:67], v[48:63]
    ds_read_b128 v[92:95], v7 offset:15360
    s_waitcnt vmcnt(20) lgkmcnt(6)
    v_mfma_f32_32x32x16_bf16 v[32:47], a[36:39], v[68:71], v[32:47]
    v_mfma_f32_32x32x16_bf16 v[48:63], a[100:103], v[68:71], v[48:63]
    s_waitcnt vmcnt(0)
    v_max3_f32 v8, |v96|, |v97|, |v98|
    v_max3_f32 v8, v8, |v99|, |v100|
    v_max3_f32 v8, v8, |v101|, |v102|
    v_max3_f32 v8, v8, |v103|, |v104|
    v_max3_f32 v8, v8, |v105|, |v106|
    v_max3_f32 v8, v8, |v107|, |v108|
    v_max3_f32 v8, v8, |v109|, |v110|
    v_max3_f32 v8, v8, |v111|, |v112|
    s_waitcnt lgkmcnt(5)
    v_mfma_f32_32x32x16_bf16 v[32:47], a[40:43], v[72:75], v[32:47]
    v_mfma_f32_32x32x16_bf16 v[48:63], a[104:107], v[72:75], v[48:63]
    v_max3_f32 v8, v8, |v113|, |v114|
    v_max3_f32 v8, v8, |v115|, |v116|
    v_max3_f32 v8, v8, |v117|, |v118|
    v_max3_f32 v8, v8, |v119|, |v120|
    v_max3_f32 v8, v8, |v121|, |v122|
    v_max3_f32 v8, v8, |v123|, |v124|
    v_max3_f32 v8, v8, |v125|, |v126|
    v_max_f32 v8, v8, |v127|
    s_waitcnt lgkmcnt(4)
    v_mfma_f32_32x32x16_bf16 v[32:47], a[44:47], v[76:79], v[32:47]
    v_mfma_f32_32x32x16_bf16 v[48:63], a[108:111], v[76:79], v[48:63]
    s_mov_b32 s41, 0x42a80000
    v_cmp_lt_f32 s[42:43], s41, v8
    v_exp_f32 v96, v96
    v_exp_f32 v97, v97
    v_exp_f32 v98, v98
    v_exp_f32 v99, v99
    v_exp_f32 v100, v100
    v_exp_f32 v101, v101
    s_waitcnt lgkmcnt(3)
    v_mfma_f32_32x32x16_bf16 v[32:47], a[48:51], v[80:83], v[32:47]
    v_mfma_f32_32x32x16_bf16 v[48:63], a[112:115], v[80:83], v[48:63]
    v_exp_f32 v102, v102
    v_exp_f32 v103, v103
    v_exp_f32 v104, v104
    v_exp_f32 v105, v105
    v_exp_f32 v106, v106
    v_exp_f32 v107, v107
    v_exp_f32 v108, v108
    v_exp_f32 v109, v109
    s_waitcnt lgkmcnt(2)
    v_mfma_f32_32x32x16_bf16 v[32:47], a[52:55], v[84:87], v[32:47]
    v_mfma_f32_32x32x16_bf16 v[48:63], a[116:119], v[84:87], v[48:63]
    v_exp_f32 v110, v110
    v_exp_f32 v111, v111
    v_exp_f32 v112, v112
    v_exp_f32 v113, v113
    v_exp_f32 v114, v114
    v_exp_f32 v115, v115
    v_exp_f32 v116, v116
    v_exp_f32 v117, v117
    s_waitcnt lgkmcnt(1)
    v_mfma_f32_32x32x16_bf16 v[32:47], a[56:59], v[88:91], v[32:47]
    v_mfma_f32_32x32x16_bf16 v[48:63], a[120:123], v[88:91], v[48:63]
    v_exp_f32 v118, v118
    v_exp_f32 v119, v119
    v_exp_f32 v120, v120
    v_exp_f32 v121, v121
    v_exp_f32 v122, v122
    v_exp_f32 v123, v123
    v_exp_f32 v124, v124
    v_exp_f32 v125, v125
    s_waitcnt lgkmcnt(0)
    v_mfma_f32_32x32x16_bf16 v[32:47], a[60:63], v[92:95], v[32:47]
    v_mfma_f32_32x32x16_bf16 v[48:63], a[124:127], v[92:95], v[48:63]
    v_exp_f32 v126, v126
    v_exp_f32 v127, v127
    s_lshl_b32 s36, s21, 12
    v_add_u32 v2, s36, v5
    v_lshrrev_b32 v10, 5, v1
    v_lshlrev_b32 v11, 4, v10
    s_lshl_b32 s36, s21, 8
    s_add_u32 s36, s36, 81920
    v_add_u32 v11, s36, v11
    v_and_b32 v12, 31, v1
    v_mul_u32_u24 v13, 1056, v12
    v_add_u32 v9, v11, v13
    v_lshrrev_b32 v13, 3, v12
    v_mul_u32_u24 v13, 1056, v13
    v_add_u32 v4, v11, v13
    s_lshl_b32 s36, s21, 3
    v_add_u32 v10, s36, v10
    v_mul_u32_u24 v13, 528, v10
    v_lshl_add_u32 v13, v12, 4, v13
    v_add_u32 v6, 115712, v13
    v_lshlrev_b32 v13, 9, v10
    v_lshl_add_u32 v7, v12, 4, v13
    s_mov_b32 s41, 0x4038aa3b
    v_mul_f32 v64, s41, v32
    v_mul_f32 v65, s41, v33
    v_mul_f32 v66, s41, v34
    v_mul_f32 v67, s41, v35
    v_mul_f32 v68, s41, v36
    v_mul_f32 v69, s41, v37
    v_mul_f32 v70, s41, v38
    v_mul_f32 v71, s41, v39
    v_mul_f32 v72, s41, v40
    v_mul_f32 v73, s41, v41
    v_mul_f32 v74, s41, v42
    v_mul_f32 v75, s41, v43
    v_mul_f32 v76, s41, v44
    v_mul_f32 v77, s41, v45
    v_mul_f32 v78, s41, v46
    v_mul_f32 v79, s41, v47
    v_mul_f32 v80, s41, v48
    v_mul_f32 v81, s41, v49
    v_mul_f32 v82, s41, v50
    v_mul_f32 v83, s41, v51
    v_mul_f32 v84, s41, v52
    v_mul_f32 v85, s41, v53
    v_mul_f32 v86, s41, v54
    v_mul_f32 v87, s41, v55
    v_mul_f32 v88, s41, v56
    v_mul_f32 v89, s41, v57
    v_mul_f32 v90, s41, v58
    v_mul_f32 v91, s41, v59
    v_mul_f32 v92, s41, v60
    v_mul_f32 v93, s41, v61
    v_mul_f32 v94, s41, v62
    v_mul_f32 v95, s41, v63
    v_max3_f32 v8, |v64|, |v65|, |v66|
    v_max3_f32 v8, v8, |v67|, |v68|
    v_max3_f32 v8, v8, |v69|, |v70|
    v_max3_f32 v8, v8, |v71|, |v72|
    v_max3_f32 v8, v8, |v73|, |v74|
    v_max3_f32 v8, v8, |v75|, |v76|
    v_max3_f32 v8, v8, |v77|, |v78|
    v_max3_f32 v8, v8, |v79|, |v80|
    v_max3_f32 v8, v8, |v81|, |v82|
    v_max3_f32 v8, v8, |v83|, |v84|
    v_max3_f32 v8, v8, |v85|, |v86|
    v_max3_f32 v8, v8, |v87|, |v88|
    v_max3_f32 v8, v8, |v89|, |v90|
    v_max3_f32 v8, v8, |v91|, |v92|
    v_max3_f32 v8, v8, |v93|, |v94|
    v_max_f32 v8, v8, |v95|
    s_mov_b32 s41, 0x42200000
    v_cmp_lt_f32 vcc, s41, v8
    s_nop 3
    s_or_b64 s[42:43], s[42:43], vcc
    s_cmp_lg_u64 s[42:43], 0
    s_cselect_b32 s44, 1, 0
    s_cmp_lg_u32 s44, 0
    s_cbranch_scc1 L_joint_kernel_slow
    v_exp_f32 v32, v64
    v_exp_f32 v33, v65
    v_exp_f32 v34, v66
    v_exp_f32 v35, v67
    v_exp_f32 v36, v68
    v_exp_f32 v37, v69
    v_exp_f32 v38, v70
    v_exp_f32 v39, v71
    v_exp_f32 v40, v72
    v_exp_f32 v41, v73
    v_exp_f32 v42, v74
    v_exp_f32 v43, v75
    v_exp_f32 v44, v76
    v_exp_f32 v45, v77
    v_exp_f32 v46, v78
    v_exp_f32 v47, v79
    v_exp_f32 v48, v80
    v_exp_f32 v49, v81
    v_exp_f32 v50, v82
    v_exp_f32 v51, v83
    v_exp_f32 v52, v84
    v_exp_f32 v53, v85
    v_exp_f32 v54, v86
    v_exp_f32 v55, v87
    v_exp_f32 v56, v88
    v_exp_f32 v57, v89
    v_exp_f32 v58, v90
    v_exp_f32 v59, v91
    v_exp_f32 v60, v92
    v_exp_f32 v61, v93
    v_exp_f32 v62, v94
    v_exp_f32 v63, v95
    ds_write_b128 v9, v[32:35] offset:0
    ds_write_b128 v9, v[36:39] offset:32
    ds_write_b128 v9, v[40:43] offset:64
    ds_write_b128 v9, v[44:47] offset:96
    ds_write_b128 v9, v[48:51] offset:128
    ds_write_b128 v9, v[52:55] offset:160
    ds_write_b128 v9, v[56:59] offset:192
    ds_write_b128 v9, v[60:63] offset:224
    s_waitcnt lgkmcnt(0)
    ds_read_b128 v[32:35], v4 offset:0
    ds_read_b128 v[36:39], v4 offset:32
    ds_read_b128 v[40:43], v4 offset:64
    ds_read_b128 v[44:47], v4 offset:96
    ds_read_b128 v[48:51], v4 offset:128
    ds_read_b128 v[52:55], v4 offset:160
    ds_read_b128 v[56:59], v4 offset:192
    ds_read_b128 v[60:63], v4 offset:224
    s_waitcnt lgkmcnt(6)
    v_fma_f32 v64, v32, v96, 1.0
    v_fma_f32 v65, v33, v97, 1.0
    v_fma_f32 v66, v34, v98, 1.0
    v_fma_f32 v67, v35, v99, 1.0
    v_fma_f32 v68, v36, v100, 1.0
    v_fma_f32 v69, v37, v101, 1.0
    v_fma_f32 v70, v38, v102, 1.0
    v_fma_f32 v71, v39, v103, 1.0
    ds_read_b128 v[32:35], v4 offset:4224
    ds_read_b128 v[36:39], v4 offset:4256
    v_rcp_f32 v64, v64
    v_rcp_f32 v65, v65
    v_rcp_f32 v66, v66
    v_rcp_f32 v67, v67
    v_rcp_f32 v68, v68
    v_rcp_f32 v69, v69
    v_rcp_f32 v70, v70
    v_rcp_f32 v71, v71
    s_nop 0
    v_cvt_pk_bf16_f32 v80, v64, v65
    v_cvt_pk_bf16_f32 v81, v66, v67
    v_cvt_pk_bf16_f32 v82, v68, v69
    v_cvt_pk_bf16_f32 v83, v70, v71
    ds_write_b128 v2, v[80:83] offset:0
    s_waitcnt lgkmcnt(7)
    v_fma_f32 v72, v40, v104, 1.0
    v_fma_f32 v73, v41, v105, 1.0
    v_fma_f32 v74, v42, v106, 1.0
    v_fma_f32 v75, v43, v107, 1.0
    v_fma_f32 v76, v44, v108, 1.0
    v_fma_f32 v77, v45, v109, 1.0
    v_fma_f32 v78, v46, v110, 1.0
    v_fma_f32 v79, v47, v111, 1.0
    ds_read_b128 v[40:43], v4 offset:4288
    ds_read_b128 v[44:47], v4 offset:4320
    v_rcp_f32 v72, v72
    v_rcp_f32 v73, v73
    v_rcp_f32 v74, v74
    v_rcp_f32 v75, v75
    v_rcp_f32 v76, v76
    v_rcp_f32 v77, v77
    v_rcp_f32 v78, v78
    v_rcp_f32 v79, v79
    s_nop 0
    v_cvt_pk_bf16_f32 v84, v72, v73
    v_cvt_pk_bf16_f32 v85, v74, v75
    v_cvt_pk_bf16_f32 v86, v76, v77
    v_cvt_pk_bf16_f32 v87, v78, v79
    ds_write_b128 v2, v[84:87] offset:1024
    s_waitcnt lgkmcnt(8)
    v_fma_f32 v64, v48, v112, 1.0
    v_fma_f32 v65, v49, v113, 1.0
    v_fma_f32 v66, v50, v114, 1.0
    v_fma_f32 v67, v51, v115, 1.0
    v_fma_f32 v68, v52, v116, 1.0
    v_fma_f32 v69, v53, v117, 1.0
    v_fma_f32 v70, v54, v118, 1.0
    v_fma_f32 v71, v55, v119, 1.0
    ds_read_b128 v[48:51], v4 offset:4352
    ds_read_b128 v[52:55], v4 offset:4384
    v_rcp_f32 v64, v64
    v_rcp_f32 v65, v65
    v_rcp_f32 v66, v66
    v_rcp_f32 v67, v67
    v_rcp_f32 v68, v68
    v_rcp_f32 v69, v69
    v_rcp_f32 v70, v70
    v_rcp_f32 v71, v71
    s_nop 0
    v_cvt_pk_bf16_f32 v80, v64, v65
    v_cvt_pk_bf16_f32 v81, v66, v67
    v_cvt_pk_bf16_f32 v82, v68, v69
    v_cvt_pk_bf16_f32 v83, v70, v71
    ds_write_b128 v2, v[80:83] offset:2048
    s_waitcnt lgkmcnt(9)
    v_fma_f32 v72, v56, v120, 1.0
    v_fma_f32 v73, v57, v121, 1.0
    v_fma_f32 v74, v58, v122, 1.0
    v_fma_f32 v75, v59, v123, 1.0
    v_fma_f32 v76, v60, v124, 1.0
    v_fma_f32 v77, v61, v125, 1.0
    v_fma_f32 v78, v62, v126, 1.0
    v_fma_f32 v79, v63, v127, 1.0
    ds_read_b128 v[56:59], v4 offset:4416
    ds_read_b128 v[60:63], v4 offset:4448
    v_rcp_f32 v72, v72
    v_rcp_f32 v73, v73
    v_rcp_f32 v74, v74
    v_rcp_f32 v75, v75
    v_rcp_f32 v76, v76
    v_rcp_f32 v77, v77
    v_rcp_f32 v78, v78
    v_rcp_f32 v79, v79
    s_nop 0
    v_cvt_pk_bf16_f32 v84, v72, v73
    v_cvt_pk_bf16_f32 v85, v74, v75
    v_cvt_pk_bf16_f32 v86, v76, v77
    v_cvt_pk_bf16_f32 v87, v78, v79
    ds_write_b128 v2, v[84:87] offset:3072
    s_waitcnt lgkmcnt(10)
    v_fma_f32 v64, v32, v96, 1.0
    v_fma_f32 v65, v33, v97, 1.0
    v_fma_f32 v66, v34, v98, 1.0
    v_fma_f32 v67, v35, v99, 1.0
    v_fma_f32 v68, v36, v100, 1.0
    v_fma_f32 v69, v37, v101, 1.0
    v_fma_f32 v70, v38, v102, 1.0
    v_fma_f32 v71, v39, v103, 1.0
    ds_read_b128 v[32:35], v4 offset:8448
    ds_read_b128 v[36:39], v4 offset:8480
    v_rcp_f32 v64, v64
    v_rcp_f32 v65, v65
    v_rcp_f32 v66, v66
    v_rcp_f32 v67, v67
    v_rcp_f32 v68, v68
    v_rcp_f32 v69, v69
    v_rcp_f32 v70, v70
    v_rcp_f32 v71, v71
    s_nop 0
    v_cvt_pk_bf16_f32 v80, v64, v65
    v_cvt_pk_bf16_f32 v81, v66, v67
    v_cvt_pk_bf16_f32 v82, v68, v69
    v_cvt_pk_bf16_f32 v83, v70, v71
    ds_write_b128 v2, v[80:83] offset:16384
    s_waitcnt lgkmcnt(10)
    v_fma_f32 v72, v40, v104, 1.0
    v_fma_f32 v73, v41, v105, 1.0
    v_fma_f32 v74, v42, v106, 1.0
    v_fma_f32 v75, v43, v107, 1.0
    v_fma_f32 v76, v44, v108, 1.0
    v_fma_f32 v77, v45, v109, 1.0
    v_fma_f32 v78, v46, v110, 1.0
    v_fma_f32 v79, v47, v111, 1.0
    ds_read_b128 v[40:43], v4 offset:8512
    ds_read_b128 v[44:47], v4 offset:8544
    v_rcp_f32 v72, v72
    v_rcp_f32 v73, v73
    v_rcp_f32 v74, v74
    v_rcp_f32 v75, v75
    v_rcp_f32 v76, v76
    v_rcp_f32 v77, v77
    v_rcp_f32 v78, v78
    v_rcp_f32 v79, v79
    s_nop 0
    v_cvt_pk_bf16_f32 v84, v72, v73
    v_cvt_pk_bf16_f32 v85, v74, v75
    v_cvt_pk_bf16_f32 v86, v76, v77
    v_cvt_pk_bf16_f32 v87, v78, v79
    ds_write_b128 v2, v[84:87] offset:17408
    s_waitcnt lgkmcnt(10)
    v_fma_f32 v64, v48, v112, 1.0
    v_fma_f32 v65, v49, v113, 1.0
    v_fma_f32 v66, v50, v114, 1.0
    v_fma_f32 v67, v51, v115, 1.0
    v_fma_f32 v68, v52, v116, 1.0
    v_fma_f32 v69, v53, v117, 1.0
    v_fma_f32 v70, v54, v118, 1.0
    v_fma_f32 v71, v55, v119, 1.0
    ds_read_b128 v[48:51], v4 offset:8576
    ds_read_b128 v[52:55], v4 offset:8608
    v_rcp_f32 v64, v64
    v_rcp_f32 v65, v65
    v_rcp_f32 v66, v66
    v_rcp_f32 v67, v67
    v_rcp_f32 v68, v68
    v_rcp_f32 v69, v69
    v_rcp_f32 v70, v70
    v_rcp_f32 v71, v71
    s_nop 0
    v_cvt_pk_bf16_f32 v80, v64, v65
    v_cvt_pk_bf16_f32 v81, v66, v67
    v_cvt_pk_bf16_f32 v82, v68, v69
    v_cvt_pk_bf16_f32 v83, v70, v71
    ds_write_b128 v2, v[80:83] offset:18432
    s_waitcnt lgkmcnt(10)
    v_fma_f32 v72, v56, v120, 1.0
    v_fma_f32 v73, v57, v121, 1.0
    v_fma_f32 v74, v58, v122, 1.0
    v_fma_f32 v75, v59, v123, 1.0
    v_fma_f32 v76, v60, v124, 1.0
    v_fma_f32 v77, v61, v125, 1.0
    v_fma_f32 v78, v62, v126, 1.0
    v_fma_f32 v79, v63, v127, 1.0
    ds_read_b128 v[56:59], v4 offset:8640
    ds_read_b128 v[60:63], v4 offset:8672
    v_rcp_f32 v72, v72
    v_rcp_f32 v73, v73
    v_rcp_f32 v74, v74
    v_rcp_f32 v75, v75
    v_rcp_f32 v76, v76
    v_rcp_f32 v77, v77
    v_rcp_f32 v78, v78
    v_rcp_f32 v79, v79
    s_nop 0
    v_cvt_pk_bf16_f32 v84, v72, v73
    v_cvt_pk_bf16_f32 v85, v74, v75
    v_cvt_pk_bf16_f32 v86, v76, v77
    v_cvt_pk_bf16_f32 v87, v78, v79
    ds_write_b128 v2, v[84:87] offset:19456
    s_waitcnt lgkmcnt(0)
    s_barrier
    v_fma_f32 v64, v32, v96, 1.0
    v_fma_f32 v65, v33, v97, 1.0
    v_fma_f32 v66, v34, v98, 1.0
    v_fma_f32 v67, v35, v99, 1.0
    v_fma_f32 v68, v36, v100, 1.0
    v_fma_f32 v69, v37, v101, 1.0
    v_fma_f32 v70, v38, v102, 1.0
    v_fma_f32 v71, v39, v103, 1.0
    ds_read_b128 v[32:35], v4 offset:12672
    ds_read_b128 v[36:39], v4 offset:12704
    v_rcp_f32 v64, v64
    v_rcp_f32 v65, v65
    v_rcp_f32 v66, v66
    v_rcp_f32 v67, v67
    v_rcp_f32 v68, v68
    v_rcp_f32 v69, v69
    v_rcp_f32 v70, v70
    v_rcp_f32 v71, v71
    s_nop 0
    v_cvt_pk_bf16_f32 v80, v64, v65
    v_cvt_pk_bf16_f32 v81, v66, v67
    v_cvt_pk_bf16_f32 v82, v68, v69
    v_cvt_pk_bf16_f32 v83, v70, v71
    ds_write_b128 v2, v[80:83] offset:32768
    v_fma_f32 v72, v40, v104, 1.0
    v_fma_f32 v73, v41, v105, 1.0
    v_fma_f32 v74, v42, v106, 1.0
    v_fma_f32 v75, v43, v107, 1.0
    v_fma_f32 v76, v44, v108, 1.0
    v_fma_f32 v77, v45, v109, 1.0
    v_fma_f32 v78, v46, v110, 1.0
    v_fma_f32 v79, v47, v111, 1.0
    ds_read_b128 v[40:43], v4 offset:12736
    ds_read_b128 v[44:47], v4 offset:12768
    v_rcp_f32 v72, v72
    v_rcp_f32 v73, v73
    v_rcp_f32 v74, v74
    v_rcp_f32 v75, v75
    v_rcp_f32 v76, v76
    v_rcp_f32 v77, v77
    v_rcp_f32 v78, v78
    v_rcp_f32 v79, v79
    s_nop 0
    v_cvt_pk_bf16_f32 v84, v72, v73
    v_cvt_pk_bf16_f32 v85, v74, v75
    v_cvt_pk_bf16_f32 v86, v76, v77
    v_cvt_pk_bf16_f32 v87, v78, v79
    ds_write_b128 v2, v[84:87] offset:33792
    v_fma_f32 v64, v48, v112, 1.0
    v_fma_f32 v65, v49, v113, 1.0
    v_fma_f32 v66, v50, v114, 1.0
    v_fma_f32 v67, v51, v115, 1.0
    v_fma_f32 v68, v52, v116, 1.0
    v_fma_f32 v69, v53, v117, 1.0
    v_fma_f32 v70, v54, v118, 1.0
    v_fma_f32 v71, v55, v119, 1.0
    ds_read_b128 v[48:51], v4 offset:12800
    ds_read_b128 v[52:55], v4 offset:12832
    v_rcp_f32 v64, v64
    v_rcp_f32 v65, v65
    v_rcp_f32 v66, v66
    v_rcp_f32 v67, v67
    v_rcp_f32 v68, v68
    v_rcp_f32 v69, v69
    v_rcp_f32 v70, v70
    v_rcp_f32 v71, v71
    s_nop 0
    v_cvt_pk_bf16_f32 v80, v64, v65
    v_cvt_pk_bf16_f32 v81, v66, v67
    v_cvt_pk_bf16_f32 v82, v68, v69
    v_cvt_pk_bf16_f32 v83, v70, v71
    ds_write_b128 v2, v[80:83] offset:34816
    v_fma_f32 v72, v56, v120, 1.0
    v_fma_f32 v73, v57, v121, 1.0
    v_fma_f32 v74, v58, v122, 1.0
    v_fma_f32 v75, v59, v123, 1.0
    v_fma_f32 v76, v60, v124, 1.0
    v_fma_f32 v77, v61, v125, 1.0
    v_fma_f32 v78, v62, v126, 1.0
    v_fma_f32 v79, v63, v127, 1.0
    ds_read_b128 v[56:59], v4 offset:12864
    ds_read_b128 v[60:63], v4 offset:12896
    v_rcp_f32 v72, v72
    v_rcp_f32 v73, v73
    v_rcp_f32 v74, v74
    v_rcp_f32 v75, v75
    v_rcp_f32 v76, v76
    v_rcp_f32 v77, v77
    v_rcp_f32 v78, v78
    v_rcp_f32 v79, v79
    s_nop 0
    v_cvt_pk_bf16_f32 v84, v72, v73
    v_cvt_pk_bf16_f32 v85, v74, v75
    v_cvt_pk_bf16_f32 v86, v76, v77
    v_cvt_pk_bf16_f32 v87, v78, v79
    ds_write_b128 v2, v[84:87] offset:35840
    s_waitcnt lgkmcnt(0)
    s_barrier
    v_fma_f32 v64, v32, v96, 1.0
    v_fma_f32 v65, v33, v97, 1.0
    v_fma_f32 v66, v34, v98, 1.0
    v_fma_f32 v67, v35, v99, 1.0
    v_fma_f32 v68, v36, v100, 1.0
    v_fma_f32 v69, v37, v101, 1.0
    v_fma_f32 v70, v38, v102, 1.0
    v_fma_f32 v71, v39, v103, 1.0
    ds_read_b128 v[32:35], v4 offset:16896
    ds_read_b128 v[36:39], v4 offset:16928
    v_rcp_f32 v64, v64
    v_rcp_f32 v65, v65
    v_rcp_f32 v66, v66
    v_rcp_f32 v67, v67
    v_rcp_f32 v68, v68
    v_rcp_f32 v69, v69
    v_rcp_f32 v70, v70
    v_rcp_f32 v71, v71
    s_nop 0
    v_cvt_pk_bf16_f32 v80, v64, v65
    v_cvt_pk_bf16_f32 v81, v66, v67
    v_cvt_pk_bf16_f32 v82, v68, v69
    v_cvt_pk_bf16_f32 v83, v70, v71
    ds_write_b128 v2, v[80:83] offset:0
    v_fma_f32 v72, v40, v104, 1.0
    v_fma_f32 v73, v41, v105, 1.0
    v_fma_f32 v74, v42, v106, 1.0
    v_fma_f32 v75, v43, v107, 1.0
    v_fma_f32 v76, v44, v108, 1.0
    v_fma_f32 v77, v45, v109, 1.0
    v_fma_f32 v78, v46, v110, 1.0
    v_fma_f32 v79, v47, v111, 1.0
    ds_read_b128 v[40:43], v4 offset:16960
    ds_read_b128 v[44:47], v4 offset:16992
    v_rcp_f32 v72, v72
    v_rcp_f32 v73, v73
    v_rcp_f32 v74, v74
    v_rcp_f32 v75, v75
    v_rcp_f32 v76, v76
    v_rcp_f32 v77, v77
    v_rcp_f32 v78, v78
    v_rcp_f32 v79, v79
    s_nop 0
    v_cvt_pk_bf16_f32 v84, v72, v73
    v_cvt_pk_bf16_f32 v85, v74, v75
    v_cvt_pk_bf16_f32 v86, v76, v77
    v_cvt_pk_bf16_f32 v87, v78, v79
    ds_write_b128 v2, v[84:87] offset:1024
    v_fma_f32 v64, v48, v112, 1.0
    v_fma_f32 v65, v49, v113, 1.0
    v_fma_f32 v66, v50, v114, 1.0
    v_fma_f32 v67, v51, v115, 1.0
    v_fma_f32 v68, v52, v116, 1.0
    v_fma_f32 v69, v53, v117, 1.0
    v_fma_f32 v70, v54, v118, 1.0
    v_fma_f32 v71, v55, v119, 1.0
    ds_read_b128 v[48:51], v4 offset:17024
    ds_read_b128 v[52:55], v4 offset:17056
    v_rcp_f32 v64, v64
    v_rcp_f32 v65, v65
    v_rcp_f32 v66, v66
    v_rcp_f32 v67, v67
    v_rcp_f32 v68, v68
    v_rcp_f32 v69, v69
    v_rcp_f32 v70, v70
    v_rcp_f32 v71, v71
    s_nop 0
    v_cvt_pk_bf16_f32 v80, v64, v65
    v_cvt_pk_bf16_f32 v81, v66, v67
    v_cvt_pk_bf16_f32 v82, v68, v69
    v_cvt_pk_bf16_f32 v83, v70, v71
    ds_write_b128 v2, v[80:83] offset:2048
    v_fma_f32 v72, v56, v120, 1.0
    v_fma_f32 v73, v57, v121, 1.0
    v_fma_f32 v74, v58, v122, 1.0
    v_fma_f32 v75, v59, v123, 1.0
    v_fma_f32 v76, v60, v124, 1.0
    v_fma_f32 v77, v61, v125, 1.0
    v_fma_f32 v78, v62, v126, 1.0
    v_fma_f32 v79, v63, v127, 1.0
    ds_read_b128 v[56:59], v4 offset:17088
    ds_read_b128 v[60:63], v4 offset:17120
    v_rcp_f32 v72, v72
    v_rcp_f32 v73, v73
    v_rcp_f32 v74, v74
    v_rcp_f32 v75, v75
    v_rcp_f32 v76, v76
    v_rcp_f32 v77, v77
    v_rcp_f32 v78, v78
    v_rcp_f32 v79, v79
    s_nop 0
    v_cvt_pk_bf16_f32 v84, v72, v73
    v_cvt_pk_bf16_f32 v85, v74, v75
    v_cvt_pk_bf16_f32 v86, v76, v77
    v_cvt_pk_bf16_f32 v87, v78, v79
    ds_write_b128 v2, v[84:87] offset:3072
    s_waitcnt lgkmcnt(0)
    s_barrier
    ds_read_b128 a[0:3], v6 offset:0
    ds_read_b128 a[4:7], v6 offset:1056
    ds_read_b128 a[8:11], v6 offset:2112
    ds_read_b128 a[12:15], v6 offset:3168
    v_fma_f32 v64, v32, v96, 1.0
    v_fma_f32 v65, v33, v97, 1.0
    v_fma_f32 v66, v34, v98, 1.0
    v_fma_f32 v67, v35, v99, 1.0
    v_fma_f32 v68, v36, v100, 1.0
    v_fma_f32 v69, v37, v101, 1.0
    v_fma_f32 v70, v38, v102, 1.0
    v_fma_f32 v71, v39, v103, 1.0
    ds_read_b128 v[32:35], v4 offset:21120
    ds_read_b128 v[36:39], v4 offset:21152
    v_rcp_f32 v64, v64
    v_rcp_f32 v65, v65
    v_rcp_f32 v66, v66
    v_rcp_f32 v67, v67
    v_rcp_f32 v68, v68
    v_rcp_f32 v69, v69
    v_rcp_f32 v70, v70
    v_rcp_f32 v71, v71
    s_waitcnt lgkmcnt(5)
    s_mov_b32 s36, 0
    buffer_store_dwordx4 a[0:3], v7, s[16:19], s36 offen sc1
    s_waitcnt lgkmcnt(4)
    s_mov_b32 s36, 1024
    buffer_store_dwordx4 a[4:7], v7, s[16:19], s36 offen sc1
    v_cvt_pk_bf16_f32 v80, v64, v65
    v_cvt_pk_bf16_f32 v81, v66, v67
    v_cvt_pk_bf16_f32 v82, v68, v69
    v_cvt_pk_bf16_f32 v83, v70, v71
    ds_write_b128 v2, v[80:83] offset:16384
    v_fma_f32 v72, v40, v104, 1.0
    v_fma_f32 v73, v41, v105, 1.0
    v_fma_f32 v74, v42, v106, 1.0
    v_fma_f32 v75, v43, v107, 1.0
    v_fma_f32 v76, v44, v108, 1.0
    v_fma_f32 v77, v45, v109, 1.0
    v_fma_f32 v78, v46, v110, 1.0
    v_fma_f32 v79, v47, v111, 1.0
    ds_read_b128 v[40:43], v4 offset:21184
    ds_read_b128 v[44:47], v4 offset:21216
    v_rcp_f32 v72, v72
    v_rcp_f32 v73, v73
    v_rcp_f32 v74, v74
    v_rcp_f32 v75, v75
    v_rcp_f32 v76, v76
    v_rcp_f32 v77, v77
    v_rcp_f32 v78, v78
    v_rcp_f32 v79, v79
    s_waitcnt lgkmcnt(6)
    s_mov_b32 s36, 2048
    buffer_store_dwordx4 a[8:11], v7, s[16:19], s36 offen sc1
    s_waitcnt lgkmcnt(5)
    s_mov_b32 s36, 3072
    buffer_store_dwordx4 a[12:15], v7, s[16:19], s36 offen sc1
    v_cvt_pk_bf16_f32 v84, v72, v73
    v_cvt_pk_bf16_f32 v85, v74, v75
    v_cvt_pk_bf16_f32 v86, v76, v77
    v_cvt_pk_bf16_f32 v87, v78, v79
    ds_write_b128 v2, v[84:87] offset:17408
    v_fma_f32 v64, v48, v112, 1.0
    v_fma_f32 v65, v49, v113, 1.0
    v_fma_f32 v66, v50, v114, 1.0
    v_fma_f32 v67, v51, v115, 1.0
    v_fma_f32 v68, v52, v116, 1.0
    v_fma_f32 v69, v53, v117, 1.0
    v_fma_f32 v70, v54, v118, 1.0
    v_fma_f32 v71, v55, v119, 1.0
    ds_read_b128 v[48:51], v4 offset:21248
    ds_read_b128 v[52:55], v4 offset:21280
    v_rcp_f32 v64, v64
    v_rcp_f32 v65, v65
    v_rcp_f32 v66, v66
    v_rcp_f32 v67, v67
    v_rcp_f32 v68, v68
    v_rcp_f32 v69, v69
    v_rcp_f32 v70, v70
    v_rcp_f32 v71, v71
    s_nop 0
    v_cvt_pk_bf16_f32 v80, v64, v65
    v_cvt_pk_bf16_f32 v81, v66, v67
    v_cvt_pk_bf16_f32 v82, v68, v69
    v_cvt_pk_bf16_f32 v83, v70, v71
    ds_write_b128 v2, v[80:83] offset:18432
    v_fma_f32 v72, v56, v120, 1.0
    v_fma_f32 v73, v57, v121, 1.0
    v_fma_f32 v74, v58, v122, 1.0
    v_fma_f32 v75, v59, v123, 1.0
    v_fma_f32 v76, v60, v124, 1.0
    v_fma_f32 v77, v61, v125, 1.0
    v_fma_f32 v78, v62, v126, 1.0
    v_fma_f32 v79, v63, v127, 1.0
    ds_read_b128 v[56:59], v4 offset:21312
    ds_read_b128 v[60:63], v4 offset:21344
    v_rcp_f32 v72, v72
    v_rcp_f32 v73, v73
    v_rcp_f32 v74, v74
    v_rcp_f32 v75, v75
    v_rcp_f32 v76, v76
    v_rcp_f32 v77, v77
    v_rcp_f32 v78, v78
    v_rcp_f32 v79, v79
    s_nop 0
    v_cvt_pk_bf16_f32 v84, v72, v73
    v_cvt_pk_bf16_f32 v85, v74, v75
    v_cvt_pk_bf16_f32 v86, v76, v77
    v_cvt_pk_bf16_f32 v87, v78, v79
    ds_write_b128 v2, v[84:87] offset:19456
    s_waitcnt lgkmcnt(0)
    s_barrier
    ds_read_b128 a[0:3], v6 offset:16896
    ds_read_b128 a[4:7], v6 offset:17952
    ds_read_b128 a[8:11], v6 offset:19008
    ds_read_b128 a[12:15], v6 offset:20064
    v_fma_f32 v64, v32, v96, 1.0
    v_fma_f32 v65, v33, v97, 1.0
    v_fma_f32 v66, v34, v98, 1.0
    v_fma_f32 v67, v35, v99, 1.0
    v_fma_f32 v68, v36, v100, 1.0
    v_fma_f32 v69, v37, v101, 1.0
    v_fma_f32 v70, v38, v102, 1.0
    v_fma_f32 v71, v39, v103, 1.0
    ds_read_b128 v[32:35], v4 offset:25344
    ds_read_b128 v[36:39], v4 offset:25376
    v_rcp_f32 v64, v64
    v_rcp_f32 v65, v65
    v_rcp_f32 v66, v66
    v_rcp_f32 v67, v67
    v_rcp_f32 v68, v68
    v_rcp_f32 v69, v69
    v_rcp_f32 v70, v70
    v_rcp_f32 v71, v71
    s_waitcnt lgkmcnt(5)
    s_mov_b32 s36, 16384
    buffer_store_dwordx4 a[0:3], v7, s[16:19], s36 offen sc1
    s_waitcnt lgkmcnt(4)
    s_mov_b32 s36, 17408
    buffer_store_dwordx4 a[4:7], v7, s[16:19], s36 offen sc1
    v_cvt_pk_bf16_f32 v80, v64, v65
    v_cvt_pk_bf16_f32 v81, v66, v67
    v_cvt_pk_bf16_f32 v82, v68, v69
    v_cvt_pk_bf16_f32 v83, v70, v71
    ds_write_b128 v2, v[80:83] offset:32768
    v_fma_f32 v72, v40, v104, 1.0
    v_fma_f32 v73, v41, v105, 1.0
    v_fma_f32 v74, v42, v106, 1.0
    v_fma_f32 v75, v43, v107, 1.0
    v_fma_f32 v76, v44, v108, 1.0
    v_fma_f32 v77, v45, v109, 1.0
    v_fma_f32 v78, v46, v110, 1.0
    v_fma_f32 v79, v47, v111, 1.0
    ds_read_b128 v[40:43], v4 offset:25408
    ds_read_b128 v[44:47], v4 offset:25440
    v_rcp_f32 v72, v72
    v_rcp_f32 v73, v73
    v_rcp_f32 v74, v74
    v_rcp_f32 v75, v75
    v_rcp_f32 v76, v76
    v_rcp_f32 v77, v77
    v_rcp_f32 v78, v78
    v_rcp_f32 v79, v79
    s_waitcnt lgkmcnt(6)
    s_mov_b32 s36, 18432
    buffer_store_dwordx4 a[8:11], v7, s[16:19], s36 offen sc1
    s_waitcnt lgkmcnt(5)
    s_mov_b32 s36, 19456
    buffer_store_dwordx4 a[12:15], v7, s[16:19], s36 offen sc1
    v_cvt_pk_bf16_f32 v84, v72, v73
    v_cvt_pk_bf16_f32 v85, v74, v75
    v_cvt_pk_bf16_f32 v86, v76, v77
    v_cvt_pk_bf16_f32 v87, v78, v79
    ds_write_b128 v2, v[84:87] offset:33792
    v_fma_f32 v64, v48, v112, 1.0
    v_fma_f32 v65, v49, v113, 1.0
    v_fma_f32 v66, v50, v114, 1.0
    v_fma_f32 v67, v51, v115, 1.0
    v_fma_f32 v68, v52, v116, 1.0
    v_fma_f32 v69, v53, v117, 1.0
    v_fma_f32 v70, v54, v118, 1.0
    v_fma_f32 v71, v55, v119, 1.0
    ds_read_b128 v[48:51], v4 offset:25472
    ds_read_b128 v[52:55], v4 offset:25504
    v_rcp_f32 v64, v64
    v_rcp_f32 v65, v65
    v_rcp_f32 v66, v66
    v_rcp_f32 v67, v67
    v_rcp_f32 v68, v68
    v_rcp_f32 v69, v69
    v_rcp_f32 v70, v70
    v_rcp_f32 v71, v71
    s_nop 0
    v_cvt_pk_bf16_f32 v80, v64, v65
    v_cvt_pk_bf16_f32 v81, v66, v67
    v_cvt_pk_bf16_f32 v82, v68, v69
    v_cvt_pk_bf16_f32 v83, v70, v71
    ds_write_b128 v2, v[80:83] offset:34816
    v_fma_f32 v72, v56, v120, 1.0
    v_fma_f32 v73, v57, v121, 1.0
    v_fma_f32 v74, v58, v122, 1.0
    v_fma_f32 v75, v59, v123, 1.0
    v_fma_f32 v76, v60, v124, 1.0
    v_fma_f32 v77, v61, v125, 1.0
    v_fma_f32 v78, v62, v126, 1.0
    v_fma_f32 v79, v63, v127, 1.0
    ds_read_b128 v[56:59], v4 offset:25536
    ds_read_b128 v[60:63], v4 offset:25568
    v_rcp_f32 v72, v72
    v_rcp_f32 v73, v73
    v_rcp_f32 v74, v74
    v_rcp_f32 v75, v75
    v_rcp_f32 v76, v76
    v_rcp_f32 v77, v77
    v_rcp_f32 v78, v78
    v_rcp_f32 v79, v79
    s_nop 0
    v_cvt_pk_bf16_f32 v84, v72, v73
    v_cvt_pk_bf16_f32 v85, v74, v75
    v_cvt_pk_bf16_f32 v86, v76, v77
    v_cvt_pk_bf16_f32 v87, v78, v79
    ds_write_b128 v2, v[84:87] offset:35840
    s_waitcnt lgkmcnt(0)
    s_barrier
    ds_read_b128 a[0:3], v6 offset:0
    ds_read_b128 a[4:7], v6 offset:1056
    ds_read_b128 a[8:11], v6 offset:2112
    ds_read_b128 a[12:15], v6 offset:3168
    v_fma_f32 v64, v32, v96, 1.0
    v_fma_f32 v65, v33, v97, 1.0
    v_fma_f32 v66, v34, v98, 1.0
    v_fma_f32 v67, v35, v99, 1.0
    v_fma_f32 v68, v36, v100, 1.0
    v_fma_f32 v69, v37, v101, 1.0
    v_fma_f32 v70, v38, v102, 1.0
    v_fma_f32 v71, v39, v103, 1.0
    ds_read_b128 v[32:35], v4 offset:29568
    ds_read_b128 v[36:39], v4 offset:29600
    v_rcp_f32 v64, v64
    v_rcp_f32 v65, v65
    v_rcp_f32 v66, v66
    v_rcp_f32 v67, v67
    v_rcp_f32 v68, v68
    v_rcp_f32 v69, v69
    v_rcp_f32 v70, v70
    v_rcp_f32 v71, v71
    s_waitcnt lgkmcnt(5)
    s_mov_b32 s36, 32768
    buffer_store_dwordx4 a[0:3], v7, s[16:19], s36 offen sc1
    s_waitcnt lgkmcnt(4)
    s_mov_b32 s36, 33792
    buffer_store_dwordx4 a[4:7], v7, s[16:19], s36 offen sc1
    v_cvt_pk_bf16_f32 v80, v64, v65
    v_cvt_pk_bf16_f32 v81, v66, v67
    v_cvt_pk_bf16_f32 v82, v68, v69
    v_cvt_pk_bf16_f32 v83, v70, v71
    ds_write_b128 v2, v[80:83] offset:0
    v_fma_f32 v72, v40, v104, 1.0
    v_fma_f32 v73, v41, v105, 1.0
    v_fma_f32 v74, v42, v106, 1.0
    v_fma_f32 v75, v43, v107, 1.0
    v_fma_f32 v76, v44, v108, 1.0
    v_fma_f32 v77, v45, v109, 1.0
    v_fma_f32 v78, v46, v110, 1.0
    v_fma_f32 v79, v47, v111, 1.0
    ds_read_b128 v[40:43], v4 offset:29632
    ds_read_b128 v[44:47], v4 offset:29664
    v_rcp_f32 v72, v72
    v_rcp_f32 v73, v73
    v_rcp_f32 v74, v74
    v_rcp_f32 v75, v75
    v_rcp_f32 v76, v76
    v_rcp_f32 v77, v77
    v_rcp_f32 v78, v78
    v_rcp_f32 v79, v79
    s_waitcnt lgkmcnt(6)
    s_mov_b32 s36, 34816
    buffer_store_dwordx4 a[8:11], v7, s[16:19], s36 offen sc1
    s_waitcnt lgkmcnt(5)
    s_mov_b32 s36, 35840
    buffer_store_dwordx4 a[12:15], v7, s[16:19], s36 offen sc1
    v_cvt_pk_bf16_f32 v84, v72, v73
    v_cvt_pk_bf16_f32 v85, v74, v75
    v_cvt_pk_bf16_f32 v86, v76, v77
    v_cvt_pk_bf16_f32 v87, v78, v79
    ds_write_b128 v2, v[84:87] offset:1024
    v_fma_f32 v64, v48, v112, 1.0
    v_fma_f32 v65, v49, v113, 1.0
    v_fma_f32 v66, v50, v114, 1.0
    v_fma_f32 v67, v51, v115, 1.0
    v_fma_f32 v68, v52, v116, 1.0
    v_fma_f32 v69, v53, v117, 1.0
    v_fma_f32 v70, v54, v118, 1.0
    v_fma_f32 v71, v55, v119, 1.0
    ds_read_b128 v[48:51], v4 offset:29696
    ds_read_b128 v[52:55], v4 offset:29728
    v_rcp_f32 v64, v64
    v_rcp_f32 v65, v65
    v_rcp_f32 v66, v66
    v_rcp_f32 v67, v67
    v_rcp_f32 v68, v68
    v_rcp_f32 v69, v69
    v_rcp_f32 v70, v70
    v_rcp_f32 v71, v71
    s_nop 0
    v_cvt_pk_bf16_f32 v80, v64, v65
    v_cvt_pk_bf16_f32 v81, v66, v67
    v_cvt_pk_bf16_f32 v82, v68, v69
    v_cvt_pk_bf16_f32 v83, v70, v71
    ds_write_b128 v2, v[80:83] offset:2048
    v_fma_f32 v72, v56, v120, 1.0
    v_fma_f32 v73, v57, v121, 1.0
    v_fma_f32 v74, v58, v122, 1.0
    v_fma_f32 v75, v59, v123, 1.0
    v_fma_f32 v76, v60, v124, 1.0
    v_fma_f32 v77, v61, v125, 1.0
    v_fma_f32 v78, v62, v126, 1.0
    v_fma_f32 v79, v63, v127, 1.0
    ds_read_b128 v[56:59], v4 offset:29760
    ds_read_b128 v[60:63], v4 offset:29792
    v_rcp_f32 v72, v72
    v_rcp_f32 v73, v73
    v_rcp_f32 v74, v74
    v_rcp_f32 v75, v75
    v_rcp_f32 v76, v76
    v_rcp_f32 v77, v77
    v_rcp_f32 v78, v78
    v_rcp_f32 v79, v79
    s_nop 0
    v_cvt_pk_bf16_f32 v84, v72, v73
    v_cvt_pk_bf16_f32 v85, v74, v75
    v_cvt_pk_bf16_f32 v86, v76, v77
    v_cvt_pk_bf16_f32 v87, v78, v79
    ds_write_b128 v2, v[84:87] offset:3072
    s_waitcnt lgkmcnt(0)
    s_barrier
    ds_read_b128 a[0:3], v6 offset:16896
    ds_read_b128 a[4:7], v6 offset:17952
    ds_read_b128 a[8:11], v6 offset:19008
    ds_read_b128 a[12:15], v6 offset:20064
    v_fma_f32 v64, v32, v96, 1.0
    v_fma_f32 v65, v33, v97, 1.0
    v_fma_f32 v66, v34, v98, 1.0
    v_fma_f32 v67, v35, v99, 1.0
    v_fma_f32 v68, v36, v100, 1.0
    v_fma_f32 v69, v37, v101, 1.0
    v_fma_f32 v70, v38, v102, 1.0
    v_fma_f32 v71, v39, v103, 1.0
    v_rcp_f32 v64, v64
    v_rcp_f32 v65, v65
    v_rcp_f32 v66, v66
    v_rcp_f32 v67, v67
    v_rcp_f32 v68, v68
    v_rcp_f32 v69, v69
    v_rcp_f32 v70, v70
    v_rcp_f32 v71, v71
    s_waitcnt lgkmcnt(3)
    s_mov_b32 s36, 49152
    buffer_store_dwordx4 a[0:3], v7, s[16:19], s36 offen sc1
    s_waitcnt lgkmcnt(2)
    s_mov_b32 s36, 50176
    buffer_store_dwordx4 a[4:7], v7, s[16:19], s36 offen sc1
    v_cvt_pk_bf16_f32 v80, v64, v65
    v_cvt_pk_bf16_f32 v81, v66, v67
    v_cvt_pk_bf16_f32 v82, v68, v69
    v_cvt_pk_bf16_f32 v83, v70, v71
    ds_write_b128 v2, v[80:83] offset:16384
    v_fma_f32 v72, v40, v104, 1.0
    v_fma_f32 v73, v41, v105, 1.0
    v_fma_f32 v74, v42, v106, 1.0
    v_fma_f32 v75, v43, v107, 1.0
    v_fma_f32 v76, v44, v108, 1.0
    v_fma_f32 v77, v45, v109, 1.0
    v_fma_f32 v78, v46, v110, 1.0
    v_fma_f32 v79, v47, v111, 1.0
    v_rcp_f32 v72, v72
    v_rcp_f32 v73, v73
    v_rcp_f32 v74, v74
    v_rcp_f32 v75, v75
    v_rcp_f32 v76, v76
    v_rcp_f32 v77, v77
    v_rcp_f32 v78, v78
    v_rcp_f32 v79, v79
    s_waitcnt lgkmcnt(2)
    s_mov_b32 s36, 51200
    buffer_store_dwordx4 a[8:11], v7, s[16:19], s36 offen sc1
    s_waitcnt lgkmcnt(1)
    s_mov_b32 s36, 52224
    buffer_store_dwordx4 a[12:15], v7, s[16:19], s36 offen sc1
    v_cvt_pk_bf16_f32 v84, v72, v73
    v_cvt_pk_bf16_f32 v85, v74, v75
    v_cvt_pk_bf16_f32 v86, v76, v77
    v_cvt_pk_bf16_f32 v87, v78, v79
    ds_write_b128 v2, v[84:87] offset:17408
    v_fma_f32 v64, v48, v112, 1.0
    v_fma_f32 v65, v49, v113, 1.0
    v_fma_f32 v66, v50, v114, 1.0
    v_fma_f32 v67, v51, v115, 1.0
    v_fma_f32 v68, v52, v116, 1.0
    v_fma_f32 v69, v53, v117, 1.0
    v_fma_f32 v70, v54, v118, 1.0
    v_fma_f32 v71, v55, v119, 1.0
    v_rcp_f32 v64, v64
    v_rcp_f32 v65, v65
    v_rcp_f32 v66, v66
    v_rcp_f32 v67, v67
    v_rcp_f32 v68, v68
    v_rcp_f32 v69, v69
    v_rcp_f32 v70, v70
    v_rcp_f32 v71, v71
    s_nop 0
    v_cvt_pk_bf16_f32 v80, v64, v65
    v_cvt_pk_bf16_f32 v81, v66, v67
    v_cvt_pk_bf16_f32 v82, v68, v69
    v_cvt_pk_bf16_f32 v83, v70, v71
    ds_write_b128 v2, v[80:83] offset:18432
    v_fma_f32 v72, v56, v120, 1.0
    v_fma_f32 v73, v57, v121, 1.0
    v_fma_f32 v74, v58, v122, 1.0
    v_fma_f32 v75, v59, v123, 1.0
    v_fma_f32 v76, v60, v124, 1.0
    v_fma_f32 v77, v61, v125, 1.0
    v_fma_f32 v78, v62, v126, 1.0
    v_fma_f32 v79, v63, v127, 1.0
    v_rcp_f32 v72, v72
    v_rcp_f32 v73, v73
    v_rcp_f32 v74, v74
    v_rcp_f32 v75, v75
    v_rcp_f32 v76, v76
    v_rcp_f32 v77, v77
    v_rcp_f32 v78, v78
    v_rcp_f32 v79, v79
    s_nop 0
    v_cvt_pk_bf16_f32 v84, v72, v73
    v_cvt_pk_bf16_f32 v85, v74, v75
    v_cvt_pk_bf16_f32 v86, v76, v77
    v_cvt_pk_bf16_f32 v87, v78, v79
    ds_write_b128 v2, v[84:87] offset:19456
    s_waitcnt lgkmcnt(0)
    s_barrier
    ds_read_b128 a[0:3], v6 offset:0
    ds_read_b128 a[4:7], v6 offset:1056
    ds_read_b128 a[8:11], v6 offset:2112
    ds_read_b128 a[12:15], v6 offset:3168
    s_waitcnt lgkmcnt(3)
    s_mov_b32 s36, 65536
    buffer_store_dwordx4 a[0:3], v7, s[16:19], s36 offen sc1
    s_waitcnt lgkmcnt(2)
    s_mov_b32 s36, 66560
    buffer_store_dwordx4 a[4:7], v7, s[16:19], s36 offen sc1
    s_waitcnt lgkmcnt(1)
    s_mov_b32 s36, 67584
    buffer_store_dwordx4 a[8:11], v7, s[16:19], s36 offen sc1
    s_waitcnt lgkmcnt(0)
    s_mov_b32 s36, 68608
    buffer_store_dwordx4 a[12:15], v7, s[16:19], s36 offen sc1
    s_barrier
    ds_read_b128 a[0:3], v6 offset:16896
    ds_read_b128 a[4:7], v6 offset:17952
    ds_read_b128 a[8:11], v6 offset:19008
    ds_read_b128 a[12:15], v6 offset:20064
    s_waitcnt lgkmcnt(3)
    s_mov_b32 s36, 81920
    buffer_store_dwordx4 a[0:3], v7, s[16:19], s36 offen sc1
    s_waitcnt lgkmcnt(2)
    s_mov_b32 s36, 82944
    buffer_store_dwordx4 a[4:7], v7, s[16:19], s36 offen sc1
    s_waitcnt lgkmcnt(1)
    s_mov_b32 s36, 83968
    buffer_store_dwordx4 a[8:11], v7, s[16:19], s36 offen sc1
    s_waitcnt lgkmcnt(0)
    s_mov_b32 s36, 84992
    buffer_store_dwordx4 a[12:15], v7, s[16:19], s36 offen sc1
    s_barrier
    ds_read_b128 a[0:3], v6 offset:0
    ds_read_b128 a[4:7], v6 offset:1056
    ds_read_b128 a[8:11], v6 offset:2112
    ds_read_b128 a[12:15], v6 offset:3168
    s_waitcnt lgkmcnt(3)
    s_mov_b32 s36, 98304
    buffer_store_dwordx4 a[0:3], v7, s[16:19], s36 offen sc1
    s_waitcnt lgkmcnt(2)
    s_mov_b32 s36, 99328
    buffer_store_dwordx4 a[4:7], v7, s[16:19], s36 offen sc1
    s_waitcnt lgkmcnt(1)
    s_mov_b32 s36, 100352
    buffer_store_dwordx4 a[8:11], v7, s[16:19], s36 offen sc1
    s_waitcnt lgkmcnt(0)
    s_mov_b32 s36, 101376
    buffer_store_dwordx4 a[12:15], v7, s[16:19], s36 offen sc1
    s_barrier
    ds_read_b128 a[0:3], v6 offset:16896
    ds_read_b128 a[4:7], v6 offset:17952
    ds_read_b128 a[8:11], v6 offset:19008
    ds_read_b128 a[12:15], v6 offset:20064
    s_waitcnt lgkmcnt(3)
    s_mov_b32 s36, 114688
    buffer_store_dwordx4 a[0:3], v7, s[16:19], s36 offen sc1
    s_waitcnt lgkmcnt(2)
    s_mov_b32 s36, 115712
    buffer_store_dwordx4 a[4:7], v7, s[16:19], s36 offen sc1
    s_waitcnt lgkmcnt(1)
    s_mov_b32 s36, 116736
    buffer_store_dwordx4 a[8:11], v7, s[16:19], s36 offen sc1
    s_waitcnt lgkmcnt(0)
    s_mov_b32 s36, 117760
    buffer_store_dwordx4 a[12:15], v7, s[16:19], s36 offen sc1
    s_endpgm
L_joint_kernel_slow:
    buffer_load_dwordx4 v[96:99], v14, s[12:15], s37 offen offset:0
    buffer_load_dwordx4 v[100:103], v14, s[12:15], s37 offen offset:32
    buffer_load_dwordx4 v[104:107], v14, s[12:15], s37 offen offset:64
    buffer_load_dwordx4 v[108:111], v14, s[12:15], s37 offen offset:96
    buffer_load_dwordx4 v[112:115], v14, s[12:15], s37 offen offset:128
    buffer_load_dwordx4 v[116:119], v14, s[12:15], s37 offen offset:160
    buffer_load_dwordx4 v[120:123], v14, s[12:15], s37 offen offset:192
    buffer_load_dwordx4 v[124:127], v14, s[12:15], s37 offen offset:224
    s_waitcnt vmcnt(0)
    ds_write_b128 v9, v[64:67] offset:0
    ds_write_b128 v9, v[68:71] offset:32
    ds_write_b128 v9, v[72:75] offset:64
    ds_write_b128 v9, v[76:79] offset:96
    ds_write_b128 v9, v[80:83] offset:128
    ds_write_b128 v9, v[84:87] offset:160
    ds_write_b128 v9, v[88:91] offset:192
    ds_write_b128 v9, v[92:95] offset:224
    s_waitcnt lgkmcnt(0)
    ds_read_b128 v[32:35], v4 offset:0
    ds_read_b128 v[36:39], v4 offset:32
    ds_read_b128 v[40:43], v4 offset:64
    ds_read_b128 v[44:47], v4 offset:96
    ds_read_b128 v[48:51], v4 offset:128
    ds_read_b128 v[52:55], v4 offset:160
    ds_read_b128 v[56:59], v4 offset:192
    ds_read_b128 v[60:63], v4 offset:224
    s_waitcnt lgkmcnt(6)
    v_add_f32 v64, v32, v96
    v_add_f32 v65, v33, v97
    v_add_f32 v66, v34, v98
    v_add_f32 v67, v35, v99
    v_add_f32 v68, v36, v100
    v_add_f32 v69, v37, v101
    v_add_f32 v70, v38, v102
    v_add_f32 v71, v39, v103
    ds_read_b128 v[32:35], v4 offset:4224
    ds_read_b128 v[36:39], v4 offset:4256
    v_exp_f32 v64, v64
    v_exp_f32 v65, v65
    v_exp_f32 v66, v66
    v_exp_f32 v67, v67
    v_exp_f32 v68, v68
    v_exp_f32 v69, v69
    v_exp_f32 v70, v70
    v_exp_f32 v71, v71
    v_add_f32 v64, 1.0, v64
    v_add_f32 v65, 1.0, v65
    v_add_f32 v66, 1.0, v66
    v_add_f32 v67, 1.0, v67
    v_add_f32 v68, 1.0, v68
    v_add_f32 v69, 1.0, v69
    v_add_f32 v70, 1.0, v70
    v_add_f32 v71, 1.0, v71
    v_rcp_f32 v64, v64
    v_rcp_f32 v65, v65
    v_rcp_f32 v66, v66
    v_rcp_f32 v67, v67
    v_rcp_f32 v68, v68
    v_rcp_f32 v69, v69
    v_rcp_f32 v70, v70
    v_rcp_f32 v71, v71
    s_nop 0
    v_cvt_pk_bf16_f32 v80, v64, v65
    v_cvt_pk_bf16_f32 v81, v66, v67
    v_cvt_pk_bf16_f32 v82, v68, v69
    v_cvt_pk_bf16_f32 v83, v70, v71
    ds_write_b128 v2, v[80:83] offset:0
    s_waitcnt lgkmcnt(7)
    v_add_f32 v72, v40, v104
    v_add_f32 v73, v41, v105
    v_add_f32 v74, v42, v106
    v_add_f32 v75, v43, v107
    v_add_f32 v76, v44, v108
    v_add_f32 v77, v45, v109
    v_add_f32 v78, v46, v110
    v_add_f32 v79, v47, v111
    ds_read_b128 v[40:43], v4 offset:4288
    ds_read_b128 v[44:47], v4 offset:4320
    v_exp_f32 v72, v72
    v_exp_f32 v73, v73
    v_exp_f32 v74, v74
    v_exp_f32 v75, v75
    v_exp_f32 v76, v76
    v_exp_f32 v77, v77
    v_exp_f32 v78, v78
    v_exp_f32 v79, v79
    v_add_f32 v72, 1.0, v72
    v_add_f32 v73, 1.0, v73
    v_add_f32 v74, 1.0, v74
    v_add_f32 v75, 1.0, v75
    v_add_f32 v76, 1.0, v76
    v_add_f32 v77, 1.0, v77
    v_add_f32 v78, 1.0, v78
    v_add_f32 v79, 1.0, v79
    v_rcp_f32 v72, v72
    v_rcp_f32 v73, v73
    v_rcp_f32 v74, v74
    v_rcp_f32 v75, v75
    v_rcp_f32 v76, v76
    v_rcp_f32 v77, v77
    v_rcp_f32 v78, v78
    v_rcp_f32 v79, v79
    s_nop 0
    v_cvt_pk_bf16_f32 v84, v72, v73
    v_cvt_pk_bf16_f32 v85, v74, v75
    v_cvt_pk_bf16_f32 v86, v76, v77
    v_cvt_pk_bf16_f32 v87, v78, v79
    ds_write_b128 v2, v[84:87] offset:1024
    s_waitcnt lgkmcnt(8)
    v_add_f32 v64, v48, v112
    v_add_f32 v65, v49, v113
    v_add_f32 v66, v50, v114
    v_add_f32 v67, v51, v115
    v_add_f32 v68, v52, v116
    v_add_f32 v69, v53, v117
    v_add_f32 v70, v54, v118
    v_add_f32 v71, v55, v119
    ds_read_b128 v[48:51], v4 offset:4352
    ds_read_b128 v[52:55], v4 offset:4384
    v_exp_f32 v64, v64
    v_exp_f32 v65, v65
    v_exp_f32 v66, v66
    v_exp_f32 v67, v67
    v_exp_f32 v68, v68
    v_exp_f32 v69, v69
    v_exp_f32 v70, v70
    v_exp_f32 v71, v71
    v_add_f32 v64, 1.0, v64
    v_add_f32 v65, 1.0, v65
    v_add_f32 v66, 1.0, v66
    v_add_f32 v67, 1.0, v67
    v_add_f32 v68, 1.0, v68
    v_add_f32 v69, 1.0, v69
    v_add_f32 v70, 1.0, v70
    v_add_f32 v71, 1.0, v71
    v_rcp_f32 v64, v64
    v_rcp_f32 v65, v65
    v_rcp_f32 v66, v66
    v_rcp_f32 v67, v67
    v_rcp_f32 v68, v68
    v_rcp_f32 v69, v69
    v_rcp_f32 v70, v70
    v_rcp_f32 v71, v71
    s_nop 0
    v_cvt_pk_bf16_f32 v80, v64, v65
    v_cvt_pk_bf16_f32 v81, v66, v67
    v_cvt_pk_bf16_f32 v82, v68, v69
    v_cvt_pk_bf16_f32 v83, v70, v71
    ds_write_b128 v2, v[80:83] offset:2048
    s_waitcnt lgkmcnt(9)
    v_add_f32 v72, v56, v120
    v_add_f32 v73, v57, v121
    v_add_f32 v74, v58, v122
    v_add_f32 v75, v59, v123
    v_add_f32 v76, v60, v124
    v_add_f32 v77, v61, v125
    v_add_f32 v78, v62, v126
    v_add_f32 v79, v63, v127
    ds_read_b128 v[56:59], v4 offset:4416
    ds_read_b128 v[60:63], v4 offset:4448
    v_exp_f32 v72, v72
    v_exp_f32 v73, v73
    v_exp_f32 v74, v74
    v_exp_f32 v75, v75
    v_exp_f32 v76, v76
    v_exp_f32 v77, v77
    v_exp_f32 v78, v78
    v_exp_f32 v79, v79
    v_add_f32 v72, 1.0, v72
    v_add_f32 v73, 1.0, v73
    v_add_f32 v74, 1.0, v74
    v_add_f32 v75, 1.0, v75
    v_add_f32 v76, 1.0, v76
    v_add_f32 v77, 1.0, v77
    v_add_f32 v78, 1.0, v78
    v_add_f32 v79, 1.0, v79
    v_rcp_f32 v72, v72
    v_rcp_f32 v73, v73
    v_rcp_f32 v74, v74
    v_rcp_f32 v75, v75
    v_rcp_f32 v76, v76
    v_rcp_f32 v77, v77
    v_rcp_f32 v78, v78
    v_rcp_f32 v79, v79
    s_nop 0
    v_cvt_pk_bf16_f32 v84, v72, v73
    v_cvt_pk_bf16_f32 v85, v74, v75
    v_cvt_pk_bf16_f32 v86, v76, v77
    v_cvt_pk_bf16_f32 v87, v78, v79
    ds_write_b128 v2, v[84:87] offset:3072
    s_waitcnt lgkmcnt(10)
    v_add_f32 v64, v32, v96
    v_add_f32 v65, v33, v97
    v_add_f32 v66, v34, v98
    v_add_f32 v67, v35, v99
    v_add_f32 v68, v36, v100
    v_add_f32 v69, v37, v101
    v_add_f32 v70, v38, v102
    v_add_f32 v71, v39, v103
    ds_read_b128 v[32:35], v4 offset:8448
    ds_read_b128 v[36:39], v4 offset:8480
    v_exp_f32 v64, v64
    v_exp_f32 v65, v65
    v_exp_f32 v66, v66
    v_exp_f32 v67, v67
    v_exp_f32 v68, v68
    v_exp_f32 v69, v69
    v_exp_f32 v70, v70
    v_exp_f32 v71, v71
    v_add_f32 v64, 1.0, v64
    v_add_f32 v65, 1.0, v65
    v_add_f32 v66, 1.0, v66
    v_add_f32 v67, 1.0, v67
    v_add_f32 v68, 1.0, v68
    v_add_f32 v69, 1.0, v69
    v_add_f32 v70, 1.0, v70
    v_add_f32 v71, 1.0, v71
    v_rcp_f32 v64, v64
    v_rcp_f32 v65, v65
    v_rcp_f32 v66, v66
    v_rcp_f32 v67, v67
    v_rcp_f32 v68, v68
    v_rcp_f32 v69, v69
    v_rcp_f32 v70, v70
    v_rcp_f32 v71, v71
    s_nop 0
    v_cvt_pk_bf16_f32 v80, v64, v65
    v_cvt_pk_bf16_f32 v81, v66, v67
    v_cvt_pk_bf16_f32 v82, v68, v69
    v_cvt_pk_bf16_f32 v83, v70, v71
    ds_write_b128 v2, v[80:83] offset:16384
    s_waitcnt lgkmcnt(10)
    v_add_f32 v72, v40, v104
    v_add_f32 v73, v41, v105
    v_add_f32 v74, v42, v106
    v_add_f32 v75, v43, v107
    v_add_f32 v76, v44, v108
    v_add_f32 v77, v45, v109
    v_add_f32 v78, v46, v110
    v_add_f32 v79, v47, v111
    ds_read_b128 v[40:43], v4 offset:8512
    ds_read_b128 v[44:47], v4 offset:8544
    v_exp_f32 v72, v72
    v_exp_f32 v73, v73
    v_exp_f32 v74, v74
    v_exp_f32 v75, v75
    v_exp_f32 v76, v76
    v_exp_f32 v77, v77
    v_exp_f32 v78, v78
    v_exp_f32 v79, v79
    v_add_f32 v72, 1.0, v72
    v_add_f32 v73, 1.0, v73
    v_add_f32 v74, 1.0, v74
    v_add_f32 v75, 1.0, v75
    v_add_f32 v76, 1.0, v76
    v_add_f32 v77, 1.0, v77
    v_add_f32 v78, 1.0, v78
    v_add_f32 v79, 1.0, v79
    v_rcp_f32 v72, v72
    v_rcp_f32 v73, v73
    v_rcp_f32 v74, v74
    v_rcp_f32 v75, v75
    v_rcp_f32 v76, v76
    v_rcp_f32 v77, v77
    v_rcp_f32 v78, v78
    v_rcp_f32 v79, v79
    s_nop 0
    v_cvt_pk_bf16_f32 v84, v72, v73
    v_cvt_pk_bf16_f32 v85, v74, v75
    v_cvt_pk_bf16_f32 v86, v76, v77
    v_cvt_pk_bf16_f32 v87, v78, v79
    ds_write_b128 v2, v[84:87] offset:17408
    s_waitcnt lgkmcnt(10)
    v_add_f32 v64, v48, v112
    v_add_f32 v65, v49, v113
    v_add_f32 v66, v50, v114
    v_add_f32 v67, v51, v115
    v_add_f32 v68, v52, v116
    v_add_f32 v69, v53, v117
    v_add_f32 v70, v54, v118
    v_add_f32 v71, v55, v119
    ds_read_b128 v[48:51], v4 offset:8576
    ds_read_b128 v[52:55], v4 offset:8608
    v_exp_f32 v64, v64
    v_exp_f32 v65, v65
    v_exp_f32 v66, v66
    v_exp_f32 v67, v67
    v_exp_f32 v68, v68
    v_exp_f32 v69, v69
    v_exp_f32 v70, v70
    v_exp_f32 v71, v71
    v_add_f32 v64, 1.0, v64
    v_add_f32 v65, 1.0, v65
    v_add_f32 v66, 1.0, v66
    v_add_f32 v67, 1.0, v67
    v_add_f32 v68, 1.0, v68
    v_add_f32 v69, 1.0, v69
    v_add_f32 v70, 1.0, v70
    v_add_f32 v71, 1.0, v71
    v_rcp_f32 v64, v64
    v_rcp_f32 v65, v65
    v_rcp_f32 v66, v66
    v_rcp_f32 v67, v67
    v_rcp_f32 v68, v68
    v_rcp_f32 v69, v69
    v_rcp_f32 v70, v70
    v_rcp_f32 v71, v71
    s_nop 0
    v_cvt_pk_bf16_f32 v80, v64, v65
    v_cvt_pk_bf16_f32 v81, v66, v67
    v_cvt_pk_bf16_f32 v82, v68, v69
    v_cvt_pk_bf16_f32 v83, v70, v71
    ds_write_b128 v2, v[80:83] offset:18432
    s_waitcnt lgkmcnt(10)
    v_add_f32 v72, v56, v120
    v_add_f32 v73, v57, v121
    v_add_f32 v74, v58, v122
    v_add_f32 v75, v59, v123
    v_add_f32 v76, v60, v124
    v_add_f32 v77, v61, v125
    v_add_f32 v78, v62, v126
    v_add_f32 v79, v63, v127
    ds_read_b128 v[56:59], v4 offset:8640
    ds_read_b128 v[60:63], v4 offset:8672
    v_exp_f32 v72, v72
    v_exp_f32 v73, v73
    v_exp_f32 v74, v74
    v_exp_f32 v75, v75
    v_exp_f32 v76, v76
    v_exp_f32 v77, v77
    v_exp_f32 v78, v78
    v_exp_f32 v79, v79
    v_add_f32 v72, 1.0, v72
    v_add_f32 v73, 1.0, v73
    v_add_f32 v74, 1.0, v74
    v_add_f32 v75, 1.0, v75
    v_add_f32 v76, 1.0, v76
    v_add_f32 v77, 1.0, v77
    v_add_f32 v78, 1.0, v78
    v_add_f32 v79, 1.0, v79
    v_rcp_f32 v72, v72
    v_rcp_f32 v73, v73
    v_rcp_f32 v74, v74
    v_rcp_f32 v75, v75
    v_rcp_f32 v76, v76
    v_rcp_f32 v77, v77
    v_rcp_f32 v78, v78
    v_rcp_f32 v79, v79
    s_nop 0
    v_cvt_pk_bf16_f32 v84, v72, v73
    v_cvt_pk_bf16_f32 v85, v74, v75
    v_cvt_pk_bf16_f32 v86, v76, v77
    v_cvt_pk_bf16_f32 v87, v78, v79
    ds_write_b128 v2, v[84:87] offset:19456
    s_waitcnt lgkmcnt(0)
    s_barrier
    v_add_f32 v64, v32, v96
    v_add_f32 v65, v33, v97
    v_add_f32 v66, v34, v98
    v_add_f32 v67, v35, v99
    v_add_f32 v68, v36, v100
    v_add_f32 v69, v37, v101
    v_add_f32 v70, v38, v102
    v_add_f32 v71, v39, v103
    ds_read_b128 v[32:35], v4 offset:12672
    ds_read_b128 v[36:39], v4 offset:12704
    v_exp_f32 v64, v64
    v_exp_f32 v65, v65
    v_exp_f32 v66, v66
    v_exp_f32 v67, v67
    v_exp_f32 v68, v68
    v_exp_f32 v69, v69
    v_exp_f32 v70, v70
    v_exp_f32 v71, v71
    v_add_f32 v64, 1.0, v64
    v_add_f32 v65, 1.0, v65
    v_add_f32 v66, 1.0, v66
    v_add_f32 v67, 1.0, v67
    v_add_f32 v68, 1.0, v68
    v_add_f32 v69, 1.0, v69
    v_add_f32 v70, 1.0, v70
    v_add_f32 v71, 1.0, v71
    v_rcp_f32 v64, v64
    v_rcp_f32 v65, v65
    v_rcp_f32 v66, v66
    v_rcp_f32 v67, v67
    v_rcp_f32 v68, v68
    v_rcp_f32 v69, v69
    v_rcp_f32 v70, v70
    v_rcp_f32 v71, v71
    s_nop 0
    v_cvt_pk_bf16_f32 v80, v64, v65
    v_cvt_pk_bf16_f32 v81, v66, v67
    v_cvt_pk_bf16_f32 v82, v68, v69
    v_cvt_pk_bf16_f32 v83, v70, v71
    ds_write_b128 v2, v[80:83] offset:32768
    v_add_f32 v72, v40, v104
    v_add_f32 v73, v41, v105
    v_add_f32 v74, v42, v106
    v_add_f32 v75, v43, v107
    v_add_f32 v76, v44, v108
    v_add_f32 v77, v45, v109
    v_add_f32 v78, v46, v110
    v_add_f32 v79, v47, v111
    ds_read_b128 v[40:43], v4 offset:12736
    ds_read_b128 v[44:47], v4 offset:12768
    v_exp_f32 v72, v72
    v_exp_f32 v73, v73
    v_exp_f32 v74, v74
    v_exp_f32 v75, v75
    v_exp_f32 v76, v76
    v_exp_f32 v77, v77
    v_exp_f32 v78, v78
    v_exp_f32 v79, v79
    v_add_f32 v72, 1.0, v72
    v_add_f32 v73, 1.0, v73
    v_add_f32 v74, 1.0, v74
    v_add_f32 v75, 1.0, v75
    v_add_f32 v76, 1.0, v76
    v_add_f32 v77, 1.0, v77
    v_add_f32 v78, 1.0, v78
    v_add_f32 v79, 1.0, v79
    v_rcp_f32 v72, v72
    v_rcp_f32 v73, v73
    v_rcp_f32 v74, v74
    v_rcp_f32 v75, v75
    v_rcp_f32 v76, v76
    v_rcp_f32 v77, v77
    v_rcp_f32 v78, v78
    v_rcp_f32 v79, v79
    s_nop 0
    v_cvt_pk_bf16_f32 v84, v72, v73
    v_cvt_pk_bf16_f32 v85, v74, v75
    v_cvt_pk_bf16_f32 v86, v76, v77
    v_cvt_pk_bf16_f32 v87, v78, v79
    ds_write_b128 v2, v[84:87] offset:33792
    v_add_f32 v64, v48, v112
    v_add_f32 v65, v49, v113
    v_add_f32 v66, v50, v114
    v_add_f32 v67, v51, v115
    v_add_f32 v68, v52, v116
    v_add_f32 v69, v53, v117
    v_add_f32 v70, v54, v118
    v_add_f32 v71, v55, v119
    ds_read_b128 v[48:51], v4 offset:12800
    ds_read_b128 v[52:55], v4 offset:12832
    v_exp_f32 v64, v64
    v_exp_f32 v65, v65
    v_exp_f32 v66, v66
    v_exp_f32 v67, v67
    v_exp_f32 v68, v68
    v_exp_f32 v69, v69
    v_exp_f32 v70, v70
    v_exp_f32 v71, v71
    v_add_f32 v64, 1.0, v64
    v_add_f32 v65, 1.0, v65
    v_add_f32 v66, 1.0, v66
    v_add_f32 v67, 1.0, v67
    v_add_f32 v68, 1.0, v68
    v_add_f32 v69, 1.0, v69
    v_add_f32 v70, 1.0, v70
    v_add_f32 v71, 1.0, v71
    v_rcp_f32 v64, v64
    v_rcp_f32 v65, v65
    v_rcp_f32 v66, v66
    v_rcp_f32 v67, v67
    v_rcp_f32 v68, v68
    v_rcp_f32 v69, v69
    v_rcp_f32 v70, v70
    v_rcp_f32 v71, v71
    s_nop 0
    v_cvt_pk_bf16_f32 v80, v64, v65
    v_cvt_pk_bf16_f32 v81, v66, v67
    v_cvt_pk_bf16_f32 v82, v68, v69
    v_cvt_pk_bf16_f32 v83, v70, v71
    ds_write_b128 v2, v[80:83] offset:34816
    v_add_f32 v72, v56, v120
    v_add_f32 v73, v57, v121
    v_add_f32 v74, v58, v122
    v_add_f32 v75, v59, v123
    v_add_f32 v76, v60, v124
    v_add_f32 v77, v61, v125
    v_add_f32 v78, v62, v126
    v_add_f32 v79, v63, v127
    ds_read_b128 v[56:59], v4 offset:12864
    ds_read_b128 v[60:63], v4 offset:12896
    v_exp_f32 v72, v72
    v_exp_f32 v73, v73
    v_exp_f32 v74, v74
    v_exp_f32 v75, v75
    v_exp_f32 v76, v76
    v_exp_f32 v77, v77
    v_exp_f32 v78, v78
    v_exp_f32 v79, v79
    v_add_f32 v72, 1.0, v72
    v_add_f32 v73, 1.0, v73
    v_add_f32 v74, 1.0, v74
    v_add_f32 v75, 1.0, v75
    v_add_f32 v76, 1.0, v76
    v_add_f32 v77, 1.0, v77
    v_add_f32 v78, 1.0, v78
    v_add_f32 v79, 1.0, v79
    v_rcp_f32 v72, v72
    v_rcp_f32 v73, v73
    v_rcp_f32 v74, v74
    v_rcp_f32 v75, v75
    v_rcp_f32 v76, v76
    v_rcp_f32 v77, v77
    v_rcp_f32 v78, v78
    v_rcp_f32 v79, v79
    s_nop 0
    v_cvt_pk_bf16_f32 v84, v72, v73
    v_cvt_pk_bf16_f32 v85, v74, v75
    v_cvt_pk_bf16_f32 v86, v76, v77
    v_cvt_pk_bf16_f32 v87, v78, v79
    ds_write_b128 v2, v[84:87] offset:35840
    s_waitcnt lgkmcnt(0)
    s_barrier
    v_add_f32 v64, v32, v96
    v_add_f32 v65, v33, v97
    v_add_f32 v66, v34, v98
    v_add_f32 v67, v35, v99
    v_add_f32 v68, v36, v100
    v_add_f32 v69, v37, v101
    v_add_f32 v70, v38, v102
    v_add_f32 v71, v39, v103
    ds_read_b128 v[32:35], v4 offset:16896
    ds_read_b128 v[36:39], v4 offset:16928
    v_exp_f32 v64, v64
    v_exp_f32 v65, v65
    v_exp_f32 v66, v66
    v_exp_f32 v67, v67
    v_exp_f32 v68, v68
    v_exp_f32 v69, v69
    v_exp_f32 v70, v70
    v_exp_f32 v71, v71
    v_add_f32 v64, 1.0, v64
    v_add_f32 v65, 1.0, v65
    v_add_f32 v66, 1.0, v66
    v_add_f32 v67, 1.0, v67
    v_add_f32 v68, 1.0, v68
    v_add_f32 v69, 1.0, v69
    v_add_f32 v70, 1.0, v70
    v_add_f32 v71, 1.0, v71
    v_rcp_f32 v64, v64
    v_rcp_f32 v65, v65
    v_rcp_f32 v66, v66
    v_rcp_f32 v67, v67
    v_rcp_f32 v68, v68
    v_rcp_f32 v69, v69
    v_rcp_f32 v70, v70
    v_rcp_f32 v71, v71
    s_nop 0
    v_cvt_pk_bf16_f32 v80, v64, v65
    v_cvt_pk_bf16_f32 v81, v66, v67
    v_cvt_pk_bf16_f32 v82, v68, v69
    v_cvt_pk_bf16_f32 v83, v70, v71
    ds_write_b128 v2, v[80:83] offset:0
    v_add_f32 v72, v40, v104
    v_add_f32 v73, v41, v105
    v_add_f32 v74, v42, v106
    v_add_f32 v75, v43, v107
    v_add_f32 v76, v44, v108
    v_add_f32 v77, v45, v109
    v_add_f32 v78, v46, v110
    v_add_f32 v79, v47, v111
    ds_read_b128 v[40:43], v4 offset:16960
    ds_read_b128 v[44:47], v4 offset:16992
    v_exp_f32 v72, v72
    v_exp_f32 v73, v73
    v_exp_f32 v74, v74
    v_exp_f32 v75, v75
    v_exp_f32 v76, v76
    v_exp_f32 v77, v77
    v_exp_f32 v78, v78
    v_exp_f32 v79, v79
    v_add_f32 v72, 1.0, v72
    v_add_f32 v73, 1.0, v73
    v_add_f32 v74, 1.0, v74
    v_add_f32 v75, 1.0, v75
    v_add_f32 v76, 1.0, v76
    v_add_f32 v77, 1.0, v77
    v_add_f32 v78, 1.0, v78
    v_add_f32 v79, 1.0, v79
    v_rcp_f32 v72, v72
    v_rcp_f32 v73, v73
    v_rcp_f32 v74, v74
    v_rcp_f32 v75, v75
    v_rcp_f32 v76, v76
    v_rcp_f32 v77, v77
    v_rcp_f32 v78, v78
    v_rcp_f32 v79, v79
    s_nop 0
    v_cvt_pk_bf16_f32 v84, v72, v73
    v_cvt_pk_bf16_f32 v85, v74, v75
    v_cvt_pk_bf16_f32 v86, v76, v77
    v_cvt_pk_bf16_f32 v87, v78, v79
    ds_write_b128 v2, v[84:87] offset:1024
    v_add_f32 v64, v48, v112
    v_add_f32 v65, v49, v113
    v_add_f32 v66, v50, v114
    v_add_f32 v67, v51, v115
    v_add_f32 v68, v52, v116
    v_add_f32 v69, v53, v117
    v_add_f32 v70, v54, v118
    v_add_f32 v71, v55, v119
    ds_read_b128 v[48:51], v4 offset:17024
    ds_read_b128 v[52:55], v4 offset:17056
    v_exp_f32 v64, v64
    v_exp_f32 v65, v65
    v_exp_f32 v66, v66
    v_exp_f32 v67, v67
    v_exp_f32 v68, v68
    v_exp_f32 v69, v69
    v_exp_f32 v70, v70
    v_exp_f32 v71, v71
    v_add_f32 v64, 1.0, v64
    v_add_f32 v65, 1.0, v65
    v_add_f32 v66, 1.0, v66
    v_add_f32 v67, 1.0, v67
    v_add_f32 v68, 1.0, v68
    v_add_f32 v69, 1.0, v69
    v_add_f32 v70, 1.0, v70
    v_add_f32 v71, 1.0, v71
    v_rcp_f32 v64, v64
    v_rcp_f32 v65, v65
    v_rcp_f32 v66, v66
    v_rcp_f32 v67, v67
    v_rcp_f32 v68, v68
    v_rcp_f32 v69, v69
    v_rcp_f32 v70, v70
    v_rcp_f32 v71, v71
    s_nop 0
    v_cvt_pk_bf16_f32 v80, v64, v65
    v_cvt_pk_bf16_f32 v81, v66, v67
    v_cvt_pk_bf16_f32 v82, v68, v69
    v_cvt_pk_bf16_f32 v83, v70, v71
    ds_write_b128 v2, v[80:83] offset:2048
    v_add_f32 v72, v56, v120
    v_add_f32 v73, v57, v121
    v_add_f32 v74, v58, v122
    v_add_f32 v75, v59, v123
    v_add_f32 v76, v60, v124
    v_add_f32 v77, v61, v125
    v_add_f32 v78, v62, v126
    v_add_f32 v79, v63, v127
    ds_read_b128 v[56:59], v4 offset:17088
    ds_read_b128 v[60:63], v4 offset:17120
    v_exp_f32 v72, v72
    v_exp_f32 v73, v73
    v_exp_f32 v74, v74
    v_exp_f32 v75, v75
    v_exp_f32 v76, v76
    v_exp_f32 v77, v77
    v_exp_f32 v78, v78
    v_exp_f32 v79, v79
    v_add_f32 v72, 1.0, v72
    v_add_f32 v73, 1.0, v73
    v_add_f32 v74, 1.0, v74
    v_add_f32 v75, 1.0, v75
    v_add_f32 v76, 1.0, v76
    v_add_f32 v77, 1.0, v77
    v_add_f32 v78, 1.0, v78
    v_add_f32 v79, 1.0, v79
    v_rcp_f32 v72, v72
    v_rcp_f32 v73, v73
    v_rcp_f32 v74, v74
    v_rcp_f32 v75, v75
    v_rcp_f32 v76, v76
    v_rcp_f32 v77, v77
    v_rcp_f32 v78, v78
    v_rcp_f32 v79, v79
    s_nop 0
    v_cvt_pk_bf16_f32 v84, v72, v73
    v_cvt_pk_bf16_f32 v85, v74, v75
    v_cvt_pk_bf16_f32 v86, v76, v77
    v_cvt_pk_bf16_f32 v87, v78, v79
    ds_write_b128 v2, v[84:87] offset:3072
    s_waitcnt lgkmcnt(0)
    s_barrier
    ds_read_b128 a[0:3], v6 offset:0
    ds_read_b128 a[4:7], v6 offset:1056
    ds_read_b128 a[8:11], v6 offset:2112
    ds_read_b128 a[12:15], v6 offset:3168
    v_add_f32 v64, v32, v96
    v_add_f32 v65, v33, v97
    v_add_f32 v66, v34, v98
    v_add_f32 v67, v35, v99
    v_add_f32 v68, v36, v100
    v_add_f32 v69, v37, v101
    v_add_f32 v70, v38, v102
    v_add_f32 v71, v39, v103
    ds_read_b128 v[32:35], v4 offset:21120
    ds_read_b128 v[36:39], v4 offset:21152
    v_exp_f32 v64, v64
    v_exp_f32 v65, v65
    v_exp_f32 v66, v66
    v_exp_f32 v67, v67
    v_exp_f32 v68, v68
    v_exp_f32 v69, v69
    v_exp_f32 v70, v70
    v_exp_f32 v71, v71
    v_add_f32 v64, 1.0, v64
    v_add_f32 v65, 1.0, v65
    v_add_f32 v66, 1.0, v66
    v_add_f32 v67, 1.0, v67
    v_add_f32 v68, 1.0, v68
    v_add_f32 v69, 1.0, v69
    v_add_f32 v70, 1.0, v70
    v_add_f32 v71, 1.0, v71
    v_rcp_f32 v64, v64
    v_rcp_f32 v65, v65
    v_rcp_f32 v66, v66
    v_rcp_f32 v67, v67
    v_rcp_f32 v68, v68
    v_rcp_f32 v69, v69
    v_rcp_f32 v70, v70
    v_rcp_f32 v71, v71
    s_waitcnt lgkmcnt(5)
    s_mov_b32 s36, 0
    buffer_store_dwordx4 a[0:3], v7, s[16:19], s36 offen sc1
    s_waitcnt lgkmcnt(4)
    s_mov_b32 s36, 1024
    buffer_store_dwordx4 a[4:7], v7, s[16:19], s36 offen sc1
    v_cvt_pk_bf16_f32 v80, v64, v65
    v_cvt_pk_bf16_f32 v81, v66, v67
    v_cvt_pk_bf16_f32 v82, v68, v69
    v_cvt_pk_bf16_f32 v83, v70, v71
    ds_write_b128 v2, v[80:83] offset:16384
    v_add_f32 v72, v40, v104
    v_add_f32 v73, v41, v105
    v_add_f32 v74, v42, v106
    v_add_f32 v75, v43, v107
    v_add_f32 v76, v44, v108
    v_add_f32 v77, v45, v109
    v_add_f32 v78, v46, v110
    v_add_f32 v79, v47, v111
    ds_read_b128 v[40:43], v4 offset:21184
    ds_read_b128 v[44:47], v4 offset:21216
    v_exp_f32 v72, v72
    v_exp_f32 v73, v73
    v_exp_f32 v74, v74
    v_exp_f32 v75, v75
    v_exp_f32 v76, v76
    v_exp_f32 v77, v77
    v_exp_f32 v78, v78
    v_exp_f32 v79, v79
    v_add_f32 v72, 1.0, v72
    v_add_f32 v73, 1.0, v73
    v_add_f32 v74, 1.0, v74
    v_add_f32 v75, 1.0, v75
    v_add_f32 v76, 1.0, v76
    v_add_f32 v77, 1.0, v77
    v_add_f32 v78, 1.0, v78
    v_add_f32 v79, 1.0, v79
    v_rcp_f32 v72, v72
    v_rcp_f32 v73, v73
    v_rcp_f32 v74, v74
    v_rcp_f32 v75, v75
    v_rcp_f32 v76, v76
    v_rcp_f32 v77, v77
    v_rcp_f32 v78, v78
    v_rcp_f32 v79, v79
    s_waitcnt lgkmcnt(6)
    s_mov_b32 s36, 2048
    buffer_store_dwordx4 a[8:11], v7, s[16:19], s36 offen sc1
    s_waitcnt lgkmcnt(5)
    s_mov_b32 s36, 3072
    buffer_store_dwordx4 a[12:15], v7, s[16:19], s36 offen sc1
    v_cvt_pk_bf16_f32 v84, v72, v73
    v_cvt_pk_bf16_f32 v85, v74, v75
    v_cvt_pk_bf16_f32 v86, v76, v77
    v_cvt_pk_bf16_f32 v87, v78, v79
    ds_write_b128 v2, v[84:87] offset:17408
    v_add_f32 v64, v48, v112
    v_add_f32 v65, v49, v113
    v_add_f32 v66, v50, v114
    v_add_f32 v67, v51, v115
    v_add_f32 v68, v52, v116
    v_add_f32 v69, v53, v117
    v_add_f32 v70, v54, v118
    v_add_f32 v71, v55, v119
    ds_read_b128 v[48:51], v4 offset:21248
    ds_read_b128 v[52:55], v4 offset:21280
    v_exp_f32 v64, v64
    v_exp_f32 v65, v65
    v_exp_f32 v66, v66
    v_exp_f32 v67, v67
    v_exp_f32 v68, v68
    v_exp_f32 v69, v69
    v_exp_f32 v70, v70
    v_exp_f32 v71, v71
    v_add_f32 v64, 1.0, v64
    v_add_f32 v65, 1.0, v65
    v_add_f32 v66, 1.0, v66
    v_add_f32 v67, 1.0, v67
    v_add_f32 v68, 1.0, v68
    v_add_f32 v69, 1.0, v69
    v_add_f32 v70, 1.0, v70
    v_add_f32 v71, 1.0, v71
    v_rcp_f32 v64, v64
    v_rcp_f32 v65, v65
    v_rcp_f32 v66, v66
    v_rcp_f32 v67, v67
    v_rcp_f32 v68, v68
    v_rcp_f32 v69, v69
    v_rcp_f32 v70, v70
    v_rcp_f32 v71, v71
    s_nop 0
    v_cvt_pk_bf16_f32 v80, v64, v65
    v_cvt_pk_bf16_f32 v81, v66, v67
    v_cvt_pk_bf16_f32 v82, v68, v69
    v_cvt_pk_bf16_f32 v83, v70, v71
    ds_write_b128 v2, v[80:83] offset:18432
    v_add_f32 v72, v56, v120
    v_add_f32 v73, v57, v121
    v_add_f32 v74, v58, v122
    v_add_f32 v75, v59, v123
    v_add_f32 v76, v60, v124
    v_add_f32 v77, v61, v125
    v_add_f32 v78, v62, v126
    v_add_f32 v79, v63, v127
    ds_read_b128 v[56:59], v4 offset:21312
    ds_read_b128 v[60:63], v4 offset:21344
    v_exp_f32 v72, v72
    v_exp_f32 v73, v73
    v_exp_f32 v74, v74
    v_exp_f32 v75, v75
    v_exp_f32 v76, v76
    v_exp_f32 v77, v77
    v_exp_f32 v78, v78
    v_exp_f32 v79, v79
    v_add_f32 v72, 1.0, v72
    v_add_f32 v73, 1.0, v73
    v_add_f32 v74, 1.0, v74
    v_add_f32 v75, 1.0, v75
    v_add_f32 v76, 1.0, v76
    v_add_f32 v77, 1.0, v77
    v_add_f32 v78, 1.0, v78
    v_add_f32 v79, 1.0, v79
    v_rcp_f32 v72, v72
    v_rcp_f32 v73, v73
    v_rcp_f32 v74, v74
    v_rcp_f32 v75, v75
    v_rcp_f32 v76, v76
    v_rcp_f32 v77, v77
    v_rcp_f32 v78, v78
    v_rcp_f32 v79, v79
    s_nop 0
    v_cvt_pk_bf16_f32 v84, v72, v73
    v_cvt_pk_bf16_f32 v85, v74, v75
    v_cvt_pk_bf16_f32 v86, v76, v77
    v_cvt_pk_bf16_f32 v87, v78, v79
    ds_write_b128 v2, v[84:87] offset:19456
    s_waitcnt lgkmcnt(0)
    s_barrier
    ds_read_b128 a[0:3], v6 offset:16896
    ds_read_b128 a[4:7], v6 offset:17952
    ds_read_b128 a[8:11], v6 offset:19008
    ds_read_b128 a[12:15], v6 offset:20064
    v_add_f32 v64, v32, v96
    v_add_f32 v65, v33, v97
    v_add_f32 v66, v34, v98
    v_add_f32 v67, v35, v99
    v_add_f32 v68, v36, v100
    v_add_f32 v69, v37, v101
    v_add_f32 v70, v38, v102
    v_add_f32 v71, v39, v103
    ds_read_b128 v[32:35], v4 offset:25344
    ds_read_b128 v[36:39], v4 offset:25376
    v_exp_f32 v64, v64
    v_exp_f32 v65, v65
    v_exp_f32 v66, v66
    v_exp_f32 v67, v67
    v_exp_f32 v68, v68
    v_exp_f32 v69, v69
    v_exp_f32 v70, v70
    v_exp_f32 v71, v71
    v_add_f32 v64, 1.0, v64
    v_add_f32 v65, 1.0, v65
    v_add_f32 v66, 1.0, v66
    v_add_f32 v67, 1.0, v67
    v_add_f32 v68, 1.0, v68
    v_add_f32 v69, 1.0, v69
    v_add_f32 v70, 1.0, v70
    v_add_f32 v71, 1.0, v71
    v_rcp_f32 v64, v64
    v_rcp_f32 v65, v65
    v_rcp_f32 v66, v66
    v_rcp_f32 v67, v67
    v_rcp_f32 v68, v68
    v_rcp_f32 v69, v69
    v_rcp_f32 v70, v70
    v_rcp_f32 v71, v71
    s_waitcnt lgkmcnt(5)
    s_mov_b32 s36, 16384
    buffer_store_dwordx4 a[0:3], v7, s[16:19], s36 offen sc1
    s_waitcnt lgkmcnt(4)
    s_mov_b32 s36, 17408
    buffer_store_dwordx4 a[4:7], v7, s[16:19], s36 offen sc1
    v_cvt_pk_bf16_f32 v80, v64, v65
    v_cvt_pk_bf16_f32 v81, v66, v67
    v_cvt_pk_bf16_f32 v82, v68, v69
    v_cvt_pk_bf16_f32 v83, v70, v71
    ds_write_b128 v2, v[80:83] offset:32768
    v_add_f32 v72, v40, v104
    v_add_f32 v73, v41, v105
    v_add_f32 v74, v42, v106
    v_add_f32 v75, v43, v107
    v_add_f32 v76, v44, v108
    v_add_f32 v77, v45, v109
    v_add_f32 v78, v46, v110
    v_add_f32 v79, v47, v111
    ds_read_b128 v[40:43], v4 offset:25408
    ds_read_b128 v[44:47], v4 offset:25440
    v_exp_f32 v72, v72
    v_exp_f32 v73, v73
    v_exp_f32 v74, v74
    v_exp_f32 v75, v75
    v_exp_f32 v76, v76
    v_exp_f32 v77, v77
    v_exp_f32 v78, v78
    v_exp_f32 v79, v79
    v_add_f32 v72, 1.0, v72
    v_add_f32 v73, 1.0, v73
    v_add_f32 v74, 1.0, v74
    v_add_f32 v75, 1.0, v75
    v_add_f32 v76, 1.0, v76
    v_add_f32 v77, 1.0, v77
    v_add_f32 v78, 1.0, v78
    v_add_f32 v79, 1.0, v79
    v_rcp_f32 v72, v72
    v_rcp_f32 v73, v73
    v_rcp_f32 v74, v74
    v_rcp_f32 v75, v75
    v_rcp_f32 v76, v76
    v_rcp_f32 v77, v77
    v_rcp_f32 v78, v78
    v_rcp_f32 v79, v79
    s_waitcnt lgkmcnt(6)
    s_mov_b32 s36, 18432
    buffer_store_dwordx4 a[8:11], v7, s[16:19], s36 offen sc1
    s_waitcnt lgkmcnt(5)
    s_mov_b32 s36, 19456
    buffer_store_dwordx4 a[12:15], v7, s[16:19], s36 offen sc1
    v_cvt_pk_bf16_f32 v84, v72, v73
    v_cvt_pk_bf16_f32 v85, v74, v75
    v_cvt_pk_bf16_f32 v86, v76, v77
    v_cvt_pk_bf16_f32 v87, v78, v79
    ds_write_b128 v2, v[84:87] offset:33792
    v_add_f32 v64, v48, v112
    v_add_f32 v65, v49, v113
    v_add_f32 v66, v50, v114
    v_add_f32 v67, v51, v115
    v_add_f32 v68, v52, v116
    v_add_f32 v69, v53, v117
    v_add_f32 v70, v54, v118
    v_add_f32 v71, v55, v119
    ds_read_b128 v[48:51], v4 offset:25472
    ds_read_b128 v[52:55], v4 offset:25504
    v_exp_f32 v64, v64
    v_exp_f32 v65, v65
    v_exp_f32 v66, v66
    v_exp_f32 v67, v67
    v_exp_f32 v68, v68
    v_exp_f32 v69, v69
    v_exp_f32 v70, v70
    v_exp_f32 v71, v71
    v_add_f32 v64, 1.0, v64
    v_add_f32 v65, 1.0, v65
    v_add_f32 v66, 1.0, v66
    v_add_f32 v67, 1.0, v67
    v_add_f32 v68, 1.0, v68
    v_add_f32 v69, 1.0, v69
    v_add_f32 v70, 1.0, v70
    v_add_f32 v71, 1.0, v71
    v_rcp_f32 v64, v64
    v_rcp_f32 v65, v65
    v_rcp_f32 v66, v66
    v_rcp_f32 v67, v67
    v_rcp_f32 v68, v68
    v_rcp_f32 v69, v69
    v_rcp_f32 v70, v70
    v_rcp_f32 v71, v71
    s_nop 0
    v_cvt_pk_bf16_f32 v80, v64, v65
    v_cvt_pk_bf16_f32 v81, v66, v67
    v_cvt_pk_bf16_f32 v82, v68, v69
    v_cvt_pk_bf16_f32 v83, v70, v71
    ds_write_b128 v2, v[80:83] offset:34816
    v_add_f32 v72, v56, v120
    v_add_f32 v73, v57, v121
    v_add_f32 v74, v58, v122
    v_add_f32 v75, v59, v123
    v_add_f32 v76, v60, v124
    v_add_f32 v77, v61, v125
    v_add_f32 v78, v62, v126
    v_add_f32 v79, v63, v127
    ds_read_b128 v[56:59], v4 offset:25536
    ds_read_b128 v[60:63], v4 offset:25568
    v_exp_f32 v72, v72
    v_exp_f32 v73, v73
    v_exp_f32 v74, v74
    v_exp_f32 v75, v75
    v_exp_f32 v76, v76
    v_exp_f32 v77, v77
    v_exp_f32 v78, v78
    v_exp_f32 v79, v79
    v_add_f32 v72, 1.0, v72
    v_add_f32 v73, 1.0, v73
    v_add_f32 v74, 1.0, v74
    v_add_f32 v75, 1.0, v75
    v_add_f32 v76, 1.0, v76
    v_add_f32 v77, 1.0, v77
    v_add_f32 v78, 1.0, v78
    v_add_f32 v79, 1.0, v79
    v_rcp_f32 v72, v72
    v_rcp_f32 v73, v73
    v_rcp_f32 v74, v74
    v_rcp_f32 v75, v75
    v_rcp_f32 v76, v76
    v_rcp_f32 v77, v77
    v_rcp_f32 v78, v78
    v_rcp_f32 v79, v79
    s_nop 0
    v_cvt_pk_bf16_f32 v84, v72, v73
    v_cvt_pk_bf16_f32 v85, v74, v75
    v_cvt_pk_bf16_f32 v86, v76, v77
    v_cvt_pk_bf16_f32 v87, v78, v79
    ds_write_b128 v2, v[84:87] offset:35840
    s_waitcnt lgkmcnt(0)
    s_barrier
    ds_read_b128 a[0:3], v6 offset:0
    ds_read_b128 a[4:7], v6 offset:1056
    ds_read_b128 a[8:11], v6 offset:2112
    ds_read_b128 a[12:15], v6 offset:3168
    v_add_f32 v64, v32, v96
    v_add_f32 v65, v33, v97
    v_add_f32 v66, v34, v98
    v_add_f32 v67, v35, v99
    v_add_f32 v68, v36, v100
    v_add_f32 v69, v37, v101
    v_add_f32 v70, v38, v102
    v_add_f32 v71, v39, v103
    ds_read_b128 v[32:35], v4 offset:29568
    ds_read_b128 v[36:39], v4 offset:29600
    v_exp_f32 v64, v64
    v_exp_f32 v65, v65
    v_exp_f32 v66, v66
    v_exp_f32 v67, v67
    v_exp_f32 v68, v68
    v_exp_f32 v69, v69
    v_exp_f32 v70, v70
    v_exp_f32 v71, v71
    v_add_f32 v64, 1.0, v64
    v_add_f32 v65, 1.0, v65
    v_add_f32 v66, 1.0, v66
    v_add_f32 v67, 1.0, v67
    v_add_f32 v68, 1.0, v68
    v_add_f32 v69, 1.0, v69
    v_add_f32 v70, 1.0, v70
    v_add_f32 v71, 1.0, v71
    v_rcp_f32 v64, v64
    v_rcp_f32 v65, v65
    v_rcp_f32 v66, v66
    v_rcp_f32 v67, v67
    v_rcp_f32 v68, v68
    v_rcp_f32 v69, v69
    v_rcp_f32 v70, v70
    v_rcp_f32 v71, v71
    s_waitcnt lgkmcnt(5)
    s_mov_b32 s36, 32768
    buffer_store_dwordx4 a[0:3], v7, s[16:19], s36 offen sc1
    s_waitcnt lgkmcnt(4)
    s_mov_b32 s36, 33792
    buffer_store_dwordx4 a[4:7], v7, s[16:19], s36 offen sc1
    v_cvt_pk_bf16_f32 v80, v64, v65
    v_cvt_pk_bf16_f32 v81, v66, v67
    v_cvt_pk_bf16_f32 v82, v68, v69
    v_cvt_pk_bf16_f32 v83, v70, v71
    ds_write_b128 v2, v[80:83] offset:0
    v_add_f32 v72, v40, v104
    v_add_f32 v73, v41, v105
    v_add_f32 v74, v42, v106
    v_add_f32 v75, v43, v107
    v_add_f32 v76, v44, v108
    v_add_f32 v77, v45, v109
    v_add_f32 v78, v46, v110
    v_add_f32 v79, v47, v111
    ds_read_b128 v[40:43], v4 offset:29632
    ds_read_b128 v[44:47], v4 offset:29664
    v_exp_f32 v72, v72
    v_exp_f32 v73, v73
    v_exp_f32 v74, v74
    v_exp_f32 v75, v75
    v_exp_f32 v76, v76
    v_exp_f32 v77, v77
    v_exp_f32 v78, v78
    v_exp_f32 v79, v79
    v_add_f32 v72, 1.0, v72
    v_add_f32 v73, 1.0, v73
    v_add_f32 v74, 1.0, v74
    v_add_f32 v75, 1.0, v75
    v_add_f32 v76, 1.0, v76
    v_add_f32 v77, 1.0, v77
    v_add_f32 v78, 1.0, v78
    v_add_f32 v79, 1.0, v79
    v_rcp_f32 v72, v72
    v_rcp_f32 v73, v73
    v_rcp_f32 v74, v74
    v_rcp_f32 v75, v75
    v_rcp_f32 v76, v76
    v_rcp_f32 v77, v77
    v_rcp_f32 v78, v78
    v_rcp_f32 v79, v79
    s_waitcnt lgkmcnt(6)
    s_mov_b32 s36, 34816
    buffer_store_dwordx4 a[8:11], v7, s[16:19], s36 offen sc1
    s_waitcnt lgkmcnt(5)
    s_mov_b32 s36, 35840
    buffer_store_dwordx4 a[12:15], v7, s[16:19], s36 offen sc1
    v_cvt_pk_bf16_f32 v84, v72, v73
    v_cvt_pk_bf16_f32 v85, v74, v75
    v_cvt_pk_bf16_f32 v86, v76, v77
    v_cvt_pk_bf16_f32 v87, v78, v79
    ds_write_b128 v2, v[84:87] offset:1024
    v_add_f32 v64, v48, v112
    v_add_f32 v65, v49, v113
    v_add_f32 v66, v50, v114
    v_add_f32 v67, v51, v115
    v_add_f32 v68, v52, v116
    v_add_f32 v69, v53, v117
    v_add_f32 v70, v54, v118
    v_add_f32 v71, v55, v119
    ds_read_b128 v[48:51], v4 offset:29696
    ds_read_b128 v[52:55], v4 offset:29728
    v_exp_f32 v64, v64
    v_exp_f32 v65, v65
    v_exp_f32 v66, v66
    v_exp_f32 v67, v67
    v_exp_f32 v68, v68
    v_exp_f32 v69, v69
    v_exp_f32 v70, v70
    v_exp_f32 v71, v71
    v_add_f32 v64, 1.0, v64
    v_add_f32 v65, 1.0, v65
    v_add_f32 v66, 1.0, v66
    v_add_f32 v67, 1.0, v67
    v_add_f32 v68, 1.0, v68
    v_add_f32 v69, 1.0, v69
    v_add_f32 v70, 1.0, v70
    v_add_f32 v71, 1.0, v71
    v_rcp_f32 v64, v64
    v_rcp_f32 v65, v65
    v_rcp_f32 v66, v66
    v_rcp_f32 v67, v67
    v_rcp_f32 v68, v68
    v_rcp_f32 v69, v69
    v_rcp_f32 v70, v70
    v_rcp_f32 v71, v71
    s_nop 0
    v_cvt_pk_bf16_f32 v80, v64, v65
    v_cvt_pk_bf16_f32 v81, v66, v67
    v_cvt_pk_bf16_f32 v82, v68, v69
    v_cvt_pk_bf16_f32 v83, v70, v71
    ds_write_b128 v2, v[80:83] offset:2048
    v_add_f32 v72, v56, v120
    v_add_f32 v73, v57, v121
    v_add_f32 v74, v58, v122
    v_add_f32 v75, v59, v123
    v_add_f32 v76, v60, v124
    v_add_f32 v77, v61, v125
    v_add_f32 v78, v62, v126
    v_add_f32 v79, v63, v127
    ds_read_b128 v[56:59], v4 offset:29760
    ds_read_b128 v[60:63], v4 offset:29792
    v_exp_f32 v72, v72
    v_exp_f32 v73, v73
    v_exp_f32 v74, v74
    v_exp_f32 v75, v75
    v_exp_f32 v76, v76
    v_exp_f32 v77, v77
    v_exp_f32 v78, v78
    v_exp_f32 v79, v79
    v_add_f32 v72, 1.0, v72
    v_add_f32 v73, 1.0, v73
    v_add_f32 v74, 1.0, v74
    v_add_f32 v75, 1.0, v75
    v_add_f32 v76, 1.0, v76
    v_add_f32 v77, 1.0, v77
    v_add_f32 v78, 1.0, v78
    v_add_f32 v79, 1.0, v79
    v_rcp_f32 v72, v72
    v_rcp_f32 v73, v73
    v_rcp_f32 v74, v74
    v_rcp_f32 v75, v75
    v_rcp_f32 v76, v76
    v_rcp_f32 v77, v77
    v_rcp_f32 v78, v78
    v_rcp_f32 v79, v79
    s_nop 0
    v_cvt_pk_bf16_f32 v84, v72, v73
    v_cvt_pk_bf16_f32 v85, v74, v75
    v_cvt_pk_bf16_f32 v86, v76, v77
    v_cvt_pk_bf16_f32 v87, v78, v79
    ds_write_b128 v2, v[84:87] offset:3072
    s_waitcnt lgkmcnt(0)
    s_barrier
    ds_read_b128 a[0:3], v6 offset:16896
    ds_read_b128 a[4:7], v6 offset:17952
    ds_read_b128 a[8:11], v6 offset:19008
    ds_read_b128 a[12:15], v6 offset:20064
    v_add_f32 v64, v32, v96
    v_add_f32 v65, v33, v97
    v_add_f32 v66, v34, v98
    v_add_f32 v67, v35, v99
    v_add_f32 v68, v36, v100
    v_add_f32 v69, v37, v101
    v_add_f32 v70, v38, v102
    v_add_f32 v71, v39, v103
    v_exp_f32 v64, v64
    v_exp_f32 v65, v65
    v_exp_f32 v66, v66
    v_exp_f32 v67, v67
    v_exp_f32 v68, v68
    v_exp_f32 v69, v69
    v_exp_f32 v70, v70
    v_exp_f32 v71, v71
    v_add_f32 v64, 1.0, v64
    v_add_f32 v65, 1.0, v65
    v_add_f32 v66, 1.0, v66
    v_add_f32 v67, 1.0, v67
    v_add_f32 v68, 1.0, v68
    v_add_f32 v69, 1.0, v69
    v_add_f32 v70, 1.0, v70
    v_add_f32 v71, 1.0, v71
    v_rcp_f32 v64, v64
    v_rcp_f32 v65, v65
    v_rcp_f32 v66, v66
    v_rcp_f32 v67, v67
    v_rcp_f32 v68, v68
    v_rcp_f32 v69, v69
    v_rcp_f32 v70, v70
    v_rcp_f32 v71, v71
    s_waitcnt lgkmcnt(3)
    s_mov_b32 s36, 49152
    buffer_store_dwordx4 a[0:3], v7, s[16:19], s36 offen sc1
    s_waitcnt lgkmcnt(2)
    s_mov_b32 s36, 50176
    buffer_store_dwordx4 a[4:7], v7, s[16:19], s36 offen sc1
    v_cvt_pk_bf16_f32 v80, v64, v65
    v_cvt_pk_bf16_f32 v81, v66, v67
    v_cvt_pk_bf16_f32 v82, v68, v69
    v_cvt_pk_bf16_f32 v83, v70, v71
    ds_write_b128 v2, v[80:83] offset:16384
    v_add_f32 v72, v40, v104
    v_add_f32 v73, v41, v105
    v_add_f32 v74, v42, v106
    v_add_f32 v75, v43, v107
    v_add_f32 v76, v44, v108
    v_add_f32 v77, v45, v109
    v_add_f32 v78, v46, v110
    v_add_f32 v79, v47, v111
    v_exp_f32 v72, v72
    v_exp_f32 v73, v73
    v_exp_f32 v74, v74
    v_exp_f32 v75, v75
    v_exp_f32 v76, v76
    v_exp_f32 v77, v77
    v_exp_f32 v78, v78
    v_exp_f32 v79, v79
    v_add_f32 v72, 1.0, v72
    v_add_f32 v73, 1.0, v73
    v_add_f32 v74, 1.0, v74
    v_add_f32 v75, 1.0, v75
    v_add_f32 v76, 1.0, v76
    v_add_f32 v77, 1.0, v77
    v_add_f32 v78, 1.0, v78
    v_add_f32 v79, 1.0, v79
    v_rcp_f32 v72, v72
    v_rcp_f32 v73, v73
    v_rcp_f32 v74, v74
    v_rcp_f32 v75, v75
    v_rcp_f32 v76, v76
    v_rcp_f32 v77, v77
    v_rcp_f32 v78, v78
    v_rcp_f32 v79, v79
    s_waitcnt lgkmcnt(2)
    s_mov_b32 s36, 51200
    buffer_store_dwordx4 a[8:11], v7, s[16:19], s36 offen sc1
    s_waitcnt lgkmcnt(1)
    s_mov_b32 s36, 52224
    buffer_store_dwordx4 a[12:15], v7, s[16:19], s36 offen sc1
    v_cvt_pk_bf16_f32 v84, v72, v73
    v_cvt_pk_bf16_f32 v85, v74, v75
    v_cvt_pk_bf16_f32 v86, v76, v77
    v_cvt_pk_bf16_f32 v87, v78, v79
    ds_write_b128 v2, v[84:87] offset:17408
    v_add_f32 v64, v48, v112
    v_add_f32 v65, v49, v113
    v_add_f32 v66, v50, v114
    v_add_f32 v67, v51, v115
    v_add_f32 v68, v52, v116
    v_add_f32 v69, v53, v117
    v_add_f32 v70, v54, v118
    v_add_f32 v71, v55, v119
    v_exp_f32 v64, v64
    v_exp_f32 v65, v65
    v_exp_f32 v66, v66
    v_exp_f32 v67, v67
    v_exp_f32 v68, v68
    v_exp_f32 v69, v69
    v_exp_f32 v70, v70
    v_exp_f32 v71, v71
    v_add_f32 v64, 1.0, v64
    v_add_f32 v65, 1.0, v65
    v_add_f32 v66, 1.0, v66
    v_add_f32 v67, 1.0, v67
    v_add_f32 v68, 1.0, v68
    v_add_f32 v69, 1.0, v69
    v_add_f32 v70, 1.0, v70
    v_add_f32 v71, 1.0, v71
    v_rcp_f32 v64, v64
    v_rcp_f32 v65, v65
    v_rcp_f32 v66, v66
    v_rcp_f32 v67, v67
    v_rcp_f32 v68, v68
    v_rcp_f32 v69, v69
    v_rcp_f32 v70, v70
    v_rcp_f32 v71, v71
    s_nop 0
    v_cvt_pk_bf16_f32 v80, v64, v65
    v_cvt_pk_bf16_f32 v81, v66, v67
    v_cvt_pk_bf16_f32 v82, v68, v69
    v_cvt_pk_bf16_f32 v83, v70, v71
    ds_write_b128 v2, v[80:83] offset:18432
    v_add_f32 v72, v56, v120
    v_add_f32 v73, v57, v121
    v_add_f32 v74, v58, v122
    v_add_f32 v75, v59, v123
    v_add_f32 v76, v60, v124
    v_add_f32 v77, v61, v125
    v_add_f32 v78, v62, v126
    v_add_f32 v79, v63, v127
    v_exp_f32 v72, v72
    v_exp_f32 v73, v73
    v_exp_f32 v74, v74
    v_exp_f32 v75, v75
    v_exp_f32 v76, v76
    v_exp_f32 v77, v77
    v_exp_f32 v78, v78
    v_exp_f32 v79, v79
    v_add_f32 v72, 1.0, v72
    v_add_f32 v73, 1.0, v73
    v_add_f32 v74, 1.0, v74
    v_add_f32 v75, 1.0, v75
    v_add_f32 v76, 1.0, v76
    v_add_f32 v77, 1.0, v77
    v_add_f32 v78, 1.0, v78
    v_add_f32 v79, 1.0, v79
    v_rcp_f32 v72, v72
    v_rcp_f32 v73, v73
    v_rcp_f32 v74, v74
    v_rcp_f32 v75, v75
    v_rcp_f32 v76, v76
    v_rcp_f32 v77, v77
    v_rcp_f32 v78, v78
    v_rcp_f32 v79, v79
    s_nop 0
    v_cvt_pk_bf16_f32 v84, v72, v73
    v_cvt_pk_bf16_f32 v85, v74, v75
    v_cvt_pk_bf16_f32 v86, v76, v77
    v_cvt_pk_bf16_f32 v87, v78, v79
    ds_write_b128 v2, v[84:87] offset:19456
    s_waitcnt lgkmcnt(0)
    s_barrier
    ds_read_b128 a[0:3], v6 offset:0
    ds_read_b128 a[4:7], v6 offset:1056
    ds_read_b128 a[8:11], v6 offset:2112
    ds_read_b128 a[12:15], v6 offset:3168
    s_waitcnt lgkmcnt(3)
    s_mov_b32 s36, 65536
    buffer_store_dwordx4 a[0:3], v7, s[16:19], s36 offen sc1
    s_waitcnt lgkmcnt(2)
    s_mov_b32 s36, 66560
    buffer_store_dwordx4 a[4:7], v7, s[16:19], s36 offen sc1
    s_waitcnt lgkmcnt(1)
    s_mov_b32 s36, 67584
    buffer_store_dwordx4 a[8:11], v7, s[16:19], s36 offen sc1
    s_waitcnt lgkmcnt(0)
    s_mov_b32 s36, 68608
    buffer_store_dwordx4 a[12:15], v7, s[16:19], s36 offen sc1
    s_barrier
    ds_read_b128 a[0:3], v6 offset:16896
    ds_read_b128 a[4:7], v6 offset:17952
    ds_read_b128 a[8:11], v6 offset:19008
    ds_read_b128 a[12:15], v6 offset:20064
    s_waitcnt lgkmcnt(3)
    s_mov_b32 s36, 81920
    buffer_store_dwordx4 a[0:3], v7, s[16:19], s36 offen sc1
    s_waitcnt lgkmcnt(2)
    s_mov_b32 s36, 82944
    buffer_store_dwordx4 a[4:7], v7, s[16:19], s36 offen sc1
    s_waitcnt lgkmcnt(1)
    s_mov_b32 s36, 83968
    buffer_store_dwordx4 a[8:11], v7, s[16:19], s36 offen sc1
    s_waitcnt lgkmcnt(0)
    s_mov_b32 s36, 84992
    buffer_store_dwordx4 a[12:15], v7, s[16:19], s36 offen sc1
    s_barrier
    ds_read_b128 a[0:3], v6 offset:0
    ds_read_b128 a[4:7], v6 offset:1056
    ds_read_b128 a[8:11], v6 offset:2112
    ds_read_b128 a[12:15], v6 offset:3168
    s_waitcnt lgkmcnt(3)
    s_mov_b32 s36, 98304
    buffer_store_dwordx4 a[0:3], v7, s[16:19], s36 offen sc1
    s_waitcnt lgkmcnt(2)
    s_mov_b32 s36, 99328
    buffer_store_dwordx4 a[4:7], v7, s[16:19], s36 offen sc1
    s_waitcnt lgkmcnt(1)
    s_mov_b32 s36, 100352
    buffer_store_dwordx4 a[8:11], v7, s[16:19], s36 offen sc1
    s_waitcnt lgkmcnt(0)
    s_mov_b32 s36, 101376
    buffer_store_dwordx4 a[12:15], v7, s[16:19], s36 offen sc1
    s_barrier
    ds_read_b128 a[0:3], v6 offset:16896
    ds_read_b128 a[4:7], v6 offset:17952
    ds_read_b128 a[8:11], v6 offset:19008
    ds_read_b128 a[12:15], v6 offset:20064
    s_waitcnt lgkmcnt(3)
    s_mov_b32 s36, 114688
    buffer_store_dwordx4 a[0:3], v7, s[16:19], s36 offen sc1
    s_waitcnt lgkmcnt(2)
    s_mov_b32 s36, 115712
    buffer_store_dwordx4 a[4:7], v7, s[16:19], s36 offen sc1
    s_waitcnt lgkmcnt(1)
    s_mov_b32 s36, 116736
    buffer_store_dwordx4 a[8:11], v7, s[16:19], s36 offen sc1
    s_waitcnt lgkmcnt(0)
    s_mov_b32 s36, 117760
    buffer_store_dwordx4 a[12:15], v7, s[16:19], s36 offen sc1
    s_endpgm
L_joint_kernel_done:
    s_endpgm
.section .rodata,"a"
.p2align 6
.amdhsa_kernel prep_kernel
  .amdhsa_next_free_vgpr 128
  .amdhsa_next_free_sgpr 102
  .amdhsa_accum_offset 128
  .amdhsa_group_segment_fixed_size 0
  .amdhsa_kernarg_size 80
  .amdhsa_user_sgpr_count 2
  .amdhsa_user_sgpr_kernarg_segment_ptr 1
  .amdhsa_system_sgpr_workgroup_id_x 1
.end_amdhsa_kernel
.p2align 6
.amdhsa_kernel gemm1_kernel
  .amdhsa_next_free_vgpr 232
  .amdhsa_next_free_sgpr 102
  .amdhsa_accum_offset 232
  .amdhsa_group_segment_fixed_size 0
  .amdhsa_kernarg_size 80
  .amdhsa_user_sgpr_count 2
  .amdhsa_user_sgpr_kernarg_segment_ptr 1
  .amdhsa_system_sgpr_workgroup_id_x 1
.end_amdhsa_kernel
.p2align 6
.amdhsa_kernel mid_kernel
  .amdhsa_next_free_vgpr 128
  .amdhsa_next_free_sgpr 102
  .amdhsa_accum_offset 128
  .amdhsa_group_segment_fixed_size 0
  .amdhsa_kernarg_size 80
  .amdhsa_user_sgpr_count 2
  .amdhsa_user_sgpr_kernarg_segment_ptr 1
  .amdhsa_system_sgpr_workgroup_id_x 1
.end_amdhsa_kernel
.p2align 6
.amdhsa_kernel gemm2_kernel
  .amdhsa_next_free_vgpr 152
  .amdhsa_next_free_sgpr 102
  .amdhsa_accum_offset 152
  .amdhsa_group_segment_fixed_size 0
  .amdhsa_kernarg_size 80
  .amdhsa_user_sgpr_count 2
  .amdhsa_user_sgpr_kernarg_segment_ptr 1
  .amdhsa_system_sgpr_workgroup_id_x 1
.end_amdhsa_kernel
.p2align 6
.amdhsa_kernel joint_kernel
  .amdhsa_next_free_vgpr 256
  .amdhsa_next_free_sgpr 102
  .amdhsa_accum_offset 128
  .amdhsa_group_segment_fixed_size 0
  .amdhsa_kernarg_size 80
  .amdhsa_user_sgpr_count 2
  .amdhsa_user_sgpr_kernarg_segment_ptr 1
  .amdhsa_system_sgpr_workgroup_id_x 1
.end_amdhsa_kernel
```

```asm
; @launch kernel=prep_kernel grid=(941,1,1) block=(256,1,1) lds=40960
; @launch kernel=gemm1_kernel grid=(256,1,1) block=(512,1,1) lds=143360
; @launch kernel=mid_kernel grid=(704,1,1) block=(256,1,1) lds=53248
; @launch kernel=gemm2_kernel grid=(256,1,1) block=(512,1,1) lds=143360
; @launch kernel=joint_kernel grid=(256,1,1) block=(512,1,1) lds=149504
.amdgcn_target "amdgcn-amd-amdhsa--gfx950"
.text
.globl prep_kernel
.p2align 8
.type prep_kernel,@function
prep_kernel:
    s_cmp_ge_u32 s2, 941
    s_cbranch_scc1 L_prep_kernel_done
    v_readfirstlane_b32 s20, v0
    s_lshr_b32 s20, s20, 6
    s_cmp_lt_u32 s2, 13
    s_cbranch_scc1 L_prep_kernel_slab
    s_cmp_lt_u32 s2, 269
    s_cbranch_scc1 L_prep_kernel_g
    s_load_dwordx2 s[4:5], s[0:1], 0
    s_load_dwordx2 s[6:7], s[0:1], 72
    s_sub_u32 s24, s2, 269
    s_and_b32 s25, s24, 7
    s_mul_i32 s25, s25, 84
    s_lshr_b32 s24, s24, 3
    s_add_u32 s24, s24, s25
    s_cmp_ge_u32 s24, 668
    s_cbranch_scc1 L_prep_kernel_done
    s_mul_hi_u32 s25, s24, 25718368
    s_mul_i32 s26, s25, 167
    s_sub_u32 s26, s24, s26
    s_and_b32 s27, s25, 1
    s_lshr_b32 s25, s25, 1
    v_and_b32 v1, 63, v0
    v_lshrrev_b32 v2, 3, v1
    s_mul_i32 s28, s26, 96
    s_add_u32 s28, s28, s27
    s_sub_u32 s28, s28, 15
    v_lshlrev_b32 v3, 1, v2
    v_add_u32 v3, s28, v3
    v_lshlrev_b32 v3, 9, v3
    s_lshl_b32 s29, s20, 7
    v_add_u32 v3, s29, v3
    v_bfe_u32 v4, v2, 1, 1
    v_lshlrev_b32 v4, 1, v4
    v_and_b32 v5, 7, v1
    v_xor_b32 v4, v4, v5
    v_lshl_add_u32 v3, v4, 4, v3
    v_xor_b32 v4, 64, v3
    s_waitcnt lgkmcnt(0)
    s_mul_i32 s30, s25, 8192000
    s_add_u32 s8, s4, s30
    s_addc_u32 s9, s5, 0
    s_mov_b32 s10, 8192000
    s_mov_b32 s11, 0x00020000
    s_lshl_b32 s31, s20, 13
    s_add_u32 m0, s31, 0
    v_add_u32 v5, 0, v3
    buffer_load_dwordx4 v5, s[8:11], 0 offen nt lds
    s_add_u32 m0, s31, 1024
    v_add_u32 v5, 8192, v4
    buffer_load_dwordx4 v5, s[8:11], 0 offen nt lds
    s_add_u32 m0, s31, 2048
    v_add_u32 v5, 16384, v3
    buffer_load_dwordx4 v5, s[8:11], 0 offen nt lds
    s_add_u32 m0, s31, 3072
    v_add_u32 v5, 24576, v4
    buffer_load_dwordx4 v5, s[8:11], 0 offen nt lds
    s_add_u32 m0, s31, 4096
    v_add_u32 v5, 32768, v3
    buffer_load_dwordx4 v5, s[8:11], 0 offen nt lds
    s_add_u32 m0, s31, 5120
    v_add_u32 v5, 40960, v4
    buffer_load_dwordx4 v5, s[8:11], 0 offen nt lds
    s_add_u32 m0, s31, 6144
    v_add_u32 v5, 49152, v3
    buffer_load_dwordx4 v5, s[8:11], 0 offen nt lds
    s_add_u32 m0, s31, 7168
    v_add_u32 v5, 57344, v4
    buffer_load_dwordx4 v5, s[8:11], 0 offen nt lds
    s_add_u32 s12, s6, 0
    s_addc_u32 s13, s7, 0
    s_mov_b32 s14, 21889024
    s_mov_b32 s15, 0x00020000
    v_mov_b32 v8, v1
    s_lshl_b32 s32, s20, 4
    v_lshlrev_b32 v6, 4, v1
    s_lshl_b32 s33, s20, 11
    v_add_u32 v7, s33, v6
    v_and_b32 v9, 15, v8
    v_lshrrev_b32 v10, 4, v8
    v_or_b32 v11, 1, v9
    v_add_u32 v11, s32, v11
    v_cvt_f32_u32 v11, v11
    v_mul_f32 v11, 0x3c000000, v11
    v_lshlrev_b32 v10, 3, v10
    v_add_u32 v10, 0, v10
    v_cvt_f32_u32 v10, v10
    v_and_b32 v9, 1, v9
    v_cvt_f32_u32 v9, v9
    v_mul_f32 v9, 0x3e800000, v9
    v_fma_f32 v12, v11, v10, v9
    v_fract_f32 v13, v12
    v_add_f32 v12, v12, v11
    v_fract_f32 v14, v12
    v_add_f32 v12, v12, v11
    v_fract_f32 v15, v12
    v_add_f32 v12, v12, v11
    v_fract_f32 v16, v12
    v_add_f32 v12, v12, v11
    v_fract_f32 v17, v12
    v_add_f32 v12, v12, v11
    v_fract_f32 v18, v12
    v_add_f32 v12, v12, v11
    v_fract_f32 v19, v12
    v_add_f32 v12, v12, v11
    v_fract_f32 v20, v12
    v_cos_f32 v13, v13
    v_cos_f32 v14, v14
    v_cos_f32 v15, v15
    v_cos_f32 v16, v16
    v_cos_f32 v17, v17
    v_cos_f32 v18, v18
    v_cos_f32 v19, v19
    v_cos_f32 v20, v20
    s_nop 0
    v_cvt_pk_bf16_f32 v24, v13, v14
    v_cvt_pk_bf16_f32 v25, v15, v16
    v_cvt_pk_bf16_f32 v26, v17, v18
    v_cvt_pk_bf16_f32 v27, v19, v20
    ds_write_b128 v7, v[24:27] offset:32768
    v_and_b32 v9, 15, v8
    v_lshrrev_b32 v10, 4, v8
    v_or_b32 v11, 1, v9
    v_add_u32 v11, s32, v11
    v_cvt_f32_u32 v11, v11
    v_mul_f32 v11, 0x3c000000, v11
    v_lshlrev_b32 v10, 3, v10
    v_add_u32 v10, 32, v10
    v_cvt_f32_u32 v10, v10
    v_and_b32 v9, 1, v9
    v_cvt_f32_u32 v9, v9
    v_mul_f32 v9, 0x3e800000, v9
    v_fma_f32 v12, v11, v10, v9
    v_fract_f32 v13, v12
    v_add_f32 v12, v12, v11
    v_fract_f32 v14, v12
    v_add_f32 v12, v12, v11
    v_fract_f32 v15, v12
    v_add_f32 v12, v12, v11
    v_fract_f32 v16, v12
    v_add_f32 v12, v12, v11
    v_fract_f32 v17, v12
    v_add_f32 v12, v12, v11
    v_fract_f32 v18, v12
    v_add_f32 v12, v12, v11
    v_fract_f32 v19, v12
    v_add_f32 v12, v12, v11
    v_fract_f32 v20, v12
    v_cos_f32 v13, v13
    v_cos_f32 v14, v14
    v_cos_f32 v15, v15
    v_cos_f32 v16, v16
    v_cos_f32 v17, v17
    v_cos_f32 v18, v18
    v_cos_f32 v19, v19
    v_cos_f32 v20, v20
    s_nop 0
    v_cvt_pk_bf16_f32 v28, v13, v14
    v_cvt_pk_bf16_f32 v29, v15, v16
    v_cvt_pk_bf16_f32 v30, v17, v18
    v_cvt_pk_bf16_f32 v31, v19, v20
    ds_write_b128 v7, v[28:31] offset:33792
    v_bfe_u32 v8, v1, 2, 2
    v_lshrrev_b32 v9, 4, v1
    v_lshl_add_u32 v10, v9, 3, v8
    v_lshlrev_b32 v10, 7, v10
    v_lshrrev_b32 v8, 1, v8
    v_and_b32 v11, 1, v9
    v_lshl_add_u32 v8, v11, 1, v8
    v_lshlrev_b32 v8, 1, v8
    v_bfe_u32 v11, v1, 1, 1
    v_xor_b32 v8, v8, v11
    v_lshl_add_u32 v10, v8, 4, v10
    v_and_b32 v11, 1, v1
    v_lshl_add_u32 v10, v11, 3, v10
    v_add_u32 v10, s31, v10
    v_xor_b32 v12, 0, v10
    v_xor_b32 v13, 32, v10
    v_xor_b32 v14, 64, v10
    v_xor_b32 v15, 96, v10
    v_bfe_u32 v8, v1, 1, 3
    s_mov_b32 s33, 684032
    v_mul_lo_u32 v8, v8, s33
    v_and_b32 v11, 1, v1
    v_lshl_add_u32 v8, v11, 6, v8
    v_lshl_add_u32 v16, v9, 4, v8
    s_mul_i32 s34, s25, 167
    s_add_u32 s34, s34, s26
    s_lshl_b32 s34, s34, 11
    s_lshl_b32 s35, s27, 3
    s_lshl_b32 s36, s20, 1
    s_add_u32 s35, s35, s36
    s_lshl_b32 s35, s35, 7
    s_add_u32 s34, s34, s35
    s_waitcnt lgkmcnt(0)
    s_barrier
    ds_read_b128 v[24:27], v6 offset:32768
    ds_read_b128 v[28:31], v6 offset:33792
    ds_read_b128 v[32:35], v6 offset:34816
    ds_read_b128 v[36:39], v6 offset:35840
    ds_read_b128 v[40:43], v6 offset:36864
    ds_read_b128 v[44:47], v6 offset:37888
    ds_read_b128 v[48:51], v6 offset:38912
    ds_read_b128 v[52:55], v6 offset:39936
    s_waitcnt vmcnt(0)
    ds_read_b64_tr_b16 v[56:57], v12 offset:0
    ds_read_b64_tr_b16 v[58:59], v12 offset:512
    ds_read_b64_tr_b16 v[60:61], v12 offset:4096
    ds_read_b64_tr_b16 v[62:63], v12 offset:4608
    ds_read_b64_tr_b16 v[64:65], v13 offset:0
    ds_read_b64_tr_b16 v[66:67], v13 offset:512
    ds_read_b64_tr_b16 v[68:69], v13 offset:4096
    ds_read_b64_tr_b16 v[70:71], v13 offset:4608
    s_waitcnt lgkmcnt(0)
    v_mfma_f32_16x16x32_bf16 v[72:75], v[56:59], v[24:27], 0
    v_mfma_f32_16x16x32_bf16 v[76:79], v[56:59], v[32:35], 0
    v_mfma_f32_16x16x32_bf16 v[80:83], v[56:59], v[40:43], 0
    v_mfma_f32_16x16x32_bf16 v[84:87], v[56:59], v[48:51], 0
    v_mfma_f32_16x16x32_bf16 v[88:91], v[64:67], v[24:27], 0
    v_mfma_f32_16x16x32_bf16 v[92:95], v[64:67], v[32:35], 0
    v_mfma_f32_16x16x32_bf16 v[96:99], v[64:67], v[40:43], 0
    v_mfma_f32_16x16x32_bf16 v[100:103], v[64:67], v[48:51], 0
    v_mfma_f32_16x16x32_bf16 v[72:75], v[60:63], v[28:31], v[72:75]
    v_mfma_f32_16x16x32_bf16 v[76:79], v[60:63], v[36:39], v[76:79]
    v_mfma_f32_16x16x32_bf16 v[80:83], v[60:63], v[44:47], v[80:83]
    v_mfma_f32_16x16x32_bf16 v[84:87], v[60:63], v[52:55], v[84:87]
    v_mfma_f32_16x16x32_bf16 v[88:91], v[68:71], v[28:31], v[88:91]
    v_mfma_f32_16x16x32_bf16 v[92:95], v[68:71], v[36:39], v[92:95]
    v_mfma_f32_16x16x32_bf16 v[96:99], v[68:71], v[44:47], v[96:99]
    v_mfma_f32_16x16x32_bf16 v[100:103], v[68:71], v[52:55], v[100:103]
    s_nop 7
    v_cvt_pk_bf16_f32 v104, v72, v73
    v_cvt_pk_bf16_f32 v105, v74, v75
    v_cvt_pk_bf16_f32 v106, v88, v89
    v_cvt_pk_bf16_f32 v107, v90, v91
    s_add_u32 s35, s34, 0
    buffer_store_dwordx4 v[104:107], v16, s[12:15], s35 offen sc1
    s_nop 1
    v_cvt_pk_bf16_f32 v108, v76, v77
    v_cvt_pk_bf16_f32 v109, v78, v79
    v_cvt_pk_bf16_f32 v110, v92, v93
    v_cvt_pk_bf16_f32 v111, v94, v95
    s_add_u32 s35, s34, 5472256
    buffer_store_dwordx4 v[108:111], v16, s[12:15], s35 offen sc1
    s_nop 1
    v_cvt_pk_bf16_f32 v104, v80, v81
    v_cvt_pk_bf16_f32 v105, v82, v83
    v_cvt_pk_bf16_f32 v106, v96, v97
    v_cvt_pk_bf16_f32 v107, v98, v99
    s_add_u32 s35, s34, 10944512
    buffer_store_dwordx4 v[104:107], v16, s[12:15], s35 offen sc1
    s_nop 1
    v_cvt_pk_bf16_f32 v108, v84, v85
    v_cvt_pk_bf16_f32 v109, v86, v87
    v_cvt_pk_bf16_f32 v110, v100, v101
    v_cvt_pk_bf16_f32 v111, v102, v103
    s_add_u32 s35, s34, 16416768
    buffer_store_dwordx4 v[108:111], v16, s[12:15], s35 offen sc1
    s_nop 1
    ds_read_b64_tr_b16 v[56:57], v14 offset:0
    ds_read_b64_tr_b16 v[58:59], v14 offset:512
    ds_read_b64_tr_b16 v[60:61], v14 offset:4096
    ds_read_b64_tr_b16 v[62:63], v14 offset:4608
    ds_read_b64_tr_b16 v[64:65], v15 offset:0
    ds_read_b64_tr_b16 v[66:67], v15 offset:512
    ds_read_b64_tr_b16 v[68:69], v15 offset:4096
    ds_read_b64_tr_b16 v[70:71], v15 offset:4608
    s_waitcnt lgkmcnt(0)
    v_mfma_f32_16x16x32_bf16 v[72:75], v[56:59], v[24:27], 0
    v_mfma_f32_16x16x32_bf16 v[76:79], v[56:59], v[32:35], 0
    v_mfma_f32_16x16x32_bf16 v[80:83], v[56:59], v[40:43], 0
    v_mfma_f32_16x16x32_bf16 v[84:87], v[56:59], v[48:51], 0
    v_mfma_f32_16x16x32_bf16 v[88:91], v[64:67], v[24:27], 0
    v_mfma_f32_16x16x32_bf16 v[92:95], v[64:67], v[32:35], 0
    v_mfma_f32_16x16x32_bf16 v[96:99], v[64:67], v[40:43], 0
    v_mfma_f32_16x16x32_bf16 v[100:103], v[64:67], v[48:51], 0
    v_mfma_f32_16x16x32_bf16 v[72:75], v[60:63], v[28:31], v[72:75]
    v_mfma_f32_16x16x32_bf16 v[76:79], v[60:63], v[36:39], v[76:79]
    v_mfma_f32_16x16x32_bf16 v[80:83], v[60:63], v[44:47], v[80:83]
    v_mfma_f32_16x16x32_bf16 v[84:87], v[60:63], v[52:55], v[84:87]
    v_mfma_f32_16x16x32_bf16 v[88:91], v[68:71], v[28:31], v[88:91]
    v_mfma_f32_16x16x32_bf16 v[92:95], v[68:71], v[36:39], v[92:95]
    v_mfma_f32_16x16x32_bf16 v[96:99], v[68:71], v[44:47], v[96:99]
    v_mfma_f32_16x16x32_bf16 v[100:103], v[68:71], v[52:55], v[100:103]
    s_nop 7
    v_cvt_pk_bf16_f32 v104, v72, v73
    v_cvt_pk_bf16_f32 v105, v74, v75
    v_cvt_pk_bf16_f32 v106, v88, v89
    v_cvt_pk_bf16_f32 v107, v90, v91
    s_add_u32 s35, s34, 128
    buffer_store_dwordx4 v[104:107], v16, s[12:15], s35 offen sc1
    s_nop 1
    v_cvt_pk_bf16_f32 v108, v76, v77
    v_cvt_pk_bf16_f32 v109, v78, v79
    v_cvt_pk_bf16_f32 v110, v92, v93
    v_cvt_pk_bf16_f32 v111, v94, v95
    s_add_u32 s35, s34, 5472384
    buffer_store_dwordx4 v[108:111], v16, s[12:15], s35 offen sc1
    s_nop 1
    v_cvt_pk_bf16_f32 v104, v80, v81
    v_cvt_pk_bf16_f32 v105, v82, v83
    v_cvt_pk_bf16_f32 v106, v96, v97
    v_cvt_pk_bf16_f32 v107, v98, v99
    s_add_u32 s35, s34, 10944640
    buffer_store_dwordx4 v[104:107], v16, s[12:15], s35 offen sc1
    s_nop 1
    v_cvt_pk_bf16_f32 v108, v84, v85
    v_cvt_pk_bf16_f32 v109, v86, v87
    v_cvt_pk_bf16_f32 v110, v100, v101
    v_cvt_pk_bf16_f32 v111, v102, v103
    s_add_u32 s35, s34, 16416896
    buffer_store_dwordx4 v[108:111], v16, s[12:15], s35 offen sc1
    s_nop 1
    s_endpgm
L_prep_kernel_g:
    s_sub_u32 s3, s2, 13
    s_load_dwordx2 s[4:5], s[0:1], 8
    s_load_dwordx2 s[6:7], s[0:1], 72
    s_lshr_b32 s24, s3, 4
    s_bfe_u32 s25, s3, 0x20002
    s_and_b32 s26, s3, 3
    s_lshr_b32 s27, s24, 3
    s_and_b32 s28, s24, 7
    v_and_b32 v1, 63, v0
    v_lshrrev_b32 v2, 3, v1
    v_lshrrev_b32 v3, 2, v2
    v_lshlrev_b32 v3, 4, v3
    v_and_b32 v4, 3, v2
    v_add_u32 v3, v3, v4
    s_lshl_b32 s29, s25, 2
    s_lshl_b32 s30, s28, 5
    s_add_u32 s29, s29, s30
    v_add_u32 v3, s29, v3
    v_lshlrev_b32 v3, 9, v3
    v_and_b32 v4, 7, v1
    s_lshr_b32 s30, s20, 1
    s_lshl_b32 s30, s30, 2
    v_xor_b32 v4, s30, v4
    v_lshl_add_u32 v3, v4, 4, v3
    s_lshl_b32 s30, s26, 7
    v_add_u32 v3, s30, v3
    v_xor_b32 v4, 32, v3
    s_waitcnt lgkmcnt(0)
    s_mov_b32 s8, s4
    s_mov_b32 s9, s5
    s_mov_b32 s10, 4063232
    s_mov_b32 s11, 0x00020000
    s_add_u32 s12, s6, 21954560
    s_addc_u32 s13, s7, 0
    s_mov_b32 s14, 16916480
    s_mov_b32 s15, 0x00020000
    s_lshl_b32 s30, s20, 3
    s_add_u32 s30, s30, s27
    s_lshl_b32 s30, s30, 17
    s_mul_i32 s31, s20, 4608
    s_add_u32 m0, s31, 0
    s_add_u32 s32, s30, 0
    buffer_load_dwordx4 v3, s[8:11], s32 offen nt lds
    s_add_u32 m0, s31, 1152
    s_add_u32 s32, s30, 262144
    buffer_load_dwordx4 v3, s[8:11], s32 offen nt lds
    s_add_u32 m0, s31, 2304
    s_add_u32 s32, s30, 524288
    buffer_load_dwordx4 v4, s[8:11], s32 offen nt lds
    s_add_u32 m0, s31, 3456
    s_add_u32 s32, s30, 786432
    buffer_load_dwordx4 v4, s[8:11], s32 offen nt lds
    v_and_b32 v8, 15, v1
    v_or_b32 v9, 1, v8
    s_lshl_b32 s33, s20, 4
    v_add_u32 v9, s33, v9
    v_cvt_f32_u32 v9, v9
    v_mul_f32 v9, 0x3c000000, v9
    v_bfe_u32 v10, v1, 4, 1
    v_lshlrev_b32 v10, 3, v10
    v_cvt_f32_u32 v10, v10
    v_and_b32 v8, 1, v8
    v_cvt_f32_u32 v8, v8
    v_mul_f32 v8, 0x3f400000, v8
    v_fma_f32 v11, v9, v10, v8
    v_fract_f32 v12, v11
    v_add_f32 v11, v11, v9
    v_fract_f32 v13, v11
    v_add_f32 v11, v11, v9
    v_fract_f32 v14, v11
    v_add_f32 v11, v11, v9
    v_fract_f32 v15, v11
    v_add_f32 v11, v11, v9
    v_fract_f32 v16, v11
    v_add_f32 v11, v11, v9
    v_fract_f32 v17, v11
    v_add_f32 v11, v11, v9
    v_fract_f32 v18, v11
    v_add_f32 v11, v11, v9
    v_fract_f32 v19, v11
    v_cos_f32 v12, v12
    v_cos_f32 v13, v13
    v_cos_f32 v14, v14
    v_cos_f32 v15, v15
    v_cos_f32 v16, v16
    v_cos_f32 v17, v17
    v_cos_f32 v18, v18
    v_cos_f32 v19, v19
    s_nop 0
    v_mul_f32 v12, 0x3d000000, v12
    v_mul_f32 v13, 0x3d000000, v13
    v_mul_f32 v14, 0x3d000000, v14
    v_mul_f32 v15, 0x3d000000, v15
    v_mul_f32 v16, 0x3d000000, v16
    v_mul_f32 v17, 0x3d000000, v17
    v_mul_f32 v18, 0x3d000000, v18
    v_mul_f32 v19, 0x3d000000, v19
    v_cvt_pk_bf16_f32 v20, v12, v13
    v_cvt_pk_bf16_f32 v21, v14, v15
    v_cvt_pk_bf16_f32 v22, v16, v17
    v_cvt_pk_bf16_f32 v23, v18, v19
    v_lshlrev_b32 v28, 16, v20
    v_and_b32 v29, 0xffff0000, v20
    v_sub_f32 v28, v12, v28
    v_sub_f32 v29, v13, v29
    v_cvt_pk_bf16_f32 v24, v28, v29
    v_lshlrev_b32 v28, 16, v21
    v_and_b32 v29, 0xffff0000, v21
    v_sub_f32 v28, v14, v28
    v_sub_f32 v29, v15, v29
    v_cvt_pk_bf16_f32 v25, v28, v29
    v_lshlrev_b32 v28, 16, v22
    v_and_b32 v29, 0xffff0000, v22
    v_sub_f32 v28, v16, v28
    v_sub_f32 v29, v17, v29
    v_cvt_pk_bf16_f32 v26, v28, v29
    v_lshlrev_b32 v28, 16, v23
    v_and_b32 v29, 0xffff0000, v23
    v_sub_f32 v28, v18, v28
    v_sub_f32 v29, v19, v29
    v_cvt_pk_bf16_f32 v27, v28, v29
    v_cmp_gt_u32 vcc, 32, v1
    s_nop 1
    v_cndmask_b32 v20, v24, v20, vcc
    v_cndmask_b32 v21, v25, v21, vcc
    v_cndmask_b32 v22, v26, v22, vcc
    v_cndmask_b32 v23, v27, v23, vcc
    v_lshlrev_b32 v28, 4, v1
    s_lshl_b32 s33, s20, 10
    v_add_u32 v29, s33, v28
    ds_write_b128 v29, v[20:23] offset:18432
    v_bfe_u32 v30, v1, 2, 2
    v_bfe_u32 v31, v1, 4, 1
    v_lshl_add_u32 v32, v31, 3, v30
    v_mul_u32_u24 v32, 1152, v32
    v_lshrrev_b32 v30, 1, v30
    v_lshl_add_u32 v30, v31, 1, v30
    v_lshlrev_b32 v30, 1, v30
    v_bfe_u32 v31, v1, 1, 1
    s_lshl_b32 s33, s20, 1
    v_add_u32 v31, s33, v31
    v_xor_b32 v30, v30, v31
    v_lshl_add_u32 v32, v30, 4, v32
    v_and_b32 v30, 1, v1
    v_lshl_add_u32 v32, v30, 3, v32
    v_lshrrev_b32 v30, 4, v1
    s_mov_b32 s33, 1057280
    v_mul_lo_u32 v30, v30, s33
    v_and_b32 v31, 15, v1
    v_lshl_add_u32 v33, v31, 4, v30
    s_lshl_b32 s34, s24, 15
    s_lshl_b32 s35, s26, 2
    s_add_u32 s35, s35, s20
    s_lshl_b32 s35, s35, 11
    s_add_u32 s34, s34, s35
    s_lshl_b32 s35, s25, 8
    s_add_u32 s34, s34, s35
    s_waitcnt vmcnt(0) lgkmcnt(0)
    s_barrier
    ds_read_b128 v[36:39], v28 offset:18432
    ds_read_b128 v[40:43], v28 offset:19456
    ds_read_b128 v[44:47], v28 offset:20480
    ds_read_b128 v[48:51], v28 offset:21504
    ds_read_b64_tr_b16 v[52:53], v32 offset:0
    ds_read_b64_tr_b16 v[54:55], v32 offset:4608
    ds_read_b64_tr_b16 v[56:57], v32 offset:128
    ds_read_b64_tr_b16 v[58:59], v32 offset:4736
    ds_read_b64_tr_b16 v[60:61], v32 offset:256
    ds_read_b64_tr_b16 v[62:63], v32 offset:4864
    ds_read_b64_tr_b16 v[64:65], v32 offset:384
    ds_read_b64_tr_b16 v[66:67], v32 offset:4992
    ds_read_b64_tr_b16 v[68:69], v32 offset:512
    ds_read_b64_tr_b16 v[70:71], v32 offset:5120
    s_waitcnt lgkmcnt(8)
    ds_read_b64_tr_b16 v[72:73], v32 offset:640
    ds_read_b64_tr_b16 v[74:75], v32 offset:5248
    ds_read_b64_tr_b16 v[76:77], v32 offset:768
    ds_read_b64_tr_b16 v[78:79], v32 offset:5376
    ds_read_b64_tr_b16 v[80:81], v32 offset:896
    ds_read_b64_tr_b16 v[82:83], v32 offset:5504
    s_waitcnt lgkmcnt(0)
    v_mfma_f32_16x16x32_bf16 v[84:87], v[36:39], v[52:55], 0
    v_mfma_f32_16x16x32_bf16 v[88:91], v[36:39], v[56:59], 0
    v_mfma_f32_16x16x32_bf16 v[92:95], v[36:39], v[60:63], 0
    v_mfma_f32_16x16x32_bf16 v[96:99], v[36:39], v[64:67], 0
    v_mfma_f32_16x16x32_bf16 v[100:103], v[36:39], v[68:71], 0
    v_mfma_f32_16x16x32_bf16 v[104:107], v[36:39], v[72:75], 0
    v_mfma_f32_16x16x32_bf16 v[108:111], v[36:39], v[76:79], 0
    v_mfma_f32_16x16x32_bf16 v[112:115], v[36:39], v[80:83], 0
    s_nop 7
    v_cvt_pk_bf16_f32 v116, v84, v88
    v_cvt_pk_bf16_f32 v117, v92, v96
    v_cvt_pk_bf16_f32 v118, v100, v104
    v_cvt_pk_bf16_f32 v119, v108, v112
    s_add_u32 s35, s34, 0
    buffer_store_dwordx4 v[116:119], v33, s[12:15], s35 offen sc1
    s_nop 1
    v_cvt_pk_bf16_f32 v120, v85, v89
    v_cvt_pk_bf16_f32 v121, v93, v97
    v_cvt_pk_bf16_f32 v122, v101, v105
    v_cvt_pk_bf16_f32 v123, v109, v113
    s_add_u32 s35, s34, 1024
    buffer_store_dwordx4 v[120:123], v33, s[12:15], s35 offen sc1
    s_nop 1
    v_cvt_pk_bf16_f32 v116, v86, v90
    v_cvt_pk_bf16_f32 v117, v94, v98
    v_cvt_pk_bf16_f32 v118, v102, v106
    v_cvt_pk_bf16_f32 v119, v110, v114
    s_add_u32 s35, s34, 528640
    buffer_store_dwordx4 v[116:119], v33, s[12:15], s35 offen sc1
    s_nop 1
    v_cvt_pk_bf16_f32 v120, v87, v91
    v_cvt_pk_bf16_f32 v121, v95, v99
    v_cvt_pk_bf16_f32 v122, v103, v107
    v_cvt_pk_bf16_f32 v123, v111, v115
    s_add_u32 s35, s34, 529664
    buffer_store_dwordx4 v[120:123], v33, s[12:15], s35 offen sc1
    s_nop 1
    v_mfma_f32_16x16x32_bf16 v[84:87], v[40:43], v[52:55], 0
    v_mfma_f32_16x16x32_bf16 v[88:91], v[40:43], v[56:59], 0
    v_mfma_f32_16x16x32_bf16 v[92:95], v[40:43], v[60:63], 0
    v_mfma_f32_16x16x32_bf16 v[96:99], v[40:43], v[64:67], 0
    v_mfma_f32_16x16x32_bf16 v[100:103], v[40:43], v[68:71], 0
    v_mfma_f32_16x16x32_bf16 v[104:107], v[40:43], v[72:75], 0
    v_mfma_f32_16x16x32_bf16 v[108:111], v[40:43], v[76:79], 0
    v_mfma_f32_16x16x32_bf16 v[112:115], v[40:43], v[80:83], 0
    s_nop 7
    v_cvt_pk_bf16_f32 v116, v84, v88
    v_cvt_pk_bf16_f32 v117, v92, v96
    v_cvt_pk_bf16_f32 v118, v100, v104
    v_cvt_pk_bf16_f32 v119, v108, v112
    s_add_u32 s35, s34, 4229120
    buffer_store_dwordx4 v[116:119], v33, s[12:15], s35 offen sc1
    s_nop 1
    v_cvt_pk_bf16_f32 v120, v85, v89
    v_cvt_pk_bf16_f32 v121, v93, v97
    v_cvt_pk_bf16_f32 v122, v101, v105
    v_cvt_pk_bf16_f32 v123, v109, v113
    s_add_u32 s35, s34, 4230144
    buffer_store_dwordx4 v[120:123], v33, s[12:15], s35 offen sc1
    s_nop 1
    v_cvt_pk_bf16_f32 v116, v86, v90
    v_cvt_pk_bf16_f32 v117, v94, v98
    v_cvt_pk_bf16_f32 v118, v102, v106
    v_cvt_pk_bf16_f32 v119, v110, v114
    s_add_u32 s35, s34, 4757760
    buffer_store_dwordx4 v[116:119], v33, s[12:15], s35 offen sc1
    s_nop 1
    v_cvt_pk_bf16_f32 v120, v87, v91
    v_cvt_pk_bf16_f32 v121, v95, v99
    v_cvt_pk_bf16_f32 v122, v103, v107
    v_cvt_pk_bf16_f32 v123, v111, v115
    s_add_u32 s35, s34, 4758784
    buffer_store_dwordx4 v[120:123], v33, s[12:15], s35 offen sc1
    s_nop 1
    v_mfma_f32_16x16x32_bf16 v[84:87], v[44:47], v[52:55], 0
    v_mfma_f32_16x16x32_bf16 v[88:91], v[44:47], v[56:59], 0
    v_mfma_f32_16x16x32_bf16 v[92:95], v[44:47], v[60:63], 0
    v_mfma_f32_16x16x32_bf16 v[96:99], v[44:47], v[64:67], 0
    v_mfma_f32_16x16x32_bf16 v[100:103], v[44:47], v[68:71], 0
    v_mfma_f32_16x16x32_bf16 v[104:107], v[44:47], v[72:75], 0
    v_mfma_f32_16x16x32_bf16 v[108:111], v[44:47], v[76:79], 0
    v_mfma_f32_16x16x32_bf16 v[112:115], v[44:47], v[80:83], 0
    s_nop 7
    v_cvt_pk_bf16_f32 v116, v84, v88
    v_cvt_pk_bf16_f32 v117, v92, v96
    v_cvt_pk_bf16_f32 v118, v100, v104
    v_cvt_pk_bf16_f32 v119, v108, v112
    s_add_u32 s35, s34, 8458240
    buffer_store_dwordx4 v[116:119], v33, s[12:15], s35 offen sc1
    s_nop 1
    v_cvt_pk_bf16_f32 v120, v85, v89
    v_cvt_pk_bf16_f32 v121, v93, v97
    v_cvt_pk_bf16_f32 v122, v101, v105
    v_cvt_pk_bf16_f32 v123, v109, v113
    s_add_u32 s35, s34, 8459264
    buffer_store_dwordx4 v[120:123], v33, s[12:15], s35 offen sc1
    s_nop 1
    v_cvt_pk_bf16_f32 v116, v86, v90
    v_cvt_pk_bf16_f32 v117, v94, v98
    v_cvt_pk_bf16_f32 v118, v102, v106
    v_cvt_pk_bf16_f32 v119, v110, v114
    s_add_u32 s35, s34, 8986880
    buffer_store_dwordx4 v[116:119], v33, s[12:15], s35 offen sc1
    s_nop 1
    v_cvt_pk_bf16_f32 v120, v87, v91
    v_cvt_pk_bf16_f32 v121, v95, v99
    v_cvt_pk_bf16_f32 v122, v103, v107
    v_cvt_pk_bf16_f32 v123, v111, v115
    s_add_u32 s35, s34, 8987904
    buffer_store_dwordx4 v[120:123], v33, s[12:15], s35 offen sc1
    s_nop 1
    v_mfma_f32_16x16x32_bf16 v[84:87], v[48:51], v[52:55], 0
    v_mfma_f32_16x16x32_bf16 v[88:91], v[48:51], v[56:59], 0
    v_mfma_f32_16x16x32_bf16 v[92:95], v[48:51], v[60:63], 0
    v_mfma_f32_16x16x32_bf16 v[96:99], v[48:51], v[64:67], 0
    v_mfma_f32_16x16x32_bf16 v[100:103], v[48:51], v[68:71], 0
    v_mfma_f32_16x16x32_bf16 v[104:107], v[48:51], v[72:75], 0
    v_mfma_f32_16x16x32_bf16 v[108:111], v[48:51], v[76:79], 0
    v_mfma_f32_16x16x32_bf16 v[112:115], v[48:51], v[80:83], 0
    s_nop 7
    v_cvt_pk_bf16_f32 v116, v84, v88
    v_cvt_pk_bf16_f32 v117, v92, v96
    v_cvt_pk_bf16_f32 v118, v100, v104
    v_cvt_pk_bf16_f32 v119, v108, v112
    s_add_u32 s35, s34, 12687360
    buffer_store_dwordx4 v[116:119], v33, s[12:15], s35 offen sc1
    s_nop 1
    v_cvt_pk_bf16_f32 v120, v85, v89
    v_cvt_pk_bf16_f32 v121, v93, v97
    v_cvt_pk_bf16_f32 v122, v101, v105
    v_cvt_pk_bf16_f32 v123, v109, v113
    s_add_u32 s35, s34, 12688384
    buffer_store_dwordx4 v[120:123], v33, s[12:15], s35 offen sc1
    s_nop 1
    v_cvt_pk_bf16_f32 v116, v86, v90
    v_cvt_pk_bf16_f32 v117, v94, v98
    v_cvt_pk_bf16_f32 v118, v102, v106
    v_cvt_pk_bf16_f32 v119, v110, v114
    s_add_u32 s35, s34, 13216000
    buffer_store_dwordx4 v[116:119], v33, s[12:15], s35 offen sc1
    s_nop 1
    v_cvt_pk_bf16_f32 v120, v87, v91
    v_cvt_pk_bf16_f32 v121, v95, v99
    v_cvt_pk_bf16_f32 v122, v103, v107
    v_cvt_pk_bf16_f32 v123, v111, v115
    s_add_u32 s35, s34, 13217024
    buffer_store_dwordx4 v[120:123], v33, s[12:15], s35 offen sc1
    s_nop 1
    s_endpgm
L_prep_kernel_slab:
    s_load_dwordx2 s[6:7], s[0:1], 72
    s_cmp_eq_u32 s2, 12
    s_cbranch_scc1 L_prep_kernel_tab
    s_lshr_b32 s24, s2, 2
    s_and_b32 s26, s2, 3
    s_mov_b32 s25, 40
    s_cmp_eq_u32 s24, 1
    s_cselect_b32 s25, 32, s25
    s_cmp_eq_u32 s24, 2
    s_cselect_b32 s25, 48, s25
    s_load_dwordx2 s[4:5], s[0:1], s25
    s_load_dwordx2 s[28:29], s[0:1], 24
    v_and_b32 v1, 63, v0
    v_lshrrev_b32 v2, 3, v1
    s_lshl_b32 s27, s20, 6
    v_add_u32 v2, s27, v2
    v_lshlrev_b32 v2, 9, v2
    v_and_b32 v3, 7, v1
    v_lshl_add_u32 v2, v3, 4, v2
    s_lshl_b32 s27, s26, 7
    v_add_u32 v2, s27, v2
    s_waitcnt lgkmcnt(0)
    s_mov_b32 s8, s4
    s_mov_b32 s9, s5
    s_mov_b32 s10, 131072
    s_mov_b32 s11, 0x00020000
    s_add_u32 s12, s6, 85499904
    s_addc_u32 s13, s7, 0
    s_mov_b32 s14, 294912
    s_mov_b32 s15, 0x00020000
    s_lshl_b32 s31, s20, 13
    s_add_u32 m0, s31, 0
    s_mov_b32 s32, 0
    buffer_load_dwordx4 v2, s[8:11], s32 offen nt lds
    s_add_u32 m0, s31, 1024
    s_mov_b32 s32, 4096
    buffer_load_dwordx4 v2, s[8:11], s32 offen nt lds
    s_add_u32 m0, s31, 2048
    s_mov_b32 s32, 8192
    buffer_load_dwordx4 v2, s[8:11], s32 offen nt lds
    s_add_u32 m0, s31, 3072
    s_mov_b32 s32, 12288
    buffer_load_dwordx4 v2, s[8:11], s32 offen nt lds
    s_add_u32 m0, s31, 4096
    s_mov_b32 s32, 16384
    buffer_load_dwordx4 v2, s[8:11], s32 offen nt lds
    s_add_u32 m0, s31, 5120
    s_mov_b32 s32, 20480
    buffer_load_dwordx4 v2, s[8:11], s32 offen nt lds
    s_add_u32 m0, s31, 6144
    s_mov_b32 s32, 24576
    buffer_load_dwordx4 v2, s[8:11], s32 offen nt lds
    s_add_u32 m0, s31, 7168
    s_mov_b32 s32, 28672
    buffer_load_dwordx4 v2, s[8:11], s32 offen nt lds
    s_cmp_eq_u32 s24, 0
    s_cbranch_scc1 L_prep_kernel_ge
    v_bfe_u32 v4, v1, 2, 2
    v_lshrrev_b32 v5, 5, v1
    v_bfe_u32 v6, v1, 4, 1
    v_and_b32 v7, 3, v1
    s_cmp_eq_u32 s24, 1
    s_cbranch_scc0 L_prep_kernel_wo
    v_lshl_add_u32 v8, v5, 4, v4
    v_lshlrev_b32 v8, 7, v8
    v_lshl_add_u32 v8, v6, 5, v8
    v_lshl_add_u32 v8, v7, 3, v8
    s_lshl_b32 s33, s20, 13
    v_add_u32 v8, s33, v8
    s_mov_b32 s34, 32768
    s_lshl_b32 s35, s26, 15
    s_add_u32 s34, s34, s35
    s_lshl_b32 s35, s20, 12
    s_add_u32 s34, s34, s35
    v_lshlrev_b32 v9, 4, v1
    s_waitcnt vmcnt(0)
    s_barrier
    ds_read_b64_tr_b16 v[16:17], v8 offset:0
    ds_read_b64_tr_b16 v[18:19], v8 offset:1024
    ds_read_b64_tr_b16 v[20:21], v8 offset:512
    ds_read_b64_tr_b16 v[22:23], v8 offset:1536
    ds_read_b64_tr_b16 v[24:25], v8 offset:4096
    ds_read_b64_tr_b16 v[26:27], v8 offset:5120
    ds_read_b64_tr_b16 v[28:29], v8 offset:4608
    ds_read_b64_tr_b16 v[30:31], v8 offset:5632
    s_waitcnt lgkmcnt(0)
    s_add_u32 s35, s34, 0
    buffer_store_dwordx4 v[16:19], v9, s[12:15], s35 offen sc1
    s_add_u32 s35, s34, 1024
    buffer_store_dwordx4 v[20:23], v9, s[12:15], s35 offen sc1
    s_add_u32 s35, s34, 2048
    buffer_store_dwordx4 v[24:27], v9, s[12:15], s35 offen sc1
    s_add_u32 s35, s34, 3072
    buffer_store_dwordx4 v[28:31], v9, s[12:15], s35 offen sc1
    ds_read_b64_tr_b16 v[32:33], v8 offset:64
    ds_read_b64_tr_b16 v[34:35], v8 offset:1088
    ds_read_b64_tr_b16 v[36:37], v8 offset:576
    ds_read_b64_tr_b16 v[38:39], v8 offset:1600
    ds_read_b64_tr_b16 v[40:41], v8 offset:4160
    ds_read_b64_tr_b16 v[42:43], v8 offset:5184
    ds_read_b64_tr_b16 v[44:45], v8 offset:4672
    ds_read_b64_tr_b16 v[46:47], v8 offset:5696
    s_waitcnt lgkmcnt(0)
    s_add_u32 s35, s34, 16384
    buffer_store_dwordx4 v[32:35], v9, s[12:15], s35 offen sc1
    s_add_u32 s35, s34, 17408
    buffer_store_dwordx4 v[36:39], v9, s[12:15], s35 offen sc1
    s_add_u32 s35, s34, 18432
    buffer_store_dwordx4 v[40:43], v9, s[12:15], s35 offen sc1
    s_add_u32 s35, s34, 19456
    buffer_store_dwordx4 v[44:47], v9, s[12:15], s35 offen sc1
    s_endpgm
L_prep_kernel_wo:
    v_lshl_add_u32 v8, v5, 2, v4
    v_lshlrev_b32 v8, 7, v8
    v_lshl_add_u32 v8, v6, 5, v8
    v_and_b32 v10, 1, v7
    v_lshl_add_u32 v8, v10, 4, v8
    v_lshrrev_b32 v10, 1, v7
    v_lshl_add_u32 v8, v10, 3, v8
    s_lshl_b32 s33, s20, 13
    v_add_u32 v8, s33, v8
    s_mov_b32 s34, 163840
    s_lshl_b32 s35, s26, 15
    s_add_u32 s34, s34, s35
    s_lshl_b32 s35, s20, 12
    s_add_u32 s34, s34, s35
    v_lshlrev_b32 v9, 4, v1
    s_waitcnt vmcnt(0)
    s_barrier
    ds_read_b64_tr_b16 v[16:17], v8 offset:0
    ds_read_b64_tr_b16 v[18:19], v8 offset:1024
    ds_read_b64_tr_b16 v[20:21], v8 offset:2048
    ds_read_b64_tr_b16 v[22:23], v8 offset:3072
    ds_read_b64_tr_b16 v[24:25], v8 offset:4096
    ds_read_b64_tr_b16 v[26:27], v8 offset:5120
    ds_read_b64_tr_b16 v[28:29], v8 offset:6144
    ds_read_b64_tr_b16 v[30:31], v8 offset:7168
    s_waitcnt lgkmcnt(0)
    v_mov_b32 v48, 0x3f803f80
    v_mov_b32 v49, 0x3f803f80
    v_mov_b32 v50, 0x3f803f80
    v_mov_b32 v51, 0x3f803f80
    s_nop 1
    v_mfma_f32_32x32x16_bf16 v[64:79], v[16:19], v[48:51], 0
    v_mfma_f32_32x32x16_bf16 v[64:79], v[20:23], v[48:51], v[64:79]
    v_mfma_f32_32x32x16_bf16 v[64:79], v[24:27], v[48:51], v[64:79]
    v_mfma_f32_32x32x16_bf16 v[64:79], v[28:31], v[48:51], v[64:79]
    v_lshlrev_b32 v52, 16, v16
    v_and_b32 v53, 0xffff0000, v16
    v_mul_f32 v52, -2.0, v52
    v_mul_f32 v53, -2.0, v53
    v_cvt_pk_bf16_f32 v16, v52, v53
    v_lshlrev_b32 v52, 16, v17
    v_and_b32 v53, 0xffff0000, v17
    v_mul_f32 v52, -2.0, v52
    v_mul_f32 v53, -2.0, v53
    v_cvt_pk_bf16_f32 v17, v52, v53
    v_lshlrev_b32 v52, 16, v18
    v_and_b32 v53, 0xffff0000, v18
    v_mul_f32 v52, -2.0, v52
    v_mul_f32 v53, -2.0, v53
    v_cvt_pk_bf16_f32 v18, v52, v53
    v_lshlrev_b32 v52, 16, v19
    v_and_b32 v53, 0xffff0000, v19
    v_mul_f32 v52, -2.0, v52
    v_mul_f32 v53, -2.0, v53
    v_cvt_pk_bf16_f32 v19, v52, v53
    v_lshlrev_b32 v52, 16, v20
    v_and_b32 v53, 0xffff0000, v20
    v_mul_f32 v52, -2.0, v52
    v_mul_f32 v53, -2.0, v53
    v_cvt_pk_bf16_f32 v20, v52, v53
    v_lshlrev_b32 v52, 16, v21
    v_and_b32 v53, 0xffff0000, v21
    v_mul_f32 v52, -2.0, v52
    v_mul_f32 v53, -2.0, v53
    v_cvt_pk_bf16_f32 v21, v52, v53
    v_lshlrev_b32 v52, 16, v22
    v_and_b32 v53, 0xffff0000, v22
    v_mul_f32 v52, -2.0, v52
    v_mul_f32 v53, -2.0, v53
    v_cvt_pk_bf16_f32 v22, v52, v53
    v_lshlrev_b32 v52, 16, v23
    v_and_b32 v53, 0xffff0000, v23
    v_mul_f32 v52, -2.0, v52
    v_mul_f32 v53, -2.0, v53
    v_cvt_pk_bf16_f32 v23, v52, v53
    v_lshlrev_b32 v52, 16, v24
    v_and_b32 v53, 0xffff0000, v24
    v_mul_f32 v52, -2.0, v52
    v_mul_f32 v53, -2.0, v53
    v_cvt_pk_bf16_f32 v24, v52, v53
    v_lshlrev_b32 v52, 16, v25
    v_and_b32 v53, 0xffff0000, v25
    v_mul_f32 v52, -2.0, v52
    v_mul_f32 v53, -2.0, v53
    v_cvt_pk_bf16_f32 v25, v52, v53
    v_lshlrev_b32 v52, 16, v26
    v_and_b32 v53, 0xffff0000, v26
    v_mul_f32 v52, -2.0, v52
    v_mul_f32 v53, -2.0, v53
    v_cvt_pk_bf16_f32 v26, v52, v53
    v_lshlrev_b32 v52, 16, v27
    v_and_b32 v53, 0xffff0000, v27
    v_mul_f32 v52, -2.0, v52
    v_mul_f32 v53, -2.0, v53
    v_cvt_pk_bf16_f32 v27, v52, v53
    v_lshlrev_b32 v52, 16, v28
    v_and_b32 v53, 0xffff0000, v28
    v_mul_f32 v52, -2.0, v52
    v_mul_f32 v53, -2.0, v53
    v_cvt_pk_bf16_f32 v28, v52, v53
    v_lshlrev_b32 v52, 16, v29
    v_and_b32 v53, 0xffff0000, v29
    v_mul_f32 v52, -2.0, v52
    v_mul_f32 v53, -2.0, v53
    v_cvt_pk_bf16_f32 v29, v52, v53
    v_lshlrev_b32 v52, 16, v30
    v_and_b32 v53, 0xffff0000, v30
    v_mul_f32 v52, -2.0, v52
    v_mul_f32 v53, -2.0, v53
    v_cvt_pk_bf16_f32 v30, v52, v53
    v_lshlrev_b32 v52, 16, v31
    v_and_b32 v53, 0xffff0000, v31
    v_mul_f32 v52, -2.0, v52
    v_mul_f32 v53, -2.0, v53
    v_cvt_pk_bf16_f32 v31, v52, v53
    s_add_u32 s35, s34, 0
    buffer_store_dwordx4 v[16:19], v9, s[12:15], s35 offen sc1
    s_add_u32 s35, s34, 1024
    buffer_store_dwordx4 v[20:23], v9, s[12:15], s35 offen sc1
    s_add_u32 s35, s34, 2048
    buffer_store_dwordx4 v[24:27], v9, s[12:15], s35 offen sc1
    s_add_u32 s35, s34, 3072
    buffer_store_dwordx4 v[28:31], v9, s[12:15], s35 offen sc1
    ds_read_b64_tr_b16 v[32:33], v8 offset:64
    ds_read_b64_tr_b16 v[34:35], v8 offset:1088
    ds_read_b64_tr_b16 v[36:37], v8 offset:2112
    ds_read_b64_tr_b16 v[38:39], v8 offset:3136
    ds_read_b64_tr_b16 v[40:41], v8 offset:4160
    ds_read_b64_tr_b16 v[42:43], v8 offset:5184
    ds_read_b64_tr_b16 v[44:45], v8 offset:6208
    ds_read_b64_tr_b16 v[46:47], v8 offset:7232
    s_waitcnt lgkmcnt(0)
    v_mfma_f32_32x32x16_bf16 v[80:95], v[32:35], v[48:51], 0
    v_mfma_f32_32x32x16_bf16 v[80:95], v[36:39], v[48:51], v[80:95]
    v_mfma_f32_32x32x16_bf16 v[80:95], v[40:43], v[48:51], v[80:95]
    v_mfma_f32_32x32x16_bf16 v[80:95], v[44:47], v[48:51], v[80:95]
    v_lshlrev_b32 v52, 16, v32
    v_and_b32 v53, 0xffff0000, v32
    v_mul_f32 v52, -2.0, v52
    v_mul_f32 v53, -2.0, v53
    v_cvt_pk_bf16_f32 v32, v52, v53
    v_lshlrev_b32 v52, 16, v33
    v_and_b32 v53, 0xffff0000, v33
    v_mul_f32 v52, -2.0, v52
    v_mul_f32 v53, -2.0, v53
    v_cvt_pk_bf16_f32 v33, v52, v53
    v_lshlrev_b32 v52, 16, v34
    v_and_b32 v53, 0xffff0000, v34
    v_mul_f32 v52, -2.0, v52
    v_mul_f32 v53, -2.0, v53
    v_cvt_pk_bf16_f32 v34, v52, v53
    v_lshlrev_b32 v52, 16, v35
    v_and_b32 v53, 0xffff0000, v35
    v_mul_f32 v52, -2.0, v52
    v_mul_f32 v53, -2.0, v53
    v_cvt_pk_bf16_f32 v35, v52, v53
    v_lshlrev_b32 v52, 16, v36
    v_and_b32 v53, 0xffff0000, v36
    v_mul_f32 v52, -2.0, v52
    v_mul_f32 v53, -2.0, v53
    v_cvt_pk_bf16_f32 v36, v52, v53
    v_lshlrev_b32 v52, 16, v37
    v_and_b32 v53, 0xffff0000, v37
    v_mul_f32 v52, -2.0, v52
    v_mul_f32 v53, -2.0, v53
    v_cvt_pk_bf16_f32 v37, v52, v53
    v_lshlrev_b32 v52, 16, v38
    v_and_b32 v53, 0xffff0000, v38
    v_mul_f32 v52, -2.0, v52
    v_mul_f32 v53, -2.0, v53
    v_cvt_pk_bf16_f32 v38, v52, v53
    v_lshlrev_b32 v52, 16, v39
    v_and_b32 v53, 0xffff0000, v39
    v_mul_f32 v52, -2.0, v52
    v_mul_f32 v53, -2.0, v53
    v_cvt_pk_bf16_f32 v39, v52, v53
    v_lshlrev_b32 v52, 16, v40
    v_and_b32 v53, 0xffff0000, v40
    v_mul_f32 v52, -2.0, v52
    v_mul_f32 v53, -2.0, v53
    v_cvt_pk_bf16_f32 v40, v52, v53
    v_lshlrev_b32 v52, 16, v41
    v_and_b32 v53, 0xffff0000, v41
    v_mul_f32 v52, -2.0, v52
    v_mul_f32 v53, -2.0, v53
    v_cvt_pk_bf16_f32 v41, v52, v53
    v_lshlrev_b32 v52, 16, v42
    v_and_b32 v53, 0xffff0000, v42
    v_mul_f32 v52, -2.0, v52
    v_mul_f32 v53, -2.0, v53
    v_cvt_pk_bf16_f32 v42, v52, v53
    v_lshlrev_b32 v52, 16, v43
    v_and_b32 v53, 0xffff0000, v43
    v_mul_f32 v52, -2.0, v52
    v_mul_f32 v53, -2.0, v53
    v_cvt_pk_bf16_f32 v43, v52, v53
    v_lshlrev_b32 v52, 16, v44
    v_and_b32 v53, 0xffff0000, v44
    v_mul_f32 v52, -2.0, v52
    v_mul_f32 v53, -2.0, v53
    v_cvt_pk_bf16_f32 v44, v52, v53
    v_lshlrev_b32 v52, 16, v45
    v_and_b32 v53, 0xffff0000, v45
    v_mul_f32 v52, -2.0, v52
    v_mul_f32 v53, -2.0, v53
    v_cvt_pk_bf16_f32 v45, v52, v53
    v_lshlrev_b32 v52, 16, v46
    v_and_b32 v53, 0xffff0000, v46
    v_mul_f32 v52, -2.0, v52
    v_mul_f32 v53, -2.0, v53
    v_cvt_pk_bf16_f32 v46, v52, v53
    v_lshlrev_b32 v52, 16, v47
    v_and_b32 v53, 0xffff0000, v47
    v_mul_f32 v52, -2.0, v52
    v_mul_f32 v53, -2.0, v53
    v_cvt_pk_bf16_f32 v47, v52, v53
    s_add_u32 s35, s34, 16384
    buffer_store_dwordx4 v[32:35], v9, s[12:15], s35 offen sc1
    s_add_u32 s35, s34, 17408
    buffer_store_dwordx4 v[36:39], v9, s[12:15], s35 offen sc1
    s_add_u32 s35, s34, 18432
    buffer_store_dwordx4 v[40:43], v9, s[12:15], s35 offen sc1
    s_add_u32 s35, s34, 19456
    buffer_store_dwordx4 v[44:47], v9, s[12:15], s35 offen sc1
    s_nop 7
    s_barrier
    v_lshlrev_b32 v10, 6, v1
    s_lshl_b32 s35, s20, 13
    v_add_u32 v11, s35, v10
    ds_write_b128 v11, v[64:67] offset:0
    ds_write_b128 v11, v[68:71] offset:16
    ds_write_b128 v11, v[72:75] offset:32
    ds_write_b128 v11, v[76:79] offset:48
    ds_write_b128 v11, v[80:83] offset:4096
    ds_write_b128 v11, v[84:87] offset:4112
    ds_write_b128 v11, v[88:91] offset:4128
    ds_write_b128 v11, v[92:95] offset:4144
    s_waitcnt lgkmcnt(0)
    s_barrier
    s_cmp_ge_u32 s20, 2
    s_cbranch_scc1 L_prep_kernel_done
    s_lshl_b32 s35, s20, 12
    v_add_u32 v11, s35, v10
    ds_read_b128 v[16:19], v11 offset:0
    ds_read_b128 v[20:23], v11 offset:16
    ds_read_b128 v[24:27], v11 offset:32
    ds_read_b128 v[28:31], v11 offset:48
    ds_read_b128 v[32:35], v11 offset:8192
    ds_read_b128 v[36:39], v11 offset:8208
    ds_read_b128 v[40:43], v11 offset:8224
    ds_read_b128 v[44:47], v11 offset:8240
    s_waitcnt lgkmcnt(0)
    ds_read_b128 v[48:51], v11 offset:16384
    ds_read_b128 v[52:55], v11 offset:16400
    ds_read_b128 v[56:59], v11 offset:16416
    ds_read_b128 v[60:63], v11 offset:16432
    ds_read_b128 v[64:67], v11 offset:24576
    ds_read_b128 v[68:71], v11 offset:24592
    ds_read_b128 v[72:75], v11 offset:24608
    ds_read_b128 v[76:79], v11 offset:24624
    s_waitcnt lgkmcnt(0)
    v_add_f32 v16, v16, v32
    v_add_f32 v48, v48, v64
    v_add_f32 v17, v17, v33
    v_add_f32 v49, v49, v65
    v_add_f32 v18, v18, v34
    v_add_f32 v50, v50, v66
    v_add_f32 v19, v19, v35
    v_add_f32 v51, v51, v67
    v_add_f32 v20, v20, v36
    v_add_f32 v52, v52, v68
    v_add_f32 v21, v21, v37
    v_add_f32 v53, v53, v69
    v_add_f32 v22, v22, v38
    v_add_f32 v54, v54, v70
    v_add_f32 v23, v23, v39
    v_add_f32 v55, v55, v71
    v_add_f32 v24, v24, v40
    v_add_f32 v56, v56, v72
    v_add_f32 v25, v25, v41
    v_add_f32 v57, v57, v73
    v_add_f32 v26, v26, v42
    v_add_f32 v58, v58, v74
    v_add_f32 v27, v27, v43
    v_add_f32 v59, v59, v75
    v_add_f32 v28, v28, v44
    v_add_f32 v60, v60, v76
    v_add_f32 v29, v29, v45
    v_add_f32 v61, v61, v77
    v_add_f32 v30, v30, v46
    v_add_f32 v62, v62, v78
    v_add_f32 v31, v31, v47
    v_add_f32 v63, v63, v79
    v_add_f32 v16, v16, v48
    v_add_f32 v17, v17, v49
    v_add_f32 v18, v18, v50
    v_add_f32 v19, v19, v51
    v_add_f32 v20, v20, v52
    v_add_f32 v21, v21, v53
    v_add_f32 v22, v22, v54
    v_add_f32 v23, v23, v55
    v_add_f32 v24, v24, v56
    v_add_f32 v25, v25, v57
    v_add_f32 v26, v26, v58
    v_add_f32 v27, v27, v59
    v_add_f32 v28, v28, v60
    v_add_f32 v29, v29, v61
    v_add_f32 v30, v30, v62
    v_add_f32 v31, v31, v63
    v_and_b32 v10, 31, v1
    v_cmp_eq_u32 vcc, 0, v10
    v_lshrrev_b32 v10, 5, v1
    v_lshlrev_b32 v10, 6, v10
    s_lshl_b32 s35, s26, 8
    s_lshl_b32 s36, s20, 7
    s_add_u32 s35, s35, s36
    s_add_u32 s35, s35, 14336
    s_and_saveexec_b64 s[38:39], vcc
    buffer_store_dwordx4 v[16:19], v10, s[12:15], s35 offen offset:0 sc1
    buffer_store_dwordx4 v[20:23], v10, s[12:15], s35 offen offset:16 sc1
    buffer_store_dwordx4 v[24:27], v10, s[12:15], s35 offen offset:32 sc1
    buffer_store_dwordx4 v[28:31], v10, s[12:15], s35 offen offset:48 sc1
    s_endpgm
L_prep_kernel_ge:
    s_mov_b32 s36, s28
    s_mov_b32 s37, s29
    s_mov_b32 s38, 8192
    s_mov_b32 s39, 0x00020000
    v_and_b32 v4, 15, v1
    v_lshrrev_b32 v5, 4, v1
    v_lshlrev_b32 v6, 9, v4
    v_lshl_add_u32 v6, v5, 4, v6
    buffer_load_dwordx4 v[16:19], v6, s[36:39], 0 offen offset:0
    buffer_load_dwordx4 v[20:23], v6, s[36:39], 0 offen offset:64
    buffer_load_dwordx4 v[24:27], v6, s[36:39], 0 offen offset:128
    buffer_load_dwordx4 v[28:31], v6, s[36:39], 0 offen offset:192
    buffer_load_dwordx4 v[32:35], v6, s[36:39], 0 offen offset:256
    buffer_load_dwordx4 v[36:39], v6, s[36:39], 0 offen offset:320
    buffer_load_dwordx4 v[40:43], v6, s[36:39], 0 offen offset:384
    buffer_load_dwordx4 v[44:47], v6, s[36:39], 0 offen offset:448
    v_bfe_u32 v7, v1, 2, 2
    v_lshl_add_u32 v7, v5, 3, v7
    v_lshlrev_b32 v7, 7, v7
    v_and_b32 v8, 3, v1
    v_lshl_add_u32 v7, v8, 3, v7
    s_lshl_b32 s33, s20, 5
    v_add_u32 v7, s33, v7
    s_waitcnt vmcnt(0)
    s_barrier
    ds_read_b64_tr_b16 v[48:49], v7 offset:0
    ds_read_b64_tr_b16 v[50:51], v7 offset:512
    ds_read_b64_tr_b16 v[52:53], v7 offset:4096
    ds_read_b64_tr_b16 v[54:55], v7 offset:4608
    ds_read_b64_tr_b16 v[56:57], v7 offset:8192
    ds_read_b64_tr_b16 v[58:59], v7 offset:8704
    ds_read_b64_tr_b16 v[60:61], v7 offset:12288
    ds_read_b64_tr_b16 v[62:63], v7 offset:12800
    s_waitcnt lgkmcnt(0)
    ds_read_b64_tr_b16 v[64:65], v7 offset:16384
    ds_read_b64_tr_b16 v[66:67], v7 offset:16896
    ds_read_b64_tr_b16 v[68:69], v7 offset:20480
    ds_read_b64_tr_b16 v[70:71], v7 offset:20992
    ds_read_b64_tr_b16 v[72:73], v7 offset:24576
    ds_read_b64_tr_b16 v[74:75], v7 offset:25088
    ds_read_b64_tr_b16 v[76:77], v7 offset:28672
    ds_read_b64_tr_b16 v[78:79], v7 offset:29184
    s_waitcnt lgkmcnt(0)
    v_mfma_f32_16x16x32_bf16 v[80:83], v[48:51], v[16:19], 0
    v_mfma_f32_16x16x32_bf16 v[80:83], v[52:55], v[20:23], v[80:83]
    v_mfma_f32_16x16x32_bf16 v[80:83], v[56:59], v[24:27], v[80:83]
    v_mfma_f32_16x16x32_bf16 v[80:83], v[60:63], v[28:31], v[80:83]
    v_mfma_f32_16x16x32_bf16 v[80:83], v[64:67], v[32:35], v[80:83]
    v_mfma_f32_16x16x32_bf16 v[80:83], v[68:71], v[36:39], v[80:83]
    v_mfma_f32_16x16x32_bf16 v[80:83], v[72:75], v[40:43], v[80:83]
    v_mfma_f32_16x16x32_bf16 v[80:83], v[76:79], v[44:47], v[80:83]
    s_nop 7
    v_cvt_pk_bf16_f32 v84, v80, v81
    v_cvt_pk_bf16_f32 v85, v82, v83
    s_mov_b32 s33, 0x4038aa3b
    v_lshlrev_b32 v80, 16, v84
    v_and_b32 v81, 0xffff0000, v84
    v_lshlrev_b32 v82, 16, v85
    v_and_b32 v83, 0xffff0000, v85
    v_mul_f32 v80, s33, v80
    v_mul_f32 v81, s33, v81
    v_mul_f32 v82, s33, v82
    v_mul_f32 v83, s33, v83
    v_lshlrev_b32 v6, 10, v4
    v_lshl_add_u32 v6, v5, 4, v6
    s_lshl_b32 s33, s26, 8
    s_lshl_b32 s34, s20, 6
    s_add_u32 s33, s33, s34
    s_add_u32 s33, s33, 16384
    buffer_store_dwordx4 v[80:83], v6, s[12:15], s33 offen sc1
    s_endpgm
L_prep_kernel_tab:
    v_and_b32 v8, 63, v0
    v_lshlrev_b32 v6, 4, v8
    s_waitcnt lgkmcnt(0)
    s_add_u32 s12, s6, 85499904
    s_addc_u32 s13, s7, 0
    s_mov_b32 s14, 294912
    s_mov_b32 s15, 0x00020000
    s_lshl_b32 s32, s20, 4
    s_lshl_b32 s33, s20, 11
    v_and_b32 v9, 15, v8
    v_lshrrev_b32 v10, 4, v8
    v_or_b32 v11, 1, v9
    v_add_u32 v11, s32, v11
    v_cvt_f32_u32 v11, v11
    v_mul_f32 v11, 0x3c000000, v11
    v_lshlrev_b32 v10, 3, v10
    v_add_u32 v10, 0, v10
    v_cvt_f32_u32 v10, v10
    v_and_b32 v9, 1, v9
    v_cvt_f32_u32 v9, v9
    v_mul_f32 v9, 0x3e800000, v9
    v_fma_f32 v12, v11, v10, v9
    v_fract_f32 v13, v12
    v_add_f32 v12, v12, v11
    v_fract_f32 v14, v12
    v_add_f32 v12, v12, v11
    v_fract_f32 v15, v12
    v_add_f32 v12, v12, v11
    v_fract_f32 v16, v12
    v_add_f32 v12, v12, v11
    v_fract_f32 v17, v12
    v_add_f32 v12, v12, v11
    v_fract_f32 v18, v12
    v_add_f32 v12, v12, v11
    v_fract_f32 v19, v12
    v_add_f32 v12, v12, v11
    v_fract_f32 v20, v12
    v_cos_f32 v13, v13
    v_cos_f32 v14, v14
    v_cos_f32 v15, v15
    v_cos_f32 v16, v16
    v_cos_f32 v17, v17
    v_cos_f32 v18, v18
    v_cos_f32 v19, v19
    v_cos_f32 v20, v20
    s_nop 0
    v_cvt_pk_bf16_f32 v24, v13, v14
    v_cvt_pk_bf16_f32 v25, v15, v16
    v_cvt_pk_bf16_f32 v26, v17, v18
    v_cvt_pk_bf16_f32 v27, v19, v20
    s_add_u32 s34, s33, 0
    buffer_store_dwordx4 v[24:27], v6, s[12:15], s34 offen sc1
    v_and_b32 v9, 15, v8
    v_lshrrev_b32 v10, 4, v8
    v_or_b32 v11, 1, v9
    v_add_u32 v11, s32, v11
    v_cvt_f32_u32 v11, v11
    v_mul_f32 v11, 0x3c000000, v11
    v_lshlrev_b32 v10, 3, v10
    v_add_u32 v10, 32, v10
    v_cvt_f32_u32 v10, v10
    v_and_b32 v9, 1, v9
    v_cvt_f32_u32 v9, v9
    v_mul_f32 v9, 0x3e800000, v9
    v_fma_f32 v12, v11, v10, v9
    v_fract_f32 v13, v12
    v_add_f32 v12, v12, v11
    v_fract_f32 v14, v12
    v_add_f32 v12, v12, v11
    v_fract_f32 v15, v12
    v_add_f32 v12, v12, v11
    v_fract_f32 v16, v12
    v_add_f32 v12, v12, v11
    v_fract_f32 v17, v12
    v_add_f32 v12, v12, v11
    v_fract_f32 v18, v12
    v_add_f32 v12, v12, v11
    v_fract_f32 v19, v12
    v_add_f32 v12, v12, v11
    v_fract_f32 v20, v12
    v_cos_f32 v13, v13
    v_cos_f32 v14, v14
    v_cos_f32 v15, v15
    v_cos_f32 v16, v16
    v_cos_f32 v17, v17
    v_cos_f32 v18, v18
    v_cos_f32 v19, v19
    v_cos_f32 v20, v20
    s_nop 0
    v_cvt_pk_bf16_f32 v28, v13, v14
    v_cvt_pk_bf16_f32 v29, v15, v16
    v_cvt_pk_bf16_f32 v30, v17, v18
    v_cvt_pk_bf16_f32 v31, v19, v20
    s_add_u32 s34, s33, 1024
    buffer_store_dwordx4 v[28:31], v6, s[12:15], s34 offen sc1
    s_cmp_ge_u32 s20, 3
    s_cbranch_scc1 L_prep_kernel_done
    v_and_b32 v9, 15, v8
    v_add_u32 v9, s32, v9
    v_cvt_f32_u32 v9, v9
    v_mul_f32 v9, 0x3c000000, v9
    v_lshrrev_b32 v10, 4, v8
    v_lshlrev_b32 v10, 3, v10
    v_add_u32 v11, 1, v10
    v_cvt_f32_u32 v11, v11
    v_mul_f32 v11, v11, v9
    v_fract_f32 v12, v11
    v_add_u32 v11, 1, v10
    v_cvt_f32_u32 v11, v11
    v_mul_f32 v11, v11, v9
    v_add_f32 v11, 0x3e800000, v11
    v_fract_f32 v13, v11
    v_add_u32 v11, 3, v10
    v_cvt_f32_u32 v11, v11
    v_mul_f32 v11, v11, v9
    v_fract_f32 v14, v11
    v_add_u32 v11, 3, v10
    v_cvt_f32_u32 v11, v11
    v_mul_f32 v11, v11, v9
    v_add_f32 v11, 0x3e800000, v11
    v_fract_f32 v15, v11
    v_add_u32 v11, 5, v10
    v_cvt_f32_u32 v11, v11
    v_mul_f32 v11, v11, v9
    v_fract_f32 v16, v11
    v_add_u32 v11, 5, v10
    v_cvt_f32_u32 v11, v11
    v_mul_f32 v11, v11, v9
    v_add_f32 v11, 0x3e800000, v11
    v_fract_f32 v17, v11
    v_add_u32 v11, 7, v10
    v_cvt_f32_u32 v11, v11
    v_mul_f32 v11, v11, v9
    v_fract_f32 v18, v11
    v_add_u32 v11, 7, v10
    v_cvt_f32_u32 v11, v11
    v_mul_f32 v11, v11, v9
    v_add_f32 v11, 0x3e800000, v11
    v_fract_f32 v19, v11
    v_cos_f32 v12, v12
    v_cos_f32 v13, v13
    v_cos_f32 v14, v14
    v_cos_f32 v15, v15
    v_cos_f32 v16, v16
    v_cos_f32 v17, v17
    v_cos_f32 v18, v18
    v_cos_f32 v19, v19
    s_nop 0
    v_cvt_pk_bf16_f32 v24, v12, v13
    v_cvt_pk_bf16_f32 v25, v14, v15
    v_cvt_pk_bf16_f32 v26, v16, v17
    v_cvt_pk_bf16_f32 v27, v18, v19
    s_add_u32 s34, s33, 8192
    buffer_store_dwordx4 v[24:27], v6, s[12:15], s34 offen sc1
    s_nop 1
    v_add_u32 v11, 33, v10
    v_cvt_f32_u32 v11, v11
    v_mul_f32 v11, v11, v9
    v_fract_f32 v12, v11
    v_add_u32 v11, 33, v10
    v_cvt_f32_u32 v11, v11
    v_mul_f32 v11, v11, v9
    v_add_f32 v11, 0x3e800000, v11
    v_fract_f32 v13, v11
    v_add_u32 v11, 35, v10
    v_cvt_f32_u32 v11, v11
    v_mul_f32 v11, v11, v9
    v_fract_f32 v14, v11
    v_add_u32 v11, 35, v10
    v_cvt_f32_u32 v11, v11
    v_mul_f32 v11, v11, v9
    v_add_f32 v11, 0x3e800000, v11
    v_fract_f32 v15, v11
    v_add_u32 v11, 37, v10
    v_cvt_f32_u32 v11, v11
    v_mul_f32 v11, v11, v9
    v_fract_f32 v16, v11
    v_add_u32 v11, 37, v10
    v_cvt_f32_u32 v11, v11
    v_mul_f32 v11, v11, v9
    v_add_f32 v11, 0x3e800000, v11
    v_fract_f32 v17, v11
    v_add_u32 v11, 39, v10
    v_cvt_f32_u32 v11, v11
    v_mul_f32 v11, v11, v9
    v_fract_f32 v18, v11
    v_add_u32 v11, 39, v10
    v_cvt_f32_u32 v11, v11
    v_mul_f32 v11, v11, v9
    v_add_f32 v11, 0x3e800000, v11
    v_fract_f32 v19, v11
    v_cos_f32 v12, v12
    v_cos_f32 v13, v13
    v_cos_f32 v14, v14
    v_cos_f32 v15, v15
    v_cos_f32 v16, v16
    v_cos_f32 v17, v17
    v_cos_f32 v18, v18
    v_cos_f32 v19, v19
    s_nop 0
    v_cvt_pk_bf16_f32 v24, v12, v13
    v_cvt_pk_bf16_f32 v25, v14, v15
    v_cvt_pk_bf16_f32 v26, v16, v17
    v_cvt_pk_bf16_f32 v27, v18, v19
    s_add_u32 s34, s33, 9216
    buffer_store_dwordx4 v[24:27], v6, s[12:15], s34 offen sc1
    s_nop 1
L_prep_kernel_done:
    s_endpgm
.globl gemm1_kernel
.p2align 8
.type gemm1_kernel,@function
gemm1_kernel:
    s_cmp_ge_u32 s2, 256
    s_cbranch_scc1 L_gemm1_kernel_done
    s_load_dwordx2 s[4:5], s[0:1], 72
    s_load_dwordx2 s[6:7], s[0:1], 72
    v_readfirstlane_b32 s20, v0
    s_lshr_b32 s20, s20, 6
    s_and_b32 s24, s2, 7
    s_lshr_b32 s25, s2, 3
    s_lshr_b32 s26, s25, 3
    s_lshl_b32 s24, s24, 2
    s_add_u32 s21, s24, s26
    s_and_b32 s25, s25, 7
    s_lshr_b32 s26, s25, 1
    s_and_b32 s27, s25, 1
    s_mul_i32 s22, s26, 84
    s_sub_u32 s28, 334, s22
    s_min_u32 s28, s28, 84
    s_waitcnt lgkmcnt(0)
    s_mul_i32 s29, s21, 684032
    s_lshl_b32 s30, s22, 11
    s_add_u32 s29, s29, s30
    s_add_u32 s29, s29, 0
    s_add_u32 s8, s6, s29
    s_addc_u32 s9, s7, 0
    s_lshl_b32 s10, s28, 11
    s_mov_b32 s11, 0x00020000
    s_mul_i32 s29, s21, 528640
    s_mul_i32 s30, s27, 16384
    s_add_u32 s29, s29, s30
    s_add_u32 s29, s29, 21954560
    s_add_u32 s12, s4, s29
    s_addc_u32 s13, s5, 0
    s_mov_b32 s14, 507904
    s_mov_b32 s15, 0x00020000
    s_cmp_lt_u32 s20, 4
    s_cbranch_scc1 L_gemm1_kernel_consumer
    s_sub_u32 s20, s20, 4
    v_and_b32 v1, 63, v0
    v_lshrrev_b32 v4, 3, v1
    v_and_b32 v5, 7, v1
    v_xor_b32 v5, v5, v4
    v_lshlrev_b32 v5, 4, v5
    v_lshl_add_u32 v2, v4, 11, v5
    v_lshlrev_b32 v3, 4, v1
    s_add_u32 s24, s20, 0
    s_lshl_b32 s40, s24, 10
    s_lshl_b32 s43, s24, 14
    s_add_u32 s24, s20, 4
    s_lshl_b32 s41, s24, 10
    s_lshl_b32 s44, s24, 14
    s_add_u32 s24, s20, 8
    s_lshl_b32 s42, s24, 10
    s_lshl_b32 s45, s24, 14
    s_mul_i32 s46, s20, 4096
    s_add_u32 s47, s46, 12288
    s_add_u32 m0, s40, 0
    s_add_u32 s24, s43, 0
    buffer_load_dwordx4 v2, s[8:11], s24 offen lds
    s_add_u32 m0, s41, 0
    s_add_u32 s24, s44, 0
    buffer_load_dwordx4 v2, s[8:11], s24 offen lds
    s_add_u32 m0, s42, 0
    s_add_u32 s24, s45, 0
    buffer_load_dwordx4 v2, s[8:11], s24 offen lds
    s_add_u32 m0, s47, 0
    s_add_u32 s24, s46, 0
    buffer_load_dwordx4 v3, s[12:15], s24 offen offset:0 lds
    buffer_load_dwordx4 v3, s[12:15], s24 offen offset:1024 lds
    buffer_load_dwordx4 v3, s[12:15], s24 offen offset:2048 lds
    buffer_load_dwordx4 v3, s[12:15], s24 offen offset:3072 lds
    s_add_u32 m0, s40, 28672
    s_add_u32 s24, s43, 128
    buffer_load_dwordx4 v2, s[8:11], s24 offen lds
    s_add_u32 m0, s41, 28672
    s_add_u32 s24, s44, 128
    buffer_load_dwordx4 v2, s[8:11], s24 offen lds
    s_add_u32 m0, s42, 28672
    s_add_u32 s24, s45, 128
    buffer_load_dwordx4 v2, s[8:11], s24 offen lds
    s_add_u32 m0, s47, 28672
    s_add_u32 s24, s46, 32768
    buffer_load_dwordx4 v3, s[12:15], s24 offen offset:0 lds
    buffer_load_dwordx4 v3, s[12:15], s24 offen offset:1024 lds
    buffer_load_dwordx4 v3, s[12:15], s24 offen offset:2048 lds
    buffer_load_dwordx4 v3, s[12:15], s24 offen offset:3072 lds
    s_waitcnt vmcnt(7)
    s_barrier
    s_add_u32 m0, s40, 57344
    s_add_u32 s24, s43, 256
    buffer_load_dwordx4 v2, s[8:11], s24 offen lds
    s_add_u32 m0, s41, 57344
    s_add_u32 s24, s44, 256
    buffer_load_dwordx4 v2, s[8:11], s24 offen lds
    s_add_u32 m0, s42, 57344
    s_add_u32 s24, s45, 256
    buffer_load_dwordx4 v2, s[8:11], s24 offen lds
    s_add_u32 m0, s47, 57344
    s_add_u32 s24, s46, 65536
    buffer_load_dwordx4 v3, s[12:15], s24 offen offset:0 lds
    buffer_load_dwordx4 v3, s[12:15], s24 offen offset:1024 lds
    buffer_load_dwordx4 v3, s[12:15], s24 offen offset:2048 lds
    buffer_load_dwordx4 v3, s[12:15], s24 offen offset:3072 lds
    s_waitcnt vmcnt(7)
    s_barrier
    s_add_u32 m0, s40, 86016
    s_add_u32 s24, s43, 384
    buffer_load_dwordx4 v2, s[8:11], s24 offen lds
    s_add_u32 m0, s41, 86016
    s_add_u32 s24, s44, 384
    buffer_load_dwordx4 v2, s[8:11], s24 offen lds
    s_add_u32 m0, s42, 86016
    s_add_u32 s24, s45, 384
    buffer_load_dwordx4 v2, s[8:11], s24 offen lds
    s_add_u32 m0, s47, 86016
    s_add_u32 s24, s46, 98304
    buffer_load_dwordx4 v3, s[12:15], s24 offen offset:0 lds
    buffer_load_dwordx4 v3, s[12:15], s24 offen offset:1024 lds
    buffer_load_dwordx4 v3, s[12:15], s24 offen offset:2048 lds
    buffer_load_dwordx4 v3, s[12:15], s24 offen offset:3072 lds
    s_add_u32 m0, s40, 114688
    s_add_u32 s24, s43, 512
    buffer_load_dwordx4 v2, s[8:11], s24 offen lds
    s_add_u32 m0, s41, 114688
    s_add_u32 s24, s44, 512
    buffer_load_dwordx4 v2, s[8:11], s24 offen lds
    s_add_u32 m0, s42, 114688
    s_add_u32 s24, s45, 512
    buffer_load_dwordx4 v2, s[8:11], s24 offen lds
    s_add_u32 m0, s47, 114688
    s_add_u32 s24, s46, 131072
    buffer_load_dwordx4 v3, s[12:15], s24 offen offset:0 lds
    buffer_load_dwordx4 v3, s[12:15], s24 offen offset:1024 lds
    buffer_load_dwordx4 v3, s[12:15], s24 offen offset:2048 lds
    buffer_load_dwordx4 v3, s[12:15], s24 offen offset:3072 lds
    s_waitcnt vmcnt(14)
    s_barrier
    s_add_u32 m0, s40, 0
    s_add_u32 s24, s43, 640
    buffer_load_dwordx4 v2, s[8:11], s24 offen lds
    s_add_u32 m0, s41, 0
    s_add_u32 s24, s44, 640
    buffer_load_dwordx4 v2, s[8:11], s24 offen lds
    s_add_u32 m0, s42, 0
    s_add_u32 s24, s45, 640
    buffer_load_dwordx4 v2, s[8:11], s24 offen lds
    s_add_u32 m0, s47, 0
    s_add_u32 s24, s46, 163840
    buffer_load_dwordx4 v3, s[12:15], s24 offen offset:0 lds
    buffer_load_dwordx4 v3, s[12:15], s24 offen offset:1024 lds
    buffer_load_dwordx4 v3, s[12:15], s24 offen offset:2048 lds
    buffer_load_dwordx4 v3, s[12:15], s24 offen offset:3072 lds
    s_add_u32 m0, s40, 28672
    s_add_u32 s24, s43, 768
    buffer_load_dwordx4 v2, s[8:11], s24 offen lds
    s_add_u32 m0, s41, 28672
    s_add_u32 s24, s44, 768
    buffer_load_dwordx4 v2, s[8:11], s24 offen lds
    s_add_u32 m0, s42, 28672
    s_add_u32 s24, s45, 768
    buffer_load_dwordx4 v2, s[8:11], s24 offen lds
    s_add_u32 m0, s47, 28672
    s_add_u32 s24, s46, 196608
    buffer_load_dwordx4 v3, s[12:15], s24 offen offset:0 lds
    buffer_load_dwordx4 v3, s[12:15], s24 offen offset:1024 lds
    buffer_load_dwordx4 v3, s[12:15], s24 offen offset:2048 lds
    buffer_load_dwordx4 v3, s[12:15], s24 offen offset:3072 lds
    s_waitcnt vmcnt(21)
    s_barrier
    s_add_u32 m0, s40, 57344
    s_add_u32 s24, s43, 896
    buffer_load_dwordx4 v2, s[8:11], s24 offen lds
    s_add_u32 m0, s41, 57344
    s_add_u32 s24, s44, 896
    buffer_load_dwordx4 v2, s[8:11], s24 offen lds
    s_add_u32 m0, s42, 57344
    s_add_u32 s24, s45, 896
    buffer_load_dwordx4 v2, s[8:11], s24 offen lds
    s_add_u32 m0, s47, 57344
    s_add_u32 s24, s46, 229376
    buffer_load_dwordx4 v3, s[12:15], s24 offen offset:0 lds
    buffer_load_dwordx4 v3, s[12:15], s24 offen offset:1024 lds
    buffer_load_dwordx4 v3, s[12:15], s24 offen offset:2048 lds
    buffer_load_dwordx4 v3, s[12:15], s24 offen offset:3072 lds
    s_waitcnt vmcnt(21)
    s_barrier
    s_add_u32 m0, s40, 86016
    s_add_u32 s24, s43, 1024
    buffer_load_dwordx4 v2, s[8:11], s24 offen lds
    s_add_u32 m0, s41, 86016
    s_add_u32 s24, s44, 1024
    buffer_load_dwordx4 v2, s[8:11], s24 offen lds
    s_add_u32 m0, s42, 86016
    s_add_u32 s24, s45, 1024
    buffer_load_dwordx4 v2, s[8:11], s24 offen lds
    s_add_u32 m0, s47, 86016
    s_add_u32 s24, s46, 262144
    buffer_load_dwordx4 v3, s[12:15], s24 offen offset:0 lds
    buffer_load_dwordx4 v3, s[12:15], s24 offen offset:1024 lds
    buffer_load_dwordx4 v3, s[12:15], s24 offen offset:2048 lds
    buffer_load_dwordx4 v3, s[12:15], s24 offen offset:3072 lds
    s_waitcnt vmcnt(21)
    s_barrier
    s_add_u32 m0, s40, 114688
    s_add_u32 s24, s43, 1152
    buffer_load_dwordx4 v2, s[8:11], s24 offen lds
    s_add_u32 m0, s41, 114688
    s_add_u32 s24, s44, 1152
    buffer_load_dwordx4 v2, s[8:11], s24 offen lds
    s_add_u32 m0, s42, 114688
    s_add_u32 s24, s45, 1152
    buffer_load_dwordx4 v2, s[8:11], s24 offen lds
    s_add_u32 m0, s47, 114688
    s_add_u32 s24, s46, 294912
    buffer_load_dwordx4 v3, s[12:15], s24 offen offset:0 lds
    buffer_load_dwordx4 v3, s[12:15], s24 offen offset:1024 lds
    buffer_load_dwordx4 v3, s[12:15], s24 offen offset:2048 lds
    buffer_load_dwordx4 v3, s[12:15], s24 offen offset:3072 lds
    s_waitcnt vmcnt(21)
    s_barrier
    s_add_u32 m0, s40, 0
    s_add_u32 s24, s43, 1280
    buffer_load_dwordx4 v2, s[8:11], s24 offen lds
    s_add_u32 m0, s41, 0
    s_add_u32 s24, s44, 1280
    buffer_load_dwordx4 v2, s[8:11], s24 offen lds
    s_add_u32 m0, s42, 0
    s_add_u32 s24, s45, 1280
    buffer_load_dwordx4 v2, s[8:11], s24 offen lds
    s_add_u32 m0, s47, 0
    s_add_u32 s24, s46, 327680
    buffer_load_dwordx4 v3, s[12:15], s24 offen offset:0 lds
    buffer_load_dwordx4 v3, s[12:15], s24 offen offset:1024 lds
    buffer_load_dwordx4 v3, s[12:15], s24 offen offset:2048 lds
    buffer_load_dwordx4 v3, s[12:15], s24 offen offset:3072 lds
    s_waitcnt vmcnt(21)
    s_barrier
    s_add_u32 m0, s40, 28672
    s_add_u32 s24, s43, 1408
    buffer_load_dwordx4 v2, s[8:11], s24 offen lds
    s_add_u32 m0, s41, 28672
    s_add_u32 s24, s44, 1408
    buffer_load_dwordx4 v2, s[8:11], s24 offen lds
    s_add_u32 m0, s42, 28672
    s_add_u32 s24, s45, 1408
    buffer_load_dwordx4 v2, s[8:11], s24 offen lds
    s_add_u32 m0, s47, 28672
    s_add_u32 s24, s46, 360448
    buffer_load_dwordx4 v3, s[12:15], s24 offen offset:0 lds
    buffer_load_dwordx4 v3, s[12:15], s24 offen offset:1024 lds
    buffer_load_dwordx4 v3, s[12:15], s24 offen offset:2048 lds
    buffer_load_dwordx4 v3, s[12:15], s24 offen offset:3072 lds
    s_waitcnt vmcnt(21)
    s_barrier
    s_add_u32 m0, s40, 57344
    s_add_u32 s24, s43, 1536
    buffer_load_dwordx4 v2, s[8:11], s24 offen lds
    s_add_u32 m0, s41, 57344
    s_add_u32 s24, s44, 1536
    buffer_load_dwordx4 v2, s[8:11], s24 offen lds
    s_add_u32 m0, s42, 57344
    s_add_u32 s24, s45, 1536
    buffer_load_dwordx4 v2, s[8:11], s24 offen lds
    s_add_u32 m0, s47, 57344
    s_add_u32 s24, s46, 393216
    buffer_load_dwordx4 v3, s[12:15], s24 offen offset:0 lds
    buffer_load_dwordx4 v3, s[12:15], s24 offen offset:1024 lds
    buffer_load_dwordx4 v3, s[12:15], s24 offen offset:2048 lds
    buffer_load_dwordx4 v3, s[12:15], s24 offen offset:3072 lds
    s_waitcnt vmcnt(21)
    s_barrier
    s_add_u32 m0, s40, 86016
    s_add_u32 s24, s43, 1664
    buffer_load_dwordx4 v2, s[8:11], s24 offen lds
    s_add_u32 m0, s41, 86016
    s_add_u32 s24, s44, 1664
    buffer_load_dwordx4 v2, s[8:11], s24 offen lds
    s_add_u32 m0, s42, 86016
    s_add_u32 s24, s45, 1664
    buffer_load_dwordx4 v2, s[8:11], s24 offen lds
    s_add_u32 m0, s47, 86016
    s_add_u32 s24, s46, 425984
    buffer_load_dwordx4 v3, s[12:15], s24 offen offset:0 lds
    buffer_load_dwordx4 v3, s[12:15], s24 offen offset:1024 lds
    buffer_load_dwordx4 v3, s[12:15], s24 offen offset:2048 lds
    buffer_load_dwordx4 v3, s[12:15], s24 offen offset:3072 lds
    s_waitcnt vmcnt(21)
    s_barrier
    s_add_u32 m0, s40, 114688
    s_add_u32 s24, s43, 1792
    buffer_load_dwordx4 v2, s[8:11], s24 offen lds
    s_add_u32 m0, s41, 114688
    s_add_u32 s24, s44, 1792
    buffer_load_dwordx4 v2, s[8:11], s24 offen lds
    s_add_u32 m0, s42, 114688
    s_add_u32 s24, s45, 1792
    buffer_load_dwordx4 v2, s[8:11], s24 offen lds
    s_add_u32 m0, s47, 114688
    s_add_u32 s24, s46, 458752
    buffer_load_dwordx4 v3, s[12:15], s24 offen offset:0 lds
    buffer_load_dwordx4 v3, s[12:15], s24 offen offset:1024 lds
    buffer_load_dwordx4 v3, s[12:15], s24 offen offset:2048 lds
    buffer_load_dwordx4 v3, s[12:15], s24 offen offset:3072 lds
    s_waitcnt vmcnt(21)
    s_barrier
    s_add_u32 m0, s40, 0
    s_add_u32 s24, s43, 1920
    buffer_load_dwordx4 v2, s[8:11], s24 offen lds
    s_add_u32 m0, s41, 0
    s_add_u32 s24, s44, 1920
    buffer_load_dwordx4 v2, s[8:11], s24 offen lds
    s_add_u32 m0, s42, 0
    s_add_u32 s24, s45, 1920
    buffer_load_dwordx4 v2, s[8:11], s24 offen lds
    s_add_u32 m0, s47, 0
    s_add_u32 s24, s46, 491520
    buffer_load_dwordx4 v3, s[12:15], s24 offen offset:0 lds
    buffer_load_dwordx4 v3, s[12:15], s24 offen offset:1024 lds
    buffer_load_dwordx4 v3, s[12:15], s24 offen offset:2048 lds
    buffer_load_dwordx4 v3, s[12:15], s24 offen offset:3072 lds
    s_waitcnt vmcnt(21)
    s_barrier
    s_waitcnt vmcnt(14)
    s_barrier
    s_waitcnt vmcnt(7)
    s_barrier
    s_waitcnt vmcnt(0)
    s_barrier
L_gemm1_kernel_done:
    s_endpgm
L_gemm1_kernel_consumer:
    s_mul_i32 s29, s22, 37120
    s_add_u32 s29, s29, 38871040
    s_add_u32 s16, s4, s29
    s_addc_u32 s17, s5, 0
    s_mul_i32 s18, s28, 37120
    s_mov_b32 s19, 0x00020000
    s_lshr_b32 s29, s20, 1
    s_and_b32 s30, s20, 1
    v_and_b32 v217, 15, v0
    v_bfe_u32 v218, v0, 4, 2
    v_and_b32 v219, 63, v0
    s_mul_i32 s31, s29, 6144
    v_and_b32 v220, 7, v217
    v_xor_b32 v220, v218, v220
    v_lshlrev_b32 v220, 4, v220
    v_lshl_add_u32 v220, v217, 7, v220
    v_add_u32 v220, s31, v220
    v_add_u32 v208, 0, v220
    v_xor_b32 v211, 64, v208
    v_add_u32 v209, 57344, v220
    v_xor_b32 v212, 64, v209
    v_add_u32 v210, 114688, v220
    v_xor_b32 v213, 64, v210
    s_mul_i32 s31, s30, 8192
    s_add_u32 s31, s31, 12288
    v_lshlrev_b32 v220, 4, v219
    v_add_u32 v220, s31, v220
    v_add_u32 v214, 0, v220
    v_add_u32 v215, 57344, v220
    v_add_u32 v216, 114688, v220
    v_and_b32 v224, 7, v217
    v_lshrrev_b32 v225, 3, v217
    v_mul_u32_u24 v222, 37120, v224
    v_lshl_add_u32 v222, v218, 4, v222
    s_mul_i32 s31, s29, 1781760
    v_add_u32 v222, s31, v222
    v_lshl_add_u32 v222, v225, 6, v222
    v_xor_b32 v225, 64, v222
    v_add_u32 v223, 296960, v225
    s_mul_i32 s31, s27, 4
    s_mul_i32 s29, s30, 2
    s_add_u32 s31, s31, s29
    s_mul_i32 s31, s31, 128
    s_mul_i32 s29, s21, 1024
    s_add_u32 s33, s31, s29
    s_mov_b32 s34, 0x80008000
    s_barrier
    ds_read_b128 v[96:99], v214 offset:0
    ds_read_b128 v[128:131], v208 offset:0
    ds_read_b128 v[136:139], v208 offset:2048
    ds_read_b128 v[144:147], v208 offset:4096
    ds_read_b128 v[104:107], v214 offset:2048
    ds_read_b128 v[112:115], v214 offset:4096
    ds_read_b128 v[120:123], v214 offset:6144
    ds_read_b128 v[132:135], v211 offset:0
    ds_read_b128 v[140:143], v211 offset:2048
    ds_read_b128 v[148:151], v211 offset:4096
    ds_read_b128 v[100:103], v214 offset:1024
    ds_read_b128 v[108:111], v214 offset:3072
    ds_read_b128 v[116:119], v214 offset:5120
    ds_read_b128 v[124:127], v214 offset:7168
    s_waitcnt lgkmcnt(0)
    s_barrier
    v_mfma_f32_16x16x32_bf16 v[0:3], v[96:99], v[128:131], 0
    ds_read_b128 v[152:155], v214 offset:28672
    v_mfma_f32_16x16x32_bf16 v[4:7], v[96:99], v[136:139], 0
    v_mfma_f32_16x16x32_bf16 v[8:11], v[96:99], v[144:147], 0
    ds_read_b128 v[184:187], v208 offset:28672
    v_mfma_f32_16x16x32_bf16 v[12:15], v[104:107], v[128:131], 0
    v_mfma_f32_16x16x32_bf16 v[16:19], v[104:107], v[136:139], 0
    ds_read_b128 v[192:195], v208 offset:30720
    v_mfma_f32_16x16x32_bf16 v[20:23], v[104:107], v[144:147], 0
    v_mfma_f32_16x16x32_bf16 v[24:27], v[112:115], v[128:131], 0
    ds_read_b128 v[200:203], v208 offset:32768
    v_mfma_f32_16x16x32_bf16 v[28:31], v[112:115], v[136:139], 0
    v_mfma_f32_16x16x32_bf16 v[32:35], v[112:115], v[144:147], 0
    ds_read_b128 v[160:163], v214 offset:30720
    v_mfma_f32_16x16x32_bf16 v[36:39], v[120:123], v[128:131], 0
    v_mfma_f32_16x16x32_bf16 v[40:43], v[120:123], v[136:139], 0
    ds_read_b128 v[168:171], v214 offset:32768
    v_mfma_f32_16x16x32_bf16 v[44:47], v[120:123], v[144:147], 0
    v_mfma_f32_16x16x32_bf16 v[48:51], v[96:99], v[132:135], 0
    ds_read_b128 v[176:179], v214 offset:34816
    v_mfma_f32_16x16x32_bf16 v[52:55], v[96:99], v[140:143], 0
    v_mfma_f32_16x16x32_bf16 v[56:59], v[96:99], v[148:151], 0
    ds_read_b128 v[188:191], v211 offset:28672
    v_mfma_f32_16x16x32_bf16 v[60:63], v[104:107], v[132:135], 0
    v_mfma_f32_16x16x32_bf16 v[64:67], v[104:107], v[140:143], 0
    ds_read_b128 v[196:199], v211 offset:30720
    v_mfma_f32_16x16x32_bf16 v[68:71], v[104:107], v[148:151], 0
    v_mfma_f32_16x16x32_bf16 v[72:75], v[112:115], v[132:135], 0
    ds_read_b128 v[204:207], v211 offset:32768
    v_mfma_f32_16x16x32_bf16 v[76:79], v[112:115], v[140:143], 0
    v_mfma_f32_16x16x32_bf16 v[80:83], v[112:115], v[148:151], 0
    ds_read_b128 v[156:159], v214 offset:29696
    v_mfma_f32_16x16x32_bf16 v[84:87], v[120:123], v[132:135], 0
    v_mfma_f32_16x16x32_bf16 v[88:91], v[120:123], v[140:143], 0
    ds_read_b128 v[164:167], v214 offset:31744
    v_mfma_f32_16x16x32_bf16 v[92:95], v[120:123], v[148:151], 0
    v_mfma_f32_16x16x32_bf16 v[48:51], v[100:103], v[128:131], v[48:51]
    ds_read_b128 v[172:175], v214 offset:33792
    v_xor_b32 v132, s34, v132
    v_xor_b32 v133, s34, v133
    v_mfma_f32_16x16x32_bf16 v[52:55], v[100:103], v[136:139], v[52:55]
    v_xor_b32 v134, s34, v134
    v_xor_b32 v135, s34, v135
    v_mfma_f32_16x16x32_bf16 v[56:59], v[100:103], v[144:147], v[56:59]
    ds_read_b128 v[180:183], v214 offset:35840
    v_xor_b32 v140, s34, v140
    v_xor_b32 v141, s34, v141
    v_mfma_f32_16x16x32_bf16 v[60:63], v[108:111], v[128:131], v[60:63]
    v_xor_b32 v142, s34, v142
    v_xor_b32 v143, s34, v143
    v_mfma_f32_16x16x32_bf16 v[64:67], v[108:111], v[136:139], v[64:67]
    v_xor_b32 v148, s34, v148
    v_xor_b32 v149, s34, v149
    v_mfma_f32_16x16x32_bf16 v[68:71], v[108:111], v[144:147], v[68:71]
    v_xor_b32 v150, s34, v150
    v_xor_b32 v151, s34, v151
    v_mfma_f32_16x16x32_bf16 v[72:75], v[116:119], v[128:131], v[72:75]
    v_mfma_f32_16x16x32_bf16 v[76:79], v[116:119], v[136:139], v[76:79]
    v_mfma_f32_16x16x32_bf16 v[80:83], v[116:119], v[144:147], v[80:83]
    v_mfma_f32_16x16x32_bf16 v[84:87], v[124:127], v[128:131], v[84:87]
    v_mfma_f32_16x16x32_bf16 v[88:91], v[124:127], v[136:139], v[88:91]
    v_mfma_f32_16x16x32_bf16 v[92:95], v[124:127], v[144:147], v[92:95]
    v_mfma_f32_16x16x32_bf16 v[0:3], v[100:103], v[132:135], v[0:3]
    v_mfma_f32_16x16x32_bf16 v[4:7], v[100:103], v[140:143], v[4:7]
    v_mfma_f32_16x16x32_bf16 v[8:11], v[100:103], v[148:151], v[8:11]
    v_mfma_f32_16x16x32_bf16 v[12:15], v[108:111], v[132:135], v[12:15]
    v_mfma_f32_16x16x32_bf16 v[16:19], v[108:111], v[140:143], v[16:19]
    s_waitcnt lgkmcnt(0)
    s_barrier
    v_mfma_f32_16x16x32_bf16 v[20:23], v[108:111], v[148:151], v[20:23]
    v_mfma_f32_16x16x32_bf16 v[24:27], v[116:119], v[132:135], v[24:27]
    v_mfma_f32_16x16x32_bf16 v[28:31], v[116:119], v[140:143], v[28:31]
    v_mfma_f32_16x16x32_bf16 v[32:35], v[116:119], v[148:151], v[32:35]
    v_mfma_f32_16x16x32_bf16 v[36:39], v[124:127], v[132:135], v[36:39]
    v_mfma_f32_16x16x32_bf16 v[40:43], v[124:127], v[140:143], v[40:43]
    v_mfma_f32_16x16x32_bf16 v[44:47], v[124:127], v[148:151], v[44:47]
    v_mfma_f32_16x16x32_bf16 v[0:3], v[152:155], v[184:187], v[0:3]
    ds_read_b128 v[96:99], v215 offset:0
    v_mfma_f32_16x16x32_bf16 v[4:7], v[152:155], v[192:195], v[4:7]
    v_mfma_f32_16x16x32_bf16 v[8:11], v[152:155], v[200:203], v[8:11]
    ds_read_b128 v[128:131], v209 offset:0
    v_mfma_f32_16x16x32_bf16 v[12:15], v[160:163], v[184:187], v[12:15]
    v_mfma_f32_16x16x32_bf16 v[16:19], v[160:163], v[192:195], v[16:19]
    ds_read_b128 v[136:139], v209 offset:2048
    v_mfma_f32_16x16x32_bf16 v[20:23], v[160:163], v[200:203], v[20:23]
    v_mfma_f32_16x16x32_bf16 v[24:27], v[168:171], v[184:187], v[24:27]
    ds_read_b128 v[144:147], v209 offset:4096
    v_mfma_f32_16x16x32_bf16 v[28:31], v[168:171], v[192:195], v[28:31]
    v_mfma_f32_16x16x32_bf16 v[32:35], v[168:171], v[200:203], v[32:35]
    ds_read_b128 v[104:107], v215 offset:2048
    v_mfma_f32_16x16x32_bf16 v[36:39], v[176:179], v[184:187], v[36:39]
    v_mfma_f32_16x16x32_bf16 v[40:43], v[176:179], v[192:195], v[40:43]
    ds_read_b128 v[112:115], v215 offset:4096
    v_mfma_f32_16x16x32_bf16 v[44:47], v[176:179], v[200:203], v[44:47]
    v_mfma_f32_16x16x32_bf16 v[48:51], v[152:155], v[188:191], v[48:51]
    ds_read_b128 v[120:123], v215 offset:6144
    v_mfma_f32_16x16x32_bf16 v[52:55], v[152:155], v[196:199], v[52:55]
    v_mfma_f32_16x16x32_bf16 v[56:59], v[152:155], v[204:207], v[56:59]
    ds_read_b128 v[132:135], v212 offset:0
    v_mfma_f32_16x16x32_bf16 v[60:63], v[160:163], v[188:191], v[60:63]
    v_mfma_f32_16x16x32_bf16 v[64:67], v[160:163], v[196:199], v[64:67]
    ds_read_b128 v[140:143], v212 offset:2048
    v_mfma_f32_16x16x32_bf16 v[68:71], v[160:163], v[204:207], v[68:71]
    v_mfma_f32_16x16x32_bf16 v[72:75], v[168:171], v[188:191], v[72:75]
    ds_read_b128 v[148:151], v212 offset:4096
    v_mfma_f32_16x16x32_bf16 v[76:79], v[168:171], v[196:199], v[76:79]
    v_mfma_f32_16x16x32_bf16 v[80:83], v[168:171], v[204:207], v[80:83]
    ds_read_b128 v[100:103], v215 offset:1024
    v_mfma_f32_16x16x32_bf16 v[84:87], v[176:179], v[188:191], v[84:87]
    v_mfma_f32_16x16x32_bf16 v[88:91], v[176:179], v[196:199], v[88:91]
    ds_read_b128 v[108:111], v215 offset:3072
    v_mfma_f32_16x16x32_bf16 v[92:95], v[176:179], v[204:207], v[92:95]
    v_mfma_f32_16x16x32_bf16 v[48:51], v[156:159], v[184:187], v[48:51]
    ds_read_b128 v[116:119], v215 offset:5120
    v_xor_b32 v188, s34, v188
    v_xor_b32 v189, s34, v189
    v_mfma_f32_16x16x32_bf16 v[52:55], v[156:159], v[192:195], v[52:55]
    v_xor_b32 v190, s34, v190
    v_xor_b32 v191, s34, v191
    v_mfma_f32_16x16x32_bf16 v[56:59], v[156:159], v[200:203], v[56:59]
    ds_read_b128 v[124:127], v215 offset:7168
    v_xor_b32 v196, s34, v196
    v_xor_b32 v197, s34, v197
    v_mfma_f32_16x16x32_bf16 v[60:63], v[164:167], v[184:187], v[60:63]
    v_xor_b32 v198, s34, v198
    v_xor_b32 v199, s34, v199
    v_mfma_f32_16x16x32_bf16 v[64:67], v[164:167], v[192:195], v[64:67]
    v_xor_b32 v204, s34, v204
    v_xor_b32 v205, s34, v205
    v_mfma_f32_16x16x32_bf16 v[68:71], v[164:167], v[200:203], v[68:71]
    v_xor_b32 v206, s34, v206
    v_xor_b32 v207, s34, v207
    v_mfma_f32_16x16x32_bf16 v[72:75], v[172:175], v[184:187], v[72:75]
    v_mfma_f32_16x16x32_bf16 v[76:79], v[172:175], v[192:195], v[76:79]
    v_mfma_f32_16x16x32_bf16 v[80:83], v[172:175], v[200:203], v[80:83]
    v_mfma_f32_16x16x32_bf16 v[84:87], v[180:183], v[184:187], v[84:87]
    v_mfma_f32_16x16x32_bf16 v[88:91], v[180:183], v[192:195], v[88:91]
    v_mfma_f32_16x16x32_bf16 v[92:95], v[180:183], v[200:203], v[92:95]
    v_mfma_f32_16x16x32_bf16 v[0:3], v[156:159], v[188:191], v[0:3]
    v_mfma_f32_16x16x32_bf16 v[4:7], v[156:159], v[196:199], v[4:7]
    v_mfma_f32_16x16x32_bf16 v[8:11], v[156:159], v[204:207], v[8:11]
    v_mfma_f32_16x16x32_bf16 v[12:15], v[164:167], v[188:191], v[12:15]
    v_mfma_f32_16x16x32_bf16 v[16:19], v[164:167], v[196:199], v[16:19]
    s_waitcnt lgkmcnt(0)
    s_barrier
    v_mfma_f32_16x16x32_bf16 v[20:23], v[164:167], v[204:207], v[20:23]
    v_mfma_f32_16x16x32_bf16 v[24:27], v[172:175], v[188:191], v[24:27]
    v_mfma_f32_16x16x32_bf16 v[28:31], v[172:175], v[196:199], v[28:31]
    v_mfma_f32_16x16x32_bf16 v[32:35], v[172:175], v[204:207], v[32:35]
    v_mfma_f32_16x16x32_bf16 v[36:39], v[180:183], v[188:191], v[36:39]
    v_mfma_f32_16x16x32_bf16 v[40:43], v[180:183], v[196:199], v[40:43]
    v_mfma_f32_16x16x32_bf16 v[44:47], v[180:183], v[204:207], v[44:47]
    v_mfma_f32_16x16x32_bf16 v[0:3], v[96:99], v[128:131], v[0:3]
    ds_read_b128 v[152:155], v215 offset:28672
    v_mfma_f32_16x16x32_bf16 v[4:7], v[96:99], v[136:139], v[4:7]
    v_mfma_f32_16x16x32_bf16 v[8:11], v[96:99], v[144:147], v[8:11]
    ds_read_b128 v[184:187], v209 offset:28672
    v_mfma_f32_16x16x32_bf16 v[12:15], v[104:107], v[128:131], v[12:15]
    v_mfma_f32_16x16x32_bf16 v[16:19], v[104:107], v[136:139], v[16:19]
    ds_read_b128 v[192:195], v209 offset:30720
    v_mfma_f32_16x16x32_bf16 v[20:23], v[104:107], v[144:147], v[20:23]
    v_mfma_f32_16x16x32_bf16 v[24:27], v[112:115], v[128:131], v[24:27]
    ds_read_b128 v[200:203], v209 offset:32768
    v_mfma_f32_16x16x32_bf16 v[28:31], v[112:115], v[136:139], v[28:31]
    v_mfma_f32_16x16x32_bf16 v[32:35], v[112:115], v[144:147], v[32:35]
    ds_read_b128 v[160:163], v215 offset:30720
    v_mfma_f32_16x16x32_bf16 v[36:39], v[120:123], v[128:131], v[36:39]
    v_mfma_f32_16x16x32_bf16 v[40:43], v[120:123], v[136:139], v[40:43]
    ds_read_b128 v[168:171], v215 offset:32768
    v_mfma_f32_16x16x32_bf16 v[44:47], v[120:123], v[144:147], v[44:47]
    v_mfma_f32_16x16x32_bf16 v[48:51], v[96:99], v[132:135], v[48:51]
    ds_read_b128 v[176:179], v215 offset:34816
    v_mfma_f32_16x16x32_bf16 v[52:55], v[96:99], v[140:143], v[52:55]
    v_mfma_f32_16x16x32_bf16 v[56:59], v[96:99], v[148:151], v[56:59]
    ds_read_b128 v[188:191], v212 offset:28672
    v_mfma_f32_16x16x32_bf16 v[60:63], v[104:107], v[132:135], v[60:63]
    v_mfma_f32_16x16x32_bf16 v[64:67], v[104:107], v[140:143], v[64:67]
    ds_read_b128 v[196:199], v212 offset:30720
    v_mfma_f32_16x16x32_bf16 v[68:71], v[104:107], v[148:151], v[68:71]
    v_mfma_f32_16x16x32_bf16 v[72:75], v[112:115], v[132:135], v[72:75]
    ds_read_b128 v[204:207], v212 offset:32768
    v_mfma_f32_16x16x32_bf16 v[76:79], v[112:115], v[140:143], v[76:79]
    v_mfma_f32_16x16x32_bf16 v[80:83], v[112:115], v[148:151], v[80:83]
    ds_read_b128 v[156:159], v215 offset:29696
    v_mfma_f32_16x16x32_bf16 v[84:87], v[120:123], v[132:135], v[84:87]
    v_mfma_f32_16x16x32_bf16 v[88:91], v[120:123], v[140:143], v[88:91]
    ds_read_b128 v[164:167], v215 offset:31744
    v_mfma_f32_16x16x32_bf16 v[92:95], v[120:123], v[148:151], v[92:95]
    v_mfma_f32_16x16x32_bf16 v[48:51], v[100:103], v[128:131], v[48:51]
    ds_read_b128 v[172:175], v215 offset:33792
    v_xor_b32 v132, s34, v132
    v_xor_b32 v133, s34, v133
    v_mfma_f32_16x16x32_bf16 v[52:55], v[100:103], v[136:139], v[52:55]
    v_xor_b32 v134, s34, v134
    v_xor_b32 v135, s34, v135
    v_mfma_f32_16x16x32_bf16 v[56:59], v[100:103], v[144:147], v[56:59]
    ds_read_b128 v[180:183], v215 offset:35840
    v_xor_b32 v140, s34, v140
    v_xor_b32 v141, s34, v141
    v_mfma_f32_16x16x32_bf16 v[60:63], v[108:111], v[128:131], v[60:63]
    v_xor_b32 v142, s34, v142
    v_xor_b32 v143, s34, v143
    v_mfma_f32_16x16x32_bf16 v[64:67], v[108:111], v[136:139], v[64:67]
    v_xor_b32 v148, s34, v148
    v_xor_b32 v149, s34, v149
    v_mfma_f32_16x16x32_bf16 v[68:71], v[108:111], v[144:147], v[68:71]
    v_xor_b32 v150, s34, v150
    v_xor_b32 v151, s34, v151
    v_mfma_f32_16x16x32_bf16 v[72:75], v[116:119], v[128:131], v[72:75]
    v_mfma_f32_16x16x32_bf16 v[76:79], v[116:119], v[136:139], v[76:79]
    v_mfma_f32_16x16x32_bf16 v[80:83], v[116:119], v[144:147], v[80:83]
    v_mfma_f32_16x16x32_bf16 v[84:87], v[124:127], v[128:131], v[84:87]
    v_mfma_f32_16x16x32_bf16 v[88:91], v[124:127], v[136:139], v[88:91]
    v_mfma_f32_16x16x32_bf16 v[92:95], v[124:127], v[144:147], v[92:95]
    v_mfma_f32_16x16x32_bf16 v[0:3], v[100:103], v[132:135], v[0:3]
    v_mfma_f32_16x16x32_bf16 v[4:7], v[100:103], v[140:143], v[4:7]
    v_mfma_f32_16x16x32_bf16 v[8:11], v[100:103], v[148:151], v[8:11]
    v_mfma_f32_16x16x32_bf16 v[12:15], v[108:111], v[132:135], v[12:15]
    v_mfma_f32_16x16x32_bf16 v[16:19], v[108:111], v[140:143], v[16:19]
    s_waitcnt lgkmcnt(0)
    s_barrier
    v_mfma_f32_16x16x32_bf16 v[20:23], v[108:111], v[148:151], v[20:23]
    v_mfma_f32_16x16x32_bf16 v[24:27], v[116:119], v[132:135], v[24:27]
    v_mfma_f32_16x16x32_bf16 v[28:31], v[116:119], v[140:143], v[28:31]
    v_mfma_f32_16x16x32_bf16 v[32:35], v[116:119], v[148:151], v[32:35]
    v_mfma_f32_16x16x32_bf16 v[36:39], v[124:127], v[132:135], v[36:39]
    v_mfma_f32_16x16x32_bf16 v[40:43], v[124:127], v[140:143], v[40:43]
    v_mfma_f32_16x16x32_bf16 v[44:47], v[124:127], v[148:151], v[44:47]
    v_mfma_f32_16x16x32_bf16 v[0:3], v[152:155], v[184:187], v[0:3]
    ds_read_b128 v[96:99], v216 offset:0
    v_mfma_f32_16x16x32_bf16 v[4:7], v[152:155], v[192:195], v[4:7]
    v_mfma_f32_16x16x32_bf16 v[8:11], v[152:155], v[200:203], v[8:11]
    ds_read_b128 v[128:131], v210 offset:0
    v_mfma_f32_16x16x32_bf16 v[12:15], v[160:163], v[184:187], v[12:15]
    v_mfma_f32_16x16x32_bf16 v[16:19], v[160:163], v[192:195], v[16:19]
    ds_read_b128 v[136:139], v210 offset:2048
    v_mfma_f32_16x16x32_bf16 v[20:23], v[160:163], v[200:203], v[20:23]
    v_mfma_f32_16x16x32_bf16 v[24:27], v[168:171], v[184:187], v[24:27]
    ds_read_b128 v[144:147], v210 offset:4096
    v_mfma_f32_16x16x32_bf16 v[28:31], v[168:171], v[192:195], v[28:31]
    v_mfma_f32_16x16x32_bf16 v[32:35], v[168:171], v[200:203], v[32:35]
    ds_read_b128 v[104:107], v216 offset:2048
    v_mfma_f32_16x16x32_bf16 v[36:39], v[176:179], v[184:187], v[36:39]
    v_mfma_f32_16x16x32_bf16 v[40:43], v[176:179], v[192:195], v[40:43]
    ds_read_b128 v[112:115], v216 offset:4096
    v_mfma_f32_16x16x32_bf16 v[44:47], v[176:179], v[200:203], v[44:47]
    v_mfma_f32_16x16x32_bf16 v[48:51], v[152:155], v[188:191], v[48:51]
    ds_read_b128 v[120:123], v216 offset:6144
    v_mfma_f32_16x16x32_bf16 v[52:55], v[152:155], v[196:199], v[52:55]
    v_mfma_f32_16x16x32_bf16 v[56:59], v[152:155], v[204:207], v[56:59]
    ds_read_b128 v[132:135], v213 offset:0
    v_mfma_f32_16x16x32_bf16 v[60:63], v[160:163], v[188:191], v[60:63]
    v_mfma_f32_16x16x32_bf16 v[64:67], v[160:163], v[196:199], v[64:67]
    ds_read_b128 v[140:143], v213 offset:2048
    v_mfma_f32_16x16x32_bf16 v[68:71], v[160:163], v[204:207], v[68:71]
    v_mfma_f32_16x16x32_bf16 v[72:75], v[168:171], v[188:191], v[72:75]
    ds_read_b128 v[148:151], v213 offset:4096
    v_mfma_f32_16x16x32_bf16 v[76:79], v[168:171], v[196:199], v[76:79]
    v_mfma_f32_16x16x32_bf16 v[80:83], v[168:171], v[204:207], v[80:83]
    ds_read_b128 v[100:103], v216 offset:1024
    v_mfma_f32_16x16x32_bf16 v[84:87], v[176:179], v[188:191], v[84:87]
    v_mfma_f32_16x16x32_bf16 v[88:91], v[176:179], v[196:199], v[88:91]
    ds_read_b128 v[108:111], v216 offset:3072
    v_mfma_f32_16x16x32_bf16 v[92:95], v[176:179], v[204:207], v[92:95]
    v_mfma_f32_16x16x32_bf16 v[48:51], v[156:159], v[184:187], v[48:51]
    ds_read_b128 v[116:119], v216 offset:5120
    v_xor_b32 v188, s34, v188
    v_xor_b32 v189, s34, v189
    v_mfma_f32_16x16x32_bf16 v[52:55], v[156:159], v[192:195], v[52:55]
    v_xor_b32 v190, s34, v190
    v_xor_b32 v191, s34, v191
    v_mfma_f32_16x16x32_bf16 v[56:59], v[156:159], v[200:203], v[56:59]
    ds_read_b128 v[124:127], v216 offset:7168
    v_xor_b32 v196, s34, v196
    v_xor_b32 v197, s34, v197
    v_mfma_f32_16x16x32_bf16 v[60:63], v[164:167], v[184:187], v[60:63]
    v_xor_b32 v198, s34, v198
    v_xor_b32 v199, s34, v199
    v_mfma_f32_16x16x32_bf16 v[64:67], v[164:167], v[192:195], v[64:67]
    v_xor_b32 v204, s34, v204
    v_xor_b32 v205, s34, v205
    v_mfma_f32_16x16x32_bf16 v[68:71], v[164:167], v[200:203], v[68:71]
    v_xor_b32 v206, s34, v206
    v_xor_b32 v207, s34, v207
    v_mfma_f32_16x16x32_bf16 v[72:75], v[172:175], v[184:187], v[72:75]
    v_mfma_f32_16x16x32_bf16 v[76:79], v[172:175], v[192:195], v[76:79]
    v_mfma_f32_16x16x32_bf16 v[80:83], v[172:175], v[200:203], v[80:83]
    v_mfma_f32_16x16x32_bf16 v[84:87], v[180:183], v[184:187], v[84:87]
    v_mfma_f32_16x16x32_bf16 v[88:91], v[180:183], v[192:195], v[88:91]
    v_mfma_f32_16x16x32_bf16 v[92:95], v[180:183], v[200:203], v[92:95]
    v_mfma_f32_16x16x32_bf16 v[0:3], v[156:159], v[188:191], v[0:3]
    v_mfma_f32_16x16x32_bf16 v[4:7], v[156:159], v[196:199], v[4:7]
    v_mfma_f32_16x16x32_bf16 v[8:11], v[156:159], v[204:207], v[8:11]
    v_mfma_f32_16x16x32_bf16 v[12:15], v[164:167], v[188:191], v[12:15]
    v_mfma_f32_16x16x32_bf16 v[16:19], v[164:167], v[196:199], v[16:19]
    s_waitcnt lgkmcnt(0)
    s_barrier
    v_mfma_f32_16x16x32_bf16 v[20:23], v[164:167], v[204:207], v[20:23]
    v_mfma_f32_16x16x32_bf16 v[24:27], v[172:175], v[188:191], v[24:27]
    v_mfma_f32_16x16x32_bf16 v[28:31], v[172:175], v[196:199], v[28:31]
    v_mfma_f32_16x16x32_bf16 v[32:35], v[172:175], v[204:207], v[32:35]
    v_mfma_f32_16x16x32_bf16 v[36:39], v[180:183], v[188:191], v[36:39]
    v_mfma_f32_16x16x32_bf16 v[40:43], v[180:183], v[196:199], v[40:43]
    v_mfma_f32_16x16x32_bf16 v[44:47], v[180:183], v[204:207], v[44:47]
    v_mfma_f32_16x16x32_bf16 v[0:3], v[96:99], v[128:131], v[0:3]
    ds_read_b128 v[152:155], v214 offset:0
    v_mfma_f32_16x16x32_bf16 v[4:7], v[96:99], v[136:139], v[4:7]
    v_mfma_f32_16x16x32_bf16 v[8:11], v[96:99], v[144:147], v[8:11]
    ds_read_b128 v[184:187], v208 offset:0
    v_mfma_f32_16x16x32_bf16 v[12:15], v[104:107], v[128:131], v[12:15]
    v_mfma_f32_16x16x32_bf16 v[16:19], v[104:107], v[136:139], v[16:19]
    ds_read_b128 v[192:195], v208 offset:2048
    v_mfma_f32_16x16x32_bf16 v[20:23], v[104:107], v[144:147], v[20:23]
    v_mfma_f32_16x16x32_bf16 v[24:27], v[112:115], v[128:131], v[24:27]
    ds_read_b128 v[200:203], v208 offset:4096
    v_mfma_f32_16x16x32_bf16 v[28:31], v[112:115], v[136:139], v[28:31]
    v_mfma_f32_16x16x32_bf16 v[32:35], v[112:115], v[144:147], v[32:35]
    ds_read_b128 v[160:163], v214 offset:2048
    v_mfma_f32_16x16x32_bf16 v[36:39], v[120:123], v[128:131], v[36:39]
    v_mfma_f32_16x16x32_bf16 v[40:43], v[120:123], v[136:139], v[40:43]
    ds_read_b128 v[168:171], v214 offset:4096
    v_mfma_f32_16x16x32_bf16 v[44:47], v[120:123], v[144:147], v[44:47]
    v_mfma_f32_16x16x32_bf16 v[48:51], v[96:99], v[132:135], v[48:51]
    ds_read_b128 v[176:179], v214 offset:6144
    v_mfma_f32_16x16x32_bf16 v[52:55], v[96:99], v[140:143], v[52:55]
    v_mfma_f32_16x16x32_bf16 v[56:59], v[96:99], v[148:151], v[56:59]
    ds_read_b128 v[188:191], v211 offset:0
    v_mfma_f32_16x16x32_bf16 v[60:63], v[104:107], v[132:135], v[60:63]
    v_mfma_f32_16x16x32_bf16 v[64:67], v[104:107], v[140:143], v[64:67]
    ds_read_b128 v[196:199], v211 offset:2048
    v_mfma_f32_16x16x32_bf16 v[68:71], v[104:107], v[148:151], v[68:71]
    v_mfma_f32_16x16x32_bf16 v[72:75], v[112:115], v[132:135], v[72:75]
    ds_read_b128 v[204:207], v211 offset:4096
    v_mfma_f32_16x16x32_bf16 v[76:79], v[112:115], v[140:143], v[76:79]
    v_mfma_f32_16x16x32_bf16 v[80:83], v[112:115], v[148:151], v[80:83]
    ds_read_b128 v[156:159], v214 offset:1024
    v_mfma_f32_16x16x32_bf16 v[84:87], v[120:123], v[132:135], v[84:87]
    v_mfma_f32_16x16x32_bf16 v[88:91], v[120:123], v[140:143], v[88:91]
    ds_read_b128 v[164:167], v214 offset:3072
    v_mfma_f32_16x16x32_bf16 v[92:95], v[120:123], v[148:151], v[92:95]
    v_mfma_f32_16x16x32_bf16 v[48:51], v[100:103], v[128:131], v[48:51]
    ds_read_b128 v[172:175], v214 offset:5120
    v_xor_b32 v132, s34, v132
    v_xor_b32 v133, s34, v133
    v_mfma_f32_16x16x32_bf16 v[52:55], v[100:103], v[136:139], v[52:55]
    v_xor_b32 v134, s34, v134
    v_xor_b32 v135, s34, v135
    v_mfma_f32_16x16x32_bf16 v[56:59], v[100:103], v[144:147], v[56:59]
    ds_read_b128 v[180:183], v214 offset:7168
    v_xor_b32 v140, s34, v140
    v_xor_b32 v141, s34, v141
    v_mfma_f32_16x16x32_bf16 v[60:63], v[108:111], v[128:131], v[60:63]
    v_xor_b32 v142, s34, v142
    v_xor_b32 v143, s34, v143
    v_mfma_f32_16x16x32_bf16 v[64:67], v[108:111], v[136:139], v[64:67]
    v_xor_b32 v148, s34, v148
    v_xor_b32 v149, s34, v149
    v_mfma_f32_16x16x32_bf16 v[68:71], v[108:111], v[144:147], v[68:71]
    v_xor_b32 v150, s34, v150
    v_xor_b32 v151, s34, v151
    v_mfma_f32_16x16x32_bf16 v[72:75], v[116:119], v[128:131], v[72:75]
    v_mfma_f32_16x16x32_bf16 v[76:79], v[116:119], v[136:139], v[76:79]
    v_mfma_f32_16x16x32_bf16 v[80:83], v[116:119], v[144:147], v[80:83]
    v_mfma_f32_16x16x32_bf16 v[84:87], v[124:127], v[128:131], v[84:87]
    v_mfma_f32_16x16x32_bf16 v[88:91], v[124:127], v[136:139], v[88:91]
    v_mfma_f32_16x16x32_bf16 v[92:95], v[124:127], v[144:147], v[92:95]
    v_mfma_f32_16x16x32_bf16 v[0:3], v[100:103], v[132:135], v[0:3]
    v_mfma_f32_16x16x32_bf16 v[4:7], v[100:103], v[140:143], v[4:7]
    v_mfma_f32_16x16x32_bf16 v[8:11], v[100:103], v[148:151], v[8:11]
    v_mfma_f32_16x16x32_bf16 v[12:15], v[108:111], v[132:135], v[12:15]
    v_mfma_f32_16x16x32_bf16 v[16:19], v[108:111], v[140:143], v[16:19]
    s_waitcnt lgkmcnt(0)
    s_barrier
    v_mfma_f32_16x16x32_bf16 v[20:23], v[108:111], v[148:151], v[20:23]
    v_mfma_f32_16x16x32_bf16 v[24:27], v[116:119], v[132:135], v[24:27]
    v_mfma_f32_16x16x32_bf16 v[28:31], v[116:119], v[140:143], v[28:31]
    v_mfma_f32_16x16x32_bf16 v[32:35], v[116:119], v[148:151], v[32:35]
    v_mfma_f32_16x16x32_bf16 v[36:39], v[124:127], v[132:135], v[36:39]
    v_mfma_f32_16x16x32_bf16 v[40:43], v[124:127], v[140:143], v[40:43]
    v_mfma_f32_16x16x32_bf16 v[44:47], v[124:127], v[148:151], v[44:47]
    v_mfma_f32_16x16x32_bf16 v[0:3], v[152:155], v[184:187], v[0:3]
    ds_read_b128 v[96:99], v214 offset:28672
    v_mfma_f32_16x16x32_bf16 v[4:7], v[152:155], v[192:195], v[4:7]
    v_mfma_f32_16x16x32_bf16 v[8:11], v[152:155], v[200:203], v[8:11]
    ds_read_b128 v[128:131], v208 offset:28672
    v_mfma_f32_16x16x32_bf16 v[12:15], v[160:163], v[184:187], v[12:15]
    v_mfma_f32_16x16x32_bf16 v[16:19], v[160:163], v[192:195], v[16:19]
    ds_read_b128 v[136:139], v208 offset:30720
    v_mfma_f32_16x16x32_bf16 v[20:23], v[160:163], v[200:203], v[20:23]
    v_mfma_f32_16x16x32_bf16 v[24:27], v[168:171], v[184:187], v[24:27]
    ds_read_b128 v[144:147], v208 offset:32768
    v_mfma_f32_16x16x32_bf16 v[28:31], v[168:171], v[192:195], v[28:31]
    v_mfma_f32_16x16x32_bf16 v[32:35], v[168:171], v[200:203], v[32:35]
    ds_read_b128 v[104:107], v214 offset:30720
    v_mfma_f32_16x16x32_bf16 v[36:39], v[176:179], v[184:187], v[36:39]
    v_mfma_f32_16x16x32_bf16 v[40:43], v[176:179], v[192:195], v[40:43]
    ds_read_b128 v[112:115], v214 offset:32768
    v_mfma_f32_16x16x32_bf16 v[44:47], v[176:179], v[200:203], v[44:47]
    v_mfma_f32_16x16x32_bf16 v[48:51], v[152:155], v[188:191], v[48:51]
    ds_read_b128 v[120:123], v214 offset:34816
    v_mfma_f32_16x16x32_bf16 v[52:55], v[152:155], v[196:199], v[52:55]
    v_mfma_f32_16x16x32_bf16 v[56:59], v[152:155], v[204:207], v[56:59]
    ds_read_b128 v[132:135], v211 offset:28672
    v_mfma_f32_16x16x32_bf16 v[60:63], v[160:163], v[188:191], v[60:63]
    v_mfma_f32_16x16x32_bf16 v[64:67], v[160:163], v[196:199], v[64:67]
    ds_read_b128 v[140:143], v211 offset:30720
    v_mfma_f32_16x16x32_bf16 v[68:71], v[160:163], v[204:207], v[68:71]
    v_mfma_f32_16x16x32_bf16 v[72:75], v[168:171], v[188:191], v[72:75]
    ds_read_b128 v[148:151], v211 offset:32768
    v_mfma_f32_16x16x32_bf16 v[76:79], v[168:171], v[196:199], v[76:79]
    v_mfma_f32_16x16x32_bf16 v[80:83], v[168:171], v[204:207], v[80:83]
    ds_read_b128 v[100:103], v214 offset:29696
    v_mfma_f32_16x16x32_bf16 v[84:87], v[176:179], v[188:191], v[84:87]
    v_mfma_f32_16x16x32_bf16 v[88:91], v[176:179], v[196:199], v[88:91]
    ds_read_b128 v[108:111], v214 offset:31744
    v_mfma_f32_16x16x32_bf16 v[92:95], v[176:179], v[204:207], v[92:95]
    v_mfma_f32_16x16x32_bf16 v[48:51], v[156:159], v[184:187], v[48:51]
    ds_read_b128 v[116:119], v214 offset:33792
    v_xor_b32 v188, s34, v188
    v_xor_b32 v189, s34, v189
    v_mfma_f32_16x16x32_bf16 v[52:55], v[156:159], v[192:195], v[52:55]
    v_xor_b32 v190, s34, v190
    v_xor_b32 v191, s34, v191
    v_mfma_f32_16x16x32_bf16 v[56:59], v[156:159], v[200:203], v[56:59]
    ds_read_b128 v[124:127], v214 offset:35840
    v_xor_b32 v196, s34, v196
    v_xor_b32 v197, s34, v197
    v_mfma_f32_16x16x32_bf16 v[60:63], v[164:167], v[184:187], v[60:63]
    v_xor_b32 v198, s34, v198
    v_xor_b32 v199, s34, v199
    v_mfma_f32_16x16x32_bf16 v[64:67], v[164:167], v[192:195], v[64:67]
    v_xor_b32 v204, s34, v204
    v_xor_b32 v205, s34, v205
    v_mfma_f32_16x16x32_bf16 v[68:71], v[164:167], v[200:203], v[68:71]
    v_xor_b32 v206, s34, v206
    v_xor_b32 v207, s34, v207
    v_mfma_f32_16x16x32_bf16 v[72:75], v[172:175], v[184:187], v[72:75]
    v_mfma_f32_16x16x32_bf16 v[76:79], v[172:175], v[192:195], v[76:79]
    v_mfma_f32_16x16x32_bf16 v[80:83], v[172:175], v[200:203], v[80:83]
    v_mfma_f32_16x16x32_bf16 v[84:87], v[180:183], v[184:187], v[84:87]
    v_mfma_f32_16x16x32_bf16 v[88:91], v[180:183], v[192:195], v[88:91]
    v_mfma_f32_16x16x32_bf16 v[92:95], v[180:183], v[200:203], v[92:95]
    v_mfma_f32_16x16x32_bf16 v[0:3], v[156:159], v[188:191], v[0:3]
    v_mfma_f32_16x16x32_bf16 v[4:7], v[156:159], v[196:199], v[4:7]
    v_mfma_f32_16x16x32_bf16 v[8:11], v[156:159], v[204:207], v[8:11]
    v_mfma_f32_16x16x32_bf16 v[12:15], v[164:167], v[188:191], v[12:15]
    v_mfma_f32_16x16x32_bf16 v[16:19], v[164:167], v[196:199], v[16:19]
    s_waitcnt lgkmcnt(0)
    s_barrier
    v_mfma_f32_16x16x32_bf16 v[20:23], v[164:167], v[204:207], v[20:23]
    v_mfma_f32_16x16x32_bf16 v[24:27], v[172:175], v[188:191], v[24:27]
    v_mfma_f32_16x16x32_bf16 v[28:31], v[172:175], v[196:199], v[28:31]
    v_mfma_f32_16x16x32_bf16 v[32:35], v[172:175], v[204:207], v[32:35]
    v_mfma_f32_16x16x32_bf16 v[36:39], v[180:183], v[188:191], v[36:39]
    v_mfma_f32_16x16x32_bf16 v[40:43], v[180:183], v[196:199], v[40:43]
    v_mfma_f32_16x16x32_bf16 v[44:47], v[180:183], v[204:207], v[44:47]
    v_mfma_f32_16x16x32_bf16 v[0:3], v[96:99], v[128:131], v[0:3]
    ds_read_b128 v[152:155], v215 offset:0
    v_mfma_f32_16x16x32_bf16 v[4:7], v[96:99], v[136:139], v[4:7]
    v_mfma_f32_16x16x32_bf16 v[8:11], v[96:99], v[144:147], v[8:11]
    ds_read_b128 v[184:187], v209 offset:0
    v_mfma_f32_16x16x32_bf16 v[12:15], v[104:107], v[128:131], v[12:15]
    v_mfma_f32_16x16x32_bf16 v[16:19], v[104:107], v[136:139], v[16:19]
    ds_read_b128 v[192:195], v209 offset:2048
    v_mfma_f32_16x16x32_bf16 v[20:23], v[104:107], v[144:147], v[20:23]
    v_mfma_f32_16x16x32_bf16 v[24:27], v[112:115], v[128:131], v[24:27]
    ds_read_b128 v[200:203], v209 offset:4096
    v_mfma_f32_16x16x32_bf16 v[28:31], v[112:115], v[136:139], v[28:31]
    v_mfma_f32_16x16x32_bf16 v[32:35], v[112:115], v[144:147], v[32:35]
    ds_read_b128 v[160:163], v215 offset:2048
    v_mfma_f32_16x16x32_bf16 v[36:39], v[120:123], v[128:131], v[36:39]
    v_mfma_f32_16x16x32_bf16 v[40:43], v[120:123], v[136:139], v[40:43]
    ds_read_b128 v[168:171], v215 offset:4096
    v_mfma_f32_16x16x32_bf16 v[44:47], v[120:123], v[144:147], v[44:47]
    v_mfma_f32_16x16x32_bf16 v[48:51], v[96:99], v[132:135], v[48:51]
    ds_read_b128 v[176:179], v215 offset:6144
    v_mfma_f32_16x16x32_bf16 v[52:55], v[96:99], v[140:143], v[52:55]
    v_mfma_f32_16x16x32_bf16 v[56:59], v[96:99], v[148:151], v[56:59]
    ds_read_b128 v[188:191], v212 offset:0
    v_mfma_f32_16x16x32_bf16 v[60:63], v[104:107], v[132:135], v[60:63]
    v_mfma_f32_16x16x32_bf16 v[64:67], v[104:107], v[140:143], v[64:67]
    ds_read_b128 v[196:199], v212 offset:2048
    v_mfma_f32_16x16x32_bf16 v[68:71], v[104:107], v[148:151], v[68:71]
    v_mfma_f32_16x16x32_bf16 v[72:75], v[112:115], v[132:135], v[72:75]
    ds_read_b128 v[204:207], v212 offset:4096
    v_mfma_f32_16x16x32_bf16 v[76:79], v[112:115], v[140:143], v[76:79]
    v_mfma_f32_16x16x32_bf16 v[80:83], v[112:115], v[148:151], v[80:83]
    ds_read_b128 v[156:159], v215 offset:1024
    v_mfma_f32_16x16x32_bf16 v[84:87], v[120:123], v[132:135], v[84:87]
    v_mfma_f32_16x16x32_bf16 v[88:91], v[120:123], v[140:143], v[88:91]
    ds_read_b128 v[164:167], v215 offset:3072
    v_mfma_f32_16x16x32_bf16 v[92:95], v[120:123], v[148:151], v[92:95]
    v_mfma_f32_16x16x32_bf16 v[48:51], v[100:103], v[128:131], v[48:51]
    ds_read_b128 v[172:175], v215 offset:5120
    v_xor_b32 v132, s34, v132
    v_xor_b32 v133, s34, v133
    v_mfma_f32_16x16x32_bf16 v[52:55], v[100:103], v[136:139], v[52:55]
    v_xor_b32 v134, s34, v134
    v_xor_b32 v135, s34, v135
    v_mfma_f32_16x16x32_bf16 v[56:59], v[100:103], v[144:147], v[56:59]
    ds_read_b128 v[180:183], v215 offset:7168
    v_xor_b32 v140, s34, v140
    v_xor_b32 v141, s34, v141
    v_mfma_f32_16x16x32_bf16 v[60:63], v[108:111], v[128:131], v[60:63]
    v_xor_b32 v142, s34, v142
    v_xor_b32 v143, s34, v143
    v_mfma_f32_16x16x32_bf16 v[64:67], v[108:111], v[136:139], v[64:67]
    v_xor_b32 v148, s34, v148
    v_xor_b32 v149, s34, v149
    v_mfma_f32_16x16x32_bf16 v[68:71], v[108:111], v[144:147], v[68:71]
    v_xor_b32 v150, s34, v150
    v_xor_b32 v151, s34, v151
    v_mfma_f32_16x16x32_bf16 v[72:75], v[116:119], v[128:131], v[72:75]
    v_mfma_f32_16x16x32_bf16 v[76:79], v[116:119], v[136:139], v[76:79]
    v_mfma_f32_16x16x32_bf16 v[80:83], v[116:119], v[144:147], v[80:83]
    v_mfma_f32_16x16x32_bf16 v[84:87], v[124:127], v[128:131], v[84:87]
    v_mfma_f32_16x16x32_bf16 v[88:91], v[124:127], v[136:139], v[88:91]
    v_mfma_f32_16x16x32_bf16 v[92:95], v[124:127], v[144:147], v[92:95]
    v_mfma_f32_16x16x32_bf16 v[0:3], v[100:103], v[132:135], v[0:3]
    v_mfma_f32_16x16x32_bf16 v[4:7], v[100:103], v[140:143], v[4:7]
    v_mfma_f32_16x16x32_bf16 v[8:11], v[100:103], v[148:151], v[8:11]
    v_mfma_f32_16x16x32_bf16 v[12:15], v[108:111], v[132:135], v[12:15]
    v_mfma_f32_16x16x32_bf16 v[16:19], v[108:111], v[140:143], v[16:19]
    s_waitcnt lgkmcnt(0)
    s_barrier
    v_mfma_f32_16x16x32_bf16 v[20:23], v[108:111], v[148:151], v[20:23]
    v_mfma_f32_16x16x32_bf16 v[24:27], v[116:119], v[132:135], v[24:27]
    v_mfma_f32_16x16x32_bf16 v[28:31], v[116:119], v[140:143], v[28:31]
    v_mfma_f32_16x16x32_bf16 v[32:35], v[116:119], v[148:151], v[32:35]
    v_mfma_f32_16x16x32_bf16 v[36:39], v[124:127], v[132:135], v[36:39]
    v_mfma_f32_16x16x32_bf16 v[40:43], v[124:127], v[140:143], v[40:43]
    v_mfma_f32_16x16x32_bf16 v[44:47], v[124:127], v[148:151], v[44:47]
    v_mfma_f32_16x16x32_bf16 v[0:3], v[152:155], v[184:187], v[0:3]
    ds_read_b128 v[96:99], v215 offset:28672
    v_mfma_f32_16x16x32_bf16 v[4:7], v[152:155], v[192:195], v[4:7]
    v_mfma_f32_16x16x32_bf16 v[8:11], v[152:155], v[200:203], v[8:11]
    ds_read_b128 v[128:131], v209 offset:28672
    v_mfma_f32_16x16x32_bf16 v[12:15], v[160:163], v[184:187], v[12:15]
    v_mfma_f32_16x16x32_bf16 v[16:19], v[160:163], v[192:195], v[16:19]
    ds_read_b128 v[136:139], v209 offset:30720
    v_mfma_f32_16x16x32_bf16 v[20:23], v[160:163], v[200:203], v[20:23]
    v_mfma_f32_16x16x32_bf16 v[24:27], v[168:171], v[184:187], v[24:27]
    ds_read_b128 v[144:147], v209 offset:32768
    v_mfma_f32_16x16x32_bf16 v[28:31], v[168:171], v[192:195], v[28:31]
    v_mfma_f32_16x16x32_bf16 v[32:35], v[168:171], v[200:203], v[32:35]
    ds_read_b128 v[104:107], v215 offset:30720
    v_mfma_f32_16x16x32_bf16 v[36:39], v[176:179], v[184:187], v[36:39]
    v_mfma_f32_16x16x32_bf16 v[40:43], v[176:179], v[192:195], v[40:43]
    ds_read_b128 v[112:115], v215 offset:32768
    v_mfma_f32_16x16x32_bf16 v[44:47], v[176:179], v[200:203], v[44:47]
    v_mfma_f32_16x16x32_bf16 v[48:51], v[152:155], v[188:191], v[48:51]
    ds_read_b128 v[120:123], v215 offset:34816
    v_mfma_f32_16x16x32_bf16 v[52:55], v[152:155], v[196:199], v[52:55]
    v_mfma_f32_16x16x32_bf16 v[56:59], v[152:155], v[204:207], v[56:59]
    ds_read_b128 v[132:135], v212 offset:28672
    v_mfma_f32_16x16x32_bf16 v[60:63], v[160:163], v[188:191], v[60:63]
    v_mfma_f32_16x16x32_bf16 v[64:67], v[160:163], v[196:199], v[64:67]
    ds_read_b128 v[140:143], v212 offset:30720
    v_mfma_f32_16x16x32_bf16 v[68:71], v[160:163], v[204:207], v[68:71]
    v_mfma_f32_16x16x32_bf16 v[72:75], v[168:171], v[188:191], v[72:75]
    ds_read_b128 v[148:151], v212 offset:32768
    v_mfma_f32_16x16x32_bf16 v[76:79], v[168:171], v[196:199], v[76:79]
    v_mfma_f32_16x16x32_bf16 v[80:83], v[168:171], v[204:207], v[80:83]
    ds_read_b128 v[100:103], v215 offset:29696
    v_mfma_f32_16x16x32_bf16 v[84:87], v[176:179], v[188:191], v[84:87]
    v_mfma_f32_16x16x32_bf16 v[88:91], v[176:179], v[196:199], v[88:91]
    ds_read_b128 v[108:111], v215 offset:31744
    v_mfma_f32_16x16x32_bf16 v[92:95], v[176:179], v[204:207], v[92:95]
    v_mfma_f32_16x16x32_bf16 v[48:51], v[156:159], v[184:187], v[48:51]
    ds_read_b128 v[116:119], v215 offset:33792
    v_xor_b32 v188, s34, v188
    v_xor_b32 v189, s34, v189
    v_mfma_f32_16x16x32_bf16 v[52:55], v[156:159], v[192:195], v[52:55]
    v_xor_b32 v190, s34, v190
    v_xor_b32 v191, s34, v191
    v_mfma_f32_16x16x32_bf16 v[56:59], v[156:159], v[200:203], v[56:59]
    ds_read_b128 v[124:127], v215 offset:35840
    v_xor_b32 v196, s34, v196
    v_xor_b32 v197, s34, v197
    v_mfma_f32_16x16x32_bf16 v[60:63], v[164:167], v[184:187], v[60:63]
    v_xor_b32 v198, s34, v198
    v_xor_b32 v199, s34, v199
    v_mfma_f32_16x16x32_bf16 v[64:67], v[164:167], v[192:195], v[64:67]
    v_xor_b32 v204, s34, v204
    v_xor_b32 v205, s34, v205
    v_mfma_f32_16x16x32_bf16 v[68:71], v[164:167], v[200:203], v[68:71]
    v_xor_b32 v206, s34, v206
    v_xor_b32 v207, s34, v207
    v_mfma_f32_16x16x32_bf16 v[72:75], v[172:175], v[184:187], v[72:75]
    v_mfma_f32_16x16x32_bf16 v[76:79], v[172:175], v[192:195], v[76:79]
    v_mfma_f32_16x16x32_bf16 v[80:83], v[172:175], v[200:203], v[80:83]
    v_mfma_f32_16x16x32_bf16 v[84:87], v[180:183], v[184:187], v[84:87]
    v_mfma_f32_16x16x32_bf16 v[88:91], v[180:183], v[192:195], v[88:91]
    v_mfma_f32_16x16x32_bf16 v[92:95], v[180:183], v[200:203], v[92:95]
    v_mfma_f32_16x16x32_bf16 v[0:3], v[156:159], v[188:191], v[0:3]
    v_mfma_f32_16x16x32_bf16 v[4:7], v[156:159], v[196:199], v[4:7]
    v_mfma_f32_16x16x32_bf16 v[8:11], v[156:159], v[204:207], v[8:11]
    v_mfma_f32_16x16x32_bf16 v[12:15], v[164:167], v[188:191], v[12:15]
    v_mfma_f32_16x16x32_bf16 v[16:19], v[164:167], v[196:199], v[16:19]
    s_waitcnt lgkmcnt(0)
    s_barrier
    v_mfma_f32_16x16x32_bf16 v[20:23], v[164:167], v[204:207], v[20:23]
    v_mfma_f32_16x16x32_bf16 v[24:27], v[172:175], v[188:191], v[24:27]
    v_mfma_f32_16x16x32_bf16 v[28:31], v[172:175], v[196:199], v[28:31]
    v_mfma_f32_16x16x32_bf16 v[32:35], v[172:175], v[204:207], v[32:35]
    v_mfma_f32_16x16x32_bf16 v[36:39], v[180:183], v[188:191], v[36:39]
    v_mfma_f32_16x16x32_bf16 v[40:43], v[180:183], v[196:199], v[40:43]
    v_mfma_f32_16x16x32_bf16 v[44:47], v[180:183], v[204:207], v[44:47]
    v_mfma_f32_16x16x32_bf16 v[0:3], v[96:99], v[128:131], v[0:3]
    ds_read_b128 v[152:155], v216 offset:0
    v_mfma_f32_16x16x32_bf16 v[4:7], v[96:99], v[136:139], v[4:7]
    v_mfma_f32_16x16x32_bf16 v[8:11], v[96:99], v[144:147], v[8:11]
    ds_read_b128 v[184:187], v210 offset:0
    v_mfma_f32_16x16x32_bf16 v[12:15], v[104:107], v[128:131], v[12:15]
    v_mfma_f32_16x16x32_bf16 v[16:19], v[104:107], v[136:139], v[16:19]
    ds_read_b128 v[192:195], v210 offset:2048
    v_mfma_f32_16x16x32_bf16 v[20:23], v[104:107], v[144:147], v[20:23]
    v_mfma_f32_16x16x32_bf16 v[24:27], v[112:115], v[128:131], v[24:27]
    ds_read_b128 v[200:203], v210 offset:4096
    v_mfma_f32_16x16x32_bf16 v[28:31], v[112:115], v[136:139], v[28:31]
    v_mfma_f32_16x16x32_bf16 v[32:35], v[112:115], v[144:147], v[32:35]
    ds_read_b128 v[160:163], v216 offset:2048
    v_mfma_f32_16x16x32_bf16 v[36:39], v[120:123], v[128:131], v[36:39]
    v_mfma_f32_16x16x32_bf16 v[40:43], v[120:123], v[136:139], v[40:43]
    ds_read_b128 v[168:171], v216 offset:4096
    v_mfma_f32_16x16x32_bf16 v[44:47], v[120:123], v[144:147], v[44:47]
    v_mfma_f32_16x16x32_bf16 v[48:51], v[96:99], v[132:135], v[48:51]
    ds_read_b128 v[176:179], v216 offset:6144
    v_mfma_f32_16x16x32_bf16 v[52:55], v[96:99], v[140:143], v[52:55]
    v_mfma_f32_16x16x32_bf16 v[56:59], v[96:99], v[148:151], v[56:59]
    ds_read_b128 v[188:191], v213 offset:0
    v_mfma_f32_16x16x32_bf16 v[60:63], v[104:107], v[132:135], v[60:63]
    v_mfma_f32_16x16x32_bf16 v[64:67], v[104:107], v[140:143], v[64:67]
    ds_read_b128 v[196:199], v213 offset:2048
    v_mfma_f32_16x16x32_bf16 v[68:71], v[104:107], v[148:151], v[68:71]
    v_mfma_f32_16x16x32_bf16 v[72:75], v[112:115], v[132:135], v[72:75]
    ds_read_b128 v[204:207], v213 offset:4096
    v_mfma_f32_16x16x32_bf16 v[76:79], v[112:115], v[140:143], v[76:79]
    v_mfma_f32_16x16x32_bf16 v[80:83], v[112:115], v[148:151], v[80:83]
    ds_read_b128 v[156:159], v216 offset:1024
    v_mfma_f32_16x16x32_bf16 v[84:87], v[120:123], v[132:135], v[84:87]
    v_mfma_f32_16x16x32_bf16 v[88:91], v[120:123], v[140:143], v[88:91]
    ds_read_b128 v[164:167], v216 offset:3072
    v_mfma_f32_16x16x32_bf16 v[92:95], v[120:123], v[148:151], v[92:95]
    v_mfma_f32_16x16x32_bf16 v[48:51], v[100:103], v[128:131], v[48:51]
    ds_read_b128 v[172:175], v216 offset:5120
    v_xor_b32 v132, s34, v132
    v_xor_b32 v133, s34, v133
    v_mfma_f32_16x16x32_bf16 v[52:55], v[100:103], v[136:139], v[52:55]
    v_xor_b32 v134, s34, v134
    v_xor_b32 v135, s34, v135
    v_mfma_f32_16x16x32_bf16 v[56:59], v[100:103], v[144:147], v[56:59]
    ds_read_b128 v[180:183], v216 offset:7168
    v_xor_b32 v140, s34, v140
    v_xor_b32 v141, s34, v141
    v_mfma_f32_16x16x32_bf16 v[60:63], v[108:111], v[128:131], v[60:63]
    v_xor_b32 v142, s34, v142
    v_xor_b32 v143, s34, v143
    v_mfma_f32_16x16x32_bf16 v[64:67], v[108:111], v[136:139], v[64:67]
    v_xor_b32 v148, s34, v148
    v_xor_b32 v149, s34, v149
    v_mfma_f32_16x16x32_bf16 v[68:71], v[108:111], v[144:147], v[68:71]
    v_xor_b32 v150, s34, v150
    v_xor_b32 v151, s34, v151
    v_mfma_f32_16x16x32_bf16 v[72:75], v[116:119], v[128:131], v[72:75]
    v_mfma_f32_16x16x32_bf16 v[76:79], v[116:119], v[136:139], v[76:79]
    v_mfma_f32_16x16x32_bf16 v[80:83], v[116:119], v[144:147], v[80:83]
    v_mfma_f32_16x16x32_bf16 v[84:87], v[124:127], v[128:131], v[84:87]
    v_mfma_f32_16x16x32_bf16 v[88:91], v[124:127], v[136:139], v[88:91]
    v_mfma_f32_16x16x32_bf16 v[92:95], v[124:127], v[144:147], v[92:95]
    v_mfma_f32_16x16x32_bf16 v[0:3], v[100:103], v[132:135], v[0:3]
    v_mfma_f32_16x16x32_bf16 v[4:7], v[100:103], v[140:143], v[4:7]
    v_mfma_f32_16x16x32_bf16 v[8:11], v[100:103], v[148:151], v[8:11]
    v_mfma_f32_16x16x32_bf16 v[12:15], v[108:111], v[132:135], v[12:15]
    v_mfma_f32_16x16x32_bf16 v[16:19], v[108:111], v[140:143], v[16:19]
    s_waitcnt lgkmcnt(0)
    s_barrier
    v_mfma_f32_16x16x32_bf16 v[20:23], v[108:111], v[148:151], v[20:23]
    v_mfma_f32_16x16x32_bf16 v[24:27], v[116:119], v[132:135], v[24:27]
    v_mfma_f32_16x16x32_bf16 v[28:31], v[116:119], v[140:143], v[28:31]
    v_mfma_f32_16x16x32_bf16 v[32:35], v[116:119], v[148:151], v[32:35]
    v_mfma_f32_16x16x32_bf16 v[36:39], v[124:127], v[132:135], v[36:39]
    v_mfma_f32_16x16x32_bf16 v[40:43], v[124:127], v[140:143], v[40:43]
    v_mfma_f32_16x16x32_bf16 v[44:47], v[124:127], v[148:151], v[44:47]
    v_mfma_f32_16x16x32_bf16 v[0:3], v[152:155], v[184:187], v[0:3]
    ds_read_b128 v[96:99], v214 offset:0
    v_mfma_f32_16x16x32_bf16 v[4:7], v[152:155], v[192:195], v[4:7]
    v_mfma_f32_16x16x32_bf16 v[8:11], v[152:155], v[200:203], v[8:11]
    ds_read_b128 v[128:131], v208 offset:0
    v_mfma_f32_16x16x32_bf16 v[12:15], v[160:163], v[184:187], v[12:15]
    v_mfma_f32_16x16x32_bf16 v[16:19], v[160:163], v[192:195], v[16:19]
    ds_read_b128 v[136:139], v208 offset:2048
    v_mfma_f32_16x16x32_bf16 v[20:23], v[160:163], v[200:203], v[20:23]
    v_mfma_f32_16x16x32_bf16 v[24:27], v[168:171], v[184:187], v[24:27]
    ds_read_b128 v[144:147], v208 offset:4096
    v_mfma_f32_16x16x32_bf16 v[28:31], v[168:171], v[192:195], v[28:31]
    v_mfma_f32_16x16x32_bf16 v[32:35], v[168:171], v[200:203], v[32:35]
    ds_read_b128 v[104:107], v214 offset:2048
    v_mfma_f32_16x16x32_bf16 v[36:39], v[176:179], v[184:187], v[36:39]
    v_mfma_f32_16x16x32_bf16 v[40:43], v[176:179], v[192:195], v[40:43]
    ds_read_b128 v[112:115], v214 offset:4096
    v_mfma_f32_16x16x32_bf16 v[44:47], v[176:179], v[200:203], v[44:47]
    v_mfma_f32_16x16x32_bf16 v[48:51], v[152:155], v[188:191], v[48:51]
    ds_read_b128 v[120:123], v214 offset:6144
    v_mfma_f32_16x16x32_bf16 v[52:55], v[152:155], v[196:199], v[52:55]
    v_mfma_f32_16x16x32_bf16 v[56:59], v[152:155], v[204:207], v[56:59]
    ds_read_b128 v[132:135], v211 offset:0
    v_mfma_f32_16x16x32_bf16 v[60:63], v[160:163], v[188:191], v[60:63]
    v_mfma_f32_16x16x32_bf16 v[64:67], v[160:163], v[196:199], v[64:67]
    ds_read_b128 v[140:143], v211 offset:2048
    v_mfma_f32_16x16x32_bf16 v[68:71], v[160:163], v[204:207], v[68:71]
    v_mfma_f32_16x16x32_bf16 v[72:75], v[168:171], v[188:191], v[72:75]
    ds_read_b128 v[148:151], v211 offset:4096
    v_mfma_f32_16x16x32_bf16 v[76:79], v[168:171], v[196:199], v[76:79]
    v_mfma_f32_16x16x32_bf16 v[80:83], v[168:171], v[204:207], v[80:83]
    ds_read_b128 v[100:103], v214 offset:1024
    v_mfma_f32_16x16x32_bf16 v[84:87], v[176:179], v[188:191], v[84:87]
    v_mfma_f32_16x16x32_bf16 v[88:91], v[176:179], v[196:199], v[88:91]
    ds_read_b128 v[108:111], v214 offset:3072
    v_mfma_f32_16x16x32_bf16 v[92:95], v[176:179], v[204:207], v[92:95]
    v_mfma_f32_16x16x32_bf16 v[48:51], v[156:159], v[184:187], v[48:51]
    ds_read_b128 v[116:119], v214 offset:5120
    v_xor_b32 v188, s34, v188
    v_xor_b32 v189, s34, v189
    v_mfma_f32_16x16x32_bf16 v[52:55], v[156:159], v[192:195], v[52:55]
    v_xor_b32 v190, s34, v190
    v_xor_b32 v191, s34, v191
    v_mfma_f32_16x16x32_bf16 v[56:59], v[156:159], v[200:203], v[56:59]
    ds_read_b128 v[124:127], v214 offset:7168
    v_xor_b32 v196, s34, v196
    v_xor_b32 v197, s34, v197
    v_mfma_f32_16x16x32_bf16 v[60:63], v[164:167], v[184:187], v[60:63]
    v_xor_b32 v198, s34, v198
    v_xor_b32 v199, s34, v199
    v_mfma_f32_16x16x32_bf16 v[64:67], v[164:167], v[192:195], v[64:67]
    v_xor_b32 v204, s34, v204
    v_xor_b32 v205, s34, v205
    v_mfma_f32_16x16x32_bf16 v[68:71], v[164:167], v[200:203], v[68:71]
    v_xor_b32 v206, s34, v206
    v_xor_b32 v207, s34, v207
    v_mfma_f32_16x16x32_bf16 v[72:75], v[172:175], v[184:187], v[72:75]
    v_mfma_f32_16x16x32_bf16 v[76:79], v[172:175], v[192:195], v[76:79]
    v_mfma_f32_16x16x32_bf16 v[80:83], v[172:175], v[200:203], v[80:83]
    v_mfma_f32_16x16x32_bf16 v[84:87], v[180:183], v[184:187], v[84:87]
    v_mfma_f32_16x16x32_bf16 v[88:91], v[180:183], v[192:195], v[88:91]
    v_mfma_f32_16x16x32_bf16 v[92:95], v[180:183], v[200:203], v[92:95]
    v_mfma_f32_16x16x32_bf16 v[0:3], v[156:159], v[188:191], v[0:3]
    v_mfma_f32_16x16x32_bf16 v[4:7], v[156:159], v[196:199], v[4:7]
    v_mfma_f32_16x16x32_bf16 v[8:11], v[156:159], v[204:207], v[8:11]
    v_mfma_f32_16x16x32_bf16 v[12:15], v[164:167], v[188:191], v[12:15]
    v_mfma_f32_16x16x32_bf16 v[16:19], v[164:167], v[196:199], v[16:19]
    s_waitcnt lgkmcnt(0)
    s_barrier
    v_mfma_f32_16x16x32_bf16 v[20:23], v[164:167], v[204:207], v[20:23]
    v_mfma_f32_16x16x32_bf16 v[24:27], v[172:175], v[188:191], v[24:27]
    v_mfma_f32_16x16x32_bf16 v[28:31], v[172:175], v[196:199], v[28:31]
    v_mfma_f32_16x16x32_bf16 v[32:35], v[172:175], v[204:207], v[32:35]
    v_mfma_f32_16x16x32_bf16 v[36:39], v[180:183], v[188:191], v[36:39]
    v_mfma_f32_16x16x32_bf16 v[40:43], v[180:183], v[196:199], v[40:43]
    v_mfma_f32_16x16x32_bf16 v[44:47], v[180:183], v[204:207], v[44:47]
    v_mfma_f32_16x16x32_bf16 v[0:3], v[96:99], v[128:131], v[0:3]
    ds_read_b128 v[152:155], v214 offset:28672
    v_mfma_f32_16x16x32_bf16 v[4:7], v[96:99], v[136:139], v[4:7]
    v_mfma_f32_16x16x32_bf16 v[8:11], v[96:99], v[144:147], v[8:11]
    ds_read_b128 v[184:187], v208 offset:28672
    v_mfma_f32_16x16x32_bf16 v[12:15], v[104:107], v[128:131], v[12:15]
    v_mfma_f32_16x16x32_bf16 v[16:19], v[104:107], v[136:139], v[16:19]
    ds_read_b128 v[192:195], v208 offset:30720
    v_mfma_f32_16x16x32_bf16 v[20:23], v[104:107], v[144:147], v[20:23]
    v_mfma_f32_16x16x32_bf16 v[24:27], v[112:115], v[128:131], v[24:27]
    ds_read_b128 v[200:203], v208 offset:32768
    v_mfma_f32_16x16x32_bf16 v[28:31], v[112:115], v[136:139], v[28:31]
    v_mfma_f32_16x16x32_bf16 v[32:35], v[112:115], v[144:147], v[32:35]
    ds_read_b128 v[160:163], v214 offset:30720
    v_mfma_f32_16x16x32_bf16 v[36:39], v[120:123], v[128:131], v[36:39]
    v_mfma_f32_16x16x32_bf16 v[40:43], v[120:123], v[136:139], v[40:43]
    ds_read_b128 v[168:171], v214 offset:32768
    v_mfma_f32_16x16x32_bf16 v[44:47], v[120:123], v[144:147], v[44:47]
    v_mfma_f32_16x16x32_bf16 v[48:51], v[96:99], v[132:135], v[48:51]
    ds_read_b128 v[176:179], v214 offset:34816
    v_mfma_f32_16x16x32_bf16 v[52:55], v[96:99], v[140:143], v[52:55]
    v_mfma_f32_16x16x32_bf16 v[56:59], v[96:99], v[148:151], v[56:59]
    ds_read_b128 v[188:191], v211 offset:28672
    v_mfma_f32_16x16x32_bf16 v[60:63], v[104:107], v[132:135], v[60:63]
    v_mfma_f32_16x16x32_bf16 v[64:67], v[104:107], v[140:143], v[64:67]
    ds_read_b128 v[196:199], v211 offset:30720
    v_mfma_f32_16x16x32_bf16 v[68:71], v[104:107], v[148:151], v[68:71]
    v_mfma_f32_16x16x32_bf16 v[72:75], v[112:115], v[132:135], v[72:75]
    ds_read_b128 v[204:207], v211 offset:32768
    v_mfma_f32_16x16x32_bf16 v[76:79], v[112:115], v[140:143], v[76:79]
    v_mfma_f32_16x16x32_bf16 v[80:83], v[112:115], v[148:151], v[80:83]
    ds_read_b128 v[156:159], v214 offset:29696
    v_mfma_f32_16x16x32_bf16 v[84:87], v[120:123], v[132:135], v[84:87]
    v_mfma_f32_16x16x32_bf16 v[88:91], v[120:123], v[140:143], v[88:91]
    ds_read_b128 v[164:167], v214 offset:31744
    v_mfma_f32_16x16x32_bf16 v[92:95], v[120:123], v[148:151], v[92:95]
    v_mfma_f32_16x16x32_bf16 v[48:51], v[100:103], v[128:131], v[48:51]
    ds_read_b128 v[172:175], v214 offset:33792
    v_xor_b32 v132, s34, v132
    v_xor_b32 v133, s34, v133
    v_mfma_f32_16x16x32_bf16 v[52:55], v[100:103], v[136:139], v[52:55]
    v_xor_b32 v134, s34, v134
    v_xor_b32 v135, s34, v135
    v_mfma_f32_16x16x32_bf16 v[56:59], v[100:103], v[144:147], v[56:59]
    ds_read_b128 v[180:183], v214 offset:35840
    v_xor_b32 v140, s34, v140
    v_xor_b32 v141, s34, v141
    v_mfma_f32_16x16x32_bf16 v[60:63], v[108:111], v[128:131], v[60:63]
    v_xor_b32 v142, s34, v142
    v_xor_b32 v143, s34, v143
    v_mfma_f32_16x16x32_bf16 v[64:67], v[108:111], v[136:139], v[64:67]
    v_xor_b32 v148, s34, v148
    v_xor_b32 v149, s34, v149
    v_mfma_f32_16x16x32_bf16 v[68:71], v[108:111], v[144:147], v[68:71]
    v_xor_b32 v150, s34, v150
    v_xor_b32 v151, s34, v151
    v_mfma_f32_16x16x32_bf16 v[72:75], v[116:119], v[128:131], v[72:75]
    v_mfma_f32_16x16x32_bf16 v[76:79], v[116:119], v[136:139], v[76:79]
    v_mfma_f32_16x16x32_bf16 v[80:83], v[116:119], v[144:147], v[80:83]
    v_mfma_f32_16x16x32_bf16 v[84:87], v[124:127], v[128:131], v[84:87]
    v_mfma_f32_16x16x32_bf16 v[88:91], v[124:127], v[136:139], v[88:91]
    v_mfma_f32_16x16x32_bf16 v[92:95], v[124:127], v[144:147], v[92:95]
    v_mfma_f32_16x16x32_bf16 v[0:3], v[100:103], v[132:135], v[0:3]
    v_mfma_f32_16x16x32_bf16 v[4:7], v[100:103], v[140:143], v[4:7]
    v_mfma_f32_16x16x32_bf16 v[8:11], v[100:103], v[148:151], v[8:11]
    v_mfma_f32_16x16x32_bf16 v[12:15], v[108:111], v[132:135], v[12:15]
    v_mfma_f32_16x16x32_bf16 v[16:19], v[108:111], v[140:143], v[16:19]
    s_waitcnt lgkmcnt(0)
    s_barrier
    v_mfma_f32_16x16x32_bf16 v[20:23], v[108:111], v[148:151], v[20:23]
    v_mfma_f32_16x16x32_bf16 v[24:27], v[116:119], v[132:135], v[24:27]
    v_mfma_f32_16x16x32_bf16 v[28:31], v[116:119], v[140:143], v[28:31]
    v_mfma_f32_16x16x32_bf16 v[32:35], v[116:119], v[148:151], v[32:35]
    v_mfma_f32_16x16x32_bf16 v[36:39], v[124:127], v[132:135], v[36:39]
    v_mfma_f32_16x16x32_bf16 v[40:43], v[124:127], v[140:143], v[40:43]
    v_mfma_f32_16x16x32_bf16 v[44:47], v[124:127], v[148:151], v[44:47]
    v_mfma_f32_16x16x32_bf16 v[0:3], v[152:155], v[184:187], v[0:3]
    ds_read_b128 v[96:99], v215 offset:0
    v_mfma_f32_16x16x32_bf16 v[4:7], v[152:155], v[192:195], v[4:7]
    v_mfma_f32_16x16x32_bf16 v[8:11], v[152:155], v[200:203], v[8:11]
    ds_read_b128 v[128:131], v209 offset:0
    v_mfma_f32_16x16x32_bf16 v[12:15], v[160:163], v[184:187], v[12:15]
    v_mfma_f32_16x16x32_bf16 v[16:19], v[160:163], v[192:195], v[16:19]
    ds_read_b128 v[136:139], v209 offset:2048
    v_mfma_f32_16x16x32_bf16 v[20:23], v[160:163], v[200:203], v[20:23]
    v_mfma_f32_16x16x32_bf16 v[24:27], v[168:171], v[184:187], v[24:27]
    ds_read_b128 v[144:147], v209 offset:4096
    v_mfma_f32_16x16x32_bf16 v[28:31], v[168:171], v[192:195], v[28:31]
    v_mfma_f32_16x16x32_bf16 v[32:35], v[168:171], v[200:203], v[32:35]
    ds_read_b128 v[104:107], v215 offset:2048
    v_mfma_f32_16x16x32_bf16 v[36:39], v[176:179], v[184:187], v[36:39]
    v_mfma_f32_16x16x32_bf16 v[40:43], v[176:179], v[192:195], v[40:43]
    ds_read_b128 v[112:115], v215 offset:4096
    v_mfma_f32_16x16x32_bf16 v[44:47], v[176:179], v[200:203], v[44:47]
    v_mfma_f32_16x16x32_bf16 v[48:51], v[152:155], v[188:191], v[48:51]
    ds_read_b128 v[120:123], v215 offset:6144
    v_mfma_f32_16x16x32_bf16 v[52:55], v[152:155], v[196:199], v[52:55]
    v_mfma_f32_16x16x32_bf16 v[56:59], v[152:155], v[204:207], v[56:59]
    ds_read_b128 v[132:135], v212 offset:0
    v_mfma_f32_16x16x32_bf16 v[60:63], v[160:163], v[188:191], v[60:63]
    v_mfma_f32_16x16x32_bf16 v[64:67], v[160:163], v[196:199], v[64:67]
    ds_read_b128 v[140:143], v212 offset:2048
    v_mfma_f32_16x16x32_bf16 v[68:71], v[160:163], v[204:207], v[68:71]
    v_mfma_f32_16x16x32_bf16 v[72:75], v[168:171], v[188:191], v[72:75]
    ds_read_b128 v[148:151], v212 offset:4096
    v_mfma_f32_16x16x32_bf16 v[76:79], v[168:171], v[196:199], v[76:79]
    v_mfma_f32_16x16x32_bf16 v[80:83], v[168:171], v[204:207], v[80:83]
    ds_read_b128 v[100:103], v215 offset:1024
    v_mfma_f32_16x16x32_bf16 v[84:87], v[176:179], v[188:191], v[84:87]
    v_mfma_f32_16x16x32_bf16 v[88:91], v[176:179], v[196:199], v[88:91]
    ds_read_b128 v[108:111], v215 offset:3072
    v_mfma_f32_16x16x32_bf16 v[92:95], v[176:179], v[204:207], v[92:95]
    v_mfma_f32_16x16x32_bf16 v[48:51], v[156:159], v[184:187], v[48:51]
    ds_read_b128 v[116:119], v215 offset:5120
    v_xor_b32 v188, s34, v188
    v_xor_b32 v189, s34, v189
    v_mfma_f32_16x16x32_bf16 v[52:55], v[156:159], v[192:195], v[52:55]
    v_xor_b32 v190, s34, v190
    v_xor_b32 v191, s34, v191
    v_mfma_f32_16x16x32_bf16 v[56:59], v[156:159], v[200:203], v[56:59]
    ds_read_b128 v[124:127], v215 offset:7168
    v_xor_b32 v196, s34, v196
    v_xor_b32 v197, s34, v197
    v_mfma_f32_16x16x32_bf16 v[60:63], v[164:167], v[184:187], v[60:63]
    v_xor_b32 v198, s34, v198
    v_xor_b32 v199, s34, v199
    v_mfma_f32_16x16x32_bf16 v[64:67], v[164:167], v[192:195], v[64:67]
    v_xor_b32 v204, s34, v204
    v_xor_b32 v205, s34, v205
    v_mfma_f32_16x16x32_bf16 v[68:71], v[164:167], v[200:203], v[68:71]
    v_xor_b32 v206, s34, v206
    v_xor_b32 v207, s34, v207
    v_mfma_f32_16x16x32_bf16 v[72:75], v[172:175], v[184:187], v[72:75]
    v_mfma_f32_16x16x32_bf16 v[76:79], v[172:175], v[192:195], v[76:79]
    v_mfma_f32_16x16x32_bf16 v[80:83], v[172:175], v[200:203], v[80:83]
    v_mfma_f32_16x16x32_bf16 v[84:87], v[180:183], v[184:187], v[84:87]
    v_mfma_f32_16x16x32_bf16 v[88:91], v[180:183], v[192:195], v[88:91]
    v_mfma_f32_16x16x32_bf16 v[92:95], v[180:183], v[200:203], v[92:95]
    v_mfma_f32_16x16x32_bf16 v[0:3], v[156:159], v[188:191], v[0:3]
    v_mfma_f32_16x16x32_bf16 v[4:7], v[156:159], v[196:199], v[4:7]
    v_mfma_f32_16x16x32_bf16 v[8:11], v[156:159], v[204:207], v[8:11]
    v_mfma_f32_16x16x32_bf16 v[12:15], v[164:167], v[188:191], v[12:15]
    v_mfma_f32_16x16x32_bf16 v[16:19], v[164:167], v[196:199], v[16:19]
    s_waitcnt lgkmcnt(0)
    s_barrier
    v_mfma_f32_16x16x32_bf16 v[20:23], v[164:167], v[204:207], v[20:23]
    v_mfma_f32_16x16x32_bf16 v[24:27], v[172:175], v[188:191], v[24:27]
    v_mfma_f32_16x16x32_bf16 v[28:31], v[172:175], v[196:199], v[28:31]
    v_mfma_f32_16x16x32_bf16 v[32:35], v[172:175], v[204:207], v[32:35]
    v_mfma_f32_16x16x32_bf16 v[36:39], v[180:183], v[188:191], v[36:39]
    v_mfma_f32_16x16x32_bf16 v[40:43], v[180:183], v[196:199], v[40:43]
    v_mfma_f32_16x16x32_bf16 v[44:47], v[180:183], v[204:207], v[44:47]
    v_mfma_f32_16x16x32_bf16 v[0:3], v[96:99], v[128:131], v[0:3]
    ds_read_b128 v[152:155], v215 offset:28672
    v_mfma_f32_16x16x32_bf16 v[4:7], v[96:99], v[136:139], v[4:7]
    v_mfma_f32_16x16x32_bf16 v[8:11], v[96:99], v[144:147], v[8:11]
    ds_read_b128 v[184:187], v209 offset:28672
    v_mfma_f32_16x16x32_bf16 v[12:15], v[104:107], v[128:131], v[12:15]
    v_mfma_f32_16x16x32_bf16 v[16:19], v[104:107], v[136:139], v[16:19]
    ds_read_b128 v[192:195], v209 offset:30720
    v_mfma_f32_16x16x32_bf16 v[20:23], v[104:107], v[144:147], v[20:23]
    v_mfma_f32_16x16x32_bf16 v[24:27], v[112:115], v[128:131], v[24:27]
    ds_read_b128 v[200:203], v209 offset:32768
    v_mfma_f32_16x16x32_bf16 v[28:31], v[112:115], v[136:139], v[28:31]
    v_mfma_f32_16x16x32_bf16 v[32:35], v[112:115], v[144:147], v[32:35]
    ds_read_b128 v[160:163], v215 offset:30720
    v_mfma_f32_16x16x32_bf16 v[36:39], v[120:123], v[128:131], v[36:39]
    v_mfma_f32_16x16x32_bf16 v[40:43], v[120:123], v[136:139], v[40:43]
    ds_read_b128 v[168:171], v215 offset:32768
    v_mfma_f32_16x16x32_bf16 v[44:47], v[120:123], v[144:147], v[44:47]
    v_mfma_f32_16x16x32_bf16 v[48:51], v[96:99], v[132:135], v[48:51]
    ds_read_b128 v[176:179], v215 offset:34816
    v_mfma_f32_16x16x32_bf16 v[52:55], v[96:99], v[140:143], v[52:55]
    v_mfma_f32_16x16x32_bf16 v[56:59], v[96:99], v[148:151], v[56:59]
    ds_read_b128 v[188:191], v212 offset:28672
    v_mfma_f32_16x16x32_bf16 v[60:63], v[104:107], v[132:135], v[60:63]
    v_mfma_f32_16x16x32_bf16 v[64:67], v[104:107], v[140:143], v[64:67]
    ds_read_b128 v[196:199], v212 offset:30720
    v_mfma_f32_16x16x32_bf16 v[68:71], v[104:107], v[148:151], v[68:71]
    v_mfma_f32_16x16x32_bf16 v[72:75], v[112:115], v[132:135], v[72:75]
    ds_read_b128 v[204:207], v212 offset:32768
    v_mfma_f32_16x16x32_bf16 v[76:79], v[112:115], v[140:143], v[76:79]
    v_mfma_f32_16x16x32_bf16 v[80:83], v[112:115], v[148:151], v[80:83]
    ds_read_b128 v[156:159], v215 offset:29696
    v_mfma_f32_16x16x32_bf16 v[84:87], v[120:123], v[132:135], v[84:87]
    v_mfma_f32_16x16x32_bf16 v[88:91], v[120:123], v[140:143], v[88:91]
    ds_read_b128 v[164:167], v215 offset:31744
    v_mfma_f32_16x16x32_bf16 v[92:95], v[120:123], v[148:151], v[92:95]
    v_mfma_f32_16x16x32_bf16 v[48:51], v[100:103], v[128:131], v[48:51]
    ds_read_b128 v[172:175], v215 offset:33792
    v_xor_b32 v132, s34, v132
    v_xor_b32 v133, s34, v133
    v_mfma_f32_16x16x32_bf16 v[52:55], v[100:103], v[136:139], v[52:55]
    v_xor_b32 v134, s34, v134
    v_xor_b32 v135, s34, v135
    v_mfma_f32_16x16x32_bf16 v[56:59], v[100:103], v[144:147], v[56:59]
    ds_read_b128 v[180:183], v215 offset:35840
    v_xor_b32 v140, s34, v140
    v_xor_b32 v141, s34, v141
    v_mfma_f32_16x16x32_bf16 v[60:63], v[108:111], v[128:131], v[60:63]
    v_xor_b32 v142, s34, v142
    v_xor_b32 v143, s34, v143
    v_mfma_f32_16x16x32_bf16 v[64:67], v[108:111], v[136:139], v[64:67]
    v_xor_b32 v148, s34, v148
    v_xor_b32 v149, s34, v149
    v_mfma_f32_16x16x32_bf16 v[68:71], v[108:111], v[144:147], v[68:71]
    v_xor_b32 v150, s34, v150
    v_xor_b32 v151, s34, v151
    v_mfma_f32_16x16x32_bf16 v[72:75], v[116:119], v[128:131], v[72:75]
    v_mfma_f32_16x16x32_bf16 v[76:79], v[116:119], v[136:139], v[76:79]
    v_mfma_f32_16x16x32_bf16 v[80:83], v[116:119], v[144:147], v[80:83]
    v_mfma_f32_16x16x32_bf16 v[84:87], v[124:127], v[128:131], v[84:87]
    v_mfma_f32_16x16x32_bf16 v[88:91], v[124:127], v[136:139], v[88:91]
    v_mfma_f32_16x16x32_bf16 v[92:95], v[124:127], v[144:147], v[92:95]
    v_mfma_f32_16x16x32_bf16 v[0:3], v[100:103], v[132:135], v[0:3]
    v_mfma_f32_16x16x32_bf16 v[4:7], v[100:103], v[140:143], v[4:7]
    v_mfma_f32_16x16x32_bf16 v[8:11], v[100:103], v[148:151], v[8:11]
    v_mfma_f32_16x16x32_bf16 v[12:15], v[108:111], v[132:135], v[12:15]
    v_mfma_f32_16x16x32_bf16 v[16:19], v[108:111], v[140:143], v[16:19]
    s_waitcnt lgkmcnt(0)
    s_barrier
    v_mfma_f32_16x16x32_bf16 v[20:23], v[108:111], v[148:151], v[20:23]
    v_mfma_f32_16x16x32_bf16 v[24:27], v[116:119], v[132:135], v[24:27]
    v_mfma_f32_16x16x32_bf16 v[28:31], v[116:119], v[140:143], v[28:31]
    v_mfma_f32_16x16x32_bf16 v[32:35], v[116:119], v[148:151], v[32:35]
    v_mfma_f32_16x16x32_bf16 v[36:39], v[124:127], v[132:135], v[36:39]
    v_mfma_f32_16x16x32_bf16 v[40:43], v[124:127], v[140:143], v[40:43]
    v_mfma_f32_16x16x32_bf16 v[44:47], v[124:127], v[148:151], v[44:47]
    v_mfma_f32_16x16x32_bf16 v[0:3], v[152:155], v[184:187], v[0:3]
    ds_read_b128 v[96:99], v216 offset:0
    v_mfma_f32_16x16x32_bf16 v[4:7], v[152:155], v[192:195], v[4:7]
    v_mfma_f32_16x16x32_bf16 v[8:11], v[152:155], v[200:203], v[8:11]
    ds_read_b128 v[128:131], v210 offset:0
    v_mfma_f32_16x16x32_bf16 v[12:15], v[160:163], v[184:187], v[12:15]
    v_mfma_f32_16x16x32_bf16 v[16:19], v[160:163], v[192:195], v[16:19]
    ds_read_b128 v[136:139], v210 offset:2048
    v_mfma_f32_16x16x32_bf16 v[20:23], v[160:163], v[200:203], v[20:23]
    v_mfma_f32_16x16x32_bf16 v[24:27], v[168:171], v[184:187], v[24:27]
    ds_read_b128 v[144:147], v210 offset:4096
    v_mfma_f32_16x16x32_bf16 v[28:31], v[168:171], v[192:195], v[28:31]
    v_mfma_f32_16x16x32_bf16 v[32:35], v[168:171], v[200:203], v[32:35]
    ds_read_b128 v[104:107], v216 offset:2048
    v_mfma_f32_16x16x32_bf16 v[36:39], v[176:179], v[184:187], v[36:39]
    v_mfma_f32_16x16x32_bf16 v[40:43], v[176:179], v[192:195], v[40:43]
    ds_read_b128 v[112:115], v216 offset:4096
    v_mfma_f32_16x16x32_bf16 v[44:47], v[176:179], v[200:203], v[44:47]
    v_mfma_f32_16x16x32_bf16 v[48:51], v[152:155], v[188:191], v[48:51]
    ds_read_b128 v[120:123], v216 offset:6144
    v_mfma_f32_16x16x32_bf16 v[52:55], v[152:155], v[196:199], v[52:55]
    v_mfma_f32_16x16x32_bf16 v[56:59], v[152:155], v[204:207], v[56:59]
    ds_read_b128 v[132:135], v213 offset:0
    v_mfma_f32_16x16x32_bf16 v[60:63], v[160:163], v[188:191], v[60:63]
    v_mfma_f32_16x16x32_bf16 v[64:67], v[160:163], v[196:199], v[64:67]
    ds_read_b128 v[140:143], v213 offset:2048
    v_mfma_f32_16x16x32_bf16 v[68:71], v[160:163], v[204:207], v[68:71]
    v_mfma_f32_16x16x32_bf16 v[72:75], v[168:171], v[188:191], v[72:75]
    ds_read_b128 v[148:151], v213 offset:4096
    v_mfma_f32_16x16x32_bf16 v[76:79], v[168:171], v[196:199], v[76:79]
    v_mfma_f32_16x16x32_bf16 v[80:83], v[168:171], v[204:207], v[80:83]
    ds_read_b128 v[100:103], v216 offset:1024
    v_mfma_f32_16x16x32_bf16 v[84:87], v[176:179], v[188:191], v[84:87]
    v_mfma_f32_16x16x32_bf16 v[88:91], v[176:179], v[196:199], v[88:91]
    ds_read_b128 v[108:111], v216 offset:3072
    v_mfma_f32_16x16x32_bf16 v[92:95], v[176:179], v[204:207], v[92:95]
    v_mfma_f32_16x16x32_bf16 v[48:51], v[156:159], v[184:187], v[48:51]
    ds_read_b128 v[116:119], v216 offset:5120
    v_xor_b32 v188, s34, v188
    v_xor_b32 v189, s34, v189
    v_mfma_f32_16x16x32_bf16 v[52:55], v[156:159], v[192:195], v[52:55]
    v_xor_b32 v190, s34, v190
    v_xor_b32 v191, s34, v191
    v_mfma_f32_16x16x32_bf16 v[56:59], v[156:159], v[200:203], v[56:59]
    ds_read_b128 v[124:127], v216 offset:7168
    v_xor_b32 v196, s34, v196
    v_xor_b32 v197, s34, v197
    v_mfma_f32_16x16x32_bf16 v[60:63], v[164:167], v[184:187], v[60:63]
    v_xor_b32 v198, s34, v198
    v_xor_b32 v199, s34, v199
    v_mfma_f32_16x16x32_bf16 v[64:67], v[164:167], v[192:195], v[64:67]
    v_xor_b32 v204, s34, v204
    v_xor_b32 v205, s34, v205
    v_mfma_f32_16x16x32_bf16 v[68:71], v[164:167], v[200:203], v[68:71]
    v_xor_b32 v206, s34, v206
    v_xor_b32 v207, s34, v207
    v_mfma_f32_16x16x32_bf16 v[72:75], v[172:175], v[184:187], v[72:75]
    v_mfma_f32_16x16x32_bf16 v[76:79], v[172:175], v[192:195], v[76:79]
    v_mfma_f32_16x16x32_bf16 v[80:83], v[172:175], v[200:203], v[80:83]
    v_mfma_f32_16x16x32_bf16 v[84:87], v[180:183], v[184:187], v[84:87]
    v_mfma_f32_16x16x32_bf16 v[88:91], v[180:183], v[192:195], v[88:91]
    v_mfma_f32_16x16x32_bf16 v[92:95], v[180:183], v[200:203], v[92:95]
    v_mfma_f32_16x16x32_bf16 v[0:3], v[156:159], v[188:191], v[0:3]
    v_mfma_f32_16x16x32_bf16 v[4:7], v[156:159], v[196:199], v[4:7]
    v_mfma_f32_16x16x32_bf16 v[8:11], v[156:159], v[204:207], v[8:11]
    v_mfma_f32_16x16x32_bf16 v[12:15], v[164:167], v[188:191], v[12:15]
    v_mfma_f32_16x16x32_bf16 v[16:19], v[164:167], v[196:199], v[16:19]
    s_waitcnt lgkmcnt(0)
    s_barrier
    v_mfma_f32_16x16x32_bf16 v[20:23], v[164:167], v[204:207], v[20:23]
    v_mfma_f32_16x16x32_bf16 v[24:27], v[172:175], v[188:191], v[24:27]
    v_mfma_f32_16x16x32_bf16 v[28:31], v[172:175], v[196:199], v[28:31]
    v_mfma_f32_16x16x32_bf16 v[32:35], v[172:175], v[204:207], v[32:35]
    v_mfma_f32_16x16x32_bf16 v[36:39], v[180:183], v[188:191], v[36:39]
    v_mfma_f32_16x16x32_bf16 v[40:43], v[180:183], v[196:199], v[40:43]
    v_mfma_f32_16x16x32_bf16 v[44:47], v[180:183], v[204:207], v[44:47]
    v_mfma_f32_16x16x32_bf16 v[0:3], v[96:99], v[128:131], v[0:3]
    ds_read_b128 v[152:155], v214 offset:0
    v_mfma_f32_16x16x32_bf16 v[4:7], v[96:99], v[136:139], v[4:7]
    v_mfma_f32_16x16x32_bf16 v[8:11], v[96:99], v[144:147], v[8:11]
    ds_read_b128 v[184:187], v208 offset:0
    v_mfma_f32_16x16x32_bf16 v[12:15], v[104:107], v[128:131], v[12:15]
    v_mfma_f32_16x16x32_bf16 v[16:19], v[104:107], v[136:139], v[16:19]
    ds_read_b128 v[192:195], v208 offset:2048
    v_mfma_f32_16x16x32_bf16 v[20:23], v[104:107], v[144:147], v[20:23]
    v_mfma_f32_16x16x32_bf16 v[24:27], v[112:115], v[128:131], v[24:27]
    ds_read_b128 v[200:203], v208 offset:4096
    v_mfma_f32_16x16x32_bf16 v[28:31], v[112:115], v[136:139], v[28:31]
    v_mfma_f32_16x16x32_bf16 v[32:35], v[112:115], v[144:147], v[32:35]
    ds_read_b128 v[160:163], v214 offset:2048
    v_mfma_f32_16x16x32_bf16 v[36:39], v[120:123], v[128:131], v[36:39]
    v_mfma_f32_16x16x32_bf16 v[40:43], v[120:123], v[136:139], v[40:43]
    ds_read_b128 v[168:171], v214 offset:4096
    v_mfma_f32_16x16x32_bf16 v[44:47], v[120:123], v[144:147], v[44:47]
    v_mfma_f32_16x16x32_bf16 v[48:51], v[96:99], v[132:135], v[48:51]
    ds_read_b128 v[176:179], v214 offset:6144
    v_mfma_f32_16x16x32_bf16 v[52:55], v[96:99], v[140:143], v[52:55]
    v_mfma_f32_16x16x32_bf16 v[56:59], v[96:99], v[148:151], v[56:59]
    ds_read_b128 v[188:191], v211 offset:0
    v_mfma_f32_16x16x32_bf16 v[60:63], v[104:107], v[132:135], v[60:63]
    v_mfma_f32_16x16x32_bf16 v[64:67], v[104:107], v[140:143], v[64:67]
    ds_read_b128 v[196:199], v211 offset:2048
    v_mfma_f32_16x16x32_bf16 v[68:71], v[104:107], v[148:151], v[68:71]
    v_mfma_f32_16x16x32_bf16 v[72:75], v[112:115], v[132:135], v[72:75]
    ds_read_b128 v[204:207], v211 offset:4096
    v_mfma_f32_16x16x32_bf16 v[76:79], v[112:115], v[140:143], v[76:79]
    v_mfma_f32_16x16x32_bf16 v[80:83], v[112:115], v[148:151], v[80:83]
    ds_read_b128 v[156:159], v214 offset:1024
    v_mfma_f32_16x16x32_bf16 v[84:87], v[120:123], v[132:135], v[84:87]
    v_mfma_f32_16x16x32_bf16 v[88:91], v[120:123], v[140:143], v[88:91]
    ds_read_b128 v[164:167], v214 offset:3072
    v_mfma_f32_16x16x32_bf16 v[92:95], v[120:123], v[148:151], v[92:95]
    v_mfma_f32_16x16x32_bf16 v[48:51], v[100:103], v[128:131], v[48:51]
    ds_read_b128 v[172:175], v214 offset:5120
    v_xor_b32 v132, s34, v132
    v_xor_b32 v133, s34, v133
    v_mfma_f32_16x16x32_bf16 v[52:55], v[100:103], v[136:139], v[52:55]
    v_xor_b32 v134, s34, v134
    v_xor_b32 v135, s34, v135
    v_mfma_f32_16x16x32_bf16 v[56:59], v[100:103], v[144:147], v[56:59]
    ds_read_b128 v[180:183], v214 offset:7168
    v_xor_b32 v140, s34, v140
    v_xor_b32 v141, s34, v141
    v_mfma_f32_16x16x32_bf16 v[60:63], v[108:111], v[128:131], v[60:63]
    v_xor_b32 v142, s34, v142
    v_xor_b32 v143, s34, v143
    v_mfma_f32_16x16x32_bf16 v[64:67], v[108:111], v[136:139], v[64:67]
    v_xor_b32 v148, s34, v148
    v_xor_b32 v149, s34, v149
    v_mfma_f32_16x16x32_bf16 v[68:71], v[108:111], v[144:147], v[68:71]
    v_xor_b32 v150, s34, v150
    v_xor_b32 v151, s34, v151
    v_mfma_f32_16x16x32_bf16 v[72:75], v[116:119], v[128:131], v[72:75]
    v_mfma_f32_16x16x32_bf16 v[76:79], v[116:119], v[136:139], v[76:79]
    v_mfma_f32_16x16x32_bf16 v[80:83], v[116:119], v[144:147], v[80:83]
    v_mfma_f32_16x16x32_bf16 v[84:87], v[124:127], v[128:131], v[84:87]
    v_mfma_f32_16x16x32_bf16 v[88:91], v[124:127], v[136:139], v[88:91]
    v_mfma_f32_16x16x32_bf16 v[92:95], v[124:127], v[144:147], v[92:95]
    v_mfma_f32_16x16x32_bf16 v[0:3], v[100:103], v[132:135], v[0:3]
    v_mfma_f32_16x16x32_bf16 v[4:7], v[100:103], v[140:143], v[4:7]
    v_mfma_f32_16x16x32_bf16 v[8:11], v[100:103], v[148:151], v[8:11]
    v_mfma_f32_16x16x32_bf16 v[12:15], v[108:111], v[132:135], v[12:15]
    v_mfma_f32_16x16x32_bf16 v[16:19], v[108:111], v[140:143], v[16:19]
    s_waitcnt lgkmcnt(0)
    v_mfma_f32_16x16x32_bf16 v[20:23], v[108:111], v[148:151], v[20:23]
    v_mfma_f32_16x16x32_bf16 v[24:27], v[116:119], v[132:135], v[24:27]
    v_mfma_f32_16x16x32_bf16 v[28:31], v[116:119], v[140:143], v[28:31]
    v_mfma_f32_16x16x32_bf16 v[32:35], v[116:119], v[148:151], v[32:35]
    v_mfma_f32_16x16x32_bf16 v[36:39], v[124:127], v[132:135], v[36:39]
    v_mfma_f32_16x16x32_bf16 v[40:43], v[124:127], v[140:143], v[40:43]
    v_mfma_f32_16x16x32_bf16 v[44:47], v[124:127], v[148:151], v[44:47]
    v_mfma_f32_16x16x32_bf16 v[0:3], v[152:155], v[184:187], v[0:3]
    v_mfma_f32_16x16x32_bf16 v[4:7], v[152:155], v[192:195], v[4:7]
    v_mfma_f32_16x16x32_bf16 v[8:11], v[152:155], v[200:203], v[8:11]
    v_mfma_f32_16x16x32_bf16 v[12:15], v[160:163], v[184:187], v[12:15]
    v_mfma_f32_16x16x32_bf16 v[16:19], v[160:163], v[192:195], v[16:19]
    v_mfma_f32_16x16x32_bf16 v[20:23], v[160:163], v[200:203], v[20:23]
    v_mfma_f32_16x16x32_bf16 v[24:27], v[168:171], v[184:187], v[24:27]
    v_mfma_f32_16x16x32_bf16 v[28:31], v[168:171], v[192:195], v[28:31]
    v_mfma_f32_16x16x32_bf16 v[32:35], v[168:171], v[200:203], v[32:35]
    v_mfma_f32_16x16x32_bf16 v[36:39], v[176:179], v[184:187], v[36:39]
    v_mfma_f32_16x16x32_bf16 v[40:43], v[176:179], v[192:195], v[40:43]
    v_mfma_f32_16x16x32_bf16 v[44:47], v[176:179], v[200:203], v[44:47]
    v_mfma_f32_16x16x32_bf16 v[48:51], v[152:155], v[188:191], v[48:51]
    v_mfma_f32_16x16x32_bf16 v[52:55], v[152:155], v[196:199], v[52:55]
    v_mfma_f32_16x16x32_bf16 v[56:59], v[152:155], v[204:207], v[56:59]
    v_mfma_f32_16x16x32_bf16 v[60:63], v[160:163], v[188:191], v[60:63]
    v_mfma_f32_16x16x32_bf16 v[64:67], v[160:163], v[196:199], v[64:67]
    v_mfma_f32_16x16x32_bf16 v[68:71], v[160:163], v[204:207], v[68:71]
    v_mfma_f32_16x16x32_bf16 v[72:75], v[168:171], v[188:191], v[72:75]
    v_mfma_f32_16x16x32_bf16 v[76:79], v[168:171], v[196:199], v[76:79]
    v_mfma_f32_16x16x32_bf16 v[80:83], v[168:171], v[204:207], v[80:83]
    v_mfma_f32_16x16x32_bf16 v[84:87], v[176:179], v[188:191], v[84:87]
    v_mfma_f32_16x16x32_bf16 v[88:91], v[176:179], v[196:199], v[88:91]
    v_mfma_f32_16x16x32_bf16 v[92:95], v[176:179], v[204:207], v[92:95]
    v_mfma_f32_16x16x32_bf16 v[48:51], v[156:159], v[184:187], v[48:51]
    v_xor_b32 v188, s34, v188
    v_xor_b32 v189, s34, v189
    v_mfma_f32_16x16x32_bf16 v[52:55], v[156:159], v[192:195], v[52:55]
    v_xor_b32 v190, s34, v190
    v_xor_b32 v191, s34, v191
    v_mfma_f32_16x16x32_bf16 v[56:59], v[156:159], v[200:203], v[56:59]
    v_xor_b32 v196, s34, v196
    v_xor_b32 v197, s34, v197
    v_mfma_f32_16x16x32_bf16 v[60:63], v[164:167], v[184:187], v[60:63]
    v_xor_b32 v198, s34, v198
    v_xor_b32 v199, s34, v199
    v_mfma_f32_16x16x32_bf16 v[64:67], v[164:167], v[192:195], v[64:67]
    v_xor_b32 v204, s34, v204
    v_xor_b32 v205, s34, v205
    v_mfma_f32_16x16x32_bf16 v[68:71], v[164:167], v[200:203], v[68:71]
    v_xor_b32 v206, s34, v206
    v_xor_b32 v207, s34, v207
    v_mfma_f32_16x16x32_bf16 v[72:75], v[172:175], v[184:187], v[72:75]
    v_mfma_f32_16x16x32_bf16 v[76:79], v[172:175], v[192:195], v[76:79]
    v_mfma_f32_16x16x32_bf16 v[80:83], v[172:175], v[200:203], v[80:83]
    v_mfma_f32_16x16x32_bf16 v[84:87], v[180:183], v[184:187], v[84:87]
    v_mfma_f32_16x16x32_bf16 v[88:91], v[180:183], v[192:195], v[88:91]
    v_mfma_f32_16x16x32_bf16 v[92:95], v[180:183], v[200:203], v[92:95]
    v_mfma_f32_16x16x32_bf16 v[0:3], v[156:159], v[188:191], v[0:3]
    v_mfma_f32_16x16x32_bf16 v[4:7], v[156:159], v[196:199], v[4:7]
    v_mfma_f32_16x16x32_bf16 v[8:11], v[156:159], v[204:207], v[8:11]
    v_mfma_f32_16x16x32_bf16 v[12:15], v[164:167], v[188:191], v[12:15]
    v_mfma_f32_16x16x32_bf16 v[16:19], v[164:167], v[196:199], v[16:19]
    v_mfma_f32_16x16x32_bf16 v[20:23], v[164:167], v[204:207], v[20:23]
    v_mfma_f32_16x16x32_bf16 v[24:27], v[172:175], v[188:191], v[24:27]
    v_mfma_f32_16x16x32_bf16 v[28:31], v[172:175], v[196:199], v[28:31]
    v_mfma_f32_16x16x32_bf16 v[32:35], v[172:175], v[204:207], v[32:35]
    v_mfma_f32_16x16x32_bf16 v[36:39], v[180:183], v[188:191], v[36:39]
    v_mfma_f32_16x16x32_bf16 v[40:43], v[180:183], v[196:199], v[40:43]
    v_mfma_f32_16x16x32_bf16 v[44:47], v[180:183], v[204:207], v[44:47]
    s_nop 7
    s_nop 7
    v_cvt_pk_bf16_f32 v96, v0, v1
    v_cvt_pk_bf16_f32 v97, v2, v3
    v_cvt_pk_bf16_f32 v98, v12, v13
    v_cvt_pk_bf16_f32 v99, v14, v15
    v_cvt_pk_bf16_f32 v100, v48, v49
    v_cvt_pk_bf16_f32 v101, v50, v51
    v_cvt_pk_bf16_f32 v102, v60, v61
    v_cvt_pk_bf16_f32 v103, v62, v63
    v_mov_b32 v104, v96
    v_mov_b32 v105, v97
    v_mov_b32 v106, v98
    v_mov_b32 v107, v99
    s_add_u32 s35, s33, 0
    v_mov_b32_dpp v104, v100 row_ror:8 row_mask:0xf bank_mask:0x3
    v_mov_b32_dpp v105, v101 row_ror:8 row_mask:0xf bank_mask:0x3
    v_mov_b32_dpp v106, v102 row_ror:8 row_mask:0xf bank_mask:0x3
    v_mov_b32_dpp v107, v103 row_ror:8 row_mask:0xf bank_mask:0x3
    v_mov_b32_dpp v96, v100 row_ror:8 row_mask:0xf bank_mask:0xc
    v_mov_b32_dpp v97, v101 row_ror:8 row_mask:0xf bank_mask:0xc
    v_mov_b32_dpp v98, v102 row_ror:8 row_mask:0xf bank_mask:0xc
    v_mov_b32_dpp v99, v103 row_ror:8 row_mask:0xf bank_mask:0xc
    buffer_store_dwordx4 v[96:99], v222, s[16:19], s35 offen sc1
    buffer_store_dwordx4 v[104:107], v223, s[16:19], s35 offen sc1
    v_cvt_pk_bf16_f32 v108, v4, v5
    v_cvt_pk_bf16_f32 v109, v6, v7
    v_cvt_pk_bf16_f32 v110, v16, v17
    v_cvt_pk_bf16_f32 v111, v18, v19
    v_cvt_pk_bf16_f32 v112, v52, v53
    v_cvt_pk_bf16_f32 v113, v54, v55
    v_cvt_pk_bf16_f32 v114, v64, v65
    v_cvt_pk_bf16_f32 v115, v66, v67
    v_mov_b32 v116, v108
    v_mov_b32 v117, v109
    v_mov_b32 v118, v110
    v_mov_b32 v119, v111
    s_add_u32 s35, s33, 593920
    v_mov_b32_dpp v116, v112 row_ror:8 row_mask:0xf bank_mask:0x3
    v_mov_b32_dpp v117, v113 row_ror:8 row_mask:0xf bank_mask:0x3
    v_mov_b32_dpp v118, v114 row_ror:8 row_mask:0xf bank_mask:0x3
    v_mov_b32_dpp v119, v115 row_ror:8 row_mask:0xf bank_mask:0x3
    v_mov_b32_dpp v108, v112 row_ror:8 row_mask:0xf bank_mask:0xc
    v_mov_b32_dpp v109, v113 row_ror:8 row_mask:0xf bank_mask:0xc
    v_mov_b32_dpp v110, v114 row_ror:8 row_mask:0xf bank_mask:0xc
    v_mov_b32_dpp v111, v115 row_ror:8 row_mask:0xf bank_mask:0xc
    buffer_store_dwordx4 v[108:111], v222, s[16:19], s35 offen sc1
    buffer_store_dwordx4 v[116:119], v223, s[16:19], s35 offen sc1
    v_cvt_pk_bf16_f32 v120, v8, v9
    v_cvt_pk_bf16_f32 v121, v10, v11
    v_cvt_pk_bf16_f32 v122, v20, v21
    v_cvt_pk_bf16_f32 v123, v22, v23
    v_cvt_pk_bf16_f32 v124, v56, v57
    v_cvt_pk_bf16_f32 v125, v58, v59
    v_cvt_pk_bf16_f32 v126, v68, v69
    v_cvt_pk_bf16_f32 v127, v70, v71
    v_mov_b32 v128, v120
    v_mov_b32 v129, v121
    v_mov_b32 v130, v122
    v_mov_b32 v131, v123
    s_add_u32 s35, s33, 1187840
    v_mov_b32_dpp v128, v124 row_ror:8 row_mask:0xf bank_mask:0x3
    v_mov_b32_dpp v129, v125 row_ror:8 row_mask:0xf bank_mask:0x3
    v_mov_b32_dpp v130, v126 row_ror:8 row_mask:0xf bank_mask:0x3
    v_mov_b32_dpp v131, v127 row_ror:8 row_mask:0xf bank_mask:0x3
    v_mov_b32_dpp v120, v124 row_ror:8 row_mask:0xf bank_mask:0xc
    v_mov_b32_dpp v121, v125 row_ror:8 row_mask:0xf bank_mask:0xc
    v_mov_b32_dpp v122, v126 row_ror:8 row_mask:0xf bank_mask:0xc
    v_mov_b32_dpp v123, v127 row_ror:8 row_mask:0xf bank_mask:0xc
    buffer_store_dwordx4 v[120:123], v222, s[16:19], s35 offen sc1
    buffer_store_dwordx4 v[128:131], v223, s[16:19], s35 offen sc1
    v_cvt_pk_bf16_f32 v96, v24, v25
    v_cvt_pk_bf16_f32 v97, v26, v27
    v_cvt_pk_bf16_f32 v98, v36, v37
    v_cvt_pk_bf16_f32 v99, v38, v39
    v_cvt_pk_bf16_f32 v100, v72, v73
    v_cvt_pk_bf16_f32 v101, v74, v75
    v_cvt_pk_bf16_f32 v102, v84, v85
    v_cvt_pk_bf16_f32 v103, v86, v87
    v_mov_b32 v104, v96
    v_mov_b32 v105, v97
    v_mov_b32 v106, v98
    v_mov_b32 v107, v99
    s_add_u32 s35, s33, 128
    v_mov_b32_dpp v104, v100 row_ror:8 row_mask:0xf bank_mask:0x3
    v_mov_b32_dpp v105, v101 row_ror:8 row_mask:0xf bank_mask:0x3
    v_mov_b32_dpp v106, v102 row_ror:8 row_mask:0xf bank_mask:0x3
    v_mov_b32_dpp v107, v103 row_ror:8 row_mask:0xf bank_mask:0x3
    v_mov_b32_dpp v96, v100 row_ror:8 row_mask:0xf bank_mask:0xc
    v_mov_b32_dpp v97, v101 row_ror:8 row_mask:0xf bank_mask:0xc
    v_mov_b32_dpp v98, v102 row_ror:8 row_mask:0xf bank_mask:0xc
    v_mov_b32_dpp v99, v103 row_ror:8 row_mask:0xf bank_mask:0xc
    buffer_store_dwordx4 v[96:99], v222, s[16:19], s35 offen sc1
    buffer_store_dwordx4 v[104:107], v223, s[16:19], s35 offen sc1
    v_cvt_pk_bf16_f32 v108, v28, v29
    v_cvt_pk_bf16_f32 v109, v30, v31
    v_cvt_pk_bf16_f32 v110, v40, v41
    v_cvt_pk_bf16_f32 v111, v42, v43
    v_cvt_pk_bf16_f32 v112, v76, v77
    v_cvt_pk_bf16_f32 v113, v78, v79
    v_cvt_pk_bf16_f32 v114, v88, v89
    v_cvt_pk_bf16_f32 v115, v90, v91
    v_mov_b32 v116, v108
    v_mov_b32 v117, v109
    v_mov_b32 v118, v110
    v_mov_b32 v119, v111
    s_add_u32 s35, s33, 594048
    v_mov_b32_dpp v116, v112 row_ror:8 row_mask:0xf bank_mask:0x3
    v_mov_b32_dpp v117, v113 row_ror:8 row_mask:0xf bank_mask:0x3
    v_mov_b32_dpp v118, v114 row_ror:8 row_mask:0xf bank_mask:0x3
    v_mov_b32_dpp v119, v115 row_ror:8 row_mask:0xf bank_mask:0x3
    v_mov_b32_dpp v108, v112 row_ror:8 row_mask:0xf bank_mask:0xc
    v_mov_b32_dpp v109, v113 row_ror:8 row_mask:0xf bank_mask:0xc
    v_mov_b32_dpp v110, v114 row_ror:8 row_mask:0xf bank_mask:0xc
    v_mov_b32_dpp v111, v115 row_ror:8 row_mask:0xf bank_mask:0xc
    buffer_store_dwordx4 v[108:111], v222, s[16:19], s35 offen sc1
    buffer_store_dwordx4 v[116:119], v223, s[16:19], s35 offen sc1
    v_cvt_pk_bf16_f32 v120, v32, v33
    v_cvt_pk_bf16_f32 v121, v34, v35
    v_cvt_pk_bf16_f32 v122, v44, v45
    v_cvt_pk_bf16_f32 v123, v46, v47
    v_cvt_pk_bf16_f32 v124, v80, v81
    v_cvt_pk_bf16_f32 v125, v82, v83
    v_cvt_pk_bf16_f32 v126, v92, v93
    v_cvt_pk_bf16_f32 v127, v94, v95
    v_mov_b32 v128, v120
    v_mov_b32 v129, v121
    v_mov_b32 v130, v122
    v_mov_b32 v131, v123
    s_add_u32 s35, s33, 1187968
    v_mov_b32_dpp v128, v124 row_ror:8 row_mask:0xf bank_mask:0x3
    v_mov_b32_dpp v129, v125 row_ror:8 row_mask:0xf bank_mask:0x3
    v_mov_b32_dpp v130, v126 row_ror:8 row_mask:0xf bank_mask:0x3
    v_mov_b32_dpp v131, v127 row_ror:8 row_mask:0xf bank_mask:0x3
    v_mov_b32_dpp v120, v124 row_ror:8 row_mask:0xf bank_mask:0xc
    v_mov_b32_dpp v121, v125 row_ror:8 row_mask:0xf bank_mask:0xc
    v_mov_b32_dpp v122, v126 row_ror:8 row_mask:0xf bank_mask:0xc
    v_mov_b32_dpp v123, v127 row_ror:8 row_mask:0xf bank_mask:0xc
    buffer_store_dwordx4 v[120:123], v222, s[16:19], s35 offen sc1
    buffer_store_dwordx4 v[128:131], v223, s[16:19], s35 offen sc1
    s_endpgm
.globl mid_kernel
.p2align 8
.type mid_kernel,@function
mid_kernel:
    s_cmp_ge_u32 s2, 704
    s_cbranch_scc1 L_mid_kernel_done
    v_readfirstlane_b32 s20, v0
    s_lshr_b32 s20, s20, 6
    s_cmp_ge_u32 s2, 448
    s_cbranch_scc1 L_mid_kernel_g
    s_mov_b32 s3, s2
    s_load_dwordx2 s[6:7], s[0:1], 72
    s_load_dwordx2 s[4:5], s[0:1], 72
    s_cmp_ge_u32 s3, 224
    s_cselect_b32 s24, 1, 0
    s_mul_i32 s25, s24, 224
    s_sub_u32 s25, s3, s25
    s_lshr_b32 s26, s25, 3
    s_and_b32 s27, s25, 7
    v_and_b32 v1, 63, v0
    v_lshrrev_b32 v2, 3, v1
    v_mul_u32_u24 v2, 1024, v2
    v_bfe_u32 v3, v1, 2, 1
    v_lshl_add_u32 v2, v3, 6, v2
    v_lshrrev_b32 v3, 5, v1
    v_lshlrev_b32 v3, 1, v3
    v_and_b32 v4, 3, v1
    v_xor_b32 v3, v3, v4
    v_lshl_add_u32 v2, v3, 4, v2
    s_mul_i32 s28, s26, 6
    s_lshl_b32 s29, s20, 1
    s_add_u32 s28, s28, s29
    s_sub_u32 s28, s28, 1
    s_mul_i32 s30, s27, 128
    s_add_u32 s31, s28, 0
    s_mul_i32 s32, s31, 37120
    s_add_u32 s32, s32, s30
    s_cmp_lt_i32 s31, 0
    s_cselect_b32 s32, 0x7f000000, s32
    v_add_u32 v3, s32, v2
    s_add_u32 s31, s28, 1
    s_mul_i32 s32, s31, 37120
    s_add_u32 s32, s32, s30
    s_cmp_lt_i32 s31, 0
    s_cselect_b32 s32, 0x7f000000, s32
    v_add_u32 v4, s32, v2
    s_waitcnt lgkmcnt(0)
    s_mul_i32 s33, s24, 6199040
    s_add_u32 s33, s33, 38871040
    s_add_u32 s8, s6, s33
    s_addc_u32 s9, s7, 0
    s_mov_b32 s10, 6199040
    s_mov_b32 s11, 0x00020000
    s_add_u32 s12, s6, 85499904
    s_addc_u32 s13, s7, 0
    s_mov_b32 s14, 16384
    s_mov_b32 s15, 0x00020000
    s_lshl_b32 s34, s20, 13
    s_add_u32 m0, s34, 0
    s_mov_b32 s35, 0
    buffer_load_dwordx4 v3, s[8:11], s35 offen lds
    s_add_u32 m0, s34, 1024
    s_mov_b32 s35, 8192
    buffer_load_dwordx4 v3, s[8:11], s35 offen lds
    s_add_u32 m0, s34, 2048
    s_mov_b32 s35, 16384
    buffer_load_dwordx4 v3, s[8:11], s35 offen lds
    s_add_u32 m0, s34, 3072
    s_mov_b32 s35, 24576
    buffer_load_dwordx4 v3, s[8:11], s35 offen lds
    s_add_u32 m0, s34, 4096
    s_mov_b32 s35, 0
    buffer_load_dwordx4 v4, s[8:11], s35 offen lds
    s_add_u32 m0, s34, 5120
    s_mov_b32 s35, 8192
    buffer_load_dwordx4 v4, s[8:11], s35 offen lds
    s_add_u32 m0, s34, 6144
    s_mov_b32 s35, 16384
    buffer_load_dwordx4 v4, s[8:11], s35 offen lds
    s_add_u32 m0, s34, 7168
    s_mov_b32 s35, 24576
    buffer_load_dwordx4 v4, s[8:11], s35 offen lds
    v_lshlrev_b32 v5, 4, v1
    s_mov_b32 s35, 8192
    buffer_load_dwordx4 v[8:11], v5, s[12:15], s35 offen
    s_mov_b32 s35, 9216
    buffer_load_dwordx4 v[12:15], v5, s[12:15], s35 offen
    s_mov_b32 s35, 10240
    buffer_load_dwordx4 v[16:19], v5, s[12:15], s35 offen
    s_mov_b32 s35, 11264
    buffer_load_dwordx4 v[20:23], v5, s[12:15], s35 offen
    s_mov_b32 s35, 12288
    buffer_load_dwordx4 v[24:27], v5, s[12:15], s35 offen
    s_mov_b32 s35, 13312
    buffer_load_dwordx4 v[28:31], v5, s[12:15], s35 offen
    s_lshl_b32 s35, s20, 11
    buffer_load_dwordx4 v[32:35], v5, s[12:15], s35 offen offset:0
    buffer_load_dwordx4 v[36:39], v5, s[12:15], s35 offen offset:1024
    v_bfe_u32 v40, v1, 2, 2
    v_lshrrev_b32 v41, 4, v1
    v_and_b32 v42, 3, v1
    v_lshl_add_u32 v43, v41, 3, v40
    v_lshlrev_b32 v46, 6, v43
    v_and_b32 v47, 1, v41
    v_lshlrev_b32 v47, 1, v47
    v_lshrrev_b32 v48, 1, v42
    v_xor_b32 v47, v47, v48
    v_lshl_add_u32 v46, v47, 4, v46
    v_and_b32 v48, 1, v42
    v_lshl_add_u32 v46, v48, 3, v46
    v_add_u32 v44, s34, v46
    v_xor_b32 v45, 32, v44
    v_add_u32 v49, 43008, v46
    v_xor_b32 v50, 32, v49
    v_add_u32 v47, 1, v43
    v_bfe_u32 v48, v47, 3, 1
    v_lshlrev_b32 v48, 1, v48
    v_lshrrev_b32 v55, 1, v42
    v_xor_b32 v48, v48, v55
    v_lshlrev_b32 v47, 6, v47
    v_lshl_add_u32 v47, v48, 4, v47
    v_and_b32 v48, 1, v42
    v_lshl_add_u32 v47, v48, 3, v47
    v_add_u32 v51, 32704, v47
    v_xor_b32 v52, 32, v51
    v_add_u32 v47, 5, v43
    v_bfe_u32 v48, v47, 3, 1
    v_lshlrev_b32 v48, 1, v48
    v_lshrrev_b32 v55, 1, v42
    v_xor_b32 v48, v48, v55
    v_lshlrev_b32 v47, 6, v47
    v_lshl_add_u32 v47, v48, 4, v47
    v_and_b32 v48, 1, v42
    v_lshl_add_u32 v47, v48, 3, v47
    v_add_u32 v53, 32704, v47
    v_xor_b32 v54, 32, v53
    v_and_b32 v47, 1, v1
    v_mul_u32_u24 v55, 10304, v47
    v_bfe_u32 v48, v1, 1, 3
    v_lshl_add_u32 v55, v48, 6, v55
    v_lshl_add_u32 v55, v41, 4, v55
    s_mul_i32 s35, s20, 3072
    s_add_u32 s35, s35, 31680
    v_add_u32 v56, s35, v55
    v_xor_b32 v57, 32, v56
    s_mul_i32 s35, s20, 48
    s_sub_u32 s35, s35, 17
    v_add_u32 v122, v48, v47
    v_add_u32 v122, s35, v122
    s_mov_b32 s35, 344064
    v_mul_lo_u32 v58, v48, s35
    v_and_b32 v47, 1, v1
    v_lshl_add_u32 v58, v47, 6, v58
    v_lshl_add_u32 v58, v41, 4, v58
    s_mov_b32 s36, 0xbdd2d3e8
    v_mov_b32 v59, 0xc0135761
    s_mov_b32 s42, 0xbdd2d3e8
    s_mov_b32 s43, 0xbdd2d3e8
    v_mov_b32 v120, 0xc0135761
    v_mov_b32 v121, 0xc0135761
    s_add_u32 s16, s4, 51269632
    s_addc_u32 s17, s5, 0
    s_mov_b32 s18, 11010048
    s_mov_b32 s19, 0x00020000
    s_mul_i32 s37, s20, 2752512
    s_mul_i32 s38, s24, 84
    s_mul_i32 s39, s26, 3
    s_add_u32 s38, s38, s39
    s_lshl_b32 s38, s38, 11
    s_add_u32 s37, s37, s38
    s_lshl_b32 s38, s27, 7
    s_add_u32 s37, s37, s38
    s_waitcnt vmcnt(2)
    ds_read_b64_tr_b16 v[60:61], v44 offset:0
    ds_read_b64_tr_b16 v[62:63], v44 offset:256
    ds_read_b64_tr_b16 v[64:65], v44 offset:2048
    ds_read_b64_tr_b16 v[66:67], v44 offset:2304
    ds_read_b64_tr_b16 v[68:69], v45 offset:0
    ds_read_b64_tr_b16 v[70:71], v45 offset:256
    ds_read_b64_tr_b16 v[72:73], v45 offset:2048
    ds_read_b64_tr_b16 v[74:75], v45 offset:2304
    s_waitcnt lgkmcnt(0)
    v_mfma_f32_16x16x32_bf16 v[76:79], v[60:63], v[8:11], 0
    v_mfma_f32_16x16x32_bf16 v[80:83], v[68:71], v[8:11], 0
    v_mfma_f32_16x16x32_bf16 v[84:87], v[60:63], v[16:19], 0
    v_mfma_f32_16x16x32_bf16 v[88:91], v[68:71], v[16:19], 0
    v_mfma_f32_16x16x32_bf16 v[92:95], v[60:63], v[24:27], 0
    v_mfma_f32_16x16x32_bf16 v[96:99], v[68:71], v[24:27], 0
    v_mfma_f32_16x16x32_bf16 v[76:79], v[64:67], v[12:15], v[76:79]
    v_mfma_f32_16x16x32_bf16 v[80:83], v[72:75], v[12:15], v[80:83]
    v_mfma_f32_16x16x32_bf16 v[84:87], v[64:67], v[20:23], v[84:87]
    v_mfma_f32_16x16x32_bf16 v[88:91], v[72:75], v[20:23], v[88:91]
    v_mfma_f32_16x16x32_bf16 v[92:95], v[64:67], v[28:31], v[92:95]
    v_mfma_f32_16x16x32_bf16 v[96:99], v[72:75], v[28:31], v[96:99]
    s_add_u32 s31, s28, 0
    s_cmp_eq_u32 s31, 166
    s_cselect_b32 s39, 0, -1
    s_nop 4
    v_mul_f32 v100, v76, v76
    v_mul_f32 v101, v77, v77
    v_mul_f32 v102, v78, v78
    v_mul_f32 v103, v79, v79
    v_mul_f32 v104, v80, v80
    v_mul_f32 v105, v81, v81
    v_mul_f32 v106, v82, v82
    v_mul_f32 v107, v83, v83
    v_fma_f32 v100, v100, s36, v59
    v_fma_f32 v101, v101, s36, v59
    v_fma_f32 v102, v102, s36, v59
    v_fma_f32 v103, v103, s36, v59
    v_fma_f32 v104, v104, s36, v59
    v_fma_f32 v105, v105, s36, v59
    v_fma_f32 v106, v106, s36, v59
    v_fma_f32 v107, v107, s36, v59
    v_mul_f32 v100, v100, v76
    v_mul_f32 v101, v101, v77
    v_mul_f32 v102, v102, v78
    v_mul_f32 v103, v103, v79
    v_mul_f32 v104, v104, v80
    v_mul_f32 v105, v105, v81
    v_mul_f32 v106, v106, v82
    v_mul_f32 v107, v107, v83
    v_exp_f32 v100, v100
    v_exp_f32 v101, v101
    v_exp_f32 v102, v102
    v_exp_f32 v103, v103
    v_exp_f32 v104, v104
    v_exp_f32 v105, v105
    v_exp_f32 v106, v106
    v_exp_f32 v107, v107
    v_add_f32 v100, 1.0, v100
    v_add_f32 v101, 1.0, v101
    v_add_f32 v102, 1.0, v102
    v_add_f32 v103, 1.0, v103
    v_add_f32 v104, 1.0, v104
    v_add_f32 v105, 1.0, v105
    v_add_f32 v106, 1.0, v106
    v_add_f32 v107, 1.0, v107
    v_rcp_f32 v100, v100
    v_rcp_f32 v101, v101
    v_rcp_f32 v102, v102
    v_rcp_f32 v103, v103
    v_rcp_f32 v104, v104
    v_rcp_f32 v105, v105
    v_rcp_f32 v106, v106
    v_rcp_f32 v107, v107
    v_mul_f32 v76, v76, v100
    v_mul_f32 v77, v77, v101
    v_mul_f32 v78, v78, v102
    v_mul_f32 v79, v79, v103
    v_mul_f32 v80, v80, v104
    v_mul_f32 v81, v81, v105
    v_mul_f32 v82, v82, v106
    v_mul_f32 v83, v83, v107
    v_cvt_pk_bf16_f32 v108, v76, v77
    v_cvt_pk_bf16_f32 v109, v78, v79
    v_cvt_pk_bf16_f32 v110, v80, v81
    v_cvt_pk_bf16_f32 v111, v82, v83
    v_add_u32 v123, 0, v122
    v_cmp_gt_u32 vcc, 160, v123
    s_nop 0
    s_and_saveexec_b64 s[40:41], vcc
    ds_write_b128 v56, v[108:111] offset:0
    s_mov_b64 exec, s[40:41]
    v_mul_f32 v100, v84, v84
    v_mul_f32 v101, v85, v85
    v_mul_f32 v102, v86, v86
    v_mul_f32 v103, v87, v87
    v_mul_f32 v104, v88, v88
    v_mul_f32 v105, v89, v89
    v_mul_f32 v106, v90, v90
    v_mul_f32 v107, v91, v91
    v_fma_f32 v100, v100, s36, v59
    v_fma_f32 v101, v101, s36, v59
    v_fma_f32 v102, v102, s36, v59
    v_fma_f32 v103, v103, s36, v59
    v_fma_f32 v104, v104, s36, v59
    v_fma_f32 v105, v105, s36, v59
    v_fma_f32 v106, v106, s36, v59
    v_fma_f32 v107, v107, s36, v59
    v_mul_f32 v100, v100, v84
    v_mul_f32 v101, v101, v85
    v_mul_f32 v102, v102, v86
    v_mul_f32 v103, v103, v87
    v_mul_f32 v104, v104, v88
    v_mul_f32 v105, v105, v89
    v_mul_f32 v106, v106, v90
    v_mul_f32 v107, v107, v91
    v_exp_f32 v100, v100
    v_exp_f32 v101, v101
    v_exp_f32 v102, v102
    v_exp_f32 v103, v103
    v_exp_f32 v104, v104
    v_exp_f32 v105, v105
    v_exp_f32 v106, v106
    v_exp_f32 v107, v107
    v_add_f32 v100, 1.0, v100
    v_add_f32 v101, 1.0, v101
    v_add_f32 v102, 1.0, v102
    v_add_f32 v103, 1.0, v103
    v_add_f32 v104, 1.0, v104
    v_add_f32 v105, 1.0, v105
    v_add_f32 v106, 1.0, v106
    v_add_f32 v107, 1.0, v107
    v_rcp_f32 v100, v100
    v_rcp_f32 v101, v101
    v_rcp_f32 v102, v102
    v_rcp_f32 v103, v103
    v_rcp_f32 v104, v104
    v_rcp_f32 v105, v105
    v_rcp_f32 v106, v106
    v_rcp_f32 v107, v107
    v_mul_f32 v84, v84, v100
    v_mul_f32 v85, v85, v101
    v_mul_f32 v86, v86, v102
    v_mul_f32 v87, v87, v103
    v_mul_f32 v88, v88, v104
    v_mul_f32 v89, v89, v105
    v_mul_f32 v90, v90, v106
    v_mul_f32 v91, v91, v107
    v_cvt_pk_bf16_f32 v112, v84, v85
    v_cvt_pk_bf16_f32 v113, v86, v87
    v_cvt_pk_bf16_f32 v114, v88, v89
    v_cvt_pk_bf16_f32 v115, v90, v91
    v_add_u32 v123, 8, v122
    v_cmp_gt_u32 vcc, 160, v123
    s_nop 0
    s_and_saveexec_b64 s[40:41], vcc
    ds_write_b128 v57, v[112:115] offset:512
    s_mov_b64 exec, s[40:41]
    v_mul_f32 v100, v92, v92
    v_mul_f32 v101, v93, v93
    v_mul_f32 v102, v94, v94
    v_mul_f32 v103, v95, v95
    v_mul_f32 v104, v96, v96
    v_mul_f32 v105, v97, v97
    v_mul_f32 v106, v98, v98
    v_mul_f32 v107, v99, v99
    v_fma_f32 v100, v100, s36, v59
    v_fma_f32 v101, v101, s36, v59
    v_fma_f32 v102, v102, s36, v59
    v_fma_f32 v103, v103, s36, v59
    v_fma_f32 v104, v104, s36, v59
    v_fma_f32 v105, v105, s36, v59
    v_fma_f32 v106, v106, s36, v59
    v_fma_f32 v107, v107, s36, v59
    v_mul_f32 v100, v100, v92
    v_mul_f32 v101, v101, v93
    v_mul_f32 v102, v102, v94
    v_mul_f32 v103, v103, v95
    v_mul_f32 v104, v104, v96
    v_mul_f32 v105, v105, v97
    v_mul_f32 v106, v106, v98
    v_mul_f32 v107, v107, v99
    v_exp_f32 v100, v100
    v_exp_f32 v101, v101
    v_exp_f32 v102, v102
    v_exp_f32 v103, v103
    v_exp_f32 v104, v104
    v_exp_f32 v105, v105
    v_exp_f32 v106, v106
    v_exp_f32 v107, v107
    v_add_f32 v100, 1.0, v100
    v_add_f32 v101, 1.0, v101
    v_add_f32 v102, 1.0, v102
    v_add_f32 v103, 1.0, v103
    v_add_f32 v104, 1.0, v104
    v_add_f32 v105, 1.0, v105
    v_add_f32 v106, 1.0, v106
    v_add_f32 v107, 1.0, v107
    v_rcp_f32 v100, v100
    v_rcp_f32 v101, v101
    v_rcp_f32 v102, v102
    v_rcp_f32 v103, v103
    v_rcp_f32 v104, v104
    v_rcp_f32 v105, v105
    v_rcp_f32 v106, v106
    v_rcp_f32 v107, v107
    v_mul_f32 v92, v92, v100
    v_mul_f32 v93, v93, v101
    v_mul_f32 v94, v94, v102
    v_mul_f32 v95, v95, v103
    v_mul_f32 v96, v96, v104
    v_mul_f32 v97, v97, v105
    v_mul_f32 v98, v98, v106
    v_mul_f32 v99, v99, v107
    v_cvt_pk_bf16_f32 v116, v92, v93
    v_cvt_pk_bf16_f32 v117, v94, v95
    v_cvt_pk_bf16_f32 v118, v96, v97
    v_cvt_pk_bf16_f32 v119, v98, v99
    v_and_b32 v116, s39, v116
    v_and_b32 v117, s39, v117
    v_and_b32 v118, s39, v118
    v_and_b32 v119, s39, v119
    v_add_u32 v123, 16, v122
    v_cmp_gt_u32 vcc, 160, v123
    s_nop 0
    s_and_saveexec_b64 s[40:41], vcc
    ds_write_b128 v56, v[116:119] offset:1024
    s_mov_b64 exec, s[40:41]
    ds_read_b64_tr_b16 v[60:61], v44 offset:4096
    ds_read_b64_tr_b16 v[62:63], v44 offset:4352
    ds_read_b64_tr_b16 v[64:65], v44 offset:6144
    ds_read_b64_tr_b16 v[66:67], v44 offset:6400
    ds_read_b64_tr_b16 v[68:69], v45 offset:4096
    ds_read_b64_tr_b16 v[70:71], v45 offset:4352
    ds_read_b64_tr_b16 v[72:73], v45 offset:6144
    ds_read_b64_tr_b16 v[74:75], v45 offset:6400
    s_waitcnt lgkmcnt(0)
    v_mfma_f32_16x16x32_bf16 v[76:79], v[60:63], v[8:11], 0
    v_mfma_f32_16x16x32_bf16 v[80:83], v[68:71], v[8:11], 0
    v_mfma_f32_16x16x32_bf16 v[84:87], v[60:63], v[16:19], 0
    v_mfma_f32_16x16x32_bf16 v[88:91], v[68:71], v[16:19], 0
    v_mfma_f32_16x16x32_bf16 v[92:95], v[60:63], v[24:27], 0
    v_mfma_f32_16x16x32_bf16 v[96:99], v[68:71], v[24:27], 0
    v_mfma_f32_16x16x32_bf16 v[76:79], v[64:67], v[12:15], v[76:79]
    v_mfma_f32_16x16x32_bf16 v[80:83], v[72:75], v[12:15], v[80:83]
    v_mfma_f32_16x16x32_bf16 v[84:87], v[64:67], v[20:23], v[84:87]
    v_mfma_f32_16x16x32_bf16 v[88:91], v[72:75], v[20:23], v[88:91]
    v_mfma_f32_16x16x32_bf16 v[92:95], v[64:67], v[28:31], v[92:95]
    v_mfma_f32_16x16x32_bf16 v[96:99], v[72:75], v[28:31], v[96:99]
    s_add_u32 s31, s28, 1
    s_cmp_eq_u32 s31, 166
    s_cselect_b32 s39, 0, -1
    s_nop 4
    v_mul_f32 v100, v76, v76
    v_mul_f32 v101, v77, v77
    v_mul_f32 v102, v78, v78
    v_mul_f32 v103, v79, v79
    v_mul_f32 v104, v80, v80
    v_mul_f32 v105, v81, v81
    v_mul_f32 v106, v82, v82
    v_mul_f32 v107, v83, v83
    v_fma_f32 v100, v100, s36, v59
    v_fma_f32 v101, v101, s36, v59
    v_fma_f32 v102, v102, s36, v59
    v_fma_f32 v103, v103, s36, v59
    v_fma_f32 v104, v104, s36, v59
    v_fma_f32 v105, v105, s36, v59
    v_fma_f32 v106, v106, s36, v59
    v_fma_f32 v107, v107, s36, v59
    v_mul_f32 v100, v100, v76
    v_mul_f32 v101, v101, v77
    v_mul_f32 v102, v102, v78
    v_mul_f32 v103, v103, v79
    v_mul_f32 v104, v104, v80
    v_mul_f32 v105, v105, v81
    v_mul_f32 v106, v106, v82
    v_mul_f32 v107, v107, v83
    v_exp_f32 v100, v100
    v_exp_f32 v101, v101
    v_exp_f32 v102, v102
    v_exp_f32 v103, v103
    v_exp_f32 v104, v104
    v_exp_f32 v105, v105
    v_exp_f32 v106, v106
    v_exp_f32 v107, v107
    v_add_f32 v100, 1.0, v100
    v_add_f32 v101, 1.0, v101
    v_add_f32 v102, 1.0, v102
    v_add_f32 v103, 1.0, v103
    v_add_f32 v104, 1.0, v104
    v_add_f32 v105, 1.0, v105
    v_add_f32 v106, 1.0, v106
    v_add_f32 v107, 1.0, v107
    v_rcp_f32 v100, v100
    v_rcp_f32 v101, v101
    v_rcp_f32 v102, v102
    v_rcp_f32 v103, v103
    v_rcp_f32 v104, v104
    v_rcp_f32 v105, v105
    v_rcp_f32 v106, v106
    v_rcp_f32 v107, v107
    v_mul_f32 v76, v76, v100
    v_mul_f32 v77, v77, v101
    v_mul_f32 v78, v78, v102
    v_mul_f32 v79, v79, v103
    v_mul_f32 v80, v80, v104
    v_mul_f32 v81, v81, v105
    v_mul_f32 v82, v82, v106
    v_mul_f32 v83, v83, v107
    v_cvt_pk_bf16_f32 v108, v76, v77
    v_cvt_pk_bf16_f32 v109, v78, v79
    v_cvt_pk_bf16_f32 v110, v80, v81
    v_cvt_pk_bf16_f32 v111, v82, v83
    v_add_u32 v123, 24, v122
    v_cmp_gt_u32 vcc, 160, v123
    s_nop 0
    s_and_saveexec_b64 s[40:41], vcc
    ds_write_b128 v57, v[108:111] offset:1536
    s_mov_b64 exec, s[40:41]
    v_mul_f32 v100, v84, v84
    v_mul_f32 v101, v85, v85
    v_mul_f32 v102, v86, v86
    v_mul_f32 v103, v87, v87
    v_mul_f32 v104, v88, v88
    v_mul_f32 v105, v89, v89
    v_mul_f32 v106, v90, v90
    v_mul_f32 v107, v91, v91
    v_fma_f32 v100, v100, s36, v59
    v_fma_f32 v101, v101, s36, v59
    v_fma_f32 v102, v102, s36, v59
    v_fma_f32 v103, v103, s36, v59
    v_fma_f32 v104, v104, s36, v59
    v_fma_f32 v105, v105, s36, v59
    v_fma_f32 v106, v106, s36, v59
    v_fma_f32 v107, v107, s36, v59
    v_mul_f32 v100, v100, v84
    v_mul_f32 v101, v101, v85
    v_mul_f32 v102, v102, v86
    v_mul_f32 v103, v103, v87
    v_mul_f32 v104, v104, v88
    v_mul_f32 v105, v105, v89
    v_mul_f32 v106, v106, v90
    v_mul_f32 v107, v107, v91
    v_exp_f32 v100, v100
    v_exp_f32 v101, v101
    v_exp_f32 v102, v102
    v_exp_f32 v103, v103
    v_exp_f32 v104, v104
    v_exp_f32 v105, v105
    v_exp_f32 v106, v106
    v_exp_f32 v107, v107
    v_add_f32 v100, 1.0, v100
    v_add_f32 v101, 1.0, v101
    v_add_f32 v102, 1.0, v102
    v_add_f32 v103, 1.0, v103
    v_add_f32 v104, 1.0, v104
    v_add_f32 v105, 1.0, v105
    v_add_f32 v106, 1.0, v106
    v_add_f32 v107, 1.0, v107
    v_rcp_f32 v100, v100
    v_rcp_f32 v101, v101
    v_rcp_f32 v102, v102
    v_rcp_f32 v103, v103
    v_rcp_f32 v104, v104
    v_rcp_f32 v105, v105
    v_rcp_f32 v106, v106
    v_rcp_f32 v107, v107
    v_mul_f32 v84, v84, v100
    v_mul_f32 v85, v85, v101
    v_mul_f32 v86, v86, v102
    v_mul_f32 v87, v87, v103
    v_mul_f32 v88, v88, v104
    v_mul_f32 v89, v89, v105
    v_mul_f32 v90, v90, v106
    v_mul_f32 v91, v91, v107
    v_cvt_pk_bf16_f32 v112, v84, v85
    v_cvt_pk_bf16_f32 v113, v86, v87
    v_cvt_pk_bf16_f32 v114, v88, v89
    v_cvt_pk_bf16_f32 v115, v90, v91
    v_add_u32 v123, 32, v122
    v_cmp_gt_u32 vcc, 160, v123
    s_nop 0
    s_and_saveexec_b64 s[40:41], vcc
    ds_write_b128 v56, v[112:115] offset:2048
    s_mov_b64 exec, s[40:41]
    v_mul_f32 v100, v92, v92
    v_mul_f32 v101, v93, v93
    v_mul_f32 v102, v94, v94
    v_mul_f32 v103, v95, v95
    v_mul_f32 v104, v96, v96
    v_mul_f32 v105, v97, v97
    v_mul_f32 v106, v98, v98
    v_mul_f32 v107, v99, v99
    v_fma_f32 v100, v100, s36, v59
    v_fma_f32 v101, v101, s36, v59
    v_fma_f32 v102, v102, s36, v59
    v_fma_f32 v103, v103, s36, v59
    v_fma_f32 v104, v104, s36, v59
    v_fma_f32 v105, v105, s36, v59
    v_fma_f32 v106, v106, s36, v59
    v_fma_f32 v107, v107, s36, v59
    v_mul_f32 v100, v100, v92
    v_mul_f32 v101, v101, v93
    v_mul_f32 v102, v102, v94
    v_mul_f32 v103, v103, v95
    v_mul_f32 v104, v104, v96
    v_mul_f32 v105, v105, v97
    v_mul_f32 v106, v106, v98
    v_mul_f32 v107, v107, v99
    v_exp_f32 v100, v100
    v_exp_f32 v101, v101
    v_exp_f32 v102, v102
    v_exp_f32 v103, v103
    v_exp_f32 v104, v104
    v_exp_f32 v105, v105
    v_exp_f32 v106, v106
    v_exp_f32 v107, v107
    v_add_f32 v100, 1.0, v100
    v_add_f32 v101, 1.0, v101
    v_add_f32 v102, 1.0, v102
    v_add_f32 v103, 1.0, v103
    v_add_f32 v104, 1.0, v104
    v_add_f32 v105, 1.0, v105
    v_add_f32 v106, 1.0, v106
    v_add_f32 v107, 1.0, v107
    v_rcp_f32 v100, v100
    v_rcp_f32 v101, v101
    v_rcp_f32 v102, v102
    v_rcp_f32 v103, v103
    v_rcp_f32 v104, v104
    v_rcp_f32 v105, v105
    v_rcp_f32 v106, v106
    v_rcp_f32 v107, v107
    v_mul_f32 v92, v92, v100
    v_mul_f32 v93, v93, v101
    v_mul_f32 v94, v94, v102
    v_mul_f32 v95, v95, v103
    v_mul_f32 v96, v96, v104
    v_mul_f32 v97, v97, v105
    v_mul_f32 v98, v98, v106
    v_mul_f32 v99, v99, v107
    v_cvt_pk_bf16_f32 v116, v92, v93
    v_cvt_pk_bf16_f32 v117, v94, v95
    v_cvt_pk_bf16_f32 v118, v96, v97
    v_cvt_pk_bf16_f32 v119, v98, v99
    v_and_b32 v116, s39, v116
    v_and_b32 v117, s39, v117
    v_and_b32 v118, s39, v118
    v_and_b32 v119, s39, v119
    v_add_u32 v123, 40, v122
    v_cmp_gt_u32 vcc, 160, v123
    s_nop 0
    s_and_saveexec_b64 s[40:41], vcc
    ds_write_b128 v57, v[116:119] offset:2560
    s_mov_b64 exec, s[40:41]
    s_waitcnt vmcnt(0)
    s_waitcnt lgkmcnt(0)
    s_barrier
    ds_read_b64_tr_b16 v[60:61], v49 offset:0
    ds_read_b64_tr_b16 v[62:63], v49 offset:256
    ds_read_b64_tr_b16 v[64:65], v49 offset:2048
    ds_read_b64_tr_b16 v[66:67], v49 offset:2304
    ds_read_b64_tr_b16 v[68:69], v50 offset:0
    ds_read_b64_tr_b16 v[70:71], v50 offset:256
    ds_read_b64_tr_b16 v[72:73], v50 offset:2048
    ds_read_b64_tr_b16 v[74:75], v50 offset:2304
    s_waitcnt lgkmcnt(0)
    v_mfma_f32_16x16x32_bf16 v[92:95], v[60:63], v[32:35], 0
    v_mfma_f32_16x16x32_bf16 v[96:99], v[68:71], v[32:35], 0
    v_mfma_f32_16x16x32_bf16 v[92:95], v[64:67], v[36:39], v[92:95]
    v_mfma_f32_16x16x32_bf16 v[96:99], v[72:75], v[36:39], v[96:99]
    ds_read_b64_tr_b16 v[76:77], v51 offset:0
    ds_read_b64_tr_b16 v[78:79], v53 offset:0
    ds_read_b64_tr_b16 v[80:81], v51 offset:2048
    ds_read_b64_tr_b16 v[82:83], v53 offset:2048
    ds_read_b64_tr_b16 v[84:85], v52 offset:0
    ds_read_b64_tr_b16 v[86:87], v54 offset:0
    ds_read_b64_tr_b16 v[88:89], v52 offset:2048
    ds_read_b64_tr_b16 v[90:91], v54 offset:2048
    v_cvt_pk_bf16_f32 v108, v92, v93
    v_cvt_pk_bf16_f32 v109, v94, v95
    v_cvt_pk_bf16_f32 v110, v96, v97
    v_cvt_pk_bf16_f32 v111, v98, v99
    s_add_u32 s38, s37, 0
    buffer_store_dwordx4 v[108:111], v58, s[16:19], s38 offen sc1
    s_waitcnt lgkmcnt(0)
    v_mfma_f32_16x16x32_bf16 v[100:103], v[76:79], v[32:35], 0
    v_mfma_f32_16x16x32_bf16 v[104:107], v[84:87], v[32:35], 0
    v_mfma_f32_16x16x32_bf16 v[100:103], v[80:83], v[36:39], v[100:103]
    v_mfma_f32_16x16x32_bf16 v[104:107], v[88:91], v[36:39], v[104:107]
    ds_read_b64_tr_b16 v[60:61], v49 offset:3072
    ds_read_b64_tr_b16 v[62:63], v49 offset:3328
    ds_read_b64_tr_b16 v[64:65], v49 offset:5120
    ds_read_b64_tr_b16 v[66:67], v49 offset:5376
    ds_read_b64_tr_b16 v[68:69], v50 offset:3072
    ds_read_b64_tr_b16 v[70:71], v50 offset:3328
    ds_read_b64_tr_b16 v[72:73], v50 offset:5120
    ds_read_b64_tr_b16 v[74:75], v50 offset:5376
    v_cvt_pk_bf16_f32 v112, v100, v101
    v_cvt_pk_bf16_f32 v113, v102, v103
    v_cvt_pk_bf16_f32 v114, v104, v105
    v_cvt_pk_bf16_f32 v115, v106, v107
    s_add_u32 s38, s37, 1024
    buffer_store_dwordx4 v[112:115], v58, s[16:19], s38 offen sc1
    s_waitcnt lgkmcnt(0)
    v_mfma_f32_16x16x32_bf16 v[92:95], v[60:63], v[32:35], 0
    v_mfma_f32_16x16x32_bf16 v[96:99], v[68:71], v[32:35], 0
    v_mfma_f32_16x16x32_bf16 v[92:95], v[64:67], v[36:39], v[92:95]
    v_mfma_f32_16x16x32_bf16 v[96:99], v[72:75], v[36:39], v[96:99]
    ds_read_b64_tr_b16 v[76:77], v51 offset:3072
    ds_read_b64_tr_b16 v[78:79], v53 offset:3072
    ds_read_b64_tr_b16 v[80:81], v51 offset:5120
    ds_read_b64_tr_b16 v[82:83], v53 offset:5120
    ds_read_b64_tr_b16 v[84:85], v52 offset:3072
    ds_read_b64_tr_b16 v[86:87], v54 offset:3072
    ds_read_b64_tr_b16 v[88:89], v52 offset:5120
    ds_read_b64_tr_b16 v[90:91], v54 offset:5120
    v_cvt_pk_bf16_f32 v108, v92, v93
    v_cvt_pk_bf16_f32 v109, v94, v95
    v_cvt_pk_bf16_f32 v110, v96, v97
    v_cvt_pk_bf16_f32 v111, v98, v99
    s_add_u32 s38, s37, 2048
    buffer_store_dwordx4 v[108:111], v58, s[16:19], s38 offen sc1
    s_waitcnt lgkmcnt(0)
    v_mfma_f32_16x16x32_bf16 v[100:103], v[76:79], v[32:35], 0
    v_mfma_f32_16x16x32_bf16 v[104:107], v[84:87], v[32:35], 0
    v_mfma_f32_16x16x32_bf16 v[100:103], v[80:83], v[36:39], v[100:103]
    v_mfma_f32_16x16x32_bf16 v[104:107], v[88:91], v[36:39], v[104:107]
    ds_read_b64_tr_b16 v[60:61], v49 offset:6144
    ds_read_b64_tr_b16 v[62:63], v49 offset:6400
    ds_read_b64_tr_b16 v[64:65], v49 offset:8192
    ds_read_b64_tr_b16 v[66:67], v49 offset:8448
    ds_read_b64_tr_b16 v[68:69], v50 offset:6144
    ds_read_b64_tr_b16 v[70:71], v50 offset:6400
    ds_read_b64_tr_b16 v[72:73], v50 offset:8192
    ds_read_b64_tr_b16 v[74:75], v50 offset:8448
    v_cvt_pk_bf16_f32 v112, v100, v101
    v_cvt_pk_bf16_f32 v113, v102, v103
    v_cvt_pk_bf16_f32 v114, v104, v105
    v_cvt_pk_bf16_f32 v115, v106, v107
    s_add_u32 s38, s37, 3072
    buffer_store_dwordx4 v[112:115], v58, s[16:19], s38 offen sc1
    s_waitcnt lgkmcnt(0)
    v_mfma_f32_16x16x32_bf16 v[92:95], v[60:63], v[32:35], 0
    v_mfma_f32_16x16x32_bf16 v[96:99], v[68:71], v[32:35], 0
    v_mfma_f32_16x16x32_bf16 v[92:95], v[64:67], v[36:39], v[92:95]
    v_mfma_f32_16x16x32_bf16 v[96:99], v[72:75], v[36:39], v[96:99]
    ds_read_b64_tr_b16 v[76:77], v51 offset:6144
    ds_read_b64_tr_b16 v[78:79], v53 offset:6144
    ds_read_b64_tr_b16 v[80:81], v51 offset:8192
    ds_read_b64_tr_b16 v[82:83], v53 offset:8192
    ds_read_b64_tr_b16 v[84:85], v52 offset:6144
    ds_read_b64_tr_b16 v[86:87], v54 offset:6144
    ds_read_b64_tr_b16 v[88:89], v52 offset:8192
    ds_read_b64_tr_b16 v[90:91], v54 offset:8192
    v_cvt_pk_bf16_f32 v108, v92, v93
    v_cvt_pk_bf16_f32 v109, v94, v95
    v_cvt_pk_bf16_f32 v110, v96, v97
    v_cvt_pk_bf16_f32 v111, v98, v99
    s_add_u32 s38, s37, 4096
    buffer_store_dwordx4 v[108:111], v58, s[16:19], s38 offen sc1
    s_waitcnt lgkmcnt(0)
    v_mfma_f32_16x16x32_bf16 v[100:103], v[76:79], v[32:35], 0
    v_mfma_f32_16x16x32_bf16 v[104:107], v[84:87], v[32:35], 0
    v_mfma_f32_16x16x32_bf16 v[100:103], v[80:83], v[36:39], v[100:103]
    v_mfma_f32_16x16x32_bf16 v[104:107], v[88:91], v[36:39], v[104:107]
    s_nop 7
    v_cvt_pk_bf16_f32 v112, v100, v101
    v_cvt_pk_bf16_f32 v113, v102, v103
    v_cvt_pk_bf16_f32 v114, v104, v105
    v_cvt_pk_bf16_f32 v115, v106, v107
    s_add_u32 s38, s37, 5120
    buffer_store_dwordx4 v[112:115], v58, s[16:19], s38 offen sc1
    s_endpgm
L_mid_kernel_g:
    s_sub_u32 s3, s2, 448
    s_load_dwordx2 s[4:5], s[0:1], 16
    s_load_dwordx2 s[6:7], s[0:1], 72
    s_lshr_b32 s24, s3, 4
    s_bfe_u32 s25, s3, 0x20002
    s_and_b32 s26, s3, 3
    s_lshr_b32 s27, s24, 3
    s_and_b32 s28, s24, 7
    v_and_b32 v1, 63, v0
    v_lshrrev_b32 v2, 3, v1
    v_mov_b32 v3, v2
    s_lshl_b32 s29, s25, 3
    s_lshl_b32 s30, s28, 5
    s_add_u32 s29, s29, s30
    v_add_u32 v3, s29, v3
    v_lshlrev_b32 v3, 9, v3
    v_and_b32 v4, 7, v1
    s_lshr_b32 s30, s20, 1
    s_lshl_b32 s30, s30, 2
    v_xor_b32 v4, s30, v4
    v_lshl_add_u32 v3, v4, 4, v3
    s_lshl_b32 s30, s26, 7
    v_add_u32 v3, s30, v3
    v_xor_b32 v4, 32, v3
    s_waitcnt lgkmcnt(0)
    s_mov_b32 s8, s4
    s_mov_b32 s9, s5
    s_mov_b32 s10, 4063232
    s_mov_b32 s11, 0x00020000
    s_add_u32 s12, s6, 62345216
    s_addc_u32 s13, s7, 0
    s_mov_b32 s14, 16916480
    s_mov_b32 s15, 0x00020000
    s_lshl_b32 s30, s20, 3
    s_add_u32 s30, s30, s27
    s_lshl_b32 s30, s30, 17
    s_mul_i32 s31, s20, 4608
    s_add_u32 m0, s31, 0
    s_add_u32 s32, s30, 0
    buffer_load_dwordx4 v3, s[8:11], s32 offen nt lds
    s_add_u32 m0, s31, 1152
    s_add_u32 s32, s30, 262144
    buffer_load_dwordx4 v3, s[8:11], s32 offen nt lds
    s_add_u32 m0, s31, 2304
    s_add_u32 s32, s30, 524288
    buffer_load_dwordx4 v4, s[8:11], s32 offen nt lds
    s_add_u32 m0, s31, 3456
    s_add_u32 s32, s30, 786432
    buffer_load_dwordx4 v4, s[8:11], s32 offen nt lds
    v_and_b32 v8, 15, v1
    v_or_b32 v9, 1, v8
    s_lshl_b32 s33, s20, 4
    v_add_u32 v9, s33, v9
    v_cvt_f32_u32 v9, v9
    v_mul_f32 v9, 0x3c000000, v9
    v_bfe_u32 v10, v1, 4, 1
    v_lshlrev_b32 v10, 3, v10
    v_cvt_f32_u32 v10, v10
    v_and_b32 v8, 1, v8
    v_cvt_f32_u32 v8, v8
    v_mul_f32 v8, 0x3f400000, v8
    v_fma_f32 v11, v9, v10, v8
    v_fract_f32 v12, v11
    v_add_f32 v11, v11, v9
    v_fract_f32 v13, v11
    v_add_f32 v11, v11, v9
    v_fract_f32 v14, v11
    v_add_f32 v11, v11, v9
    v_fract_f32 v15, v11
    v_add_f32 v11, v11, v9
    v_fract_f32 v16, v11
    v_add_f32 v11, v11, v9
    v_fract_f32 v17, v11
    v_add_f32 v11, v11, v9
    v_fract_f32 v18, v11
    v_add_f32 v11, v11, v9
    v_fract_f32 v19, v11
    v_cos_f32 v12, v12
    v_cos_f32 v13, v13
    v_cos_f32 v14, v14
    v_cos_f32 v15, v15
    v_cos_f32 v16, v16
    v_cos_f32 v17, v17
    v_cos_f32 v18, v18
    v_cos_f32 v19, v19
    s_nop 0
    v_mul_f32 v12, 0x3d000000, v12
    v_mul_f32 v13, 0x3d000000, v13
    v_mul_f32 v14, 0x3d000000, v14
    v_mul_f32 v15, 0x3d000000, v15
    v_mul_f32 v16, 0x3d000000, v16
    v_mul_f32 v17, 0x3d000000, v17
    v_mul_f32 v18, 0x3d000000, v18
    v_mul_f32 v19, 0x3d000000, v19
    v_cvt_pk_bf16_f32 v20, v12, v13
    v_cvt_pk_bf16_f32 v21, v14, v15
    v_cvt_pk_bf16_f32 v22, v16, v17
    v_cvt_pk_bf16_f32 v23, v18, v19
    v_lshlrev_b32 v28, 16, v20
    v_and_b32 v29, 0xffff0000, v20
    v_sub_f32 v28, v12, v28
    v_sub_f32 v29, v13, v29
    v_cvt_pk_bf16_f32 v24, v28, v29
    v_lshlrev_b32 v28, 16, v21
    v_and_b32 v29, 0xffff0000, v21
    v_sub_f32 v28, v14, v28
    v_sub_f32 v29, v15, v29
    v_cvt_pk_bf16_f32 v25, v28, v29
    v_lshlrev_b32 v28, 16, v22
    v_and_b32 v29, 0xffff0000, v22
    v_sub_f32 v28, v16, v28
    v_sub_f32 v29, v17, v29
    v_cvt_pk_bf16_f32 v26, v28, v29
    v_lshlrev_b32 v28, 16, v23
    v_and_b32 v29, 0xffff0000, v23
    v_sub_f32 v28, v18, v28
    v_sub_f32 v29, v19, v29
    v_cvt_pk_bf16_f32 v27, v28, v29
    v_cmp_gt_u32 vcc, 32, v1
    s_nop 1
    v_cndmask_b32 v20, v24, v20, vcc
    v_cndmask_b32 v21, v25, v21, vcc
    v_cndmask_b32 v22, v26, v22, vcc
    v_cndmask_b32 v23, v27, v23, vcc
    v_lshlrev_b32 v28, 4, v1
    s_lshl_b32 s33, s20, 10
    v_add_u32 v29, s33, v28
    ds_write_b128 v29, v[20:23] offset:18432
    v_bfe_u32 v30, v1, 2, 2
    v_bfe_u32 v31, v1, 4, 1
    v_lshl_add_u32 v32, v31, 3, v30
    v_mul_u32_u24 v32, 1152, v32
    v_lshrrev_b32 v30, 1, v30
    v_lshl_add_u32 v30, v31, 1, v30
    v_lshlrev_b32 v30, 1, v30
    v_bfe_u32 v31, v1, 1, 1
    s_lshl_b32 s33, s20, 1
    v_add_u32 v31, s33, v31
    v_xor_b32 v30, v30, v31
    v_lshl_add_u32 v32, v30, 4, v32
    v_and_b32 v30, 1, v1
    v_lshl_add_u32 v32, v30, 3, v32
    v_lshrrev_b32 v30, 4, v1
    s_mov_b32 s33, 1057280
    v_mul_lo_u32 v30, v30, s33
    v_and_b32 v31, 15, v1
    v_lshl_add_u32 v33, v31, 4, v30
    s_lshl_b32 s34, s24, 15
    s_lshl_b32 s35, s26, 2
    s_add_u32 s35, s35, s20
    s_lshl_b32 s35, s35, 11
    s_add_u32 s34, s34, s35
    s_lshl_b32 s35, s25, 8
    s_add_u32 s34, s34, s35
    s_waitcnt vmcnt(0) lgkmcnt(0)
    s_barrier
    ds_read_b128 v[36:39], v28 offset:18432
    ds_read_b128 v[40:43], v28 offset:19456
    ds_read_b128 v[44:47], v28 offset:20480
    ds_read_b128 v[48:51], v28 offset:21504
    ds_read_b64_tr_b16 v[52:53], v32 offset:0
    ds_read_b64_tr_b16 v[54:55], v32 offset:4608
    ds_read_b64_tr_b16 v[56:57], v32 offset:128
    ds_read_b64_tr_b16 v[58:59], v32 offset:4736
    ds_read_b64_tr_b16 v[60:61], v32 offset:256
    ds_read_b64_tr_b16 v[62:63], v32 offset:4864
    ds_read_b64_tr_b16 v[64:65], v32 offset:384
    ds_read_b64_tr_b16 v[66:67], v32 offset:4992
    ds_read_b64_tr_b16 v[68:69], v32 offset:512
    ds_read_b64_tr_b16 v[70:71], v32 offset:5120
    s_waitcnt lgkmcnt(8)
    ds_read_b64_tr_b16 v[72:73], v32 offset:640
    ds_read_b64_tr_b16 v[74:75], v32 offset:5248
    ds_read_b64_tr_b16 v[76:77], v32 offset:768
    ds_read_b64_tr_b16 v[78:79], v32 offset:5376
    ds_read_b64_tr_b16 v[80:81], v32 offset:896
    ds_read_b64_tr_b16 v[82:83], v32 offset:5504
    s_waitcnt lgkmcnt(0)
    v_mfma_f32_16x16x32_bf16 v[84:87], v[36:39], v[52:55], 0
    v_mfma_f32_16x16x32_bf16 v[88:91], v[36:39], v[56:59], 0
    v_mfma_f32_16x16x32_bf16 v[92:95], v[36:39], v[60:63], 0
    v_mfma_f32_16x16x32_bf16 v[96:99], v[36:39], v[64:67], 0
    v_mfma_f32_16x16x32_bf16 v[100:103], v[36:39], v[68:71], 0
    v_mfma_f32_16x16x32_bf16 v[104:107], v[36:39], v[72:75], 0
    v_mfma_f32_16x16x32_bf16 v[108:111], v[36:39], v[76:79], 0
    v_mfma_f32_16x16x32_bf16 v[112:115], v[36:39], v[80:83], 0
    s_nop 7
    v_cvt_pk_bf16_f32 v116, v84, v88
    v_cvt_pk_bf16_f32 v117, v92, v96
    v_cvt_pk_bf16_f32 v118, v100, v104
    v_cvt_pk_bf16_f32 v119, v108, v112
    s_add_u32 s35, s34, 0
    buffer_store_dwordx4 v[116:119], v33, s[12:15], s35 offen sc1
    s_nop 1
    v_cvt_pk_bf16_f32 v120, v85, v89
    v_cvt_pk_bf16_f32 v121, v93, v97
    v_cvt_pk_bf16_f32 v122, v101, v105
    v_cvt_pk_bf16_f32 v123, v109, v113
    s_add_u32 s35, s34, 1024
    buffer_store_dwordx4 v[120:123], v33, s[12:15], s35 offen sc1
    s_nop 1
    v_cvt_pk_bf16_f32 v116, v86, v90
    v_cvt_pk_bf16_f32 v117, v94, v98
    v_cvt_pk_bf16_f32 v118, v102, v106
    v_cvt_pk_bf16_f32 v119, v110, v114
    s_add_u32 s35, s34, 528640
    buffer_store_dwordx4 v[116:119], v33, s[12:15], s35 offen sc1
    s_nop 1
    v_cvt_pk_bf16_f32 v120, v87, v91
    v_cvt_pk_bf16_f32 v121, v95, v99
    v_cvt_pk_bf16_f32 v122, v103, v107
    v_cvt_pk_bf16_f32 v123, v111, v115
    s_add_u32 s35, s34, 529664
    buffer_store_dwordx4 v[120:123], v33, s[12:15], s35 offen sc1
    s_nop 1
    v_mfma_f32_16x16x32_bf16 v[84:87], v[40:43], v[52:55], 0
    v_mfma_f32_16x16x32_bf16 v[88:91], v[40:43], v[56:59], 0
    v_mfma_f32_16x16x32_bf16 v[92:95], v[40:43], v[60:63], 0
    v_mfma_f32_16x16x32_bf16 v[96:99], v[40:43], v[64:67], 0
    v_mfma_f32_16x16x32_bf16 v[100:103], v[40:43], v[68:71], 0
    v_mfma_f32_16x16x32_bf16 v[104:107], v[40:43], v[72:75], 0
    v_mfma_f32_16x16x32_bf16 v[108:111], v[40:43], v[76:79], 0
    v_mfma_f32_16x16x32_bf16 v[112:115], v[40:43], v[80:83], 0
    s_nop 7
    v_cvt_pk_bf16_f32 v116, v84, v88
    v_cvt_pk_bf16_f32 v117, v92, v96
    v_cvt_pk_bf16_f32 v118, v100, v104
    v_cvt_pk_bf16_f32 v119, v108, v112
    s_add_u32 s35, s34, 4229120
    buffer_store_dwordx4 v[116:119], v33, s[12:15], s35 offen sc1
    s_nop 1
    v_cvt_pk_bf16_f32 v120, v85, v89
    v_cvt_pk_bf16_f32 v121, v93, v97
    v_cvt_pk_bf16_f32 v122, v101, v105
    v_cvt_pk_bf16_f32 v123, v109, v113
    s_add_u32 s35, s34, 4230144
    buffer_store_dwordx4 v[120:123], v33, s[12:15], s35 offen sc1
    s_nop 1
    v_cvt_pk_bf16_f32 v116, v86, v90
    v_cvt_pk_bf16_f32 v117, v94, v98
    v_cvt_pk_bf16_f32 v118, v102, v106
    v_cvt_pk_bf16_f32 v119, v110, v114
    s_add_u32 s35, s34, 4757760
    buffer_store_dwordx4 v[116:119], v33, s[12:15], s35 offen sc1
    s_nop 1
    v_cvt_pk_bf16_f32 v120, v87, v91
    v_cvt_pk_bf16_f32 v121, v95, v99
    v_cvt_pk_bf16_f32 v122, v103, v107
    v_cvt_pk_bf16_f32 v123, v111, v115
    s_add_u32 s35, s34, 4758784
    buffer_store_dwordx4 v[120:123], v33, s[12:15], s35 offen sc1
    s_nop 1
    v_mfma_f32_16x16x32_bf16 v[84:87], v[44:47], v[52:55], 0
    v_mfma_f32_16x16x32_bf16 v[88:91], v[44:47], v[56:59], 0
    v_mfma_f32_16x16x32_bf16 v[92:95], v[44:47], v[60:63], 0
    v_mfma_f32_16x16x32_bf16 v[96:99], v[44:47], v[64:67], 0
    v_mfma_f32_16x16x32_bf16 v[100:103], v[44:47], v[68:71], 0
    v_mfma_f32_16x16x32_bf16 v[104:107], v[44:47], v[72:75], 0
    v_mfma_f32_16x16x32_bf16 v[108:111], v[44:47], v[76:79], 0
    v_mfma_f32_16x16x32_bf16 v[112:115], v[44:47], v[80:83], 0
    s_nop 7
    v_cvt_pk_bf16_f32 v116, v84, v88
    v_cvt_pk_bf16_f32 v117, v92, v96
    v_cvt_pk_bf16_f32 v118, v100, v104
    v_cvt_pk_bf16_f32 v119, v108, v112
    s_add_u32 s35, s34, 8458240
    buffer_store_dwordx4 v[116:119], v33, s[12:15], s35 offen sc1
    s_nop 1
    v_cvt_pk_bf16_f32 v120, v85, v89
    v_cvt_pk_bf16_f32 v121, v93, v97
    v_cvt_pk_bf16_f32 v122, v101, v105
    v_cvt_pk_bf16_f32 v123, v109, v113
    s_add_u32 s35, s34, 8459264
    buffer_store_dwordx4 v[120:123], v33, s[12:15], s35 offen sc1
    s_nop 1
    v_cvt_pk_bf16_f32 v116, v86, v90
    v_cvt_pk_bf16_f32 v117, v94, v98
    v_cvt_pk_bf16_f32 v118, v102, v106
    v_cvt_pk_bf16_f32 v119, v110, v114
    s_add_u32 s35, s34, 8986880
    buffer_store_dwordx4 v[116:119], v33, s[12:15], s35 offen sc1
    s_nop 1
    v_cvt_pk_bf16_f32 v120, v87, v91
    v_cvt_pk_bf16_f32 v121, v95, v99
    v_cvt_pk_bf16_f32 v122, v103, v107
    v_cvt_pk_bf16_f32 v123, v111, v115
    s_add_u32 s35, s34, 8987904
    buffer_store_dwordx4 v[120:123], v33, s[12:15], s35 offen sc1
    s_nop 1
    v_mfma_f32_16x16x32_bf16 v[84:87], v[48:51], v[52:55], 0
    v_mfma_f32_16x16x32_bf16 v[88:91], v[48:51], v[56:59], 0
    v_mfma_f32_16x16x32_bf16 v[92:95], v[48:51], v[60:63], 0
    v_mfma_f32_16x16x32_bf16 v[96:99], v[48:51], v[64:67], 0
    v_mfma_f32_16x16x32_bf16 v[100:103], v[48:51], v[68:71], 0
    v_mfma_f32_16x16x32_bf16 v[104:107], v[48:51], v[72:75], 0
    v_mfma_f32_16x16x32_bf16 v[108:111], v[48:51], v[76:79], 0
    v_mfma_f32_16x16x32_bf16 v[112:115], v[48:51], v[80:83], 0
    s_nop 7
    v_cvt_pk_bf16_f32 v116, v84, v88
    v_cvt_pk_bf16_f32 v117, v92, v96
    v_cvt_pk_bf16_f32 v118, v100, v104
    v_cvt_pk_bf16_f32 v119, v108, v112
    s_add_u32 s35, s34, 12687360
    buffer_store_dwordx4 v[116:119], v33, s[12:15], s35 offen sc1
    s_nop 1
    v_cvt_pk_bf16_f32 v120, v85, v89
    v_cvt_pk_bf16_f32 v121, v93, v97
    v_cvt_pk_bf16_f32 v122, v101, v105
    v_cvt_pk_bf16_f32 v123, v109, v113
    s_add_u32 s35, s34, 12688384
    buffer_store_dwordx4 v[120:123], v33, s[12:15], s35 offen sc1
    s_nop 1
    v_cvt_pk_bf16_f32 v116, v86, v90
    v_cvt_pk_bf16_f32 v117, v94, v98
    v_cvt_pk_bf16_f32 v118, v102, v106
    v_cvt_pk_bf16_f32 v119, v110, v114
    s_add_u32 s35, s34, 13216000
    buffer_store_dwordx4 v[116:119], v33, s[12:15], s35 offen sc1
    s_nop 1
    v_cvt_pk_bf16_f32 v120, v87, v91
    v_cvt_pk_bf16_f32 v121, v95, v99
    v_cvt_pk_bf16_f32 v122, v103, v107
    v_cvt_pk_bf16_f32 v123, v111, v115
    s_add_u32 s35, s34, 13217024
    buffer_store_dwordx4 v[120:123], v33, s[12:15], s35 offen sc1
    s_nop 1
    s_endpgm
L_mid_kernel_done:
    s_endpgm
.globl gemm2_kernel
.p2align 8
.type gemm2_kernel,@function
gemm2_kernel:
    s_cmp_ge_u32 s2, 256
    s_cbranch_scc1 L_gemm2_kernel_done
    s_load_dwordx2 s[4:5], s[0:1], 72
    s_load_dwordx2 s[6:7], s[0:1], 72
    v_readfirstlane_b32 s20, v0
    s_lshr_b32 s20, s20, 6
    s_and_b32 s24, s2, 7
    s_lshr_b32 s25, s2, 3
    s_lshr_b32 s26, s25, 3
    s_lshl_b32 s24, s24, 2
    s_add_u32 s21, s24, s26
    s_and_b32 s25, s25, 7
    s_lshr_b32 s26, s25, 2
    s_and_b32 s27, s25, 3
    s_mul_i32 s22, s26, 84
    s_sub_u32 s28, 168, s22
    s_min_u32 s28, s28, 84
    s_waitcnt lgkmcnt(0)
    s_mul_i32 s29, s21, 344064
    s_lshl_b32 s30, s22, 11
    s_add_u32 s29, s29, s30
    s_add_u32 s29, s29, 51269632
    s_add_u32 s8, s6, s29
    s_addc_u32 s9, s7, 0
    s_lshl_b32 s10, s28, 11
    s_mov_b32 s11, 0x00020000
    s_mul_i32 s29, s21, 528640
    s_mul_i32 s30, s27, 8192
    s_add_u32 s29, s29, s30
    s_add_u32 s29, s29, 62345216
    s_add_u32 s12, s4, s29
    s_addc_u32 s13, s5, 0
    s_mov_b32 s14, 499712
    s_mov_b32 s15, 0x00020000
    s_cmp_lt_u32 s20, 4
    s_cbranch_scc1 L_gemm2_kernel_consumer
    s_sub_u32 s20, s20, 4
    v_and_b32 v1, 63, v0
    v_lshrrev_b32 v4, 3, v1
    v_and_b32 v5, 7, v1
    v_xor_b32 v5, v5, v4
    v_lshlrev_b32 v5, 4, v5
    v_lshl_add_u32 v2, v4, 11, v5
    v_lshlrev_b32 v3, 4, v1
    s_add_u32 s24, s20, 0
    s_lshl_b32 s40, s24, 10
    s_lshl_b32 s43, s24, 14
    s_add_u32 s24, s20, 4
    s_lshl_b32 s41, s24, 10
    s_lshl_b32 s44, s24, 14
    s_add_u32 s24, s20, 8
    s_lshl_b32 s42, s24, 10
    s_lshl_b32 s45, s24, 14
    s_mul_i32 s46, s20, 2048
    s_add_u32 s47, s46, 12288
    s_add_u32 m0, s40, 0
    s_add_u32 s24, s43, 0
    buffer_load_dwordx4 v2, s[8:11], s24 offen lds
    s_add_u32 m0, s41, 0
    s_add_u32 s24, s44, 0
    buffer_load_dwordx4 v2, s[8:11], s24 offen lds
    s_add_u32 m0, s42, 0
    s_add_u32 s24, s45, 0
    buffer_load_dwordx4 v2, s[8:11], s24 offen lds
    s_add_u32 m0, s47, 0
    s_add_u32 s24, s46, 0
    buffer_load_dwordx4 v3, s[12:15], s24 offen offset:0 lds
    buffer_load_dwordx4 v3, s[12:15], s24 offen offset:1024 lds
    s_add_u32 m0, s40, 20480
    s_add_u32 s24, s43, 128
    buffer_load_dwordx4 v2, s[8:11], s24 offen lds
    s_add_u32 m0, s41, 20480
    s_add_u32 s24, s44, 128
    buffer_load_dwordx4 v2, s[8:11], s24 offen lds
    s_add_u32 m0, s42, 20480
    s_add_u32 s24, s45, 128
    buffer_load_dwordx4 v2, s[8:11], s24 offen lds
    s_add_u32 m0, s47, 20480
    s_add_u32 s24, s46, 32768
    buffer_load_dwordx4 v3, s[12:15], s24 offen offset:0 lds
    buffer_load_dwordx4 v3, s[12:15], s24 offen offset:1024 lds
    s_waitcnt vmcnt(5)
    s_barrier
    s_add_u32 m0, s40, 40960
    s_add_u32 s24, s43, 256
    buffer_load_dwordx4 v2, s[8:11], s24 offen lds
    s_add_u32 m0, s41, 40960
    s_add_u32 s24, s44, 256
    buffer_load_dwordx4 v2, s[8:11], s24 offen lds
    s_add_u32 m0, s42, 40960
    s_add_u32 s24, s45, 256
    buffer_load_dwordx4 v2, s[8:11], s24 offen lds
    s_add_u32 m0, s47, 40960
    s_add_u32 s24, s46, 65536
    buffer_load_dwordx4 v3, s[12:15], s24 offen offset:0 lds
    buffer_load_dwordx4 v3, s[12:15], s24 offen offset:1024 lds
    s_waitcnt vmcnt(5)
    s_barrier
    s_add_u32 m0, s40, 61440
    s_add_u32 s24, s43, 384
    buffer_load_dwordx4 v2, s[8:11], s24 offen lds
    s_add_u32 m0, s41, 61440
    s_add_u32 s24, s44, 384
    buffer_load_dwordx4 v2, s[8:11], s24 offen lds
    s_add_u32 m0, s42, 61440
    s_add_u32 s24, s45, 384
    buffer_load_dwordx4 v2, s[8:11], s24 offen lds
    s_add_u32 m0, s47, 61440
    s_add_u32 s24, s46, 98304
    buffer_load_dwordx4 v3, s[12:15], s24 offen offset:0 lds
    buffer_load_dwordx4 v3, s[12:15], s24 offen offset:1024 lds
    s_add_u32 m0, s40, 81920
    s_add_u32 s24, s43, 512
    buffer_load_dwordx4 v2, s[8:11], s24 offen lds
    s_add_u32 m0, s41, 81920
    s_add_u32 s24, s44, 512
    buffer_load_dwordx4 v2, s[8:11], s24 offen lds
    s_add_u32 m0, s42, 81920
    s_add_u32 s24, s45, 512
    buffer_load_dwordx4 v2, s[8:11], s24 offen lds
    s_add_u32 m0, s47, 81920
    s_add_u32 s24, s46, 131072
    buffer_load_dwordx4 v3, s[12:15], s24 offen offset:0 lds
    buffer_load_dwordx4 v3, s[12:15], s24 offen offset:1024 lds
    s_waitcnt vmcnt(10)
    s_barrier
    s_add_u32 m0, s40, 102400
    s_add_u32 s24, s43, 640
    buffer_load_dwordx4 v2, s[8:11], s24 offen lds
    s_add_u32 m0, s41, 102400
    s_add_u32 s24, s44, 640
    buffer_load_dwordx4 v2, s[8:11], s24 offen lds
    s_add_u32 m0, s42, 102400
    s_add_u32 s24, s45, 640
    buffer_load_dwordx4 v2, s[8:11], s24 offen lds
    s_add_u32 m0, s47, 102400
    s_add_u32 s24, s46, 163840
    buffer_load_dwordx4 v3, s[12:15], s24 offen offset:0 lds
    buffer_load_dwordx4 v3, s[12:15], s24 offen offset:1024 lds
    s_add_u32 m0, s40, 122880
    s_add_u32 s24, s43, 768
    buffer_load_dwordx4 v2, s[8:11], s24 offen lds
    s_add_u32 m0, s41, 122880
    s_add_u32 s24, s44, 768
    buffer_load_dwordx4 v2, s[8:11], s24 offen lds
    s_add_u32 m0, s42, 122880
    s_add_u32 s24, s45, 768
    buffer_load_dwordx4 v2, s[8:11], s24 offen lds
    s_add_u32 m0, s47, 122880
    s_add_u32 s24, s46, 196608
    buffer_load_dwordx4 v3, s[12:15], s24 offen offset:0 lds
    buffer_load_dwordx4 v3, s[12:15], s24 offen offset:1024 lds
    s_waitcnt vmcnt(15)
    s_barrier
    s_add_u32 m0, s40, 0
    s_add_u32 s24, s43, 896
    buffer_load_dwordx4 v2, s[8:11], s24 offen lds
    s_add_u32 m0, s41, 0
    s_add_u32 s24, s44, 896
    buffer_load_dwordx4 v2, s[8:11], s24 offen lds
    s_add_u32 m0, s42, 0
    s_add_u32 s24, s45, 896
    buffer_load_dwordx4 v2, s[8:11], s24 offen lds
    s_add_u32 m0, s47, 0
    s_add_u32 s24, s46, 229376
    buffer_load_dwordx4 v3, s[12:15], s24 offen offset:0 lds
    buffer_load_dwordx4 v3, s[12:15], s24 offen offset:1024 lds
    s_add_u32 m0, s40, 20480
    s_add_u32 s24, s43, 1024
    buffer_load_dwordx4 v2, s[8:11], s24 offen lds
    s_add_u32 m0, s41, 20480
    s_add_u32 s24, s44, 1024
    buffer_load_dwordx4 v2, s[8:11], s24 offen lds
    s_add_u32 m0, s42, 20480
    s_add_u32 s24, s45, 1024
    buffer_load_dwordx4 v2, s[8:11], s24 offen lds
    s_add_u32 m0, s47, 20480
    s_add_u32 s24, s46, 262144
    buffer_load_dwordx4 v3, s[12:15], s24 offen offset:0 lds
    buffer_load_dwordx4 v3, s[12:15], s24 offen offset:1024 lds
    s_waitcnt vmcnt(20)
    s_barrier
    s_add_u32 m0, s40, 40960
    s_add_u32 s24, s43, 1152
    buffer_load_dwordx4 v2, s[8:11], s24 offen lds
    s_add_u32 m0, s41, 40960
    s_add_u32 s24, s44, 1152
    buffer_load_dwordx4 v2, s[8:11], s24 offen lds
    s_add_u32 m0, s42, 40960
    s_add_u32 s24, s45, 1152
    buffer_load_dwordx4 v2, s[8:11], s24 offen lds
    s_add_u32 m0, s47, 40960
    s_add_u32 s24, s46, 294912
    buffer_load_dwordx4 v3, s[12:15], s24 offen offset:0 lds
    buffer_load_dwordx4 v3, s[12:15], s24 offen offset:1024 lds
    s_add_u32 m0, s40, 61440
    s_add_u32 s24, s43, 1280
    buffer_load_dwordx4 v2, s[8:11], s24 offen lds
    s_add_u32 m0, s41, 61440
    s_add_u32 s24, s44, 1280
    buffer_load_dwordx4 v2, s[8:11], s24 offen lds
    s_add_u32 m0, s42, 61440
    s_add_u32 s24, s45, 1280
    buffer_load_dwordx4 v2, s[8:11], s24 offen lds
    s_add_u32 m0, s47, 61440
    s_add_u32 s24, s46, 327680
    buffer_load_dwordx4 v3, s[12:15], s24 offen offset:0 lds
    buffer_load_dwordx4 v3, s[12:15], s24 offen offset:1024 lds
    s_waitcnt vmcnt(25)
    s_barrier
    s_add_u32 m0, s40, 81920
    s_add_u32 s24, s43, 1408
    buffer_load_dwordx4 v2, s[8:11], s24 offen lds
    s_add_u32 m0, s41, 81920
    s_add_u32 s24, s44, 1408
    buffer_load_dwordx4 v2, s[8:11], s24 offen lds
    s_add_u32 m0, s42, 81920
    s_add_u32 s24, s45, 1408
    buffer_load_dwordx4 v2, s[8:11], s24 offen lds
    s_add_u32 m0, s47, 81920
    s_add_u32 s24, s46, 360448
    buffer_load_dwordx4 v3, s[12:15], s24 offen offset:0 lds
    buffer_load_dwordx4 v3, s[12:15], s24 offen offset:1024 lds
    s_waitcnt vmcnt(25)
    s_barrier
    s_add_u32 m0, s40, 102400
    s_add_u32 s24, s43, 1536
    buffer_load_dwordx4 v2, s[8:11], s24 offen lds
    s_add_u32 m0, s41, 102400
    s_add_u32 s24, s44, 1536
    buffer_load_dwordx4 v2, s[8:11], s24 offen lds
    s_add_u32 m0, s42, 102400
    s_add_u32 s24, s45, 1536
    buffer_load_dwordx4 v2, s[8:11], s24 offen lds
    s_add_u32 m0, s47, 102400
    s_add_u32 s24, s46, 393216
    buffer_load_dwordx4 v3, s[12:15], s24 offen offset:0 lds
    buffer_load_dwordx4 v3, s[12:15], s24 offen offset:1024 lds
    s_waitcnt vmcnt(25)
    s_barrier
    s_add_u32 m0, s40, 122880
    s_add_u32 s24, s43, 1664
    buffer_load_dwordx4 v2, s[8:11], s24 offen lds
    s_add_u32 m0, s41, 122880
    s_add_u32 s24, s44, 1664
    buffer_load_dwordx4 v2, s[8:11], s24 offen lds
    s_add_u32 m0, s42, 122880
    s_add_u32 s24, s45, 1664
    buffer_load_dwordx4 v2, s[8:11], s24 offen lds
    s_add_u32 m0, s47, 122880
    s_add_u32 s24, s46, 425984
    buffer_load_dwordx4 v3, s[12:15], s24 offen offset:0 lds
    buffer_load_dwordx4 v3, s[12:15], s24 offen offset:1024 lds
    s_waitcnt vmcnt(25)
    s_barrier
    s_add_u32 m0, s40, 0
    s_add_u32 s24, s43, 1792
    buffer_load_dwordx4 v2, s[8:11], s24 offen lds
    s_add_u32 m0, s41, 0
    s_add_u32 s24, s44, 1792
    buffer_load_dwordx4 v2, s[8:11], s24 offen lds
    s_add_u32 m0, s42, 0
    s_add_u32 s24, s45, 1792
    buffer_load_dwordx4 v2, s[8:11], s24 offen lds
    s_add_u32 m0, s47, 0
    s_add_u32 s24, s46, 458752
    buffer_load_dwordx4 v3, s[12:15], s24 offen offset:0 lds
    buffer_load_dwordx4 v3, s[12:15], s24 offen offset:1024 lds
    s_waitcnt vmcnt(25)
    s_barrier
    s_add_u32 m0, s40, 20480
    s_add_u32 s24, s43, 1920
    buffer_load_dwordx4 v2, s[8:11], s24 offen lds
    s_add_u32 m0, s41, 20480
    s_add_u32 s24, s44, 1920
    buffer_load_dwordx4 v2, s[8:11], s24 offen lds
    s_add_u32 m0, s42, 20480
    s_add_u32 s24, s45, 1920
    buffer_load_dwordx4 v2, s[8:11], s24 offen lds
    s_add_u32 m0, s47, 20480
    s_add_u32 s24, s46, 491520
    buffer_load_dwordx4 v3, s[12:15], s24 offen offset:0 lds
    buffer_load_dwordx4 v3, s[12:15], s24 offen offset:1024 lds
    s_waitcnt vmcnt(25)
    s_barrier
    s_waitcnt vmcnt(20)
    s_barrier
    s_waitcnt vmcnt(15)
    s_barrier
    s_waitcnt vmcnt(10)
    s_barrier
    s_waitcnt vmcnt(5)
    s_barrier
    s_waitcnt vmcnt(0)
    s_barrier
L_gemm2_kernel_done:
    s_endpgm
L_gemm2_kernel_consumer:
    s_mul_i32 s29, s22, 37120
    s_add_u32 s29, s29, 79261696
    s_add_u32 s16, s4, s29
    s_addc_u32 s17, s5, 0
    s_mul_i32 s18, s28, 37120
    s_mov_b32 s19, 0x00020000
    s_lshr_b32 s29, s20, 1
    s_and_b32 s30, s20, 1
    v_and_b32 v137, 15, v0
    v_bfe_u32 v138, v0, 4, 2
    v_and_b32 v139, 63, v0
    s_mul_i32 s31, s29, 6144
    v_and_b32 v140, 7, v137
    v_xor_b32 v140, v138, v140
    v_lshlrev_b32 v140, 4, v140
    v_lshl_add_u32 v140, v137, 7, v140
    v_add_u32 v140, s31, v140
    v_add_u32 v128, 0, v140
    v_xor_b32 v131, 64, v128
    v_add_u32 v129, 61440, v140
    v_xor_b32 v132, 64, v129
    v_add_u32 v130, 122880, v140
    v_xor_b32 v133, 64, v130
    s_mul_i32 s31, s30, 4096
    s_add_u32 s31, s31, 12288
    v_lshlrev_b32 v140, 4, v139
    v_add_u32 v140, s31, v140
    v_add_u32 v134, 0, v140
    v_add_u32 v135, 61440, v140
    v_add_u32 v136, 122880, v140
    v_and_b32 v144, 7, v137
    v_lshrrev_b32 v145, 3, v137
    v_mul_u32_u24 v142, 37120, v144
    v_lshl_add_u32 v142, v138, 4, v142
    s_mul_i32 s31, s29, 1781760
    v_add_u32 v142, s31, v142
    v_lshl_add_u32 v142, v145, 6, v142
    v_xor_b32 v145, 64, v142
    v_add_u32 v143, 296960, v145
    s_mul_i32 s31, s27, 2
    s_mul_i32 s29, s30, 1
    s_add_u32 s31, s31, s29
    s_mul_i32 s31, s31, 128
    s_mul_i32 s29, s21, 1024
    s_add_u32 s33, s31, s29
    s_mov_b32 s34, 0x80008000
    s_barrier
    ds_read_b128 v[48:51], v134 offset:0
    ds_read_b128 v[64:67], v128 offset:0
    ds_read_b128 v[72:75], v128 offset:2048
    ds_read_b128 v[80:83], v128 offset:4096
    ds_read_b128 v[56:59], v134 offset:2048
    ds_read_b128 v[68:71], v131 offset:0
    ds_read_b128 v[76:79], v131 offset:2048
    ds_read_b128 v[84:87], v131 offset:4096
    ds_read_b128 v[52:55], v134 offset:1024
    ds_read_b128 v[60:63], v134 offset:3072
    s_waitcnt lgkmcnt(0)
    s_barrier
    v_mfma_f32_16x16x32_bf16 v[0:3], v[48:51], v[64:67], 0
    ds_read_b128 v[88:91], v134 offset:20480
    v_mfma_f32_16x16x32_bf16 v[4:7], v[48:51], v[72:75], 0
    ds_read_b128 v[104:107], v128 offset:20480
    v_mfma_f32_16x16x32_bf16 v[8:11], v[48:51], v[80:83], 0
    ds_read_b128 v[112:115], v128 offset:22528
    v_mfma_f32_16x16x32_bf16 v[12:15], v[56:59], v[64:67], 0
    ds_read_b128 v[120:123], v128 offset:24576
    v_mfma_f32_16x16x32_bf16 v[16:19], v[56:59], v[72:75], 0
    ds_read_b128 v[96:99], v134 offset:22528
    v_mfma_f32_16x16x32_bf16 v[20:23], v[56:59], v[80:83], 0
    ds_read_b128 v[108:111], v131 offset:20480
    v_mfma_f32_16x16x32_bf16 v[24:27], v[48:51], v[68:71], 0
    ds_read_b128 v[116:119], v131 offset:22528
    v_mfma_f32_16x16x32_bf16 v[28:31], v[48:51], v[76:79], 0
    ds_read_b128 v[124:127], v131 offset:24576
    v_mfma_f32_16x16x32_bf16 v[32:35], v[48:51], v[84:87], 0
    ds_read_b128 v[92:95], v134 offset:21504
    v_mfma_f32_16x16x32_bf16 v[36:39], v[56:59], v[68:71], 0
    ds_read_b128 v[100:103], v134 offset:23552
    v_mfma_f32_16x16x32_bf16 v[40:43], v[56:59], v[76:79], 0
    v_mfma_f32_16x16x32_bf16 v[44:47], v[56:59], v[84:87], 0
    v_mfma_f32_16x16x32_bf16 v[24:27], v[52:55], v[64:67], v[24:27]
    v_xor_b32 v68, s34, v68
    v_xor_b32 v69, s34, v69
    v_mfma_f32_16x16x32_bf16 v[28:31], v[52:55], v[72:75], v[28:31]
    v_xor_b32 v70, s34, v70
    v_xor_b32 v71, s34, v71
    v_mfma_f32_16x16x32_bf16 v[32:35], v[52:55], v[80:83], v[32:35]
    v_xor_b32 v76, s34, v76
    v_xor_b32 v77, s34, v77
    v_mfma_f32_16x16x32_bf16 v[36:39], v[60:63], v[64:67], v[36:39]
    v_xor_b32 v78, s34, v78
    v_xor_b32 v79, s34, v79
    v_mfma_f32_16x16x32_bf16 v[40:43], v[60:63], v[72:75], v[40:43]
    v_xor_b32 v84, s34, v84
    v_xor_b32 v85, s34, v85
    v_mfma_f32_16x16x32_bf16 v[44:47], v[60:63], v[80:83], v[44:47]
    v_xor_b32 v86, s34, v86
    v_xor_b32 v87, s34, v87
    v_mfma_f32_16x16x32_bf16 v[0:3], v[52:55], v[68:71], v[0:3]
    v_mfma_f32_16x16x32_bf16 v[4:7], v[52:55], v[76:79], v[4:7]
    v_mfma_f32_16x16x32_bf16 v[8:11], v[52:55], v[84:87], v[8:11]
    s_waitcnt lgkmcnt(0)
    s_barrier
    v_mfma_f32_16x16x32_bf16 v[12:15], v[60:63], v[68:71], v[12:15]
    v_mfma_f32_16x16x32_bf16 v[16:19], v[60:63], v[76:79], v[16:19]
    v_mfma_f32_16x16x32_bf16 v[20:23], v[60:63], v[84:87], v[20:23]
    v_mfma_f32_16x16x32_bf16 v[0:3], v[88:91], v[104:107], v[0:3]
    ds_read_b128 v[48:51], v134 offset:40960
    v_mfma_f32_16x16x32_bf16 v[4:7], v[88:91], v[112:115], v[4:7]
    ds_read_b128 v[64:67], v128 offset:40960
    v_mfma_f32_16x16x32_bf16 v[8:11], v[88:91], v[120:123], v[8:11]
    ds_read_b128 v[72:75], v128 offset:43008
    v_mfma_f32_16x16x32_bf16 v[12:15], v[96:99], v[104:107], v[12:15]
    ds_read_b128 v[80:83], v128 offset:45056
    v_mfma_f32_16x16x32_bf16 v[16:19], v[96:99], v[112:115], v[16:19]
    ds_read_b128 v[56:59], v134 offset:43008
    v_mfma_f32_16x16x32_bf16 v[20:23], v[96:99], v[120:123], v[20:23]
    ds_read_b128 v[68:71], v131 offset:40960
    v_mfma_f32_16x16x32_bf16 v[24:27], v[88:91], v[108:111], v[24:27]
    ds_read_b128 v[76:79], v131 offset:43008
    v_mfma_f32_16x16x32_bf16 v[28:31], v[88:91], v[116:119], v[28:31]
    ds_read_b128 v[84:87], v131 offset:45056
    v_mfma_f32_16x16x32_bf16 v[32:35], v[88:91], v[124:127], v[32:35]
    ds_read_b128 v[52:55], v134 offset:41984
    v_mfma_f32_16x16x32_bf16 v[36:39], v[96:99], v[108:111], v[36:39]
    ds_read_b128 v[60:63], v134 offset:44032
    v_mfma_f32_16x16x32_bf16 v[40:43], v[96:99], v[116:119], v[40:43]
    v_mfma_f32_16x16x32_bf16 v[44:47], v[96:99], v[124:127], v[44:47]
    v_mfma_f32_16x16x32_bf16 v[24:27], v[92:95], v[104:107], v[24:27]
    v_xor_b32 v108, s34, v108
    v_xor_b32 v109, s34, v109
    v_mfma_f32_16x16x32_bf16 v[28:31], v[92:95], v[112:115], v[28:31]
    v_xor_b32 v110, s34, v110
    v_xor_b32 v111, s34, v111
    v_mfma_f32_16x16x32_bf16 v[32:35], v[92:95], v[120:123], v[32:35]
    v_xor_b32 v116, s34, v116
    v_xor_b32 v117, s34, v117
    v_mfma_f32_16x16x32_bf16 v[36:39], v[100:103], v[104:107], v[36:39]
    v_xor_b32 v118, s34, v118
    v_xor_b32 v119, s34, v119
    v_mfma_f32_16x16x32_bf16 v[40:43], v[100:103], v[112:115], v[40:43]
    v_xor_b32 v124, s34, v124
    v_xor_b32 v125, s34, v125
    v_mfma_f32_16x16x32_bf16 v[44:47], v[100:103], v[120:123], v[44:47]
    v_xor_b32 v126, s34, v126
    v_xor_b32 v127, s34, v127
    v_mfma_f32_16x16x32_bf16 v[0:3], v[92:95], v[108:111], v[0:3]
    v_mfma_f32_16x16x32_bf16 v[4:7], v[92:95], v[116:119], v[4:7]
    v_mfma_f32_16x16x32_bf16 v[8:11], v[92:95], v[124:127], v[8:11]
    s_waitcnt lgkmcnt(0)
    s_barrier
    v_mfma_f32_16x16x32_bf16 v[12:15], v[100:103], v[108:111], v[12:15]
    v_mfma_f32_16x16x32_bf16 v[16:19], v[100:103], v[116:119], v[16:19]
    v_mfma_f32_16x16x32_bf16 v[20:23], v[100:103], v[124:127], v[20:23]
    v_mfma_f32_16x16x32_bf16 v[0:3], v[48:51], v[64:67], v[0:3]
    ds_read_b128 v[88:91], v135 offset:0
    v_mfma_f32_16x16x32_bf16 v[4:7], v[48:51], v[72:75], v[4:7]
    ds_read_b128 v[104:107], v129 offset:0
    v_mfma_f32_16x16x32_bf16 v[8:11], v[48:51], v[80:83], v[8:11]
    ds_read_b128 v[112:115], v129 offset:2048
    v_mfma_f32_16x16x32_bf16 v[12:15], v[56:59], v[64:67], v[12:15]
    ds_read_b128 v[120:123], v129 offset:4096
    v_mfma_f32_16x16x32_bf16 v[16:19], v[56:59], v[72:75], v[16:19]
    ds_read_b128 v[96:99], v135 offset:2048
    v_mfma_f32_16x16x32_bf16 v[20:23], v[56:59], v[80:83], v[20:23]
    ds_read_b128 v[108:111], v132 offset:0
    v_mfma_f32_16x16x32_bf16 v[24:27], v[48:51], v[68:71], v[24:27]
    ds_read_b128 v[116:119], v132 offset:2048
    v_mfma_f32_16x16x32_bf16 v[28:31], v[48:51], v[76:79], v[28:31]
    ds_read_b128 v[124:127], v132 offset:4096
    v_mfma_f32_16x16x32_bf16 v[32:35], v[48:51], v[84:87], v[32:35]
    ds_read_b128 v[92:95], v135 offset:1024
    v_mfma_f32_16x16x32_bf16 v[36:39], v[56:59], v[68:71], v[36:39]
    ds_read_b128 v[100:103], v135 offset:3072
    v_mfma_f32_16x16x32_bf16 v[40:43], v[56:59], v[76:79], v[40:43]
    v_mfma_f32_16x16x32_bf16 v[44:47], v[56:59], v[84:87], v[44:47]
    v_mfma_f32_16x16x32_bf16 v[24:27], v[52:55], v[64:67], v[24:27]
    v_xor_b32 v68, s34, v68
    v_xor_b32 v69, s34, v69
    v_mfma_f32_16x16x32_bf16 v[28:31], v[52:55], v[72:75], v[28:31]
    v_xor_b32 v70, s34, v70
    v_xor_b32 v71, s34, v71
    v_mfma_f32_16x16x32_bf16 v[32:35], v[52:55], v[80:83], v[32:35]
    v_xor_b32 v76, s34, v76
    v_xor_b32 v77, s34, v77
    v_mfma_f32_16x16x32_bf16 v[36:39], v[60:63], v[64:67], v[36:39]
    v_xor_b32 v78, s34, v78
    v_xor_b32 v79, s34, v79
    v_mfma_f32_16x16x32_bf16 v[40:43], v[60:63], v[72:75], v[40:43]
    v_xor_b32 v84, s34, v84
    v_xor_b32 v85, s34, v85
    v_mfma_f32_16x16x32_bf16 v[44:47], v[60:63], v[80:83], v[44:47]
    v_xor_b32 v86, s34, v86
    v_xor_b32 v87, s34, v87
    v_mfma_f32_16x16x32_bf16 v[0:3], v[52:55], v[68:71], v[0:3]
    v_mfma_f32_16x16x32_bf16 v[4:7], v[52:55], v[76:79], v[4:7]
    v_mfma_f32_16x16x32_bf16 v[8:11], v[52:55], v[84:87], v[8:11]
    s_waitcnt lgkmcnt(0)
    s_barrier
    v_mfma_f32_16x16x32_bf16 v[12:15], v[60:63], v[68:71], v[12:15]
    v_mfma_f32_16x16x32_bf16 v[16:19], v[60:63], v[76:79], v[16:19]
    v_mfma_f32_16x16x32_bf16 v[20:23], v[60:63], v[84:87], v[20:23]
    v_mfma_f32_16x16x32_bf16 v[0:3], v[88:91], v[104:107], v[0:3]
    ds_read_b128 v[48:51], v135 offset:20480
    v_mfma_f32_16x16x32_bf16 v[4:7], v[88:91], v[112:115], v[4:7]
    ds_read_b128 v[64:67], v129 offset:20480
    v_mfma_f32_16x16x32_bf16 v[8:11], v[88:91], v[120:123], v[8:11]
    ds_read_b128 v[72:75], v129 offset:22528
    v_mfma_f32_16x16x32_bf16 v[12:15], v[96:99], v[104:107], v[12:15]
    ds_read_b128 v[80:83], v129 offset:24576
    v_mfma_f32_16x16x32_bf16 v[16:19], v[96:99], v[112:115], v[16:19]
    ds_read_b128 v[56:59], v135 offset:22528
    v_mfma_f32_16x16x32_bf16 v[20:23], v[96:99], v[120:123], v[20:23]
    ds_read_b128 v[68:71], v132 offset:20480
    v_mfma_f32_16x16x32_bf16 v[24:27], v[88:91], v[108:111], v[24:27]
    ds_read_b128 v[76:79], v132 offset:22528
    v_mfma_f32_16x16x32_bf16 v[28:31], v[88:91], v[116:119], v[28:31]
    ds_read_b128 v[84:87], v132 offset:24576
    v_mfma_f32_16x16x32_bf16 v[32:35], v[88:91], v[124:127], v[32:35]
    ds_read_b128 v[52:55], v135 offset:21504
    v_mfma_f32_16x16x32_bf16 v[36:39], v[96:99], v[108:111], v[36:39]
    ds_read_b128 v[60:63], v135 offset:23552
    v_mfma_f32_16x16x32_bf16 v[40:43], v[96:99], v[116:119], v[40:43]
    v_mfma_f32_16x16x32_bf16 v[44:47], v[96:99], v[124:127], v[44:47]
    v_mfma_f32_16x16x32_bf16 v[24:27], v[92:95], v[104:107], v[24:27]
    v_xor_b32 v108, s34, v108
    v_xor_b32 v109, s34, v109
    v_mfma_f32_16x16x32_bf16 v[28:31], v[92:95], v[112:115], v[28:31]
    v_xor_b32 v110, s34, v110
    v_xor_b32 v111, s34, v111
    v_mfma_f32_16x16x32_bf16 v[32:35], v[92:95], v[120:123], v[32:35]
    v_xor_b32 v116, s34, v116
    v_xor_b32 v117, s34, v117
    v_mfma_f32_16x16x32_bf16 v[36:39], v[100:103], v[104:107], v[36:39]
    v_xor_b32 v118, s34, v118
    v_xor_b32 v119, s34, v119
    v_mfma_f32_16x16x32_bf16 v[40:43], v[100:103], v[112:115], v[40:43]
    v_xor_b32 v124, s34, v124
    v_xor_b32 v125, s34, v125
    v_mfma_f32_16x16x32_bf16 v[44:47], v[100:103], v[120:123], v[44:47]
    v_xor_b32 v126, s34, v126
    v_xor_b32 v127, s34, v127
    v_mfma_f32_16x16x32_bf16 v[0:3], v[92:95], v[108:111], v[0:3]
    v_mfma_f32_16x16x32_bf16 v[4:7], v[92:95], v[116:119], v[4:7]
    v_mfma_f32_16x16x32_bf16 v[8:11], v[92:95], v[124:127], v[8:11]
    s_waitcnt lgkmcnt(0)
    s_barrier
    v_mfma_f32_16x16x32_bf16 v[12:15], v[100:103], v[108:111], v[12:15]
    v_mfma_f32_16x16x32_bf16 v[16:19], v[100:103], v[116:119], v[16:19]
    v_mfma_f32_16x16x32_bf16 v[20:23], v[100:103], v[124:127], v[20:23]
    v_mfma_f32_16x16x32_bf16 v[0:3], v[48:51], v[64:67], v[0:3]
    ds_read_b128 v[88:91], v135 offset:40960
    v_mfma_f32_16x16x32_bf16 v[4:7], v[48:51], v[72:75], v[4:7]
    ds_read_b128 v[104:107], v129 offset:40960
    v_mfma_f32_16x16x32_bf16 v[8:11], v[48:51], v[80:83], v[8:11]
    ds_read_b128 v[112:115], v129 offset:43008
    v_mfma_f32_16x16x32_bf16 v[12:15], v[56:59], v[64:67], v[12:15]
    ds_read_b128 v[120:123], v129 offset:45056
    v_mfma_f32_16x16x32_bf16 v[16:19], v[56:59], v[72:75], v[16:19]
    ds_read_b128 v[96:99], v135 offset:43008
    v_mfma_f32_16x16x32_bf16 v[20:23], v[56:59], v[80:83], v[20:23]
    ds_read_b128 v[108:111], v132 offset:40960
    v_mfma_f32_16x16x32_bf16 v[24:27], v[48:51], v[68:71], v[24:27]
    ds_read_b128 v[116:119], v132 offset:43008
    v_mfma_f32_16x16x32_bf16 v[28:31], v[48:51], v[76:79], v[28:31]
    ds_read_b128 v[124:127], v132 offset:45056
    v_mfma_f32_16x16x32_bf16 v[32:35], v[48:51], v[84:87], v[32:35]
    ds_read_b128 v[92:95], v135 offset:41984
    v_mfma_f32_16x16x32_bf16 v[36:39], v[56:59], v[68:71], v[36:39]
    ds_read_b128 v[100:103], v135 offset:44032
    v_mfma_f32_16x16x32_bf16 v[40:43], v[56:59], v[76:79], v[40:43]
    v_mfma_f32_16x16x32_bf16 v[44:47], v[56:59], v[84:87], v[44:47]
    v_mfma_f32_16x16x32_bf16 v[24:27], v[52:55], v[64:67], v[24:27]
    v_xor_b32 v68, s34, v68
    v_xor_b32 v69, s34, v69
    v_mfma_f32_16x16x32_bf16 v[28:31], v[52:55], v[72:75], v[28:31]
    v_xor_b32 v70, s34, v70
    v_xor_b32 v71, s34, v71
    v_mfma_f32_16x16x32_bf16 v[32:35], v[52:55], v[80:83], v[32:35]
    v_xor_b32 v76, s34, v76
    v_xor_b32 v77, s34, v77
    v_mfma_f32_16x16x32_bf16 v[36:39], v[60:63], v[64:67], v[36:39]
    v_xor_b32 v78, s34, v78
    v_xor_b32 v79, s34, v79
    v_mfma_f32_16x16x32_bf16 v[40:43], v[60:63], v[72:75], v[40:43]
    v_xor_b32 v84, s34, v84
    v_xor_b32 v85, s34, v85
    v_mfma_f32_16x16x32_bf16 v[44:47], v[60:63], v[80:83], v[44:47]
    v_xor_b32 v86, s34, v86
    v_xor_b32 v87, s34, v87
    v_mfma_f32_16x16x32_bf16 v[0:3], v[52:55], v[68:71], v[0:3]
    v_mfma_f32_16x16x32_bf16 v[4:7], v[52:55], v[76:79], v[4:7]
    v_mfma_f32_16x16x32_bf16 v[8:11], v[52:55], v[84:87], v[8:11]
    s_waitcnt lgkmcnt(0)
    s_barrier
    v_mfma_f32_16x16x32_bf16 v[12:15], v[60:63], v[68:71], v[12:15]
    v_mfma_f32_16x16x32_bf16 v[16:19], v[60:63], v[76:79], v[16:19]
    v_mfma_f32_16x16x32_bf16 v[20:23], v[60:63], v[84:87], v[20:23]
    v_mfma_f32_16x16x32_bf16 v[0:3], v[88:91], v[104:107], v[0:3]
    ds_read_b128 v[48:51], v136 offset:0
    v_mfma_f32_16x16x32_bf16 v[4:7], v[88:91], v[112:115], v[4:7]
    ds_read_b128 v[64:67], v130 offset:0
    v_mfma_f32_16x16x32_bf16 v[8:11], v[88:91], v[120:123], v[8:11]
    ds_read_b128 v[72:75], v130 offset:2048
    v_mfma_f32_16x16x32_bf16 v[12:15], v[96:99], v[104:107], v[12:15]
    ds_read_b128 v[80:83], v130 offset:4096
    v_mfma_f32_16x16x32_bf16 v[16:19], v[96:99], v[112:115], v[16:19]
    ds_read_b128 v[56:59], v136 offset:2048
    v_mfma_f32_16x16x32_bf16 v[20:23], v[96:99], v[120:123], v[20:23]
    ds_read_b128 v[68:71], v133 offset:0
    v_mfma_f32_16x16x32_bf16 v[24:27], v[88:91], v[108:111], v[24:27]
    ds_read_b128 v[76:79], v133 offset:2048
    v_mfma_f32_16x16x32_bf16 v[28:31], v[88:91], v[116:119], v[28:31]
    ds_read_b128 v[84:87], v133 offset:4096
    v_mfma_f32_16x16x32_bf16 v[32:35], v[88:91], v[124:127], v[32:35]
    ds_read_b128 v[52:55], v136 offset:1024
    v_mfma_f32_16x16x32_bf16 v[36:39], v[96:99], v[108:111], v[36:39]
    ds_read_b128 v[60:63], v136 offset:3072
    v_mfma_f32_16x16x32_bf16 v[40:43], v[96:99], v[116:119], v[40:43]
    v_mfma_f32_16x16x32_bf16 v[44:47], v[96:99], v[124:127], v[44:47]
    v_mfma_f32_16x16x32_bf16 v[24:27], v[92:95], v[104:107], v[24:27]
    v_xor_b32 v108, s34, v108
    v_xor_b32 v109, s34, v109
    v_mfma_f32_16x16x32_bf16 v[28:31], v[92:95], v[112:115], v[28:31]
    v_xor_b32 v110, s34, v110
    v_xor_b32 v111, s34, v111
    v_mfma_f32_16x16x32_bf16 v[32:35], v[92:95], v[120:123], v[32:35]
    v_xor_b32 v116, s34, v116
    v_xor_b32 v117, s34, v117
    v_mfma_f32_16x16x32_bf16 v[36:39], v[100:103], v[104:107], v[36:39]
    v_xor_b32 v118, s34, v118
    v_xor_b32 v119, s34, v119
    v_mfma_f32_16x16x32_bf16 v[40:43], v[100:103], v[112:115], v[40:43]
    v_xor_b32 v124, s34, v124
    v_xor_b32 v125, s34, v125
    v_mfma_f32_16x16x32_bf16 v[44:47], v[100:103], v[120:123], v[44:47]
    v_xor_b32 v126, s34, v126
    v_xor_b32 v127, s34, v127
    v_mfma_f32_16x16x32_bf16 v[0:3], v[92:95], v[108:111], v[0:3]
    v_mfma_f32_16x16x32_bf16 v[4:7], v[92:95], v[116:119], v[4:7]
    v_mfma_f32_16x16x32_bf16 v[8:11], v[92:95], v[124:127], v[8:11]
    s_waitcnt lgkmcnt(0)
    s_barrier
    v_mfma_f32_16x16x32_bf16 v[12:15], v[100:103], v[108:111], v[12:15]
    v_mfma_f32_16x16x32_bf16 v[16:19], v[100:103], v[116:119], v[16:19]
    v_mfma_f32_16x16x32_bf16 v[20:23], v[100:103], v[124:127], v[20:23]
    v_mfma_f32_16x16x32_bf16 v[0:3], v[48:51], v[64:67], v[0:3]
    ds_read_b128 v[88:91], v134 offset:0
    v_mfma_f32_16x16x32_bf16 v[4:7], v[48:51], v[72:75], v[4:7]
    ds_read_b128 v[104:107], v128 offset:0
    v_mfma_f32_16x16x32_bf16 v[8:11], v[48:51], v[80:83], v[8:11]
    ds_read_b128 v[112:115], v128 offset:2048
    v_mfma_f32_16x16x32_bf16 v[12:15], v[56:59], v[64:67], v[12:15]
    ds_read_b128 v[120:123], v128 offset:4096
    v_mfma_f32_16x16x32_bf16 v[16:19], v[56:59], v[72:75], v[16:19]
    ds_read_b128 v[96:99], v134 offset:2048
    v_mfma_f32_16x16x32_bf16 v[20:23], v[56:59], v[80:83], v[20:23]
    ds_read_b128 v[108:111], v131 offset:0
    v_mfma_f32_16x16x32_bf16 v[24:27], v[48:51], v[68:71], v[24:27]
    ds_read_b128 v[116:119], v131 offset:2048
    v_mfma_f32_16x16x32_bf16 v[28:31], v[48:51], v[76:79], v[28:31]
    ds_read_b128 v[124:127], v131 offset:4096
    v_mfma_f32_16x16x32_bf16 v[32:35], v[48:51], v[84:87], v[32:35]
    ds_read_b128 v[92:95], v134 offset:1024
    v_mfma_f32_16x16x32_bf16 v[36:39], v[56:59], v[68:71], v[36:39]
    ds_read_b128 v[100:103], v134 offset:3072
    v_mfma_f32_16x16x32_bf16 v[40:43], v[56:59], v[76:79], v[40:43]
    v_mfma_f32_16x16x32_bf16 v[44:47], v[56:59], v[84:87], v[44:47]
    v_mfma_f32_16x16x32_bf16 v[24:27], v[52:55], v[64:67], v[24:27]
    v_xor_b32 v68, s34, v68
    v_xor_b32 v69, s34, v69
    v_mfma_f32_16x16x32_bf16 v[28:31], v[52:55], v[72:75], v[28:31]
    v_xor_b32 v70, s34, v70
    v_xor_b32 v71, s34, v71
    v_mfma_f32_16x16x32_bf16 v[32:35], v[52:55], v[80:83], v[32:35]
    v_xor_b32 v76, s34, v76
    v_xor_b32 v77, s34, v77
    v_mfma_f32_16x16x32_bf16 v[36:39], v[60:63], v[64:67], v[36:39]
    v_xor_b32 v78, s34, v78
    v_xor_b32 v79, s34, v79
    v_mfma_f32_16x16x32_bf16 v[40:43], v[60:63], v[72:75], v[40:43]
    v_xor_b32 v84, s34, v84
    v_xor_b32 v85, s34, v85
    v_mfma_f32_16x16x32_bf16 v[44:47], v[60:63], v[80:83], v[44:47]
    v_xor_b32 v86, s34, v86
    v_xor_b32 v87, s34, v87
    v_mfma_f32_16x16x32_bf16 v[0:3], v[52:55], v[68:71], v[0:3]
    v_mfma_f32_16x16x32_bf16 v[4:7], v[52:55], v[76:79], v[4:7]
    v_mfma_f32_16x16x32_bf16 v[8:11], v[52:55], v[84:87], v[8:11]
    s_waitcnt lgkmcnt(0)
    s_barrier
    v_mfma_f32_16x16x32_bf16 v[12:15], v[60:63], v[68:71], v[12:15]
    v_mfma_f32_16x16x32_bf16 v[16:19], v[60:63], v[76:79], v[16:19]
    v_mfma_f32_16x16x32_bf16 v[20:23], v[60:63], v[84:87], v[20:23]
    v_mfma_f32_16x16x32_bf16 v[0:3], v[88:91], v[104:107], v[0:3]
    ds_read_b128 v[48:51], v134 offset:20480
    v_mfma_f32_16x16x32_bf16 v[4:7], v[88:91], v[112:115], v[4:7]
    ds_read_b128 v[64:67], v128 offset:20480
    v_mfma_f32_16x16x32_bf16 v[8:11], v[88:91], v[120:123], v[8:11]
    ds_read_b128 v[72:75], v128 offset:22528
    v_mfma_f32_16x16x32_bf16 v[12:15], v[96:99], v[104:107], v[12:15]
    ds_read_b128 v[80:83], v128 offset:24576
    v_mfma_f32_16x16x32_bf16 v[16:19], v[96:99], v[112:115], v[16:19]
    ds_read_b128 v[56:59], v134 offset:22528
    v_mfma_f32_16x16x32_bf16 v[20:23], v[96:99], v[120:123], v[20:23]
    ds_read_b128 v[68:71], v131 offset:20480
    v_mfma_f32_16x16x32_bf16 v[24:27], v[88:91], v[108:111], v[24:27]
    ds_read_b128 v[76:79], v131 offset:22528
    v_mfma_f32_16x16x32_bf16 v[28:31], v[88:91], v[116:119], v[28:31]
    ds_read_b128 v[84:87], v131 offset:24576
    v_mfma_f32_16x16x32_bf16 v[32:35], v[88:91], v[124:127], v[32:35]
    ds_read_b128 v[52:55], v134 offset:21504
    v_mfma_f32_16x16x32_bf16 v[36:39], v[96:99], v[108:111], v[36:39]
    ds_read_b128 v[60:63], v134 offset:23552
    v_mfma_f32_16x16x32_bf16 v[40:43], v[96:99], v[116:119], v[40:43]
    v_mfma_f32_16x16x32_bf16 v[44:47], v[96:99], v[124:127], v[44:47]
    v_mfma_f32_16x16x32_bf16 v[24:27], v[92:95], v[104:107], v[24:27]
    v_xor_b32 v108, s34, v108
    v_xor_b32 v109, s34, v109
    v_mfma_f32_16x16x32_bf16 v[28:31], v[92:95], v[112:115], v[28:31]
    v_xor_b32 v110, s34, v110
    v_xor_b32 v111, s34, v111
    v_mfma_f32_16x16x32_bf16 v[32:35], v[92:95], v[120:123], v[32:35]
    v_xor_b32 v116, s34, v116
    v_xor_b32 v117, s34, v117
    v_mfma_f32_16x16x32_bf16 v[36:39], v[100:103], v[104:107], v[36:39]
    v_xor_b32 v118, s34, v118
    v_xor_b32 v119, s34, v119
    v_mfma_f32_16x16x32_bf16 v[40:43], v[100:103], v[112:115], v[40:43]
    v_xor_b32 v124, s34, v124
    v_xor_b32 v125, s34, v125
    v_mfma_f32_16x16x32_bf16 v[44:47], v[100:103], v[120:123], v[44:47]
    v_xor_b32 v126, s34, v126
    v_xor_b32 v127, s34, v127
    v_mfma_f32_16x16x32_bf16 v[0:3], v[92:95], v[108:111], v[0:3]
    v_mfma_f32_16x16x32_bf16 v[4:7], v[92:95], v[116:119], v[4:7]
    v_mfma_f32_16x16x32_bf16 v[8:11], v[92:95], v[124:127], v[8:11]
    s_waitcnt lgkmcnt(0)
    s_barrier
    v_mfma_f32_16x16x32_bf16 v[12:15], v[100:103], v[108:111], v[12:15]
    v_mfma_f32_16x16x32_bf16 v[16:19], v[100:103], v[116:119], v[16:19]
    v_mfma_f32_16x16x32_bf16 v[20:23], v[100:103], v[124:127], v[20:23]
    v_mfma_f32_16x16x32_bf16 v[0:3], v[48:51], v[64:67], v[0:3]
    ds_read_b128 v[88:91], v134 offset:40960
    v_mfma_f32_16x16x32_bf16 v[4:7], v[48:51], v[72:75], v[4:7]
    ds_read_b128 v[104:107], v128 offset:40960
    v_mfma_f32_16x16x32_bf16 v[8:11], v[48:51], v[80:83], v[8:11]
    ds_read_b128 v[112:115], v128 offset:43008
    v_mfma_f32_16x16x32_bf16 v[12:15], v[56:59], v[64:67], v[12:15]
    ds_read_b128 v[120:123], v128 offset:45056
    v_mfma_f32_16x16x32_bf16 v[16:19], v[56:59], v[72:75], v[16:19]
    ds_read_b128 v[96:99], v134 offset:43008
    v_mfma_f32_16x16x32_bf16 v[20:23], v[56:59], v[80:83], v[20:23]
    ds_read_b128 v[108:111], v131 offset:40960
    v_mfma_f32_16x16x32_bf16 v[24:27], v[48:51], v[68:71], v[24:27]
    ds_read_b128 v[116:119], v131 offset:43008
    v_mfma_f32_16x16x32_bf16 v[28:31], v[48:51], v[76:79], v[28:31]
    ds_read_b128 v[124:127], v131 offset:45056
    v_mfma_f32_16x16x32_bf16 v[32:35], v[48:51], v[84:87], v[32:35]
    ds_read_b128 v[92:95], v134 offset:41984
    v_mfma_f32_16x16x32_bf16 v[36:39], v[56:59], v[68:71], v[36:39]
    ds_read_b128 v[100:103], v134 offset:44032
    v_mfma_f32_16x16x32_bf16 v[40:43], v[56:59], v[76:79], v[40:43]
    v_mfma_f32_16x16x32_bf16 v[44:47], v[56:59], v[84:87], v[44:47]
    v_mfma_f32_16x16x32_bf16 v[24:27], v[52:55], v[64:67], v[24:27]
    v_xor_b32 v68, s34, v68
    v_xor_b32 v69, s34, v69
    v_mfma_f32_16x16x32_bf16 v[28:31], v[52:55], v[72:75], v[28:31]
    v_xor_b32 v70, s34, v70
    v_xor_b32 v71, s34, v71
    v_mfma_f32_16x16x32_bf16 v[32:35], v[52:55], v[80:83], v[32:35]
    v_xor_b32 v76, s34, v76
    v_xor_b32 v77, s34, v77
    v_mfma_f32_16x16x32_bf16 v[36:39], v[60:63], v[64:67], v[36:39]
    v_xor_b32 v78, s34, v78
    v_xor_b32 v79, s34, v79
    v_mfma_f32_16x16x32_bf16 v[40:43], v[60:63], v[72:75], v[40:43]
    v_xor_b32 v84, s34, v84
    v_xor_b32 v85, s34, v85
    v_mfma_f32_16x16x32_bf16 v[44:47], v[60:63], v[80:83], v[44:47]
    v_xor_b32 v86, s34, v86
    v_xor_b32 v87, s34, v87
    v_mfma_f32_16x16x32_bf16 v[0:3], v[52:55], v[68:71], v[0:3]
    v_mfma_f32_16x16x32_bf16 v[4:7], v[52:55], v[76:79], v[4:7]
    v_mfma_f32_16x16x32_bf16 v[8:11], v[52:55], v[84:87], v[8:11]
    s_waitcnt lgkmcnt(0)
    s_barrier
    v_mfma_f32_16x16x32_bf16 v[12:15], v[60:63], v[68:71], v[12:15]
    v_mfma_f32_16x16x32_bf16 v[16:19], v[60:63], v[76:79], v[16:19]
    v_mfma_f32_16x16x32_bf16 v[20:23], v[60:63], v[84:87], v[20:23]
    v_mfma_f32_16x16x32_bf16 v[0:3], v[88:91], v[104:107], v[0:3]
    ds_read_b128 v[48:51], v135 offset:0
    v_mfma_f32_16x16x32_bf16 v[4:7], v[88:91], v[112:115], v[4:7]
    ds_read_b128 v[64:67], v129 offset:0
    v_mfma_f32_16x16x32_bf16 v[8:11], v[88:91], v[120:123], v[8:11]
    ds_read_b128 v[72:75], v129 offset:2048
    v_mfma_f32_16x16x32_bf16 v[12:15], v[96:99], v[104:107], v[12:15]
    ds_read_b128 v[80:83], v129 offset:4096
    v_mfma_f32_16x16x32_bf16 v[16:19], v[96:99], v[112:115], v[16:19]
    ds_read_b128 v[56:59], v135 offset:2048
    v_mfma_f32_16x16x32_bf16 v[20:23], v[96:99], v[120:123], v[20:23]
    ds_read_b128 v[68:71], v132 offset:0
    v_mfma_f32_16x16x32_bf16 v[24:27], v[88:91], v[108:111], v[24:27]
    ds_read_b128 v[76:79], v132 offset:2048
    v_mfma_f32_16x16x32_bf16 v[28:31], v[88:91], v[116:119], v[28:31]
    ds_read_b128 v[84:87], v132 offset:4096
    v_mfma_f32_16x16x32_bf16 v[32:35], v[88:91], v[124:127], v[32:35]
    ds_read_b128 v[52:55], v135 offset:1024
    v_mfma_f32_16x16x32_bf16 v[36:39], v[96:99], v[108:111], v[36:39]
    ds_read_b128 v[60:63], v135 offset:3072
    v_mfma_f32_16x16x32_bf16 v[40:43], v[96:99], v[116:119], v[40:43]
    v_mfma_f32_16x16x32_bf16 v[44:47], v[96:99], v[124:127], v[44:47]
    v_mfma_f32_16x16x32_bf16 v[24:27], v[92:95], v[104:107], v[24:27]
    v_xor_b32 v108, s34, v108
    v_xor_b32 v109, s34, v109
    v_mfma_f32_16x16x32_bf16 v[28:31], v[92:95], v[112:115], v[28:31]
    v_xor_b32 v110, s34, v110
    v_xor_b32 v111, s34, v111
    v_mfma_f32_16x16x32_bf16 v[32:35], v[92:95], v[120:123], v[32:35]
    v_xor_b32 v116, s34, v116
    v_xor_b32 v117, s34, v117
    v_mfma_f32_16x16x32_bf16 v[36:39], v[100:103], v[104:107], v[36:39]
    v_xor_b32 v118, s34, v118
    v_xor_b32 v119, s34, v119
    v_mfma_f32_16x16x32_bf16 v[40:43], v[100:103], v[112:115], v[40:43]
    v_xor_b32 v124, s34, v124
    v_xor_b32 v125, s34, v125
    v_mfma_f32_16x16x32_bf16 v[44:47], v[100:103], v[120:123], v[44:47]
    v_xor_b32 v126, s34, v126
    v_xor_b32 v127, s34, v127
    v_mfma_f32_16x16x32_bf16 v[0:3], v[92:95], v[108:111], v[0:3]
    v_mfma_f32_16x16x32_bf16 v[4:7], v[92:95], v[116:119], v[4:7]
    v_mfma_f32_16x16x32_bf16 v[8:11], v[92:95], v[124:127], v[8:11]
    s_waitcnt lgkmcnt(0)
    s_barrier
    v_mfma_f32_16x16x32_bf16 v[12:15], v[100:103], v[108:111], v[12:15]
    v_mfma_f32_16x16x32_bf16 v[16:19], v[100:103], v[116:119], v[16:19]
    v_mfma_f32_16x16x32_bf16 v[20:23], v[100:103], v[124:127], v[20:23]
    v_mfma_f32_16x16x32_bf16 v[0:3], v[48:51], v[64:67], v[0:3]
    ds_read_b128 v[88:91], v135 offset:20480
    v_mfma_f32_16x16x32_bf16 v[4:7], v[48:51], v[72:75], v[4:7]
    ds_read_b128 v[104:107], v129 offset:20480
    v_mfma_f32_16x16x32_bf16 v[8:11], v[48:51], v[80:83], v[8:11]
    ds_read_b128 v[112:115], v129 offset:22528
    v_mfma_f32_16x16x32_bf16 v[12:15], v[56:59], v[64:67], v[12:15]
    ds_read_b128 v[120:123], v129 offset:24576
    v_mfma_f32_16x16x32_bf16 v[16:19], v[56:59], v[72:75], v[16:19]
    ds_read_b128 v[96:99], v135 offset:22528
    v_mfma_f32_16x16x32_bf16 v[20:23], v[56:59], v[80:83], v[20:23]
    ds_read_b128 v[108:111], v132 offset:20480
    v_mfma_f32_16x16x32_bf16 v[24:27], v[48:51], v[68:71], v[24:27]
    ds_read_b128 v[116:119], v132 offset:22528
    v_mfma_f32_16x16x32_bf16 v[28:31], v[48:51], v[76:79], v[28:31]
    ds_read_b128 v[124:127], v132 offset:24576
    v_mfma_f32_16x16x32_bf16 v[32:35], v[48:51], v[84:87], v[32:35]
    ds_read_b128 v[92:95], v135 offset:21504
    v_mfma_f32_16x16x32_bf16 v[36:39], v[56:59], v[68:71], v[36:39]
    ds_read_b128 v[100:103], v135 offset:23552
    v_mfma_f32_16x16x32_bf16 v[40:43], v[56:59], v[76:79], v[40:43]
    v_mfma_f32_16x16x32_bf16 v[44:47], v[56:59], v[84:87], v[44:47]
    v_mfma_f32_16x16x32_bf16 v[24:27], v[52:55], v[64:67], v[24:27]
    v_xor_b32 v68, s34, v68
    v_xor_b32 v69, s34, v69
    v_mfma_f32_16x16x32_bf16 v[28:31], v[52:55], v[72:75], v[28:31]
    v_xor_b32 v70, s34, v70
    v_xor_b32 v71, s34, v71
    v_mfma_f32_16x16x32_bf16 v[32:35], v[52:55], v[80:83], v[32:35]
    v_xor_b32 v76, s34, v76
    v_xor_b32 v77, s34, v77
    v_mfma_f32_16x16x32_bf16 v[36:39], v[60:63], v[64:67], v[36:39]
    v_xor_b32 v78, s34, v78
    v_xor_b32 v79, s34, v79
    v_mfma_f32_16x16x32_bf16 v[40:43], v[60:63], v[72:75], v[40:43]
    v_xor_b32 v84, s34, v84
    v_xor_b32 v85, s34, v85
    v_mfma_f32_16x16x32_bf16 v[44:47], v[60:63], v[80:83], v[44:47]
    v_xor_b32 v86, s34, v86
    v_xor_b32 v87, s34, v87
    v_mfma_f32_16x16x32_bf16 v[0:3], v[52:55], v[68:71], v[0:3]
    v_mfma_f32_16x16x32_bf16 v[4:7], v[52:55], v[76:79], v[4:7]
    v_mfma_f32_16x16x32_bf16 v[8:11], v[52:55], v[84:87], v[8:11]
    s_waitcnt lgkmcnt(0)
    s_barrier
    v_mfma_f32_16x16x32_bf16 v[12:15], v[60:63], v[68:71], v[12:15]
    v_mfma_f32_16x16x32_bf16 v[16:19], v[60:63], v[76:79], v[16:19]
    v_mfma_f32_16x16x32_bf16 v[20:23], v[60:63], v[84:87], v[20:23]
    v_mfma_f32_16x16x32_bf16 v[0:3], v[88:91], v[104:107], v[0:3]
    ds_read_b128 v[48:51], v135 offset:40960
    v_mfma_f32_16x16x32_bf16 v[4:7], v[88:91], v[112:115], v[4:7]
    ds_read_b128 v[64:67], v129 offset:40960
    v_mfma_f32_16x16x32_bf16 v[8:11], v[88:91], v[120:123], v[8:11]
    ds_read_b128 v[72:75], v129 offset:43008
    v_mfma_f32_16x16x32_bf16 v[12:15], v[96:99], v[104:107], v[12:15]
    ds_read_b128 v[80:83], v129 offset:45056
    v_mfma_f32_16x16x32_bf16 v[16:19], v[96:99], v[112:115], v[16:19]
    ds_read_b128 v[56:59], v135 offset:43008
    v_mfma_f32_16x16x32_bf16 v[20:23], v[96:99], v[120:123], v[20:23]
    ds_read_b128 v[68:71], v132 offset:40960
    v_mfma_f32_16x16x32_bf16 v[24:27], v[88:91], v[108:111], v[24:27]
    ds_read_b128 v[76:79], v132 offset:43008
    v_mfma_f32_16x16x32_bf16 v[28:31], v[88:91], v[116:119], v[28:31]
    ds_read_b128 v[84:87], v132 offset:45056
    v_mfma_f32_16x16x32_bf16 v[32:35], v[88:91], v[124:127], v[32:35]
    ds_read_b128 v[52:55], v135 offset:41984
    v_mfma_f32_16x16x32_bf16 v[36:39], v[96:99], v[108:111], v[36:39]
    ds_read_b128 v[60:63], v135 offset:44032
    v_mfma_f32_16x16x32_bf16 v[40:43], v[96:99], v[116:119], v[40:43]
    v_mfma_f32_16x16x32_bf16 v[44:47], v[96:99], v[124:127], v[44:47]
    v_mfma_f32_16x16x32_bf16 v[24:27], v[92:95], v[104:107], v[24:27]
    v_xor_b32 v108, s34, v108
    v_xor_b32 v109, s34, v109
    v_mfma_f32_16x16x32_bf16 v[28:31], v[92:95], v[112:115], v[28:31]
    v_xor_b32 v110, s34, v110
    v_xor_b32 v111, s34, v111
    v_mfma_f32_16x16x32_bf16 v[32:35], v[92:95], v[120:123], v[32:35]
    v_xor_b32 v116, s34, v116
    v_xor_b32 v117, s34, v117
    v_mfma_f32_16x16x32_bf16 v[36:39], v[100:103], v[104:107], v[36:39]
    v_xor_b32 v118, s34, v118
    v_xor_b32 v119, s34, v119
    v_mfma_f32_16x16x32_bf16 v[40:43], v[100:103], v[112:115], v[40:43]
    v_xor_b32 v124, s34, v124
    v_xor_b32 v125, s34, v125
    v_mfma_f32_16x16x32_bf16 v[44:47], v[100:103], v[120:123], v[44:47]
    v_xor_b32 v126, s34, v126
    v_xor_b32 v127, s34, v127
    v_mfma_f32_16x16x32_bf16 v[0:3], v[92:95], v[108:111], v[0:3]
    v_mfma_f32_16x16x32_bf16 v[4:7], v[92:95], v[116:119], v[4:7]
    v_mfma_f32_16x16x32_bf16 v[8:11], v[92:95], v[124:127], v[8:11]
    s_waitcnt lgkmcnt(0)
    s_barrier
    v_mfma_f32_16x16x32_bf16 v[12:15], v[100:103], v[108:111], v[12:15]
    v_mfma_f32_16x16x32_bf16 v[16:19], v[100:103], v[116:119], v[16:19]
    v_mfma_f32_16x16x32_bf16 v[20:23], v[100:103], v[124:127], v[20:23]
    v_mfma_f32_16x16x32_bf16 v[0:3], v[48:51], v[64:67], v[0:3]
    ds_read_b128 v[88:91], v136 offset:0
    v_mfma_f32_16x16x32_bf16 v[4:7], v[48:51], v[72:75], v[4:7]
    ds_read_b128 v[104:107], v130 offset:0
    v_mfma_f32_16x16x32_bf16 v[8:11], v[48:51], v[80:83], v[8:11]
    ds_read_b128 v[112:115], v130 offset:2048
    v_mfma_f32_16x16x32_bf16 v[12:15], v[56:59], v[64:67], v[12:15]
    ds_read_b128 v[120:123], v130 offset:4096
    v_mfma_f32_16x16x32_bf16 v[16:19], v[56:59], v[72:75], v[16:19]
    ds_read_b128 v[96:99], v136 offset:2048
    v_mfma_f32_16x16x32_bf16 v[20:23], v[56:59], v[80:83], v[20:23]
    ds_read_b128 v[108:111], v133 offset:0
    v_mfma_f32_16x16x32_bf16 v[24:27], v[48:51], v[68:71], v[24:27]
    ds_read_b128 v[116:119], v133 offset:2048
    v_mfma_f32_16x16x32_bf16 v[28:31], v[48:51], v[76:79], v[28:31]
    ds_read_b128 v[124:127], v133 offset:4096
    v_mfma_f32_16x16x32_bf16 v[32:35], v[48:51], v[84:87], v[32:35]
    ds_read_b128 v[92:95], v136 offset:1024
    v_mfma_f32_16x16x32_bf16 v[36:39], v[56:59], v[68:71], v[36:39]
    ds_read_b128 v[100:103], v136 offset:3072
    v_mfma_f32_16x16x32_bf16 v[40:43], v[56:59], v[76:79], v[40:43]
    v_mfma_f32_16x16x32_bf16 v[44:47], v[56:59], v[84:87], v[44:47]
    v_mfma_f32_16x16x32_bf16 v[24:27], v[52:55], v[64:67], v[24:27]
    v_xor_b32 v68, s34, v68
    v_xor_b32 v69, s34, v69
    v_mfma_f32_16x16x32_bf16 v[28:31], v[52:55], v[72:75], v[28:31]
    v_xor_b32 v70, s34, v70
    v_xor_b32 v71, s34, v71
    v_mfma_f32_16x16x32_bf16 v[32:35], v[52:55], v[80:83], v[32:35]
    v_xor_b32 v76, s34, v76
    v_xor_b32 v77, s34, v77
    v_mfma_f32_16x16x32_bf16 v[36:39], v[60:63], v[64:67], v[36:39]
    v_xor_b32 v78, s34, v78
    v_xor_b32 v79, s34, v79
    v_mfma_f32_16x16x32_bf16 v[40:43], v[60:63], v[72:75], v[40:43]
    v_xor_b32 v84, s34, v84
    v_xor_b32 v85, s34, v85
    v_mfma_f32_16x16x32_bf16 v[44:47], v[60:63], v[80:83], v[44:47]
    v_xor_b32 v86, s34, v86
    v_xor_b32 v87, s34, v87
    v_mfma_f32_16x16x32_bf16 v[0:3], v[52:55], v[68:71], v[0:3]
    v_mfma_f32_16x16x32_bf16 v[4:7], v[52:55], v[76:79], v[4:7]
    v_mfma_f32_16x16x32_bf16 v[8:11], v[52:55], v[84:87], v[8:11]
    s_waitcnt lgkmcnt(0)
    s_barrier
    v_mfma_f32_16x16x32_bf16 v[12:15], v[60:63], v[68:71], v[12:15]
    v_mfma_f32_16x16x32_bf16 v[16:19], v[60:63], v[76:79], v[16:19]
    v_mfma_f32_16x16x32_bf16 v[20:23], v[60:63], v[84:87], v[20:23]
    v_mfma_f32_16x16x32_bf16 v[0:3], v[88:91], v[104:107], v[0:3]
    ds_read_b128 v[48:51], v134 offset:0
    v_mfma_f32_16x16x32_bf16 v[4:7], v[88:91], v[112:115], v[4:7]
    ds_read_b128 v[64:67], v128 offset:0
    v_mfma_f32_16x16x32_bf16 v[8:11], v[88:91], v[120:123], v[8:11]
    ds_read_b128 v[72:75], v128 offset:2048
    v_mfma_f32_16x16x32_bf16 v[12:15], v[96:99], v[104:107], v[12:15]
    ds_read_b128 v[80:83], v128 offset:4096
    v_mfma_f32_16x16x32_bf16 v[16:19], v[96:99], v[112:115], v[16:19]
    ds_read_b128 v[56:59], v134 offset:2048
    v_mfma_f32_16x16x32_bf16 v[20:23], v[96:99], v[120:123], v[20:23]
    ds_read_b128 v[68:71], v131 offset:0
    v_mfma_f32_16x16x32_bf16 v[24:27], v[88:91], v[108:111], v[24:27]
    ds_read_b128 v[76:79], v131 offset:2048
    v_mfma_f32_16x16x32_bf16 v[28:31], v[88:91], v[116:119], v[28:31]
    ds_read_b128 v[84:87], v131 offset:4096
    v_mfma_f32_16x16x32_bf16 v[32:35], v[88:91], v[124:127], v[32:35]
    ds_read_b128 v[52:55], v134 offset:1024
    v_mfma_f32_16x16x32_bf16 v[36:39], v[96:99], v[108:111], v[36:39]
    ds_read_b128 v[60:63], v134 offset:3072
    v_mfma_f32_16x16x32_bf16 v[40:43], v[96:99], v[116:119], v[40:43]
    v_mfma_f32_16x16x32_bf16 v[44:47], v[96:99], v[124:127], v[44:47]
    v_mfma_f32_16x16x32_bf16 v[24:27], v[92:95], v[104:107], v[24:27]
    v_xor_b32 v108, s34, v108
    v_xor_b32 v109, s34, v109
    v_mfma_f32_16x16x32_bf16 v[28:31], v[92:95], v[112:115], v[28:31]
    v_xor_b32 v110, s34, v110
    v_xor_b32 v111, s34, v111
    v_mfma_f32_16x16x32_bf16 v[32:35], v[92:95], v[120:123], v[32:35]
    v_xor_b32 v116, s34, v116
    v_xor_b32 v117, s34, v117
    v_mfma_f32_16x16x32_bf16 v[36:39], v[100:103], v[104:107], v[36:39]
    v_xor_b32 v118, s34, v118
    v_xor_b32 v119, s34, v119
    v_mfma_f32_16x16x32_bf16 v[40:43], v[100:103], v[112:115], v[40:43]
    v_xor_b32 v124, s34, v124
    v_xor_b32 v125, s34, v125
    v_mfma_f32_16x16x32_bf16 v[44:47], v[100:103], v[120:123], v[44:47]
    v_xor_b32 v126, s34, v126
    v_xor_b32 v127, s34, v127
    v_mfma_f32_16x16x32_bf16 v[0:3], v[92:95], v[108:111], v[0:3]
    v_mfma_f32_16x16x32_bf16 v[4:7], v[92:95], v[116:119], v[4:7]
    v_mfma_f32_16x16x32_bf16 v[8:11], v[92:95], v[124:127], v[8:11]
    s_waitcnt lgkmcnt(0)
    s_barrier
    v_mfma_f32_16x16x32_bf16 v[12:15], v[100:103], v[108:111], v[12:15]
    v_mfma_f32_16x16x32_bf16 v[16:19], v[100:103], v[116:119], v[16:19]
    v_mfma_f32_16x16x32_bf16 v[20:23], v[100:103], v[124:127], v[20:23]
    v_mfma_f32_16x16x32_bf16 v[0:3], v[48:51], v[64:67], v[0:3]
    ds_read_b128 v[88:91], v134 offset:20480
    v_mfma_f32_16x16x32_bf16 v[4:7], v[48:51], v[72:75], v[4:7]
    ds_read_b128 v[104:107], v128 offset:20480
    v_mfma_f32_16x16x32_bf16 v[8:11], v[48:51], v[80:83], v[8:11]
    ds_read_b128 v[112:115], v128 offset:22528
    v_mfma_f32_16x16x32_bf16 v[12:15], v[56:59], v[64:67], v[12:15]
    ds_read_b128 v[120:123], v128 offset:24576
    v_mfma_f32_16x16x32_bf16 v[16:19], v[56:59], v[72:75], v[16:19]
    ds_read_b128 v[96:99], v134 offset:22528
    v_mfma_f32_16x16x32_bf16 v[20:23], v[56:59], v[80:83], v[20:23]
    ds_read_b128 v[108:111], v131 offset:20480
    v_mfma_f32_16x16x32_bf16 v[24:27], v[48:51], v[68:71], v[24:27]
    ds_read_b128 v[116:119], v131 offset:22528
    v_mfma_f32_16x16x32_bf16 v[28:31], v[48:51], v[76:79], v[28:31]
    ds_read_b128 v[124:127], v131 offset:24576
    v_mfma_f32_16x16x32_bf16 v[32:35], v[48:51], v[84:87], v[32:35]
    ds_read_b128 v[92:95], v134 offset:21504
    v_mfma_f32_16x16x32_bf16 v[36:39], v[56:59], v[68:71], v[36:39]
    ds_read_b128 v[100:103], v134 offset:23552
    v_mfma_f32_16x16x32_bf16 v[40:43], v[56:59], v[76:79], v[40:43]
    v_mfma_f32_16x16x32_bf16 v[44:47], v[56:59], v[84:87], v[44:47]
    v_mfma_f32_16x16x32_bf16 v[24:27], v[52:55], v[64:67], v[24:27]
    v_xor_b32 v68, s34, v68
    v_xor_b32 v69, s34, v69
    v_mfma_f32_16x16x32_bf16 v[28:31], v[52:55], v[72:75], v[28:31]
    v_xor_b32 v70, s34, v70
    v_xor_b32 v71, s34, v71
    v_mfma_f32_16x16x32_bf16 v[32:35], v[52:55], v[80:83], v[32:35]
    v_xor_b32 v76, s34, v76
    v_xor_b32 v77, s34, v77
    v_mfma_f32_16x16x32_bf16 v[36:39], v[60:63], v[64:67], v[36:39]
    v_xor_b32 v78, s34, v78
    v_xor_b32 v79, s34, v79
    v_mfma_f32_16x16x32_bf16 v[40:43], v[60:63], v[72:75], v[40:43]
    v_xor_b32 v84, s34, v84
    v_xor_b32 v85, s34, v85
    v_mfma_f32_16x16x32_bf16 v[44:47], v[60:63], v[80:83], v[44:47]
    v_xor_b32 v86, s34, v86
    v_xor_b32 v87, s34, v87
    v_mfma_f32_16x16x32_bf16 v[0:3], v[52:55], v[68:71], v[0:3]
    v_mfma_f32_16x16x32_bf16 v[4:7], v[52:55], v[76:79], v[4:7]
    v_mfma_f32_16x16x32_bf16 v[8:11], v[52:55], v[84:87], v[8:11]
    s_waitcnt lgkmcnt(0)
    v_mfma_f32_16x16x32_bf16 v[12:15], v[60:63], v[68:71], v[12:15]
    v_mfma_f32_16x16x32_bf16 v[16:19], v[60:63], v[76:79], v[16:19]
    v_mfma_f32_16x16x32_bf16 v[20:23], v[60:63], v[84:87], v[20:23]
    v_mfma_f32_16x16x32_bf16 v[0:3], v[88:91], v[104:107], v[0:3]
    v_mfma_f32_16x16x32_bf16 v[4:7], v[88:91], v[112:115], v[4:7]
    v_mfma_f32_16x16x32_bf16 v[8:11], v[88:91], v[120:123], v[8:11]
    v_mfma_f32_16x16x32_bf16 v[12:15], v[96:99], v[104:107], v[12:15]
    v_mfma_f32_16x16x32_bf16 v[16:19], v[96:99], v[112:115], v[16:19]
    v_mfma_f32_16x16x32_bf16 v[20:23], v[96:99], v[120:123], v[20:23]
    v_mfma_f32_16x16x32_bf16 v[24:27], v[88:91], v[108:111], v[24:27]
    v_mfma_f32_16x16x32_bf16 v[28:31], v[88:91], v[116:119], v[28:31]
    v_mfma_f32_16x16x32_bf16 v[32:35], v[88:91], v[124:127], v[32:35]
    v_mfma_f32_16x16x32_bf16 v[36:39], v[96:99], v[108:111], v[36:39]
    v_mfma_f32_16x16x32_bf16 v[40:43], v[96:99], v[116:119], v[40:43]
    v_mfma_f32_16x16x32_bf16 v[44:47], v[96:99], v[124:127], v[44:47]
    v_mfma_f32_16x16x32_bf16 v[24:27], v[92:95], v[104:107], v[24:27]
    v_xor_b32 v108, s34, v108
    v_xor_b32 v109, s34, v109
    v_mfma_f32_16x16x32_bf16 v[28:31], v[92:95], v[112:115], v[28:31]
    v_xor_b32 v110, s34, v110
    v_xor_b32 v111, s34, v111
    v_mfma_f32_16x16x32_bf16 v[32:35], v[92:95], v[120:123], v[32:35]
    v_xor_b32 v116, s34, v116
    v_xor_b32 v117, s34, v117
    v_mfma_f32_16x16x32_bf16 v[36:39], v[100:103], v[104:107], v[36:39]
    v_xor_b32 v118, s34, v118
    v_xor_b32 v119, s34, v119
    v_mfma_f32_16x16x32_bf16 v[40:43], v[100:103], v[112:115], v[40:43]
    v_xor_b32 v124, s34, v124
    v_xor_b32 v125, s34, v125
    v_mfma_f32_16x16x32_bf16 v[44:47], v[100:103], v[120:123], v[44:47]
    v_xor_b32 v126, s34, v126
    v_xor_b32 v127, s34, v127
    v_mfma_f32_16x16x32_bf16 v[0:3], v[92:95], v[108:111], v[0:3]
    v_mfma_f32_16x16x32_bf16 v[4:7], v[92:95], v[116:119], v[4:7]
    v_mfma_f32_16x16x32_bf16 v[8:11], v[92:95], v[124:127], v[8:11]
    v_mfma_f32_16x16x32_bf16 v[12:15], v[100:103], v[108:111], v[12:15]
    v_mfma_f32_16x16x32_bf16 v[16:19], v[100:103], v[116:119], v[16:19]
    v_mfma_f32_16x16x32_bf16 v[20:23], v[100:103], v[124:127], v[20:23]
    s_nop 7
    s_nop 7
    v_cvt_pk_bf16_f32 v48, v0, v1
    v_cvt_pk_bf16_f32 v49, v2, v3
    v_cvt_pk_bf16_f32 v50, v12, v13
    v_cvt_pk_bf16_f32 v51, v14, v15
    v_cvt_pk_bf16_f32 v52, v24, v25
    v_cvt_pk_bf16_f32 v53, v26, v27
    v_cvt_pk_bf16_f32 v54, v36, v37
    v_cvt_pk_bf16_f32 v55, v38, v39
    v_mov_b32 v56, v48
    v_mov_b32 v57, v49
    v_mov_b32 v58, v50
    v_mov_b32 v59, v51
    s_add_u32 s35, s33, 0
    v_mov_b32_dpp v56, v52 row_ror:8 row_mask:0xf bank_mask:0x3
    v_mov_b32_dpp v57, v53 row_ror:8 row_mask:0xf bank_mask:0x3
    v_mov_b32_dpp v58, v54 row_ror:8 row_mask:0xf bank_mask:0x3
    v_mov_b32_dpp v59, v55 row_ror:8 row_mask:0xf bank_mask:0x3
    v_mov_b32_dpp v48, v52 row_ror:8 row_mask:0xf bank_mask:0xc
    v_mov_b32_dpp v49, v53 row_ror:8 row_mask:0xf bank_mask:0xc
    v_mov_b32_dpp v50, v54 row_ror:8 row_mask:0xf bank_mask:0xc
    v_mov_b32_dpp v51, v55 row_ror:8 row_mask:0xf bank_mask:0xc
    buffer_store_dwordx4 v[48:51], v142, s[16:19], s35 offen sc1
    buffer_store_dwordx4 v[56:59], v143, s[16:19], s35 offen sc1
    v_cvt_pk_bf16_f32 v60, v4, v5
    v_cvt_pk_bf16_f32 v61, v6, v7
    v_cvt_pk_bf16_f32 v62, v16, v17
    v_cvt_pk_bf16_f32 v63, v18, v19
    v_cvt_pk_bf16_f32 v64, v28, v29
    v_cvt_pk_bf16_f32 v65, v30, v31
    v_cvt_pk_bf16_f32 v66, v40, v41
    v_cvt_pk_bf16_f32 v67, v42, v43
    v_mov_b32 v68, v60
    v_mov_b32 v69, v61
    v_mov_b32 v70, v62
    v_mov_b32 v71, v63
    s_add_u32 s35, s33, 593920
    v_mov_b32_dpp v68, v64 row_ror:8 row_mask:0xf bank_mask:0x3
    v_mov_b32_dpp v69, v65 row_ror:8 row_mask:0xf bank_mask:0x3
    v_mov_b32_dpp v70, v66 row_ror:8 row_mask:0xf bank_mask:0x3
    v_mov_b32_dpp v71, v67 row_ror:8 row_mask:0xf bank_mask:0x3
    v_mov_b32_dpp v60, v64 row_ror:8 row_mask:0xf bank_mask:0xc
    v_mov_b32_dpp v61, v65 row_ror:8 row_mask:0xf bank_mask:0xc
    v_mov_b32_dpp v62, v66 row_ror:8 row_mask:0xf bank_mask:0xc
    v_mov_b32_dpp v63, v67 row_ror:8 row_mask:0xf bank_mask:0xc
    buffer_store_dwordx4 v[60:63], v142, s[16:19], s35 offen sc1
    buffer_store_dwordx4 v[68:71], v143, s[16:19], s35 offen sc1
    v_cvt_pk_bf16_f32 v72, v8, v9
    v_cvt_pk_bf16_f32 v73, v10, v11
    v_cvt_pk_bf16_f32 v74, v20, v21
    v_cvt_pk_bf16_f32 v75, v22, v23
    v_cvt_pk_bf16_f32 v76, v32, v33
    v_cvt_pk_bf16_f32 v77, v34, v35
    v_cvt_pk_bf16_f32 v78, v44, v45
    v_cvt_pk_bf16_f32 v79, v46, v47
    v_mov_b32 v80, v72
    v_mov_b32 v81, v73
    v_mov_b32 v82, v74
    v_mov_b32 v83, v75
    s_add_u32 s35, s33, 1187840
    v_mov_b32_dpp v80, v76 row_ror:8 row_mask:0xf bank_mask:0x3
    v_mov_b32_dpp v81, v77 row_ror:8 row_mask:0xf bank_mask:0x3
    v_mov_b32_dpp v82, v78 row_ror:8 row_mask:0xf bank_mask:0x3
    v_mov_b32_dpp v83, v79 row_ror:8 row_mask:0xf bank_mask:0x3
    v_mov_b32_dpp v72, v76 row_ror:8 row_mask:0xf bank_mask:0xc
    v_mov_b32_dpp v73, v77 row_ror:8 row_mask:0xf bank_mask:0xc
    v_mov_b32_dpp v74, v78 row_ror:8 row_mask:0xf bank_mask:0xc
    v_mov_b32_dpp v75, v79 row_ror:8 row_mask:0xf bank_mask:0xc
    buffer_store_dwordx4 v[72:75], v142, s[16:19], s35 offen sc1
    buffer_store_dwordx4 v[80:83], v143, s[16:19], s35 offen sc1
    s_endpgm
.globl joint_kernel
.p2align 8
.type joint_kernel,@function
joint_kernel:
    s_cmp_ge_u32 s2, 256
    s_cbranch_scc1 L_joint_kernel_done
    s_load_dwordx2 s[6:7], s[0:1], 72
    s_load_dwordx2 s[4:5], s[0:1], 56
    v_readfirstlane_b32 s20, v0
    s_lshr_b32 s20, s20, 6
    s_and_b32 s21, s20, 3
    s_and_b32 s23, s2, 7
    s_lshl_b32 s23, s23, 5
    s_lshr_b32 s22, s2, 3
    s_add_u32 s23, s23, s22
    s_cmp_ge_u32 s23, 250
    s_cbranch_scc1 L_joint_kernel_done
    s_cmp_ge_u32 s23, 125
    s_cselect_b32 s24, 1, 0
    s_mul_i32 s25, s24, 125
    s_sub_u32 s25, s23, s25
    s_lshl_b32 s26, s25, 1
    s_add_u32 s26, s26, 0
    s_mul_i32 s27, s26, 171
    s_lshr_b32 s28, s27, 9
    s_mul_i32 s27, s28, 3
    s_sub_u32 s30, s26, s27
    s_lshl_b32 s26, s25, 1
    s_add_u32 s26, s26, 1
    s_mul_i32 s27, s26, 171
    s_lshr_b32 s29, s27, 9
    s_mul_i32 s27, s29, 3
    s_sub_u32 s31, s26, s27
    v_and_b32 v1, 63, v0
    v_lshlrev_b32 v5, 4, v1
    s_waitcnt lgkmcnt(0)
    s_add_u32 s12, s6, 85499904
    s_addc_u32 s13, s7, 0
    s_mov_b32 s14, 295936
    s_mov_b32 s15, 0x00020000
    s_mul_i32 s36, s24, 4000
    s_lshl_b32 s37, s25, 5
    s_add_u32 s36, s36, s37
    s_lshl_b32 s36, s36, 12
    s_add_u32 s16, s4, s36
    s_addc_u32 s17, s5, 0
    s_mov_b32 s18, 131072
    s_mov_b32 s19, 0x00020000
    s_lshl_b32 s38, s21, 15
    s_cmp_lt_u32 s20, 4
    s_cbranch_scc1 L_joint_kernel_mpath
    v_and_b32 v14, 7, v1
    v_lshlrev_b32 v14, 10, v14
    v_lshrrev_b32 v15, 5, v1
    v_lshl_add_u32 v14, v15, 4, v14
    s_lshl_b32 s36, s24, 13
    s_lshl_b32 s37, s21, 8
    s_add_u32 s36, s36, s37
    s_add_u32 s37, s36, 16384
    s_add_u32 s36, s38, 32768
    buffer_load_dwordx4 a[0:3], v5, s[12:15], s36 offen
    s_add_u32 s36, s38, 49152
    buffer_load_dwordx4 a[64:67], v5, s[12:15], s36 offen
    s_add_u32 s36, s38, 33792
    buffer_load_dwordx4 a[4:7], v5, s[12:15], s36 offen
    s_add_u32 s36, s38, 50176
    buffer_load_dwordx4 a[68:71], v5, s[12:15], s36 offen
    s_add_u32 s36, s38, 34816
    buffer_load_dwordx4 a[8:11], v5, s[12:15], s36 offen
    s_add_u32 s36, s38, 51200
    buffer_load_dwordx4 a[72:75], v5, s[12:15], s36 offen
    s_add_u32 s36, s38, 35840
    buffer_load_dwordx4 a[12:15], v5, s[12:15], s36 offen
    s_add_u32 s36, s38, 52224
    buffer_load_dwordx4 a[76:79], v5, s[12:15], s36 offen
    s_add_u32 s36, s38, 36864
    buffer_load_dwordx4 a[16:19], v5, s[12:15], s36 offen
    s_add_u32 s36, s38, 53248
    buffer_load_dwordx4 a[80:83], v5, s[12:15], s36 offen
    s_add_u32 s36, s38, 37888
    buffer_load_dwordx4 a[20:23], v5, s[12:15], s36 offen
    s_add_u32 s36, s38, 54272
    buffer_load_dwordx4 a[84:87], v5, s[12:15], s36 offen
    s_add_u32 s36, s38, 38912
    buffer_load_dwordx4 a[24:27], v5, s[12:15], s36 offen
    s_add_u32 s36, s38, 55296
    buffer_load_dwordx4 a[88:91], v5, s[12:15], s36 offen
    s_add_u32 s36, s38, 39936
    buffer_load_dwordx4 a[28:31], v5, s[12:15], s36 offen
    s_add_u32 s36, s38, 56320
    buffer_load_dwordx4 a[92:95], v5, s[12:15], s36 offen
    s_add_u32 s36, s38, 40960
    buffer_load_dwordx4 a[32:35], v5, s[12:15], s36 offen
    s_add_u32 s36, s38, 57344
    buffer_load_dwordx4 a[96:99], v5, s[12:15], s36 offen
    s_add_u32 s36, s38, 41984
    buffer_load_dwordx4 a[36:39], v5, s[12:15], s36 offen
    s_add_u32 s36, s38, 58368
    buffer_load_dwordx4 a[100:103], v5, s[12:15], s36 offen
    s_add_u32 s36, s38, 43008
    buffer_load_dwordx4 a[40:43], v5, s[12:15], s36 offen
    s_add_u32 s36, s38, 59392
    buffer_load_dwordx4 a[104:107], v5, s[12:15], s36 offen
    s_add_u32 s36, s38, 44032
    buffer_load_dwordx4 a[44:47], v5, s[12:15], s36 offen
    s_add_u32 s36, s38, 60416
    buffer_load_dwordx4 a[108:111], v5, s[12:15], s36 offen
    s_add_u32 s36, s38, 45056
    buffer_load_dwordx4 a[48:51], v5, s[12:15], s36 offen
    s_add_u32 s36, s38, 61440
    buffer_load_dwordx4 a[112:115], v5, s[12:15], s36 offen
    s_add_u32 s36, s38, 46080
    buffer_load_dwordx4 a[52:55], v5, s[12:15], s36 offen
    s_add_u32 s36, s38, 62464
    buffer_load_dwordx4 a[116:119], v5, s[12:15], s36 offen
    s_add_u32 s36, s38, 47104
    buffer_load_dwordx4 a[56:59], v5, s[12:15], s36 offen
    s_add_u32 s36, s38, 63488
    buffer_load_dwordx4 a[120:123], v5, s[12:15], s36 offen
    s_add_u32 s36, s38, 48128
    buffer_load_dwordx4 a[60:63], v5, s[12:15], s36 offen
    s_add_u32 s36, s38, 64512
    buffer_load_dwordx4 a[124:127], v5, s[12:15], s36 offen
    buffer_load_dwordx4 v[96:99], v14, s[12:15], s37 offen offset:0
    buffer_load_dwordx4 v[100:103], v14, s[12:15], s37 offen offset:32
    buffer_load_dwordx4 v[104:107], v14, s[12:15], s37 offen offset:64
    buffer_load_dwordx4 v[108:111], v14, s[12:15], s37 offen offset:96
    buffer_load_dwordx4 v[112:115], v14, s[12:15], s37 offen offset:128
    buffer_load_dwordx4 v[116:119], v14, s[12:15], s37 offen offset:160
    buffer_load_dwordx4 v[120:123], v14, s[12:15], s37 offen offset:192
    buffer_load_dwordx4 v[124:127], v14, s[12:15], s37 offen offset:224
    s_branch L_joint_kernel_helper
L_joint_kernel_mpath:
    s_lshr_b32 s36, s2, 3
    s_and_b32 s36, s36, 31
    s_lshl_b32 s36, s36, 13
    s_add_u32 s36, s36, 32768
    v_lshlrev_b32 v6, 7, v1
    s_cmp_lg_u32 s20, 0
    s_cbranch_scc1 L_joint_kernel_nopf
    buffer_load_dword v7, v6, s[12:15], s36 offen
L_joint_kernel_nopf:
    v_lshrrev_b32 v2, 3, v1
    v_mul_u32_u24 v2, 1024, v2
    v_bfe_u32 v3, v1, 2, 1
    v_lshl_add_u32 v2, v3, 6, v2
    v_lshrrev_b32 v3, 5, v1
    v_lshlrev_b32 v3, 1, v3
    v_and_b32 v4, 3, v1
    v_xor_b32 v3, v3, v4
    v_lshl_add_u32 v2, v3, 4, v2
    s_lshl_b32 s34, s21, 14
    s_mul_i32 s35, s21, 256
    s_mul_i32 s33, s24, 3118080
    s_add_u32 s33, s33, 79261696
    s_add_u32 s8, s6, s33
    s_addc_u32 s9, s7, 0
    s_mov_b32 s10, 3118080
    s_mov_b32 s11, 0x00020000
    s_mov_b32 s46, 0
    s_cmp_eq_u32 s28, s29
    s_cbranch_scc1 L_joint_kernel_same
    s_mul_i32 s36, s29, 37120
    s_add_u32 s36, s36, s35
    s_add_u32 m0, s34, 8192
    s_add_u32 s37, s36, 0
    buffer_load_dwordx4 v2, s[8:11], s37 offen lds
    s_add_u32 m0, s34, 9216
    s_add_u32 s37, s36, 8192
    buffer_load_dwordx4 v2, s[8:11], s37 offen lds
    s_add_u32 m0, s34, 10240
    s_add_u32 s37, s36, 16384
    buffer_load_dwordx4 v2, s[8:11], s37 offen lds
    s_add_u32 m0, s34, 11264
    s_add_u32 s37, s36, 24576
    buffer_load_dwordx4 v2, s[8:11], s37 offen lds
    s_add_u32 m0, s34, 12288
    s_add_u32 s37, s36, 128
    buffer_load_dwordx4 v2, s[8:11], s37 offen lds
    s_add_u32 m0, s34, 13312
    s_add_u32 s37, s36, 8320
    buffer_load_dwordx4 v2, s[8:11], s37 offen lds
    s_add_u32 m0, s34, 14336
    s_add_u32 s37, s36, 16512
    buffer_load_dwordx4 v2, s[8:11], s37 offen lds
    s_add_u32 m0, s34, 15360
    s_add_u32 s37, s36, 24704
    buffer_load_dwordx4 v2, s[8:11], s37 offen lds
    s_mov_b32 s46, 8192
L_joint_kernel_same:
    s_lshl_b32 s36, s30, 11
    s_add_u32 s36, s36, 8192
    buffer_load_dwordx4 v[8:11], v5, s[12:15], s36 offen offset:0
    buffer_load_dwordx4 v[12:15], v5, s[12:15], s36 offen offset:1024
    s_lshl_b32 s36, s31, 11
    s_add_u32 s36, s36, 8192
    buffer_load_dwordx4 v[16:19], v5, s[12:15], s36 offen offset:0
    buffer_load_dwordx4 v[20:23], v5, s[12:15], s36 offen offset:1024
    s_mul_i32 s36, s28, 37120
    s_add_u32 s36, s36, s35
    s_add_u32 m0, s34, 0
    s_add_u32 s37, s36, 0
    buffer_load_dwordx4 v2, s[8:11], s37 offen lds
    s_add_u32 m0, s34, 1024
    s_add_u32 s37, s36, 8192
    buffer_load_dwordx4 v2, s[8:11], s37 offen lds
    s_add_u32 m0, s34, 2048
    s_add_u32 s37, s36, 16384
    buffer_load_dwordx4 v2, s[8:11], s37 offen lds
    s_add_u32 m0, s34, 3072
    s_add_u32 s37, s36, 24576
    buffer_load_dwordx4 v2, s[8:11], s37 offen lds
    s_add_u32 m0, s34, 4096
    s_add_u32 s37, s36, 128
    buffer_load_dwordx4 v2, s[8:11], s37 offen lds
    s_add_u32 m0, s34, 5120
    s_add_u32 s37, s36, 8320
    buffer_load_dwordx4 v2, s[8:11], s37 offen lds
    s_add_u32 m0, s34, 6144
    s_add_u32 s37, s36, 16512
    buffer_load_dwordx4 v2, s[8:11], s37 offen lds
    s_add_u32 m0, s34, 7168
    s_add_u32 s37, s36, 24704
    buffer_load_dwordx4 v2, s[8:11], s37 offen lds
    v_bfe_u32 v32, v1, 2, 2
    v_lshrrev_b32 v33, 4, v1
    v_and_b32 v34, 3, v1
    v_lshl_add_u32 v35, v33, 3, v32
    v_lshlrev_b32 v40, 6, v35
    v_and_b32 v41, 1, v33
    v_lshlrev_b32 v41, 1, v41
    v_lshrrev_b32 v42, 1, v34
    v_xor_b32 v41, v41, v42
    v_lshl_add_u32 v40, v41, 4, v40
    v_and_b32 v42, 1, v34
    v_lshl_add_u32 v40, v42, 3, v40
    v_add_u32 v36, s34, v40
    v_xor_b32 v37, 32, v36
    v_add_u32 v38, s46, v36
    v_add_u32 v39, s46, v37
    v_lshrrev_b32 v41, 1, v33
    v_lshlrev_b32 v41, 10, v41
    v_and_b32 v42, 1, v33
    v_lshl_add_u32 v41, v42, 9, v41
    v_and_b32 v42, 15, v1
    v_lshl_add_u32 v41, v42, 4, v41
    s_lshl_b32 s36, s21, 12
    s_add_u32 s36, s36, 65536
    v_add_u32 v43, s36, v41
    s_mov_b32 s40, 0xbdd2d3e8
    v_mov_b32 v44, 0xc0135761
    s_mov_b32 s41, 0xbdd2d3e8
    v_mov_b32 v45, 0xc0135761
    s_waitcnt vmcnt(4)
    ds_read_b64_tr_b16 v[48:49], v36 offset:0
    ds_read_b64_tr_b16 v[50:51], v36 offset:256
    ds_read_b64_tr_b16 v[52:53], v36 offset:2048
    ds_read_b64_tr_b16 v[54:55], v36 offset:2304
    ds_read_b64_tr_b16 v[56:57], v37 offset:0
    ds_read_b64_tr_b16 v[58:59], v37 offset:256
    ds_read_b64_tr_b16 v[60:61], v37 offset:2048
    ds_read_b64_tr_b16 v[62:63], v37 offset:2304
    s_waitcnt lgkmcnt(0)
    v_mfma_f32_16x16x32_bf16 v[64:67], v[48:51], v[8:11], 0
    v_mfma_f32_16x16x32_bf16 v[68:71], v[56:59], v[8:11], 0
    v_mfma_f32_16x16x32_bf16 v[64:67], v[52:55], v[12:15], v[64:67]
    v_mfma_f32_16x16x32_bf16 v[68:71], v[60:63], v[12:15], v[68:71]
    ds_read_b64_tr_b16 v[84:85], v38 offset:0
    ds_read_b64_tr_b16 v[86:87], v38 offset:256
    ds_read_b64_tr_b16 v[88:89], v38 offset:2048
    ds_read_b64_tr_b16 v[90:91], v38 offset:2304
    ds_read_b64_tr_b16 v[92:93], v39 offset:0
    ds_read_b64_tr_b16 v[94:95], v39 offset:256
    ds_read_b64_tr_b16 v[96:97], v39 offset:2048
    ds_read_b64_tr_b16 v[98:99], v39 offset:2304
    v_mul_f32 v72, v64, v64
    v_mul_f32 v73, v65, v65
    v_mul_f32 v74, v66, v66
    v_mul_f32 v75, v67, v67
    v_mul_f32 v76, v68, v68
    v_mul_f32 v77, v69, v69
    v_mul_f32 v78, v70, v70
    v_mul_f32 v79, v71, v71
    v_fma_f32 v72, v72, s40, v44
    v_fma_f32 v73, v73, s40, v44
    v_fma_f32 v74, v74, s40, v44
    v_fma_f32 v75, v75, s40, v44
    v_fma_f32 v76, v76, s40, v44
    v_fma_f32 v77, v77, s40, v44
    v_fma_f32 v78, v78, s40, v44
    v_fma_f32 v79, v79, s40, v44
    v_mul_f32 v72, v72, v64
    v_mul_f32 v73, v73, v65
    v_mul_f32 v74, v74, v66
    v_mul_f32 v75, v75, v67
    v_mul_f32 v76, v76, v68
    v_mul_f32 v77, v77, v69
    v_mul_f32 v78, v78, v70
    v_mul_f32 v79, v79, v71
    v_exp_f32 v72, v72
    v_exp_f32 v73, v73
    v_exp_f32 v74, v74
    v_exp_f32 v75, v75
    v_exp_f32 v76, v76
    v_exp_f32 v77, v77
    v_exp_f32 v78, v78
    v_exp_f32 v79, v79
    v_add_f32 v72, 1.0, v72
    v_add_f32 v73, 1.0, v73
    v_add_f32 v74, 1.0, v74
    v_add_f32 v75, 1.0, v75
    v_add_f32 v76, 1.0, v76
    v_add_f32 v77, 1.0, v77
    v_add_f32 v78, 1.0, v78
    v_add_f32 v79, 1.0, v79
    v_rcp_f32 v72, v72
    v_rcp_f32 v73, v73
    v_rcp_f32 v74, v74
    v_rcp_f32 v75, v75
    v_rcp_f32 v76, v76
    v_rcp_f32 v77, v77
    v_rcp_f32 v78, v78
    v_rcp_f32 v79, v79
    v_mul_f32 v64, v64, v72
    v_mul_f32 v65, v65, v73
    v_mul_f32 v66, v66, v74
    v_mul_f32 v67, v67, v75
    v_mul_f32 v68, v68, v76
    v_mul_f32 v69, v69, v77
    v_mul_f32 v70, v70, v78
    v_mul_f32 v71, v71, v79
    v_cvt_pk_bf16_f32 v80, v64, v65
    v_cvt_pk_bf16_f32 v81, v66, v67
    v_cvt_pk_bf16_f32 v82, v68, v69
    v_cvt_pk_bf16_f32 v83, v70, v71
    ds_write_b128 v43, v[80:83] offset:0
    s_waitcnt vmcnt(0)
    s_waitcnt lgkmcnt(1)
    v_mfma_f32_16x16x32_bf16 v[100:103], v[84:87], v[16:19], 0
    v_mfma_f32_16x16x32_bf16 v[104:107], v[92:95], v[16:19], 0
    v_mfma_f32_16x16x32_bf16 v[100:103], v[88:91], v[20:23], v[100:103]
    v_mfma_f32_16x16x32_bf16 v[104:107], v[96:99], v[20:23], v[104:107]
    ds_read_b64_tr_b16 v[48:49], v36 offset:4096
    ds_read_b64_tr_b16 v[50:51], v36 offset:4352
    ds_read_b64_tr_b16 v[52:53], v36 offset:6144
    ds_read_b64_tr_b16 v[54:55], v36 offset:6400
    ds_read_b64_tr_b16 v[56:57], v37 offset:4096
    ds_read_b64_tr_b16 v[58:59], v37 offset:4352
    ds_read_b64_tr_b16 v[60:61], v37 offset:6144
    ds_read_b64_tr_b16 v[62:63], v37 offset:6400
    v_mul_f32 v72, v100, v100
    v_mul_f32 v73, v101, v101
    v_mul_f32 v74, v102, v102
    v_mul_f32 v75, v103, v103
    v_mul_f32 v76, v104, v104
    v_mul_f32 v77, v105, v105
    v_mul_f32 v78, v106, v106
    v_mul_f32 v79, v107, v107
    v_fma_f32 v72, v72, s40, v44
    v_fma_f32 v73, v73, s40, v44
    v_fma_f32 v74, v74, s40, v44
    v_fma_f32 v75, v75, s40, v44
    v_fma_f32 v76, v76, s40, v44
    v_fma_f32 v77, v77, s40, v44
    v_fma_f32 v78, v78, s40, v44
    v_fma_f32 v79, v79, s40, v44
    v_mul_f32 v72, v72, v100
    v_mul_f32 v73, v73, v101
    v_mul_f32 v74, v74, v102
    v_mul_f32 v75, v75, v103
    v_mul_f32 v76, v76, v104
    v_mul_f32 v77, v77, v105
    v_mul_f32 v78, v78, v106
    v_mul_f32 v79, v79, v107
    v_exp_f32 v72, v72
    v_exp_f32 v73, v73
    v_exp_f32 v74, v74
    v_exp_f32 v75, v75
    v_exp_f32 v76, v76
    v_exp_f32 v77, v77
    v_exp_f32 v78, v78
    v_exp_f32 v79, v79
    v_add_f32 v72, 1.0, v72
    v_add_f32 v73, 1.0, v73
    v_add_f32 v74, 1.0, v74
    v_add_f32 v75, 1.0, v75
    v_add_f32 v76, 1.0, v76
    v_add_f32 v77, 1.0, v77
    v_add_f32 v78, 1.0, v78
    v_add_f32 v79, 1.0, v79
    v_rcp_f32 v72, v72
    v_rcp_f32 v73, v73
    v_rcp_f32 v74, v74
    v_rcp_f32 v75, v75
    v_rcp_f32 v76, v76
    v_rcp_f32 v77, v77
    v_rcp_f32 v78, v78
    v_rcp_f32 v79, v79
    v_mul_f32 v100, v100, v72
    v_mul_f32 v101, v101, v73
    v_mul_f32 v102, v102, v74
    v_mul_f32 v103, v103, v75
    v_mul_f32 v104, v104, v76
    v_mul_f32 v105, v105, v77
    v_mul_f32 v106, v106, v78
    v_mul_f32 v107, v107, v79
    v_cvt_pk_bf16_f32 v108, v100, v101
    v_cvt_pk_bf16_f32 v109, v102, v103
    v_cvt_pk_bf16_f32 v110, v104, v105
    v_cvt_pk_bf16_f32 v111, v106, v107
    ds_write_b128 v43, v[108:111] offset:256
    s_waitcnt lgkmcnt(1)
    v_mfma_f32_16x16x32_bf16 v[64:67], v[48:51], v[8:11], 0
    v_mfma_f32_16x16x32_bf16 v[68:71], v[56:59], v[8:11], 0
    v_mfma_f32_16x16x32_bf16 v[64:67], v[52:55], v[12:15], v[64:67]
    v_mfma_f32_16x16x32_bf16 v[68:71], v[60:63], v[12:15], v[68:71]
    ds_read_b64_tr_b16 v[84:85], v38 offset:4096
    ds_read_b64_tr_b16 v[86:87], v38 offset:4352
    ds_read_b64_tr_b16 v[88:89], v38 offset:6144
    ds_read_b64_tr_b16 v[90:91], v38 offset:6400
    ds_read_b64_tr_b16 v[92:93], v39 offset:4096
    ds_read_b64_tr_b16 v[94:95], v39 offset:4352
    ds_read_b64_tr_b16 v[96:97], v39 offset:6144
    ds_read_b64_tr_b16 v[98:99], v39 offset:6400
    v_mul_f32 v72, v64, v64
    v_mul_f32 v73, v65, v65
    v_mul_f32 v74, v66, v66
    v_mul_f32 v75, v67, v67
    v_mul_f32 v76, v68, v68
    v_mul_f32 v77, v69, v69
    v_mul_f32 v78, v70, v70
    v_mul_f32 v79, v71, v71
    v_fma_f32 v72, v72, s40, v44
    v_fma_f32 v73, v73, s40, v44
    v_fma_f32 v74, v74, s40, v44
    v_fma_f32 v75, v75, s40, v44
    v_fma_f32 v76, v76, s40, v44
    v_fma_f32 v77, v77, s40, v44
    v_fma_f32 v78, v78, s40, v44
    v_fma_f32 v79, v79, s40, v44
    v_mul_f32 v72, v72, v64
    v_mul_f32 v73, v73, v65
    v_mul_f32 v74, v74, v66
    v_mul_f32 v75, v75, v67
    v_mul_f32 v76, v76, v68
    v_mul_f32 v77, v77, v69
    v_mul_f32 v78, v78, v70
    v_mul_f32 v79, v79, v71
    v_exp_f32 v72, v72
    v_exp_f32 v73, v73
    v_exp_f32 v74, v74
    v_exp_f32 v75, v75
    v_exp_f32 v76, v76
    v_exp_f32 v77, v77
    v_exp_f32 v78, v78
    v_exp_f32 v79, v79
    v_add_f32 v72, 1.0, v72
    v_add_f32 v73, 1.0, v73
    v_add_f32 v74, 1.0, v74
    v_add_f32 v75, 1.0, v75
    v_add_f32 v76, 1.0, v76
    v_add_f32 v77, 1.0, v77
    v_add_f32 v78, 1.0, v78
    v_add_f32 v79, 1.0, v79
    v_rcp_f32 v72, v72
    v_rcp_f32 v73, v73
    v_rcp_f32 v74, v74
    v_rcp_f32 v75, v75
    v_rcp_f32 v76, v76
    v_rcp_f32 v77, v77
    v_rcp_f32 v78, v78
    v_rcp_f32 v79, v79
    v_mul_f32 v64, v64, v72
    v_mul_f32 v65, v65, v73
    v_mul_f32 v66, v66, v74
    v_mul_f32 v67, v67, v75
    v_mul_f32 v68, v68, v76
    v_mul_f32 v69, v69, v77
    v_mul_f32 v70, v70, v78
    v_mul_f32 v71, v71, v79
    v_cvt_pk_bf16_f32 v80, v64, v65
    v_cvt_pk_bf16_f32 v81, v66, v67
    v_cvt_pk_bf16_f32 v82, v68, v69
    v_cvt_pk_bf16_f32 v83, v70, v71
    ds_write_b128 v43, v[80:83] offset:2048
    s_waitcnt lgkmcnt(1)
    v_mfma_f32_16x16x32_bf16 v[100:103], v[84:87], v[16:19], 0
    v_mfma_f32_16x16x32_bf16 v[104:107], v[92:95], v[16:19], 0
    v_mfma_f32_16x16x32_bf16 v[100:103], v[88:91], v[20:23], v[100:103]
    v_mfma_f32_16x16x32_bf16 v[104:107], v[96:99], v[20:23], v[104:107]
    s_nop 7
    v_mul_f32 v72, v100, v100
    v_mul_f32 v73, v101, v101
    v_mul_f32 v74, v102, v102
    v_mul_f32 v75, v103, v103
    v_mul_f32 v76, v104, v104
    v_mul_f32 v77, v105, v105
    v_mul_f32 v78, v106, v106
    v_mul_f32 v79, v107, v107
    v_fma_f32 v72, v72, s40, v44
    v_fma_f32 v73, v73, s40, v44
    v_fma_f32 v74, v74, s40, v44
    v_fma_f32 v75, v75, s40, v44
    v_fma_f32 v76, v76, s40, v44
    v_fma_f32 v77, v77, s40, v44
    v_fma_f32 v78, v78, s40, v44
    v_fma_f32 v79, v79, s40, v44
    v_mul_f32 v72, v72, v100
    v_mul_f32 v73, v73, v101
    v_mul_f32 v74, v74, v102
    v_mul_f32 v75, v75, v103
    v_mul_f32 v76, v76, v104
    v_mul_f32 v77, v77, v105
    v_mul_f32 v78, v78, v106
    v_mul_f32 v79, v79, v107
    v_exp_f32 v72, v72
    v_exp_f32 v73, v73
    v_exp_f32 v74, v74
    v_exp_f32 v75, v75
    v_exp_f32 v76, v76
    v_exp_f32 v77, v77
    v_exp_f32 v78, v78
    v_exp_f32 v79, v79
    v_add_f32 v72, 1.0, v72
    v_add_f32 v73, 1.0, v73
    v_add_f32 v74, 1.0, v74
    v_add_f32 v75, 1.0, v75
    v_add_f32 v76, 1.0, v76
    v_add_f32 v77, 1.0, v77
    v_add_f32 v78, 1.0, v78
    v_add_f32 v79, 1.0, v79
    v_rcp_f32 v72, v72
    v_rcp_f32 v73, v73
    v_rcp_f32 v74, v74
    v_rcp_f32 v75, v75
    v_rcp_f32 v76, v76
    v_rcp_f32 v77, v77
    v_rcp_f32 v78, v78
    v_rcp_f32 v79, v79
    v_mul_f32 v100, v100, v72
    v_mul_f32 v101, v101, v73
    v_mul_f32 v102, v102, v74
    v_mul_f32 v103, v103, v75
    v_mul_f32 v104, v104, v76
    v_mul_f32 v105, v105, v77
    v_mul_f32 v106, v106, v78
    v_mul_f32 v107, v107, v79
    v_cvt_pk_bf16_f32 v108, v100, v101
    v_cvt_pk_bf16_f32 v109, v102, v103
    v_cvt_pk_bf16_f32 v110, v104, v105
    v_cvt_pk_bf16_f32 v111, v106, v107
    ds_write_b128 v43, v[108:111] offset:2304
    s_waitcnt lgkmcnt(0)
    s_barrier
    v_and_b32 v46, 31, v1
    v_mul_u32_u24 v47, 528, v46
    v_lshrrev_b32 v45, 5, v1
    v_lshl_add_u32 v47, v45, 4, v47
    s_lshl_b32 s36, s21, 7
    s_add_u32 s36, s36, 115712
    v_add_u32 v6, s36, v47
    v_lshlrev_b32 v7, 6, v45
    s_lshl_b32 s36, s21, 8
    s_add_u32 s36, s36, 14336
    buffer_load_dwordx4 v[72:75], v7, s[12:15], s36 offen offset:0
    buffer_load_dwordx4 v[76:79], v7, s[12:15], s36 offen offset:16
    buffer_load_dwordx4 v[80:83], v7, s[12:15], s36 offen offset:32
    buffer_load_dwordx4 v[84:87], v7, s[12:15], s36 offen offset:48
    buffer_load_dwordx4 v[88:91], v7, s[12:15], s36 offen offset:128
    buffer_load_dwordx4 v[92:95], v7, s[12:15], s36 offen offset:144
    buffer_load_dwordx4 v[96:99], v7, s[12:15], s36 offen offset:160
    buffer_load_dwordx4 v[100:103], v7, s[12:15], s36 offen offset:176
    s_add_u32 s36, s38, 163840
    buffer_load_dwordx4 a[0:3], v5, s[12:15], s36 offen
    s_add_u32 s36, s38, 180224
    buffer_load_dwordx4 a[64:67], v5, s[12:15], s36 offen
    s_add_u32 s36, s38, 164864
    buffer_load_dwordx4 a[4:7], v5, s[12:15], s36 offen
    s_add_u32 s36, s38, 181248
    buffer_load_dwordx4 a[68:71], v5, s[12:15], s36 offen
    s_add_u32 s36, s38, 165888
    buffer_load_dwordx4 a[8:11], v5, s[12:15], s36 offen
    s_add_u32 s36, s38, 182272
    buffer_load_dwordx4 a[72:75], v5, s[12:15], s36 offen
    s_add_u32 s36, s38, 166912
    buffer_load_dwordx4 a[12:15], v5, s[12:15], s36 offen
    s_add_u32 s36, s38, 183296
    buffer_load_dwordx4 a[76:79], v5, s[12:15], s36 offen
    s_add_u32 s36, s38, 167936
    buffer_load_dwordx4 a[16:19], v5, s[12:15], s36 offen
    s_add_u32 s36, s38, 184320
    buffer_load_dwordx4 a[80:83], v5, s[12:15], s36 offen
    s_add_u32 s36, s38, 168960
    buffer_load_dwordx4 a[20:23], v5, s[12:15], s36 offen
    s_add_u32 s36, s38, 185344
    buffer_load_dwordx4 a[84:87], v5, s[12:15], s36 offen
    s_add_u32 s36, s38, 169984
    buffer_load_dwordx4 a[24:27], v5, s[12:15], s36 offen
    s_add_u32 s36, s38, 186368
    buffer_load_dwordx4 a[88:91], v5, s[12:15], s36 offen
    s_add_u32 s36, s38, 171008
    buffer_load_dwordx4 a[28:31], v5, s[12:15], s36 offen
    s_add_u32 s36, s38, 187392
    buffer_load_dwordx4 a[92:95], v5, s[12:15], s36 offen
    s_add_u32 s36, s38, 172032
    buffer_load_dwordx4 a[32:35], v5, s[12:15], s36 offen
    s_add_u32 s36, s38, 188416
    buffer_load_dwordx4 a[96:99], v5, s[12:15], s36 offen
    s_add_u32 s36, s38, 173056
    buffer_load_dwordx4 a[36:39], v5, s[12:15], s36 offen
    s_add_u32 s36, s38, 189440
    buffer_load_dwordx4 a[100:103], v5, s[12:15], s36 offen
    s_add_u32 s36, s38, 174080
    buffer_load_dwordx4 a[40:43], v5, s[12:15], s36 offen
    s_add_u32 s36, s38, 190464
    buffer_load_dwordx4 a[104:107], v5, s[12:15], s36 offen
    s_add_u32 s36, s38, 175104
    buffer_load_dwordx4 a[44:47], v5, s[12:15], s36 offen
    s_add_u32 s36, s38, 191488
    buffer_load_dwordx4 a[108:111], v5, s[12:15], s36 offen
    s_add_u32 s36, s38, 176128
    buffer_load_dwordx4 a[48:51], v5, s[12:15], s36 offen
    s_add_u32 s36, s38, 192512
    buffer_load_dwordx4 a[112:115], v5, s[12:15], s36 offen
    s_add_u32 s36, s38, 177152
    buffer_load_dwordx4 a[52:55], v5, s[12:15], s36 offen
    s_add_u32 s36, s38, 193536
    buffer_load_dwordx4 a[116:119], v5, s[12:15], s36 offen
    s_add_u32 s36, s38, 178176
    buffer_load_dwordx4 a[56:59], v5, s[12:15], s36 offen
    s_add_u32 s36, s38, 194560
    buffer_load_dwordx4 a[120:123], v5, s[12:15], s36 offen
    s_add_u32 s36, s38, 179200
    buffer_load_dwordx4 a[60:63], v5, s[12:15], s36 offen
    s_add_u32 s36, s38, 195584
    buffer_load_dwordx4 a[124:127], v5, s[12:15], s36 offen
    s_setprio 1
    s_barrier
    ds_read_b128 v[104:107], v5 offset:0
    ds_read_b128 v[108:111], v5 offset:1024
    ds_read_b128 v[112:115], v5 offset:2048
    s_waitcnt lgkmcnt(2)
    s_waitcnt vmcnt(30)
    v_mfma_f32_32x32x16_bf16 v[8:23], a[0:3], v[104:107], v[72:87]
    ds_read_b128 v[116:119], v5 offset:3072
    v_mfma_f32_32x32x16_bf16 v[24:39], a[64:67], v[104:107], v[88:103]
    s_waitcnt lgkmcnt(2)
    s_waitcnt vmcnt(28)
    v_mfma_f32_32x32x16_bf16 v[8:23], a[4:7], v[108:111], v[8:23]
    ds_read_b128 v[104:107], v5 offset:4096
    v_mfma_f32_32x32x16_bf16 v[24:39], a[68:71], v[108:111], v[24:39]
    s_waitcnt lgkmcnt(2)
    s_waitcnt vmcnt(26)
    v_mfma_f32_32x32x16_bf16 v[8:23], a[8:11], v[112:115], v[8:23]
    ds_read_b128 v[108:111], v5 offset:5120
    v_mfma_f32_32x32x16_bf16 v[24:39], a[72:75], v[112:115], v[24:39]
    s_waitcnt lgkmcnt(2)
    s_waitcnt vmcnt(24)
    v_mfma_f32_32x32x16_bf16 v[8:23], a[12:15], v[116:119], v[8:23]
    ds_read_b128 v[112:115], v5 offset:6144
    v_mfma_f32_32x32x16_bf16 v[24:39], a[76:79], v[116:119], v[24:39]
    s_waitcnt lgkmcnt(2)
    s_waitcnt vmcnt(22)
    v_mfma_f32_32x32x16_bf16 v[8:23], a[16:19], v[104:107], v[8:23]
    ds_read_b128 v[116:119], v5 offset:7168
    v_mfma_f32_32x32x16_bf16 v[24:39], a[80:83], v[104:107], v[24:39]
    s_waitcnt lgkmcnt(2)
    s_waitcnt vmcnt(20)
    v_mfma_f32_32x32x16_bf16 v[8:23], a[20:23], v[108:111], v[8:23]
    ds_read_b128 v[104:107], v5 offset:8192
    v_mfma_f32_32x32x16_bf16 v[24:39], a[84:87], v[108:111], v[24:39]
    s_waitcnt lgkmcnt(2)
    s_waitcnt vmcnt(18)
    v_mfma_f32_32x32x16_bf16 v[8:23], a[24:27], v[112:115], v[8:23]
    ds_read_b128 v[108:111], v5 offset:9216
    v_mfma_f32_32x32x16_bf16 v[24:39], a[88:91], v[112:115], v[24:39]
    s_waitcnt lgkmcnt(2)
    s_waitcnt vmcnt(16)
    v_mfma_f32_32x32x16_bf16 v[8:23], a[28:31], v[116:119], v[8:23]
    ds_read_b128 v[112:115], v5 offset:10240
    v_mfma_f32_32x32x16_bf16 v[24:39], a[92:95], v[116:119], v[24:39]
    s_waitcnt lgkmcnt(2)
    s_waitcnt vmcnt(14)
    v_mfma_f32_32x32x16_bf16 v[8:23], a[32:35], v[104:107], v[8:23]
    ds_read_b128 v[116:119], v5 offset:11264
    v_mfma_f32_32x32x16_bf16 v[24:39], a[96:99], v[104:107], v[24:39]
    s_waitcnt lgkmcnt(2)
    s_waitcnt vmcnt(12)
    v_mfma_f32_32x32x16_bf16 v[8:23], a[36:39], v[108:111], v[8:23]
    ds_read_b128 v[104:107], v5 offset:12288
    v_mfma_f32_32x32x16_bf16 v[24:39], a[100:103], v[108:111], v[24:39]
    s_waitcnt lgkmcnt(2)
    s_waitcnt vmcnt(10)
    v_mfma_f32_32x32x16_bf16 v[8:23], a[40:43], v[112:115], v[8:23]
    ds_read_b128 v[108:111], v5 offset:13312
    v_mfma_f32_32x32x16_bf16 v[24:39], a[104:107], v[112:115], v[24:39]
    s_waitcnt lgkmcnt(2)
    s_waitcnt vmcnt(8)
    v_mfma_f32_32x32x16_bf16 v[8:23], a[44:47], v[116:119], v[8:23]
    ds_read_b128 v[112:115], v5 offset:14336
    v_mfma_f32_32x32x16_bf16 v[24:39], a[108:111], v[116:119], v[24:39]
    s_waitcnt lgkmcnt(2)
    s_waitcnt vmcnt(6)
    v_mfma_f32_32x32x16_bf16 v[8:23], a[48:51], v[104:107], v[8:23]
    ds_read_b128 v[116:119], v5 offset:15360
    v_mfma_f32_32x32x16_bf16 v[24:39], a[112:115], v[104:107], v[24:39]
    s_waitcnt lgkmcnt(2)
    s_waitcnt vmcnt(4)
    v_mfma_f32_32x32x16_bf16 v[8:23], a[52:55], v[108:111], v[8:23]
    ds_read_b128 v[104:107], v5 offset:16384
    v_mfma_f32_32x32x16_bf16 v[24:39], a[116:119], v[108:111], v[24:39]
    s_waitcnt lgkmcnt(2)
    s_waitcnt vmcnt(2)
    v_mfma_f32_32x32x16_bf16 v[8:23], a[56:59], v[112:115], v[8:23]
    ds_read_b128 v[108:111], v5 offset:17408
    v_mfma_f32_32x32x16_bf16 v[24:39], a[120:123], v[112:115], v[24:39]
    s_waitcnt lgkmcnt(2)
    s_waitcnt vmcnt(0)
    v_mfma_f32_32x32x16_bf16 v[8:23], a[60:63], v[116:119], v[8:23]
    ds_read_b128 v[112:115], v5 offset:18432
    v_mfma_f32_32x32x16_bf16 v[24:39], a[124:127], v[116:119], v[24:39]
    s_barrier
    s_waitcnt lgkmcnt(2)
    v_mfma_f32_32x32x16_bf16 v[40:55], a[0:3], v[104:107], v[72:87]
    ds_read_b128 v[116:119], v5 offset:19456
    v_mfma_f32_32x32x16_bf16 v[56:71], a[64:67], v[104:107], v[88:103]
    s_waitcnt lgkmcnt(2)
    v_mfma_f32_32x32x16_bf16 v[40:55], a[4:7], v[108:111], v[40:55]
    ds_read_b128 v[104:107], v5 offset:20480
    v_mfma_f32_32x32x16_bf16 v[56:71], a[68:71], v[108:111], v[56:71]
    s_waitcnt lgkmcnt(2)
    v_mfma_f32_32x32x16_bf16 v[40:55], a[8:11], v[112:115], v[40:55]
    ds_read_b128 v[108:111], v5 offset:21504
    v_cvt_pk_bf16_f32 v120, v8, v9
    v_mfma_f32_32x32x16_bf16 v[56:71], a[72:75], v[112:115], v[56:71]
    v_cvt_pk_bf16_f32 v121, v10, v11
    s_waitcnt lgkmcnt(2)
    v_mfma_f32_32x32x16_bf16 v[40:55], a[12:15], v[116:119], v[40:55]
    ds_read_b128 v[112:115], v5 offset:22528
    v_cvt_pk_bf16_f32 v122, v12, v13
    v_mfma_f32_32x32x16_bf16 v[56:71], a[76:79], v[116:119], v[56:71]
    v_cvt_pk_bf16_f32 v123, v14, v15
    s_waitcnt lgkmcnt(2)
    v_mfma_f32_32x32x16_bf16 v[40:55], a[16:19], v[104:107], v[40:55]
    ds_read_b128 v[116:119], v5 offset:23552
    ds_write_b128 v6, v[120:123] offset:0
    v_mfma_f32_32x32x16_bf16 v[56:71], a[80:83], v[104:107], v[56:71]
    v_cvt_pk_bf16_f32 v124, v16, v17
    s_waitcnt lgkmcnt(3)
    v_mfma_f32_32x32x16_bf16 v[40:55], a[20:23], v[108:111], v[40:55]
    ds_read_b128 v[104:107], v5 offset:24576
    v_cvt_pk_bf16_f32 v125, v18, v19
    v_mfma_f32_32x32x16_bf16 v[56:71], a[84:87], v[108:111], v[56:71]
    v_cvt_pk_bf16_f32 v126, v20, v21
    s_waitcnt lgkmcnt(3)
    v_mfma_f32_32x32x16_bf16 v[40:55], a[24:27], v[112:115], v[40:55]
    ds_read_b128 v[108:111], v5 offset:25600
    v_cvt_pk_bf16_f32 v127, v22, v23
    v_mfma_f32_32x32x16_bf16 v[56:71], a[88:91], v[112:115], v[56:71]
    ds_write_b128 v6, v[124:127] offset:32
    s_waitcnt lgkmcnt(4)
    v_mfma_f32_32x32x16_bf16 v[40:55], a[28:31], v[116:119], v[40:55]
    ds_read_b128 v[112:115], v5 offset:26624
    v_cvt_pk_bf16_f32 v120, v24, v25
    v_mfma_f32_32x32x16_bf16 v[56:71], a[92:95], v[116:119], v[56:71]
    v_cvt_pk_bf16_f32 v121, v26, v27
    s_waitcnt lgkmcnt(3)
    v_mfma_f32_32x32x16_bf16 v[40:55], a[32:35], v[104:107], v[40:55]
    ds_read_b128 v[116:119], v5 offset:27648
    v_cvt_pk_bf16_f32 v122, v28, v29
    v_mfma_f32_32x32x16_bf16 v[56:71], a[96:99], v[104:107], v[56:71]
    v_cvt_pk_bf16_f32 v123, v30, v31
    s_waitcnt lgkmcnt(3)
    v_mfma_f32_32x32x16_bf16 v[40:55], a[36:39], v[108:111], v[40:55]
    ds_read_b128 v[104:107], v5 offset:28672
    ds_write_b128 v6, v[120:123] offset:64
    v_mfma_f32_32x32x16_bf16 v[56:71], a[100:103], v[108:111], v[56:71]
    v_cvt_pk_bf16_f32 v124, v32, v33
    s_waitcnt lgkmcnt(3)
    v_mfma_f32_32x32x16_bf16 v[40:55], a[40:43], v[112:115], v[40:55]
    ds_read_b128 v[108:111], v5 offset:29696
    v_cvt_pk_bf16_f32 v125, v34, v35
    v_mfma_f32_32x32x16_bf16 v[56:71], a[104:107], v[112:115], v[56:71]
    v_cvt_pk_bf16_f32 v126, v36, v37
    s_waitcnt lgkmcnt(3)
    v_mfma_f32_32x32x16_bf16 v[40:55], a[44:47], v[116:119], v[40:55]
    ds_read_b128 v[112:115], v5 offset:30720
    v_cvt_pk_bf16_f32 v127, v38, v39
    v_mfma_f32_32x32x16_bf16 v[56:71], a[108:111], v[116:119], v[56:71]
    ds_write_b128 v6, v[124:127] offset:96
    s_waitcnt lgkmcnt(4)
    v_mfma_f32_32x32x16_bf16 v[40:55], a[48:51], v[104:107], v[40:55]
    ds_read_b128 v[116:119], v5 offset:31744
    v_mfma_f32_32x32x16_bf16 v[56:71], a[112:115], v[104:107], v[56:71]
    s_waitcnt lgkmcnt(3)
    v_mfma_f32_32x32x16_bf16 v[40:55], a[52:55], v[108:111], v[40:55]
    ds_read_b128 v[104:107], v5 offset:32768
    v_mfma_f32_32x32x16_bf16 v[56:71], a[116:119], v[108:111], v[56:71]
    s_waitcnt lgkmcnt(3)
    v_mfma_f32_32x32x16_bf16 v[40:55], a[56:59], v[112:115], v[40:55]
    ds_read_b128 v[108:111], v5 offset:33792
    v_mfma_f32_32x32x16_bf16 v[56:71], a[120:123], v[112:115], v[56:71]
    s_waitcnt lgkmcnt(2)
    v_mfma_f32_32x32x16_bf16 v[40:55], a[60:63], v[116:119], v[40:55]
    ds_read_b128 v[112:115], v5 offset:34816
    v_mfma_f32_32x32x16_bf16 v[56:71], a[124:127], v[116:119], v[56:71]
    s_barrier
    s_waitcnt lgkmcnt(2)
    v_mfma_f32_32x32x16_bf16 v[8:23], a[0:3], v[104:107], v[72:87]
    ds_read_b128 v[116:119], v5 offset:35840
    v_mfma_f32_32x32x16_bf16 v[24:39], a[64:67], v[104:107], v[88:103]
    s_waitcnt lgkmcnt(2)
    v_mfma_f32_32x32x16_bf16 v[8:23], a[4:7], v[108:111], v[8:23]
    ds_read_b128 v[104:107], v5 offset:36864
    v_mfma_f32_32x32x16_bf16 v[24:39], a[68:71], v[108:111], v[24:39]
    s_waitcnt lgkmcnt(2)
    v_mfma_f32_32x32x16_bf16 v[8:23], a[8:11], v[112:115], v[8:23]
    ds_read_b128 v[108:111], v5 offset:37888
    v_cvt_pk_bf16_f32 v120, v40, v41
    v_mfma_f32_32x32x16_bf16 v[24:39], a[72:75], v[112:115], v[24:39]
    v_cvt_pk_bf16_f32 v121, v42, v43
    s_waitcnt lgkmcnt(2)
    v_mfma_f32_32x32x16_bf16 v[8:23], a[12:15], v[116:119], v[8:23]
    ds_read_b128 v[112:115], v5 offset:38912
    v_cvt_pk_bf16_f32 v122, v44, v45
    v_mfma_f32_32x32x16_bf16 v[24:39], a[76:79], v[116:119], v[24:39]
    v_cvt_pk_bf16_f32 v123, v46, v47
    s_waitcnt lgkmcnt(2)
    v_mfma_f32_32x32x16_bf16 v[8:23], a[16:19], v[104:107], v[8:23]
    ds_read_b128 v[116:119], v5 offset:39936
    ds_write_b128 v6, v[120:123] offset:16896
    v_mfma_f32_32x32x16_bf16 v[24:39], a[80:83], v[104:107], v[24:39]
    v_cvt_pk_bf16_f32 v124, v48, v49
    s_waitcnt lgkmcnt(3)
    v_mfma_f32_32x32x16_bf16 v[8:23], a[20:23], v[108:111], v[8:23]
    ds_read_b128 v[104:107], v5 offset:40960
    v_cvt_pk_bf16_f32 v125, v50, v51
    v_mfma_f32_32x32x16_bf16 v[24:39], a[84:87], v[108:111], v[24:39]
    v_cvt_pk_bf16_f32 v126, v52, v53
    s_waitcnt lgkmcnt(3)
    v_mfma_f32_32x32x16_bf16 v[8:23], a[24:27], v[112:115], v[8:23]
    ds_read_b128 v[108:111], v5 offset:41984
    v_cvt_pk_bf16_f32 v127, v54, v55
    v_mfma_f32_32x32x16_bf16 v[24:39], a[88:91], v[112:115], v[24:39]
    ds_write_b128 v6, v[124:127] offset:16928
    s_waitcnt lgkmcnt(4)
    v_mfma_f32_32x32x16_bf16 v[8:23], a[28:31], v[116:119], v[8:23]
    ds_read_b128 v[112:115], v5 offset:43008
    v_cvt_pk_bf16_f32 v120, v56, v57
    v_mfma_f32_32x32x16_bf16 v[24:39], a[92:95], v[116:119], v[24:39]
    v_cvt_pk_bf16_f32 v121, v58, v59
    s_waitcnt lgkmcnt(3)
    v_mfma_f32_32x32x16_bf16 v[8:23], a[32:35], v[104:107], v[8:23]
    ds_read_b128 v[116:119], v5 offset:44032
    v_cvt_pk_bf16_f32 v122, v60, v61
    v_mfma_f32_32x32x16_bf16 v[24:39], a[96:99], v[104:107], v[24:39]
    v_cvt_pk_bf16_f32 v123, v62, v63
    s_waitcnt lgkmcnt(3)
    v_mfma_f32_32x32x16_bf16 v[8:23], a[36:39], v[108:111], v[8:23]
    ds_read_b128 v[104:107], v5 offset:45056
    ds_write_b128 v6, v[120:123] offset:16960
    v_mfma_f32_32x32x16_bf16 v[24:39], a[100:103], v[108:111], v[24:39]
    v_cvt_pk_bf16_f32 v124, v64, v65
    s_waitcnt lgkmcnt(3)
    v_mfma_f32_32x32x16_bf16 v[8:23], a[40:43], v[112:115], v[8:23]
    ds_read_b128 v[108:111], v5 offset:46080
    v_cvt_pk_bf16_f32 v125, v66, v67
    v_mfma_f32_32x32x16_bf16 v[24:39], a[104:107], v[112:115], v[24:39]
    v_cvt_pk_bf16_f32 v126, v68, v69
    s_waitcnt lgkmcnt(3)
    v_mfma_f32_32x32x16_bf16 v[8:23], a[44:47], v[116:119], v[8:23]
    ds_read_b128 v[112:115], v5 offset:47104
    v_cvt_pk_bf16_f32 v127, v70, v71
    v_mfma_f32_32x32x16_bf16 v[24:39], a[108:111], v[116:119], v[24:39]
    ds_write_b128 v6, v[124:127] offset:16992
    s_waitcnt lgkmcnt(4)
    v_mfma_f32_32x32x16_bf16 v[8:23], a[48:51], v[104:107], v[8:23]
    ds_read_b128 v[116:119], v5 offset:48128
    v_mfma_f32_32x32x16_bf16 v[24:39], a[112:115], v[104:107], v[24:39]
    s_waitcnt lgkmcnt(3)
    v_mfma_f32_32x32x16_bf16 v[8:23], a[52:55], v[108:111], v[8:23]
    ds_read_b128 v[104:107], v5 offset:0
    v_mfma_f32_32x32x16_bf16 v[24:39], a[116:119], v[108:111], v[24:39]
    s_waitcnt lgkmcnt(3)
    v_mfma_f32_32x32x16_bf16 v[8:23], a[56:59], v[112:115], v[8:23]
    ds_read_b128 v[108:111], v5 offset:1024
    v_mfma_f32_32x32x16_bf16 v[24:39], a[120:123], v[112:115], v[24:39]
    s_waitcnt lgkmcnt(2)
    v_mfma_f32_32x32x16_bf16 v[8:23], a[60:63], v[116:119], v[8:23]
    ds_read_b128 v[112:115], v5 offset:2048
    v_mfma_f32_32x32x16_bf16 v[24:39], a[124:127], v[116:119], v[24:39]
    s_barrier
    s_waitcnt lgkmcnt(2)
    v_mfma_f32_32x32x16_bf16 v[40:55], a[0:3], v[104:107], v[72:87]
    ds_read_b128 v[116:119], v5 offset:3072
    v_mfma_f32_32x32x16_bf16 v[56:71], a[64:67], v[104:107], v[88:103]
    s_waitcnt lgkmcnt(2)
    v_mfma_f32_32x32x16_bf16 v[40:55], a[4:7], v[108:111], v[40:55]
    ds_read_b128 v[104:107], v5 offset:4096
    v_mfma_f32_32x32x16_bf16 v[56:71], a[68:71], v[108:111], v[56:71]
    s_waitcnt lgkmcnt(2)
    v_mfma_f32_32x32x16_bf16 v[40:55], a[8:11], v[112:115], v[40:55]
    ds_read_b128 v[108:111], v5 offset:5120
    v_cvt_pk_bf16_f32 v120, v8, v9
    v_mfma_f32_32x32x16_bf16 v[56:71], a[72:75], v[112:115], v[56:71]
    v_cvt_pk_bf16_f32 v121, v10, v11
    s_waitcnt lgkmcnt(2)
    v_mfma_f32_32x32x16_bf16 v[40:55], a[12:15], v[116:119], v[40:55]
    ds_read_b128 v[112:115], v5 offset:6144
    v_cvt_pk_bf16_f32 v122, v12, v13
    v_mfma_f32_32x32x16_bf16 v[56:71], a[76:79], v[116:119], v[56:71]
    v_cvt_pk_bf16_f32 v123, v14, v15
    s_waitcnt lgkmcnt(2)
    v_mfma_f32_32x32x16_bf16 v[40:55], a[16:19], v[104:107], v[40:55]
    ds_read_b128 v[116:119], v5 offset:7168
    ds_write_b128 v6, v[120:123] offset:0
    v_mfma_f32_32x32x16_bf16 v[56:71], a[80:83], v[104:107], v[56:71]
    v_cvt_pk_bf16_f32 v124, v16, v17
    s_waitcnt lgkmcnt(3)
    v_mfma_f32_32x32x16_bf16 v[40:55], a[20:23], v[108:111], v[40:55]
    ds_read_b128 v[104:107], v5 offset:8192
    v_cvt_pk_bf16_f32 v125, v18, v19
    v_mfma_f32_32x32x16_bf16 v[56:71], a[84:87], v[108:111], v[56:71]
    v_cvt_pk_bf16_f32 v126, v20, v21
    s_waitcnt lgkmcnt(3)
    v_mfma_f32_32x32x16_bf16 v[40:55], a[24:27], v[112:115], v[40:55]
    ds_read_b128 v[108:111], v5 offset:9216
    v_cvt_pk_bf16_f32 v127, v22, v23
    v_mfma_f32_32x32x16_bf16 v[56:71], a[88:91], v[112:115], v[56:71]
    ds_write_b128 v6, v[124:127] offset:32
    s_waitcnt lgkmcnt(4)
    v_mfma_f32_32x32x16_bf16 v[40:55], a[28:31], v[116:119], v[40:55]
    ds_read_b128 v[112:115], v5 offset:10240
    v_cvt_pk_bf16_f32 v120, v24, v25
    v_mfma_f32_32x32x16_bf16 v[56:71], a[92:95], v[116:119], v[56:71]
    v_cvt_pk_bf16_f32 v121, v26, v27
    s_waitcnt lgkmcnt(3)
    v_mfma_f32_32x32x16_bf16 v[40:55], a[32:35], v[104:107], v[40:55]
    ds_read_b128 v[116:119], v5 offset:11264
    v_cvt_pk_bf16_f32 v122, v28, v29
    v_mfma_f32_32x32x16_bf16 v[56:71], a[96:99], v[104:107], v[56:71]
    v_cvt_pk_bf16_f32 v123, v30, v31
    s_waitcnt lgkmcnt(3)
    v_mfma_f32_32x32x16_bf16 v[40:55], a[36:39], v[108:111], v[40:55]
    ds_read_b128 v[104:107], v5 offset:12288
    ds_write_b128 v6, v[120:123] offset:64
    v_mfma_f32_32x32x16_bf16 v[56:71], a[100:103], v[108:111], v[56:71]
    v_cvt_pk_bf16_f32 v124, v32, v33
    s_waitcnt lgkmcnt(3)
    v_mfma_f32_32x32x16_bf16 v[40:55], a[40:43], v[112:115], v[40:55]
    ds_read_b128 v[108:111], v5 offset:13312
    v_cvt_pk_bf16_f32 v125, v34, v35
    v_mfma_f32_32x32x16_bf16 v[56:71], a[104:107], v[112:115], v[56:71]
    v_cvt_pk_bf16_f32 v126, v36, v37
    s_waitcnt lgkmcnt(3)
    v_mfma_f32_32x32x16_bf16 v[40:55], a[44:47], v[116:119], v[40:55]
    ds_read_b128 v[112:115], v5 offset:14336
    v_cvt_pk_bf16_f32 v127, v38, v39
    v_mfma_f32_32x32x16_bf16 v[56:71], a[108:111], v[116:119], v[56:71]
    ds_write_b128 v6, v[124:127] offset:96
    s_waitcnt lgkmcnt(4)
    v_mfma_f32_32x32x16_bf16 v[40:55], a[48:51], v[104:107], v[40:55]
    ds_read_b128 v[116:119], v5 offset:15360
    v_mfma_f32_32x32x16_bf16 v[56:71], a[112:115], v[104:107], v[56:71]
    s_waitcnt lgkmcnt(3)
    v_mfma_f32_32x32x16_bf16 v[40:55], a[52:55], v[108:111], v[40:55]
    ds_read_b128 v[104:107], v5 offset:16384
    v_mfma_f32_32x32x16_bf16 v[56:71], a[116:119], v[108:111], v[56:71]
    s_waitcnt lgkmcnt(3)
    v_mfma_f32_32x32x16_bf16 v[40:55], a[56:59], v[112:115], v[40:55]
    ds_read_b128 v[108:111], v5 offset:17408
    v_mfma_f32_32x32x16_bf16 v[56:71], a[120:123], v[112:115], v[56:71]
    s_waitcnt lgkmcnt(2)
    v_mfma_f32_32x32x16_bf16 v[40:55], a[60:63], v[116:119], v[40:55]
    ds_read_b128 v[112:115], v5 offset:18432
    v_mfma_f32_32x32x16_bf16 v[56:71], a[124:127], v[116:119], v[56:71]
    s_barrier
    s_waitcnt lgkmcnt(2)
    v_mfma_f32_32x32x16_bf16 v[8:23], a[0:3], v[104:107], v[72:87]
    ds_read_b128 v[116:119], v5 offset:19456
    v_mfma_f32_32x32x16_bf16 v[24:39], a[64:67], v[104:107], v[88:103]
    s_waitcnt lgkmcnt(2)
    v_mfma_f32_32x32x16_bf16 v[8:23], a[4:7], v[108:111], v[8:23]
    ds_read_b128 v[104:107], v5 offset:20480
    v_mfma_f32_32x32x16_bf16 v[24:39], a[68:71], v[108:111], v[24:39]
    s_waitcnt lgkmcnt(2)
    v_mfma_f32_32x32x16_bf16 v[8:23], a[8:11], v[112:115], v[8:23]
    ds_read_b128 v[108:111], v5 offset:21504
    v_cvt_pk_bf16_f32 v120, v40, v41
    v_mfma_f32_32x32x16_bf16 v[24:39], a[72:75], v[112:115], v[24:39]
    v_cvt_pk_bf16_f32 v121, v42, v43
    s_waitcnt lgkmcnt(2)
    v_mfma_f32_32x32x16_bf16 v[8:23], a[12:15], v[116:119], v[8:23]
    ds_read_b128 v[112:115], v5 offset:22528
    v_cvt_pk_bf16_f32 v122, v44, v45
    v_mfma_f32_32x32x16_bf16 v[24:39], a[76:79], v[116:119], v[24:39]
    v_cvt_pk_bf16_f32 v123, v46, v47
    s_waitcnt lgkmcnt(2)
    v_mfma_f32_32x32x16_bf16 v[8:23], a[16:19], v[104:107], v[8:23]
    ds_read_b128 v[116:119], v5 offset:23552
    ds_write_b128 v6, v[120:123] offset:16896
    v_mfma_f32_32x32x16_bf16 v[24:39], a[80:83], v[104:107], v[24:39]
    v_cvt_pk_bf16_f32 v124, v48, v49
    s_waitcnt lgkmcnt(3)
    v_mfma_f32_32x32x16_bf16 v[8:23], a[20:23], v[108:111], v[8:23]
    ds_read_b128 v[104:107], v5 offset:24576
    v_cvt_pk_bf16_f32 v125, v50, v51
    v_mfma_f32_32x32x16_bf16 v[24:39], a[84:87], v[108:111], v[24:39]
    v_cvt_pk_bf16_f32 v126, v52, v53
    s_waitcnt lgkmcnt(3)
    v_mfma_f32_32x32x16_bf16 v[8:23], a[24:27], v[112:115], v[8:23]
    ds_read_b128 v[108:111], v5 offset:25600
    v_cvt_pk_bf16_f32 v127, v54, v55
    v_mfma_f32_32x32x16_bf16 v[24:39], a[88:91], v[112:115], v[24:39]
    ds_write_b128 v6, v[124:127] offset:16928
    s_waitcnt lgkmcnt(4)
    v_mfma_f32_32x32x16_bf16 v[8:23], a[28:31], v[116:119], v[8:23]
    ds_read_b128 v[112:115], v5 offset:26624
    v_cvt_pk_bf16_f32 v120, v56, v57
    v_mfma_f32_32x32x16_bf16 v[24:39], a[92:95], v[116:119], v[24:39]
    v_cvt_pk_bf16_f32 v121, v58, v59
    s_waitcnt lgkmcnt(3)
    v_mfma_f32_32x32x16_bf16 v[8:23], a[32:35], v[104:107], v[8:23]
    ds_read_b128 v[116:119], v5 offset:27648
    v_cvt_pk_bf16_f32 v122, v60, v61
    v_mfma_f32_32x32x16_bf16 v[24:39], a[96:99], v[104:107], v[24:39]
    v_cvt_pk_bf16_f32 v123, v62, v63
    s_waitcnt lgkmcnt(3)
    v_mfma_f32_32x32x16_bf16 v[8:23], a[36:39], v[108:111], v[8:23]
    ds_read_b128 v[104:107], v5 offset:28672
    ds_write_b128 v6, v[120:123] offset:16960
    v_mfma_f32_32x32x16_bf16 v[24:39], a[100:103], v[108:111], v[24:39]
    v_cvt_pk_bf16_f32 v124, v64, v65
    s_waitcnt lgkmcnt(3)
    v_mfma_f32_32x32x16_bf16 v[8:23], a[40:43], v[112:115], v[8:23]
    ds_read_b128 v[108:111], v5 offset:29696
    v_cvt_pk_bf16_f32 v125, v66, v67
    v_mfma_f32_32x32x16_bf16 v[24:39], a[104:107], v[112:115], v[24:39]
    v_cvt_pk_bf16_f32 v126, v68, v69
    s_waitcnt lgkmcnt(3)
    v_mfma_f32_32x32x16_bf16 v[8:23], a[44:47], v[116:119], v[8:23]
    ds_read_b128 v[112:115], v5 offset:30720
    v_cvt_pk_bf16_f32 v127, v70, v71
    v_mfma_f32_32x32x16_bf16 v[24:39], a[108:111], v[116:119], v[24:39]
    ds_write_b128 v6, v[124:127] offset:16992
    s_waitcnt lgkmcnt(4)
    v_mfma_f32_32x32x16_bf16 v[8:23], a[48:51], v[104:107], v[8:23]
    ds_read_b128 v[116:119], v5 offset:31744
    v_mfma_f32_32x32x16_bf16 v[24:39], a[112:115], v[104:107], v[24:39]
    s_waitcnt lgkmcnt(3)
    v_mfma_f32_32x32x16_bf16 v[8:23], a[52:55], v[108:111], v[8:23]
    ds_read_b128 v[104:107], v5 offset:32768
    v_mfma_f32_32x32x16_bf16 v[24:39], a[116:119], v[108:111], v[24:39]
    s_waitcnt lgkmcnt(3)
    v_mfma_f32_32x32x16_bf16 v[8:23], a[56:59], v[112:115], v[8:23]
    ds_read_b128 v[108:111], v5 offset:33792
    v_mfma_f32_32x32x16_bf16 v[24:39], a[120:123], v[112:115], v[24:39]
    s_waitcnt lgkmcnt(2)
    v_mfma_f32_32x32x16_bf16 v[8:23], a[60:63], v[116:119], v[8:23]
    ds_read_b128 v[112:115], v5 offset:34816
    v_mfma_f32_32x32x16_bf16 v[24:39], a[124:127], v[116:119], v[24:39]
    s_barrier
    s_waitcnt lgkmcnt(2)
    v_mfma_f32_32x32x16_bf16 v[40:55], a[0:3], v[104:107], v[72:87]
    ds_read_b128 v[116:119], v5 offset:35840
    v_mfma_f32_32x32x16_bf16 v[56:71], a[64:67], v[104:107], v[88:103]
    s_waitcnt lgkmcnt(2)
    v_mfma_f32_32x32x16_bf16 v[40:55], a[4:7], v[108:111], v[40:55]
    ds_read_b128 v[104:107], v5 offset:36864
    v_mfma_f32_32x32x16_bf16 v[56:71], a[68:71], v[108:111], v[56:71]
    s_waitcnt lgkmcnt(2)
    v_mfma_f32_32x32x16_bf16 v[40:55], a[8:11], v[112:115], v[40:55]
    ds_read_b128 v[108:111], v5 offset:37888
    v_cvt_pk_bf16_f32 v120, v8, v9
    v_mfma_f32_32x32x16_bf16 v[56:71], a[72:75], v[112:115], v[56:71]
    v_cvt_pk_bf16_f32 v121, v10, v11
    s_waitcnt lgkmcnt(2)
    v_mfma_f32_32x32x16_bf16 v[40:55], a[12:15], v[116:119], v[40:55]
    ds_read_b128 v[112:115], v5 offset:38912
    v_cvt_pk_bf16_f32 v122, v12, v13
    v_mfma_f32_32x32x16_bf16 v[56:71], a[76:79], v[116:119], v[56:71]
    v_cvt_pk_bf16_f32 v123, v14, v15
    s_waitcnt lgkmcnt(2)
    v_mfma_f32_32x32x16_bf16 v[40:55], a[16:19], v[104:107], v[40:55]
    ds_read_b128 v[116:119], v5 offset:39936
    ds_write_b128 v6, v[120:123] offset:0
    v_mfma_f32_32x32x16_bf16 v[56:71], a[80:83], v[104:107], v[56:71]
    v_cvt_pk_bf16_f32 v124, v16, v17
    s_waitcnt lgkmcnt(3)
    v_mfma_f32_32x32x16_bf16 v[40:55], a[20:23], v[108:111], v[40:55]
    ds_read_b128 v[104:107], v5 offset:40960
    v_cvt_pk_bf16_f32 v125, v18, v19
    v_mfma_f32_32x32x16_bf16 v[56:71], a[84:87], v[108:111], v[56:71]
    v_cvt_pk_bf16_f32 v126, v20, v21
    s_waitcnt lgkmcnt(3)
    v_mfma_f32_32x32x16_bf16 v[40:55], a[24:27], v[112:115], v[40:55]
    ds_read_b128 v[108:111], v5 offset:41984
    v_cvt_pk_bf16_f32 v127, v22, v23
    v_mfma_f32_32x32x16_bf16 v[56:71], a[88:91], v[112:115], v[56:71]
    ds_write_b128 v6, v[124:127] offset:32
    s_waitcnt lgkmcnt(4)
    v_mfma_f32_32x32x16_bf16 v[40:55], a[28:31], v[116:119], v[40:55]
    ds_read_b128 v[112:115], v5 offset:43008
    v_cvt_pk_bf16_f32 v120, v24, v25
    v_mfma_f32_32x32x16_bf16 v[56:71], a[92:95], v[116:119], v[56:71]
    v_cvt_pk_bf16_f32 v121, v26, v27
    s_waitcnt lgkmcnt(3)
    v_mfma_f32_32x32x16_bf16 v[40:55], a[32:35], v[104:107], v[40:55]
    ds_read_b128 v[116:119], v5 offset:44032
    v_cvt_pk_bf16_f32 v122, v28, v29
    v_mfma_f32_32x32x16_bf16 v[56:71], a[96:99], v[104:107], v[56:71]
    v_cvt_pk_bf16_f32 v123, v30, v31
    s_waitcnt lgkmcnt(3)
    v_mfma_f32_32x32x16_bf16 v[40:55], a[36:39], v[108:111], v[40:55]
    ds_read_b128 v[104:107], v5 offset:45056
    ds_write_b128 v6, v[120:123] offset:64
    v_mfma_f32_32x32x16_bf16 v[56:71], a[100:103], v[108:111], v[56:71]
    v_cvt_pk_bf16_f32 v124, v32, v33
    s_waitcnt lgkmcnt(3)
    v_mfma_f32_32x32x16_bf16 v[40:55], a[40:43], v[112:115], v[40:55]
    ds_read_b128 v[108:111], v5 offset:46080
    v_cvt_pk_bf16_f32 v125, v34, v35
    v_mfma_f32_32x32x16_bf16 v[56:71], a[104:107], v[112:115], v[56:71]
    v_cvt_pk_bf16_f32 v126, v36, v37
    s_waitcnt lgkmcnt(3)
    v_mfma_f32_32x32x16_bf16 v[40:55], a[44:47], v[116:119], v[40:55]
    ds_read_b128 v[112:115], v5 offset:47104
    v_cvt_pk_bf16_f32 v127, v38, v39
    v_mfma_f32_32x32x16_bf16 v[56:71], a[108:111], v[116:119], v[56:71]
    ds_write_b128 v6, v[124:127] offset:96
    s_waitcnt lgkmcnt(4)
    v_mfma_f32_32x32x16_bf16 v[40:55], a[48:51], v[104:107], v[40:55]
    ds_read_b128 v[116:119], v5 offset:48128
    v_mfma_f32_32x32x16_bf16 v[56:71], a[112:115], v[104:107], v[56:71]
    s_waitcnt lgkmcnt(3)
    v_mfma_f32_32x32x16_bf16 v[40:55], a[52:55], v[108:111], v[40:55]
    ds_read_b128 v[104:107], v5 offset:0
    v_mfma_f32_32x32x16_bf16 v[56:71], a[116:119], v[108:111], v[56:71]
    s_waitcnt lgkmcnt(3)
    v_mfma_f32_32x32x16_bf16 v[40:55], a[56:59], v[112:115], v[40:55]
    ds_read_b128 v[108:111], v5 offset:1024
    v_mfma_f32_32x32x16_bf16 v[56:71], a[120:123], v[112:115], v[56:71]
    s_waitcnt lgkmcnt(2)
    v_mfma_f32_32x32x16_bf16 v[40:55], a[60:63], v[116:119], v[40:55]
    ds_read_b128 v[112:115], v5 offset:2048
    v_mfma_f32_32x32x16_bf16 v[56:71], a[124:127], v[116:119], v[56:71]
    s_barrier
    s_waitcnt lgkmcnt(2)
    v_mfma_f32_32x32x16_bf16 v[8:23], a[0:3], v[104:107], v[72:87]
    ds_read_b128 v[116:119], v5 offset:3072
    v_mfma_f32_32x32x16_bf16 v[24:39], a[64:67], v[104:107], v[88:103]
    s_waitcnt lgkmcnt(2)
    v_mfma_f32_32x32x16_bf16 v[8:23], a[4:7], v[108:111], v[8:23]
    ds_read_b128 v[104:107], v5 offset:4096
    v_mfma_f32_32x32x16_bf16 v[24:39], a[68:71], v[108:111], v[24:39]
    s_waitcnt lgkmcnt(2)
    v_mfma_f32_32x32x16_bf16 v[8:23], a[8:11], v[112:115], v[8:23]
    ds_read_b128 v[108:111], v5 offset:5120
    v_cvt_pk_bf16_f32 v120, v40, v41
    v_mfma_f32_32x32x16_bf16 v[24:39], a[72:75], v[112:115], v[24:39]
    v_cvt_pk_bf16_f32 v121, v42, v43
    s_waitcnt lgkmcnt(2)
    v_mfma_f32_32x32x16_bf16 v[8:23], a[12:15], v[116:119], v[8:23]
    ds_read_b128 v[112:115], v5 offset:6144
    v_cvt_pk_bf16_f32 v122, v44, v45
    v_mfma_f32_32x32x16_bf16 v[24:39], a[76:79], v[116:119], v[24:39]
    v_cvt_pk_bf16_f32 v123, v46, v47
    s_waitcnt lgkmcnt(2)
    v_mfma_f32_32x32x16_bf16 v[8:23], a[16:19], v[104:107], v[8:23]
    ds_read_b128 v[116:119], v5 offset:7168
    ds_write_b128 v6, v[120:123] offset:16896
    v_mfma_f32_32x32x16_bf16 v[24:39], a[80:83], v[104:107], v[24:39]
    v_cvt_pk_bf16_f32 v124, v48, v49
    s_waitcnt lgkmcnt(3)
    v_mfma_f32_32x32x16_bf16 v[8:23], a[20:23], v[108:111], v[8:23]
    ds_read_b128 v[104:107], v5 offset:8192
    v_cvt_pk_bf16_f32 v125, v50, v51
    v_mfma_f32_32x32x16_bf16 v[24:39], a[84:87], v[108:111], v[24:39]
    v_cvt_pk_bf16_f32 v126, v52, v53
    s_waitcnt lgkmcnt(3)
    v_mfma_f32_32x32x16_bf16 v[8:23], a[24:27], v[112:115], v[8:23]
    ds_read_b128 v[108:111], v5 offset:9216
    v_cvt_pk_bf16_f32 v127, v54, v55
    v_mfma_f32_32x32x16_bf16 v[24:39], a[88:91], v[112:115], v[24:39]
    ds_write_b128 v6, v[124:127] offset:16928
    s_waitcnt lgkmcnt(4)
    v_mfma_f32_32x32x16_bf16 v[8:23], a[28:31], v[116:119], v[8:23]
    ds_read_b128 v[112:115], v5 offset:10240
    v_cvt_pk_bf16_f32 v120, v56, v57
    v_mfma_f32_32x32x16_bf16 v[24:39], a[92:95], v[116:119], v[24:39]
    v_cvt_pk_bf16_f32 v121, v58, v59
    s_waitcnt lgkmcnt(3)
    v_mfma_f32_32x32x16_bf16 v[8:23], a[32:35], v[104:107], v[8:23]
    ds_read_b128 v[116:119], v5 offset:11264
    v_cvt_pk_bf16_f32 v122, v60, v61
    v_mfma_f32_32x32x16_bf16 v[24:39], a[96:99], v[104:107], v[24:39]
    v_cvt_pk_bf16_f32 v123, v62, v63
    s_waitcnt lgkmcnt(3)
    v_mfma_f32_32x32x16_bf16 v[8:23], a[36:39], v[108:111], v[8:23]
    ds_read_b128 v[104:107], v5 offset:12288
    ds_write_b128 v6, v[120:123] offset:16960
    v_mfma_f32_32x32x16_bf16 v[24:39], a[100:103], v[108:111], v[24:39]
    v_cvt_pk_bf16_f32 v124, v64, v65
    s_waitcnt lgkmcnt(3)
    v_mfma_f32_32x32x16_bf16 v[8:23], a[40:43], v[112:115], v[8:23]
    ds_read_b128 v[108:111], v5 offset:13312
    v_cvt_pk_bf16_f32 v125, v66, v67
    v_mfma_f32_32x32x16_bf16 v[24:39], a[104:107], v[112:115], v[24:39]
    v_cvt_pk_bf16_f32 v126, v68, v69
    s_waitcnt lgkmcnt(3)
    v_mfma_f32_32x32x16_bf16 v[8:23], a[44:47], v[116:119], v[8:23]
    ds_read_b128 v[112:115], v5 offset:14336
    v_cvt_pk_bf16_f32 v127, v70, v71
    v_mfma_f32_32x32x16_bf16 v[24:39], a[108:111], v[116:119], v[24:39]
    ds_write_b128 v6, v[124:127] offset:16992
    s_waitcnt lgkmcnt(4)
    v_mfma_f32_32x32x16_bf16 v[8:23], a[48:51], v[104:107], v[8:23]
    ds_read_b128 v[116:119], v5 offset:15360
    v_mfma_f32_32x32x16_bf16 v[24:39], a[112:115], v[104:107], v[24:39]
    s_waitcnt lgkmcnt(3)
    v_mfma_f32_32x32x16_bf16 v[8:23], a[52:55], v[108:111], v[8:23]
    ds_read_b128 v[104:107], v5 offset:16384
    v_mfma_f32_32x32x16_bf16 v[24:39], a[116:119], v[108:111], v[24:39]
    s_waitcnt lgkmcnt(3)
    v_mfma_f32_32x32x16_bf16 v[8:23], a[56:59], v[112:115], v[8:23]
    ds_read_b128 v[108:111], v5 offset:17408
    v_mfma_f32_32x32x16_bf16 v[24:39], a[120:123], v[112:115], v[24:39]
    s_waitcnt lgkmcnt(2)
    v_mfma_f32_32x32x16_bf16 v[8:23], a[60:63], v[116:119], v[8:23]
    ds_read_b128 v[112:115], v5 offset:18432
    v_mfma_f32_32x32x16_bf16 v[24:39], a[124:127], v[116:119], v[24:39]
    s_barrier
    s_waitcnt lgkmcnt(2)
    v_mfma_f32_32x32x16_bf16 v[40:55], a[0:3], v[104:107], v[72:87]
    ds_read_b128 v[116:119], v5 offset:19456
    v_mfma_f32_32x32x16_bf16 v[56:71], a[64:67], v[104:107], v[88:103]
    s_waitcnt lgkmcnt(2)
    v_mfma_f32_32x32x16_bf16 v[40:55], a[4:7], v[108:111], v[40:55]
    ds_read_b128 v[104:107], v5 offset:20480
    v_mfma_f32_32x32x16_bf16 v[56:71], a[68:71], v[108:111], v[56:71]
    s_waitcnt lgkmcnt(2)
    v_mfma_f32_32x32x16_bf16 v[40:55], a[8:11], v[112:115], v[40:55]
    ds_read_b128 v[108:111], v5 offset:21504
    v_cvt_pk_bf16_f32 v120, v8, v9
    v_mfma_f32_32x32x16_bf16 v[56:71], a[72:75], v[112:115], v[56:71]
    v_cvt_pk_bf16_f32 v121, v10, v11
    s_waitcnt lgkmcnt(2)
    v_mfma_f32_32x32x16_bf16 v[40:55], a[12:15], v[116:119], v[40:55]
    ds_read_b128 v[112:115], v5 offset:22528
    v_cvt_pk_bf16_f32 v122, v12, v13
    v_mfma_f32_32x32x16_bf16 v[56:71], a[76:79], v[116:119], v[56:71]
    v_cvt_pk_bf16_f32 v123, v14, v15
    s_waitcnt lgkmcnt(2)
    v_mfma_f32_32x32x16_bf16 v[40:55], a[16:19], v[104:107], v[40:55]
    ds_read_b128 v[116:119], v5 offset:23552
    ds_write_b128 v6, v[120:123] offset:0
    v_mfma_f32_32x32x16_bf16 v[56:71], a[80:83], v[104:107], v[56:71]
    v_cvt_pk_bf16_f32 v124, v16, v17
    s_waitcnt lgkmcnt(3)
    v_mfma_f32_32x32x16_bf16 v[40:55], a[20:23], v[108:111], v[40:55]
    ds_read_b128 v[104:107], v5 offset:24576
    v_cvt_pk_bf16_f32 v125, v18, v19
    v_mfma_f32_32x32x16_bf16 v[56:71], a[84:87], v[108:111], v[56:71]
    v_cvt_pk_bf16_f32 v126, v20, v21
    s_waitcnt lgkmcnt(3)
    v_mfma_f32_32x32x16_bf16 v[40:55], a[24:27], v[112:115], v[40:55]
    ds_read_b128 v[108:111], v5 offset:25600
    v_cvt_pk_bf16_f32 v127, v22, v23
    v_mfma_f32_32x32x16_bf16 v[56:71], a[88:91], v[112:115], v[56:71]
    ds_write_b128 v6, v[124:127] offset:32
    s_waitcnt lgkmcnt(4)
    v_mfma_f32_32x32x16_bf16 v[40:55], a[28:31], v[116:119], v[40:55]
    ds_read_b128 v[112:115], v5 offset:26624
    v_cvt_pk_bf16_f32 v120, v24, v25
    v_mfma_f32_32x32x16_bf16 v[56:71], a[92:95], v[116:119], v[56:71]
    v_cvt_pk_bf16_f32 v121, v26, v27
    s_waitcnt lgkmcnt(3)
    v_mfma_f32_32x32x16_bf16 v[40:55], a[32:35], v[104:107], v[40:55]
    ds_read_b128 v[116:119], v5 offset:27648
    v_cvt_pk_bf16_f32 v122, v28, v29
    v_mfma_f32_32x32x16_bf16 v[56:71], a[96:99], v[104:107], v[56:71]
    v_cvt_pk_bf16_f32 v123, v30, v31
    s_waitcnt lgkmcnt(3)
    v_mfma_f32_32x32x16_bf16 v[40:55], a[36:39], v[108:111], v[40:55]
    ds_read_b128 v[104:107], v5 offset:28672
    ds_write_b128 v6, v[120:123] offset:64
    v_mfma_f32_32x32x16_bf16 v[56:71], a[100:103], v[108:111], v[56:71]
    v_cvt_pk_bf16_f32 v124, v32, v33
    s_waitcnt lgkmcnt(3)
    v_mfma_f32_32x32x16_bf16 v[40:55], a[40:43], v[112:115], v[40:55]
    ds_read_b128 v[108:111], v5 offset:29696
    v_cvt_pk_bf16_f32 v125, v34, v35
    v_mfma_f32_32x32x16_bf16 v[56:71], a[104:107], v[112:115], v[56:71]
    v_cvt_pk_bf16_f32 v126, v36, v37
    s_waitcnt lgkmcnt(3)
    v_mfma_f32_32x32x16_bf16 v[40:55], a[44:47], v[116:119], v[40:55]
    ds_read_b128 v[112:115], v5 offset:30720
    v_cvt_pk_bf16_f32 v127, v38, v39
    v_mfma_f32_32x32x16_bf16 v[56:71], a[108:111], v[116:119], v[56:71]
    ds_write_b128 v6, v[124:127] offset:96
    s_waitcnt lgkmcnt(4)
    v_mfma_f32_32x32x16_bf16 v[40:55], a[48:51], v[104:107], v[40:55]
    ds_read_b128 v[116:119], v5 offset:31744
    v_mfma_f32_32x32x16_bf16 v[56:71], a[112:115], v[104:107], v[56:71]
    s_waitcnt lgkmcnt(3)
    v_mfma_f32_32x32x16_bf16 v[40:55], a[52:55], v[108:111], v[40:55]
    v_mfma_f32_32x32x16_bf16 v[56:71], a[116:119], v[108:111], v[56:71]
    s_waitcnt lgkmcnt(2)
    v_mfma_f32_32x32x16_bf16 v[40:55], a[56:59], v[112:115], v[40:55]
    v_mfma_f32_32x32x16_bf16 v[56:71], a[120:123], v[112:115], v[56:71]
    s_waitcnt lgkmcnt(0)
    v_mfma_f32_32x32x16_bf16 v[40:55], a[60:63], v[116:119], v[40:55]
    v_mfma_f32_32x32x16_bf16 v[56:71], a[124:127], v[116:119], v[56:71]
    s_barrier
    s_nop 7
    s_nop 7
    v_cvt_pk_bf16_f32 v120, v40, v41
    v_cvt_pk_bf16_f32 v121, v42, v43
    v_cvt_pk_bf16_f32 v122, v44, v45
    v_cvt_pk_bf16_f32 v123, v46, v47
    ds_write_b128 v6, v[120:123] offset:16896
    v_cvt_pk_bf16_f32 v124, v48, v49
    v_cvt_pk_bf16_f32 v125, v50, v51
    v_cvt_pk_bf16_f32 v126, v52, v53
    v_cvt_pk_bf16_f32 v127, v54, v55
    ds_write_b128 v6, v[124:127] offset:16928
    v_cvt_pk_bf16_f32 v120, v56, v57
    v_cvt_pk_bf16_f32 v121, v58, v59
    v_cvt_pk_bf16_f32 v122, v60, v61
    v_cvt_pk_bf16_f32 v123, v62, v63
    ds_write_b128 v6, v[120:123] offset:16960
    v_cvt_pk_bf16_f32 v124, v64, v65
    v_cvt_pk_bf16_f32 v125, v66, v67
    v_cvt_pk_bf16_f32 v126, v68, v69
    v_cvt_pk_bf16_f32 v127, v70, v71
    ds_write_b128 v6, v[124:127] offset:16992
    s_waitcnt lgkmcnt(0)
    s_barrier
    s_endpgm
L_joint_kernel_helper:
    s_barrier
    v_add_u32 v7, 65536, v5
    ds_read_b128 v[64:67], v7 offset:0
    ds_read_b128 v[68:71], v7 offset:1024
    ds_read_b128 v[72:75], v7 offset:2048
    ds_read_b128 v[76:79], v7 offset:3072
    ds_read_b128 v[80:83], v7 offset:4096
    ds_read_b128 v[84:87], v7 offset:5120
    ds_read_b128 v[88:91], v7 offset:6144
    ds_read_b128 v[92:95], v7 offset:7168
    s_waitcnt vmcnt(38) lgkmcnt(7)
    v_mfma_f32_32x32x16_bf16 v[32:47], a[0:3], v[64:67], 0
    v_mfma_f32_32x32x16_bf16 v[48:63], a[64:67], v[64:67], 0
    s_waitcnt vmcnt(36) lgkmcnt(6)
    v_mfma_f32_32x32x16_bf16 v[32:47], a[4:7], v[68:71], v[32:47]
    v_mfma_f32_32x32x16_bf16 v[48:63], a[68:71], v[68:71], v[48:63]
    ds_read_b128 v[64:67], v7 offset:8192
    s_waitcnt vmcnt(34) lgkmcnt(6)
    v_mfma_f32_32x32x16_bf16 v[32:47], a[8:11], v[72:75], v[32:47]
    v_mfma_f32_32x32x16_bf16 v[48:63], a[72:75], v[72:75], v[48:63]
    ds_read_b128 v[68:71], v7 offset:9216
    s_waitcnt vmcnt(32) lgkmcnt(6)
    v_mfma_f32_32x32x16_bf16 v[32:47], a[12:15], v[76:79], v[32:47]
    v_mfma_f32_32x32x16_bf16 v[48:63], a[76:79], v[76:79], v[48:63]
    ds_read_b128 v[72:75], v7 offset:10240
    s_waitcnt vmcnt(30) lgkmcnt(6)
    v_mfma_f32_32x32x16_bf16 v[32:47], a[16:19], v[80:83], v[32:47]
    v_mfma_f32_32x32x16_bf16 v[48:63], a[80:83], v[80:83], v[48:63]
    ds_read_b128 v[76:79], v7 offset:11264
    s_waitcnt vmcnt(28) lgkmcnt(6)
    v_mfma_f32_32x32x16_bf16 v[32:47], a[20:23], v[84:87], v[32:47]
    v_mfma_f32_32x32x16_bf16 v[48:63], a[84:87], v[84:87], v[48:63]
    ds_read_b128 v[80:83], v7 offset:12288
    s_waitcnt vmcnt(26) lgkmcnt(6)
    v_mfma_f32_32x32x16_bf16 v[32:47], a[24:27], v[88:91], v[32:47]
    v_mfma_f32_32x32x16_bf16 v[48:63], a[88:91], v[88:91], v[48:63]
    ds_read_b128 v[84:87], v7 offset:13312
    s_waitcnt vmcnt(24) lgkmcnt(6)
    v_mfma_f32_32x32x16_bf16 v[32:47], a[28:31], v[92:95], v[32:47]
    v_mfma_f32_32x32x16_bf16 v[48:63], a[92:95], v[92:95], v[48:63]
    ds_read_b128 v[88:91], v7 offset:14336
    s_waitcnt vmcnt(22) lgkmcnt(6)
    v_mfma_f32_32x32x16_bf16 v[32:47], a[32:35], v[64:67], v[32:47]
    v_mfma_f32_32x32x16_bf16 v[48:63], a[96:99], v[64:67], v[48:63]
    ds_read_b128 v[92:95], v7 offset:15360
    s_waitcnt vmcnt(20) lgkmcnt(6)
    v_mfma_f32_32x32x16_bf16 v[32:47], a[36:39], v[68:71], v[32:47]
    v_mfma_f32_32x32x16_bf16 v[48:63], a[100:103], v[68:71], v[48:63]
    s_waitcnt vmcnt(0)
    v_max3_f32 v8, |v96|, |v97|, |v98|
    v_max3_f32 v8, v8, |v99|, |v100|
    v_max3_f32 v8, v8, |v101|, |v102|
    v_max3_f32 v8, v8, |v103|, |v104|
    v_max3_f32 v8, v8, |v105|, |v106|
    v_max3_f32 v8, v8, |v107|, |v108|
    v_max3_f32 v8, v8, |v109|, |v110|
    v_max3_f32 v8, v8, |v111|, |v112|
    s_waitcnt lgkmcnt(5)
    v_mfma_f32_32x32x16_bf16 v[32:47], a[40:43], v[72:75], v[32:47]
    v_mfma_f32_32x32x16_bf16 v[48:63], a[104:107], v[72:75], v[48:63]
    v_max3_f32 v8, v8, |v113|, |v114|
    v_max3_f32 v8, v8, |v115|, |v116|
    v_max3_f32 v8, v8, |v117|, |v118|
    v_max3_f32 v8, v8, |v119|, |v120|
    v_max3_f32 v8, v8, |v121|, |v122|
    v_max3_f32 v8, v8, |v123|, |v124|
    v_max3_f32 v8, v8, |v125|, |v126|
    v_max_f32 v8, v8, |v127|
    s_waitcnt lgkmcnt(4)
    v_mfma_f32_32x32x16_bf16 v[32:47], a[44:47], v[76:79], v[32:47]
    v_mfma_f32_32x32x16_bf16 v[48:63], a[108:111], v[76:79], v[48:63]
    s_mov_b32 s41, 0x42a80000
    v_cmp_lt_f32 s[42:43], s41, v8
    v_exp_f32 v96, v96
    v_exp_f32 v97, v97
    v_exp_f32 v98, v98
    v_exp_f32 v99, v99
    v_exp_f32 v100, v100
    v_exp_f32 v101, v101
    s_waitcnt lgkmcnt(3)
    v_mfma_f32_32x32x16_bf16 v[32:47], a[48:51], v[80:83], v[32:47]
    v_mfma_f32_32x32x16_bf16 v[48:63], a[112:115], v[80:83], v[48:63]
    v_exp_f32 v102, v102
    v_exp_f32 v103, v103
    v_exp_f32 v104, v104
    v_exp_f32 v105, v105
    v_exp_f32 v106, v106
    v_exp_f32 v107, v107
    v_exp_f32 v108, v108
    v_exp_f32 v109, v109
    s_waitcnt lgkmcnt(2)
    v_mfma_f32_32x32x16_bf16 v[32:47], a[52:55], v[84:87], v[32:47]
    v_mfma_f32_32x32x16_bf16 v[48:63], a[116:119], v[84:87], v[48:63]
    v_exp_f32 v110, v110
    v_exp_f32 v111, v111
    v_exp_f32 v112, v112
    v_exp_f32 v113, v113
    v_exp_f32 v114, v114
    v_exp_f32 v115, v115
    v_exp_f32 v116, v116
    v_exp_f32 v117, v117
    s_waitcnt lgkmcnt(1)
    v_mfma_f32_32x32x16_bf16 v[32:47], a[56:59], v[88:91], v[32:47]
    v_mfma_f32_32x32x16_bf16 v[48:63], a[120:123], v[88:91], v[48:63]
    v_exp_f32 v118, v118
    v_exp_f32 v119, v119
    v_exp_f32 v120, v120
    v_exp_f32 v121, v121
    v_exp_f32 v122, v122
    v_exp_f32 v123, v123
    v_exp_f32 v124, v124
    v_exp_f32 v125, v125
    s_waitcnt lgkmcnt(0)
    v_mfma_f32_32x32x16_bf16 v[32:47], a[60:63], v[92:95], v[32:47]
    v_mfma_f32_32x32x16_bf16 v[48:63], a[124:127], v[92:95], v[48:63]
    v_exp_f32 v126, v126
    v_exp_f32 v127, v127
    s_lshl_b32 s36, s21, 12
    v_add_u32 v2, s36, v5
    v_lshrrev_b32 v10, 5, v1
    v_lshlrev_b32 v11, 4, v10
    s_lshl_b32 s36, s21, 8
    s_add_u32 s36, s36, 81920
    v_add_u32 v11, s36, v11
    v_and_b32 v12, 31, v1
    v_mul_u32_u24 v13, 1056, v12
    v_add_u32 v9, v11, v13
    v_lshrrev_b32 v13, 3, v12
    v_mul_u32_u24 v13, 1056, v13
    v_add_u32 v4, v11, v13
    s_lshl_b32 s36, s21, 3
    v_add_u32 v10, s36, v10
    v_mul_u32_u24 v13, 528, v10
    v_lshl_add_u32 v13, v12, 4, v13
    v_add_u32 v6, 115712, v13
    v_lshlrev_b32 v13, 9, v10
    v_lshl_add_u32 v7, v12, 4, v13
    s_mov_b32 s41, 0x4038aa3b
    v_mul_f32 v64, s41, v32
    v_mul_f32 v65, s41, v33
    v_mul_f32 v66, s41, v34
    v_mul_f32 v67, s41, v35
    v_mul_f32 v68, s41, v36
    v_mul_f32 v69, s41, v37
    v_mul_f32 v70, s41, v38
    v_mul_f32 v71, s41, v39
    v_mul_f32 v72, s41, v40
    v_mul_f32 v73, s41, v41
    v_mul_f32 v74, s41, v42
    v_mul_f32 v75, s41, v43
    v_mul_f32 v76, s41, v44
    v_mul_f32 v77, s41, v45
    v_mul_f32 v78, s41, v46
    v_mul_f32 v79, s41, v47
    v_mul_f32 v80, s41, v48
    v_mul_f32 v81, s41, v49
    v_mul_f32 v82, s41, v50
    v_mul_f32 v83, s41, v51
    v_mul_f32 v84, s41, v52
    v_mul_f32 v85, s41, v53
    v_mul_f32 v86, s41, v54
    v_mul_f32 v87, s41, v55
    v_mul_f32 v88, s41, v56
    v_mul_f32 v89, s41, v57
    v_mul_f32 v90, s41, v58
    v_mul_f32 v91, s41, v59
    v_mul_f32 v92, s41, v60
    v_mul_f32 v93, s41, v61
    v_mul_f32 v94, s41, v62
    v_mul_f32 v95, s41, v63
    v_max3_f32 v8, |v64|, |v65|, |v66|
    v_max3_f32 v8, v8, |v67|, |v68|
    v_max3_f32 v8, v8, |v69|, |v70|
    v_max3_f32 v8, v8, |v71|, |v72|
    v_max3_f32 v8, v8, |v73|, |v74|
    v_max3_f32 v8, v8, |v75|, |v76|
    v_max3_f32 v8, v8, |v77|, |v78|
    v_max3_f32 v8, v8, |v79|, |v80|
    v_max3_f32 v8, v8, |v81|, |v82|
    v_max3_f32 v8, v8, |v83|, |v84|
    v_max3_f32 v8, v8, |v85|, |v86|
    v_max3_f32 v8, v8, |v87|, |v88|
    v_max3_f32 v8, v8, |v89|, |v90|
    v_max3_f32 v8, v8, |v91|, |v92|
    v_max3_f32 v8, v8, |v93|, |v94|
    v_max_f32 v8, v8, |v95|
    s_mov_b32 s41, 0x42200000
    v_cmp_lt_f32 vcc, s41, v8
    s_nop 3
    s_or_b64 s[42:43], s[42:43], vcc
    s_cmp_lg_u64 s[42:43], 0
    s_cselect_b32 s44, 1, 0
    s_cmp_lg_u32 s44, 0
    s_cbranch_scc1 L_joint_kernel_slow
    v_exp_f32 v32, v64
    v_exp_f32 v33, v65
    v_exp_f32 v34, v66
    v_exp_f32 v35, v67
    v_exp_f32 v36, v68
    v_exp_f32 v37, v69
    v_exp_f32 v38, v70
    v_exp_f32 v39, v71
    v_exp_f32 v40, v72
    v_exp_f32 v41, v73
    v_exp_f32 v42, v74
    v_exp_f32 v43, v75
    v_exp_f32 v44, v76
    v_exp_f32 v45, v77
    v_exp_f32 v46, v78
    v_exp_f32 v47, v79
    v_exp_f32 v48, v80
    v_exp_f32 v49, v81
    v_exp_f32 v50, v82
    v_exp_f32 v51, v83
    v_exp_f32 v52, v84
    v_exp_f32 v53, v85
    v_exp_f32 v54, v86
    v_exp_f32 v55, v87
    v_exp_f32 v56, v88
    v_exp_f32 v57, v89
    v_exp_f32 v58, v90
    v_exp_f32 v59, v91
    v_exp_f32 v60, v92
    v_exp_f32 v61, v93
    v_exp_f32 v62, v94
    v_exp_f32 v63, v95
    ds_write_b128 v9, v[32:35] offset:0
    ds_write_b128 v9, v[36:39] offset:32
    ds_write_b128 v9, v[40:43] offset:64
    ds_write_b128 v9, v[44:47] offset:96
    ds_write_b128 v9, v[48:51] offset:128
    ds_write_b128 v9, v[52:55] offset:160
    ds_write_b128 v9, v[56:59] offset:192
    ds_write_b128 v9, v[60:63] offset:224
    s_waitcnt lgkmcnt(0)
    ds_read_b128 v[32:35], v4 offset:0
    ds_read_b128 v[36:39], v4 offset:32
    ds_read_b128 v[40:43], v4 offset:64
    ds_read_b128 v[44:47], v4 offset:96
    ds_read_b128 v[48:51], v4 offset:128
    ds_read_b128 v[52:55], v4 offset:160
    ds_read_b128 v[56:59], v4 offset:192
    ds_read_b128 v[60:63], v4 offset:224
    s_waitcnt lgkmcnt(6)
    v_fma_f32 v64, v32, v96, 1.0
    v_fma_f32 v65, v33, v97, 1.0
    v_fma_f32 v66, v34, v98, 1.0
    v_fma_f32 v67, v35, v99, 1.0
    v_fma_f32 v68, v36, v100, 1.0
    v_fma_f32 v69, v37, v101, 1.0
    v_fma_f32 v70, v38, v102, 1.0
    v_fma_f32 v71, v39, v103, 1.0
    ds_read_b128 v[32:35], v4 offset:4224
    ds_read_b128 v[36:39], v4 offset:4256
    v_rcp_f32 v64, v64
    v_rcp_f32 v65, v65
    v_rcp_f32 v66, v66
    v_rcp_f32 v67, v67
    v_rcp_f32 v68, v68
    v_rcp_f32 v69, v69
    v_rcp_f32 v70, v70
    v_rcp_f32 v71, v71
    s_nop 0
    v_cvt_pk_bf16_f32 v80, v64, v65
    v_cvt_pk_bf16_f32 v81, v66, v67
    v_cvt_pk_bf16_f32 v82, v68, v69
    v_cvt_pk_bf16_f32 v83, v70, v71
    ds_write_b128 v2, v[80:83] offset:0
    s_waitcnt lgkmcnt(7)
    v_fma_f32 v72, v40, v104, 1.0
    v_fma_f32 v73, v41, v105, 1.0
    v_fma_f32 v74, v42, v106, 1.0
    v_fma_f32 v75, v43, v107, 1.0
    v_fma_f32 v76, v44, v108, 1.0
    v_fma_f32 v77, v45, v109, 1.0
    v_fma_f32 v78, v46, v110, 1.0
    v_fma_f32 v79, v47, v111, 1.0
    ds_read_b128 v[40:43], v4 offset:4288
    ds_read_b128 v[44:47], v4 offset:4320
    v_rcp_f32 v72, v72
    v_rcp_f32 v73, v73
    v_rcp_f32 v74, v74
    v_rcp_f32 v75, v75
    v_rcp_f32 v76, v76
    v_rcp_f32 v77, v77
    v_rcp_f32 v78, v78
    v_rcp_f32 v79, v79
    s_nop 0
    v_cvt_pk_bf16_f32 v84, v72, v73
    v_cvt_pk_bf16_f32 v85, v74, v75
    v_cvt_pk_bf16_f32 v86, v76, v77
    v_cvt_pk_bf16_f32 v87, v78, v79
    ds_write_b128 v2, v[84:87] offset:1024
    s_waitcnt lgkmcnt(8)
    v_fma_f32 v64, v48, v112, 1.0
    v_fma_f32 v65, v49, v113, 1.0
    v_fma_f32 v66, v50, v114, 1.0
    v_fma_f32 v67, v51, v115, 1.0
    v_fma_f32 v68, v52, v116, 1.0
    v_fma_f32 v69, v53, v117, 1.0
    v_fma_f32 v70, v54, v118, 1.0
    v_fma_f32 v71, v55, v119, 1.0
    ds_read_b128 v[48:51], v4 offset:4352
    ds_read_b128 v[52:55], v4 offset:4384
    v_rcp_f32 v64, v64
    v_rcp_f32 v65, v65
    v_rcp_f32 v66, v66
    v_rcp_f32 v67, v67
    v_rcp_f32 v68, v68
    v_rcp_f32 v69, v69
    v_rcp_f32 v70, v70
    v_rcp_f32 v71, v71
    s_nop 0
    v_cvt_pk_bf16_f32 v80, v64, v65
    v_cvt_pk_bf16_f32 v81, v66, v67
    v_cvt_pk_bf16_f32 v82, v68, v69
    v_cvt_pk_bf16_f32 v83, v70, v71
    ds_write_b128 v2, v[80:83] offset:2048
    s_waitcnt lgkmcnt(9)
    v_fma_f32 v72, v56, v120, 1.0
    v_fma_f32 v73, v57, v121, 1.0
    v_fma_f32 v74, v58, v122, 1.0
    v_fma_f32 v75, v59, v123, 1.0
    v_fma_f32 v76, v60, v124, 1.0
    v_fma_f32 v77, v61, v125, 1.0
    v_fma_f32 v78, v62, v126, 1.0
    v_fma_f32 v79, v63, v127, 1.0
    ds_read_b128 v[56:59], v4 offset:4416
    ds_read_b128 v[60:63], v4 offset:4448
    v_rcp_f32 v72, v72
    v_rcp_f32 v73, v73
    v_rcp_f32 v74, v74
    v_rcp_f32 v75, v75
    v_rcp_f32 v76, v76
    v_rcp_f32 v77, v77
    v_rcp_f32 v78, v78
    v_rcp_f32 v79, v79
    s_nop 0
    v_cvt_pk_bf16_f32 v84, v72, v73
    v_cvt_pk_bf16_f32 v85, v74, v75
    v_cvt_pk_bf16_f32 v86, v76, v77
    v_cvt_pk_bf16_f32 v87, v78, v79
    ds_write_b128 v2, v[84:87] offset:3072
    s_waitcnt lgkmcnt(10)
    v_fma_f32 v64, v32, v96, 1.0
    v_fma_f32 v65, v33, v97, 1.0
    v_fma_f32 v66, v34, v98, 1.0
    v_fma_f32 v67, v35, v99, 1.0
    v_fma_f32 v68, v36, v100, 1.0
    v_fma_f32 v69, v37, v101, 1.0
    v_fma_f32 v70, v38, v102, 1.0
    v_fma_f32 v71, v39, v103, 1.0
    ds_read_b128 v[32:35], v4 offset:8448
    ds_read_b128 v[36:39], v4 offset:8480
    v_rcp_f32 v64, v64
    v_rcp_f32 v65, v65
    v_rcp_f32 v66, v66
    v_rcp_f32 v67, v67
    v_rcp_f32 v68, v68
    v_rcp_f32 v69, v69
    v_rcp_f32 v70, v70
    v_rcp_f32 v71, v71
    s_nop 0
    v_cvt_pk_bf16_f32 v80, v64, v65
    v_cvt_pk_bf16_f32 v81, v66, v67
    v_cvt_pk_bf16_f32 v82, v68, v69
    v_cvt_pk_bf16_f32 v83, v70, v71
    ds_write_b128 v2, v[80:83] offset:16384
    s_waitcnt lgkmcnt(10)
    v_fma_f32 v72, v40, v104, 1.0
    v_fma_f32 v73, v41, v105, 1.0
    v_fma_f32 v74, v42, v106, 1.0
    v_fma_f32 v75, v43, v107, 1.0
    v_fma_f32 v76, v44, v108, 1.0
    v_fma_f32 v77, v45, v109, 1.0
    v_fma_f32 v78, v46, v110, 1.0
    v_fma_f32 v79, v47, v111, 1.0
    ds_read_b128 v[40:43], v4 offset:8512
    ds_read_b128 v[44:47], v4 offset:8544
    v_rcp_f32 v72, v72
    v_rcp_f32 v73, v73
    v_rcp_f32 v74, v74
    v_rcp_f32 v75, v75
    v_rcp_f32 v76, v76
    v_rcp_f32 v77, v77
    v_rcp_f32 v78, v78
    v_rcp_f32 v79, v79
    s_nop 0
    v_cvt_pk_bf16_f32 v84, v72, v73
    v_cvt_pk_bf16_f32 v85, v74, v75
    v_cvt_pk_bf16_f32 v86, v76, v77
    v_cvt_pk_bf16_f32 v87, v78, v79
    ds_write_b128 v2, v[84:87] offset:17408
    s_waitcnt lgkmcnt(10)
    v_fma_f32 v64, v48, v112, 1.0
    v_fma_f32 v65, v49, v113, 1.0
    v_fma_f32 v66, v50, v114, 1.0
    v_fma_f32 v67, v51, v115, 1.0
    v_fma_f32 v68, v52, v116, 1.0
    v_fma_f32 v69, v53, v117, 1.0
    v_fma_f32 v70, v54, v118, 1.0
    v_fma_f32 v71, v55, v119, 1.0
    ds_read_b128 v[48:51], v4 offset:8576
    ds_read_b128 v[52:55], v4 offset:8608
    v_rcp_f32 v64, v64
    v_rcp_f32 v65, v65
    v_rcp_f32 v66, v66
    v_rcp_f32 v67, v67
    v_rcp_f32 v68, v68
    v_rcp_f32 v69, v69
    v_rcp_f32 v70, v70
    v_rcp_f32 v71, v71
    s_nop 0
    v_cvt_pk_bf16_f32 v80, v64, v65
    v_cvt_pk_bf16_f32 v81, v66, v67
    v_cvt_pk_bf16_f32 v82, v68, v69
    v_cvt_pk_bf16_f32 v83, v70, v71
    ds_write_b128 v2, v[80:83] offset:18432
    s_waitcnt lgkmcnt(10)
    v_fma_f32 v72, v56, v120, 1.0
    v_fma_f32 v73, v57, v121, 1.0
    v_fma_f32 v74, v58, v122, 1.0
    v_fma_f32 v75, v59, v123, 1.0
    v_fma_f32 v76, v60, v124, 1.0
    v_fma_f32 v77, v61, v125, 1.0
    v_fma_f32 v78, v62, v126, 1.0
    v_fma_f32 v79, v63, v127, 1.0
    ds_read_b128 v[56:59], v4 offset:8640
    ds_read_b128 v[60:63], v4 offset:8672
    v_rcp_f32 v72, v72
    v_rcp_f32 v73, v73
    v_rcp_f32 v74, v74
    v_rcp_f32 v75, v75
    v_rcp_f32 v76, v76
    v_rcp_f32 v77, v77
    v_rcp_f32 v78, v78
    v_rcp_f32 v79, v79
    s_nop 0
    v_cvt_pk_bf16_f32 v84, v72, v73
    v_cvt_pk_bf16_f32 v85, v74, v75
    v_cvt_pk_bf16_f32 v86, v76, v77
    v_cvt_pk_bf16_f32 v87, v78, v79
    ds_write_b128 v2, v[84:87] offset:19456
    s_waitcnt lgkmcnt(0)
    s_barrier
    v_fma_f32 v64, v32, v96, 1.0
    v_fma_f32 v65, v33, v97, 1.0
    v_fma_f32 v66, v34, v98, 1.0
    v_fma_f32 v67, v35, v99, 1.0
    v_fma_f32 v68, v36, v100, 1.0
    v_fma_f32 v69, v37, v101, 1.0
    v_fma_f32 v70, v38, v102, 1.0
    v_fma_f32 v71, v39, v103, 1.0
    ds_read_b128 v[32:35], v4 offset:12672
    ds_read_b128 v[36:39], v4 offset:12704
    v_rcp_f32 v64, v64
    v_rcp_f32 v65, v65
    v_rcp_f32 v66, v66
    v_rcp_f32 v67, v67
    v_rcp_f32 v68, v68
    v_rcp_f32 v69, v69
    v_rcp_f32 v70, v70
    v_rcp_f32 v71, v71
    s_nop 0
    v_cvt_pk_bf16_f32 v80, v64, v65
    v_cvt_pk_bf16_f32 v81, v66, v67
    v_cvt_pk_bf16_f32 v82, v68, v69
    v_cvt_pk_bf16_f32 v83, v70, v71
    ds_write_b128 v2, v[80:83] offset:32768
    v_fma_f32 v72, v40, v104, 1.0
    v_fma_f32 v73, v41, v105, 1.0
    v_fma_f32 v74, v42, v106, 1.0
    v_fma_f32 v75, v43, v107, 1.0
    v_fma_f32 v76, v44, v108, 1.0
    v_fma_f32 v77, v45, v109, 1.0
    v_fma_f32 v78, v46, v110, 1.0
    v_fma_f32 v79, v47, v111, 1.0
    ds_read_b128 v[40:43], v4 offset:12736
    ds_read_b128 v[44:47], v4 offset:12768
    v_rcp_f32 v72, v72
    v_rcp_f32 v73, v73
    v_rcp_f32 v74, v74
    v_rcp_f32 v75, v75
    v_rcp_f32 v76, v76
    v_rcp_f32 v77, v77
    v_rcp_f32 v78, v78
    v_rcp_f32 v79, v79
    s_nop 0
    v_cvt_pk_bf16_f32 v84, v72, v73
    v_cvt_pk_bf16_f32 v85, v74, v75
    v_cvt_pk_bf16_f32 v86, v76, v77
    v_cvt_pk_bf16_f32 v87, v78, v79
    ds_write_b128 v2, v[84:87] offset:33792
    v_fma_f32 v64, v48, v112, 1.0
    v_fma_f32 v65, v49, v113, 1.0
    v_fma_f32 v66, v50, v114, 1.0
    v_fma_f32 v67, v51, v115, 1.0
    v_fma_f32 v68, v52, v116, 1.0
    v_fma_f32 v69, v53, v117, 1.0
    v_fma_f32 v70, v54, v118, 1.0
    v_fma_f32 v71, v55, v119, 1.0
    ds_read_b128 v[48:51], v4 offset:12800
    ds_read_b128 v[52:55], v4 offset:12832
    v_rcp_f32 v64, v64
    v_rcp_f32 v65, v65
    v_rcp_f32 v66, v66
    v_rcp_f32 v67, v67
    v_rcp_f32 v68, v68
    v_rcp_f32 v69, v69
    v_rcp_f32 v70, v70
    v_rcp_f32 v71, v71
    s_nop 0
    v_cvt_pk_bf16_f32 v80, v64, v65
    v_cvt_pk_bf16_f32 v81, v66, v67
    v_cvt_pk_bf16_f32 v82, v68, v69
    v_cvt_pk_bf16_f32 v83, v70, v71
    ds_write_b128 v2, v[80:83] offset:34816
    v_fma_f32 v72, v56, v120, 1.0
    v_fma_f32 v73, v57, v121, 1.0
    v_fma_f32 v74, v58, v122, 1.0
    v_fma_f32 v75, v59, v123, 1.0
    v_fma_f32 v76, v60, v124, 1.0
    v_fma_f32 v77, v61, v125, 1.0
    v_fma_f32 v78, v62, v126, 1.0
    v_fma_f32 v79, v63, v127, 1.0
    ds_read_b128 v[56:59], v4 offset:12864
    ds_read_b128 v[60:63], v4 offset:12896
    v_rcp_f32 v72, v72
    v_rcp_f32 v73, v73
    v_rcp_f32 v74, v74
    v_rcp_f32 v75, v75
    v_rcp_f32 v76, v76
    v_rcp_f32 v77, v77
    v_rcp_f32 v78, v78
    v_rcp_f32 v79, v79
    s_nop 0
    v_cvt_pk_bf16_f32 v84, v72, v73
    v_cvt_pk_bf16_f32 v85, v74, v75
    v_cvt_pk_bf16_f32 v86, v76, v77
    v_cvt_pk_bf16_f32 v87, v78, v79
    ds_write_b128 v2, v[84:87] offset:35840
    s_waitcnt lgkmcnt(0)
    s_barrier
    v_fma_f32 v64, v32, v96, 1.0
    v_fma_f32 v65, v33, v97, 1.0
    v_fma_f32 v66, v34, v98, 1.0
    v_fma_f32 v67, v35, v99, 1.0
    v_fma_f32 v68, v36, v100, 1.0
    v_fma_f32 v69, v37, v101, 1.0
    v_fma_f32 v70, v38, v102, 1.0
    v_fma_f32 v71, v39, v103, 1.0
    ds_read_b128 v[32:35], v4 offset:16896
    ds_read_b128 v[36:39], v4 offset:16928
    v_rcp_f32 v64, v64
    v_rcp_f32 v65, v65
    v_rcp_f32 v66, v66
    v_rcp_f32 v67, v67
    v_rcp_f32 v68, v68
    v_rcp_f32 v69, v69
    v_rcp_f32 v70, v70
    v_rcp_f32 v71, v71
    s_nop 0
    v_cvt_pk_bf16_f32 v80, v64, v65
    v_cvt_pk_bf16_f32 v81, v66, v67
    v_cvt_pk_bf16_f32 v82, v68, v69
    v_cvt_pk_bf16_f32 v83, v70, v71
    ds_write_b128 v2, v[80:83] offset:0
    v_fma_f32 v72, v40, v104, 1.0
    v_fma_f32 v73, v41, v105, 1.0
    v_fma_f32 v74, v42, v106, 1.0
    v_fma_f32 v75, v43, v107, 1.0
    v_fma_f32 v76, v44, v108, 1.0
    v_fma_f32 v77, v45, v109, 1.0
    v_fma_f32 v78, v46, v110, 1.0
    v_fma_f32 v79, v47, v111, 1.0
    ds_read_b128 v[40:43], v4 offset:16960
    ds_read_b128 v[44:47], v4 offset:16992
    v_rcp_f32 v72, v72
    v_rcp_f32 v73, v73
    v_rcp_f32 v74, v74
    v_rcp_f32 v75, v75
    v_rcp_f32 v76, v76
    v_rcp_f32 v77, v77
    v_rcp_f32 v78, v78
    v_rcp_f32 v79, v79
    s_nop 0
    v_cvt_pk_bf16_f32 v84, v72, v73
    v_cvt_pk_bf16_f32 v85, v74, v75
    v_cvt_pk_bf16_f32 v86, v76, v77
    v_cvt_pk_bf16_f32 v87, v78, v79
    ds_write_b128 v2, v[84:87] offset:1024
    v_fma_f32 v64, v48, v112, 1.0
    v_fma_f32 v65, v49, v113, 1.0
    v_fma_f32 v66, v50, v114, 1.0
    v_fma_f32 v67, v51, v115, 1.0
    v_fma_f32 v68, v52, v116, 1.0
    v_fma_f32 v69, v53, v117, 1.0
    v_fma_f32 v70, v54, v118, 1.0
    v_fma_f32 v71, v55, v119, 1.0
    ds_read_b128 v[48:51], v4 offset:17024
    ds_read_b128 v[52:55], v4 offset:17056
    v_rcp_f32 v64, v64
    v_rcp_f32 v65, v65
    v_rcp_f32 v66, v66
    v_rcp_f32 v67, v67
    v_rcp_f32 v68, v68
    v_rcp_f32 v69, v69
    v_rcp_f32 v70, v70
    v_rcp_f32 v71, v71
    s_nop 0
    v_cvt_pk_bf16_f32 v80, v64, v65
    v_cvt_pk_bf16_f32 v81, v66, v67
    v_cvt_pk_bf16_f32 v82, v68, v69
    v_cvt_pk_bf16_f32 v83, v70, v71
    ds_write_b128 v2, v[80:83] offset:2048
    v_fma_f32 v72, v56, v120, 1.0
    v_fma_f32 v73, v57, v121, 1.0
    v_fma_f32 v74, v58, v122, 1.0
    v_fma_f32 v75, v59, v123, 1.0
    v_fma_f32 v76, v60, v124, 1.0
    v_fma_f32 v77, v61, v125, 1.0
    v_fma_f32 v78, v62, v126, 1.0
    v_fma_f32 v79, v63, v127, 1.0
    ds_read_b128 v[56:59], v4 offset:17088
    ds_read_b128 v[60:63], v4 offset:17120
    v_rcp_f32 v72, v72
    v_rcp_f32 v73, v73
    v_rcp_f32 v74, v74
    v_rcp_f32 v75, v75
    v_rcp_f32 v76, v76
    v_rcp_f32 v77, v77
    v_rcp_f32 v78, v78
    v_rcp_f32 v79, v79
    s_nop 0
    v_cvt_pk_bf16_f32 v84, v72, v73
    v_cvt_pk_bf16_f32 v85, v74, v75
    v_cvt_pk_bf16_f32 v86, v76, v77
    v_cvt_pk_bf16_f32 v87, v78, v79
    ds_write_b128 v2, v[84:87] offset:3072
    s_waitcnt lgkmcnt(0)
    s_barrier
    ds_read_b128 a[0:3], v6 offset:0
    ds_read_b128 a[4:7], v6 offset:1056
    ds_read_b128 a[8:11], v6 offset:2112
    ds_read_b128 a[12:15], v6 offset:3168
    v_fma_f32 v64, v32, v96, 1.0
    v_fma_f32 v65, v33, v97, 1.0
    v_fma_f32 v66, v34, v98, 1.0
    v_fma_f32 v67, v35, v99, 1.0
    v_fma_f32 v68, v36, v100, 1.0
    v_fma_f32 v69, v37, v101, 1.0
    v_fma_f32 v70, v38, v102, 1.0
    v_fma_f32 v71, v39, v103, 1.0
    ds_read_b128 v[32:35], v4 offset:21120
    ds_read_b128 v[36:39], v4 offset:21152
    v_rcp_f32 v64, v64
    v_rcp_f32 v65, v65
    v_rcp_f32 v66, v66
    v_rcp_f32 v67, v67
    v_rcp_f32 v68, v68
    v_rcp_f32 v69, v69
    v_rcp_f32 v70, v70
    v_rcp_f32 v71, v71
    s_waitcnt lgkmcnt(5)
    s_mov_b32 s36, 0
    buffer_store_dwordx4 a[0:3], v7, s[16:19], s36 offen sc1
    s_waitcnt lgkmcnt(4)
    s_mov_b32 s36, 1024
    buffer_store_dwordx4 a[4:7], v7, s[16:19], s36 offen sc1
    v_cvt_pk_bf16_f32 v80, v64, v65
    v_cvt_pk_bf16_f32 v81, v66, v67
    v_cvt_pk_bf16_f32 v82, v68, v69
    v_cvt_pk_bf16_f32 v83, v70, v71
    ds_write_b128 v2, v[80:83] offset:16384
    v_fma_f32 v72, v40, v104, 1.0
    v_fma_f32 v73, v41, v105, 1.0
    v_fma_f32 v74, v42, v106, 1.0
    v_fma_f32 v75, v43, v107, 1.0
    v_fma_f32 v76, v44, v108, 1.0
    v_fma_f32 v77, v45, v109, 1.0
    v_fma_f32 v78, v46, v110, 1.0
    v_fma_f32 v79, v47, v111, 1.0
    ds_read_b128 v[40:43], v4 offset:21184
    ds_read_b128 v[44:47], v4 offset:21216
    v_rcp_f32 v72, v72
    v_rcp_f32 v73, v73
    v_rcp_f32 v74, v74
    v_rcp_f32 v75, v75
    v_rcp_f32 v76, v76
    v_rcp_f32 v77, v77
    v_rcp_f32 v78, v78
    v_rcp_f32 v79, v79
    s_waitcnt lgkmcnt(6)
    s_mov_b32 s36, 2048
    buffer_store_dwordx4 a[8:11], v7, s[16:19], s36 offen sc1
    s_waitcnt lgkmcnt(5)
    s_mov_b32 s36, 3072
    buffer_store_dwordx4 a[12:15], v7, s[16:19], s36 offen sc1
    v_cvt_pk_bf16_f32 v84, v72, v73
    v_cvt_pk_bf16_f32 v85, v74, v75
    v_cvt_pk_bf16_f32 v86, v76, v77
    v_cvt_pk_bf16_f32 v87, v78, v79
    ds_write_b128 v2, v[84:87] offset:17408
    v_fma_f32 v64, v48, v112, 1.0
    v_fma_f32 v65, v49, v113, 1.0
    v_fma_f32 v66, v50, v114, 1.0
    v_fma_f32 v67, v51, v115, 1.0
    v_fma_f32 v68, v52, v116, 1.0
    v_fma_f32 v69, v53, v117, 1.0
    v_fma_f32 v70, v54, v118, 1.0
    v_fma_f32 v71, v55, v119, 1.0
    ds_read_b128 v[48:51], v4 offset:21248
    ds_read_b128 v[52:55], v4 offset:21280
    v_rcp_f32 v64, v64
    v_rcp_f32 v65, v65
    v_rcp_f32 v66, v66
    v_rcp_f32 v67, v67
    v_rcp_f32 v68, v68
    v_rcp_f32 v69, v69
    v_rcp_f32 v70, v70
    v_rcp_f32 v71, v71
    s_nop 0
    v_cvt_pk_bf16_f32 v80, v64, v65
    v_cvt_pk_bf16_f32 v81, v66, v67
    v_cvt_pk_bf16_f32 v82, v68, v69
    v_cvt_pk_bf16_f32 v83, v70, v71
    ds_write_b128 v2, v[80:83] offset:18432
    v_fma_f32 v72, v56, v120, 1.0
    v_fma_f32 v73, v57, v121, 1.0
    v_fma_f32 v74, v58, v122, 1.0
    v_fma_f32 v75, v59, v123, 1.0
    v_fma_f32 v76, v60, v124, 1.0
    v_fma_f32 v77, v61, v125, 1.0
    v_fma_f32 v78, v62, v126, 1.0
    v_fma_f32 v79, v63, v127, 1.0
    ds_read_b128 v[56:59], v4 offset:21312
    ds_read_b128 v[60:63], v4 offset:21344
    v_rcp_f32 v72, v72
    v_rcp_f32 v73, v73
    v_rcp_f32 v74, v74
    v_rcp_f32 v75, v75
    v_rcp_f32 v76, v76
    v_rcp_f32 v77, v77
    v_rcp_f32 v78, v78
    v_rcp_f32 v79, v79
    s_nop 0
    v_cvt_pk_bf16_f32 v84, v72, v73
    v_cvt_pk_bf16_f32 v85, v74, v75
    v_cvt_pk_bf16_f32 v86, v76, v77
    v_cvt_pk_bf16_f32 v87, v78, v79
    ds_write_b128 v2, v[84:87] offset:19456
    s_waitcnt lgkmcnt(0)
    s_barrier
    ds_read_b128 a[0:3], v6 offset:16896
    ds_read_b128 a[4:7], v6 offset:17952
    ds_read_b128 a[8:11], v6 offset:19008
    ds_read_b128 a[12:15], v6 offset:20064
    v_fma_f32 v64, v32, v96, 1.0
    v_fma_f32 v65, v33, v97, 1.0
    v_fma_f32 v66, v34, v98, 1.0
    v_fma_f32 v67, v35, v99, 1.0
    v_fma_f32 v68, v36, v100, 1.0
    v_fma_f32 v69, v37, v101, 1.0
    v_fma_f32 v70, v38, v102, 1.0
    v_fma_f32 v71, v39, v103, 1.0
    ds_read_b128 v[32:35], v4 offset:25344
    ds_read_b128 v[36:39], v4 offset:25376
    v_rcp_f32 v64, v64
    v_rcp_f32 v65, v65
    v_rcp_f32 v66, v66
    v_rcp_f32 v67, v67
    v_rcp_f32 v68, v68
    v_rcp_f32 v69, v69
    v_rcp_f32 v70, v70
    v_rcp_f32 v71, v71
    s_waitcnt lgkmcnt(5)
    s_mov_b32 s36, 16384
    buffer_store_dwordx4 a[0:3], v7, s[16:19], s36 offen sc1
    s_waitcnt lgkmcnt(4)
    s_mov_b32 s36, 17408
    buffer_store_dwordx4 a[4:7], v7, s[16:19], s36 offen sc1
    v_cvt_pk_bf16_f32 v80, v64, v65
    v_cvt_pk_bf16_f32 v81, v66, v67
    v_cvt_pk_bf16_f32 v82, v68, v69
    v_cvt_pk_bf16_f32 v83, v70, v71
    ds_write_b128 v2, v[80:83] offset:32768
    v_fma_f32 v72, v40, v104, 1.0
    v_fma_f32 v73, v41, v105, 1.0
    v_fma_f32 v74, v42, v106, 1.0
    v_fma_f32 v75, v43, v107, 1.0
    v_fma_f32 v76, v44, v108, 1.0
    v_fma_f32 v77, v45, v109, 1.0
    v_fma_f32 v78, v46, v110, 1.0
    v_fma_f32 v79, v47, v111, 1.0
    ds_read_b128 v[40:43], v4 offset:25408
    ds_read_b128 v[44:47], v4 offset:25440
    v_rcp_f32 v72, v72
    v_rcp_f32 v73, v73
    v_rcp_f32 v74, v74
    v_rcp_f32 v75, v75
    v_rcp_f32 v76, v76
    v_rcp_f32 v77, v77
    v_rcp_f32 v78, v78
    v_rcp_f32 v79, v79
    s_waitcnt lgkmcnt(6)
    s_mov_b32 s36, 18432
    buffer_store_dwordx4 a[8:11], v7, s[16:19], s36 offen sc1
    s_waitcnt lgkmcnt(5)
    s_mov_b32 s36, 19456
    buffer_store_dwordx4 a[12:15], v7, s[16:19], s36 offen sc1
    v_cvt_pk_bf16_f32 v84, v72, v73
    v_cvt_pk_bf16_f32 v85, v74, v75
    v_cvt_pk_bf16_f32 v86, v76, v77
    v_cvt_pk_bf16_f32 v87, v78, v79
    ds_write_b128 v2, v[84:87] offset:33792
    v_fma_f32 v64, v48, v112, 1.0
    v_fma_f32 v65, v49, v113, 1.0
    v_fma_f32 v66, v50, v114, 1.0
    v_fma_f32 v67, v51, v115, 1.0
    v_fma_f32 v68, v52, v116, 1.0
    v_fma_f32 v69, v53, v117, 1.0
    v_fma_f32 v70, v54, v118, 1.0
    v_fma_f32 v71, v55, v119, 1.0
    ds_read_b128 v[48:51], v4 offset:25472
    ds_read_b128 v[52:55], v4 offset:25504
    v_rcp_f32 v64, v64
    v_rcp_f32 v65, v65
    v_rcp_f32 v66, v66
    v_rcp_f32 v67, v67
    v_rcp_f32 v68, v68
    v_rcp_f32 v69, v69
    v_rcp_f32 v70, v70
    v_rcp_f32 v71, v71
    s_nop 0
    v_cvt_pk_bf16_f32 v80, v64, v65
    v_cvt_pk_bf16_f32 v81, v66, v67
    v_cvt_pk_bf16_f32 v82, v68, v69
    v_cvt_pk_bf16_f32 v83, v70, v71
    ds_write_b128 v2, v[80:83] offset:34816
    v_fma_f32 v72, v56, v120, 1.0
    v_fma_f32 v73, v57, v121, 1.0
    v_fma_f32 v74, v58, v122, 1.0
    v_fma_f32 v75, v59, v123, 1.0
    v_fma_f32 v76, v60, v124, 1.0
    v_fma_f32 v77, v61, v125, 1.0
    v_fma_f32 v78, v62, v126, 1.0
    v_fma_f32 v79, v63, v127, 1.0
    ds_read_b128 v[56:59], v4 offset:25536
    ds_read_b128 v[60:63], v4 offset:25568
    v_rcp_f32 v72, v72
    v_rcp_f32 v73, v73
    v_rcp_f32 v74, v74
    v_rcp_f32 v75, v75
    v_rcp_f32 v76, v76
    v_rcp_f32 v77, v77
    v_rcp_f32 v78, v78
    v_rcp_f32 v79, v79
    s_nop 0
    v_cvt_pk_bf16_f32 v84, v72, v73
    v_cvt_pk_bf16_f32 v85, v74, v75
    v_cvt_pk_bf16_f32 v86, v76, v77
    v_cvt_pk_bf16_f32 v87, v78, v79
    ds_write_b128 v2, v[84:87] offset:35840
    s_waitcnt lgkmcnt(0)
    s_barrier
    ds_read_b128 a[0:3], v6 offset:0
    ds_read_b128 a[4:7], v6 offset:1056
    ds_read_b128 a[8:11], v6 offset:2112
    ds_read_b128 a[12:15], v6 offset:3168
    v_fma_f32 v64, v32, v96, 1.0
    v_fma_f32 v65, v33, v97, 1.0
    v_fma_f32 v66, v34, v98, 1.0
    v_fma_f32 v67, v35, v99, 1.0
    v_fma_f32 v68, v36, v100, 1.0
    v_fma_f32 v69, v37, v101, 1.0
    v_fma_f32 v70, v38, v102, 1.0
    v_fma_f32 v71, v39, v103, 1.0
    ds_read_b128 v[32:35], v4 offset:29568
    ds_read_b128 v[36:39], v4 offset:29600
    v_rcp_f32 v64, v64
    v_rcp_f32 v65, v65
    v_rcp_f32 v66, v66
    v_rcp_f32 v67, v67
    v_rcp_f32 v68, v68
    v_rcp_f32 v69, v69
    v_rcp_f32 v70, v70
    v_rcp_f32 v71, v71
    s_waitcnt lgkmcnt(5)
    s_mov_b32 s36, 32768
    buffer_store_dwordx4 a[0:3], v7, s[16:19], s36 offen sc1
    s_waitcnt lgkmcnt(4)
    s_mov_b32 s36, 33792
    buffer_store_dwordx4 a[4:7], v7, s[16:19], s36 offen sc1
    v_cvt_pk_bf16_f32 v80, v64, v65
    v_cvt_pk_bf16_f32 v81, v66, v67
    v_cvt_pk_bf16_f32 v82, v68, v69
    v_cvt_pk_bf16_f32 v83, v70, v71
    ds_write_b128 v2, v[80:83] offset:0
    v_fma_f32 v72, v40, v104, 1.0
    v_fma_f32 v73, v41, v105, 1.0
    v_fma_f32 v74, v42, v106, 1.0
    v_fma_f32 v75, v43, v107, 1.0
    v_fma_f32 v76, v44, v108, 1.0
    v_fma_f32 v77, v45, v109, 1.0
    v_fma_f32 v78, v46, v110, 1.0
    v_fma_f32 v79, v47, v111, 1.0
    ds_read_b128 v[40:43], v4 offset:29632
    ds_read_b128 v[44:47], v4 offset:29664
    v_rcp_f32 v72, v72
    v_rcp_f32 v73, v73
    v_rcp_f32 v74, v74
    v_rcp_f32 v75, v75
    v_rcp_f32 v76, v76
    v_rcp_f32 v77, v77
    v_rcp_f32 v78, v78
    v_rcp_f32 v79, v79
    s_waitcnt lgkmcnt(6)
    s_mov_b32 s36, 34816
    buffer_store_dwordx4 a[8:11], v7, s[16:19], s36 offen sc1
    s_waitcnt lgkmcnt(5)
    s_mov_b32 s36, 35840
    buffer_store_dwordx4 a[12:15], v7, s[16:19], s36 offen sc1
    v_cvt_pk_bf16_f32 v84, v72, v73
    v_cvt_pk_bf16_f32 v85, v74, v75
    v_cvt_pk_bf16_f32 v86, v76, v77
    v_cvt_pk_bf16_f32 v87, v78, v79
    ds_write_b128 v2, v[84:87] offset:1024
    v_fma_f32 v64, v48, v112, 1.0
    v_fma_f32 v65, v49, v113, 1.0
    v_fma_f32 v66, v50, v114, 1.0
    v_fma_f32 v67, v51, v115, 1.0
    v_fma_f32 v68, v52, v116, 1.0
    v_fma_f32 v69, v53, v117, 1.0
    v_fma_f32 v70, v54, v118, 1.0
    v_fma_f32 v71, v55, v119, 1.0
    ds_read_b128 v[48:51], v4 offset:29696
    ds_read_b128 v[52:55], v4 offset:29728
    v_rcp_f32 v64, v64
    v_rcp_f32 v65, v65
    v_rcp_f32 v66, v66
    v_rcp_f32 v67, v67
    v_rcp_f32 v68, v68
    v_rcp_f32 v69, v69
    v_rcp_f32 v70, v70
    v_rcp_f32 v71, v71
    s_nop 0
    v_cvt_pk_bf16_f32 v80, v64, v65
    v_cvt_pk_bf16_f32 v81, v66, v67
    v_cvt_pk_bf16_f32 v82, v68, v69
    v_cvt_pk_bf16_f32 v83, v70, v71
    ds_write_b128 v2, v[80:83] offset:2048
    v_fma_f32 v72, v56, v120, 1.0
    v_fma_f32 v73, v57, v121, 1.0
    v_fma_f32 v74, v58, v122, 1.0
    v_fma_f32 v75, v59, v123, 1.0
    v_fma_f32 v76, v60, v124, 1.0
    v_fma_f32 v77, v61, v125, 1.0
    v_fma_f32 v78, v62, v126, 1.0
    v_fma_f32 v79, v63, v127, 1.0
    ds_read_b128 v[56:59], v4 offset:29760
    ds_read_b128 v[60:63], v4 offset:29792
    v_rcp_f32 v72, v72
    v_rcp_f32 v73, v73
    v_rcp_f32 v74, v74
    v_rcp_f32 v75, v75
    v_rcp_f32 v76, v76
    v_rcp_f32 v77, v77
    v_rcp_f32 v78, v78
    v_rcp_f32 v79, v79
    s_nop 0
    v_cvt_pk_bf16_f32 v84, v72, v73
    v_cvt_pk_bf16_f32 v85, v74, v75
    v_cvt_pk_bf16_f32 v86, v76, v77
    v_cvt_pk_bf16_f32 v87, v78, v79
    ds_write_b128 v2, v[84:87] offset:3072
    s_waitcnt lgkmcnt(0)
    s_barrier
    ds_read_b128 a[0:3], v6 offset:16896
    ds_read_b128 a[4:7], v6 offset:17952
    ds_read_b128 a[8:11], v6 offset:19008
    ds_read_b128 a[12:15], v6 offset:20064
    v_fma_f32 v64, v32, v96, 1.0
    v_fma_f32 v65, v33, v97, 1.0
    v_fma_f32 v66, v34, v98, 1.0
    v_fma_f32 v67, v35, v99, 1.0
    v_fma_f32 v68, v36, v100, 1.0
    v_fma_f32 v69, v37, v101, 1.0
    v_fma_f32 v70, v38, v102, 1.0
    v_fma_f32 v71, v39, v103, 1.0
    v_rcp_f32 v64, v64
    v_rcp_f32 v65, v65
    v_rcp_f32 v66, v66
    v_rcp_f32 v67, v67
    v_rcp_f32 v68, v68
    v_rcp_f32 v69, v69
    v_rcp_f32 v70, v70
    v_rcp_f32 v71, v71
    s_waitcnt lgkmcnt(3)
    s_mov_b32 s36, 49152
    buffer_store_dwordx4 a[0:3], v7, s[16:19], s36 offen sc1
    s_waitcnt lgkmcnt(2)
    s_mov_b32 s36, 50176
    buffer_store_dwordx4 a[4:7], v7, s[16:19], s36 offen sc1
    v_cvt_pk_bf16_f32 v80, v64, v65
    v_cvt_pk_bf16_f32 v81, v66, v67
    v_cvt_pk_bf16_f32 v82, v68, v69
    v_cvt_pk_bf16_f32 v83, v70, v71
    ds_write_b128 v2, v[80:83] offset:16384
    v_fma_f32 v72, v40, v104, 1.0
    v_fma_f32 v73, v41, v105, 1.0
    v_fma_f32 v74, v42, v106, 1.0
    v_fma_f32 v75, v43, v107, 1.0
    v_fma_f32 v76, v44, v108, 1.0
    v_fma_f32 v77, v45, v109, 1.0
    v_fma_f32 v78, v46, v110, 1.0
    v_fma_f32 v79, v47, v111, 1.0
    v_rcp_f32 v72, v72
    v_rcp_f32 v73, v73
    v_rcp_f32 v74, v74
    v_rcp_f32 v75, v75
    v_rcp_f32 v76, v76
    v_rcp_f32 v77, v77
    v_rcp_f32 v78, v78
    v_rcp_f32 v79, v79
    s_waitcnt lgkmcnt(2)
    s_mov_b32 s36, 51200
    buffer_store_dwordx4 a[8:11], v7, s[16:19], s36 offen sc1
    s_waitcnt lgkmcnt(1)
    s_mov_b32 s36, 52224
    buffer_store_dwordx4 a[12:15], v7, s[16:19], s36 offen sc1
    v_cvt_pk_bf16_f32 v84, v72, v73
    v_cvt_pk_bf16_f32 v85, v74, v75
    v_cvt_pk_bf16_f32 v86, v76, v77
    v_cvt_pk_bf16_f32 v87, v78, v79
    ds_write_b128 v2, v[84:87] offset:17408
    v_fma_f32 v64, v48, v112, 1.0
    v_fma_f32 v65, v49, v113, 1.0
    v_fma_f32 v66, v50, v114, 1.0
    v_fma_f32 v67, v51, v115, 1.0
    v_fma_f32 v68, v52, v116, 1.0
    v_fma_f32 v69, v53, v117, 1.0
    v_fma_f32 v70, v54, v118, 1.0
    v_fma_f32 v71, v55, v119, 1.0
    v_rcp_f32 v64, v64
    v_rcp_f32 v65, v65
    v_rcp_f32 v66, v66
    v_rcp_f32 v67, v67
    v_rcp_f32 v68, v68
    v_rcp_f32 v69, v69
    v_rcp_f32 v70, v70
    v_rcp_f32 v71, v71
    s_nop 0
    v_cvt_pk_bf16_f32 v80, v64, v65
    v_cvt_pk_bf16_f32 v81, v66, v67
    v_cvt_pk_bf16_f32 v82, v68, v69
    v_cvt_pk_bf16_f32 v83, v70, v71
    ds_write_b128 v2, v[80:83] offset:18432
    v_fma_f32 v72, v56, v120, 1.0
    v_fma_f32 v73, v57, v121, 1.0
    v_fma_f32 v74, v58, v122, 1.0
    v_fma_f32 v75, v59, v123, 1.0
    v_fma_f32 v76, v60, v124, 1.0
    v_fma_f32 v77, v61, v125, 1.0
    v_fma_f32 v78, v62, v126, 1.0
    v_fma_f32 v79, v63, v127, 1.0
    v_rcp_f32 v72, v72
    v_rcp_f32 v73, v73
    v_rcp_f32 v74, v74
    v_rcp_f32 v75, v75
    v_rcp_f32 v76, v76
    v_rcp_f32 v77, v77
    v_rcp_f32 v78, v78
    v_rcp_f32 v79, v79
    s_nop 0
    v_cvt_pk_bf16_f32 v84, v72, v73
    v_cvt_pk_bf16_f32 v85, v74, v75
    v_cvt_pk_bf16_f32 v86, v76, v77
    v_cvt_pk_bf16_f32 v87, v78, v79
    ds_write_b128 v2, v[84:87] offset:19456
    s_waitcnt lgkmcnt(0)
    s_barrier
    ds_read_b128 a[0:3], v6 offset:0
    ds_read_b128 a[4:7], v6 offset:1056
    ds_read_b128 a[8:11], v6 offset:2112
    ds_read_b128 a[12:15], v6 offset:3168
    s_waitcnt lgkmcnt(3)
    s_mov_b32 s36, 65536
    buffer_store_dwordx4 a[0:3], v7, s[16:19], s36 offen sc1
    s_waitcnt lgkmcnt(2)
    s_mov_b32 s36, 66560
    buffer_store_dwordx4 a[4:7], v7, s[16:19], s36 offen sc1
    s_waitcnt lgkmcnt(1)
    s_mov_b32 s36, 67584
    buffer_store_dwordx4 a[8:11], v7, s[16:19], s36 offen sc1
    s_waitcnt lgkmcnt(0)
    s_mov_b32 s36, 68608
    buffer_store_dwordx4 a[12:15], v7, s[16:19], s36 offen sc1
    s_barrier
    ds_read_b128 a[0:3], v6 offset:16896
    ds_read_b128 a[4:7], v6 offset:17952
    ds_read_b128 a[8:11], v6 offset:19008
    ds_read_b128 a[12:15], v6 offset:20064
    s_waitcnt lgkmcnt(3)
    s_mov_b32 s36, 81920
    buffer_store_dwordx4 a[0:3], v7, s[16:19], s36 offen sc1
    s_waitcnt lgkmcnt(2)
    s_mov_b32 s36, 82944
    buffer_store_dwordx4 a[4:7], v7, s[16:19], s36 offen sc1
    s_waitcnt lgkmcnt(1)
    s_mov_b32 s36, 83968
    buffer_store_dwordx4 a[8:11], v7, s[16:19], s36 offen sc1
    s_waitcnt lgkmcnt(0)
    s_mov_b32 s36, 84992
    buffer_store_dwordx4 a[12:15], v7, s[16:19], s36 offen sc1
    s_barrier
    ds_read_b128 a[0:3], v6 offset:0
    ds_read_b128 a[4:7], v6 offset:1056
    ds_read_b128 a[8:11], v6 offset:2112
    ds_read_b128 a[12:15], v6 offset:3168
    s_waitcnt lgkmcnt(3)
    s_mov_b32 s36, 98304
    buffer_store_dwordx4 a[0:3], v7, s[16:19], s36 offen sc1
    s_waitcnt lgkmcnt(2)
    s_mov_b32 s36, 99328
    buffer_store_dwordx4 a[4:7], v7, s[16:19], s36 offen sc1
    s_waitcnt lgkmcnt(1)
    s_mov_b32 s36, 100352
    buffer_store_dwordx4 a[8:11], v7, s[16:19], s36 offen sc1
    s_waitcnt lgkmcnt(0)
    s_mov_b32 s36, 101376
    buffer_store_dwordx4 a[12:15], v7, s[16:19], s36 offen sc1
    s_barrier
    ds_read_b128 a[0:3], v6 offset:16896
    ds_read_b128 a[4:7], v6 offset:17952
    ds_read_b128 a[8:11], v6 offset:19008
    ds_read_b128 a[12:15], v6 offset:20064
    s_waitcnt lgkmcnt(3)
    s_mov_b32 s36, 114688
    buffer_store_dwordx4 a[0:3], v7, s[16:19], s36 offen sc1
    s_waitcnt lgkmcnt(2)
    s_mov_b32 s36, 115712
    buffer_store_dwordx4 a[4:7], v7, s[16:19], s36 offen sc1
    s_waitcnt lgkmcnt(1)
    s_mov_b32 s36, 116736
    buffer_store_dwordx4 a[8:11], v7, s[16:19], s36 offen sc1
    s_waitcnt lgkmcnt(0)
    s_mov_b32 s36, 117760
    buffer_store_dwordx4 a[12:15], v7, s[16:19], s36 offen sc1
    s_endpgm
L_joint_kernel_slow:
    buffer_load_dwordx4 v[96:99], v14, s[12:15], s37 offen offset:0
    buffer_load_dwordx4 v[100:103], v14, s[12:15], s37 offen offset:32
    buffer_load_dwordx4 v[104:107], v14, s[12:15], s37 offen offset:64
    buffer_load_dwordx4 v[108:111], v14, s[12:15], s37 offen offset:96
    buffer_load_dwordx4 v[112:115], v14, s[12:15], s37 offen offset:128
    buffer_load_dwordx4 v[116:119], v14, s[12:15], s37 offen offset:160
    buffer_load_dwordx4 v[120:123], v14, s[12:15], s37 offen offset:192
    buffer_load_dwordx4 v[124:127], v14, s[12:15], s37 offen offset:224
    s_waitcnt vmcnt(0)
    ds_write_b128 v9, v[64:67] offset:0
    ds_write_b128 v9, v[68:71] offset:32
    ds_write_b128 v9, v[72:75] offset:64
    ds_write_b128 v9, v[76:79] offset:96
    ds_write_b128 v9, v[80:83] offset:128
    ds_write_b128 v9, v[84:87] offset:160
    ds_write_b128 v9, v[88:91] offset:192
    ds_write_b128 v9, v[92:95] offset:224
    s_waitcnt lgkmcnt(0)
    ds_read_b128 v[32:35], v4 offset:0
    ds_read_b128 v[36:39], v4 offset:32
    ds_read_b128 v[40:43], v4 offset:64
    ds_read_b128 v[44:47], v4 offset:96
    ds_read_b128 v[48:51], v4 offset:128
    ds_read_b128 v[52:55], v4 offset:160
    ds_read_b128 v[56:59], v4 offset:192
    ds_read_b128 v[60:63], v4 offset:224
    s_waitcnt lgkmcnt(6)
    v_add_f32 v64, v32, v96
    v_add_f32 v65, v33, v97
    v_add_f32 v66, v34, v98
    v_add_f32 v67, v35, v99
    v_add_f32 v68, v36, v100
    v_add_f32 v69, v37, v101
    v_add_f32 v70, v38, v102
    v_add_f32 v71, v39, v103
    ds_read_b128 v[32:35], v4 offset:4224
    ds_read_b128 v[36:39], v4 offset:4256
    v_exp_f32 v64, v64
    v_exp_f32 v65, v65
    v_exp_f32 v66, v66
    v_exp_f32 v67, v67
    v_exp_f32 v68, v68
    v_exp_f32 v69, v69
    v_exp_f32 v70, v70
    v_exp_f32 v71, v71
    v_add_f32 v64, 1.0, v64
    v_add_f32 v65, 1.0, v65
    v_add_f32 v66, 1.0, v66
    v_add_f32 v67, 1.0, v67
    v_add_f32 v68, 1.0, v68
    v_add_f32 v69, 1.0, v69
    v_add_f32 v70, 1.0, v70
    v_add_f32 v71, 1.0, v71
    v_rcp_f32 v64, v64
    v_rcp_f32 v65, v65
    v_rcp_f32 v66, v66
    v_rcp_f32 v67, v67
    v_rcp_f32 v68, v68
    v_rcp_f32 v69, v69
    v_rcp_f32 v70, v70
    v_rcp_f32 v71, v71
    s_nop 0
    v_cvt_pk_bf16_f32 v80, v64, v65
    v_cvt_pk_bf16_f32 v81, v66, v67
    v_cvt_pk_bf16_f32 v82, v68, v69
    v_cvt_pk_bf16_f32 v83, v70, v71
    ds_write_b128 v2, v[80:83] offset:0
    s_waitcnt lgkmcnt(7)
    v_add_f32 v72, v40, v104
    v_add_f32 v73, v41, v105
    v_add_f32 v74, v42, v106
    v_add_f32 v75, v43, v107
    v_add_f32 v76, v44, v108
    v_add_f32 v77, v45, v109
    v_add_f32 v78, v46, v110
    v_add_f32 v79, v47, v111
    ds_read_b128 v[40:43], v4 offset:4288
    ds_read_b128 v[44:47], v4 offset:4320
    v_exp_f32 v72, v72
    v_exp_f32 v73, v73
    v_exp_f32 v74, v74
    v_exp_f32 v75, v75
    v_exp_f32 v76, v76
    v_exp_f32 v77, v77
    v_exp_f32 v78, v78
    v_exp_f32 v79, v79
    v_add_f32 v72, 1.0, v72
    v_add_f32 v73, 1.0, v73
    v_add_f32 v74, 1.0, v74
    v_add_f32 v75, 1.0, v75
    v_add_f32 v76, 1.0, v76
    v_add_f32 v77, 1.0, v77
    v_add_f32 v78, 1.0, v78
    v_add_f32 v79, 1.0, v79
    v_rcp_f32 v72, v72
    v_rcp_f32 v73, v73
    v_rcp_f32 v74, v74
    v_rcp_f32 v75, v75
    v_rcp_f32 v76, v76
    v_rcp_f32 v77, v77
    v_rcp_f32 v78, v78
    v_rcp_f32 v79, v79
    s_nop 0
    v_cvt_pk_bf16_f32 v84, v72, v73
    v_cvt_pk_bf16_f32 v85, v74, v75
    v_cvt_pk_bf16_f32 v86, v76, v77
    v_cvt_pk_bf16_f32 v87, v78, v79
    ds_write_b128 v2, v[84:87] offset:1024
    s_waitcnt lgkmcnt(8)
    v_add_f32 v64, v48, v112
    v_add_f32 v65, v49, v113
    v_add_f32 v66, v50, v114
    v_add_f32 v67, v51, v115
    v_add_f32 v68, v52, v116
    v_add_f32 v69, v53, v117
    v_add_f32 v70, v54, v118
    v_add_f32 v71, v55, v119
    ds_read_b128 v[48:51], v4 offset:4352
    ds_read_b128 v[52:55], v4 offset:4384
    v_exp_f32 v64, v64
    v_exp_f32 v65, v65
    v_exp_f32 v66, v66
    v_exp_f32 v67, v67
    v_exp_f32 v68, v68
    v_exp_f32 v69, v69
    v_exp_f32 v70, v70
    v_exp_f32 v71, v71
    v_add_f32 v64, 1.0, v64
    v_add_f32 v65, 1.0, v65
    v_add_f32 v66, 1.0, v66
    v_add_f32 v67, 1.0, v67
    v_add_f32 v68, 1.0, v68
    v_add_f32 v69, 1.0, v69
    v_add_f32 v70, 1.0, v70
    v_add_f32 v71, 1.0, v71
    v_rcp_f32 v64, v64
    v_rcp_f32 v65, v65
    v_rcp_f32 v66, v66
    v_rcp_f32 v67, v67
    v_rcp_f32 v68, v68
    v_rcp_f32 v69, v69
    v_rcp_f32 v70, v70
    v_rcp_f32 v71, v71
    s_nop 0
    v_cvt_pk_bf16_f32 v80, v64, v65
    v_cvt_pk_bf16_f32 v81, v66, v67
    v_cvt_pk_bf16_f32 v82, v68, v69
    v_cvt_pk_bf16_f32 v83, v70, v71
    ds_write_b128 v2, v[80:83] offset:2048
    s_waitcnt lgkmcnt(9)
    v_add_f32 v72, v56, v120
    v_add_f32 v73, v57, v121
    v_add_f32 v74, v58, v122
    v_add_f32 v75, v59, v123
    v_add_f32 v76, v60, v124
    v_add_f32 v77, v61, v125
    v_add_f32 v78, v62, v126
    v_add_f32 v79, v63, v127
    ds_read_b128 v[56:59], v4 offset:4416
    ds_read_b128 v[60:63], v4 offset:4448
    v_exp_f32 v72, v72
    v_exp_f32 v73, v73
    v_exp_f32 v74, v74
    v_exp_f32 v75, v75
    v_exp_f32 v76, v76
    v_exp_f32 v77, v77
    v_exp_f32 v78, v78
    v_exp_f32 v79, v79
    v_add_f32 v72, 1.0, v72
    v_add_f32 v73, 1.0, v73
    v_add_f32 v74, 1.0, v74
    v_add_f32 v75, 1.0, v75
    v_add_f32 v76, 1.0, v76
    v_add_f32 v77, 1.0, v77
    v_add_f32 v78, 1.0, v78
    v_add_f32 v79, 1.0, v79
    v_rcp_f32 v72, v72
    v_rcp_f32 v73, v73
    v_rcp_f32 v74, v74
    v_rcp_f32 v75, v75
    v_rcp_f32 v76, v76
    v_rcp_f32 v77, v77
    v_rcp_f32 v78, v78
    v_rcp_f32 v79, v79
    s_nop 0
    v_cvt_pk_bf16_f32 v84, v72, v73
    v_cvt_pk_bf16_f32 v85, v74, v75
    v_cvt_pk_bf16_f32 v86, v76, v77
    v_cvt_pk_bf16_f32 v87, v78, v79
    ds_write_b128 v2, v[84:87] offset:3072
    s_waitcnt lgkmcnt(10)
    v_add_f32 v64, v32, v96
    v_add_f32 v65, v33, v97
    v_add_f32 v66, v34, v98
    v_add_f32 v67, v35, v99
    v_add_f32 v68, v36, v100
    v_add_f32 v69, v37, v101
    v_add_f32 v70, v38, v102
    v_add_f32 v71, v39, v103
    ds_read_b128 v[32:35], v4 offset:8448
    ds_read_b128 v[36:39], v4 offset:8480
    v_exp_f32 v64, v64
    v_exp_f32 v65, v65
    v_exp_f32 v66, v66
    v_exp_f32 v67, v67
    v_exp_f32 v68, v68
    v_exp_f32 v69, v69
    v_exp_f32 v70, v70
    v_exp_f32 v71, v71
    v_add_f32 v64, 1.0, v64
    v_add_f32 v65, 1.0, v65
    v_add_f32 v66, 1.0, v66
    v_add_f32 v67, 1.0, v67
    v_add_f32 v68, 1.0, v68
    v_add_f32 v69, 1.0, v69
    v_add_f32 v70, 1.0, v70
    v_add_f32 v71, 1.0, v71
    v_rcp_f32 v64, v64
    v_rcp_f32 v65, v65
    v_rcp_f32 v66, v66
    v_rcp_f32 v67, v67
    v_rcp_f32 v68, v68
    v_rcp_f32 v69, v69
    v_rcp_f32 v70, v70
    v_rcp_f32 v71, v71
    s_nop 0
    v_cvt_pk_bf16_f32 v80, v64, v65
    v_cvt_pk_bf16_f32 v81, v66, v67
    v_cvt_pk_bf16_f32 v82, v68, v69
    v_cvt_pk_bf16_f32 v83, v70, v71
    ds_write_b128 v2, v[80:83] offset:16384
    s_waitcnt lgkmcnt(10)
    v_add_f32 v72, v40, v104
    v_add_f32 v73, v41, v105
    v_add_f32 v74, v42, v106
    v_add_f32 v75, v43, v107
    v_add_f32 v76, v44, v108
    v_add_f32 v77, v45, v109
    v_add_f32 v78, v46, v110
    v_add_f32 v79, v47, v111
    ds_read_b128 v[40:43], v4 offset:8512
    ds_read_b128 v[44:47], v4 offset:8544
    v_exp_f32 v72, v72
    v_exp_f32 v73, v73
    v_exp_f32 v74, v74
    v_exp_f32 v75, v75
    v_exp_f32 v76, v76
    v_exp_f32 v77, v77
    v_exp_f32 v78, v78
    v_exp_f32 v79, v79
    v_add_f32 v72, 1.0, v72
    v_add_f32 v73, 1.0, v73
    v_add_f32 v74, 1.0, v74
    v_add_f32 v75, 1.0, v75
    v_add_f32 v76, 1.0, v76
    v_add_f32 v77, 1.0, v77
    v_add_f32 v78, 1.0, v78
    v_add_f32 v79, 1.0, v79
    v_rcp_f32 v72, v72
    v_rcp_f32 v73, v73
    v_rcp_f32 v74, v74
    v_rcp_f32 v75, v75
    v_rcp_f32 v76, v76
    v_rcp_f32 v77, v77
    v_rcp_f32 v78, v78
    v_rcp_f32 v79, v79
    s_nop 0
    v_cvt_pk_bf16_f32 v84, v72, v73
    v_cvt_pk_bf16_f32 v85, v74, v75
    v_cvt_pk_bf16_f32 v86, v76, v77
    v_cvt_pk_bf16_f32 v87, v78, v79
    ds_write_b128 v2, v[84:87] offset:17408
    s_waitcnt lgkmcnt(10)
    v_add_f32 v64, v48, v112
    v_add_f32 v65, v49, v113
    v_add_f32 v66, v50, v114
    v_add_f32 v67, v51, v115
    v_add_f32 v68, v52, v116
    v_add_f32 v69, v53, v117
    v_add_f32 v70, v54, v118
    v_add_f32 v71, v55, v119
    ds_read_b128 v[48:51], v4 offset:8576
    ds_read_b128 v[52:55], v4 offset:8608
    v_exp_f32 v64, v64
    v_exp_f32 v65, v65
    v_exp_f32 v66, v66
    v_exp_f32 v67, v67
    v_exp_f32 v68, v68
    v_exp_f32 v69, v69
    v_exp_f32 v70, v70
    v_exp_f32 v71, v71
    v_add_f32 v64, 1.0, v64
    v_add_f32 v65, 1.0, v65
    v_add_f32 v66, 1.0, v66
    v_add_f32 v67, 1.0, v67
    v_add_f32 v68, 1.0, v68
    v_add_f32 v69, 1.0, v69
    v_add_f32 v70, 1.0, v70
    v_add_f32 v71, 1.0, v71
    v_rcp_f32 v64, v64
    v_rcp_f32 v65, v65
    v_rcp_f32 v66, v66
    v_rcp_f32 v67, v67
    v_rcp_f32 v68, v68
    v_rcp_f32 v69, v69
    v_rcp_f32 v70, v70
    v_rcp_f32 v71, v71
    s_nop 0
    v_cvt_pk_bf16_f32 v80, v64, v65
    v_cvt_pk_bf16_f32 v81, v66, v67
    v_cvt_pk_bf16_f32 v82, v68, v69
    v_cvt_pk_bf16_f32 v83, v70, v71
    ds_write_b128 v2, v[80:83] offset:18432
    s_waitcnt lgkmcnt(10)
    v_add_f32 v72, v56, v120
    v_add_f32 v73, v57, v121
    v_add_f32 v74, v58, v122
    v_add_f32 v75, v59, v123
    v_add_f32 v76, v60, v124
    v_add_f32 v77, v61, v125
    v_add_f32 v78, v62, v126
    v_add_f32 v79, v63, v127
    ds_read_b128 v[56:59], v4 offset:8640
    ds_read_b128 v[60:63], v4 offset:8672
    v_exp_f32 v72, v72
    v_exp_f32 v73, v73
    v_exp_f32 v74, v74
    v_exp_f32 v75, v75
    v_exp_f32 v76, v76
    v_exp_f32 v77, v77
    v_exp_f32 v78, v78
    v_exp_f32 v79, v79
    v_add_f32 v72, 1.0, v72
    v_add_f32 v73, 1.0, v73
    v_add_f32 v74, 1.0, v74
    v_add_f32 v75, 1.0, v75
    v_add_f32 v76, 1.0, v76
    v_add_f32 v77, 1.0, v77
    v_add_f32 v78, 1.0, v78
    v_add_f32 v79, 1.0, v79
    v_rcp_f32 v72, v72
    v_rcp_f32 v73, v73
    v_rcp_f32 v74, v74
    v_rcp_f32 v75, v75
    v_rcp_f32 v76, v76
    v_rcp_f32 v77, v77
    v_rcp_f32 v78, v78
    v_rcp_f32 v79, v79
    s_nop 0
    v_cvt_pk_bf16_f32 v84, v72, v73
    v_cvt_pk_bf16_f32 v85, v74, v75
    v_cvt_pk_bf16_f32 v86, v76, v77
    v_cvt_pk_bf16_f32 v87, v78, v79
    ds_write_b128 v2, v[84:87] offset:19456
    s_waitcnt lgkmcnt(0)
    s_barrier
    v_add_f32 v64, v32, v96
    v_add_f32 v65, v33, v97
    v_add_f32 v66, v34, v98
    v_add_f32 v67, v35, v99
    v_add_f32 v68, v36, v100
    v_add_f32 v69, v37, v101
    v_add_f32 v70, v38, v102
    v_add_f32 v71, v39, v103
    ds_read_b128 v[32:35], v4 offset:12672
    ds_read_b128 v[36:39], v4 offset:12704
    v_exp_f32 v64, v64
    v_exp_f32 v65, v65
    v_exp_f32 v66, v66
    v_exp_f32 v67, v67
    v_exp_f32 v68, v68
    v_exp_f32 v69, v69
    v_exp_f32 v70, v70
    v_exp_f32 v71, v71
    v_add_f32 v64, 1.0, v64
    v_add_f32 v65, 1.0, v65
    v_add_f32 v66, 1.0, v66
    v_add_f32 v67, 1.0, v67
    v_add_f32 v68, 1.0, v68
    v_add_f32 v69, 1.0, v69
    v_add_f32 v70, 1.0, v70
    v_add_f32 v71, 1.0, v71
    v_rcp_f32 v64, v64
    v_rcp_f32 v65, v65
    v_rcp_f32 v66, v66
    v_rcp_f32 v67, v67
    v_rcp_f32 v68, v68
    v_rcp_f32 v69, v69
    v_rcp_f32 v70, v70
    v_rcp_f32 v71, v71
    s_nop 0
    v_cvt_pk_bf16_f32 v80, v64, v65
    v_cvt_pk_bf16_f32 v81, v66, v67
    v_cvt_pk_bf16_f32 v82, v68, v69
    v_cvt_pk_bf16_f32 v83, v70, v71
    ds_write_b128 v2, v[80:83] offset:32768
    v_add_f32 v72, v40, v104
    v_add_f32 v73, v41, v105
    v_add_f32 v74, v42, v106
    v_add_f32 v75, v43, v107
    v_add_f32 v76, v44, v108
    v_add_f32 v77, v45, v109
    v_add_f32 v78, v46, v110
    v_add_f32 v79, v47, v111
    ds_read_b128 v[40:43], v4 offset:12736
    ds_read_b128 v[44:47], v4 offset:12768
    v_exp_f32 v72, v72
    v_exp_f32 v73, v73
    v_exp_f32 v74, v74
    v_exp_f32 v75, v75
    v_exp_f32 v76, v76
    v_exp_f32 v77, v77
    v_exp_f32 v78, v78
    v_exp_f32 v79, v79
    v_add_f32 v72, 1.0, v72
    v_add_f32 v73, 1.0, v73
    v_add_f32 v74, 1.0, v74
    v_add_f32 v75, 1.0, v75
    v_add_f32 v76, 1.0, v76
    v_add_f32 v77, 1.0, v77
    v_add_f32 v78, 1.0, v78
    v_add_f32 v79, 1.0, v79
    v_rcp_f32 v72, v72
    v_rcp_f32 v73, v73
    v_rcp_f32 v74, v74
    v_rcp_f32 v75, v75
    v_rcp_f32 v76, v76
    v_rcp_f32 v77, v77
    v_rcp_f32 v78, v78
    v_rcp_f32 v79, v79
    s_nop 0
    v_cvt_pk_bf16_f32 v84, v72, v73
    v_cvt_pk_bf16_f32 v85, v74, v75
    v_cvt_pk_bf16_f32 v86, v76, v77
    v_cvt_pk_bf16_f32 v87, v78, v79
    ds_write_b128 v2, v[84:87] offset:33792
    v_add_f32 v64, v48, v112
    v_add_f32 v65, v49, v113
    v_add_f32 v66, v50, v114
    v_add_f32 v67, v51, v115
    v_add_f32 v68, v52, v116
    v_add_f32 v69, v53, v117
    v_add_f32 v70, v54, v118
    v_add_f32 v71, v55, v119
    ds_read_b128 v[48:51], v4 offset:12800
    ds_read_b128 v[52:55], v4 offset:12832
    v_exp_f32 v64, v64
    v_exp_f32 v65, v65
    v_exp_f32 v66, v66
    v_exp_f32 v67, v67
    v_exp_f32 v68, v68
    v_exp_f32 v69, v69
    v_exp_f32 v70, v70
    v_exp_f32 v71, v71
    v_add_f32 v64, 1.0, v64
    v_add_f32 v65, 1.0, v65
    v_add_f32 v66, 1.0, v66
    v_add_f32 v67, 1.0, v67
    v_add_f32 v68, 1.0, v68
    v_add_f32 v69, 1.0, v69
    v_add_f32 v70, 1.0, v70
    v_add_f32 v71, 1.0, v71
    v_rcp_f32 v64, v64
    v_rcp_f32 v65, v65
    v_rcp_f32 v66, v66
    v_rcp_f32 v67, v67
    v_rcp_f32 v68, v68
    v_rcp_f32 v69, v69
    v_rcp_f32 v70, v70
    v_rcp_f32 v71, v71
    s_nop 0
    v_cvt_pk_bf16_f32 v80, v64, v65
    v_cvt_pk_bf16_f32 v81, v66, v67
    v_cvt_pk_bf16_f32 v82, v68, v69
    v_cvt_pk_bf16_f32 v83, v70, v71
    ds_write_b128 v2, v[80:83] offset:34816
    v_add_f32 v72, v56, v120
    v_add_f32 v73, v57, v121
    v_add_f32 v74, v58, v122
    v_add_f32 v75, v59, v123
    v_add_f32 v76, v60, v124
    v_add_f32 v77, v61, v125
    v_add_f32 v78, v62, v126
    v_add_f32 v79, v63, v127
    ds_read_b128 v[56:59], v4 offset:12864
    ds_read_b128 v[60:63], v4 offset:12896
    v_exp_f32 v72, v72
    v_exp_f32 v73, v73
    v_exp_f32 v74, v74
    v_exp_f32 v75, v75
    v_exp_f32 v76, v76
    v_exp_f32 v77, v77
    v_exp_f32 v78, v78
    v_exp_f32 v79, v79
    v_add_f32 v72, 1.0, v72
    v_add_f32 v73, 1.0, v73
    v_add_f32 v74, 1.0, v74
    v_add_f32 v75, 1.0, v75
    v_add_f32 v76, 1.0, v76
    v_add_f32 v77, 1.0, v77
    v_add_f32 v78, 1.0, v78
    v_add_f32 v79, 1.0, v79
    v_rcp_f32 v72, v72
    v_rcp_f32 v73, v73
    v_rcp_f32 v74, v74
    v_rcp_f32 v75, v75
    v_rcp_f32 v76, v76
    v_rcp_f32 v77, v77
    v_rcp_f32 v78, v78
    v_rcp_f32 v79, v79
    s_nop 0
    v_cvt_pk_bf16_f32 v84, v72, v73
    v_cvt_pk_bf16_f32 v85, v74, v75
    v_cvt_pk_bf16_f32 v86, v76, v77
    v_cvt_pk_bf16_f32 v87, v78, v79
    ds_write_b128 v2, v[84:87] offset:35840
    s_waitcnt lgkmcnt(0)
    s_barrier
    v_add_f32 v64, v32, v96
    v_add_f32 v65, v33, v97
    v_add_f32 v66, v34, v98
    v_add_f32 v67, v35, v99
    v_add_f32 v68, v36, v100
    v_add_f32 v69, v37, v101
    v_add_f32 v70, v38, v102
    v_add_f32 v71, v39, v103
    ds_read_b128 v[32:35], v4 offset:16896
    ds_read_b128 v[36:39], v4 offset:16928
    v_exp_f32 v64, v64
    v_exp_f32 v65, v65
    v_exp_f32 v66, v66
    v_exp_f32 v67, v67
    v_exp_f32 v68, v68
    v_exp_f32 v69, v69
    v_exp_f32 v70, v70
    v_exp_f32 v71, v71
    v_add_f32 v64, 1.0, v64
    v_add_f32 v65, 1.0, v65
    v_add_f32 v66, 1.0, v66
    v_add_f32 v67, 1.0, v67
    v_add_f32 v68, 1.0, v68
    v_add_f32 v69, 1.0, v69
    v_add_f32 v70, 1.0, v70
    v_add_f32 v71, 1.0, v71
    v_rcp_f32 v64, v64
    v_rcp_f32 v65, v65
    v_rcp_f32 v66, v66
    v_rcp_f32 v67, v67
    v_rcp_f32 v68, v68
    v_rcp_f32 v69, v69
    v_rcp_f32 v70, v70
    v_rcp_f32 v71, v71
    s_nop 0
    v_cvt_pk_bf16_f32 v80, v64, v65
    v_cvt_pk_bf16_f32 v81, v66, v67
    v_cvt_pk_bf16_f32 v82, v68, v69
    v_cvt_pk_bf16_f32 v83, v70, v71
    ds_write_b128 v2, v[80:83] offset:0
    v_add_f32 v72, v40, v104
    v_add_f32 v73, v41, v105
    v_add_f32 v74, v42, v106
    v_add_f32 v75, v43, v107
    v_add_f32 v76, v44, v108
    v_add_f32 v77, v45, v109
    v_add_f32 v78, v46, v110
    v_add_f32 v79, v47, v111
    ds_read_b128 v[40:43], v4 offset:16960
    ds_read_b128 v[44:47], v4 offset:16992
    v_exp_f32 v72, v72
    v_exp_f32 v73, v73
    v_exp_f32 v74, v74
    v_exp_f32 v75, v75
    v_exp_f32 v76, v76
    v_exp_f32 v77, v77
    v_exp_f32 v78, v78
    v_exp_f32 v79, v79
    v_add_f32 v72, 1.0, v72
    v_add_f32 v73, 1.0, v73
    v_add_f32 v74, 1.0, v74
    v_add_f32 v75, 1.0, v75
    v_add_f32 v76, 1.0, v76
    v_add_f32 v77, 1.0, v77
    v_add_f32 v78, 1.0, v78
    v_add_f32 v79, 1.0, v79
    v_rcp_f32 v72, v72
    v_rcp_f32 v73, v73
    v_rcp_f32 v74, v74
    v_rcp_f32 v75, v75
    v_rcp_f32 v76, v76
    v_rcp_f32 v77, v77
    v_rcp_f32 v78, v78
    v_rcp_f32 v79, v79
    s_nop 0
    v_cvt_pk_bf16_f32 v84, v72, v73
    v_cvt_pk_bf16_f32 v85, v74, v75
    v_cvt_pk_bf16_f32 v86, v76, v77
    v_cvt_pk_bf16_f32 v87, v78, v79
    ds_write_b128 v2, v[84:87] offset:1024
    v_add_f32 v64, v48, v112
    v_add_f32 v65, v49, v113
    v_add_f32 v66, v50, v114
    v_add_f32 v67, v51, v115
    v_add_f32 v68, v52, v116
    v_add_f32 v69, v53, v117
    v_add_f32 v70, v54, v118
    v_add_f32 v71, v55, v119
    ds_read_b128 v[48:51], v4 offset:17024
    ds_read_b128 v[52:55], v4 offset:17056
    v_exp_f32 v64, v64
    v_exp_f32 v65, v65
    v_exp_f32 v66, v66
    v_exp_f32 v67, v67
    v_exp_f32 v68, v68
    v_exp_f32 v69, v69
    v_exp_f32 v70, v70
    v_exp_f32 v71, v71
    v_add_f32 v64, 1.0, v64
    v_add_f32 v65, 1.0, v65
    v_add_f32 v66, 1.0, v66
    v_add_f32 v67, 1.0, v67
    v_add_f32 v68, 1.0, v68
    v_add_f32 v69, 1.0, v69
    v_add_f32 v70, 1.0, v70
    v_add_f32 v71, 1.0, v71
    v_rcp_f32 v64, v64
    v_rcp_f32 v65, v65
    v_rcp_f32 v66, v66
    v_rcp_f32 v67, v67
    v_rcp_f32 v68, v68
    v_rcp_f32 v69, v69
    v_rcp_f32 v70, v70
    v_rcp_f32 v71, v71
    s_nop 0
    v_cvt_pk_bf16_f32 v80, v64, v65
    v_cvt_pk_bf16_f32 v81, v66, v67
    v_cvt_pk_bf16_f32 v82, v68, v69
    v_cvt_pk_bf16_f32 v83, v70, v71
    ds_write_b128 v2, v[80:83] offset:2048
    v_add_f32 v72, v56, v120
    v_add_f32 v73, v57, v121
    v_add_f32 v74, v58, v122
    v_add_f32 v75, v59, v123
    v_add_f32 v76, v60, v124
    v_add_f32 v77, v61, v125
    v_add_f32 v78, v62, v126
    v_add_f32 v79, v63, v127
    ds_read_b128 v[56:59], v4 offset:17088
    ds_read_b128 v[60:63], v4 offset:17120
    v_exp_f32 v72, v72
    v_exp_f32 v73, v73
    v_exp_f32 v74, v74
    v_exp_f32 v75, v75
    v_exp_f32 v76, v76
    v_exp_f32 v77, v77
    v_exp_f32 v78, v78
    v_exp_f32 v79, v79
    v_add_f32 v72, 1.0, v72
    v_add_f32 v73, 1.0, v73
    v_add_f32 v74, 1.0, v74
    v_add_f32 v75, 1.0, v75
    v_add_f32 v76, 1.0, v76
    v_add_f32 v77, 1.0, v77
    v_add_f32 v78, 1.0, v78
    v_add_f32 v79, 1.0, v79
    v_rcp_f32 v72, v72
    v_rcp_f32 v73, v73
    v_rcp_f32 v74, v74
    v_rcp_f32 v75, v75
    v_rcp_f32 v76, v76
    v_rcp_f32 v77, v77
    v_rcp_f32 v78, v78
    v_rcp_f32 v79, v79
    s_nop 0
    v_cvt_pk_bf16_f32 v84, v72, v73
    v_cvt_pk_bf16_f32 v85, v74, v75
    v_cvt_pk_bf16_f32 v86, v76, v77
    v_cvt_pk_bf16_f32 v87, v78, v79
    ds_write_b128 v2, v[84:87] offset:3072
    s_waitcnt lgkmcnt(0)
    s_barrier
    ds_read_b128 a[0:3], v6 offset:0
    ds_read_b128 a[4:7], v6 offset:1056
    ds_read_b128 a[8:11], v6 offset:2112
    ds_read_b128 a[12:15], v6 offset:3168
    v_add_f32 v64, v32, v96
    v_add_f32 v65, v33, v97
    v_add_f32 v66, v34, v98
    v_add_f32 v67, v35, v99
    v_add_f32 v68, v36, v100
    v_add_f32 v69, v37, v101
    v_add_f32 v70, v38, v102
    v_add_f32 v71, v39, v103
    ds_read_b128 v[32:35], v4 offset:21120
    ds_read_b128 v[36:39], v4 offset:21152
    v_exp_f32 v64, v64
    v_exp_f32 v65, v65
    v_exp_f32 v66, v66
    v_exp_f32 v67, v67
    v_exp_f32 v68, v68
    v_exp_f32 v69, v69
    v_exp_f32 v70, v70
    v_exp_f32 v71, v71
    v_add_f32 v64, 1.0, v64
    v_add_f32 v65, 1.0, v65
    v_add_f32 v66, 1.0, v66
    v_add_f32 v67, 1.0, v67
    v_add_f32 v68, 1.0, v68
    v_add_f32 v69, 1.0, v69
    v_add_f32 v70, 1.0, v70
    v_add_f32 v71, 1.0, v71
    v_rcp_f32 v64, v64
    v_rcp_f32 v65, v65
    v_rcp_f32 v66, v66
    v_rcp_f32 v67, v67
    v_rcp_f32 v68, v68
    v_rcp_f32 v69, v69
    v_rcp_f32 v70, v70
    v_rcp_f32 v71, v71
    s_waitcnt lgkmcnt(5)
    s_mov_b32 s36, 0
    buffer_store_dwordx4 a[0:3], v7, s[16:19], s36 offen sc1
    s_waitcnt lgkmcnt(4)
    s_mov_b32 s36, 1024
    buffer_store_dwordx4 a[4:7], v7, s[16:19], s36 offen sc1
    v_cvt_pk_bf16_f32 v80, v64, v65
    v_cvt_pk_bf16_f32 v81, v66, v67
    v_cvt_pk_bf16_f32 v82, v68, v69
    v_cvt_pk_bf16_f32 v83, v70, v71
    ds_write_b128 v2, v[80:83] offset:16384
    v_add_f32 v72, v40, v104
    v_add_f32 v73, v41, v105
    v_add_f32 v74, v42, v106
    v_add_f32 v75, v43, v107
    v_add_f32 v76, v44, v108
    v_add_f32 v77, v45, v109
    v_add_f32 v78, v46, v110
    v_add_f32 v79, v47, v111
    ds_read_b128 v[40:43], v4 offset:21184
    ds_read_b128 v[44:47], v4 offset:21216
    v_exp_f32 v72, v72
    v_exp_f32 v73, v73
    v_exp_f32 v74, v74
    v_exp_f32 v75, v75
    v_exp_f32 v76, v76
    v_exp_f32 v77, v77
    v_exp_f32 v78, v78
    v_exp_f32 v79, v79
    v_add_f32 v72, 1.0, v72
    v_add_f32 v73, 1.0, v73
    v_add_f32 v74, 1.0, v74
    v_add_f32 v75, 1.0, v75
    v_add_f32 v76, 1.0, v76
    v_add_f32 v77, 1.0, v77
    v_add_f32 v78, 1.0, v78
    v_add_f32 v79, 1.0, v79
    v_rcp_f32 v72, v72
    v_rcp_f32 v73, v73
    v_rcp_f32 v74, v74
    v_rcp_f32 v75, v75
    v_rcp_f32 v76, v76
    v_rcp_f32 v77, v77
    v_rcp_f32 v78, v78
    v_rcp_f32 v79, v79
    s_waitcnt lgkmcnt(6)
    s_mov_b32 s36, 2048
    buffer_store_dwordx4 a[8:11], v7, s[16:19], s36 offen sc1
    s_waitcnt lgkmcnt(5)
    s_mov_b32 s36, 3072
    buffer_store_dwordx4 a[12:15], v7, s[16:19], s36 offen sc1
    v_cvt_pk_bf16_f32 v84, v72, v73
    v_cvt_pk_bf16_f32 v85, v74, v75
    v_cvt_pk_bf16_f32 v86, v76, v77
    v_cvt_pk_bf16_f32 v87, v78, v79
    ds_write_b128 v2, v[84:87] offset:17408
    v_add_f32 v64, v48, v112
    v_add_f32 v65, v49, v113
    v_add_f32 v66, v50, v114
    v_add_f32 v67, v51, v115
    v_add_f32 v68, v52, v116
    v_add_f32 v69, v53, v117
    v_add_f32 v70, v54, v118
    v_add_f32 v71, v55, v119
    ds_read_b128 v[48:51], v4 offset:21248
    ds_read_b128 v[52:55], v4 offset:21280
    v_exp_f32 v64, v64
    v_exp_f32 v65, v65
    v_exp_f32 v66, v66
    v_exp_f32 v67, v67
    v_exp_f32 v68, v68
    v_exp_f32 v69, v69
    v_exp_f32 v70, v70
    v_exp_f32 v71, v71
    v_add_f32 v64, 1.0, v64
    v_add_f32 v65, 1.0, v65
    v_add_f32 v66, 1.0, v66
    v_add_f32 v67, 1.0, v67
    v_add_f32 v68, 1.0, v68
    v_add_f32 v69, 1.0, v69
    v_add_f32 v70, 1.0, v70
    v_add_f32 v71, 1.0, v71
    v_rcp_f32 v64, v64
    v_rcp_f32 v65, v65
    v_rcp_f32 v66, v66
    v_rcp_f32 v67, v67
    v_rcp_f32 v68, v68
    v_rcp_f32 v69, v69
    v_rcp_f32 v70, v70
    v_rcp_f32 v71, v71
    s_nop 0
    v_cvt_pk_bf16_f32 v80, v64, v65
    v_cvt_pk_bf16_f32 v81, v66, v67
    v_cvt_pk_bf16_f32 v82, v68, v69
    v_cvt_pk_bf16_f32 v83, v70, v71
    ds_write_b128 v2, v[80:83] offset:18432
    v_add_f32 v72, v56, v120
    v_add_f32 v73, v57, v121
    v_add_f32 v74, v58, v122
    v_add_f32 v75, v59, v123
    v_add_f32 v76, v60, v124
    v_add_f32 v77, v61, v125
    v_add_f32 v78, v62, v126
    v_add_f32 v79, v63, v127
    ds_read_b128 v[56:59], v4 offset:21312
    ds_read_b128 v[60:63], v4 offset:21344
    v_exp_f32 v72, v72
    v_exp_f32 v73, v73
    v_exp_f32 v74, v74
    v_exp_f32 v75, v75
    v_exp_f32 v76, v76
    v_exp_f32 v77, v77
    v_exp_f32 v78, v78
    v_exp_f32 v79, v79
    v_add_f32 v72, 1.0, v72
    v_add_f32 v73, 1.0, v73
    v_add_f32 v74, 1.0, v74
    v_add_f32 v75, 1.0, v75
    v_add_f32 v76, 1.0, v76
    v_add_f32 v77, 1.0, v77
    v_add_f32 v78, 1.0, v78
    v_add_f32 v79, 1.0, v79
    v_rcp_f32 v72, v72
    v_rcp_f32 v73, v73
    v_rcp_f32 v74, v74
    v_rcp_f32 v75, v75
    v_rcp_f32 v76, v76
    v_rcp_f32 v77, v77
    v_rcp_f32 v78, v78
    v_rcp_f32 v79, v79
    s_nop 0
    v_cvt_pk_bf16_f32 v84, v72, v73
    v_cvt_pk_bf16_f32 v85, v74, v75
    v_cvt_pk_bf16_f32 v86, v76, v77
    v_cvt_pk_bf16_f32 v87, v78, v79
    ds_write_b128 v2, v[84:87] offset:19456
    s_waitcnt lgkmcnt(0)
    s_barrier
    ds_read_b128 a[0:3], v6 offset:16896
    ds_read_b128 a[4:7], v6 offset:17952
    ds_read_b128 a[8:11], v6 offset:19008
    ds_read_b128 a[12:15], v6 offset:20064
    v_add_f32 v64, v32, v96
    v_add_f32 v65, v33, v97
    v_add_f32 v66, v34, v98
    v_add_f32 v67, v35, v99
    v_add_f32 v68, v36, v100
    v_add_f32 v69, v37, v101
    v_add_f32 v70, v38, v102
    v_add_f32 v71, v39, v103
    ds_read_b128 v[32:35], v4 offset:25344
    ds_read_b128 v[36:39], v4 offset:25376
    v_exp_f32 v64, v64
    v_exp_f32 v65, v65
    v_exp_f32 v66, v66
    v_exp_f32 v67, v67
    v_exp_f32 v68, v68
    v_exp_f32 v69, v69
    v_exp_f32 v70, v70
    v_exp_f32 v71, v71
    v_add_f32 v64, 1.0, v64
    v_add_f32 v65, 1.0, v65
    v_add_f32 v66, 1.0, v66
    v_add_f32 v67, 1.0, v67
    v_add_f32 v68, 1.0, v68
    v_add_f32 v69, 1.0, v69
    v_add_f32 v70, 1.0, v70
    v_add_f32 v71, 1.0, v71
    v_rcp_f32 v64, v64
    v_rcp_f32 v65, v65
    v_rcp_f32 v66, v66
    v_rcp_f32 v67, v67
    v_rcp_f32 v68, v68
    v_rcp_f32 v69, v69
    v_rcp_f32 v70, v70
    v_rcp_f32 v71, v71
    s_waitcnt lgkmcnt(5)
    s_mov_b32 s36, 16384
    buffer_store_dwordx4 a[0:3], v7, s[16:19], s36 offen sc1
    s_waitcnt lgkmcnt(4)
    s_mov_b32 s36, 17408
    buffer_store_dwordx4 a[4:7], v7, s[16:19], s36 offen sc1
    v_cvt_pk_bf16_f32 v80, v64, v65
    v_cvt_pk_bf16_f32 v81, v66, v67
    v_cvt_pk_bf16_f32 v82, v68, v69
    v_cvt_pk_bf16_f32 v83, v70, v71
    ds_write_b128 v2, v[80:83] offset:32768
    v_add_f32 v72, v40, v104
    v_add_f32 v73, v41, v105
    v_add_f32 v74, v42, v106
    v_add_f32 v75, v43, v107
    v_add_f32 v76, v44, v108
    v_add_f32 v77, v45, v109
    v_add_f32 v78, v46, v110
    v_add_f32 v79, v47, v111
    ds_read_b128 v[40:43], v4 offset:25408
    ds_read_b128 v[44:47], v4 offset:25440
    v_exp_f32 v72, v72
    v_exp_f32 v73, v73
    v_exp_f32 v74, v74
    v_exp_f32 v75, v75
    v_exp_f32 v76, v76
    v_exp_f32 v77, v77
    v_exp_f32 v78, v78
    v_exp_f32 v79, v79
    v_add_f32 v72, 1.0, v72
    v_add_f32 v73, 1.0, v73
    v_add_f32 v74, 1.0, v74
    v_add_f32 v75, 1.0, v75
    v_add_f32 v76, 1.0, v76
    v_add_f32 v77, 1.0, v77
    v_add_f32 v78, 1.0, v78
    v_add_f32 v79, 1.0, v79
    v_rcp_f32 v72, v72
    v_rcp_f32 v73, v73
    v_rcp_f32 v74, v74
    v_rcp_f32 v75, v75
    v_rcp_f32 v76, v76
    v_rcp_f32 v77, v77
    v_rcp_f32 v78, v78
    v_rcp_f32 v79, v79
    s_waitcnt lgkmcnt(6)
    s_mov_b32 s36, 18432
    buffer_store_dwordx4 a[8:11], v7, s[16:19], s36 offen sc1
    s_waitcnt lgkmcnt(5)
    s_mov_b32 s36, 19456
    buffer_store_dwordx4 a[12:15], v7, s[16:19], s36 offen sc1
    v_cvt_pk_bf16_f32 v84, v72, v73
    v_cvt_pk_bf16_f32 v85, v74, v75
    v_cvt_pk_bf16_f32 v86, v76, v77
    v_cvt_pk_bf16_f32 v87, v78, v79
    ds_write_b128 v2, v[84:87] offset:33792
    v_add_f32 v64, v48, v112
    v_add_f32 v65, v49, v113
    v_add_f32 v66, v50, v114
    v_add_f32 v67, v51, v115
    v_add_f32 v68, v52, v116
    v_add_f32 v69, v53, v117
    v_add_f32 v70, v54, v118
    v_add_f32 v71, v55, v119
    ds_read_b128 v[48:51], v4 offset:25472
    ds_read_b128 v[52:55], v4 offset:25504
    v_exp_f32 v64, v64
    v_exp_f32 v65, v65
    v_exp_f32 v66, v66
    v_exp_f32 v67, v67
    v_exp_f32 v68, v68
    v_exp_f32 v69, v69
    v_exp_f32 v70, v70
    v_exp_f32 v71, v71
    v_add_f32 v64, 1.0, v64
    v_add_f32 v65, 1.0, v65
    v_add_f32 v66, 1.0, v66
    v_add_f32 v67, 1.0, v67
    v_add_f32 v68, 1.0, v68
    v_add_f32 v69, 1.0, v69
    v_add_f32 v70, 1.0, v70
    v_add_f32 v71, 1.0, v71
    v_rcp_f32 v64, v64
    v_rcp_f32 v65, v65
    v_rcp_f32 v66, v66
    v_rcp_f32 v67, v67
    v_rcp_f32 v68, v68
    v_rcp_f32 v69, v69
    v_rcp_f32 v70, v70
    v_rcp_f32 v71, v71
    s_nop 0
    v_cvt_pk_bf16_f32 v80, v64, v65
    v_cvt_pk_bf16_f32 v81, v66, v67
    v_cvt_pk_bf16_f32 v82, v68, v69
    v_cvt_pk_bf16_f32 v83, v70, v71
    ds_write_b128 v2, v[80:83] offset:34816
    v_add_f32 v72, v56, v120
    v_add_f32 v73, v57, v121
    v_add_f32 v74, v58, v122
    v_add_f32 v75, v59, v123
    v_add_f32 v76, v60, v124
    v_add_f32 v77, v61, v125
    v_add_f32 v78, v62, v126
    v_add_f32 v79, v63, v127
    ds_read_b128 v[56:59], v4 offset:25536
    ds_read_b128 v[60:63], v4 offset:25568
    v_exp_f32 v72, v72
    v_exp_f32 v73, v73
    v_exp_f32 v74, v74
    v_exp_f32 v75, v75
    v_exp_f32 v76, v76
    v_exp_f32 v77, v77
    v_exp_f32 v78, v78
    v_exp_f32 v79, v79
    v_add_f32 v72, 1.0, v72
    v_add_f32 v73, 1.0, v73
    v_add_f32 v74, 1.0, v74
    v_add_f32 v75, 1.0, v75
    v_add_f32 v76, 1.0, v76
    v_add_f32 v77, 1.0, v77
    v_add_f32 v78, 1.0, v78
    v_add_f32 v79, 1.0, v79
    v_rcp_f32 v72, v72
    v_rcp_f32 v73, v73
    v_rcp_f32 v74, v74
    v_rcp_f32 v75, v75
    v_rcp_f32 v76, v76
    v_rcp_f32 v77, v77
    v_rcp_f32 v78, v78
    v_rcp_f32 v79, v79
    s_nop 0
    v_cvt_pk_bf16_f32 v84, v72, v73
    v_cvt_pk_bf16_f32 v85, v74, v75
    v_cvt_pk_bf16_f32 v86, v76, v77
    v_cvt_pk_bf16_f32 v87, v78, v79
    ds_write_b128 v2, v[84:87] offset:35840
    s_waitcnt lgkmcnt(0)
    s_barrier
    ds_read_b128 a[0:3], v6 offset:0
    ds_read_b128 a[4:7], v6 offset:1056
    ds_read_b128 a[8:11], v6 offset:2112
    ds_read_b128 a[12:15], v6 offset:3168
    v_add_f32 v64, v32, v96
    v_add_f32 v65, v33, v97
    v_add_f32 v66, v34, v98
    v_add_f32 v67, v35, v99
    v_add_f32 v68, v36, v100
    v_add_f32 v69, v37, v101
    v_add_f32 v70, v38, v102
    v_add_f32 v71, v39, v103
    ds_read_b128 v[32:35], v4 offset:29568
    ds_read_b128 v[36:39], v4 offset:29600
    v_exp_f32 v64, v64
    v_exp_f32 v65, v65
    v_exp_f32 v66, v66
    v_exp_f32 v67, v67
    v_exp_f32 v68, v68
    v_exp_f32 v69, v69
    v_exp_f32 v70, v70
    v_exp_f32 v71, v71
    v_add_f32 v64, 1.0, v64
    v_add_f32 v65, 1.0, v65
    v_add_f32 v66, 1.0, v66
    v_add_f32 v67, 1.0, v67
    v_add_f32 v68, 1.0, v68
    v_add_f32 v69, 1.0, v69
    v_add_f32 v70, 1.0, v70
    v_add_f32 v71, 1.0, v71
    v_rcp_f32 v64, v64
    v_rcp_f32 v65, v65
    v_rcp_f32 v66, v66
    v_rcp_f32 v67, v67
    v_rcp_f32 v68, v68
    v_rcp_f32 v69, v69
    v_rcp_f32 v70, v70
    v_rcp_f32 v71, v71
    s_waitcnt lgkmcnt(5)
    s_mov_b32 s36, 32768
    buffer_store_dwordx4 a[0:3], v7, s[16:19], s36 offen sc1
    s_waitcnt lgkmcnt(4)
    s_mov_b32 s36, 33792
    buffer_store_dwordx4 a[4:7], v7, s[16:19], s36 offen sc1
    v_cvt_pk_bf16_f32 v80, v64, v65
    v_cvt_pk_bf16_f32 v81, v66, v67
    v_cvt_pk_bf16_f32 v82, v68, v69
    v_cvt_pk_bf16_f32 v83, v70, v71
    ds_write_b128 v2, v[80:83] offset:0
    v_add_f32 v72, v40, v104
    v_add_f32 v73, v41, v105
    v_add_f32 v74, v42, v106
    v_add_f32 v75, v43, v107
    v_add_f32 v76, v44, v108
    v_add_f32 v77, v45, v109
    v_add_f32 v78, v46, v110
    v_add_f32 v79, v47, v111
    ds_read_b128 v[40:43], v4 offset:29632
    ds_read_b128 v[44:47], v4 offset:29664
    v_exp_f32 v72, v72
    v_exp_f32 v73, v73
    v_exp_f32 v74, v74
    v_exp_f32 v75, v75
    v_exp_f32 v76, v76
    v_exp_f32 v77, v77
    v_exp_f32 v78, v78
    v_exp_f32 v79, v79
    v_add_f32 v72, 1.0, v72
    v_add_f32 v73, 1.0, v73
    v_add_f32 v74, 1.0, v74
    v_add_f32 v75, 1.0, v75
    v_add_f32 v76, 1.0, v76
    v_add_f32 v77, 1.0, v77
    v_add_f32 v78, 1.0, v78
    v_add_f32 v79, 1.0, v79
    v_rcp_f32 v72, v72
    v_rcp_f32 v73, v73
    v_rcp_f32 v74, v74
    v_rcp_f32 v75, v75
    v_rcp_f32 v76, v76
    v_rcp_f32 v77, v77
    v_rcp_f32 v78, v78
    v_rcp_f32 v79, v79
    s_waitcnt lgkmcnt(6)
    s_mov_b32 s36, 34816
    buffer_store_dwordx4 a[8:11], v7, s[16:19], s36 offen sc1
    s_waitcnt lgkmcnt(5)
    s_mov_b32 s36, 35840
    buffer_store_dwordx4 a[12:15], v7, s[16:19], s36 offen sc1
    v_cvt_pk_bf16_f32 v84, v72, v73
    v_cvt_pk_bf16_f32 v85, v74, v75
    v_cvt_pk_bf16_f32 v86, v76, v77
    v_cvt_pk_bf16_f32 v87, v78, v79
    ds_write_b128 v2, v[84:87] offset:1024
    v_add_f32 v64, v48, v112
    v_add_f32 v65, v49, v113
    v_add_f32 v66, v50, v114
    v_add_f32 v67, v51, v115
    v_add_f32 v68, v52, v116
    v_add_f32 v69, v53, v117
    v_add_f32 v70, v54, v118
    v_add_f32 v71, v55, v119
    ds_read_b128 v[48:51], v4 offset:29696
    ds_read_b128 v[52:55], v4 offset:29728
    v_exp_f32 v64, v64
    v_exp_f32 v65, v65
    v_exp_f32 v66, v66
    v_exp_f32 v67, v67
    v_exp_f32 v68, v68
    v_exp_f32 v69, v69
    v_exp_f32 v70, v70
    v_exp_f32 v71, v71
    v_add_f32 v64, 1.0, v64
    v_add_f32 v65, 1.0, v65
    v_add_f32 v66, 1.0, v66
    v_add_f32 v67, 1.0, v67
    v_add_f32 v68, 1.0, v68
    v_add_f32 v69, 1.0, v69
    v_add_f32 v70, 1.0, v70
    v_add_f32 v71, 1.0, v71
    v_rcp_f32 v64, v64
    v_rcp_f32 v65, v65
    v_rcp_f32 v66, v66
    v_rcp_f32 v67, v67
    v_rcp_f32 v68, v68
    v_rcp_f32 v69, v69
    v_rcp_f32 v70, v70
    v_rcp_f32 v71, v71
    s_nop 0
    v_cvt_pk_bf16_f32 v80, v64, v65
    v_cvt_pk_bf16_f32 v81, v66, v67
    v_cvt_pk_bf16_f32 v82, v68, v69
    v_cvt_pk_bf16_f32 v83, v70, v71
    ds_write_b128 v2, v[80:83] offset:2048
    v_add_f32 v72, v56, v120
    v_add_f32 v73, v57, v121
    v_add_f32 v74, v58, v122
    v_add_f32 v75, v59, v123
    v_add_f32 v76, v60, v124
    v_add_f32 v77, v61, v125
    v_add_f32 v78, v62, v126
    v_add_f32 v79, v63, v127
    ds_read_b128 v[56:59], v4 offset:29760
    ds_read_b128 v[60:63], v4 offset:29792
    v_exp_f32 v72, v72
    v_exp_f32 v73, v73
    v_exp_f32 v74, v74
    v_exp_f32 v75, v75
    v_exp_f32 v76, v76
    v_exp_f32 v77, v77
    v_exp_f32 v78, v78
    v_exp_f32 v79, v79
    v_add_f32 v72, 1.0, v72
    v_add_f32 v73, 1.0, v73
    v_add_f32 v74, 1.0, v74
    v_add_f32 v75, 1.0, v75
    v_add_f32 v76, 1.0, v76
    v_add_f32 v77, 1.0, v77
    v_add_f32 v78, 1.0, v78
    v_add_f32 v79, 1.0, v79
    v_rcp_f32 v72, v72
    v_rcp_f32 v73, v73
    v_rcp_f32 v74, v74
    v_rcp_f32 v75, v75
    v_rcp_f32 v76, v76
    v_rcp_f32 v77, v77
    v_rcp_f32 v78, v78
    v_rcp_f32 v79, v79
    s_nop 0
    v_cvt_pk_bf16_f32 v84, v72, v73
    v_cvt_pk_bf16_f32 v85, v74, v75
    v_cvt_pk_bf16_f32 v86, v76, v77
    v_cvt_pk_bf16_f32 v87, v78, v79
    ds_write_b128 v2, v[84:87] offset:3072
    s_waitcnt lgkmcnt(0)
    s_barrier
    ds_read_b128 a[0:3], v6 offset:16896
    ds_read_b128 a[4:7], v6 offset:17952
    ds_read_b128 a[8:11], v6 offset:19008
    ds_read_b128 a[12:15], v6 offset:20064
    v_add_f32 v64, v32, v96
    v_add_f32 v65, v33, v97
    v_add_f32 v66, v34, v98
    v_add_f32 v67, v35, v99
    v_add_f32 v68, v36, v100
    v_add_f32 v69, v37, v101
    v_add_f32 v70, v38, v102
    v_add_f32 v71, v39, v103
    v_exp_f32 v64, v64
    v_exp_f32 v65, v65
    v_exp_f32 v66, v66
    v_exp_f32 v67, v67
    v_exp_f32 v68, v68
    v_exp_f32 v69, v69
    v_exp_f32 v70, v70
    v_exp_f32 v71, v71
    v_add_f32 v64, 1.0, v64
    v_add_f32 v65, 1.0, v65
    v_add_f32 v66, 1.0, v66
    v_add_f32 v67, 1.0, v67
    v_add_f32 v68, 1.0, v68
    v_add_f32 v69, 1.0, v69
    v_add_f32 v70, 1.0, v70
    v_add_f32 v71, 1.0, v71
    v_rcp_f32 v64, v64
    v_rcp_f32 v65, v65
    v_rcp_f32 v66, v66
    v_rcp_f32 v67, v67
    v_rcp_f32 v68, v68
    v_rcp_f32 v69, v69
    v_rcp_f32 v70, v70
    v_rcp_f32 v71, v71
    s_waitcnt lgkmcnt(3)
    s_mov_b32 s36, 49152
    buffer_store_dwordx4 a[0:3], v7, s[16:19], s36 offen sc1
    s_waitcnt lgkmcnt(2)
    s_mov_b32 s36, 50176
    buffer_store_dwordx4 a[4:7], v7, s[16:19], s36 offen sc1
    v_cvt_pk_bf16_f32 v80, v64, v65
    v_cvt_pk_bf16_f32 v81, v66, v67
    v_cvt_pk_bf16_f32 v82, v68, v69
    v_cvt_pk_bf16_f32 v83, v70, v71
    ds_write_b128 v2, v[80:83] offset:16384
    v_add_f32 v72, v40, v104
    v_add_f32 v73, v41, v105
    v_add_f32 v74, v42, v106
    v_add_f32 v75, v43, v107
    v_add_f32 v76, v44, v108
    v_add_f32 v77, v45, v109
    v_add_f32 v78, v46, v110
    v_add_f32 v79, v47, v111
    v_exp_f32 v72, v72
    v_exp_f32 v73, v73
    v_exp_f32 v74, v74
    v_exp_f32 v75, v75
    v_exp_f32 v76, v76
    v_exp_f32 v77, v77
    v_exp_f32 v78, v78
    v_exp_f32 v79, v79
    v_add_f32 v72, 1.0, v72
    v_add_f32 v73, 1.0, v73
    v_add_f32 v74, 1.0, v74
    v_add_f32 v75, 1.0, v75
    v_add_f32 v76, 1.0, v76
    v_add_f32 v77, 1.0, v77
    v_add_f32 v78, 1.0, v78
    v_add_f32 v79, 1.0, v79
    v_rcp_f32 v72, v72
    v_rcp_f32 v73, v73
    v_rcp_f32 v74, v74
    v_rcp_f32 v75, v75
    v_rcp_f32 v76, v76
    v_rcp_f32 v77, v77
    v_rcp_f32 v78, v78
    v_rcp_f32 v79, v79
    s_waitcnt lgkmcnt(2)
    s_mov_b32 s36, 51200
    buffer_store_dwordx4 a[8:11], v7, s[16:19], s36 offen sc1
    s_waitcnt lgkmcnt(1)
    s_mov_b32 s36, 52224
    buffer_store_dwordx4 a[12:15], v7, s[16:19], s36 offen sc1
    v_cvt_pk_bf16_f32 v84, v72, v73
    v_cvt_pk_bf16_f32 v85, v74, v75
    v_cvt_pk_bf16_f32 v86, v76, v77
    v_cvt_pk_bf16_f32 v87, v78, v79
    ds_write_b128 v2, v[84:87] offset:17408
    v_add_f32 v64, v48, v112
    v_add_f32 v65, v49, v113
    v_add_f32 v66, v50, v114
    v_add_f32 v67, v51, v115
    v_add_f32 v68, v52, v116
    v_add_f32 v69, v53, v117
    v_add_f32 v70, v54, v118
    v_add_f32 v71, v55, v119
    v_exp_f32 v64, v64
    v_exp_f32 v65, v65
    v_exp_f32 v66, v66
    v_exp_f32 v67, v67
    v_exp_f32 v68, v68
    v_exp_f32 v69, v69
    v_exp_f32 v70, v70
    v_exp_f32 v71, v71
    v_add_f32 v64, 1.0, v64
    v_add_f32 v65, 1.0, v65
    v_add_f32 v66, 1.0, v66
    v_add_f32 v67, 1.0, v67
    v_add_f32 v68, 1.0, v68
    v_add_f32 v69, 1.0, v69
    v_add_f32 v70, 1.0, v70
    v_add_f32 v71, 1.0, v71
    v_rcp_f32 v64, v64
    v_rcp_f32 v65, v65
    v_rcp_f32 v66, v66
    v_rcp_f32 v67, v67
    v_rcp_f32 v68, v68
    v_rcp_f32 v69, v69
    v_rcp_f32 v70, v70
    v_rcp_f32 v71, v71
    s_nop 0
    v_cvt_pk_bf16_f32 v80, v64, v65
    v_cvt_pk_bf16_f32 v81, v66, v67
    v_cvt_pk_bf16_f32 v82, v68, v69
    v_cvt_pk_bf16_f32 v83, v70, v71
    ds_write_b128 v2, v[80:83] offset:18432
    v_add_f32 v72, v56, v120
    v_add_f32 v73, v57, v121
    v_add_f32 v74, v58, v122
    v_add_f32 v75, v59, v123
    v_add_f32 v76, v60, v124
    v_add_f32 v77, v61, v125
    v_add_f32 v78, v62, v126
    v_add_f32 v79, v63, v127
    v_exp_f32 v72, v72
    v_exp_f32 v73, v73
    v_exp_f32 v74, v74
    v_exp_f32 v75, v75
    v_exp_f32 v76, v76
    v_exp_f32 v77, v77
    v_exp_f32 v78, v78
    v_exp_f32 v79, v79
    v_add_f32 v72, 1.0, v72
    v_add_f32 v73, 1.0, v73
    v_add_f32 v74, 1.0, v74
    v_add_f32 v75, 1.0, v75
    v_add_f32 v76, 1.0, v76
    v_add_f32 v77, 1.0, v77
    v_add_f32 v78, 1.0, v78
    v_add_f32 v79, 1.0, v79
    v_rcp_f32 v72, v72
    v_rcp_f32 v73, v73
    v_rcp_f32 v74, v74
    v_rcp_f32 v75, v75
    v_rcp_f32 v76, v76
    v_rcp_f32 v77, v77
    v_rcp_f32 v78, v78
    v_rcp_f32 v79, v79
    s_nop 0
    v_cvt_pk_bf16_f32 v84, v72, v73
    v_cvt_pk_bf16_f32 v85, v74, v75
    v_cvt_pk_bf16_f32 v86, v76, v77
    v_cvt_pk_bf16_f32 v87, v78, v79
    ds_write_b128 v2, v[84:87] offset:19456
    s_waitcnt lgkmcnt(0)
    s_barrier
    ds_read_b128 a[0:3], v6 offset:0
    ds_read_b128 a[4:7], v6 offset:1056
    ds_read_b128 a[8:11], v6 offset:2112
    ds_read_b128 a[12:15], v6 offset:3168
    s_waitcnt lgkmcnt(3)
    s_mov_b32 s36, 65536
    buffer_store_dwordx4 a[0:3], v7, s[16:19], s36 offen sc1
    s_waitcnt lgkmcnt(2)
    s_mov_b32 s36, 66560
    buffer_store_dwordx4 a[4:7], v7, s[16:19], s36 offen sc1
    s_waitcnt lgkmcnt(1)
    s_mov_b32 s36, 67584
    buffer_store_dwordx4 a[8:11], v7, s[16:19], s36 offen sc1
    s_waitcnt lgkmcnt(0)
    s_mov_b32 s36, 68608
    buffer_store_dwordx4 a[12:15], v7, s[16:19], s36 offen sc1
    s_barrier
    ds_read_b128 a[0:3], v6 offset:16896
    ds_read_b128 a[4:7], v6 offset:17952
    ds_read_b128 a[8:11], v6 offset:19008
    ds_read_b128 a[12:15], v6 offset:20064
    s_waitcnt lgkmcnt(3)
    s_mov_b32 s36, 81920
    buffer_store_dwordx4 a[0:3], v7, s[16:19], s36 offen sc1
    s_waitcnt lgkmcnt(2)
    s_mov_b32 s36, 82944
    buffer_store_dwordx4 a[4:7], v7, s[16:19], s36 offen sc1
    s_waitcnt lgkmcnt(1)
    s_mov_b32 s36, 83968
    buffer_store_dwordx4 a[8:11], v7, s[16:19], s36 offen sc1
    s_waitcnt lgkmcnt(0)
    s_mov_b32 s36, 84992
    buffer_store_dwordx4 a[12:15], v7, s[16:19], s36 offen sc1
    s_barrier
    ds_read_b128 a[0:3], v6 offset:0
    ds_read_b128 a[4:7], v6 offset:1056
    ds_read_b128 a[8:11], v6 offset:2112
    ds_read_b128 a[12:15], v6 offset:3168
    s_waitcnt lgkmcnt(3)
    s_mov_b32 s36, 98304
    buffer_store_dwordx4 a[0:3], v7, s[16:19], s36 offen sc1
    s_waitcnt lgkmcnt(2)
    s_mov_b32 s36, 99328
    buffer_store_dwordx4 a[4:7], v7, s[16:19], s36 offen sc1
    s_waitcnt lgkmcnt(1)
    s_mov_b32 s36, 100352
    buffer_store_dwordx4 a[8:11], v7, s[16:19], s36 offen sc1
    s_waitcnt lgkmcnt(0)
    s_mov_b32 s36, 101376
    buffer_store_dwordx4 a[12:15], v7, s[16:19], s36 offen sc1
    s_barrier
    ds_read_b128 a[0:3], v6 offset:16896
    ds_read_b128 a[4:7], v6 offset:17952
    ds_read_b128 a[8:11], v6 offset:19008
    ds_read_b128 a[12:15], v6 offset:20064
    s_waitcnt lgkmcnt(3)
    s_mov_b32 s36, 114688
    buffer_store_dwordx4 a[0:3], v7, s[16:19], s36 offen sc1
    s_waitcnt lgkmcnt(2)
    s_mov_b32 s36, 115712
    buffer_store_dwordx4 a[4:7], v7, s[16:19], s36 offen sc1
    s_waitcnt lgkmcnt(1)
    s_mov_b32 s36, 116736
    buffer_store_dwordx4 a[8:11], v7, s[16:19], s36 offen sc1
    s_waitcnt lgkmcnt(0)
    s_mov_b32 s36, 117760
    buffer_store_dwordx4 a[12:15], v7, s[16:19], s36 offen sc1
    s_endpgm
L_joint_kernel_done:
    s_endpgm
.section .rodata,"a"
.p2align 6
.amdhsa_kernel prep_kernel
  .amdhsa_next_free_vgpr 128
  .amdhsa_next_free_sgpr 102
  .amdhsa_accum_offset 128
  .amdhsa_group_segment_fixed_size 0
  .amdhsa_kernarg_size 80
  .amdhsa_user_sgpr_count 2
  .amdhsa_user_sgpr_kernarg_segment_ptr 1
  .amdhsa_system_sgpr_workgroup_id_x 1
.end_amdhsa_kernel
.p2align 6
.amdhsa_kernel gemm1_kernel
  .amdhsa_next_free_vgpr 232
  .amdhsa_next_free_sgpr 102
  .amdhsa_accum_offset 232
  .amdhsa_group_segment_fixed_size 0
  .amdhsa_kernarg_size 80
  .amdhsa_user_sgpr_count 2
  .amdhsa_user_sgpr_kernarg_segment_ptr 1
  .amdhsa_system_sgpr_workgroup_id_x 1
.end_amdhsa_kernel
.p2align 6
.amdhsa_kernel mid_kernel
  .amdhsa_next_free_vgpr 128
  .amdhsa_next_free_sgpr 102
  .amdhsa_accum_offset 128
  .amdhsa_group_segment_fixed_size 0
  .amdhsa_kernarg_size 80
  .amdhsa_user_sgpr_count 2
  .amdhsa_user_sgpr_kernarg_segment_ptr 1
  .amdhsa_system_sgpr_workgroup_id_x 1
.end_amdhsa_kernel
.p2align 6
.amdhsa_kernel gemm2_kernel
  .amdhsa_next_free_vgpr 152
  .amdhsa_next_free_sgpr 102
  .amdhsa_accum_offset 152
  .amdhsa_group_segment_fixed_size 0
  .amdhsa_kernarg_size 80
  .amdhsa_user_sgpr_count 2
  .amdhsa_user_sgpr_kernarg_segment_ptr 1
  .amdhsa_system_sgpr_workgroup_id_x 1
.end_amdhsa_kernel
.p2align 6
.amdhsa_kernel joint_kernel
  .amdhsa_next_free_vgpr 256
  .amdhsa_next_free_sgpr 102
  .amdhsa_accum_offset 128
  .amdhsa_group_segment_fixed_size 0
  .amdhsa_kernarg_size 80
  .amdhsa_user_sgpr_count 2
  .amdhsa_user_sgpr_kernarg_segment_ptr 1
  .amdhsa_system_sgpr_workgroup_id_x 1
.end_amdhsa_kernel
```

```asm
; @launch kernel=prep_kernel grid=(941,1,1) block=(256,1,1) lds=40960
; @launch kernel=gemm1_kernel grid=(256,1,1) block=(512,1,1) lds=143360
; @launch kernel=mid_kernel grid=(704,1,1) block=(256,1,1) lds=53248
; @launch kernel=gemm2_kernel grid=(256,1,1) block=(512,1,1) lds=143360
; @launch kernel=joint_kernel grid=(256,1,1) block=(512,1,1) lds=149504
.amdgcn_target "amdgcn-amd-amdhsa--gfx950"
.text
.globl prep_kernel
.p2align 8
.type prep_kernel,@function
prep_kernel:
    s_cmp_ge_u32 s2, 941
    s_cbranch_scc1 L_prep_kernel_done
    v_readfirstlane_b32 s20, v0
    s_lshr_b32 s20, s20, 6
    s_cmp_lt_u32 s2, 13
    s_cbranch_scc1 L_prep_kernel_slab
    s_cmp_lt_u32 s2, 269
    s_cbranch_scc1 L_prep_kernel_g
    s_load_dwordx2 s[4:5], s[0:1], 0
    s_load_dwordx2 s[6:7], s[0:1], 72
    s_sub_u32 s24, s2, 269
    s_and_b32 s25, s24, 7
    s_mul_i32 s25, s25, 84
    s_lshr_b32 s24, s24, 3
    s_add_u32 s24, s24, s25
    s_cmp_ge_u32 s24, 668
    s_cbranch_scc1 L_prep_kernel_done
    s_mul_hi_u32 s25, s24, 25718368
    s_mul_i32 s26, s25, 167
    s_sub_u32 s26, s24, s26
    s_and_b32 s27, s25, 1
    s_lshr_b32 s25, s25, 1
    v_and_b32 v1, 63, v0
    v_lshrrev_b32 v2, 3, v1
    s_mul_i32 s28, s26, 96
    s_add_u32 s28, s28, s27
    s_sub_u32 s28, s28, 15
    v_lshlrev_b32 v3, 1, v2
    v_add_u32 v3, s28, v3
    v_lshlrev_b32 v3, 9, v3
    s_lshl_b32 s29, s20, 7
    v_add_u32 v3, s29, v3
    v_bfe_u32 v4, v2, 1, 1
    v_lshlrev_b32 v4, 1, v4
    v_and_b32 v5, 7, v1
    v_xor_b32 v4, v4, v5
    v_lshl_add_u32 v3, v4, 4, v3
    v_xor_b32 v4, 64, v3
    s_waitcnt lgkmcnt(0)
    s_mul_i32 s30, s25, 8192000
    s_add_u32 s8, s4, s30
    s_addc_u32 s9, s5, 0
    s_mov_b32 s10, 8192000
    s_mov_b32 s11, 0x00020000
    s_lshl_b32 s31, s20, 13
    s_add_u32 m0, s31, 0
    v_add_u32 v5, 0, v3
    buffer_load_dwordx4 v5, s[8:11], 0 offen nt lds
    s_add_u32 m0, s31, 1024
    v_add_u32 v5, 8192, v4
    buffer_load_dwordx4 v5, s[8:11], 0 offen nt lds
    s_add_u32 m0, s31, 2048
    v_add_u32 v5, 16384, v3
    buffer_load_dwordx4 v5, s[8:11], 0 offen nt lds
    s_add_u32 m0, s31, 3072
    v_add_u32 v5, 24576, v4
    buffer_load_dwordx4 v5, s[8:11], 0 offen nt lds
    s_add_u32 m0, s31, 4096
    v_add_u32 v5, 32768, v3
    buffer_load_dwordx4 v5, s[8:11], 0 offen nt lds
    s_add_u32 m0, s31, 5120
    v_add_u32 v5, 40960, v4
    buffer_load_dwordx4 v5, s[8:11], 0 offen nt lds
    s_add_u32 m0, s31, 6144
    v_add_u32 v5, 49152, v3
    buffer_load_dwordx4 v5, s[8:11], 0 offen nt lds
    s_add_u32 m0, s31, 7168
    v_add_u32 v5, 57344, v4
    buffer_load_dwordx4 v5, s[8:11], 0 offen nt lds
    s_add_u32 s12, s6, 0
    s_addc_u32 s13, s7, 0
    s_mov_b32 s14, 21889024
    s_mov_b32 s15, 0x00020000
    v_mov_b32 v8, v1
    s_lshl_b32 s32, s20, 4
    v_lshlrev_b32 v6, 4, v1
    s_lshl_b32 s33, s20, 11
    v_add_u32 v7, s33, v6
    v_and_b32 v9, 15, v8
    v_lshrrev_b32 v10, 4, v8
    v_or_b32 v11, 1, v9
    v_add_u32 v11, s32, v11
    v_cvt_f32_u32 v11, v11
    v_mul_f32 v11, 0x3c000000, v11
    v_lshlrev_b32 v10, 3, v10
    v_add_u32 v10, 0, v10
    v_cvt_f32_u32 v10, v10
    v_and_b32 v9, 1, v9
    v_cvt_f32_u32 v9, v9
    v_mul_f32 v9, 0x3e800000, v9
    v_fma_f32 v12, v11, v10, v9
    v_fract_f32 v13, v12
    v_add_f32 v12, v12, v11
    v_fract_f32 v14, v12
    v_add_f32 v12, v12, v11
    v_fract_f32 v15, v12
    v_add_f32 v12, v12, v11
    v_fract_f32 v16, v12
    v_add_f32 v12, v12, v11
    v_fract_f32 v17, v12
    v_add_f32 v12, v12, v11
    v_fract_f32 v18, v12
    v_add_f32 v12, v12, v11
    v_fract_f32 v19, v12
    v_add_f32 v12, v12, v11
    v_fract_f32 v20, v12
    v_cos_f32 v13, v13
    v_cos_f32 v14, v14
    v_cos_f32 v15, v15
    v_cos_f32 v16, v16
    v_cos_f32 v17, v17
    v_cos_f32 v18, v18
    v_cos_f32 v19, v19
    v_cos_f32 v20, v20
    s_nop 0
    v_cvt_pk_bf16_f32 v24, v13, v14
    v_cvt_pk_bf16_f32 v25, v15, v16
    v_cvt_pk_bf16_f32 v26, v17, v18
    v_cvt_pk_bf16_f32 v27, v19, v20
    ds_write_b128 v7, v[24:27] offset:32768
    v_and_b32 v9, 15, v8
    v_lshrrev_b32 v10, 4, v8
    v_or_b32 v11, 1, v9
    v_add_u32 v11, s32, v11
    v_cvt_f32_u32 v11, v11
    v_mul_f32 v11, 0x3c000000, v11
    v_lshlrev_b32 v10, 3, v10
    v_add_u32 v10, 32, v10
    v_cvt_f32_u32 v10, v10
    v_and_b32 v9, 1, v9
    v_cvt_f32_u32 v9, v9
    v_mul_f32 v9, 0x3e800000, v9
    v_fma_f32 v12, v11, v10, v9
    v_fract_f32 v13, v12
    v_add_f32 v12, v12, v11
    v_fract_f32 v14, v12
    v_add_f32 v12, v12, v11
    v_fract_f32 v15, v12
    v_add_f32 v12, v12, v11
    v_fract_f32 v16, v12
    v_add_f32 v12, v12, v11
    v_fract_f32 v17, v12
    v_add_f32 v12, v12, v11
    v_fract_f32 v18, v12
    v_add_f32 v12, v12, v11
    v_fract_f32 v19, v12
    v_add_f32 v12, v12, v11
    v_fract_f32 v20, v12
    v_cos_f32 v13, v13
    v_cos_f32 v14, v14
    v_cos_f32 v15, v15
    v_cos_f32 v16, v16
    v_cos_f32 v17, v17
    v_cos_f32 v18, v18
    v_cos_f32 v19, v19
    v_cos_f32 v20, v20
    s_nop 0
    v_cvt_pk_bf16_f32 v28, v13, v14
    v_cvt_pk_bf16_f32 v29, v15, v16
    v_cvt_pk_bf16_f32 v30, v17, v18
    v_cvt_pk_bf16_f32 v31, v19, v20
    ds_write_b128 v7, v[28:31] offset:33792
    v_bfe_u32 v8, v1, 2, 2
    v_lshrrev_b32 v9, 4, v1
    v_lshl_add_u32 v10, v9, 3, v8
    v_lshlrev_b32 v10, 7, v10
    v_lshrrev_b32 v8, 1, v8
    v_and_b32 v11, 1, v9
    v_lshl_add_u32 v8, v11, 1, v8
    v_lshlrev_b32 v8, 1, v8
    v_bfe_u32 v11, v1, 1, 1
    v_xor_b32 v8, v8, v11
    v_lshl_add_u32 v10, v8, 4, v10
    v_and_b32 v11, 1, v1
    v_lshl_add_u32 v10, v11, 3, v10
    v_add_u32 v10, s31, v10
    v_xor_b32 v12, 0, v10
    v_xor_b32 v13, 32, v10
    v_xor_b32 v14, 64, v10
    v_xor_b32 v15, 96, v10
    v_bfe_u32 v8, v1, 1, 3
    s_mov_b32 s33, 684032
    v_mul_lo_u32 v8, v8, s33
    v_and_b32 v11, 1, v1
    v_lshl_add_u32 v8, v11, 6, v8
    v_lshl_add_u32 v16, v9, 4, v8
    s_mul_i32 s34, s25, 167
    s_add_u32 s34, s34, s26
    s_lshl_b32 s34, s34, 11
    s_lshl_b32 s35, s27, 3
    s_lshl_b32 s36, s20, 1
    s_add_u32 s35, s35, s36
    s_lshl_b32 s35, s35, 7
    s_add_u32 s34, s34, s35
    s_waitcnt lgkmcnt(0)
    s_barrier
    ds_read_b128 v[24:27], v6 offset:32768
    ds_read_b128 v[28:31], v6 offset:33792
    ds_read_b128 v[32:35], v6 offset:34816
    ds_read_b128 v[36:39], v6 offset:35840
    ds_read_b128 v[40:43], v6 offset:36864
    ds_read_b128 v[44:47], v6 offset:37888
    ds_read_b128 v[48:51], v6 offset:38912
    ds_read_b128 v[52:55], v6 offset:39936
    s_waitcnt vmcnt(0)
    ds_read_b64_tr_b16 v[56:57], v12 offset:0
    ds_read_b64_tr_b16 v[58:59], v12 offset:512
    ds_read_b64_tr_b16 v[60:61], v12 offset:4096
    ds_read_b64_tr_b16 v[62:63], v12 offset:4608
    ds_read_b64_tr_b16 v[64:65], v13 offset:0
    ds_read_b64_tr_b16 v[66:67], v13 offset:512
    ds_read_b64_tr_b16 v[68:69], v13 offset:4096
    ds_read_b64_tr_b16 v[70:71], v13 offset:4608
    s_waitcnt lgkmcnt(0)
    v_mfma_f32_16x16x32_bf16 v[72:75], v[56:59], v[24:27], 0
    v_mfma_f32_16x16x32_bf16 v[76:79], v[56:59], v[32:35], 0
    v_mfma_f32_16x16x32_bf16 v[80:83], v[56:59], v[40:43], 0
    v_mfma_f32_16x16x32_bf16 v[84:87], v[56:59], v[48:51], 0
    v_mfma_f32_16x16x32_bf16 v[88:91], v[64:67], v[24:27], 0
    v_mfma_f32_16x16x32_bf16 v[92:95], v[64:67], v[32:35], 0
    v_mfma_f32_16x16x32_bf16 v[96:99], v[64:67], v[40:43], 0
    v_mfma_f32_16x16x32_bf16 v[100:103], v[64:67], v[48:51], 0
    v_mfma_f32_16x16x32_bf16 v[72:75], v[60:63], v[28:31], v[72:75]
    v_mfma_f32_16x16x32_bf16 v[76:79], v[60:63], v[36:39], v[76:79]
    v_mfma_f32_16x16x32_bf16 v[80:83], v[60:63], v[44:47], v[80:83]
    v_mfma_f32_16x16x32_bf16 v[84:87], v[60:63], v[52:55], v[84:87]
    v_mfma_f32_16x16x32_bf16 v[88:91], v[68:71], v[28:31], v[88:91]
    v_mfma_f32_16x16x32_bf16 v[92:95], v[68:71], v[36:39], v[92:95]
    v_mfma_f32_16x16x32_bf16 v[96:99], v[68:71], v[44:47], v[96:99]
    v_mfma_f32_16x16x32_bf16 v[100:103], v[68:71], v[52:55], v[100:103]
    s_nop 7
    v_cvt_pk_bf16_f32 v104, v72, v73
    v_cvt_pk_bf16_f32 v105, v74, v75
    v_cvt_pk_bf16_f32 v106, v88, v89
    v_cvt_pk_bf16_f32 v107, v90, v91
    s_add_u32 s35, s34, 0
    buffer_store_dwordx4 v[104:107], v16, s[12:15], s35 offen sc1
    s_nop 1
    v_cvt_pk_bf16_f32 v108, v76, v77
    v_cvt_pk_bf16_f32 v109, v78, v79
    v_cvt_pk_bf16_f32 v110, v92, v93
    v_cvt_pk_bf16_f32 v111, v94, v95
    s_add_u32 s35, s34, 5472256
    buffer_store_dwordx4 v[108:111], v16, s[12:15], s35 offen sc1
    s_nop 1
    v_cvt_pk_bf16_f32 v104, v80, v81
    v_cvt_pk_bf16_f32 v105, v82, v83
    v_cvt_pk_bf16_f32 v106, v96, v97
    v_cvt_pk_bf16_f32 v107, v98, v99
    s_add_u32 s35, s34, 10944512
    buffer_store_dwordx4 v[104:107], v16, s[12:15], s35 offen sc1
    s_nop 1
    v_cvt_pk_bf16_f32 v108, v84, v85
    v_cvt_pk_bf16_f32 v109, v86, v87
    v_cvt_pk_bf16_f32 v110, v100, v101
    v_cvt_pk_bf16_f32 v111, v102, v103
    s_add_u32 s35, s34, 16416768
    buffer_store_dwordx4 v[108:111], v16, s[12:15], s35 offen sc1
    s_nop 1
    ds_read_b64_tr_b16 v[56:57], v14 offset:0
    ds_read_b64_tr_b16 v[58:59], v14 offset:512
    ds_read_b64_tr_b16 v[60:61], v14 offset:4096
    ds_read_b64_tr_b16 v[62:63], v14 offset:4608
    ds_read_b64_tr_b16 v[64:65], v15 offset:0
    ds_read_b64_tr_b16 v[66:67], v15 offset:512
    ds_read_b64_tr_b16 v[68:69], v15 offset:4096
    ds_read_b64_tr_b16 v[70:71], v15 offset:4608
    s_waitcnt lgkmcnt(0)
    v_mfma_f32_16x16x32_bf16 v[72:75], v[56:59], v[24:27], 0
    v_mfma_f32_16x16x32_bf16 v[76:79], v[56:59], v[32:35], 0
    v_mfma_f32_16x16x32_bf16 v[80:83], v[56:59], v[40:43], 0
    v_mfma_f32_16x16x32_bf16 v[84:87], v[56:59], v[48:51], 0
    v_mfma_f32_16x16x32_bf16 v[88:91], v[64:67], v[24:27], 0
    v_mfma_f32_16x16x32_bf16 v[92:95], v[64:67], v[32:35], 0
    v_mfma_f32_16x16x32_bf16 v[96:99], v[64:67], v[40:43], 0
    v_mfma_f32_16x16x32_bf16 v[100:103], v[64:67], v[48:51], 0
    v_mfma_f32_16x16x32_bf16 v[72:75], v[60:63], v[28:31], v[72:75]
    v_mfma_f32_16x16x32_bf16 v[76:79], v[60:63], v[36:39], v[76:79]
    v_mfma_f32_16x16x32_bf16 v[80:83], v[60:63], v[44:47], v[80:83]
    v_mfma_f32_16x16x32_bf16 v[84:87], v[60:63], v[52:55], v[84:87]
    v_mfma_f32_16x16x32_bf16 v[88:91], v[68:71], v[28:31], v[88:91]
    v_mfma_f32_16x16x32_bf16 v[92:95], v[68:71], v[36:39], v[92:95]
    v_mfma_f32_16x16x32_bf16 v[96:99], v[68:71], v[44:47], v[96:99]
    v_mfma_f32_16x16x32_bf16 v[100:103], v[68:71], v[52:55], v[100:103]
    s_nop 7
    v_cvt_pk_bf16_f32 v104, v72, v73
    v_cvt_pk_bf16_f32 v105, v74, v75
    v_cvt_pk_bf16_f32 v106, v88, v89
    v_cvt_pk_bf16_f32 v107, v90, v91
    s_add_u32 s35, s34, 128
    buffer_store_dwordx4 v[104:107], v16, s[12:15], s35 offen sc1
    s_nop 1
    v_cvt_pk_bf16_f32 v108, v76, v77
    v_cvt_pk_bf16_f32 v109, v78, v79
    v_cvt_pk_bf16_f32 v110, v92, v93
    v_cvt_pk_bf16_f32 v111, v94, v95
    s_add_u32 s35, s34, 5472384
    buffer_store_dwordx4 v[108:111], v16, s[12:15], s35 offen sc1
    s_nop 1
    v_cvt_pk_bf16_f32 v104, v80, v81
    v_cvt_pk_bf16_f32 v105, v82, v83
    v_cvt_pk_bf16_f32 v106, v96, v97
    v_cvt_pk_bf16_f32 v107, v98, v99
    s_add_u32 s35, s34, 10944640
    buffer_store_dwordx4 v[104:107], v16, s[12:15], s35 offen sc1
    s_nop 1
    v_cvt_pk_bf16_f32 v108, v84, v85
    v_cvt_pk_bf16_f32 v109, v86, v87
    v_cvt_pk_bf16_f32 v110, v100, v101
    v_cvt_pk_bf16_f32 v111, v102, v103
    s_add_u32 s35, s34, 16416896
    buffer_store_dwordx4 v[108:111], v16, s[12:15], s35 offen sc1
    s_nop 1
    s_endpgm
L_prep_kernel_g:
    s_sub_u32 s3, s2, 13
    s_load_dwordx2 s[4:5], s[0:1], 8
    s_load_dwordx2 s[6:7], s[0:1], 72
    s_lshr_b32 s24, s3, 4
    s_bfe_u32 s25, s3, 0x20002
    s_and_b32 s26, s3, 3
    s_lshr_b32 s27, s24, 3
    s_and_b32 s28, s24, 7
    v_and_b32 v1, 63, v0
    v_lshrrev_b32 v2, 3, v1
    v_lshrrev_b32 v3, 2, v2
    v_lshlrev_b32 v3, 4, v3
    v_and_b32 v4, 3, v2
    v_add_u32 v3, v3, v4
    s_lshl_b32 s29, s25, 2
    s_lshl_b32 s30, s28, 5
    s_add_u32 s29, s29, s30
    v_add_u32 v3, s29, v3
    v_lshlrev_b32 v3, 9, v3
    v_and_b32 v4, 7, v1
    s_lshr_b32 s30, s20, 1
    s_lshl_b32 s30, s30, 2
    v_xor_b32 v4, s30, v4
    v_lshl_add_u32 v3, v4, 4, v3
    s_lshl_b32 s30, s26, 7
    v_add_u32 v3, s30, v3
    v_xor_b32 v4, 32, v3
    s_waitcnt lgkmcnt(0)
    s_mov_b32 s8, s4
    s_mov_b32 s9, s5
    s_mov_b32 s10, 4063232
    s_mov_b32 s11, 0x00020000
    s_add_u32 s12, s6, 21954560
    s_addc_u32 s13, s7, 0
    s_mov_b32 s14, 16916480
    s_mov_b32 s15, 0x00020000
    s_lshl_b32 s30, s20, 3
    s_add_u32 s30, s30, s27
    s_lshl_b32 s30, s30, 17
    s_mul_i32 s31, s20, 4608
    s_add_u32 m0, s31, 0
    s_add_u32 s32, s30, 0
    buffer_load_dwordx4 v3, s[8:11], s32 offen nt lds
    s_add_u32 m0, s31, 1152
    s_add_u32 s32, s30, 262144
    buffer_load_dwordx4 v3, s[8:11], s32 offen nt lds
    s_add_u32 m0, s31, 2304
    s_add_u32 s32, s30, 524288
    buffer_load_dwordx4 v4, s[8:11], s32 offen nt lds
    s_add_u32 m0, s31, 3456
    s_add_u32 s32, s30, 786432
    buffer_load_dwordx4 v4, s[8:11], s32 offen nt lds
    v_and_b32 v8, 15, v1
    v_or_b32 v9, 1, v8
    s_lshl_b32 s33, s20, 4
    v_add_u32 v9, s33, v9
    v_cvt_f32_u32 v9, v9
    v_mul_f32 v9, 0x3c000000, v9
    v_bfe_u32 v10, v1, 4, 1
    v_lshlrev_b32 v10, 3, v10
    v_cvt_f32_u32 v10, v10
    v_and_b32 v8, 1, v8
    v_cvt_f32_u32 v8, v8
    v_mul_f32 v8, 0x3f400000, v8
    v_fma_f32 v11, v9, v10, v8
    v_fract_f32 v12, v11
    v_add_f32 v11, v11, v9
    v_fract_f32 v13, v11
    v_add_f32 v11, v11, v9
    v_fract_f32 v14, v11
    v_add_f32 v11, v11, v9
    v_fract_f32 v15, v11
    v_add_f32 v11, v11, v9
    v_fract_f32 v16, v11
    v_add_f32 v11, v11, v9
    v_fract_f32 v17, v11
    v_add_f32 v11, v11, v9
    v_fract_f32 v18, v11
    v_add_f32 v11, v11, v9
    v_fract_f32 v19, v11
    v_cos_f32 v12, v12
    v_cos_f32 v13, v13
    v_cos_f32 v14, v14
    v_cos_f32 v15, v15
    v_cos_f32 v16, v16
    v_cos_f32 v17, v17
    v_cos_f32 v18, v18
    v_cos_f32 v19, v19
    s_nop 0
    v_mul_f32 v12, 0x3d000000, v12
    v_mul_f32 v13, 0x3d000000, v13
    v_mul_f32 v14, 0x3d000000, v14
    v_mul_f32 v15, 0x3d000000, v15
    v_mul_f32 v16, 0x3d000000, v16
    v_mul_f32 v17, 0x3d000000, v17
    v_mul_f32 v18, 0x3d000000, v18
    v_mul_f32 v19, 0x3d000000, v19
    v_cvt_pk_bf16_f32 v20, v12, v13
    v_cvt_pk_bf16_f32 v21, v14, v15
    v_cvt_pk_bf16_f32 v22, v16, v17
    v_cvt_pk_bf16_f32 v23, v18, v19
    v_lshlrev_b32 v28, 16, v20
    v_and_b32 v29, 0xffff0000, v20
    v_sub_f32 v28, v12, v28
    v_sub_f32 v29, v13, v29
    v_cvt_pk_bf16_f32 v24, v28, v29
    v_lshlrev_b32 v28, 16, v21
    v_and_b32 v29, 0xffff0000, v21
    v_sub_f32 v28, v14, v28
    v_sub_f32 v29, v15, v29
    v_cvt_pk_bf16_f32 v25, v28, v29
    v_lshlrev_b32 v28, 16, v22
    v_and_b32 v29, 0xffff0000, v22
    v_sub_f32 v28, v16, v28
    v_sub_f32 v29, v17, v29
    v_cvt_pk_bf16_f32 v26, v28, v29
    v_lshlrev_b32 v28, 16, v23
    v_and_b32 v29, 0xffff0000, v23
    v_sub_f32 v28, v18, v28
    v_sub_f32 v29, v19, v29
    v_cvt_pk_bf16_f32 v27, v28, v29
    v_cmp_gt_u32 vcc, 32, v1
    s_nop 1
    v_cndmask_b32 v20, v24, v20, vcc
    v_cndmask_b32 v21, v25, v21, vcc
    v_cndmask_b32 v22, v26, v22, vcc
    v_cndmask_b32 v23, v27, v23, vcc
    v_lshlrev_b32 v28, 4, v1
    s_lshl_b32 s33, s20, 10
    v_add_u32 v29, s33, v28
    ds_write_b128 v29, v[20:23] offset:18432
    v_bfe_u32 v30, v1, 2, 2
    v_bfe_u32 v31, v1, 4, 1
    v_lshl_add_u32 v32, v31, 3, v30
    v_mul_u32_u24 v32, 1152, v32
    v_lshrrev_b32 v30, 1, v30
    v_lshl_add_u32 v30, v31, 1, v30
    v_lshlrev_b32 v30, 1, v30
    v_bfe_u32 v31, v1, 1, 1
    s_lshl_b32 s33, s20, 1
    v_add_u32 v31, s33, v31
    v_xor_b32 v30, v30, v31
    v_lshl_add_u32 v32, v30, 4, v32
    v_and_b32 v30, 1, v1
    v_lshl_add_u32 v32, v30, 3, v32
    v_lshrrev_b32 v30, 4, v1
    s_mov_b32 s33, 1057280
    v_mul_lo_u32 v30, v30, s33
    v_and_b32 v31, 15, v1
    v_lshl_add_u32 v33, v31, 4, v30
    s_lshl_b32 s34, s24, 15
    s_lshl_b32 s35, s26, 2
    s_add_u32 s35, s35, s20
    s_lshl_b32 s35, s35, 11
    s_add_u32 s34, s34, s35
    s_lshl_b32 s35, s25, 8
    s_add_u32 s34, s34, s35
    s_waitcnt vmcnt(0) lgkmcnt(0)
    s_barrier
    ds_read_b128 v[36:39], v28 offset:18432
    ds_read_b128 v[40:43], v28 offset:19456
    ds_read_b128 v[44:47], v28 offset:20480
    ds_read_b128 v[48:51], v28 offset:21504
    ds_read_b64_tr_b16 v[52:53], v32 offset:0
    ds_read_b64_tr_b16 v[54:55], v32 offset:4608
    ds_read_b64_tr_b16 v[56:57], v32 offset:128
    ds_read_b64_tr_b16 v[58:59], v32 offset:4736
    ds_read_b64_tr_b16 v[60:61], v32 offset:256
    ds_read_b64_tr_b16 v[62:63], v32 offset:4864
    ds_read_b64_tr_b16 v[64:65], v32 offset:384
    ds_read_b64_tr_b16 v[66:67], v32 offset:4992
    ds_read_b64_tr_b16 v[68:69], v32 offset:512
    ds_read_b64_tr_b16 v[70:71], v32 offset:5120
    s_waitcnt lgkmcnt(8)
    ds_read_b64_tr_b16 v[72:73], v32 offset:640
    ds_read_b64_tr_b16 v[74:75], v32 offset:5248
    ds_read_b64_tr_b16 v[76:77], v32 offset:768
    ds_read_b64_tr_b16 v[78:79], v32 offset:5376
    ds_read_b64_tr_b16 v[80:81], v32 offset:896
    ds_read_b64_tr_b16 v[82:83], v32 offset:5504
    s_waitcnt lgkmcnt(0)
    v_mfma_f32_16x16x32_bf16 v[84:87], v[36:39], v[52:55], 0
    v_mfma_f32_16x16x32_bf16 v[88:91], v[36:39], v[56:59], 0
    v_mfma_f32_16x16x32_bf16 v[92:95], v[36:39], v[60:63], 0
    v_mfma_f32_16x16x32_bf16 v[96:99], v[36:39], v[64:67], 0
    v_mfma_f32_16x16x32_bf16 v[100:103], v[36:39], v[68:71], 0
    v_mfma_f32_16x16x32_bf16 v[104:107], v[36:39], v[72:75], 0
    v_mfma_f32_16x16x32_bf16 v[108:111], v[36:39], v[76:79], 0
    v_mfma_f32_16x16x32_bf16 v[112:115], v[36:39], v[80:83], 0
    s_nop 7
    v_cvt_pk_bf16_f32 v116, v84, v88
    v_cvt_pk_bf16_f32 v117, v92, v96
    v_cvt_pk_bf16_f32 v118, v100, v104
    v_cvt_pk_bf16_f32 v119, v108, v112
    s_add_u32 s35, s34, 0
    buffer_store_dwordx4 v[116:119], v33, s[12:15], s35 offen sc1
    s_nop 1
    v_cvt_pk_bf16_f32 v120, v85, v89
    v_cvt_pk_bf16_f32 v121, v93, v97
    v_cvt_pk_bf16_f32 v122, v101, v105
    v_cvt_pk_bf16_f32 v123, v109, v113
    s_add_u32 s35, s34, 1024
    buffer_store_dwordx4 v[120:123], v33, s[12:15], s35 offen sc1
    s_nop 1
    v_cvt_pk_bf16_f32 v116, v86, v90
    v_cvt_pk_bf16_f32 v117, v94, v98
    v_cvt_pk_bf16_f32 v118, v102, v106
    v_cvt_pk_bf16_f32 v119, v110, v114
    s_add_u32 s35, s34, 528640
    buffer_store_dwordx4 v[116:119], v33, s[12:15], s35 offen sc1
    s_nop 1
    v_cvt_pk_bf16_f32 v120, v87, v91
    v_cvt_pk_bf16_f32 v121, v95, v99
    v_cvt_pk_bf16_f32 v122, v103, v107
    v_cvt_pk_bf16_f32 v123, v111, v115
    s_add_u32 s35, s34, 529664
    buffer_store_dwordx4 v[120:123], v33, s[12:15], s35 offen sc1
    s_nop 1
    v_mfma_f32_16x16x32_bf16 v[84:87], v[40:43], v[52:55], 0
    v_mfma_f32_16x16x32_bf16 v[88:91], v[40:43], v[56:59], 0
    v_mfma_f32_16x16x32_bf16 v[92:95], v[40:43], v[60:63], 0
    v_mfma_f32_16x16x32_bf16 v[96:99], v[40:43], v[64:67], 0
    v_mfma_f32_16x16x32_bf16 v[100:103], v[40:43], v[68:71], 0
    v_mfma_f32_16x16x32_bf16 v[104:107], v[40:43], v[72:75], 0
    v_mfma_f32_16x16x32_bf16 v[108:111], v[40:43], v[76:79], 0
    v_mfma_f32_16x16x32_bf16 v[112:115], v[40:43], v[80:83], 0
    s_nop 7
    v_cvt_pk_bf16_f32 v116, v84, v88
    v_cvt_pk_bf16_f32 v117, v92, v96
    v_cvt_pk_bf16_f32 v118, v100, v104
    v_cvt_pk_bf16_f32 v119, v108, v112
    s_add_u32 s35, s34, 4229120
    buffer_store_dwordx4 v[116:119], v33, s[12:15], s35 offen sc1
    s_nop 1
    v_cvt_pk_bf16_f32 v120, v85, v89
    v_cvt_pk_bf16_f32 v121, v93, v97
    v_cvt_pk_bf16_f32 v122, v101, v105
    v_cvt_pk_bf16_f32 v123, v109, v113
    s_add_u32 s35, s34, 4230144
    buffer_store_dwordx4 v[120:123], v33, s[12:15], s35 offen sc1
    s_nop 1
    v_cvt_pk_bf16_f32 v116, v86, v90
    v_cvt_pk_bf16_f32 v117, v94, v98
    v_cvt_pk_bf16_f32 v118, v102, v106
    v_cvt_pk_bf16_f32 v119, v110, v114
    s_add_u32 s35, s34, 4757760
    buffer_store_dwordx4 v[116:119], v33, s[12:15], s35 offen sc1
    s_nop 1
    v_cvt_pk_bf16_f32 v120, v87, v91
    v_cvt_pk_bf16_f32 v121, v95, v99
    v_cvt_pk_bf16_f32 v122, v103, v107
    v_cvt_pk_bf16_f32 v123, v111, v115
    s_add_u32 s35, s34, 4758784
    buffer_store_dwordx4 v[120:123], v33, s[12:15], s35 offen sc1
    s_nop 1
    v_mfma_f32_16x16x32_bf16 v[84:87], v[44:47], v[52:55], 0
    v_mfma_f32_16x16x32_bf16 v[88:91], v[44:47], v[56:59], 0
    v_mfma_f32_16x16x32_bf16 v[92:95], v[44:47], v[60:63], 0
    v_mfma_f32_16x16x32_bf16 v[96:99], v[44:47], v[64:67], 0
    v_mfma_f32_16x16x32_bf16 v[100:103], v[44:47], v[68:71], 0
    v_mfma_f32_16x16x32_bf16 v[104:107], v[44:47], v[72:75], 0
    v_mfma_f32_16x16x32_bf16 v[108:111], v[44:47], v[76:79], 0
    v_mfma_f32_16x16x32_bf16 v[112:115], v[44:47], v[80:83], 0
    s_nop 7
    v_cvt_pk_bf16_f32 v116, v84, v88
    v_cvt_pk_bf16_f32 v117, v92, v96
    v_cvt_pk_bf16_f32 v118, v100, v104
    v_cvt_pk_bf16_f32 v119, v108, v112
    s_add_u32 s35, s34, 8458240
    buffer_store_dwordx4 v[116:119], v33, s[12:15], s35 offen sc1
    s_nop 1
    v_cvt_pk_bf16_f32 v120, v85, v89
    v_cvt_pk_bf16_f32 v121, v93, v97
    v_cvt_pk_bf16_f32 v122, v101, v105
    v_cvt_pk_bf16_f32 v123, v109, v113
    s_add_u32 s35, s34, 8459264
    buffer_store_dwordx4 v[120:123], v33, s[12:15], s35 offen sc1
    s_nop 1
    v_cvt_pk_bf16_f32 v116, v86, v90
    v_cvt_pk_bf16_f32 v117, v94, v98
    v_cvt_pk_bf16_f32 v118, v102, v106
    v_cvt_pk_bf16_f32 v119, v110, v114
    s_add_u32 s35, s34, 8986880
    buffer_store_dwordx4 v[116:119], v33, s[12:15], s35 offen sc1
    s_nop 1
    v_cvt_pk_bf16_f32 v120, v87, v91
    v_cvt_pk_bf16_f32 v121, v95, v99
    v_cvt_pk_bf16_f32 v122, v103, v107
    v_cvt_pk_bf16_f32 v123, v111, v115
    s_add_u32 s35, s34, 8987904
    buffer_store_dwordx4 v[120:123], v33, s[12:15], s35 offen sc1
    s_nop 1
    v_mfma_f32_16x16x32_bf16 v[84:87], v[48:51], v[52:55], 0
    v_mfma_f32_16x16x32_bf16 v[88:91], v[48:51], v[56:59], 0
    v_mfma_f32_16x16x32_bf16 v[92:95], v[48:51], v[60:63], 0
    v_mfma_f32_16x16x32_bf16 v[96:99], v[48:51], v[64:67], 0
    v_mfma_f32_16x16x32_bf16 v[100:103], v[48:51], v[68:71], 0
    v_mfma_f32_16x16x32_bf16 v[104:107], v[48:51], v[72:75], 0
    v_mfma_f32_16x16x32_bf16 v[108:111], v[48:51], v[76:79], 0
    v_mfma_f32_16x16x32_bf16 v[112:115], v[48:51], v[80:83], 0
    s_nop 7
    v_cvt_pk_bf16_f32 v116, v84, v88
    v_cvt_pk_bf16_f32 v117, v92, v96
    v_cvt_pk_bf16_f32 v118, v100, v104
    v_cvt_pk_bf16_f32 v119, v108, v112
    s_add_u32 s35, s34, 12687360
    buffer_store_dwordx4 v[116:119], v33, s[12:15], s35 offen sc1
    s_nop 1
    v_cvt_pk_bf16_f32 v120, v85, v89
    v_cvt_pk_bf16_f32 v121, v93, v97
    v_cvt_pk_bf16_f32 v122, v101, v105
    v_cvt_pk_bf16_f32 v123, v109, v113
    s_add_u32 s35, s34, 12688384
    buffer_store_dwordx4 v[120:123], v33, s[12:15], s35 offen sc1
    s_nop 1
    v_cvt_pk_bf16_f32 v116, v86, v90
    v_cvt_pk_bf16_f32 v117, v94, v98
    v_cvt_pk_bf16_f32 v118, v102, v106
    v_cvt_pk_bf16_f32 v119, v110, v114
    s_add_u32 s35, s34, 13216000
    buffer_store_dwordx4 v[116:119], v33, s[12:15], s35 offen sc1
    s_nop 1
    v_cvt_pk_bf16_f32 v120, v87, v91
    v_cvt_pk_bf16_f32 v121, v95, v99
    v_cvt_pk_bf16_f32 v122, v103, v107
    v_cvt_pk_bf16_f32 v123, v111, v115
    s_add_u32 s35, s34, 13217024
    buffer_store_dwordx4 v[120:123], v33, s[12:15], s35 offen sc1
    s_nop 1
    s_endpgm
L_prep_kernel_slab:
    s_load_dwordx2 s[6:7], s[0:1], 72
    s_cmp_eq_u32 s2, 12
    s_cbranch_scc1 L_prep_kernel_tab
    s_lshr_b32 s24, s2, 2
    s_and_b32 s26, s2, 3
    s_mov_b32 s25, 40
    s_cmp_eq_u32 s24, 1
    s_cselect_b32 s25, 32, s25
    s_cmp_eq_u32 s24, 2
    s_cselect_b32 s25, 48, s25
    s_load_dwordx2 s[4:5], s[0:1], s25
    s_load_dwordx2 s[28:29], s[0:1], 24
    v_and_b32 v1, 63, v0
    v_lshrrev_b32 v2, 3, v1
    s_lshl_b32 s27, s20, 6
    v_add_u32 v2, s27, v2
    v_lshlrev_b32 v2, 9, v2
    v_and_b32 v3, 7, v1
    v_lshl_add_u32 v2, v3, 4, v2
    s_lshl_b32 s27, s26, 7
    v_add_u32 v2, s27, v2
    s_waitcnt lgkmcnt(0)
    s_mov_b32 s8, s4
    s_mov_b32 s9, s5
    s_mov_b32 s10, 131072
    s_mov_b32 s11, 0x00020000
    s_add_u32 s12, s6, 85499904
    s_addc_u32 s13, s7, 0
    s_mov_b32 s14, 294912
    s_mov_b32 s15, 0x00020000
    s_lshl_b32 s31, s20, 13
    s_add_u32 m0, s31, 0
    s_mov_b32 s32, 0
    buffer_load_dwordx4 v2, s[8:11], s32 offen nt lds
    s_add_u32 m0, s31, 1024
    s_mov_b32 s32, 4096
    buffer_load_dwordx4 v2, s[8:11], s32 offen nt lds
    s_add_u32 m0, s31, 2048
    s_mov_b32 s32, 8192
    buffer_load_dwordx4 v2, s[8:11], s32 offen nt lds
    s_add_u32 m0, s31, 3072
    s_mov_b32 s32, 12288
    buffer_load_dwordx4 v2, s[8:11], s32 offen nt lds
    s_add_u32 m0, s31, 4096
    s_mov_b32 s32, 16384
    buffer_load_dwordx4 v2, s[8:11], s32 offen nt lds
    s_add_u32 m0, s31, 5120
    s_mov_b32 s32, 20480
    buffer_load_dwordx4 v2, s[8:11], s32 offen nt lds
    s_add_u32 m0, s31, 6144
    s_mov_b32 s32, 24576
    buffer_load_dwordx4 v2, s[8:11], s32 offen nt lds
    s_add_u32 m0, s31, 7168
    s_mov_b32 s32, 28672
    buffer_load_dwordx4 v2, s[8:11], s32 offen nt lds
    s_cmp_eq_u32 s24, 0
    s_cbranch_scc1 L_prep_kernel_ge
    v_bfe_u32 v4, v1, 2, 2
    v_lshrrev_b32 v5, 5, v1
    v_bfe_u32 v6, v1, 4, 1
    v_and_b32 v7, 3, v1
    s_cmp_eq_u32 s24, 1
    s_cbranch_scc0 L_prep_kernel_wo
    v_lshl_add_u32 v8, v5, 4, v4
    v_lshlrev_b32 v8, 7, v8
    v_lshl_add_u32 v8, v6, 5, v8
    v_lshl_add_u32 v8, v7, 3, v8
    s_lshl_b32 s33, s20, 13
    v_add_u32 v8, s33, v8
    s_mov_b32 s34, 32768
    s_lshl_b32 s35, s26, 15
    s_add_u32 s34, s34, s35
    s_lshl_b32 s35, s20, 12
    s_add_u32 s34, s34, s35
    v_lshlrev_b32 v9, 4, v1
    s_waitcnt vmcnt(0)
    s_barrier
    ds_read_b64_tr_b16 v[16:17], v8 offset:0
    ds_read_b64_tr_b16 v[18:19], v8 offset:1024
    ds_read_b64_tr_b16 v[20:21], v8 offset:512
    ds_read_b64_tr_b16 v[22:23], v8 offset:1536
    ds_read_b64_tr_b16 v[24:25], v8 offset:4096
    ds_read_b64_tr_b16 v[26:27], v8 offset:5120
    ds_read_b64_tr_b16 v[28:29], v8 offset:4608
    ds_read_b64_tr_b16 v[30:31], v8 offset:5632
    s_waitcnt lgkmcnt(0)
    s_add_u32 s35, s34, 0
    buffer_store_dwordx4 v[16:19], v9, s[12:15], s35 offen sc1
    s_add_u32 s35, s34, 1024
    buffer_store_dwordx4 v[20:23], v9, s[12:15], s35 offen sc1
    s_add_u32 s35, s34, 2048
    buffer_store_dwordx4 v[24:27], v9, s[12:15], s35 offen sc1
    s_add_u32 s35, s34, 3072
    buffer_store_dwordx4 v[28:31], v9, s[12:15], s35 offen sc1
    ds_read_b64_tr_b16 v[32:33], v8 offset:64
    ds_read_b64_tr_b16 v[34:35], v8 offset:1088
    ds_read_b64_tr_b16 v[36:37], v8 offset:576
    ds_read_b64_tr_b16 v[38:39], v8 offset:1600
    ds_read_b64_tr_b16 v[40:41], v8 offset:4160
    ds_read_b64_tr_b16 v[42:43], v8 offset:5184
    ds_read_b64_tr_b16 v[44:45], v8 offset:4672
    ds_read_b64_tr_b16 v[46:47], v8 offset:5696
    s_waitcnt lgkmcnt(0)
    s_add_u32 s35, s34, 16384
    buffer_store_dwordx4 v[32:35], v9, s[12:15], s35 offen sc1
    s_add_u32 s35, s34, 17408
    buffer_store_dwordx4 v[36:39], v9, s[12:15], s35 offen sc1
    s_add_u32 s35, s34, 18432
    buffer_store_dwordx4 v[40:43], v9, s[12:15], s35 offen sc1
    s_add_u32 s35, s34, 19456
    buffer_store_dwordx4 v[44:47], v9, s[12:15], s35 offen sc1
    s_endpgm
L_prep_kernel_wo:
    v_lshl_add_u32 v8, v5, 2, v4
    v_lshlrev_b32 v8, 7, v8
    v_lshl_add_u32 v8, v6, 5, v8
    v_and_b32 v10, 1, v7
    v_lshl_add_u32 v8, v10, 4, v8
    v_lshrrev_b32 v10, 1, v7
    v_lshl_add_u32 v8, v10, 3, v8
    s_lshl_b32 s33, s20, 13
    v_add_u32 v8, s33, v8
    s_mov_b32 s34, 163840
    s_lshl_b32 s35, s26, 15
    s_add_u32 s34, s34, s35
    s_lshl_b32 s35, s20, 12
    s_add_u32 s34, s34, s35
    v_lshlrev_b32 v9, 4, v1
    s_waitcnt vmcnt(0)
    s_barrier
    ds_read_b64_tr_b16 v[16:17], v8 offset:0
    ds_read_b64_tr_b16 v[18:19], v8 offset:1024
    ds_read_b64_tr_b16 v[20:21], v8 offset:2048
    ds_read_b64_tr_b16 v[22:23], v8 offset:3072
    ds_read_b64_tr_b16 v[24:25], v8 offset:4096
    ds_read_b64_tr_b16 v[26:27], v8 offset:5120
    ds_read_b64_tr_b16 v[28:29], v8 offset:6144
    ds_read_b64_tr_b16 v[30:31], v8 offset:7168
    s_waitcnt lgkmcnt(0)
    v_mov_b32 v48, 0x3f803f80
    v_mov_b32 v49, 0x3f803f80
    v_mov_b32 v50, 0x3f803f80
    v_mov_b32 v51, 0x3f803f80
    s_nop 1
    v_mfma_f32_32x32x16_bf16 v[64:79], v[16:19], v[48:51], 0
    v_mfma_f32_32x32x16_bf16 v[64:79], v[20:23], v[48:51], v[64:79]
    v_mfma_f32_32x32x16_bf16 v[64:79], v[24:27], v[48:51], v[64:79]
    v_mfma_f32_32x32x16_bf16 v[64:79], v[28:31], v[48:51], v[64:79]
    v_lshlrev_b32 v52, 16, v16
    v_and_b32 v53, 0xffff0000, v16
    v_mul_f32 v52, -2.0, v52
    v_mul_f32 v53, -2.0, v53
    v_cvt_pk_bf16_f32 v16, v52, v53
    v_lshlrev_b32 v52, 16, v17
    v_and_b32 v53, 0xffff0000, v17
    v_mul_f32 v52, -2.0, v52
    v_mul_f32 v53, -2.0, v53
    v_cvt_pk_bf16_f32 v17, v52, v53
    v_lshlrev_b32 v52, 16, v18
    v_and_b32 v53, 0xffff0000, v18
    v_mul_f32 v52, -2.0, v52
    v_mul_f32 v53, -2.0, v53
    v_cvt_pk_bf16_f32 v18, v52, v53
    v_lshlrev_b32 v52, 16, v19
    v_and_b32 v53, 0xffff0000, v19
    v_mul_f32 v52, -2.0, v52
    v_mul_f32 v53, -2.0, v53
    v_cvt_pk_bf16_f32 v19, v52, v53
    v_lshlrev_b32 v52, 16, v20
    v_and_b32 v53, 0xffff0000, v20
    v_mul_f32 v52, -2.0, v52
    v_mul_f32 v53, -2.0, v53
    v_cvt_pk_bf16_f32 v20, v52, v53
    v_lshlrev_b32 v52, 16, v21
    v_and_b32 v53, 0xffff0000, v21
    v_mul_f32 v52, -2.0, v52
    v_mul_f32 v53, -2.0, v53
    v_cvt_pk_bf16_f32 v21, v52, v53
    v_lshlrev_b32 v52, 16, v22
    v_and_b32 v53, 0xffff0000, v22
    v_mul_f32 v52, -2.0, v52
    v_mul_f32 v53, -2.0, v53
    v_cvt_pk_bf16_f32 v22, v52, v53
    v_lshlrev_b32 v52, 16, v23
    v_and_b32 v53, 0xffff0000, v23
    v_mul_f32 v52, -2.0, v52
    v_mul_f32 v53, -2.0, v53
    v_cvt_pk_bf16_f32 v23, v52, v53
    v_lshlrev_b32 v52, 16, v24
    v_and_b32 v53, 0xffff0000, v24
    v_mul_f32 v52, -2.0, v52
    v_mul_f32 v53, -2.0, v53
    v_cvt_pk_bf16_f32 v24, v52, v53
    v_lshlrev_b32 v52, 16, v25
    v_and_b32 v53, 0xffff0000, v25
    v_mul_f32 v52, -2.0, v52
    v_mul_f32 v53, -2.0, v53
    v_cvt_pk_bf16_f32 v25, v52, v53
    v_lshlrev_b32 v52, 16, v26
    v_and_b32 v53, 0xffff0000, v26
    v_mul_f32 v52, -2.0, v52
    v_mul_f32 v53, -2.0, v53
    v_cvt_pk_bf16_f32 v26, v52, v53
    v_lshlrev_b32 v52, 16, v27
    v_and_b32 v53, 0xffff0000, v27
    v_mul_f32 v52, -2.0, v52
    v_mul_f32 v53, -2.0, v53
    v_cvt_pk_bf16_f32 v27, v52, v53
    v_lshlrev_b32 v52, 16, v28
    v_and_b32 v53, 0xffff0000, v28
    v_mul_f32 v52, -2.0, v52
    v_mul_f32 v53, -2.0, v53
    v_cvt_pk_bf16_f32 v28, v52, v53
    v_lshlrev_b32 v52, 16, v29
    v_and_b32 v53, 0xffff0000, v29
    v_mul_f32 v52, -2.0, v52
    v_mul_f32 v53, -2.0, v53
    v_cvt_pk_bf16_f32 v29, v52, v53
    v_lshlrev_b32 v52, 16, v30
    v_and_b32 v53, 0xffff0000, v30
    v_mul_f32 v52, -2.0, v52
    v_mul_f32 v53, -2.0, v53
    v_cvt_pk_bf16_f32 v30, v52, v53
    v_lshlrev_b32 v52, 16, v31
    v_and_b32 v53, 0xffff0000, v31
    v_mul_f32 v52, -2.0, v52
    v_mul_f32 v53, -2.0, v53
    v_cvt_pk_bf16_f32 v31, v52, v53
    s_add_u32 s35, s34, 0
    buffer_store_dwordx4 v[16:19], v9, s[12:15], s35 offen sc1
    s_add_u32 s35, s34, 1024
    buffer_store_dwordx4 v[20:23], v9, s[12:15], s35 offen sc1
    s_add_u32 s35, s34, 2048
    buffer_store_dwordx4 v[24:27], v9, s[12:15], s35 offen sc1
    s_add_u32 s35, s34, 3072
    buffer_store_dwordx4 v[28:31], v9, s[12:15], s35 offen sc1
    ds_read_b64_tr_b16 v[32:33], v8 offset:64
    ds_read_b64_tr_b16 v[34:35], v8 offset:1088
    ds_read_b64_tr_b16 v[36:37], v8 offset:2112
    ds_read_b64_tr_b16 v[38:39], v8 offset:3136
    ds_read_b64_tr_b16 v[40:41], v8 offset:4160
    ds_read_b64_tr_b16 v[42:43], v8 offset:5184
    ds_read_b64_tr_b16 v[44:45], v8 offset:6208
    ds_read_b64_tr_b16 v[46:47], v8 offset:7232
    s_waitcnt lgkmcnt(0)
    v_mfma_f32_32x32x16_bf16 v[80:95], v[32:35], v[48:51], 0
    v_mfma_f32_32x32x16_bf16 v[80:95], v[36:39], v[48:51], v[80:95]
    v_mfma_f32_32x32x16_bf16 v[80:95], v[40:43], v[48:51], v[80:95]
    v_mfma_f32_32x32x16_bf16 v[80:95], v[44:47], v[48:51], v[80:95]
    v_lshlrev_b32 v52, 16, v32
    v_and_b32 v53, 0xffff0000, v32
    v_mul_f32 v52, -2.0, v52
    v_mul_f32 v53, -2.0, v53
    v_cvt_pk_bf16_f32 v32, v52, v53
    v_lshlrev_b32 v52, 16, v33
    v_and_b32 v53, 0xffff0000, v33
    v_mul_f32 v52, -2.0, v52
    v_mul_f32 v53, -2.0, v53
    v_cvt_pk_bf16_f32 v33, v52, v53
    v_lshlrev_b32 v52, 16, v34
    v_and_b32 v53, 0xffff0000, v34
    v_mul_f32 v52, -2.0, v52
    v_mul_f32 v53, -2.0, v53
    v_cvt_pk_bf16_f32 v34, v52, v53
    v_lshlrev_b32 v52, 16, v35
    v_and_b32 v53, 0xffff0000, v35
    v_mul_f32 v52, -2.0, v52
    v_mul_f32 v53, -2.0, v53
    v_cvt_pk_bf16_f32 v35, v52, v53
    v_lshlrev_b32 v52, 16, v36
    v_and_b32 v53, 0xffff0000, v36
    v_mul_f32 v52, -2.0, v52
    v_mul_f32 v53, -2.0, v53
    v_cvt_pk_bf16_f32 v36, v52, v53
    v_lshlrev_b32 v52, 16, v37
    v_and_b32 v53, 0xffff0000, v37
    v_mul_f32 v52, -2.0, v52
    v_mul_f32 v53, -2.0, v53
    v_cvt_pk_bf16_f32 v37, v52, v53
    v_lshlrev_b32 v52, 16, v38
    v_and_b32 v53, 0xffff0000, v38
    v_mul_f32 v52, -2.0, v52
    v_mul_f32 v53, -2.0, v53
    v_cvt_pk_bf16_f32 v38, v52, v53
    v_lshlrev_b32 v52, 16, v39
    v_and_b32 v53, 0xffff0000, v39
    v_mul_f32 v52, -2.0, v52
    v_mul_f32 v53, -2.0, v53
    v_cvt_pk_bf16_f32 v39, v52, v53
    v_lshlrev_b32 v52, 16, v40
    v_and_b32 v53, 0xffff0000, v40
    v_mul_f32 v52, -2.0, v52
    v_mul_f32 v53, -2.0, v53
    v_cvt_pk_bf16_f32 v40, v52, v53
    v_lshlrev_b32 v52, 16, v41
    v_and_b32 v53, 0xffff0000, v41
    v_mul_f32 v52, -2.0, v52
    v_mul_f32 v53, -2.0, v53
    v_cvt_pk_bf16_f32 v41, v52, v53
    v_lshlrev_b32 v52, 16, v42
    v_and_b32 v53, 0xffff0000, v42
    v_mul_f32 v52, -2.0, v52
    v_mul_f32 v53, -2.0, v53
    v_cvt_pk_bf16_f32 v42, v52, v53
    v_lshlrev_b32 v52, 16, v43
    v_and_b32 v53, 0xffff0000, v43
    v_mul_f32 v52, -2.0, v52
    v_mul_f32 v53, -2.0, v53
    v_cvt_pk_bf16_f32 v43, v52, v53
    v_lshlrev_b32 v52, 16, v44
    v_and_b32 v53, 0xffff0000, v44
    v_mul_f32 v52, -2.0, v52
    v_mul_f32 v53, -2.0, v53
    v_cvt_pk_bf16_f32 v44, v52, v53
    v_lshlrev_b32 v52, 16, v45
    v_and_b32 v53, 0xffff0000, v45
    v_mul_f32 v52, -2.0, v52
    v_mul_f32 v53, -2.0, v53
    v_cvt_pk_bf16_f32 v45, v52, v53
    v_lshlrev_b32 v52, 16, v46
    v_and_b32 v53, 0xffff0000, v46
    v_mul_f32 v52, -2.0, v52
    v_mul_f32 v53, -2.0, v53
    v_cvt_pk_bf16_f32 v46, v52, v53
    v_lshlrev_b32 v52, 16, v47
    v_and_b32 v53, 0xffff0000, v47
    v_mul_f32 v52, -2.0, v52
    v_mul_f32 v53, -2.0, v53
    v_cvt_pk_bf16_f32 v47, v52, v53
    s_add_u32 s35, s34, 16384
    buffer_store_dwordx4 v[32:35], v9, s[12:15], s35 offen sc1
    s_add_u32 s35, s34, 17408
    buffer_store_dwordx4 v[36:39], v9, s[12:15], s35 offen sc1
    s_add_u32 s35, s34, 18432
    buffer_store_dwordx4 v[40:43], v9, s[12:15], s35 offen sc1
    s_add_u32 s35, s34, 19456
    buffer_store_dwordx4 v[44:47], v9, s[12:15], s35 offen sc1
    s_nop 7
    s_barrier
    v_lshlrev_b32 v10, 6, v1
    s_lshl_b32 s35, s20, 13
    v_add_u32 v11, s35, v10
    ds_write_b128 v11, v[64:67] offset:0
    ds_write_b128 v11, v[68:71] offset:16
    ds_write_b128 v11, v[72:75] offset:32
    ds_write_b128 v11, v[76:79] offset:48
    ds_write_b128 v11, v[80:83] offset:4096
    ds_write_b128 v11, v[84:87] offset:4112
    ds_write_b128 v11, v[88:91] offset:4128
    ds_write_b128 v11, v[92:95] offset:4144
    s_waitcnt lgkmcnt(0)
    s_barrier
    s_cmp_ge_u32 s20, 2
    s_cbranch_scc1 L_prep_kernel_done
    s_lshl_b32 s35, s20, 12
    v_add_u32 v11, s35, v10
    ds_read_b128 v[16:19], v11 offset:0
    ds_read_b128 v[20:23], v11 offset:16
    ds_read_b128 v[24:27], v11 offset:32
    ds_read_b128 v[28:31], v11 offset:48
    ds_read_b128 v[32:35], v11 offset:8192
    ds_read_b128 v[36:39], v11 offset:8208
    ds_read_b128 v[40:43], v11 offset:8224
    ds_read_b128 v[44:47], v11 offset:8240
    s_waitcnt lgkmcnt(0)
    ds_read_b128 v[48:51], v11 offset:16384
    ds_read_b128 v[52:55], v11 offset:16400
    ds_read_b128 v[56:59], v11 offset:16416
    ds_read_b128 v[60:63], v11 offset:16432
    ds_read_b128 v[64:67], v11 offset:24576
    ds_read_b128 v[68:71], v11 offset:24592
    ds_read_b128 v[72:75], v11 offset:24608
    ds_read_b128 v[76:79], v11 offset:24624
    s_waitcnt lgkmcnt(0)
    v_add_f32 v16, v16, v32
    v_add_f32 v48, v48, v64
    v_add_f32 v17, v17, v33
    v_add_f32 v49, v49, v65
    v_add_f32 v18, v18, v34
    v_add_f32 v50, v50, v66
    v_add_f32 v19, v19, v35
    v_add_f32 v51, v51, v67
    v_add_f32 v20, v20, v36
    v_add_f32 v52, v52, v68
    v_add_f32 v21, v21, v37
    v_add_f32 v53, v53, v69
    v_add_f32 v22, v22, v38
    v_add_f32 v54, v54, v70
    v_add_f32 v23, v23, v39
    v_add_f32 v55, v55, v71
    v_add_f32 v24, v24, v40
    v_add_f32 v56, v56, v72
    v_add_f32 v25, v25, v41
    v_add_f32 v57, v57, v73
    v_add_f32 v26, v26, v42
    v_add_f32 v58, v58, v74
    v_add_f32 v27, v27, v43
    v_add_f32 v59, v59, v75
    v_add_f32 v28, v28, v44
    v_add_f32 v60, v60, v76
    v_add_f32 v29, v29, v45
    v_add_f32 v61, v61, v77
    v_add_f32 v30, v30, v46
    v_add_f32 v62, v62, v78
    v_add_f32 v31, v31, v47
    v_add_f32 v63, v63, v79
    v_add_f32 v16, v16, v48
    v_add_f32 v17, v17, v49
    v_add_f32 v18, v18, v50
    v_add_f32 v19, v19, v51
    v_add_f32 v20, v20, v52
    v_add_f32 v21, v21, v53
    v_add_f32 v22, v22, v54
    v_add_f32 v23, v23, v55
    v_add_f32 v24, v24, v56
    v_add_f32 v25, v25, v57
    v_add_f32 v26, v26, v58
    v_add_f32 v27, v27, v59
    v_add_f32 v28, v28, v60
    v_add_f32 v29, v29, v61
    v_add_f32 v30, v30, v62
    v_add_f32 v31, v31, v63
    v_and_b32 v10, 31, v1
    v_cmp_eq_u32 vcc, 0, v10
    v_lshrrev_b32 v10, 5, v1
    v_lshlrev_b32 v10, 6, v10
    s_lshl_b32 s35, s26, 8
    s_lshl_b32 s36, s20, 7
    s_add_u32 s35, s35, s36
    s_add_u32 s35, s35, 14336
    s_and_saveexec_b64 s[38:39], vcc
    buffer_store_dwordx4 v[16:19], v10, s[12:15], s35 offen offset:0 sc1
    buffer_store_dwordx4 v[20:23], v10, s[12:15], s35 offen offset:16 sc1
    buffer_store_dwordx4 v[24:27], v10, s[12:15], s35 offen offset:32 sc1
    buffer_store_dwordx4 v[28:31], v10, s[12:15], s35 offen offset:48 sc1
    s_endpgm
L_prep_kernel_ge:
    s_mov_b32 s36, s28
    s_mov_b32 s37, s29
    s_mov_b32 s38, 8192
    s_mov_b32 s39, 0x00020000
    v_and_b32 v4, 15, v1
    v_lshrrev_b32 v5, 4, v1
    v_lshlrev_b32 v6, 9, v4
    v_lshl_add_u32 v6, v5, 4, v6
    buffer_load_dwordx4 v[16:19], v6, s[36:39], 0 offen offset:0
    buffer_load_dwordx4 v[20:23], v6, s[36:39], 0 offen offset:64
    buffer_load_dwordx4 v[24:27], v6, s[36:39], 0 offen offset:128
    buffer_load_dwordx4 v[28:31], v6, s[36:39], 0 offen offset:192
    buffer_load_dwordx4 v[32:35], v6, s[36:39], 0 offen offset:256
    buffer_load_dwordx4 v[36:39], v6, s[36:39], 0 offen offset:320
    buffer_load_dwordx4 v[40:43], v6, s[36:39], 0 offen offset:384
    buffer_load_dwordx4 v[44:47], v6, s[36:39], 0 offen offset:448
    v_bfe_u32 v7, v1, 2, 2
    v_lshl_add_u32 v7, v5, 3, v7
    v_lshlrev_b32 v7, 7, v7
    v_and_b32 v8, 3, v1
    v_lshl_add_u32 v7, v8, 3, v7
    s_lshl_b32 s33, s20, 5
    v_add_u32 v7, s33, v7
    s_waitcnt vmcnt(0)
    s_barrier
    ds_read_b64_tr_b16 v[48:49], v7 offset:0
    ds_read_b64_tr_b16 v[50:51], v7 offset:512
    ds_read_b64_tr_b16 v[52:53], v7 offset:4096
    ds_read_b64_tr_b16 v[54:55], v7 offset:4608
    ds_read_b64_tr_b16 v[56:57], v7 offset:8192
    ds_read_b64_tr_b16 v[58:59], v7 offset:8704
    ds_read_b64_tr_b16 v[60:61], v7 offset:12288
    ds_read_b64_tr_b16 v[62:63], v7 offset:12800
    s_waitcnt lgkmcnt(0)
    ds_read_b64_tr_b16 v[64:65], v7 offset:16384
    ds_read_b64_tr_b16 v[66:67], v7 offset:16896
    ds_read_b64_tr_b16 v[68:69], v7 offset:20480
    ds_read_b64_tr_b16 v[70:71], v7 offset:20992
    ds_read_b64_tr_b16 v[72:73], v7 offset:24576
    ds_read_b64_tr_b16 v[74:75], v7 offset:25088
    ds_read_b64_tr_b16 v[76:77], v7 offset:28672
    ds_read_b64_tr_b16 v[78:79], v7 offset:29184
    s_waitcnt lgkmcnt(0)
    v_mfma_f32_16x16x32_bf16 v[80:83], v[48:51], v[16:19], 0
    v_mfma_f32_16x16x32_bf16 v[80:83], v[52:55], v[20:23], v[80:83]
    v_mfma_f32_16x16x32_bf16 v[80:83], v[56:59], v[24:27], v[80:83]
    v_mfma_f32_16x16x32_bf16 v[80:83], v[60:63], v[28:31], v[80:83]
    v_mfma_f32_16x16x32_bf16 v[80:83], v[64:67], v[32:35], v[80:83]
    v_mfma_f32_16x16x32_bf16 v[80:83], v[68:71], v[36:39], v[80:83]
    v_mfma_f32_16x16x32_bf16 v[80:83], v[72:75], v[40:43], v[80:83]
    v_mfma_f32_16x16x32_bf16 v[80:83], v[76:79], v[44:47], v[80:83]
    s_nop 7
    v_cvt_pk_bf16_f32 v84, v80, v81
    v_cvt_pk_bf16_f32 v85, v82, v83
    s_mov_b32 s33, 0x4038aa3b
    v_lshlrev_b32 v80, 16, v84
    v_and_b32 v81, 0xffff0000, v84
    v_lshlrev_b32 v82, 16, v85
    v_and_b32 v83, 0xffff0000, v85
    v_mul_f32 v80, s33, v80
    v_mul_f32 v81, s33, v81
    v_mul_f32 v82, s33, v82
    v_mul_f32 v83, s33, v83
    v_lshlrev_b32 v6, 10, v4
    v_lshl_add_u32 v6, v5, 4, v6
    s_lshl_b32 s33, s26, 8
    s_lshl_b32 s34, s20, 6
    s_add_u32 s33, s33, s34
    s_add_u32 s33, s33, 16384
    buffer_store_dwordx4 v[80:83], v6, s[12:15], s33 offen sc1
    s_endpgm
L_prep_kernel_tab:
    v_and_b32 v8, 63, v0
    v_lshlrev_b32 v6, 4, v8
    s_waitcnt lgkmcnt(0)
    s_add_u32 s12, s6, 85499904
    s_addc_u32 s13, s7, 0
    s_mov_b32 s14, 294912
    s_mov_b32 s15, 0x00020000
    s_lshl_b32 s32, s20, 4
    s_lshl_b32 s33, s20, 11
    v_and_b32 v9, 15, v8
    v_lshrrev_b32 v10, 4, v8
    v_or_b32 v11, 1, v9
    v_add_u32 v11, s32, v11
    v_cvt_f32_u32 v11, v11
    v_mul_f32 v11, 0x3c000000, v11
    v_lshlrev_b32 v10, 3, v10
    v_add_u32 v10, 0, v10
    v_cvt_f32_u32 v10, v10
    v_and_b32 v9, 1, v9
    v_cvt_f32_u32 v9, v9
    v_mul_f32 v9, 0x3e800000, v9
    v_fma_f32 v12, v11, v10, v9
    v_fract_f32 v13, v12
    v_add_f32 v12, v12, v11
    v_fract_f32 v14, v12
    v_add_f32 v12, v12, v11
    v_fract_f32 v15, v12
    v_add_f32 v12, v12, v11
    v_fract_f32 v16, v12
    v_add_f32 v12, v12, v11
    v_fract_f32 v17, v12
    v_add_f32 v12, v12, v11
    v_fract_f32 v18, v12
    v_add_f32 v12, v12, v11
    v_fract_f32 v19, v12
    v_add_f32 v12, v12, v11
    v_fract_f32 v20, v12
    v_cos_f32 v13, v13
    v_cos_f32 v14, v14
    v_cos_f32 v15, v15
    v_cos_f32 v16, v16
    v_cos_f32 v17, v17
    v_cos_f32 v18, v18
    v_cos_f32 v19, v19
    v_cos_f32 v20, v20
    s_nop 0
    v_cvt_pk_bf16_f32 v24, v13, v14
    v_cvt_pk_bf16_f32 v25, v15, v16
    v_cvt_pk_bf16_f32 v26, v17, v18
    v_cvt_pk_bf16_f32 v27, v19, v20
    s_add_u32 s34, s33, 0
    buffer_store_dwordx4 v[24:27], v6, s[12:15], s34 offen sc1
    v_and_b32 v9, 15, v8
    v_lshrrev_b32 v10, 4, v8
    v_or_b32 v11, 1, v9
    v_add_u32 v11, s32, v11
    v_cvt_f32_u32 v11, v11
    v_mul_f32 v11, 0x3c000000, v11
    v_lshlrev_b32 v10, 3, v10
    v_add_u32 v10, 32, v10
    v_cvt_f32_u32 v10, v10
    v_and_b32 v9, 1, v9
    v_cvt_f32_u32 v9, v9
    v_mul_f32 v9, 0x3e800000, v9
    v_fma_f32 v12, v11, v10, v9
    v_fract_f32 v13, v12
    v_add_f32 v12, v12, v11
    v_fract_f32 v14, v12
    v_add_f32 v12, v12, v11
    v_fract_f32 v15, v12
    v_add_f32 v12, v12, v11
    v_fract_f32 v16, v12
    v_add_f32 v12, v12, v11
    v_fract_f32 v17, v12
    v_add_f32 v12, v12, v11
    v_fract_f32 v18, v12
    v_add_f32 v12, v12, v11
    v_fract_f32 v19, v12
    v_add_f32 v12, v12, v11
    v_fract_f32 v20, v12
    v_cos_f32 v13, v13
    v_cos_f32 v14, v14
    v_cos_f32 v15, v15
    v_cos_f32 v16, v16
    v_cos_f32 v17, v17
    v_cos_f32 v18, v18
    v_cos_f32 v19, v19
    v_cos_f32 v20, v20
    s_nop 0
    v_cvt_pk_bf16_f32 v28, v13, v14
    v_cvt_pk_bf16_f32 v29, v15, v16
    v_cvt_pk_bf16_f32 v30, v17, v18
    v_cvt_pk_bf16_f32 v31, v19, v20
    s_add_u32 s34, s33, 1024
    buffer_store_dwordx4 v[28:31], v6, s[12:15], s34 offen sc1
    s_cmp_ge_u32 s20, 3
    s_cbranch_scc1 L_prep_kernel_done
    v_and_b32 v9, 15, v8
    v_add_u32 v9, s32, v9
    v_cvt_f32_u32 v9, v9
    v_mul_f32 v9, 0x3c000000, v9
    v_lshrrev_b32 v10, 4, v8
    v_lshlrev_b32 v10, 3, v10
    v_add_u32 v11, 1, v10
    v_cvt_f32_u32 v11, v11
    v_mul_f32 v11, v11, v9
    v_fract_f32 v12, v11
    v_add_u32 v11, 1, v10
    v_cvt_f32_u32 v11, v11
    v_mul_f32 v11, v11, v9
    v_add_f32 v11, 0x3e800000, v11
    v_fract_f32 v13, v11
    v_add_u32 v11, 3, v10
    v_cvt_f32_u32 v11, v11
    v_mul_f32 v11, v11, v9
    v_fract_f32 v14, v11
    v_add_u32 v11, 3, v10
    v_cvt_f32_u32 v11, v11
    v_mul_f32 v11, v11, v9
    v_add_f32 v11, 0x3e800000, v11
    v_fract_f32 v15, v11
    v_add_u32 v11, 5, v10
    v_cvt_f32_u32 v11, v11
    v_mul_f32 v11, v11, v9
    v_fract_f32 v16, v11
    v_add_u32 v11, 5, v10
    v_cvt_f32_u32 v11, v11
    v_mul_f32 v11, v11, v9
    v_add_f32 v11, 0x3e800000, v11
    v_fract_f32 v17, v11
    v_add_u32 v11, 7, v10
    v_cvt_f32_u32 v11, v11
    v_mul_f32 v11, v11, v9
    v_fract_f32 v18, v11
    v_add_u32 v11, 7, v10
    v_cvt_f32_u32 v11, v11
    v_mul_f32 v11, v11, v9
    v_add_f32 v11, 0x3e800000, v11
    v_fract_f32 v19, v11
    v_cos_f32 v12, v12
    v_cos_f32 v13, v13
    v_cos_f32 v14, v14
    v_cos_f32 v15, v15
    v_cos_f32 v16, v16
    v_cos_f32 v17, v17
    v_cos_f32 v18, v18
    v_cos_f32 v19, v19
    s_nop 0
    v_cvt_pk_bf16_f32 v24, v12, v13
    v_cvt_pk_bf16_f32 v25, v14, v15
    v_cvt_pk_bf16_f32 v26, v16, v17
    v_cvt_pk_bf16_f32 v27, v18, v19
    s_add_u32 s34, s33, 8192
    buffer_store_dwordx4 v[24:27], v6, s[12:15], s34 offen sc1
    s_nop 1
    v_add_u32 v11, 33, v10
    v_cvt_f32_u32 v11, v11
    v_mul_f32 v11, v11, v9
    v_fract_f32 v12, v11
    v_add_u32 v11, 33, v10
    v_cvt_f32_u32 v11, v11
    v_mul_f32 v11, v11, v9
    v_add_f32 v11, 0x3e800000, v11
    v_fract_f32 v13, v11
    v_add_u32 v11, 35, v10
    v_cvt_f32_u32 v11, v11
    v_mul_f32 v11, v11, v9
    v_fract_f32 v14, v11
    v_add_u32 v11, 35, v10
    v_cvt_f32_u32 v11, v11
    v_mul_f32 v11, v11, v9
    v_add_f32 v11, 0x3e800000, v11
    v_fract_f32 v15, v11
    v_add_u32 v11, 37, v10
    v_cvt_f32_u32 v11, v11
    v_mul_f32 v11, v11, v9
    v_fract_f32 v16, v11
    v_add_u32 v11, 37, v10
    v_cvt_f32_u32 v11, v11
    v_mul_f32 v11, v11, v9
    v_add_f32 v11, 0x3e800000, v11
    v_fract_f32 v17, v11
    v_add_u32 v11, 39, v10
    v_cvt_f32_u32 v11, v11
    v_mul_f32 v11, v11, v9
    v_fract_f32 v18, v11
    v_add_u32 v11, 39, v10
    v_cvt_f32_u32 v11, v11
    v_mul_f32 v11, v11, v9
    v_add_f32 v11, 0x3e800000, v11
    v_fract_f32 v19, v11
    v_cos_f32 v12, v12
    v_cos_f32 v13, v13
    v_cos_f32 v14, v14
    v_cos_f32 v15, v15
    v_cos_f32 v16, v16
    v_cos_f32 v17, v17
    v_cos_f32 v18, v18
    v_cos_f32 v19, v19
    s_nop 0
    v_cvt_pk_bf16_f32 v24, v12, v13
    v_cvt_pk_bf16_f32 v25, v14, v15
    v_cvt_pk_bf16_f32 v26, v16, v17
    v_cvt_pk_bf16_f32 v27, v18, v19
    s_add_u32 s34, s33, 9216
    buffer_store_dwordx4 v[24:27], v6, s[12:15], s34 offen sc1
    s_nop 1
L_prep_kernel_done:
    s_endpgm
.globl gemm1_kernel
.p2align 8
.type gemm1_kernel,@function
gemm1_kernel:
    s_cmp_ge_u32 s2, 256
    s_cbranch_scc1 L_gemm1_kernel_done
    s_load_dwordx2 s[4:5], s[0:1], 72
    s_load_dwordx2 s[6:7], s[0:1], 72
    v_readfirstlane_b32 s20, v0
    s_lshr_b32 s20, s20, 6
    s_and_b32 s24, s2, 7
    s_lshr_b32 s25, s2, 3
    s_lshr_b32 s26, s25, 3
    s_lshl_b32 s24, s24, 2
    s_add_u32 s21, s24, s26
    s_and_b32 s25, s25, 7
    s_lshr_b32 s26, s25, 1
    s_and_b32 s27, s25, 1
    s_mul_i32 s22, s26, 84
    s_sub_u32 s28, 334, s22
    s_min_u32 s28, s28, 84
    s_waitcnt lgkmcnt(0)
    s_mul_i32 s29, s21, 684032
    s_lshl_b32 s30, s22, 11
    s_add_u32 s29, s29, s30
    s_add_u32 s29, s29, 0
    s_add_u32 s8, s6, s29
    s_addc_u32 s9, s7, 0
    s_lshl_b32 s10, s28, 11
    s_mov_b32 s11, 0x00020000
    s_mul_i32 s29, s21, 528640
    s_mul_i32 s30, s27, 16384
    s_add_u32 s29, s29, s30
    s_add_u32 s29, s29, 21954560
    s_add_u32 s12, s4, s29
    s_addc_u32 s13, s5, 0
    s_mov_b32 s14, 507904
    s_mov_b32 s15, 0x00020000
    s_cmp_lt_u32 s20, 4
    s_cbranch_scc1 L_gemm1_kernel_consumer
    s_sub_u32 s20, s20, 4
    v_and_b32 v1, 63, v0
    v_lshrrev_b32 v4, 3, v1
    v_and_b32 v5, 7, v1
    v_xor_b32 v5, v5, v4
    v_lshlrev_b32 v5, 4, v5
    v_lshl_add_u32 v2, v4, 11, v5
    v_lshlrev_b32 v3, 4, v1
    s_add_u32 s24, s20, 0
    s_lshl_b32 s40, s24, 10
    s_lshl_b32 s43, s24, 14
    s_add_u32 s24, s20, 4
    s_lshl_b32 s41, s24, 10
    s_lshl_b32 s44, s24, 14
    s_add_u32 s24, s20, 8
    s_lshl_b32 s42, s24, 10
    s_lshl_b32 s45, s24, 14
    s_mul_i32 s46, s20, 4096
    s_add_u32 s47, s46, 12288
    s_add_u32 m0, s40, 0
    s_add_u32 s24, s43, 0
    buffer_load_dwordx4 v2, s[8:11], s24 offen lds
    s_add_u32 m0, s41, 0
    s_add_u32 s24, s44, 0
    buffer_load_dwordx4 v2, s[8:11], s24 offen lds
    s_add_u32 m0, s42, 0
    s_add_u32 s24, s45, 0
    buffer_load_dwordx4 v2, s[8:11], s24 offen lds
    s_add_u32 m0, s47, 0
    s_add_u32 s24, s46, 0
    buffer_load_dwordx4 v3, s[12:15], s24 offen offset:0 lds
    buffer_load_dwordx4 v3, s[12:15], s24 offen offset:1024 lds
    buffer_load_dwordx4 v3, s[12:15], s24 offen offset:2048 lds
    buffer_load_dwordx4 v3, s[12:15], s24 offen offset:3072 lds
    s_add_u32 m0, s40, 28672
    s_add_u32 s24, s43, 128
    buffer_load_dwordx4 v2, s[8:11], s24 offen lds
    s_add_u32 m0, s41, 28672
    s_add_u32 s24, s44, 128
    buffer_load_dwordx4 v2, s[8:11], s24 offen lds
    s_add_u32 m0, s42, 28672
    s_add_u32 s24, s45, 128
    buffer_load_dwordx4 v2, s[8:11], s24 offen lds
    s_add_u32 m0, s47, 28672
    s_add_u32 s24, s46, 32768
    buffer_load_dwordx4 v3, s[12:15], s24 offen offset:0 lds
    buffer_load_dwordx4 v3, s[12:15], s24 offen offset:1024 lds
    buffer_load_dwordx4 v3, s[12:15], s24 offen offset:2048 lds
    buffer_load_dwordx4 v3, s[12:15], s24 offen offset:3072 lds
    s_waitcnt vmcnt(7)
    s_barrier
    s_add_u32 m0, s40, 57344
    s_add_u32 s24, s43, 256
    buffer_load_dwordx4 v2, s[8:11], s24 offen lds
    s_add_u32 m0, s41, 57344
    s_add_u32 s24, s44, 256
    buffer_load_dwordx4 v2, s[8:11], s24 offen lds
    s_add_u32 m0, s42, 57344
    s_add_u32 s24, s45, 256
    buffer_load_dwordx4 v2, s[8:11], s24 offen lds
    s_add_u32 m0, s47, 57344
    s_add_u32 s24, s46, 65536
    buffer_load_dwordx4 v3, s[12:15], s24 offen offset:0 lds
    buffer_load_dwordx4 v3, s[12:15], s24 offen offset:1024 lds
    buffer_load_dwordx4 v3, s[12:15], s24 offen offset:2048 lds
    buffer_load_dwordx4 v3, s[12:15], s24 offen offset:3072 lds
    s_waitcnt vmcnt(7)
    s_barrier
    s_add_u32 m0, s40, 86016
    s_add_u32 s24, s43, 384
    buffer_load_dwordx4 v2, s[8:11], s24 offen lds
    s_add_u32 m0, s41, 86016
    s_add_u32 s24, s44, 384
    buffer_load_dwordx4 v2, s[8:11], s24 offen lds
    s_add_u32 m0, s42, 86016
    s_add_u32 s24, s45, 384
    buffer_load_dwordx4 v2, s[8:11], s24 offen lds
    s_add_u32 m0, s47, 86016
    s_add_u32 s24, s46, 98304
    buffer_load_dwordx4 v3, s[12:15], s24 offen offset:0 lds
    buffer_load_dwordx4 v3, s[12:15], s24 offen offset:1024 lds
    buffer_load_dwordx4 v3, s[12:15], s24 offen offset:2048 lds
    buffer_load_dwordx4 v3, s[12:15], s24 offen offset:3072 lds
    s_add_u32 m0, s40, 114688
    s_add_u32 s24, s43, 512
    buffer_load_dwordx4 v2, s[8:11], s24 offen lds
    s_add_u32 m0, s41, 114688
    s_add_u32 s24, s44, 512
    buffer_load_dwordx4 v2, s[8:11], s24 offen lds
    s_add_u32 m0, s42, 114688
    s_add_u32 s24, s45, 512
    buffer_load_dwordx4 v2, s[8:11], s24 offen lds
    s_add_u32 m0, s47, 114688
    s_add_u32 s24, s46, 131072
    buffer_load_dwordx4 v3, s[12:15], s24 offen offset:0 lds
    buffer_load_dwordx4 v3, s[12:15], s24 offen offset:1024 lds
    buffer_load_dwordx4 v3, s[12:15], s24 offen offset:2048 lds
    buffer_load_dwordx4 v3, s[12:15], s24 offen offset:3072 lds
    s_waitcnt vmcnt(14)
    s_barrier
    s_add_u32 m0, s40, 0
    s_add_u32 s24, s43, 640
    buffer_load_dwordx4 v2, s[8:11], s24 offen lds
    s_add_u32 m0, s41, 0
    s_add_u32 s24, s44, 640
    buffer_load_dwordx4 v2, s[8:11], s24 offen lds
    s_add_u32 m0, s42, 0
    s_add_u32 s24, s45, 640
    buffer_load_dwordx4 v2, s[8:11], s24 offen lds
    s_add_u32 m0, s47, 0
    s_add_u32 s24, s46, 163840
    buffer_load_dwordx4 v3, s[12:15], s24 offen offset:0 lds
    buffer_load_dwordx4 v3, s[12:15], s24 offen offset:1024 lds
    buffer_load_dwordx4 v3, s[12:15], s24 offen offset:2048 lds
    buffer_load_dwordx4 v3, s[12:15], s24 offen offset:3072 lds
    s_add_u32 m0, s40, 28672
    s_add_u32 s24, s43, 768
    buffer_load_dwordx4 v2, s[8:11], s24 offen lds
    s_add_u32 m0, s41, 28672
    s_add_u32 s24, s44, 768
    buffer_load_dwordx4 v2, s[8:11], s24 offen lds
    s_add_u32 m0, s42, 28672
    s_add_u32 s24, s45, 768
    buffer_load_dwordx4 v2, s[8:11], s24 offen lds
    s_add_u32 m0, s47, 28672
    s_add_u32 s24, s46, 196608
    buffer_load_dwordx4 v3, s[12:15], s24 offen offset:0 lds
    buffer_load_dwordx4 v3, s[12:15], s24 offen offset:1024 lds
    buffer_load_dwordx4 v3, s[12:15], s24 offen offset:2048 lds
    buffer_load_dwordx4 v3, s[12:15], s24 offen offset:3072 lds
    s_waitcnt vmcnt(21)
    s_barrier
    s_add_u32 m0, s40, 57344
    s_add_u32 s24, s43, 896
    buffer_load_dwordx4 v2, s[8:11], s24 offen lds
    s_add_u32 m0, s41, 57344
    s_add_u32 s24, s44, 896
    buffer_load_dwordx4 v2, s[8:11], s24 offen lds
    s_add_u32 m0, s42, 57344
    s_add_u32 s24, s45, 896
    buffer_load_dwordx4 v2, s[8:11], s24 offen lds
    s_add_u32 m0, s47, 57344
    s_add_u32 s24, s46, 229376
    buffer_load_dwordx4 v3, s[12:15], s24 offen offset:0 lds
    buffer_load_dwordx4 v3, s[12:15], s24 offen offset:1024 lds
    buffer_load_dwordx4 v3, s[12:15], s24 offen offset:2048 lds
    buffer_load_dwordx4 v3, s[12:15], s24 offen offset:3072 lds
    s_waitcnt vmcnt(21)
    s_barrier
    s_add_u32 m0, s40, 86016
    s_add_u32 s24, s43, 1024
    buffer_load_dwordx4 v2, s[8:11], s24 offen lds
    s_add_u32 m0, s41, 86016
    s_add_u32 s24, s44, 1024
    buffer_load_dwordx4 v2, s[8:11], s24 offen lds
    s_add_u32 m0, s42, 86016
    s_add_u32 s24, s45, 1024
    buffer_load_dwordx4 v2, s[8:11], s24 offen lds
    s_add_u32 m0, s47, 86016
    s_add_u32 s24, s46, 262144
    buffer_load_dwordx4 v3, s[12:15], s24 offen offset:0 lds
    buffer_load_dwordx4 v3, s[12:15], s24 offen offset:1024 lds
    buffer_load_dwordx4 v3, s[12:15], s24 offen offset:2048 lds
    buffer_load_dwordx4 v3, s[12:15], s24 offen offset:3072 lds
    s_waitcnt vmcnt(21)
    s_barrier
    s_add_u32 m0, s40, 114688
    s_add_u32 s24, s43, 1152
    buffer_load_dwordx4 v2, s[8:11], s24 offen lds
    s_add_u32 m0, s41, 114688
    s_add_u32 s24, s44, 1152
    buffer_load_dwordx4 v2, s[8:11], s24 offen lds
    s_add_u32 m0, s42, 114688
    s_add_u32 s24, s45, 1152
    buffer_load_dwordx4 v2, s[8:11], s24 offen lds
    s_add_u32 m0, s47, 114688
    s_add_u32 s24, s46, 294912
    buffer_load_dwordx4 v3, s[12:15], s24 offen offset:0 lds
    buffer_load_dwordx4 v3, s[12:15], s24 offen offset:1024 lds
    buffer_load_dwordx4 v3, s[12:15], s24 offen offset:2048 lds
    buffer_load_dwordx4 v3, s[12:15], s24 offen offset:3072 lds
    s_waitcnt vmcnt(21)
    s_barrier
    s_add_u32 m0, s40, 0
    s_add_u32 s24, s43, 1280
    buffer_load_dwordx4 v2, s[8:11], s24 offen lds
    s_add_u32 m0, s41, 0
    s_add_u32 s24, s44, 1280
    buffer_load_dwordx4 v2, s[8:11], s24 offen lds
    s_add_u32 m0, s42, 0
    s_add_u32 s24, s45, 1280
    buffer_load_dwordx4 v2, s[8:11], s24 offen lds
    s_add_u32 m0, s47, 0
    s_add_u32 s24, s46, 327680
    buffer_load_dwordx4 v3, s[12:15], s24 offen offset:0 lds
    buffer_load_dwordx4 v3, s[12:15], s24 offen offset:1024 lds
    buffer_load_dwordx4 v3, s[12:15], s24 offen offset:2048 lds
    buffer_load_dwordx4 v3, s[12:15], s24 offen offset:3072 lds
    s_waitcnt vmcnt(21)
    s_barrier
    s_add_u32 m0, s40, 28672
    s_add_u32 s24, s43, 1408
    buffer_load_dwordx4 v2, s[8:11], s24 offen lds
    s_add_u32 m0, s41, 28672
    s_add_u32 s24, s44, 1408
    buffer_load_dwordx4 v2, s[8:11], s24 offen lds
    s_add_u32 m0, s42, 28672
    s_add_u32 s24, s45, 1408
    buffer_load_dwordx4 v2, s[8:11], s24 offen lds
    s_add_u32 m0, s47, 28672
    s_add_u32 s24, s46, 360448
    buffer_load_dwordx4 v3, s[12:15], s24 offen offset:0 lds
    buffer_load_dwordx4 v3, s[12:15], s24 offen offset:1024 lds
    buffer_load_dwordx4 v3, s[12:15], s24 offen offset:2048 lds
    buffer_load_dwordx4 v3, s[12:15], s24 offen offset:3072 lds
    s_waitcnt vmcnt(21)
    s_barrier
    s_add_u32 m0, s40, 57344
    s_add_u32 s24, s43, 1536
    buffer_load_dwordx4 v2, s[8:11], s24 offen lds
    s_add_u32 m0, s41, 57344
    s_add_u32 s24, s44, 1536
    buffer_load_dwordx4 v2, s[8:11], s24 offen lds
    s_add_u32 m0, s42, 57344
    s_add_u32 s24, s45, 1536
    buffer_load_dwordx4 v2, s[8:11], s24 offen lds
    s_add_u32 m0, s47, 57344
    s_add_u32 s24, s46, 393216
    buffer_load_dwordx4 v3, s[12:15], s24 offen offset:0 lds
    buffer_load_dwordx4 v3, s[12:15], s24 offen offset:1024 lds
    buffer_load_dwordx4 v3, s[12:15], s24 offen offset:2048 lds
    buffer_load_dwordx4 v3, s[12:15], s24 offen offset:3072 lds
    s_waitcnt vmcnt(21)
    s_barrier
    s_add_u32 m0, s40, 86016
    s_add_u32 s24, s43, 1664
    buffer_load_dwordx4 v2, s[8:11], s24 offen lds
    s_add_u32 m0, s41, 86016
    s_add_u32 s24, s44, 1664
    buffer_load_dwordx4 v2, s[8:11], s24 offen lds
    s_add_u32 m0, s42, 86016
    s_add_u32 s24, s45, 1664
    buffer_load_dwordx4 v2, s[8:11], s24 offen lds
    s_add_u32 m0, s47, 86016
    s_add_u32 s24, s46, 425984
    buffer_load_dwordx4 v3, s[12:15], s24 offen offset:0 lds
    buffer_load_dwordx4 v3, s[12:15], s24 offen offset:1024 lds
    buffer_load_dwordx4 v3, s[12:15], s24 offen offset:2048 lds
    buffer_load_dwordx4 v3, s[12:15], s24 offen offset:3072 lds
    s_waitcnt vmcnt(21)
    s_barrier
    s_add_u32 m0, s40, 114688
    s_add_u32 s24, s43, 1792
    buffer_load_dwordx4 v2, s[8:11], s24 offen lds
    s_add_u32 m0, s41, 114688
    s_add_u32 s24, s44, 1792
    buffer_load_dwordx4 v2, s[8:11], s24 offen lds
    s_add_u32 m0, s42, 114688
    s_add_u32 s24, s45, 1792
    buffer_load_dwordx4 v2, s[8:11], s24 offen lds
    s_add_u32 m0, s47, 114688
    s_add_u32 s24, s46, 458752
    buffer_load_dwordx4 v3, s[12:15], s24 offen offset:0 lds
    buffer_load_dwordx4 v3, s[12:15], s24 offen offset:1024 lds
    buffer_load_dwordx4 v3, s[12:15], s24 offen offset:2048 lds
    buffer_load_dwordx4 v3, s[12:15], s24 offen offset:3072 lds
    s_waitcnt vmcnt(21)
    s_barrier
    s_add_u32 m0, s40, 0
    s_add_u32 s24, s43, 1920
    buffer_load_dwordx4 v2, s[8:11], s24 offen lds
    s_add_u32 m0, s41, 0
    s_add_u32 s24, s44, 1920
    buffer_load_dwordx4 v2, s[8:11], s24 offen lds
    s_add_u32 m0, s42, 0
    s_add_u32 s24, s45, 1920
    buffer_load_dwordx4 v2, s[8:11], s24 offen lds
    s_add_u32 m0, s47, 0
    s_add_u32 s24, s46, 491520
    buffer_load_dwordx4 v3, s[12:15], s24 offen offset:0 lds
    buffer_load_dwordx4 v3, s[12:15], s24 offen offset:1024 lds
    buffer_load_dwordx4 v3, s[12:15], s24 offen offset:2048 lds
    buffer_load_dwordx4 v3, s[12:15], s24 offen offset:3072 lds
    s_waitcnt vmcnt(21)
    s_barrier
    s_waitcnt vmcnt(14)
    s_barrier
    s_waitcnt vmcnt(7)
    s_barrier
    s_waitcnt vmcnt(0)
    s_barrier
    s_barrier
    s_barrier
L_gemm1_kernel_done:
    s_endpgm
L_gemm1_kernel_consumer:
    s_mul_i32 s29, s22, 37120
    s_add_u32 s29, s29, 38871040
    s_add_u32 s16, s4, s29
    s_addc_u32 s17, s5, 0
    s_mul_i32 s18, s28, 37120
    s_mov_b32 s19, 0x00020000
    s_lshr_b32 s29, s20, 1
    s_and_b32 s30, s20, 1
    v_and_b32 v217, 15, v0
    v_bfe_u32 v218, v0, 4, 2
    v_and_b32 v219, 63, v0
    s_mul_i32 s31, s29, 6144
    v_and_b32 v220, 7, v217
    v_xor_b32 v220, v218, v220
    v_lshlrev_b32 v220, 4, v220
    v_lshl_add_u32 v220, v217, 7, v220
    v_add_u32 v220, s31, v220
    v_add_u32 v208, 0, v220
    v_xor_b32 v211, 64, v208
    v_add_u32 v209, 57344, v220
    v_xor_b32 v212, 64, v209
    v_add_u32 v210, 114688, v220
    v_xor_b32 v213, 64, v210
    s_mul_i32 s31, s30, 8192
    s_add_u32 s31, s31, 12288
    v_lshlrev_b32 v220, 4, v219
    v_add_u32 v220, s31, v220
    v_add_u32 v214, 0, v220
    v_add_u32 v215, 57344, v220
    v_add_u32 v216, 114688, v220
    v_and_b32 v224, 7, v217
    v_lshrrev_b32 v225, 3, v217
    v_mul_u32_u24 v222, 37120, v224
    v_lshl_add_u32 v222, v218, 4, v222
    s_mul_i32 s31, s29, 1781760
    v_add_u32 v222, s31, v222
    v_lshl_add_u32 v222, v225, 6, v222
    v_xor_b32 v225, 64, v222
    v_add_u32 v223, 296960, v225
    s_mul_i32 s31, s27, 4
    s_mul_i32 s29, s30, 2
    s_add_u32 s31, s31, s29
    s_mul_i32 s31, s31, 128
    s_mul_i32 s29, s21, 1024
    s_add_u32 s33, s31, s29
    s_mov_b32 s34, 0x80008000
    v_mov_b32 v0, 0
    v_mov_b32 v48, 0
    v_mov_b32 v1, 0
    v_mov_b32 v49, 0
    v_mov_b32 v2, 0
    v_mov_b32 v50, 0
    v_mov_b32 v3, 0
    v_mov_b32 v51, 0
    v_mov_b32 v4, 0
    v_mov_b32 v52, 0
    v_mov_b32 v5, 0
    v_mov_b32 v53, 0
    v_mov_b32 v6, 0
    v_mov_b32 v54, 0
    v_mov_b32 v7, 0
    v_mov_b32 v55, 0
    v_mov_b32 v8, 0
    v_mov_b32 v56, 0
    v_mov_b32 v9, 0
    v_mov_b32 v57, 0
    v_mov_b32 v10, 0
    v_mov_b32 v58, 0
    v_mov_b32 v11, 0
    v_mov_b32 v59, 0
    v_mov_b32 v12, 0
    v_mov_b32 v60, 0
    v_mov_b32 v13, 0
    v_mov_b32 v61, 0
    v_mov_b32 v14, 0
    v_mov_b32 v62, 0
    v_mov_b32 v15, 0
    v_mov_b32 v63, 0
    v_mov_b32 v16, 0
    v_mov_b32 v64, 0
    v_mov_b32 v17, 0
    v_mov_b32 v65, 0
    v_mov_b32 v18, 0
    v_mov_b32 v66, 0
    v_mov_b32 v19, 0
    v_mov_b32 v67, 0
    v_mov_b32 v20, 0
    v_mov_b32 v68, 0
    v_mov_b32 v21, 0
    v_mov_b32 v69, 0
    v_mov_b32 v22, 0
    v_mov_b32 v70, 0
    v_mov_b32 v23, 0
    v_mov_b32 v71, 0
    v_mov_b32 v24, 0
    v_mov_b32 v72, 0
    v_mov_b32 v25, 0
    v_mov_b32 v73, 0
    v_mov_b32 v26, 0
    v_mov_b32 v74, 0
    v_mov_b32 v27, 0
    v_mov_b32 v75, 0
    v_mov_b32 v28, 0
    v_mov_b32 v76, 0
    v_mov_b32 v29, 0
    v_mov_b32 v77, 0
    v_mov_b32 v30, 0
    v_mov_b32 v78, 0
    v_mov_b32 v31, 0
    v_mov_b32 v79, 0
    v_mov_b32 v32, 0
    v_mov_b32 v80, 0
    v_mov_b32 v33, 0
    v_mov_b32 v81, 0
    v_mov_b32 v34, 0
    v_mov_b32 v82, 0
    v_mov_b32 v35, 0
    v_mov_b32 v83, 0
    v_mov_b32 v36, 0
    v_mov_b32 v84, 0
    v_mov_b32 v37, 0
    v_mov_b32 v85, 0
    v_mov_b32 v38, 0
    v_mov_b32 v86, 0
    v_mov_b32 v39, 0
    v_mov_b32 v87, 0
    v_mov_b32 v40, 0
    v_mov_b32 v88, 0
    v_mov_b32 v41, 0
    v_mov_b32 v89, 0
    v_mov_b32 v42, 0
    v_mov_b32 v90, 0
    v_mov_b32 v43, 0
    v_mov_b32 v91, 0
    v_mov_b32 v44, 0
    v_mov_b32 v92, 0
    v_mov_b32 v45, 0
    v_mov_b32 v93, 0
    v_mov_b32 v46, 0
    v_mov_b32 v94, 0
    v_mov_b32 v47, 0
    v_mov_b32 v95, 0
    s_mov_b32 s38, 0
    v_add_u32 v209, s38, v208
    v_add_u32 v215, s38, v214
    v_xor_b32 v211, 64, v209
    s_add_u32 s38, s38, 28672
    s_cmp_eq_u32 s38, 143360
    s_cselect_b32 s38, 0, s38
    s_barrier
    ds_read_b128 v[96:99], v215 offset:0
    ds_read_b128 v[128:131], v209 offset:0
    ds_read_b128 v[136:139], v209 offset:2048
    ds_read_b128 v[144:147], v209 offset:4096
    ds_read_b128 v[104:107], v215 offset:2048
    ds_read_b128 v[112:115], v215 offset:4096
    ds_read_b128 v[120:123], v215 offset:6144
    ds_read_b128 v[132:135], v211 offset:0
    ds_read_b128 v[140:143], v211 offset:2048
    ds_read_b128 v[148:151], v211 offset:4096
    ds_read_b128 v[100:103], v215 offset:1024
    ds_read_b128 v[108:111], v215 offset:3072
    ds_read_b128 v[116:119], v215 offset:5120
    ds_read_b128 v[124:127], v215 offset:7168
    v_add_u32 v209, s38, v208
    v_add_u32 v215, s38, v214
    v_xor_b32 v211, 64, v209
    s_add_u32 s38, s38, 28672
    s_cmp_eq_u32 s38, 143360
    s_cselect_b32 s38, 0, s38
    s_mov_b32 s39, 8
    s_waitcnt lgkmcnt(0)
    s_barrier
L_gemm1_kernel_loop:
    v_mfma_f32_16x16x32_bf16 v[0:3], v[96:99], v[128:131], v[0:3]
    ds_read_b128 v[152:155], v215 offset:0
    v_mfma_f32_16x16x32_bf16 v[4:7], v[96:99], v[136:139], v[4:7]
    v_mfma_f32_16x16x32_bf16 v[8:11], v[96:99], v[144:147], v[8:11]
    ds_read_b128 v[184:187], v209 offset:0
    v_mfma_f32_16x16x32_bf16 v[12:15], v[104:107], v[128:131], v[12:15]
    v_mfma_f32_16x16x32_bf16 v[16:19], v[104:107], v[136:139], v[16:19]
    ds_read_b128 v[192:195], v209 offset:2048
    v_mfma_f32_16x16x32_bf16 v[20:23], v[104:107], v[144:147], v[20:23]
    v_mfma_f32_16x16x32_bf16 v[24:27], v[112:115], v[128:131], v[24:27]
    ds_read_b128 v[200:203], v209 offset:4096
    v_mfma_f32_16x16x32_bf16 v[28:31], v[112:115], v[136:139], v[28:31]
    v_mfma_f32_16x16x32_bf16 v[32:35], v[112:115], v[144:147], v[32:35]
    ds_read_b128 v[160:163], v215 offset:2048
    v_mfma_f32_16x16x32_bf16 v[36:39], v[120:123], v[128:131], v[36:39]
    v_mfma_f32_16x16x32_bf16 v[40:43], v[120:123], v[136:139], v[40:43]
    ds_read_b128 v[168:171], v215 offset:4096
    v_mfma_f32_16x16x32_bf16 v[44:47], v[120:123], v[144:147], v[44:47]
    v_mfma_f32_16x16x32_bf16 v[48:51], v[96:99], v[132:135], v[48:51]
    ds_read_b128 v[176:179], v215 offset:6144
    v_mfma_f32_16x16x32_bf16 v[52:55], v[96:99], v[140:143], v[52:55]
    v_mfma_f32_16x16x32_bf16 v[56:59], v[96:99], v[148:151], v[56:59]
    ds_read_b128 v[188:191], v211 offset:0
    v_mfma_f32_16x16x32_bf16 v[60:63], v[104:107], v[132:135], v[60:63]
    v_mfma_f32_16x16x32_bf16 v[64:67], v[104:107], v[140:143], v[64:67]
    ds_read_b128 v[196:199], v211 offset:2048
    v_mfma_f32_16x16x32_bf16 v[68:71], v[104:107], v[148:151], v[68:71]
    v_mfma_f32_16x16x32_bf16 v[72:75], v[112:115], v[132:135], v[72:75]
    ds_read_b128 v[204:207], v211 offset:4096
    v_mfma_f32_16x16x32_bf16 v[76:79], v[112:115], v[140:143], v[76:79]
    v_mfma_f32_16x16x32_bf16 v[80:83], v[112:115], v[148:151], v[80:83]
    ds_read_b128 v[156:159], v215 offset:1024
    v_mfma_f32_16x16x32_bf16 v[84:87], v[120:123], v[132:135], v[84:87]
    v_mfma_f32_16x16x32_bf16 v[88:91], v[120:123], v[140:143], v[88:91]
    ds_read_b128 v[164:167], v215 offset:3072
    v_mfma_f32_16x16x32_bf16 v[92:95], v[120:123], v[148:151], v[92:95]
    v_mfma_f32_16x16x32_bf16 v[48:51], v[100:103], v[128:131], v[48:51]
    ds_read_b128 v[172:175], v215 offset:5120
    v_xor_b32 v132, s34, v132
    v_xor_b32 v133, s34, v133
    v_mfma_f32_16x16x32_bf16 v[52:55], v[100:103], v[136:139], v[52:55]
    v_xor_b32 v134, s34, v134
    v_xor_b32 v135, s34, v135
    v_mfma_f32_16x16x32_bf16 v[56:59], v[100:103], v[144:147], v[56:59]
    ds_read_b128 v[180:183], v215 offset:7168
    v_xor_b32 v140, s34, v140
    v_xor_b32 v141, s34, v141
    v_mfma_f32_16x16x32_bf16 v[60:63], v[108:111], v[128:131], v[60:63]
    v_xor_b32 v142, s34, v142
    v_xor_b32 v143, s34, v143
    v_mfma_f32_16x16x32_bf16 v[64:67], v[108:111], v[136:139], v[64:67]
    v_xor_b32 v148, s34, v148
    v_xor_b32 v149, s34, v149
    v_mfma_f32_16x16x32_bf16 v[68:71], v[108:111], v[144:147], v[68:71]
    v_xor_b32 v150, s34, v150
    v_xor_b32 v151, s34, v151
    v_mfma_f32_16x16x32_bf16 v[72:75], v[116:119], v[128:131], v[72:75]
    v_mfma_f32_16x16x32_bf16 v[76:79], v[116:119], v[136:139], v[76:79]
    v_mfma_f32_16x16x32_bf16 v[80:83], v[116:119], v[144:147], v[80:83]
    v_mfma_f32_16x16x32_bf16 v[84:87], v[124:127], v[128:131], v[84:87]
    v_mfma_f32_16x16x32_bf16 v[88:91], v[124:127], v[136:139], v[88:91]
    v_mfma_f32_16x16x32_bf16 v[92:95], v[124:127], v[144:147], v[92:95]
    v_mfma_f32_16x16x32_bf16 v[0:3], v[100:103], v[132:135], v[0:3]
    v_mfma_f32_16x16x32_bf16 v[4:7], v[100:103], v[140:143], v[4:7]
    v_mfma_f32_16x16x32_bf16 v[8:11], v[100:103], v[148:151], v[8:11]
    v_mfma_f32_16x16x32_bf16 v[12:15], v[108:111], v[132:135], v[12:15]
    v_mfma_f32_16x16x32_bf16 v[16:19], v[108:111], v[140:143], v[16:19]
    s_waitcnt lgkmcnt(0)
    s_barrier
    v_mfma_f32_16x16x32_bf16 v[20:23], v[108:111], v[148:151], v[20:23]
    v_add_u32 v209, s38, v208
    v_add_u32 v215, s38, v214
    v_mfma_f32_16x16x32_bf16 v[24:27], v[116:119], v[132:135], v[24:27]
    v_xor_b32 v211, 64, v209
    s_add_u32 s38, s38, 28672
    v_mfma_f32_16x16x32_bf16 v[28:31], v[116:119], v[140:143], v[28:31]
    s_cmp_eq_u32 s38, 143360
    s_cselect_b32 s38, 0, s38
    v_mfma_f32_16x16x32_bf16 v[32:35], v[116:119], v[148:151], v[32:35]
    v_mfma_f32_16x16x32_bf16 v[36:39], v[124:127], v[132:135], v[36:39]
    v_mfma_f32_16x16x32_bf16 v[40:43], v[124:127], v[140:143], v[40:43]
    v_mfma_f32_16x16x32_bf16 v[44:47], v[124:127], v[148:151], v[44:47]
    v_mfma_f32_16x16x32_bf16 v[0:3], v[152:155], v[184:187], v[0:3]
    ds_read_b128 v[96:99], v215 offset:0
    v_mfma_f32_16x16x32_bf16 v[4:7], v[152:155], v[192:195], v[4:7]
    v_mfma_f32_16x16x32_bf16 v[8:11], v[152:155], v[200:203], v[8:11]
    ds_read_b128 v[128:131], v209 offset:0
    v_mfma_f32_16x16x32_bf16 v[12:15], v[160:163], v[184:187], v[12:15]
    v_mfma_f32_16x16x32_bf16 v[16:19], v[160:163], v[192:195], v[16:19]
    ds_read_b128 v[136:139], v209 offset:2048
    v_mfma_f32_16x16x32_bf16 v[20:23], v[160:163], v[200:203], v[20:23]
    v_mfma_f32_16x16x32_bf16 v[24:27], v[168:171], v[184:187], v[24:27]
    ds_read_b128 v[144:147], v209 offset:4096
    v_mfma_f32_16x16x32_bf16 v[28:31], v[168:171], v[192:195], v[28:31]
    v_mfma_f32_16x16x32_bf16 v[32:35], v[168:171], v[200:203], v[32:35]
    ds_read_b128 v[104:107], v215 offset:2048
    v_mfma_f32_16x16x32_bf16 v[36:39], v[176:179], v[184:187], v[36:39]
    v_mfma_f32_16x16x32_bf16 v[40:43], v[176:179], v[192:195], v[40:43]
    ds_read_b128 v[112:115], v215 offset:4096
    v_mfma_f32_16x16x32_bf16 v[44:47], v[176:179], v[200:203], v[44:47]
    v_mfma_f32_16x16x32_bf16 v[48:51], v[152:155], v[188:191], v[48:51]
    ds_read_b128 v[120:123], v215 offset:6144
    v_mfma_f32_16x16x32_bf16 v[52:55], v[152:155], v[196:199], v[52:55]
    v_mfma_f32_16x16x32_bf16 v[56:59], v[152:155], v[204:207], v[56:59]
    ds_read_b128 v[132:135], v211 offset:0
    v_mfma_f32_16x16x32_bf16 v[60:63], v[160:163], v[188:191], v[60:63]
    v_mfma_f32_16x16x32_bf16 v[64:67], v[160:163], v[196:199], v[64:67]
    ds_read_b128 v[140:143], v211 offset:2048
    v_mfma_f32_16x16x32_bf16 v[68:71], v[160:163], v[204:207], v[68:71]
    v_mfma_f32_16x16x32_bf16 v[72:75], v[168:171], v[188:191], v[72:75]
    ds_read_b128 v[148:151], v211 offset:4096
    v_mfma_f32_16x16x32_bf16 v[76:79], v[168:171], v[196:199], v[76:79]
    v_mfma_f32_16x16x32_bf16 v[80:83], v[168:171], v[204:207], v[80:83]
    ds_read_b128 v[100:103], v215 offset:1024
    v_mfma_f32_16x16x32_bf16 v[84:87], v[176:179], v[188:191], v[84:87]
    v_mfma_f32_16x16x32_bf16 v[88:91], v[176:179], v[196:199], v[88:91]
    ds_read_b128 v[108:111], v215 offset:3072
    v_mfma_f32_16x16x32_bf16 v[92:95], v[176:179], v[204:207], v[92:95]
    v_mfma_f32_16x16x32_bf16 v[48:51], v[156:159], v[184:187], v[48:51]
    ds_read_b128 v[116:119], v215 offset:5120
    v_xor_b32 v188, s34, v188
    v_xor_b32 v189, s34, v189
    v_mfma_f32_16x16x32_bf16 v[52:55], v[156:159], v[192:195], v[52:55]
    v_xor_b32 v190, s34, v190
    v_xor_b32 v191, s34, v191
    v_mfma_f32_16x16x32_bf16 v[56:59], v[156:159], v[200:203], v[56:59]
    ds_read_b128 v[124:127], v215 offset:7168
    v_xor_b32 v196, s34, v196
    v_xor_b32 v197, s34, v197
    v_mfma_f32_16x16x32_bf16 v[60:63], v[164:167], v[184:187], v[60:63]
    v_xor_b32 v198, s34, v198
    v_xor_b32 v199, s34, v199
    v_mfma_f32_16x16x32_bf16 v[64:67], v[164:167], v[192:195], v[64:67]
    v_xor_b32 v204, s34, v204
    v_xor_b32 v205, s34, v205
    v_mfma_f32_16x16x32_bf16 v[68:71], v[164:167], v[200:203], v[68:71]
    v_xor_b32 v206, s34, v206
    v_xor_b32 v207, s34, v207
    v_mfma_f32_16x16x32_bf16 v[72:75], v[172:175], v[184:187], v[72:75]
    v_mfma_f32_16x16x32_bf16 v[76:79], v[172:175], v[192:195], v[76:79]
    v_mfma_f32_16x16x32_bf16 v[80:83], v[172:175], v[200:203], v[80:83]
    v_mfma_f32_16x16x32_bf16 v[84:87], v[180:183], v[184:187], v[84:87]
    v_mfma_f32_16x16x32_bf16 v[88:91], v[180:183], v[192:195], v[88:91]
    v_mfma_f32_16x16x32_bf16 v[92:95], v[180:183], v[200:203], v[92:95]
    v_mfma_f32_16x16x32_bf16 v[0:3], v[156:159], v[188:191], v[0:3]
    v_mfma_f32_16x16x32_bf16 v[4:7], v[156:159], v[196:199], v[4:7]
    v_mfma_f32_16x16x32_bf16 v[8:11], v[156:159], v[204:207], v[8:11]
    v_mfma_f32_16x16x32_bf16 v[12:15], v[164:167], v[188:191], v[12:15]
    v_mfma_f32_16x16x32_bf16 v[16:19], v[164:167], v[196:199], v[16:19]
    s_waitcnt lgkmcnt(0)
    s_barrier
    v_mfma_f32_16x16x32_bf16 v[20:23], v[164:167], v[204:207], v[20:23]
    v_add_u32 v209, s38, v208
    v_add_u32 v215, s38, v214
    v_mfma_f32_16x16x32_bf16 v[24:27], v[172:175], v[188:191], v[24:27]
    v_xor_b32 v211, 64, v209
    s_add_u32 s38, s38, 28672
    v_mfma_f32_16x16x32_bf16 v[28:31], v[172:175], v[196:199], v[28:31]
    s_cmp_eq_u32 s38, 143360
    s_cselect_b32 s38, 0, s38
    v_mfma_f32_16x16x32_bf16 v[32:35], v[172:175], v[204:207], v[32:35]
    v_mfma_f32_16x16x32_bf16 v[36:39], v[180:183], v[188:191], v[36:39]
    v_mfma_f32_16x16x32_bf16 v[40:43], v[180:183], v[196:199], v[40:43]
    s_sub_u32 s39, s39, 1
    v_mfma_f32_16x16x32_bf16 v[44:47], v[180:183], v[204:207], v[44:47]
    s_cmp_lg_u32 s39, 0
    s_cbranch_scc1 L_gemm1_kernel_loop
    s_nop 7
    s_nop 7
    v_cvt_pk_bf16_f32 v96, v0, v1
    v_cvt_pk_bf16_f32 v97, v2, v3
    v_cvt_pk_bf16_f32 v98, v12, v13
    v_cvt_pk_bf16_f32 v99, v14, v15
    v_cvt_pk_bf16_f32 v100, v48, v49
    v_cvt_pk_bf16_f32 v101, v50, v51
    v_cvt_pk_bf16_f32 v102, v60, v61
    v_cvt_pk_bf16_f32 v103, v62, v63
    v_mov_b32 v104, v96
    v_mov_b32 v105, v97
    v_mov_b32 v106, v98
    v_mov_b32 v107, v99
    s_add_u32 s35, s33, 0
    v_mov_b32_dpp v104, v100 row_ror:8 row_mask:0xf bank_mask:0x3
    v_mov_b32_dpp v105, v101 row_ror:8 row_mask:0xf bank_mask:0x3
    v_mov_b32_dpp v106, v102 row_ror:8 row_mask:0xf bank_mask:0x3
    v_mov_b32_dpp v107, v103 row_ror:8 row_mask:0xf bank_mask:0x3
    v_mov_b32_dpp v96, v100 row_ror:8 row_mask:0xf bank_mask:0xc
    v_mov_b32_dpp v97, v101 row_ror:8 row_mask:0xf bank_mask:0xc
    v_mov_b32_dpp v98, v102 row_ror:8 row_mask:0xf bank_mask:0xc
    v_mov_b32_dpp v99, v103 row_ror:8 row_mask:0xf bank_mask:0xc
    buffer_store_dwordx4 v[96:99], v222, s[16:19], s35 offen sc1
    buffer_store_dwordx4 v[104:107], v223, s[16:19], s35 offen sc1
    v_cvt_pk_bf16_f32 v108, v4, v5
    v_cvt_pk_bf16_f32 v109, v6, v7
    v_cvt_pk_bf16_f32 v110, v16, v17
    v_cvt_pk_bf16_f32 v111, v18, v19
    v_cvt_pk_bf16_f32 v112, v52, v53
    v_cvt_pk_bf16_f32 v113, v54, v55
    v_cvt_pk_bf16_f32 v114, v64, v65
    v_cvt_pk_bf16_f32 v115, v66, v67
    v_mov_b32 v116, v108
    v_mov_b32 v117, v109
    v_mov_b32 v118, v110
    v_mov_b32 v119, v111
    s_add_u32 s35, s33, 593920
    v_mov_b32_dpp v116, v112 row_ror:8 row_mask:0xf bank_mask:0x3
    v_mov_b32_dpp v117, v113 row_ror:8 row_mask:0xf bank_mask:0x3
    v_mov_b32_dpp v118, v114 row_ror:8 row_mask:0xf bank_mask:0x3
    v_mov_b32_dpp v119, v115 row_ror:8 row_mask:0xf bank_mask:0x3
    v_mov_b32_dpp v108, v112 row_ror:8 row_mask:0xf bank_mask:0xc
    v_mov_b32_dpp v109, v113 row_ror:8 row_mask:0xf bank_mask:0xc
    v_mov_b32_dpp v110, v114 row_ror:8 row_mask:0xf bank_mask:0xc
    v_mov_b32_dpp v111, v115 row_ror:8 row_mask:0xf bank_mask:0xc
    buffer_store_dwordx4 v[108:111], v222, s[16:19], s35 offen sc1
    buffer_store_dwordx4 v[116:119], v223, s[16:19], s35 offen sc1
    v_cvt_pk_bf16_f32 v120, v8, v9
    v_cvt_pk_bf16_f32 v121, v10, v11
    v_cvt_pk_bf16_f32 v122, v20, v21
    v_cvt_pk_bf16_f32 v123, v22, v23
    v_cvt_pk_bf16_f32 v124, v56, v57
    v_cvt_pk_bf16_f32 v125, v58, v59
    v_cvt_pk_bf16_f32 v126, v68, v69
    v_cvt_pk_bf16_f32 v127, v70, v71
    v_mov_b32 v128, v120
    v_mov_b32 v129, v121
    v_mov_b32 v130, v122
    v_mov_b32 v131, v123
    s_add_u32 s35, s33, 1187840
    v_mov_b32_dpp v128, v124 row_ror:8 row_mask:0xf bank_mask:0x3
    v_mov_b32_dpp v129, v125 row_ror:8 row_mask:0xf bank_mask:0x3
    v_mov_b32_dpp v130, v126 row_ror:8 row_mask:0xf bank_mask:0x3
    v_mov_b32_dpp v131, v127 row_ror:8 row_mask:0xf bank_mask:0x3
    v_mov_b32_dpp v120, v124 row_ror:8 row_mask:0xf bank_mask:0xc
    v_mov_b32_dpp v121, v125 row_ror:8 row_mask:0xf bank_mask:0xc
    v_mov_b32_dpp v122, v126 row_ror:8 row_mask:0xf bank_mask:0xc
    v_mov_b32_dpp v123, v127 row_ror:8 row_mask:0xf bank_mask:0xc
    buffer_store_dwordx4 v[120:123], v222, s[16:19], s35 offen sc1
    buffer_store_dwordx4 v[128:131], v223, s[16:19], s35 offen sc1
    v_cvt_pk_bf16_f32 v96, v24, v25
    v_cvt_pk_bf16_f32 v97, v26, v27
    v_cvt_pk_bf16_f32 v98, v36, v37
    v_cvt_pk_bf16_f32 v99, v38, v39
    v_cvt_pk_bf16_f32 v100, v72, v73
    v_cvt_pk_bf16_f32 v101, v74, v75
    v_cvt_pk_bf16_f32 v102, v84, v85
    v_cvt_pk_bf16_f32 v103, v86, v87
    v_mov_b32 v104, v96
    v_mov_b32 v105, v97
    v_mov_b32 v106, v98
    v_mov_b32 v107, v99
    s_add_u32 s35, s33, 128
    v_mov_b32_dpp v104, v100 row_ror:8 row_mask:0xf bank_mask:0x3
    v_mov_b32_dpp v105, v101 row_ror:8 row_mask:0xf bank_mask:0x3
    v_mov_b32_dpp v106, v102 row_ror:8 row_mask:0xf bank_mask:0x3
    v_mov_b32_dpp v107, v103 row_ror:8 row_mask:0xf bank_mask:0x3
    v_mov_b32_dpp v96, v100 row_ror:8 row_mask:0xf bank_mask:0xc
    v_mov_b32_dpp v97, v101 row_ror:8 row_mask:0xf bank_mask:0xc
    v_mov_b32_dpp v98, v102 row_ror:8 row_mask:0xf bank_mask:0xc
    v_mov_b32_dpp v99, v103 row_ror:8 row_mask:0xf bank_mask:0xc
    buffer_store_dwordx4 v[96:99], v222, s[16:19], s35 offen sc1
    buffer_store_dwordx4 v[104:107], v223, s[16:19], s35 offen sc1
    v_cvt_pk_bf16_f32 v108, v28, v29
    v_cvt_pk_bf16_f32 v109, v30, v31
    v_cvt_pk_bf16_f32 v110, v40, v41
    v_cvt_pk_bf16_f32 v111, v42, v43
    v_cvt_pk_bf16_f32 v112, v76, v77
    v_cvt_pk_bf16_f32 v113, v78, v79
    v_cvt_pk_bf16_f32 v114, v88, v89
    v_cvt_pk_bf16_f32 v115, v90, v91
    v_mov_b32 v116, v108
    v_mov_b32 v117, v109
    v_mov_b32 v118, v110
    v_mov_b32 v119, v111
    s_add_u32 s35, s33, 594048
    v_mov_b32_dpp v116, v112 row_ror:8 row_mask:0xf bank_mask:0x3
    v_mov_b32_dpp v117, v113 row_ror:8 row_mask:0xf bank_mask:0x3
    v_mov_b32_dpp v118, v114 row_ror:8 row_mask:0xf bank_mask:0x3
    v_mov_b32_dpp v119, v115 row_ror:8 row_mask:0xf bank_mask:0x3
    v_mov_b32_dpp v108, v112 row_ror:8 row_mask:0xf bank_mask:0xc
    v_mov_b32_dpp v109, v113 row_ror:8 row_mask:0xf bank_mask:0xc
    v_mov_b32_dpp v110, v114 row_ror:8 row_mask:0xf bank_mask:0xc
    v_mov_b32_dpp v111, v115 row_ror:8 row_mask:0xf bank_mask:0xc
    buffer_store_dwordx4 v[108:111], v222, s[16:19], s35 offen sc1
    buffer_store_dwordx4 v[116:119], v223, s[16:19], s35 offen sc1
    v_cvt_pk_bf16_f32 v120, v32, v33
    v_cvt_pk_bf16_f32 v121, v34, v35
    v_cvt_pk_bf16_f32 v122, v44, v45
    v_cvt_pk_bf16_f32 v123, v46, v47
    v_cvt_pk_bf16_f32 v124, v80, v81
    v_cvt_pk_bf16_f32 v125, v82, v83
    v_cvt_pk_bf16_f32 v126, v92, v93
    v_cvt_pk_bf16_f32 v127, v94, v95
    v_mov_b32 v128, v120
    v_mov_b32 v129, v121
    v_mov_b32 v130, v122
    v_mov_b32 v131, v123
    s_add_u32 s35, s33, 1187968
    v_mov_b32_dpp v128, v124 row_ror:8 row_mask:0xf bank_mask:0x3
    v_mov_b32_dpp v129, v125 row_ror:8 row_mask:0xf bank_mask:0x3
    v_mov_b32_dpp v130, v126 row_ror:8 row_mask:0xf bank_mask:0x3
    v_mov_b32_dpp v131, v127 row_ror:8 row_mask:0xf bank_mask:0x3
    v_mov_b32_dpp v120, v124 row_ror:8 row_mask:0xf bank_mask:0xc
    v_mov_b32_dpp v121, v125 row_ror:8 row_mask:0xf bank_mask:0xc
    v_mov_b32_dpp v122, v126 row_ror:8 row_mask:0xf bank_mask:0xc
    v_mov_b32_dpp v123, v127 row_ror:8 row_mask:0xf bank_mask:0xc
    buffer_store_dwordx4 v[120:123], v222, s[16:19], s35 offen sc1
    buffer_store_dwordx4 v[128:131], v223, s[16:19], s35 offen sc1
    s_endpgm
.globl mid_kernel
.p2align 8
.type mid_kernel,@function
mid_kernel:
    s_cmp_ge_u32 s2, 704
    s_cbranch_scc1 L_mid_kernel_done
    v_readfirstlane_b32 s20, v0
    s_lshr_b32 s20, s20, 6
    s_cmp_ge_u32 s2, 448
    s_cbranch_scc1 L_mid_kernel_g
    s_mov_b32 s3, s2
    s_load_dwordx2 s[6:7], s[0:1], 72
    s_load_dwordx2 s[4:5], s[0:1], 72
    s_cmp_ge_u32 s3, 224
    s_cselect_b32 s24, 1, 0
    s_mul_i32 s25, s24, 224
    s_sub_u32 s25, s3, s25
    s_lshr_b32 s26, s25, 3
    s_and_b32 s27, s25, 7
    v_and_b32 v1, 63, v0
    v_lshrrev_b32 v2, 3, v1
    v_mul_u32_u24 v2, 1024, v2
    v_bfe_u32 v3, v1, 2, 1
    v_lshl_add_u32 v2, v3, 6, v2
    v_lshrrev_b32 v3, 5, v1
    v_lshlrev_b32 v3, 1, v3
    v_and_b32 v4, 3, v1
    v_xor_b32 v3, v3, v4
    v_lshl_add_u32 v2, v3, 4, v2
    s_mul_i32 s28, s26, 6
    s_lshl_b32 s29, s20, 1
    s_add_u32 s28, s28, s29
    s_sub_u32 s28, s28, 1
    s_mul_i32 s30, s27, 128
    s_add_u32 s31, s28, 0
    s_mul_i32 s32, s31, 37120
    s_add_u32 s32, s32, s30
    s_cmp_lt_i32 s31, 0
    s_cselect_b32 s32, 0x7f000000, s32
    v_add_u32 v3, s32, v2
    s_add_u32 s31, s28, 1
    s_mul_i32 s32, s31, 37120
    s_add_u32 s32, s32, s30
    s_cmp_lt_i32 s31, 0
    s_cselect_b32 s32, 0x7f000000, s32
    v_add_u32 v4, s32, v2
    s_waitcnt lgkmcnt(0)
    s_mul_i32 s33, s24, 6199040
    s_add_u32 s33, s33, 38871040
    s_add_u32 s8, s6, s33
    s_addc_u32 s9, s7, 0
    s_mov_b32 s10, 6199040
    s_mov_b32 s11, 0x00020000
    s_add_u32 s12, s6, 85499904
    s_addc_u32 s13, s7, 0
    s_mov_b32 s14, 16384
    s_mov_b32 s15, 0x00020000
    s_lshl_b32 s34, s20, 13
    s_add_u32 m0, s34, 0
    s_mov_b32 s35, 0
    buffer_load_dwordx4 v3, s[8:11], s35 offen lds
    s_add_u32 m0, s34, 1024
    s_mov_b32 s35, 8192
    buffer_load_dwordx4 v3, s[8:11], s35 offen lds
    s_add_u32 m0, s34, 2048
    s_mov_b32 s35, 16384
    buffer_load_dwordx4 v3, s[8:11], s35 offen lds
    s_add_u32 m0, s34, 3072
    s_mov_b32 s35, 24576
    buffer_load_dwordx4 v3, s[8:11], s35 offen lds
    s_add_u32 m0, s34, 4096
    s_mov_b32 s35, 0
    buffer_load_dwordx4 v4, s[8:11], s35 offen lds
    s_add_u32 m0, s34, 5120
    s_mov_b32 s35, 8192
    buffer_load_dwordx4 v4, s[8:11], s35 offen lds
    s_add_u32 m0, s34, 6144
    s_mov_b32 s35, 16384
    buffer_load_dwordx4 v4, s[8:11], s35 offen lds
    s_add_u32 m0, s34, 7168
    s_mov_b32 s35, 24576
    buffer_load_dwordx4 v4, s[8:11], s35 offen lds
    v_lshlrev_b32 v5, 4, v1
    s_mov_b32 s35, 8192
    buffer_load_dwordx4 v[8:11], v5, s[12:15], s35 offen
    s_mov_b32 s35, 9216
    buffer_load_dwordx4 v[12:15], v5, s[12:15], s35 offen
    s_mov_b32 s35, 10240
    buffer_load_dwordx4 v[16:19], v5, s[12:15], s35 offen
    s_mov_b32 s35, 11264
    buffer_load_dwordx4 v[20:23], v5, s[12:15], s35 offen
    s_mov_b32 s35, 12288
    buffer_load_dwordx4 v[24:27], v5, s[12:15], s35 offen
    s_mov_b32 s35, 13312
    buffer_load_dwordx4 v[28:31], v5, s[12:15], s35 offen
    s_lshl_b32 s35, s20, 11
    buffer_load_dwordx4 v[32:35], v5, s[12:15], s35 offen offset:0
    buffer_load_dwordx4 v[36:39], v5, s[12:15], s35 offen offset:1024
    v_bfe_u32 v40, v1, 2, 2
    v_lshrrev_b32 v41, 4, v1
    v_and_b32 v42, 3, v1
    v_lshl_add_u32 v43, v41, 3, v40
    v_lshlrev_b32 v46, 6, v43
    v_and_b32 v47, 1, v41
    v_lshlrev_b32 v47, 1, v47
    v_lshrrev_b32 v48, 1, v42
    v_xor_b32 v47, v47, v48
    v_lshl_add_u32 v46, v47, 4, v46
    v_and_b32 v48, 1, v42
    v_lshl_add_u32 v46, v48, 3, v46
    v_add_u32 v44, s34, v46
    v_xor_b32 v45, 32, v44
    v_add_u32 v49, 43008, v46
    v_xor_b32 v50, 32, v49
    v_add_u32 v47, 1, v43
    v_bfe_u32 v48, v47, 3, 1
    v_lshlrev_b32 v48, 1, v48
    v_lshrrev_b32 v55, 1, v42
    v_xor_b32 v48, v48, v55
    v_lshlrev_b32 v47, 6, v47
    v_lshl_add_u32 v47, v48, 4, v47
    v_and_b32 v48, 1, v42
    v_lshl_add_u32 v47, v48, 3, v47
    v_add_u32 v51, 32704, v47
    v_xor_b32 v52, 32, v51
    v_add_u32 v47, 5, v43
    v_bfe_u32 v48, v47, 3, 1
    v_lshlrev_b32 v48, 1, v48
    v_lshrrev_b32 v55, 1, v42
    v_xor_b32 v48, v48, v55
    v_lshlrev_b32 v47, 6, v47
    v_lshl_add_u32 v47, v48, 4, v47
    v_and_b32 v48, 1, v42
    v_lshl_add_u32 v47, v48, 3, v47
    v_add_u32 v53, 32704, v47
    v_xor_b32 v54, 32, v53
    v_and_b32 v47, 1, v1
    v_mul_u32_u24 v55, 10304, v47
    v_bfe_u32 v48, v1, 1, 3
    v_lshl_add_u32 v55, v48, 6, v55
    v_lshl_add_u32 v55, v41, 4, v55
    s_mul_i32 s35, s20, 3072
    s_add_u32 s35, s35, 31680
    v_add_u32 v56, s35, v55
    v_xor_b32 v57, 32, v56
    s_mul_i32 s35, s20, 48
    s_sub_u32 s35, s35, 17
    v_add_u32 v122, v48, v47
    v_add_u32 v122, s35, v122
    s_mov_b32 s35, 344064
    v_mul_lo_u32 v58, v48, s35
    v_and_b32 v47, 1, v1
    v_lshl_add_u32 v58, v47, 6, v58
    v_lshl_add_u32 v58, v41, 4, v58
    s_mov_b32 s36, 0xbdd2d3e8
    v_mov_b32 v59, 0xc0135761
    s_mov_b32 s42, 0xbdd2d3e8
    s_mov_b32 s43, 0xbdd2d3e8
    v_mov_b32 v120, 0xc0135761
    v_mov_b32 v121, 0xc0135761
    s_add_u32 s16, s4, 51269632
    s_addc_u32 s17, s5, 0
    s_mov_b32 s18, 11010048
    s_mov_b32 s19, 0x00020000
    s_mul_i32 s37, s20, 2752512
    s_mul_i32 s38, s24, 84
    s_mul_i32 s39, s26, 3
    s_add_u32 s38, s38, s39
    s_lshl_b32 s38, s38, 11
    s_add_u32 s37, s37, s38
    s_lshl_b32 s38, s27, 7
    s_add_u32 s37, s37, s38
    s_waitcnt vmcnt(2)
    ds_read_b64_tr_b16 v[60:61], v44 offset:0
    ds_read_b64_tr_b16 v[62:63], v44 offset:256
    ds_read_b64_tr_b16 v[64:65], v44 offset:2048
    ds_read_b64_tr_b16 v[66:67], v44 offset:2304
    ds_read_b64_tr_b16 v[68:69], v45 offset:0
    ds_read_b64_tr_b16 v[70:71], v45 offset:256
    ds_read_b64_tr_b16 v[72:73], v45 offset:2048
    ds_read_b64_tr_b16 v[74:75], v45 offset:2304
    s_waitcnt lgkmcnt(0)
    v_mfma_f32_16x16x32_bf16 v[76:79], v[60:63], v[8:11], 0
    v_mfma_f32_16x16x32_bf16 v[80:83], v[68:71], v[8:11], 0
    v_mfma_f32_16x16x32_bf16 v[84:87], v[60:63], v[16:19], 0
    v_mfma_f32_16x16x32_bf16 v[88:91], v[68:71], v[16:19], 0
    v_mfma_f32_16x16x32_bf16 v[92:95], v[60:63], v[24:27], 0
    v_mfma_f32_16x16x32_bf16 v[96:99], v[68:71], v[24:27], 0
    v_mfma_f32_16x16x32_bf16 v[76:79], v[64:67], v[12:15], v[76:79]
    v_mfma_f32_16x16x32_bf16 v[80:83], v[72:75], v[12:15], v[80:83]
    v_mfma_f32_16x16x32_bf16 v[84:87], v[64:67], v[20:23], v[84:87]
    v_mfma_f32_16x16x32_bf16 v[88:91], v[72:75], v[20:23], v[88:91]
    v_mfma_f32_16x16x32_bf16 v[92:95], v[64:67], v[28:31], v[92:95]
    v_mfma_f32_16x16x32_bf16 v[96:99], v[72:75], v[28:31], v[96:99]
    s_add_u32 s31, s28, 0
    s_cmp_eq_u32 s31, 166
    s_cselect_b32 s39, 0, -1
    s_nop 4
    v_mul_f32 v100, v76, v76
    v_mul_f32 v101, v77, v77
    v_mul_f32 v102, v78, v78
    v_mul_f32 v103, v79, v79
    v_mul_f32 v104, v80, v80
    v_mul_f32 v105, v81, v81
    v_mul_f32 v106, v82, v82
    v_mul_f32 v107, v83, v83
    v_fma_f32 v100, v100, s36, v59
    v_fma_f32 v101, v101, s36, v59
    v_fma_f32 v102, v102, s36, v59
    v_fma_f32 v103, v103, s36, v59
    v_fma_f32 v104, v104, s36, v59
    v_fma_f32 v105, v105, s36, v59
    v_fma_f32 v106, v106, s36, v59
    v_fma_f32 v107, v107, s36, v59
    v_mul_f32 v100, v100, v76
    v_mul_f32 v101, v101, v77
    v_mul_f32 v102, v102, v78
    v_mul_f32 v103, v103, v79
    v_mul_f32 v104, v104, v80
    v_mul_f32 v105, v105, v81
    v_mul_f32 v106, v106, v82
    v_mul_f32 v107, v107, v83
    v_exp_f32 v100, v100
    v_exp_f32 v101, v101
    v_exp_f32 v102, v102
    v_exp_f32 v103, v103
    v_exp_f32 v104, v104
    v_exp_f32 v105, v105
    v_exp_f32 v106, v106
    v_exp_f32 v107, v107
    v_add_f32 v100, 1.0, v100
    v_add_f32 v101, 1.0, v101
    v_add_f32 v102, 1.0, v102
    v_add_f32 v103, 1.0, v103
    v_add_f32 v104, 1.0, v104
    v_add_f32 v105, 1.0, v105
    v_add_f32 v106, 1.0, v106
    v_add_f32 v107, 1.0, v107
    v_rcp_f32 v100, v100
    v_rcp_f32 v101, v101
    v_rcp_f32 v102, v102
    v_rcp_f32 v103, v103
    v_rcp_f32 v104, v104
    v_rcp_f32 v105, v105
    v_rcp_f32 v106, v106
    v_rcp_f32 v107, v107
    v_mul_f32 v76, v76, v100
    v_mul_f32 v77, v77, v101
    v_mul_f32 v78, v78, v102
    v_mul_f32 v79, v79, v103
    v_mul_f32 v80, v80, v104
    v_mul_f32 v81, v81, v105
    v_mul_f32 v82, v82, v106
    v_mul_f32 v83, v83, v107
    v_cvt_pk_bf16_f32 v108, v76, v77
    v_cvt_pk_bf16_f32 v109, v78, v79
    v_cvt_pk_bf16_f32 v110, v80, v81
    v_cvt_pk_bf16_f32 v111, v82, v83
    v_add_u32 v123, 0, v122
    v_cmp_gt_u32 vcc, 160, v123
    s_nop 0
    s_and_saveexec_b64 s[40:41], vcc
    ds_write_b128 v56, v[108:111] offset:0
    s_mov_b64 exec, s[40:41]
    v_mul_f32 v100, v84, v84
    v_mul_f32 v101, v85, v85
    v_mul_f32 v102, v86, v86
    v_mul_f32 v103, v87, v87
    v_mul_f32 v104, v88, v88
    v_mul_f32 v105, v89, v89
    v_mul_f32 v106, v90, v90
    v_mul_f32 v107, v91, v91
    v_fma_f32 v100, v100, s36, v59
    v_fma_f32 v101, v101, s36, v59
    v_fma_f32 v102, v102, s36, v59
    v_fma_f32 v103, v103, s36, v59
    v_fma_f32 v104, v104, s36, v59
    v_fma_f32 v105, v105, s36, v59
    v_fma_f32 v106, v106, s36, v59
    v_fma_f32 v107, v107, s36, v59
    v_mul_f32 v100, v100, v84
    v_mul_f32 v101, v101, v85
    v_mul_f32 v102, v102, v86
    v_mul_f32 v103, v103, v87
    v_mul_f32 v104, v104, v88
    v_mul_f32 v105, v105, v89
    v_mul_f32 v106, v106, v90
    v_mul_f32 v107, v107, v91
    v_exp_f32 v100, v100
    v_exp_f32 v101, v101
    v_exp_f32 v102, v102
    v_exp_f32 v103, v103
    v_exp_f32 v104, v104
    v_exp_f32 v105, v105
    v_exp_f32 v106, v106
    v_exp_f32 v107, v107
    v_add_f32 v100, 1.0, v100
    v_add_f32 v101, 1.0, v101
    v_add_f32 v102, 1.0, v102
    v_add_f32 v103, 1.0, v103
    v_add_f32 v104, 1.0, v104
    v_add_f32 v105, 1.0, v105
    v_add_f32 v106, 1.0, v106
    v_add_f32 v107, 1.0, v107
    v_rcp_f32 v100, v100
    v_rcp_f32 v101, v101
    v_rcp_f32 v102, v102
    v_rcp_f32 v103, v103
    v_rcp_f32 v104, v104
    v_rcp_f32 v105, v105
    v_rcp_f32 v106, v106
    v_rcp_f32 v107, v107
    v_mul_f32 v84, v84, v100
    v_mul_f32 v85, v85, v101
    v_mul_f32 v86, v86, v102
    v_mul_f32 v87, v87, v103
    v_mul_f32 v88, v88, v104
    v_mul_f32 v89, v89, v105
    v_mul_f32 v90, v90, v106
    v_mul_f32 v91, v91, v107
    v_cvt_pk_bf16_f32 v112, v84, v85
    v_cvt_pk_bf16_f32 v113, v86, v87
    v_cvt_pk_bf16_f32 v114, v88, v89
    v_cvt_pk_bf16_f32 v115, v90, v91
    v_add_u32 v123, 8, v122
    v_cmp_gt_u32 vcc, 160, v123
    s_nop 0
    s_and_saveexec_b64 s[40:41], vcc
    ds_write_b128 v57, v[112:115] offset:512
    s_mov_b64 exec, s[40:41]
    v_mul_f32 v100, v92, v92
    v_mul_f32 v101, v93, v93
    v_mul_f32 v102, v94, v94
    v_mul_f32 v103, v95, v95
    v_mul_f32 v104, v96, v96
    v_mul_f32 v105, v97, v97
    v_mul_f32 v106, v98, v98
    v_mul_f32 v107, v99, v99
    v_fma_f32 v100, v100, s36, v59
    v_fma_f32 v101, v101, s36, v59
    v_fma_f32 v102, v102, s36, v59
    v_fma_f32 v103, v103, s36, v59
    v_fma_f32 v104, v104, s36, v59
    v_fma_f32 v105, v105, s36, v59
    v_fma_f32 v106, v106, s36, v59
    v_fma_f32 v107, v107, s36, v59
    v_mul_f32 v100, v100, v92
    v_mul_f32 v101, v101, v93
    v_mul_f32 v102, v102, v94
    v_mul_f32 v103, v103, v95
    v_mul_f32 v104, v104, v96
    v_mul_f32 v105, v105, v97
    v_mul_f32 v106, v106, v98
    v_mul_f32 v107, v107, v99
    v_exp_f32 v100, v100
    v_exp_f32 v101, v101
    v_exp_f32 v102, v102
    v_exp_f32 v103, v103
    v_exp_f32 v104, v104
    v_exp_f32 v105, v105
    v_exp_f32 v106, v106
    v_exp_f32 v107, v107
    v_add_f32 v100, 1.0, v100
    v_add_f32 v101, 1.0, v101
    v_add_f32 v102, 1.0, v102
    v_add_f32 v103, 1.0, v103
    v_add_f32 v104, 1.0, v104
    v_add_f32 v105, 1.0, v105
    v_add_f32 v106, 1.0, v106
    v_add_f32 v107, 1.0, v107
    v_rcp_f32 v100, v100
    v_rcp_f32 v101, v101
    v_rcp_f32 v102, v102
    v_rcp_f32 v103, v103
    v_rcp_f32 v104, v104
    v_rcp_f32 v105, v105
    v_rcp_f32 v106, v106
    v_rcp_f32 v107, v107
    v_mul_f32 v92, v92, v100
    v_mul_f32 v93, v93, v101
    v_mul_f32 v94, v94, v102
    v_mul_f32 v95, v95, v103
    v_mul_f32 v96, v96, v104
    v_mul_f32 v97, v97, v105
    v_mul_f32 v98, v98, v106
    v_mul_f32 v99, v99, v107
    v_cvt_pk_bf16_f32 v116, v92, v93
    v_cvt_pk_bf16_f32 v117, v94, v95
    v_cvt_pk_bf16_f32 v118, v96, v97
    v_cvt_pk_bf16_f32 v119, v98, v99
    v_and_b32 v116, s39, v116
    v_and_b32 v117, s39, v117
    v_and_b32 v118, s39, v118
    v_and_b32 v119, s39, v119
    v_add_u32 v123, 16, v122
    v_cmp_gt_u32 vcc, 160, v123
    s_nop 0
    s_and_saveexec_b64 s[40:41], vcc
    ds_write_b128 v56, v[116:119] offset:1024
    s_mov_b64 exec, s[40:41]
    ds_read_b64_tr_b16 v[60:61], v44 offset:4096
    ds_read_b64_tr_b16 v[62:63], v44 offset:4352
    ds_read_b64_tr_b16 v[64:65], v44 offset:6144
    ds_read_b64_tr_b16 v[66:67], v44 offset:6400
    ds_read_b64_tr_b16 v[68:69], v45 offset:4096
    ds_read_b64_tr_b16 v[70:71], v45 offset:4352
    ds_read_b64_tr_b16 v[72:73], v45 offset:6144
    ds_read_b64_tr_b16 v[74:75], v45 offset:6400
    s_waitcnt lgkmcnt(0)
    v_mfma_f32_16x16x32_bf16 v[76:79], v[60:63], v[8:11], 0
    v_mfma_f32_16x16x32_bf16 v[80:83], v[68:71], v[8:11], 0
    v_mfma_f32_16x16x32_bf16 v[84:87], v[60:63], v[16:19], 0
    v_mfma_f32_16x16x32_bf16 v[88:91], v[68:71], v[16:19], 0
    v_mfma_f32_16x16x32_bf16 v[92:95], v[60:63], v[24:27], 0
    v_mfma_f32_16x16x32_bf16 v[96:99], v[68:71], v[24:27], 0
    v_mfma_f32_16x16x32_bf16 v[76:79], v[64:67], v[12:15], v[76:79]
    v_mfma_f32_16x16x32_bf16 v[80:83], v[72:75], v[12:15], v[80:83]
    v_mfma_f32_16x16x32_bf16 v[84:87], v[64:67], v[20:23], v[84:87]
    v_mfma_f32_16x16x32_bf16 v[88:91], v[72:75], v[20:23], v[88:91]
    v_mfma_f32_16x16x32_bf16 v[92:95], v[64:67], v[28:31], v[92:95]
    v_mfma_f32_16x16x32_bf16 v[96:99], v[72:75], v[28:31], v[96:99]
    s_add_u32 s31, s28, 1
    s_cmp_eq_u32 s31, 166
    s_cselect_b32 s39, 0, -1
    s_nop 4
    v_mul_f32 v100, v76, v76
    v_mul_f32 v101, v77, v77
    v_mul_f32 v102, v78, v78
    v_mul_f32 v103, v79, v79
    v_mul_f32 v104, v80, v80
    v_mul_f32 v105, v81, v81
    v_mul_f32 v106, v82, v82
    v_mul_f32 v107, v83, v83
    v_fma_f32 v100, v100, s36, v59
    v_fma_f32 v101, v101, s36, v59
    v_fma_f32 v102, v102, s36, v59
    v_fma_f32 v103, v103, s36, v59
    v_fma_f32 v104, v104, s36, v59
    v_fma_f32 v105, v105, s36, v59
    v_fma_f32 v106, v106, s36, v59
    v_fma_f32 v107, v107, s36, v59
    v_mul_f32 v100, v100, v76
    v_mul_f32 v101, v101, v77
    v_mul_f32 v102, v102, v78
    v_mul_f32 v103, v103, v79
    v_mul_f32 v104, v104, v80
    v_mul_f32 v105, v105, v81
    v_mul_f32 v106, v106, v82
    v_mul_f32 v107, v107, v83
    v_exp_f32 v100, v100
    v_exp_f32 v101, v101
    v_exp_f32 v102, v102
    v_exp_f32 v103, v103
    v_exp_f32 v104, v104
    v_exp_f32 v105, v105
    v_exp_f32 v106, v106
    v_exp_f32 v107, v107
    v_add_f32 v100, 1.0, v100
    v_add_f32 v101, 1.0, v101
    v_add_f32 v102, 1.0, v102
    v_add_f32 v103, 1.0, v103
    v_add_f32 v104, 1.0, v104
    v_add_f32 v105, 1.0, v105
    v_add_f32 v106, 1.0, v106
    v_add_f32 v107, 1.0, v107
    v_rcp_f32 v100, v100
    v_rcp_f32 v101, v101
    v_rcp_f32 v102, v102
    v_rcp_f32 v103, v103
    v_rcp_f32 v104, v104
    v_rcp_f32 v105, v105
    v_rcp_f32 v106, v106
    v_rcp_f32 v107, v107
    v_mul_f32 v76, v76, v100
    v_mul_f32 v77, v77, v101
    v_mul_f32 v78, v78, v102
    v_mul_f32 v79, v79, v103
    v_mul_f32 v80, v80, v104
    v_mul_f32 v81, v81, v105
    v_mul_f32 v82, v82, v106
    v_mul_f32 v83, v83, v107
    v_cvt_pk_bf16_f32 v108, v76, v77
    v_cvt_pk_bf16_f32 v109, v78, v79
    v_cvt_pk_bf16_f32 v110, v80, v81
    v_cvt_pk_bf16_f32 v111, v82, v83
    v_add_u32 v123, 24, v122
    v_cmp_gt_u32 vcc, 160, v123
    s_nop 0
    s_and_saveexec_b64 s[40:41], vcc
    ds_write_b128 v57, v[108:111] offset:1536
    s_mov_b64 exec, s[40:41]
    v_mul_f32 v100, v84, v84
    v_mul_f32 v101, v85, v85
    v_mul_f32 v102, v86, v86
    v_mul_f32 v103, v87, v87
    v_mul_f32 v104, v88, v88
    v_mul_f32 v105, v89, v89
    v_mul_f32 v106, v90, v90
    v_mul_f32 v107, v91, v91
    v_fma_f32 v100, v100, s36, v59
    v_fma_f32 v101, v101, s36, v59
    v_fma_f32 v102, v102, s36, v59
    v_fma_f32 v103, v103, s36, v59
    v_fma_f32 v104, v104, s36, v59
    v_fma_f32 v105, v105, s36, v59
    v_fma_f32 v106, v106, s36, v59
    v_fma_f32 v107, v107, s36, v59
    v_mul_f32 v100, v100, v84
    v_mul_f32 v101, v101, v85
    v_mul_f32 v102, v102, v86
    v_mul_f32 v103, v103, v87
    v_mul_f32 v104, v104, v88
    v_mul_f32 v105, v105, v89
    v_mul_f32 v106, v106, v90
    v_mul_f32 v107, v107, v91
    v_exp_f32 v100, v100
    v_exp_f32 v101, v101
    v_exp_f32 v102, v102
    v_exp_f32 v103, v103
    v_exp_f32 v104, v104
    v_exp_f32 v105, v105
    v_exp_f32 v106, v106
    v_exp_f32 v107, v107
    v_add_f32 v100, 1.0, v100
    v_add_f32 v101, 1.0, v101
    v_add_f32 v102, 1.0, v102
    v_add_f32 v103, 1.0, v103
    v_add_f32 v104, 1.0, v104
    v_add_f32 v105, 1.0, v105
    v_add_f32 v106, 1.0, v106
    v_add_f32 v107, 1.0, v107
    v_rcp_f32 v100, v100
    v_rcp_f32 v101, v101
    v_rcp_f32 v102, v102
    v_rcp_f32 v103, v103
    v_rcp_f32 v104, v104
    v_rcp_f32 v105, v105
    v_rcp_f32 v106, v106
    v_rcp_f32 v107, v107
    v_mul_f32 v84, v84, v100
    v_mul_f32 v85, v85, v101
    v_mul_f32 v86, v86, v102
    v_mul_f32 v87, v87, v103
    v_mul_f32 v88, v88, v104
    v_mul_f32 v89, v89, v105
    v_mul_f32 v90, v90, v106
    v_mul_f32 v91, v91, v107
    v_cvt_pk_bf16_f32 v112, v84, v85
    v_cvt_pk_bf16_f32 v113, v86, v87
    v_cvt_pk_bf16_f32 v114, v88, v89
    v_cvt_pk_bf16_f32 v115, v90, v91
    v_add_u32 v123, 32, v122
    v_cmp_gt_u32 vcc, 160, v123
    s_nop 0
    s_and_saveexec_b64 s[40:41], vcc
    ds_write_b128 v56, v[112:115] offset:2048
    s_mov_b64 exec, s[40:41]
    v_mul_f32 v100, v92, v92
    v_mul_f32 v101, v93, v93
    v_mul_f32 v102, v94, v94
    v_mul_f32 v103, v95, v95
    v_mul_f32 v104, v96, v96
    v_mul_f32 v105, v97, v97
    v_mul_f32 v106, v98, v98
    v_mul_f32 v107, v99, v99
    v_fma_f32 v100, v100, s36, v59
    v_fma_f32 v101, v101, s36, v59
    v_fma_f32 v102, v102, s36, v59
    v_fma_f32 v103, v103, s36, v59
    v_fma_f32 v104, v104, s36, v59
    v_fma_f32 v105, v105, s36, v59
    v_fma_f32 v106, v106, s36, v59
    v_fma_f32 v107, v107, s36, v59
    v_mul_f32 v100, v100, v92
    v_mul_f32 v101, v101, v93
    v_mul_f32 v102, v102, v94
    v_mul_f32 v103, v103, v95
    v_mul_f32 v104, v104, v96
    v_mul_f32 v105, v105, v97
    v_mul_f32 v106, v106, v98
    v_mul_f32 v107, v107, v99
    v_exp_f32 v100, v100
    v_exp_f32 v101, v101
    v_exp_f32 v102, v102
    v_exp_f32 v103, v103
    v_exp_f32 v104, v104
    v_exp_f32 v105, v105
    v_exp_f32 v106, v106
    v_exp_f32 v107, v107
    v_add_f32 v100, 1.0, v100
    v_add_f32 v101, 1.0, v101
    v_add_f32 v102, 1.0, v102
    v_add_f32 v103, 1.0, v103
    v_add_f32 v104, 1.0, v104
    v_add_f32 v105, 1.0, v105
    v_add_f32 v106, 1.0, v106
    v_add_f32 v107, 1.0, v107
    v_rcp_f32 v100, v100
    v_rcp_f32 v101, v101
    v_rcp_f32 v102, v102
    v_rcp_f32 v103, v103
    v_rcp_f32 v104, v104
    v_rcp_f32 v105, v105
    v_rcp_f32 v106, v106
    v_rcp_f32 v107, v107
    v_mul_f32 v92, v92, v100
    v_mul_f32 v93, v93, v101
    v_mul_f32 v94, v94, v102
    v_mul_f32 v95, v95, v103
    v_mul_f32 v96, v96, v104
    v_mul_f32 v97, v97, v105
    v_mul_f32 v98, v98, v106
    v_mul_f32 v99, v99, v107
    v_cvt_pk_bf16_f32 v116, v92, v93
    v_cvt_pk_bf16_f32 v117, v94, v95
    v_cvt_pk_bf16_f32 v118, v96, v97
    v_cvt_pk_bf16_f32 v119, v98, v99
    v_and_b32 v116, s39, v116
    v_and_b32 v117, s39, v117
    v_and_b32 v118, s39, v118
    v_and_b32 v119, s39, v119
    v_add_u32 v123, 40, v122
    v_cmp_gt_u32 vcc, 160, v123
    s_nop 0
    s_and_saveexec_b64 s[40:41], vcc
    ds_write_b128 v57, v[116:119] offset:2560
    s_mov_b64 exec, s[40:41]
    s_waitcnt vmcnt(0)
    s_waitcnt lgkmcnt(0)
    s_barrier
    ds_read_b64_tr_b16 v[60:61], v49 offset:0
    ds_read_b64_tr_b16 v[62:63], v49 offset:256
    ds_read_b64_tr_b16 v[64:65], v49 offset:2048
    ds_read_b64_tr_b16 v[66:67], v49 offset:2304
    ds_read_b64_tr_b16 v[68:69], v50 offset:0
    ds_read_b64_tr_b16 v[70:71], v50 offset:256
    ds_read_b64_tr_b16 v[72:73], v50 offset:2048
    ds_read_b64_tr_b16 v[74:75], v50 offset:2304
    s_waitcnt lgkmcnt(0)
    v_mfma_f32_16x16x32_bf16 v[92:95], v[60:63], v[32:35], 0
    v_mfma_f32_16x16x32_bf16 v[96:99], v[68:71], v[32:35], 0
    v_mfma_f32_16x16x32_bf16 v[92:95], v[64:67], v[36:39], v[92:95]
    v_mfma_f32_16x16x32_bf16 v[96:99], v[72:75], v[36:39], v[96:99]
    ds_read_b64_tr_b16 v[76:77], v51 offset:0
    ds_read_b64_tr_b16 v[78:79], v53 offset:0
    ds_read_b64_tr_b16 v[80:81], v51 offset:2048
    ds_read_b64_tr_b16 v[82:83], v53 offset:2048
    ds_read_b64_tr_b16 v[84:85], v52 offset:0
    ds_read_b64_tr_b16 v[86:87], v54 offset:0
    ds_read_b64_tr_b16 v[88:89], v52 offset:2048
    ds_read_b64_tr_b16 v[90:91], v54 offset:2048
    v_cvt_pk_bf16_f32 v108, v92, v93
    v_cvt_pk_bf16_f32 v109, v94, v95
    v_cvt_pk_bf16_f32 v110, v96, v97
    v_cvt_pk_bf16_f32 v111, v98, v99
    s_add_u32 s38, s37, 0
    buffer_store_dwordx4 v[108:111], v58, s[16:19], s38 offen sc1
    s_waitcnt lgkmcnt(0)
    v_mfma_f32_16x16x32_bf16 v[100:103], v[76:79], v[32:35], 0
    v_mfma_f32_16x16x32_bf16 v[104:107], v[84:87], v[32:35], 0
    v_mfma_f32_16x16x32_bf16 v[100:103], v[80:83], v[36:39], v[100:103]
    v_mfma_f32_16x16x32_bf16 v[104:107], v[88:91], v[36:39], v[104:107]
    ds_read_b64_tr_b16 v[60:61], v49 offset:3072
    ds_read_b64_tr_b16 v[62:63], v49 offset:3328
    ds_read_b64_tr_b16 v[64:65], v49 offset:5120
    ds_read_b64_tr_b16 v[66:67], v49 offset:5376
    ds_read_b64_tr_b16 v[68:69], v50 offset:3072
    ds_read_b64_tr_b16 v[70:71], v50 offset:3328
    ds_read_b64_tr_b16 v[72:73], v50 offset:5120
    ds_read_b64_tr_b16 v[74:75], v50 offset:5376
    v_cvt_pk_bf16_f32 v112, v100, v101
    v_cvt_pk_bf16_f32 v113, v102, v103
    v_cvt_pk_bf16_f32 v114, v104, v105
    v_cvt_pk_bf16_f32 v115, v106, v107
    s_add_u32 s38, s37, 1024
    buffer_store_dwordx4 v[112:115], v58, s[16:19], s38 offen sc1
    s_waitcnt lgkmcnt(0)
    v_mfma_f32_16x16x32_bf16 v[92:95], v[60:63], v[32:35], 0
    v_mfma_f32_16x16x32_bf16 v[96:99], v[68:71], v[32:35], 0
    v_mfma_f32_16x16x32_bf16 v[92:95], v[64:67], v[36:39], v[92:95]
    v_mfma_f32_16x16x32_bf16 v[96:99], v[72:75], v[36:39], v[96:99]
    ds_read_b64_tr_b16 v[76:77], v51 offset:3072
    ds_read_b64_tr_b16 v[78:79], v53 offset:3072
    ds_read_b64_tr_b16 v[80:81], v51 offset:5120
    ds_read_b64_tr_b16 v[82:83], v53 offset:5120
    ds_read_b64_tr_b16 v[84:85], v52 offset:3072
    ds_read_b64_tr_b16 v[86:87], v54 offset:3072
    ds_read_b64_tr_b16 v[88:89], v52 offset:5120
    ds_read_b64_tr_b16 v[90:91], v54 offset:5120
    v_cvt_pk_bf16_f32 v108, v92, v93
    v_cvt_pk_bf16_f32 v109, v94, v95
    v_cvt_pk_bf16_f32 v110, v96, v97
    v_cvt_pk_bf16_f32 v111, v98, v99
    s_add_u32 s38, s37, 2048
    buffer_store_dwordx4 v[108:111], v58, s[16:19], s38 offen sc1
    s_waitcnt lgkmcnt(0)
    v_mfma_f32_16x16x32_bf16 v[100:103], v[76:79], v[32:35], 0
    v_mfma_f32_16x16x32_bf16 v[104:107], v[84:87], v[32:35], 0
    v_mfma_f32_16x16x32_bf16 v[100:103], v[80:83], v[36:39], v[100:103]
    v_mfma_f32_16x16x32_bf16 v[104:107], v[88:91], v[36:39], v[104:107]
    ds_read_b64_tr_b16 v[60:61], v49 offset:6144
    ds_read_b64_tr_b16 v[62:63], v49 offset:6400
    ds_read_b64_tr_b16 v[64:65], v49 offset:8192
    ds_read_b64_tr_b16 v[66:67], v49 offset:8448
    ds_read_b64_tr_b16 v[68:69], v50 offset:6144
    ds_read_b64_tr_b16 v[70:71], v50 offset:6400
    ds_read_b64_tr_b16 v[72:73], v50 offset:8192
    ds_read_b64_tr_b16 v[74:75], v50 offset:8448
    v_cvt_pk_bf16_f32 v112, v100, v101
    v_cvt_pk_bf16_f32 v113, v102, v103
    v_cvt_pk_bf16_f32 v114, v104, v105
    v_cvt_pk_bf16_f32 v115, v106, v107
    s_add_u32 s38, s37, 3072
    buffer_store_dwordx4 v[112:115], v58, s[16:19], s38 offen sc1
    s_waitcnt lgkmcnt(0)
    v_mfma_f32_16x16x32_bf16 v[92:95], v[60:63], v[32:35], 0
    v_mfma_f32_16x16x32_bf16 v[96:99], v[68:71], v[32:35], 0
    v_mfma_f32_16x16x32_bf16 v[92:95], v[64:67], v[36:39], v[92:95]
    v_mfma_f32_16x16x32_bf16 v[96:99], v[72:75], v[36:39], v[96:99]
    ds_read_b64_tr_b16 v[76:77], v51 offset:6144
    ds_read_b64_tr_b16 v[78:79], v53 offset:6144
    ds_read_b64_tr_b16 v[80:81], v51 offset:8192
    ds_read_b64_tr_b16 v[82:83], v53 offset:8192
    ds_read_b64_tr_b16 v[84:85], v52 offset:6144
    ds_read_b64_tr_b16 v[86:87], v54 offset:6144
    ds_read_b64_tr_b16 v[88:89], v52 offset:8192
    ds_read_b64_tr_b16 v[90:91], v54 offset:8192
    v_cvt_pk_bf16_f32 v108, v92, v93
    v_cvt_pk_bf16_f32 v109, v94, v95
    v_cvt_pk_bf16_f32 v110, v96, v97
    v_cvt_pk_bf16_f32 v111, v98, v99
    s_add_u32 s38, s37, 4096
    buffer_store_dwordx4 v[108:111], v58, s[16:19], s38 offen sc1
    s_waitcnt lgkmcnt(0)
    v_mfma_f32_16x16x32_bf16 v[100:103], v[76:79], v[32:35], 0
    v_mfma_f32_16x16x32_bf16 v[104:107], v[84:87], v[32:35], 0
    v_mfma_f32_16x16x32_bf16 v[100:103], v[80:83], v[36:39], v[100:103]
    v_mfma_f32_16x16x32_bf16 v[104:107], v[88:91], v[36:39], v[104:107]
    s_nop 7
    v_cvt_pk_bf16_f32 v112, v100, v101
    v_cvt_pk_bf16_f32 v113, v102, v103
    v_cvt_pk_bf16_f32 v114, v104, v105
    v_cvt_pk_bf16_f32 v115, v106, v107
    s_add_u32 s38, s37, 5120
    buffer_store_dwordx4 v[112:115], v58, s[16:19], s38 offen sc1
    s_endpgm
L_mid_kernel_g:
    s_sub_u32 s3, s2, 448
    s_load_dwordx2 s[4:5], s[0:1], 16
    s_load_dwordx2 s[6:7], s[0:1], 72
    s_lshr_b32 s24, s3, 4
    s_bfe_u32 s25, s3, 0x20002
    s_and_b32 s26, s3, 3
    s_lshr_b32 s27, s24, 3
    s_and_b32 s28, s24, 7
    v_and_b32 v1, 63, v0
    v_lshrrev_b32 v2, 3, v1
    v_mov_b32 v3, v2
    s_lshl_b32 s29, s25, 3
    s_lshl_b32 s30, s28, 5
    s_add_u32 s29, s29, s30
    v_add_u32 v3, s29, v3
    v_lshlrev_b32 v3, 9, v3
    v_and_b32 v4, 7, v1
    s_lshr_b32 s30, s20, 1
    s_lshl_b32 s30, s30, 2
    v_xor_b32 v4, s30, v4
    v_lshl_add_u32 v3, v4, 4, v3
    s_lshl_b32 s30, s26, 7
    v_add_u32 v3, s30, v3
    v_xor_b32 v4, 32, v3
    s_waitcnt lgkmcnt(0)
    s_mov_b32 s8, s4
    s_mov_b32 s9, s5
    s_mov_b32 s10, 4063232
    s_mov_b32 s11, 0x00020000
    s_add_u32 s12, s6, 62345216
    s_addc_u32 s13, s7, 0
    s_mov_b32 s14, 16916480
    s_mov_b32 s15, 0x00020000
    s_lshl_b32 s30, s20, 3
    s_add_u32 s30, s30, s27
    s_lshl_b32 s30, s30, 17
    s_mul_i32 s31, s20, 4608
    s_add_u32 m0, s31, 0
    s_add_u32 s32, s30, 0
    buffer_load_dwordx4 v3, s[8:11], s32 offen nt lds
    s_add_u32 m0, s31, 1152
    s_add_u32 s32, s30, 262144
    buffer_load_dwordx4 v3, s[8:11], s32 offen nt lds
    s_add_u32 m0, s31, 2304
    s_add_u32 s32, s30, 524288
    buffer_load_dwordx4 v4, s[8:11], s32 offen nt lds
    s_add_u32 m0, s31, 3456
    s_add_u32 s32, s30, 786432
    buffer_load_dwordx4 v4, s[8:11], s32 offen nt lds
    v_and_b32 v8, 15, v1
    v_or_b32 v9, 1, v8
    s_lshl_b32 s33, s20, 4
    v_add_u32 v9, s33, v9
    v_cvt_f32_u32 v9, v9
    v_mul_f32 v9, 0x3c000000, v9
    v_bfe_u32 v10, v1, 4, 1
    v_lshlrev_b32 v10, 3, v10
    v_cvt_f32_u32 v10, v10
    v_and_b32 v8, 1, v8
    v_cvt_f32_u32 v8, v8
    v_mul_f32 v8, 0x3f400000, v8
    v_fma_f32 v11, v9, v10, v8
    v_fract_f32 v12, v11
    v_add_f32 v11, v11, v9
    v_fract_f32 v13, v11
    v_add_f32 v11, v11, v9
    v_fract_f32 v14, v11
    v_add_f32 v11, v11, v9
    v_fract_f32 v15, v11
    v_add_f32 v11, v11, v9
    v_fract_f32 v16, v11
    v_add_f32 v11, v11, v9
    v_fract_f32 v17, v11
    v_add_f32 v11, v11, v9
    v_fract_f32 v18, v11
    v_add_f32 v11, v11, v9
    v_fract_f32 v19, v11
    v_cos_f32 v12, v12
    v_cos_f32 v13, v13
    v_cos_f32 v14, v14
    v_cos_f32 v15, v15
    v_cos_f32 v16, v16
    v_cos_f32 v17, v17
    v_cos_f32 v18, v18
    v_cos_f32 v19, v19
    s_nop 0
    v_mul_f32 v12, 0x3d000000, v12
    v_mul_f32 v13, 0x3d000000, v13
    v_mul_f32 v14, 0x3d000000, v14
    v_mul_f32 v15, 0x3d000000, v15
    v_mul_f32 v16, 0x3d000000, v16
    v_mul_f32 v17, 0x3d000000, v17
    v_mul_f32 v18, 0x3d000000, v18
    v_mul_f32 v19, 0x3d000000, v19
    v_cvt_pk_bf16_f32 v20, v12, v13
    v_cvt_pk_bf16_f32 v21, v14, v15
    v_cvt_pk_bf16_f32 v22, v16, v17
    v_cvt_pk_bf16_f32 v23, v18, v19
    v_lshlrev_b32 v28, 16, v20
    v_and_b32 v29, 0xffff0000, v20
    v_sub_f32 v28, v12, v28
    v_sub_f32 v29, v13, v29
    v_cvt_pk_bf16_f32 v24, v28, v29
    v_lshlrev_b32 v28, 16, v21
    v_and_b32 v29, 0xffff0000, v21
    v_sub_f32 v28, v14, v28
    v_sub_f32 v29, v15, v29
    v_cvt_pk_bf16_f32 v25, v28, v29
    v_lshlrev_b32 v28, 16, v22
    v_and_b32 v29, 0xffff0000, v22
    v_sub_f32 v28, v16, v28
    v_sub_f32 v29, v17, v29
    v_cvt_pk_bf16_f32 v26, v28, v29
    v_lshlrev_b32 v28, 16, v23
    v_and_b32 v29, 0xffff0000, v23
    v_sub_f32 v28, v18, v28
    v_sub_f32 v29, v19, v29
    v_cvt_pk_bf16_f32 v27, v28, v29
    v_cmp_gt_u32 vcc, 32, v1
    s_nop 1
    v_cndmask_b32 v20, v24, v20, vcc
    v_cndmask_b32 v21, v25, v21, vcc
    v_cndmask_b32 v22, v26, v22, vcc
    v_cndmask_b32 v23, v27, v23, vcc
    v_lshlrev_b32 v28, 4, v1
    s_lshl_b32 s33, s20, 10
    v_add_u32 v29, s33, v28
    ds_write_b128 v29, v[20:23] offset:18432
    v_bfe_u32 v30, v1, 2, 2
    v_bfe_u32 v31, v1, 4, 1
    v_lshl_add_u32 v32, v31, 3, v30
    v_mul_u32_u24 v32, 1152, v32
    v_lshrrev_b32 v30, 1, v30
    v_lshl_add_u32 v30, v31, 1, v30
    v_lshlrev_b32 v30, 1, v30
    v_bfe_u32 v31, v1, 1, 1
    s_lshl_b32 s33, s20, 1
    v_add_u32 v31, s33, v31
    v_xor_b32 v30, v30, v31
    v_lshl_add_u32 v32, v30, 4, v32
    v_and_b32 v30, 1, v1
    v_lshl_add_u32 v32, v30, 3, v32
    v_lshrrev_b32 v30, 4, v1
    s_mov_b32 s33, 1057280
    v_mul_lo_u32 v30, v30, s33
    v_and_b32 v31, 15, v1
    v_lshl_add_u32 v33, v31, 4, v30
    s_lshl_b32 s34, s24, 15
    s_lshl_b32 s35, s26, 2
    s_add_u32 s35, s35, s20
    s_lshl_b32 s35, s35, 11
    s_add_u32 s34, s34, s35
    s_lshl_b32 s35, s25, 8
    s_add_u32 s34, s34, s35
    s_waitcnt vmcnt(0) lgkmcnt(0)
    s_barrier
    ds_read_b128 v[36:39], v28 offset:18432
    ds_read_b128 v[40:43], v28 offset:19456
    ds_read_b128 v[44:47], v28 offset:20480
    ds_read_b128 v[48:51], v28 offset:21504
    ds_read_b64_tr_b16 v[52:53], v32 offset:0
    ds_read_b64_tr_b16 v[54:55], v32 offset:4608
    ds_read_b64_tr_b16 v[56:57], v32 offset:128
    ds_read_b64_tr_b16 v[58:59], v32 offset:4736
    ds_read_b64_tr_b16 v[60:61], v32 offset:256
    ds_read_b64_tr_b16 v[62:63], v32 offset:4864
    ds_read_b64_tr_b16 v[64:65], v32 offset:384
    ds_read_b64_tr_b16 v[66:67], v32 offset:4992
    ds_read_b64_tr_b16 v[68:69], v32 offset:512
    ds_read_b64_tr_b16 v[70:71], v32 offset:5120
    s_waitcnt lgkmcnt(8)
    ds_read_b64_tr_b16 v[72:73], v32 offset:640
    ds_read_b64_tr_b16 v[74:75], v32 offset:5248
    ds_read_b64_tr_b16 v[76:77], v32 offset:768
    ds_read_b64_tr_b16 v[78:79], v32 offset:5376
    ds_read_b64_tr_b16 v[80:81], v32 offset:896
    ds_read_b64_tr_b16 v[82:83], v32 offset:5504
    s_waitcnt lgkmcnt(0)
    v_mfma_f32_16x16x32_bf16 v[84:87], v[36:39], v[52:55], 0
    v_mfma_f32_16x16x32_bf16 v[88:91], v[36:39], v[56:59], 0
    v_mfma_f32_16x16x32_bf16 v[92:95], v[36:39], v[60:63], 0
    v_mfma_f32_16x16x32_bf16 v[96:99], v[36:39], v[64:67], 0
    v_mfma_f32_16x16x32_bf16 v[100:103], v[36:39], v[68:71], 0
    v_mfma_f32_16x16x32_bf16 v[104:107], v[36:39], v[72:75], 0
    v_mfma_f32_16x16x32_bf16 v[108:111], v[36:39], v[76:79], 0
    v_mfma_f32_16x16x32_bf16 v[112:115], v[36:39], v[80:83], 0
    s_nop 7
    v_cvt_pk_bf16_f32 v116, v84, v88
    v_cvt_pk_bf16_f32 v117, v92, v96
    v_cvt_pk_bf16_f32 v118, v100, v104
    v_cvt_pk_bf16_f32 v119, v108, v112
    s_add_u32 s35, s34, 0
    buffer_store_dwordx4 v[116:119], v33, s[12:15], s35 offen sc1
    s_nop 1
    v_cvt_pk_bf16_f32 v120, v85, v89
    v_cvt_pk_bf16_f32 v121, v93, v97
    v_cvt_pk_bf16_f32 v122, v101, v105
    v_cvt_pk_bf16_f32 v123, v109, v113
    s_add_u32 s35, s34, 1024
    buffer_store_dwordx4 v[120:123], v33, s[12:15], s35 offen sc1
    s_nop 1
    v_cvt_pk_bf16_f32 v116, v86, v90
    v_cvt_pk_bf16_f32 v117, v94, v98
    v_cvt_pk_bf16_f32 v118, v102, v106
    v_cvt_pk_bf16_f32 v119, v110, v114
    s_add_u32 s35, s34, 528640
    buffer_store_dwordx4 v[116:119], v33, s[12:15], s35 offen sc1
    s_nop 1
    v_cvt_pk_bf16_f32 v120, v87, v91
    v_cvt_pk_bf16_f32 v121, v95, v99
    v_cvt_pk_bf16_f32 v122, v103, v107
    v_cvt_pk_bf16_f32 v123, v111, v115
    s_add_u32 s35, s34, 529664
    buffer_store_dwordx4 v[120:123], v33, s[12:15], s35 offen sc1
    s_nop 1
    v_mfma_f32_16x16x32_bf16 v[84:87], v[40:43], v[52:55], 0
    v_mfma_f32_16x16x32_bf16 v[88:91], v[40:43], v[56:59], 0
    v_mfma_f32_16x16x32_bf16 v[92:95], v[40:43], v[60:63], 0
    v_mfma_f32_16x16x32_bf16 v[96:99], v[40:43], v[64:67], 0
    v_mfma_f32_16x16x32_bf16 v[100:103], v[40:43], v[68:71], 0
    v_mfma_f32_16x16x32_bf16 v[104:107], v[40:43], v[72:75], 0
    v_mfma_f32_16x16x32_bf16 v[108:111], v[40:43], v[76:79], 0
    v_mfma_f32_16x16x32_bf16 v[112:115], v[40:43], v[80:83], 0
    s_nop 7
    v_cvt_pk_bf16_f32 v116, v84, v88
    v_cvt_pk_bf16_f32 v117, v92, v96
    v_cvt_pk_bf16_f32 v118, v100, v104
    v_cvt_pk_bf16_f32 v119, v108, v112
    s_add_u32 s35, s34, 4229120
    buffer_store_dwordx4 v[116:119], v33, s[12:15], s35 offen sc1
    s_nop 1
    v_cvt_pk_bf16_f32 v120, v85, v89
    v_cvt_pk_bf16_f32 v121, v93, v97
    v_cvt_pk_bf16_f32 v122, v101, v105
    v_cvt_pk_bf16_f32 v123, v109, v113
    s_add_u32 s35, s34, 4230144
    buffer_store_dwordx4 v[120:123], v33, s[12:15], s35 offen sc1
    s_nop 1
    v_cvt_pk_bf16_f32 v116, v86, v90
    v_cvt_pk_bf16_f32 v117, v94, v98
    v_cvt_pk_bf16_f32 v118, v102, v106
    v_cvt_pk_bf16_f32 v119, v110, v114
    s_add_u32 s35, s34, 4757760
    buffer_store_dwordx4 v[116:119], v33, s[12:15], s35 offen sc1
    s_nop 1
    v_cvt_pk_bf16_f32 v120, v87, v91
    v_cvt_pk_bf16_f32 v121, v95, v99
    v_cvt_pk_bf16_f32 v122, v103, v107
    v_cvt_pk_bf16_f32 v123, v111, v115
    s_add_u32 s35, s34, 4758784
    buffer_store_dwordx4 v[120:123], v33, s[12:15], s35 offen sc1
    s_nop 1
    v_mfma_f32_16x16x32_bf16 v[84:87], v[44:47], v[52:55], 0
    v_mfma_f32_16x16x32_bf16 v[88:91], v[44:47], v[56:59], 0
    v_mfma_f32_16x16x32_bf16 v[92:95], v[44:47], v[60:63], 0
    v_mfma_f32_16x16x32_bf16 v[96:99], v[44:47], v[64:67], 0
    v_mfma_f32_16x16x32_bf16 v[100:103], v[44:47], v[68:71], 0
    v_mfma_f32_16x16x32_bf16 v[104:107], v[44:47], v[72:75], 0
    v_mfma_f32_16x16x32_bf16 v[108:111], v[44:47], v[76:79], 0
    v_mfma_f32_16x16x32_bf16 v[112:115], v[44:47], v[80:83], 0
    s_nop 7
    v_cvt_pk_bf16_f32 v116, v84, v88
    v_cvt_pk_bf16_f32 v117, v92, v96
    v_cvt_pk_bf16_f32 v118, v100, v104
    v_cvt_pk_bf16_f32 v119, v108, v112
    s_add_u32 s35, s34, 8458240
    buffer_store_dwordx4 v[116:119], v33, s[12:15], s35 offen sc1
    s_nop 1
    v_cvt_pk_bf16_f32 v120, v85, v89
    v_cvt_pk_bf16_f32 v121, v93, v97
    v_cvt_pk_bf16_f32 v122, v101, v105
    v_cvt_pk_bf16_f32 v123, v109, v113
    s_add_u32 s35, s34, 8459264
    buffer_store_dwordx4 v[120:123], v33, s[12:15], s35 offen sc1
    s_nop 1
    v_cvt_pk_bf16_f32 v116, v86, v90
    v_cvt_pk_bf16_f32 v117, v94, v98
    v_cvt_pk_bf16_f32 v118, v102, v106
    v_cvt_pk_bf16_f32 v119, v110, v114
    s_add_u32 s35, s34, 8986880
    buffer_store_dwordx4 v[116:119], v33, s[12:15], s35 offen sc1
    s_nop 1
    v_cvt_pk_bf16_f32 v120, v87, v91
    v_cvt_pk_bf16_f32 v121, v95, v99
    v_cvt_pk_bf16_f32 v122, v103, v107
    v_cvt_pk_bf16_f32 v123, v111, v115
    s_add_u32 s35, s34, 8987904
    buffer_store_dwordx4 v[120:123], v33, s[12:15], s35 offen sc1
    s_nop 1
    v_mfma_f32_16x16x32_bf16 v[84:87], v[48:51], v[52:55], 0
    v_mfma_f32_16x16x32_bf16 v[88:91], v[48:51], v[56:59], 0
    v_mfma_f32_16x16x32_bf16 v[92:95], v[48:51], v[60:63], 0
    v_mfma_f32_16x16x32_bf16 v[96:99], v[48:51], v[64:67], 0
    v_mfma_f32_16x16x32_bf16 v[100:103], v[48:51], v[68:71], 0
    v_mfma_f32_16x16x32_bf16 v[104:107], v[48:51], v[72:75], 0
    v_mfma_f32_16x16x32_bf16 v[108:111], v[48:51], v[76:79], 0
    v_mfma_f32_16x16x32_bf16 v[112:115], v[48:51], v[80:83], 0
    s_nop 7
    v_cvt_pk_bf16_f32 v116, v84, v88
    v_cvt_pk_bf16_f32 v117, v92, v96
    v_cvt_pk_bf16_f32 v118, v100, v104
    v_cvt_pk_bf16_f32 v119, v108, v112
    s_add_u32 s35, s34, 12687360
    buffer_store_dwordx4 v[116:119], v33, s[12:15], s35 offen sc1
    s_nop 1
    v_cvt_pk_bf16_f32 v120, v85, v89
    v_cvt_pk_bf16_f32 v121, v93, v97
    v_cvt_pk_bf16_f32 v122, v101, v105
    v_cvt_pk_bf16_f32 v123, v109, v113
    s_add_u32 s35, s34, 12688384
    buffer_store_dwordx4 v[120:123], v33, s[12:15], s35 offen sc1
    s_nop 1
    v_cvt_pk_bf16_f32 v116, v86, v90
    v_cvt_pk_bf16_f32 v117, v94, v98
    v_cvt_pk_bf16_f32 v118, v102, v106
    v_cvt_pk_bf16_f32 v119, v110, v114
    s_add_u32 s35, s34, 13216000
    buffer_store_dwordx4 v[116:119], v33, s[12:15], s35 offen sc1
    s_nop 1
    v_cvt_pk_bf16_f32 v120, v87, v91
    v_cvt_pk_bf16_f32 v121, v95, v99
    v_cvt_pk_bf16_f32 v122, v103, v107
    v_cvt_pk_bf16_f32 v123, v111, v115
    s_add_u32 s35, s34, 13217024
    buffer_store_dwordx4 v[120:123], v33, s[12:15], s35 offen sc1
    s_nop 1
    s_endpgm
L_mid_kernel_done:
    s_endpgm
.globl gemm2_kernel
.p2align 8
.type gemm2_kernel,@function
gemm2_kernel:
    s_cmp_ge_u32 s2, 256
    s_cbranch_scc1 L_gemm2_kernel_done
    s_load_dwordx2 s[4:5], s[0:1], 72
    s_load_dwordx2 s[6:7], s[0:1], 72
    v_readfirstlane_b32 s20, v0
    s_lshr_b32 s20, s20, 6
    s_and_b32 s24, s2, 7
    s_lshr_b32 s25, s2, 3
    s_lshr_b32 s26, s25, 3
    s_lshl_b32 s24, s24, 2
    s_add_u32 s21, s24, s26
    s_and_b32 s25, s25, 7
    s_lshr_b32 s26, s25, 2
    s_and_b32 s27, s25, 3
    s_mul_i32 s22, s26, 84
    s_sub_u32 s28, 168, s22
    s_min_u32 s28, s28, 84
    s_waitcnt lgkmcnt(0)
    s_mul_i32 s29, s21, 344064
    s_lshl_b32 s30, s22, 11
    s_add_u32 s29, s29, s30
    s_add_u32 s29, s29, 51269632
    s_add_u32 s8, s6, s29
    s_addc_u32 s9, s7, 0
    s_lshl_b32 s10, s28, 11
    s_mov_b32 s11, 0x00020000
    s_mul_i32 s29, s21, 528640
    s_mul_i32 s30, s27, 8192
    s_add_u32 s29, s29, s30
    s_add_u32 s29, s29, 62345216
    s_add_u32 s12, s4, s29
    s_addc_u32 s13, s5, 0
    s_mov_b32 s14, 499712
    s_mov_b32 s15, 0x00020000
    s_cmp_lt_u32 s20, 4
    s_cbranch_scc1 L_gemm2_kernel_consumer
    s_sub_u32 s20, s20, 4
    v_and_b32 v1, 63, v0
    v_lshrrev_b32 v4, 3, v1
    v_and_b32 v5, 7, v1
    v_xor_b32 v5, v5, v4
    v_lshlrev_b32 v5, 4, v5
    v_lshl_add_u32 v2, v4, 11, v5
    v_lshlrev_b32 v3, 4, v1
    s_add_u32 s24, s20, 0
    s_lshl_b32 s40, s24, 10
    s_lshl_b32 s43, s24, 14
    s_add_u32 s24, s20, 4
    s_lshl_b32 s41, s24, 10
    s_lshl_b32 s44, s24, 14
    s_add_u32 s24, s20, 8
    s_lshl_b32 s42, s24, 10
    s_lshl_b32 s45, s24, 14
    s_mul_i32 s46, s20, 2048
    s_add_u32 s47, s46, 12288
    s_add_u32 m0, s40, 0
    s_add_u32 s24, s43, 0
    buffer_load_dwordx4 v2, s[8:11], s24 offen lds
    s_add_u32 m0, s41, 0
    s_add_u32 s24, s44, 0
    buffer_load_dwordx4 v2, s[8:11], s24 offen lds
    s_add_u32 m0, s42, 0
    s_add_u32 s24, s45, 0
    buffer_load_dwordx4 v2, s[8:11], s24 offen lds
    s_add_u32 m0, s47, 0
    s_add_u32 s24, s46, 0
    buffer_load_dwordx4 v3, s[12:15], s24 offen offset:0 lds
    buffer_load_dwordx4 v3, s[12:15], s24 offen offset:1024 lds
    s_add_u32 m0, s40, 20480
    s_add_u32 s24, s43, 128
    buffer_load_dwordx4 v2, s[8:11], s24 offen lds
    s_add_u32 m0, s41, 20480
    s_add_u32 s24, s44, 128
    buffer_load_dwordx4 v2, s[8:11], s24 offen lds
    s_add_u32 m0, s42, 20480
    s_add_u32 s24, s45, 128
    buffer_load_dwordx4 v2, s[8:11], s24 offen lds
    s_add_u32 m0, s47, 20480
    s_add_u32 s24, s46, 32768
    buffer_load_dwordx4 v3, s[12:15], s24 offen offset:0 lds
    buffer_load_dwordx4 v3, s[12:15], s24 offen offset:1024 lds
    s_waitcnt vmcnt(5)
    s_barrier
    s_add_u32 m0, s40, 40960
    s_add_u32 s24, s43, 256
    buffer_load_dwordx4 v2, s[8:11], s24 offen lds
    s_add_u32 m0, s41, 40960
    s_add_u32 s24, s44, 256
    buffer_load_dwordx4 v2, s[8:11], s24 offen lds
    s_add_u32 m0, s42, 40960
    s_add_u32 s24, s45, 256
    buffer_load_dwordx4 v2, s[8:11], s24 offen lds
    s_add_u32 m0, s47, 40960
    s_add_u32 s24, s46, 65536
    buffer_load_dwordx4 v3, s[12:15], s24 offen offset:0 lds
    buffer_load_dwordx4 v3, s[12:15], s24 offen offset:1024 lds
    s_waitcnt vmcnt(5)
    s_barrier
    s_add_u32 m0, s40, 61440
    s_add_u32 s24, s43, 384
    buffer_load_dwordx4 v2, s[8:11], s24 offen lds
    s_add_u32 m0, s41, 61440
    s_add_u32 s24, s44, 384
    buffer_load_dwordx4 v2, s[8:11], s24 offen lds
    s_add_u32 m0, s42, 61440
    s_add_u32 s24, s45, 384
    buffer_load_dwordx4 v2, s[8:11], s24 offen lds
    s_add_u32 m0, s47, 61440
    s_add_u32 s24, s46, 98304
    buffer_load_dwordx4 v3, s[12:15], s24 offen offset:0 lds
    buffer_load_dwordx4 v3, s[12:15], s24 offen offset:1024 lds
    s_add_u32 m0, s40, 81920
    s_add_u32 s24, s43, 512
    buffer_load_dwordx4 v2, s[8:11], s24 offen lds
    s_add_u32 m0, s41, 81920
    s_add_u32 s24, s44, 512
    buffer_load_dwordx4 v2, s[8:11], s24 offen lds
    s_add_u32 m0, s42, 81920
    s_add_u32 s24, s45, 512
    buffer_load_dwordx4 v2, s[8:11], s24 offen lds
    s_add_u32 m0, s47, 81920
    s_add_u32 s24, s46, 131072
    buffer_load_dwordx4 v3, s[12:15], s24 offen offset:0 lds
    buffer_load_dwordx4 v3, s[12:15], s24 offen offset:1024 lds
    s_waitcnt vmcnt(10)
    s_barrier
    s_add_u32 m0, s40, 102400
    s_add_u32 s24, s43, 640
    buffer_load_dwordx4 v2, s[8:11], s24 offen lds
    s_add_u32 m0, s41, 102400
    s_add_u32 s24, s44, 640
    buffer_load_dwordx4 v2, s[8:11], s24 offen lds
    s_add_u32 m0, s42, 102400
    s_add_u32 s24, s45, 640
    buffer_load_dwordx4 v2, s[8:11], s24 offen lds
    s_add_u32 m0, s47, 102400
    s_add_u32 s24, s46, 163840
    buffer_load_dwordx4 v3, s[12:15], s24 offen offset:0 lds
    buffer_load_dwordx4 v3, s[12:15], s24 offen offset:1024 lds
    s_add_u32 m0, s40, 122880
    s_add_u32 s24, s43, 768
    buffer_load_dwordx4 v2, s[8:11], s24 offen lds
    s_add_u32 m0, s41, 122880
    s_add_u32 s24, s44, 768
    buffer_load_dwordx4 v2, s[8:11], s24 offen lds
    s_add_u32 m0, s42, 122880
    s_add_u32 s24, s45, 768
    buffer_load_dwordx4 v2, s[8:11], s24 offen lds
    s_add_u32 m0, s47, 122880
    s_add_u32 s24, s46, 196608
    buffer_load_dwordx4 v3, s[12:15], s24 offen offset:0 lds
    buffer_load_dwordx4 v3, s[12:15], s24 offen offset:1024 lds
    s_waitcnt vmcnt(15)
    s_barrier
    s_add_u32 m0, s40, 0
    s_add_u32 s24, s43, 896
    buffer_load_dwordx4 v2, s[8:11], s24 offen lds
    s_add_u32 m0, s41, 0
    s_add_u32 s24, s44, 896
    buffer_load_dwordx4 v2, s[8:11], s24 offen lds
    s_add_u32 m0, s42, 0
    s_add_u32 s24, s45, 896
    buffer_load_dwordx4 v2, s[8:11], s24 offen lds
    s_add_u32 m0, s47, 0
    s_add_u32 s24, s46, 229376
    buffer_load_dwordx4 v3, s[12:15], s24 offen offset:0 lds
    buffer_load_dwordx4 v3, s[12:15], s24 offen offset:1024 lds
    s_add_u32 m0, s40, 20480
    s_add_u32 s24, s43, 1024
    buffer_load_dwordx4 v2, s[8:11], s24 offen lds
    s_add_u32 m0, s41, 20480
    s_add_u32 s24, s44, 1024
    buffer_load_dwordx4 v2, s[8:11], s24 offen lds
    s_add_u32 m0, s42, 20480
    s_add_u32 s24, s45, 1024
    buffer_load_dwordx4 v2, s[8:11], s24 offen lds
    s_add_u32 m0, s47, 20480
    s_add_u32 s24, s46, 262144
    buffer_load_dwordx4 v3, s[12:15], s24 offen offset:0 lds
    buffer_load_dwordx4 v3, s[12:15], s24 offen offset:1024 lds
    s_waitcnt vmcnt(20)
    s_barrier
    s_add_u32 m0, s40, 40960
    s_add_u32 s24, s43, 1152
    buffer_load_dwordx4 v2, s[8:11], s24 offen lds
    s_add_u32 m0, s41, 40960
    s_add_u32 s24, s44, 1152
    buffer_load_dwordx4 v2, s[8:11], s24 offen lds
    s_add_u32 m0, s42, 40960
    s_add_u32 s24, s45, 1152
    buffer_load_dwordx4 v2, s[8:11], s24 offen lds
    s_add_u32 m0, s47, 40960
    s_add_u32 s24, s46, 294912
    buffer_load_dwordx4 v3, s[12:15], s24 offen offset:0 lds
    buffer_load_dwordx4 v3, s[12:15], s24 offen offset:1024 lds
    s_add_u32 m0, s40, 61440
    s_add_u32 s24, s43, 1280
    buffer_load_dwordx4 v2, s[8:11], s24 offen lds
    s_add_u32 m0, s41, 61440
    s_add_u32 s24, s44, 1280
    buffer_load_dwordx4 v2, s[8:11], s24 offen lds
    s_add_u32 m0, s42, 61440
    s_add_u32 s24, s45, 1280
    buffer_load_dwordx4 v2, s[8:11], s24 offen lds
    s_add_u32 m0, s47, 61440
    s_add_u32 s24, s46, 327680
    buffer_load_dwordx4 v3, s[12:15], s24 offen offset:0 lds
    buffer_load_dwordx4 v3, s[12:15], s24 offen offset:1024 lds
    s_waitcnt vmcnt(25)
    s_barrier
    s_add_u32 m0, s40, 81920
    s_add_u32 s24, s43, 1408
    buffer_load_dwordx4 v2, s[8:11], s24 offen lds
    s_add_u32 m0, s41, 81920
    s_add_u32 s24, s44, 1408
    buffer_load_dwordx4 v2, s[8:11], s24 offen lds
    s_add_u32 m0, s42, 81920
    s_add_u32 s24, s45, 1408
    buffer_load_dwordx4 v2, s[8:11], s24 offen lds
    s_add_u32 m0, s47, 81920
    s_add_u32 s24, s46, 360448
    buffer_load_dwordx4 v3, s[12:15], s24 offen offset:0 lds
    buffer_load_dwordx4 v3, s[12:15], s24 offen offset:1024 lds
    s_waitcnt vmcnt(25)
    s_barrier
    s_add_u32 m0, s40, 102400
    s_add_u32 s24, s43, 1536
    buffer_load_dwordx4 v2, s[8:11], s24 offen lds
    s_add_u32 m0, s41, 102400
    s_add_u32 s24, s44, 1536
    buffer_load_dwordx4 v2, s[8:11], s24 offen lds
    s_add_u32 m0, s42, 102400
    s_add_u32 s24, s45, 1536
    buffer_load_dwordx4 v2, s[8:11], s24 offen lds
    s_add_u32 m0, s47, 102400
    s_add_u32 s24, s46, 393216
    buffer_load_dwordx4 v3, s[12:15], s24 offen offset:0 lds
    buffer_load_dwordx4 v3, s[12:15], s24 offen offset:1024 lds
    s_waitcnt vmcnt(25)
    s_barrier
    s_add_u32 m0, s40, 122880
    s_add_u32 s24, s43, 1664
    buffer_load_dwordx4 v2, s[8:11], s24 offen lds
    s_add_u32 m0, s41, 122880
    s_add_u32 s24, s44, 1664
    buffer_load_dwordx4 v2, s[8:11], s24 offen lds
    s_add_u32 m0, s42, 122880
    s_add_u32 s24, s45, 1664
    buffer_load_dwordx4 v2, s[8:11], s24 offen lds
    s_add_u32 m0, s47, 122880
    s_add_u32 s24, s46, 425984
    buffer_load_dwordx4 v3, s[12:15], s24 offen offset:0 lds
    buffer_load_dwordx4 v3, s[12:15], s24 offen offset:1024 lds
    s_waitcnt vmcnt(25)
    s_barrier
    s_add_u32 m0, s40, 0
    s_add_u32 s24, s43, 1792
    buffer_load_dwordx4 v2, s[8:11], s24 offen lds
    s_add_u32 m0, s41, 0
    s_add_u32 s24, s44, 1792
    buffer_load_dwordx4 v2, s[8:11], s24 offen lds
    s_add_u32 m0, s42, 0
    s_add_u32 s24, s45, 1792
    buffer_load_dwordx4 v2, s[8:11], s24 offen lds
    s_add_u32 m0, s47, 0
    s_add_u32 s24, s46, 458752
    buffer_load_dwordx4 v3, s[12:15], s24 offen offset:0 lds
    buffer_load_dwordx4 v3, s[12:15], s24 offen offset:1024 lds
    s_waitcnt vmcnt(25)
    s_barrier
    s_add_u32 m0, s40, 20480
    s_add_u32 s24, s43, 1920
    buffer_load_dwordx4 v2, s[8:11], s24 offen lds
    s_add_u32 m0, s41, 20480
    s_add_u32 s24, s44, 1920
    buffer_load_dwordx4 v2, s[8:11], s24 offen lds
    s_add_u32 m0, s42, 20480
    s_add_u32 s24, s45, 1920
    buffer_load_dwordx4 v2, s[8:11], s24 offen lds
    s_add_u32 m0, s47, 20480
    s_add_u32 s24, s46, 491520
    buffer_load_dwordx4 v3, s[12:15], s24 offen offset:0 lds
    buffer_load_dwordx4 v3, s[12:15], s24 offen offset:1024 lds
    s_waitcnt vmcnt(25)
    s_barrier
    s_waitcnt vmcnt(20)
    s_barrier
    s_waitcnt vmcnt(15)
    s_barrier
    s_waitcnt vmcnt(10)
    s_barrier
    s_waitcnt vmcnt(5)
    s_barrier
    s_waitcnt vmcnt(0)
    s_barrier
    s_barrier
    s_barrier
L_gemm2_kernel_done:
    s_endpgm
L_gemm2_kernel_consumer:
    s_mul_i32 s29, s22, 37120
    s_add_u32 s29, s29, 79261696
    s_add_u32 s16, s4, s29
    s_addc_u32 s17, s5, 0
    s_mul_i32 s18, s28, 37120
    s_mov_b32 s19, 0x00020000
    s_lshr_b32 s29, s20, 1
    s_and_b32 s30, s20, 1
    v_and_b32 v137, 15, v0
    v_bfe_u32 v138, v0, 4, 2
    v_and_b32 v139, 63, v0
    s_mul_i32 s31, s29, 6144
    v_and_b32 v140, 7, v137
    v_xor_b32 v140, v138, v140
    v_lshlrev_b32 v140, 4, v140
    v_lshl_add_u32 v140, v137, 7, v140
    v_add_u32 v140, s31, v140
    v_add_u32 v128, 0, v140
    v_xor_b32 v131, 64, v128
    v_add_u32 v129, 61440, v140
    v_xor_b32 v132, 64, v129
    v_add_u32 v130, 122880, v140
    v_xor_b32 v133, 64, v130
    s_mul_i32 s31, s30, 4096
    s_add_u32 s31, s31, 12288
    v_lshlrev_b32 v140, 4, v139
    v_add_u32 v140, s31, v140
    v_add_u32 v134, 0, v140
    v_add_u32 v135, 61440, v140
    v_add_u32 v136, 122880, v140
    v_and_b32 v144, 7, v137
    v_lshrrev_b32 v145, 3, v137
    v_mul_u32_u24 v142, 37120, v144
    v_lshl_add_u32 v142, v138, 4, v142
    s_mul_i32 s31, s29, 1781760
    v_add_u32 v142, s31, v142
    v_lshl_add_u32 v142, v145, 6, v142
    v_xor_b32 v145, 64, v142
    v_add_u32 v143, 296960, v145
    s_mul_i32 s31, s27, 2
    s_mul_i32 s29, s30, 1
    s_add_u32 s31, s31, s29
    s_mul_i32 s31, s31, 128
    s_mul_i32 s29, s21, 1024
    s_add_u32 s33, s31, s29
    s_mov_b32 s34, 0x80008000
    v_mov_b32 v0, 0
    v_mov_b32 v24, 0
    v_mov_b32 v1, 0
    v_mov_b32 v25, 0
    v_mov_b32 v2, 0
    v_mov_b32 v26, 0
    v_mov_b32 v3, 0
    v_mov_b32 v27, 0
    v_mov_b32 v4, 0
    v_mov_b32 v28, 0
    v_mov_b32 v5, 0
    v_mov_b32 v29, 0
    v_mov_b32 v6, 0
    v_mov_b32 v30, 0
    v_mov_b32 v7, 0
    v_mov_b32 v31, 0
    v_mov_b32 v8, 0
    v_mov_b32 v32, 0
    v_mov_b32 v9, 0
    v_mov_b32 v33, 0
    v_mov_b32 v10, 0
    v_mov_b32 v34, 0
    v_mov_b32 v11, 0
    v_mov_b32 v35, 0
    v_mov_b32 v12, 0
    v_mov_b32 v36, 0
    v_mov_b32 v13, 0
    v_mov_b32 v37, 0
    v_mov_b32 v14, 0
    v_mov_b32 v38, 0
    v_mov_b32 v15, 0
    v_mov_b32 v39, 0
    v_mov_b32 v16, 0
    v_mov_b32 v40, 0
    v_mov_b32 v17, 0
    v_mov_b32 v41, 0
    v_mov_b32 v18, 0
    v_mov_b32 v42, 0
    v_mov_b32 v19, 0
    v_mov_b32 v43, 0
    v_mov_b32 v20, 0
    v_mov_b32 v44, 0
    v_mov_b32 v21, 0
    v_mov_b32 v45, 0
    v_mov_b32 v22, 0
    v_mov_b32 v46, 0
    v_mov_b32 v23, 0
    v_mov_b32 v47, 0
    s_mov_b32 s38, 0
    v_add_u32 v129, s38, v128
    v_add_u32 v135, s38, v134
    v_xor_b32 v131, 64, v129
    s_add_u32 s38, s38, 20480
    s_cmp_eq_u32 s38, 143360
    s_cselect_b32 s38, 0, s38
    s_barrier
    ds_read_b128 v[48:51], v135 offset:0
    ds_read_b128 v[64:67], v129 offset:0
    ds_read_b128 v[72:75], v129 offset:2048
    ds_read_b128 v[80:83], v129 offset:4096
    ds_read_b128 v[56:59], v135 offset:2048
    ds_read_b128 v[68:71], v131 offset:0
    ds_read_b128 v[76:79], v131 offset:2048
    ds_read_b128 v[84:87], v131 offset:4096
    ds_read_b128 v[52:55], v135 offset:1024
    ds_read_b128 v[60:63], v135 offset:3072
    v_add_u32 v129, s38, v128
    v_add_u32 v135, s38, v134
    v_xor_b32 v131, 64, v129
    s_add_u32 s38, s38, 20480
    s_cmp_eq_u32 s38, 143360
    s_cselect_b32 s38, 0, s38
    s_mov_b32 s39, 8
    s_waitcnt lgkmcnt(0)
    s_barrier
L_gemm2_kernel_loop:
    v_mfma_f32_16x16x32_bf16 v[0:3], v[48:51], v[64:67], v[0:3]
    ds_read_b128 v[88:91], v135 offset:0
    v_mfma_f32_16x16x32_bf16 v[4:7], v[48:51], v[72:75], v[4:7]
    ds_read_b128 v[104:107], v129 offset:0
    v_mfma_f32_16x16x32_bf16 v[8:11], v[48:51], v[80:83], v[8:11]
    ds_read_b128 v[112:115], v129 offset:2048
    v_mfma_f32_16x16x32_bf16 v[12:15], v[56:59], v[64:67], v[12:15]
    ds_read_b128 v[120:123], v129 offset:4096
    v_mfma_f32_16x16x32_bf16 v[16:19], v[56:59], v[72:75], v[16:19]
    ds_read_b128 v[96:99], v135 offset:2048
    v_mfma_f32_16x16x32_bf16 v[20:23], v[56:59], v[80:83], v[20:23]
    ds_read_b128 v[108:111], v131 offset:0
    v_mfma_f32_16x16x32_bf16 v[24:27], v[48:51], v[68:71], v[24:27]
    ds_read_b128 v[116:119], v131 offset:2048
    v_mfma_f32_16x16x32_bf16 v[28:31], v[48:51], v[76:79], v[28:31]
    ds_read_b128 v[124:127], v131 offset:4096
    v_mfma_f32_16x16x32_bf16 v[32:35], v[48:51], v[84:87], v[32:35]
    ds_read_b128 v[92:95], v135 offset:1024
    v_mfma_f32_16x16x32_bf16 v[36:39], v[56:59], v[68:71], v[36:39]
    ds_read_b128 v[100:103], v135 offset:3072
    v_mfma_f32_16x16x32_bf16 v[40:43], v[56:59], v[76:79], v[40:43]
    v_mfma_f32_16x16x32_bf16 v[44:47], v[56:59], v[84:87], v[44:47]
    v_mfma_f32_16x16x32_bf16 v[24:27], v[52:55], v[64:67], v[24:27]
    v_xor_b32 v68, s34, v68
    v_xor_b32 v69, s34, v69
    v_mfma_f32_16x16x32_bf16 v[28:31], v[52:55], v[72:75], v[28:31]
    v_xor_b32 v70, s34, v70
    v_xor_b32 v71, s34, v71
    v_mfma_f32_16x16x32_bf16 v[32:35], v[52:55], v[80:83], v[32:35]
    v_xor_b32 v76, s34, v76
    v_xor_b32 v77, s34, v77
    v_mfma_f32_16x16x32_bf16 v[36:39], v[60:63], v[64:67], v[36:39]
    v_xor_b32 v78, s34, v78
    v_xor_b32 v79, s34, v79
    v_mfma_f32_16x16x32_bf16 v[40:43], v[60:63], v[72:75], v[40:43]
    v_xor_b32 v84, s34, v84
    v_xor_b32 v85, s34, v85
    v_mfma_f32_16x16x32_bf16 v[44:47], v[60:63], v[80:83], v[44:47]
    v_xor_b32 v86, s34, v86
    v_xor_b32 v87, s34, v87
    v_mfma_f32_16x16x32_bf16 v[0:3], v[52:55], v[68:71], v[0:3]
    v_mfma_f32_16x16x32_bf16 v[4:7], v[52:55], v[76:79], v[4:7]
    v_mfma_f32_16x16x32_bf16 v[8:11], v[52:55], v[84:87], v[8:11]
    s_waitcnt lgkmcnt(0)
    s_barrier
    v_mfma_f32_16x16x32_bf16 v[12:15], v[60:63], v[68:71], v[12:15]
    v_add_u32 v129, s38, v128
    v_add_u32 v135, s38, v134
    v_mfma_f32_16x16x32_bf16 v[16:19], v[60:63], v[76:79], v[16:19]
    v_xor_b32 v131, 64, v129
    s_add_u32 s38, s38, 20480
    v_mfma_f32_16x16x32_bf16 v[20:23], v[60:63], v[84:87], v[20:23]
    s_cmp_eq_u32 s38, 143360
    s_cselect_b32 s38, 0, s38
    v_mfma_f32_16x16x32_bf16 v[0:3], v[88:91], v[104:107], v[0:3]
    ds_read_b128 v[48:51], v135 offset:0
    v_mfma_f32_16x16x32_bf16 v[4:7], v[88:91], v[112:115], v[4:7]
    ds_read_b128 v[64:67], v129 offset:0
    v_mfma_f32_16x16x32_bf16 v[8:11], v[88:91], v[120:123], v[8:11]
    ds_read_b128 v[72:75], v129 offset:2048
    v_mfma_f32_16x16x32_bf16 v[12:15], v[96:99], v[104:107], v[12:15]
    ds_read_b128 v[80:83], v129 offset:4096
    v_mfma_f32_16x16x32_bf16 v[16:19], v[96:99], v[112:115], v[16:19]
    ds_read_b128 v[56:59], v135 offset:2048
    v_mfma_f32_16x16x32_bf16 v[20:23], v[96:99], v[120:123], v[20:23]
    ds_read_b128 v[68:71], v131 offset:0
    v_mfma_f32_16x16x32_bf16 v[24:27], v[88:91], v[108:111], v[24:27]
    ds_read_b128 v[76:79], v131 offset:2048
    v_mfma_f32_16x16x32_bf16 v[28:31], v[88:91], v[116:119], v[28:31]
    ds_read_b128 v[84:87], v131 offset:4096
    v_mfma_f32_16x16x32_bf16 v[32:35], v[88:91], v[124:127], v[32:35]
    ds_read_b128 v[52:55], v135 offset:1024
    v_mfma_f32_16x16x32_bf16 v[36:39], v[96:99], v[108:111], v[36:39]
    ds_read_b128 v[60:63], v135 offset:3072
    v_mfma_f32_16x16x32_bf16 v[40:43], v[96:99], v[116:119], v[40:43]
    v_mfma_f32_16x16x32_bf16 v[44:47], v[96:99], v[124:127], v[44:47]
    v_mfma_f32_16x16x32_bf16 v[24:27], v[92:95], v[104:107], v[24:27]
    v_xor_b32 v108, s34, v108
    v_xor_b32 v109, s34, v109
    v_mfma_f32_16x16x32_bf16 v[28:31], v[92:95], v[112:115], v[28:31]
    v_xor_b32 v110, s34, v110
    v_xor_b32 v111, s34, v111
    v_mfma_f32_16x16x32_bf16 v[32:35], v[92:95], v[120:123], v[32:35]
    v_xor_b32 v116, s34, v116
    v_xor_b32 v117, s34, v117
    v_mfma_f32_16x16x32_bf16 v[36:39], v[100:103], v[104:107], v[36:39]
    v_xor_b32 v118, s34, v118
    v_xor_b32 v119, s34, v119
    v_mfma_f32_16x16x32_bf16 v[40:43], v[100:103], v[112:115], v[40:43]
    v_xor_b32 v124, s34, v124
    v_xor_b32 v125, s34, v125
    v_mfma_f32_16x16x32_bf16 v[44:47], v[100:103], v[120:123], v[44:47]
    v_xor_b32 v126, s34, v126
    v_xor_b32 v127, s34, v127
    v_mfma_f32_16x16x32_bf16 v[0:3], v[92:95], v[108:111], v[0:3]
    v_mfma_f32_16x16x32_bf16 v[4:7], v[92:95], v[116:119], v[4:7]
    v_mfma_f32_16x16x32_bf16 v[8:11], v[92:95], v[124:127], v[8:11]
    s_waitcnt lgkmcnt(0)
    s_barrier
    v_mfma_f32_16x16x32_bf16 v[12:15], v[100:103], v[108:111], v[12:15]
    v_add_u32 v129, s38, v128
    v_add_u32 v135, s38, v134
    v_mfma_f32_16x16x32_bf16 v[16:19], v[100:103], v[116:119], v[16:19]
    v_xor_b32 v131, 64, v129
    s_add_u32 s38, s38, 20480
    s_sub_u32 s39, s39, 1
    v_mfma_f32_16x16x32_bf16 v[20:23], v[100:103], v[124:127], v[20:23]
    s_cmp_eq_u32 s38, 143360
    s_cselect_b32 s38, 0, s38
    s_cmp_lg_u32 s39, 0
    s_cbranch_scc1 L_gemm2_kernel_loop
    s_nop 7
    s_nop 7
    v_cvt_pk_bf16_f32 v48, v0, v1
    v_cvt_pk_bf16_f32 v49, v2, v3
    v_cvt_pk_bf16_f32 v50, v12, v13
    v_cvt_pk_bf16_f32 v51, v14, v15
    v_cvt_pk_bf16_f32 v52, v24, v25
    v_cvt_pk_bf16_f32 v53, v26, v27
    v_cvt_pk_bf16_f32 v54, v36, v37
    v_cvt_pk_bf16_f32 v55, v38, v39
    v_mov_b32 v56, v48
    v_mov_b32 v57, v49
    v_mov_b32 v58, v50
    v_mov_b32 v59, v51
    s_add_u32 s35, s33, 0
    v_mov_b32_dpp v56, v52 row_ror:8 row_mask:0xf bank_mask:0x3
    v_mov_b32_dpp v57, v53 row_ror:8 row_mask:0xf bank_mask:0x3
    v_mov_b32_dpp v58, v54 row_ror:8 row_mask:0xf bank_mask:0x3
    v_mov_b32_dpp v59, v55 row_ror:8 row_mask:0xf bank_mask:0x3
    v_mov_b32_dpp v48, v52 row_ror:8 row_mask:0xf bank_mask:0xc
    v_mov_b32_dpp v49, v53 row_ror:8 row_mask:0xf bank_mask:0xc
    v_mov_b32_dpp v50, v54 row_ror:8 row_mask:0xf bank_mask:0xc
    v_mov_b32_dpp v51, v55 row_ror:8 row_mask:0xf bank_mask:0xc
    buffer_store_dwordx4 v[48:51], v142, s[16:19], s35 offen sc1
    buffer_store_dwordx4 v[56:59], v143, s[16:19], s35 offen sc1
    v_cvt_pk_bf16_f32 v60, v4, v5
    v_cvt_pk_bf16_f32 v61, v6, v7
    v_cvt_pk_bf16_f32 v62, v16, v17
    v_cvt_pk_bf16_f32 v63, v18, v19
    v_cvt_pk_bf16_f32 v64, v28, v29
    v_cvt_pk_bf16_f32 v65, v30, v31
    v_cvt_pk_bf16_f32 v66, v40, v41
    v_cvt_pk_bf16_f32 v67, v42, v43
    v_mov_b32 v68, v60
    v_mov_b32 v69, v61
    v_mov_b32 v70, v62
    v_mov_b32 v71, v63
    s_add_u32 s35, s33, 593920
    v_mov_b32_dpp v68, v64 row_ror:8 row_mask:0xf bank_mask:0x3
    v_mov_b32_dpp v69, v65 row_ror:8 row_mask:0xf bank_mask:0x3
    v_mov_b32_dpp v70, v66 row_ror:8 row_mask:0xf bank_mask:0x3
    v_mov_b32_dpp v71, v67 row_ror:8 row_mask:0xf bank_mask:0x3
    v_mov_b32_dpp v60, v64 row_ror:8 row_mask:0xf bank_mask:0xc
    v_mov_b32_dpp v61, v65 row_ror:8 row_mask:0xf bank_mask:0xc
    v_mov_b32_dpp v62, v66 row_ror:8 row_mask:0xf bank_mask:0xc
    v_mov_b32_dpp v63, v67 row_ror:8 row_mask:0xf bank_mask:0xc
    buffer_store_dwordx4 v[60:63], v142, s[16:19], s35 offen sc1
    buffer_store_dwordx4 v[68:71], v143, s[16:19], s35 offen sc1
    v_cvt_pk_bf16_f32 v72, v8, v9
    v_cvt_pk_bf16_f32 v73, v10, v11
    v_cvt_pk_bf16_f32 v74, v20, v21
    v_cvt_pk_bf16_f32 v75, v22, v23
    v_cvt_pk_bf16_f32 v76, v32, v33
    v_cvt_pk_bf16_f32 v77, v34, v35
    v_cvt_pk_bf16_f32 v78, v44, v45
    v_cvt_pk_bf16_f32 v79, v46, v47
    v_mov_b32 v80, v72
    v_mov_b32 v81, v73
    v_mov_b32 v82, v74
    v_mov_b32 v83, v75
    s_add_u32 s35, s33, 1187840
    v_mov_b32_dpp v80, v76 row_ror:8 row_mask:0xf bank_mask:0x3
    v_mov_b32_dpp v81, v77 row_ror:8 row_mask:0xf bank_mask:0x3
    v_mov_b32_dpp v82, v78 row_ror:8 row_mask:0xf bank_mask:0x3
    v_mov_b32_dpp v83, v79 row_ror:8 row_mask:0xf bank_mask:0x3
    v_mov_b32_dpp v72, v76 row_ror:8 row_mask:0xf bank_mask:0xc
    v_mov_b32_dpp v73, v77 row_ror:8 row_mask:0xf bank_mask:0xc
    v_mov_b32_dpp v74, v78 row_ror:8 row_mask:0xf bank_mask:0xc
    v_mov_b32_dpp v75, v79 row_ror:8 row_mask:0xf bank_mask:0xc
    buffer_store_dwordx4 v[72:75], v142, s[16:19], s35 offen sc1
    buffer_store_dwordx4 v[80:83], v143, s[16:19], s35 offen sc1
    s_endpgm
.globl joint_kernel
.p2align 8
.type joint_kernel,@function
joint_kernel:
    s_cmp_ge_u32 s2, 256
    s_cbranch_scc1 L_joint_kernel_done
    s_load_dwordx2 s[6:7], s[0:1], 72
    s_load_dwordx2 s[4:5], s[0:1], 56
    v_readfirstlane_b32 s20, v0
    s_lshr_b32 s20, s20, 6
    s_and_b32 s21, s20, 3
    s_and_b32 s23, s2, 7
    s_lshl_b32 s23, s23, 5
    s_lshr_b32 s22, s2, 3
    s_add_u32 s23, s23, s22
    s_cmp_ge_u32 s23, 250
    s_cbranch_scc1 L_joint_kernel_done
    s_cmp_ge_u32 s23, 125
    s_cselect_b32 s24, 1, 0
    s_mul_i32 s25, s24, 125
    s_sub_u32 s25, s23, s25
    s_lshl_b32 s26, s25, 1
    s_add_u32 s26, s26, 0
    s_mul_i32 s27, s26, 171
    s_lshr_b32 s28, s27, 9
    s_mul_i32 s27, s28, 3
    s_sub_u32 s30, s26, s27
    s_lshl_b32 s26, s25, 1
    s_add_u32 s26, s26, 1
    s_mul_i32 s27, s26, 171
    s_lshr_b32 s29, s27, 9
    s_mul_i32 s27, s29, 3
    s_sub_u32 s31, s26, s27
    v_and_b32 v1, 63, v0
    v_lshlrev_b32 v5, 4, v1
    s_waitcnt lgkmcnt(0)
    s_add_u32 s12, s6, 85499904
    s_addc_u32 s13, s7, 0
    s_mov_b32 s14, 295936
    s_mov_b32 s15, 0x00020000
    s_mul_i32 s36, s24, 4000
    s_lshl_b32 s37, s25, 5
    s_add_u32 s36, s36, s37
    s_lshl_b32 s36, s36, 12
    s_add_u32 s16, s4, s36
    s_addc_u32 s17, s5, 0
    s_mov_b32 s18, 131072
    s_mov_b32 s19, 0x00020000
    s_lshl_b32 s38, s21, 15
    s_cmp_lt_u32 s20, 4
    s_cbranch_scc1 L_joint_kernel_mpath
    v_and_b32 v14, 7, v1
    v_lshlrev_b32 v14, 10, v14
    v_lshrrev_b32 v15, 5, v1
    v_lshl_add_u32 v14, v15, 4, v14
    s_lshl_b32 s36, s24, 13
    s_lshl_b32 s37, s21, 8
    s_add_u32 s36, s36, s37
    s_add_u32 s37, s36, 16384
    s_add_u32 s36, s38, 32768
    buffer_load_dwordx4 a[0:3], v5, s[12:15], s36 offen
    s_add_u32 s36, s38, 49152
    buffer_load_dwordx4 a[64:67], v5, s[12:15], s36 offen
    s_add_u32 s36, s38, 33792
    buffer_load_dwordx4 a[4:7], v5, s[12:15], s36 offen
    s_add_u32 s36, s38, 50176
    buffer_load_dwordx4 a[68:71], v5, s[12:15], s36 offen
    s_add_u32 s36, s38, 34816
    buffer_load_dwordx4 a[8:11], v5, s[12:15], s36 offen
    s_add_u32 s36, s38, 51200
    buffer_load_dwordx4 a[72:75], v5, s[12:15], s36 offen
    s_add_u32 s36, s38, 35840
    buffer_load_dwordx4 a[12:15], v5, s[12:15], s36 offen
    s_add_u32 s36, s38, 52224
    buffer_load_dwordx4 a[76:79], v5, s[12:15], s36 offen
    s_add_u32 s36, s38, 36864
    buffer_load_dwordx4 a[16:19], v5, s[12:15], s36 offen
    s_add_u32 s36, s38, 53248
    buffer_load_dwordx4 a[80:83], v5, s[12:15], s36 offen
    s_add_u32 s36, s38, 37888
    buffer_load_dwordx4 a[20:23], v5, s[12:15], s36 offen
    s_add_u32 s36, s38, 54272
    buffer_load_dwordx4 a[84:87], v5, s[12:15], s36 offen
    s_add_u32 s36, s38, 38912
    buffer_load_dwordx4 a[24:27], v5, s[12:15], s36 offen
    s_add_u32 s36, s38, 55296
    buffer_load_dwordx4 a[88:91], v5, s[12:15], s36 offen
    s_add_u32 s36, s38, 39936
    buffer_load_dwordx4 a[28:31], v5, s[12:15], s36 offen
    s_add_u32 s36, s38, 56320
    buffer_load_dwordx4 a[92:95], v5, s[12:15], s36 offen
    s_add_u32 s36, s38, 40960
    buffer_load_dwordx4 a[32:35], v5, s[12:15], s36 offen
    s_add_u32 s36, s38, 57344
    buffer_load_dwordx4 a[96:99], v5, s[12:15], s36 offen
    s_add_u32 s36, s38, 41984
    buffer_load_dwordx4 a[36:39], v5, s[12:15], s36 offen
    s_add_u32 s36, s38, 58368
    buffer_load_dwordx4 a[100:103], v5, s[12:15], s36 offen
    s_add_u32 s36, s38, 43008
    buffer_load_dwordx4 a[40:43], v5, s[12:15], s36 offen
    s_add_u32 s36, s38, 59392
    buffer_load_dwordx4 a[104:107], v5, s[12:15], s36 offen
    s_add_u32 s36, s38, 44032
    buffer_load_dwordx4 a[44:47], v5, s[12:15], s36 offen
    s_add_u32 s36, s38, 60416
    buffer_load_dwordx4 a[108:111], v5, s[12:15], s36 offen
    s_add_u32 s36, s38, 45056
    buffer_load_dwordx4 a[48:51], v5, s[12:15], s36 offen
    s_add_u32 s36, s38, 61440
    buffer_load_dwordx4 a[112:115], v5, s[12:15], s36 offen
    s_add_u32 s36, s38, 46080
    buffer_load_dwordx4 a[52:55], v5, s[12:15], s36 offen
    s_add_u32 s36, s38, 62464
    buffer_load_dwordx4 a[116:119], v5, s[12:15], s36 offen
    s_add_u32 s36, s38, 47104
    buffer_load_dwordx4 a[56:59], v5, s[12:15], s36 offen
    s_add_u32 s36, s38, 63488
    buffer_load_dwordx4 a[120:123], v5, s[12:15], s36 offen
    s_add_u32 s36, s38, 48128
    buffer_load_dwordx4 a[60:63], v5, s[12:15], s36 offen
    s_add_u32 s36, s38, 64512
    buffer_load_dwordx4 a[124:127], v5, s[12:15], s36 offen
    buffer_load_dwordx4 v[96:99], v14, s[12:15], s37 offen offset:0
    buffer_load_dwordx4 v[100:103], v14, s[12:15], s37 offen offset:32
    buffer_load_dwordx4 v[104:107], v14, s[12:15], s37 offen offset:64
    buffer_load_dwordx4 v[108:111], v14, s[12:15], s37 offen offset:96
    buffer_load_dwordx4 v[112:115], v14, s[12:15], s37 offen offset:128
    buffer_load_dwordx4 v[116:119], v14, s[12:15], s37 offen offset:160
    buffer_load_dwordx4 v[120:123], v14, s[12:15], s37 offen offset:192
    buffer_load_dwordx4 v[124:127], v14, s[12:15], s37 offen offset:224
    s_branch L_joint_kernel_helper
L_joint_kernel_mpath:
    s_lshr_b32 s36, s2, 3
    s_and_b32 s36, s36, 31
    s_lshl_b32 s36, s36, 13
    s_add_u32 s36, s36, 32768
    v_lshlrev_b32 v6, 7, v1
    s_cmp_lg_u32 s20, 0
    s_cbranch_scc1 L_joint_kernel_nopf
    buffer_load_dword v7, v6, s[12:15], s36 offen
L_joint_kernel_nopf:
    v_lshrrev_b32 v2, 3, v1
    v_mul_u32_u24 v2, 1024, v2
    v_bfe_u32 v3, v1, 2, 1
    v_lshl_add_u32 v2, v3, 6, v2
    v_lshrrev_b32 v3, 5, v1
    v_lshlrev_b32 v3, 1, v3
    v_and_b32 v4, 3, v1
    v_xor_b32 v3, v3, v4
    v_lshl_add_u32 v2, v3, 4, v2
    s_lshl_b32 s34, s21, 14
    s_mul_i32 s35, s21, 256
    s_mul_i32 s33, s24, 3118080
    s_add_u32 s33, s33, 79261696
    s_add_u32 s8, s6, s33
    s_addc_u32 s9, s7, 0
    s_mov_b32 s10, 3118080
    s_mov_b32 s11, 0x00020000
    s_mov_b32 s46, 0
    s_cmp_eq_u32 s28, s29
    s_cbranch_scc1 L_joint_kernel_same
    s_mul_i32 s36, s29, 37120
    s_add_u32 s36, s36, s35
    s_add_u32 m0, s34, 8192
    s_add_u32 s37, s36, 0
    buffer_load_dwordx4 v2, s[8:11], s37 offen lds
    s_add_u32 m0, s34, 9216
    s_add_u32 s37, s36, 8192
    buffer_load_dwordx4 v2, s[8:11], s37 offen lds
    s_add_u32 m0, s34, 10240
    s_add_u32 s37, s36, 16384
    buffer_load_dwordx4 v2, s[8:11], s37 offen lds
    s_add_u32 m0, s34, 11264
    s_add_u32 s37, s36, 24576
    buffer_load_dwordx4 v2, s[8:11], s37 offen lds
    s_add_u32 m0, s34, 12288
    s_add_u32 s37, s36, 128
    buffer_load_dwordx4 v2, s[8:11], s37 offen lds
    s_add_u32 m0, s34, 13312
    s_add_u32 s37, s36, 8320
    buffer_load_dwordx4 v2, s[8:11], s37 offen lds
    s_add_u32 m0, s34, 14336
    s_add_u32 s37, s36, 16512
    buffer_load_dwordx4 v2, s[8:11], s37 offen lds
    s_add_u32 m0, s34, 15360
    s_add_u32 s37, s36, 24704
    buffer_load_dwordx4 v2, s[8:11], s37 offen lds
    s_mov_b32 s46, 8192
L_joint_kernel_same:
    s_lshl_b32 s36, s30, 11
    s_add_u32 s36, s36, 8192
    buffer_load_dwordx4 v[8:11], v5, s[12:15], s36 offen offset:0
    buffer_load_dwordx4 v[12:15], v5, s[12:15], s36 offen offset:1024
    s_lshl_b32 s36, s31, 11
    s_add_u32 s36, s36, 8192
    buffer_load_dwordx4 v[16:19], v5, s[12:15], s36 offen offset:0
    buffer_load_dwordx4 v[20:23], v5, s[12:15], s36 offen offset:1024
    s_mul_i32 s36, s28, 37120
    s_add_u32 s36, s36, s35
    s_add_u32 m0, s34, 0
    s_add_u32 s37, s36, 0
    buffer_load_dwordx4 v2, s[8:11], s37 offen lds
    s_add_u32 m0, s34, 1024
    s_add_u32 s37, s36, 8192
    buffer_load_dwordx4 v2, s[8:11], s37 offen lds
    s_add_u32 m0, s34, 2048
    s_add_u32 s37, s36, 16384
    buffer_load_dwordx4 v2, s[8:11], s37 offen lds
    s_add_u32 m0, s34, 3072
    s_add_u32 s37, s36, 24576
    buffer_load_dwordx4 v2, s[8:11], s37 offen lds
    s_add_u32 m0, s34, 4096
    s_add_u32 s37, s36, 128
    buffer_load_dwordx4 v2, s[8:11], s37 offen lds
    s_add_u32 m0, s34, 5120
    s_add_u32 s37, s36, 8320
    buffer_load_dwordx4 v2, s[8:11], s37 offen lds
    s_add_u32 m0, s34, 6144
    s_add_u32 s37, s36, 16512
    buffer_load_dwordx4 v2, s[8:11], s37 offen lds
    s_add_u32 m0, s34, 7168
    s_add_u32 s37, s36, 24704
    buffer_load_dwordx4 v2, s[8:11], s37 offen lds
    v_bfe_u32 v32, v1, 2, 2
    v_lshrrev_b32 v33, 4, v1
    v_and_b32 v34, 3, v1
    v_lshl_add_u32 v35, v33, 3, v32
    v_lshlrev_b32 v40, 6, v35
    v_and_b32 v41, 1, v33
    v_lshlrev_b32 v41, 1, v41
    v_lshrrev_b32 v42, 1, v34
    v_xor_b32 v41, v41, v42
    v_lshl_add_u32 v40, v41, 4, v40
    v_and_b32 v42, 1, v34
    v_lshl_add_u32 v40, v42, 3, v40
    v_add_u32 v36, s34, v40
    v_xor_b32 v37, 32, v36
    v_add_u32 v38, s46, v36
    v_add_u32 v39, s46, v37
    v_lshrrev_b32 v41, 1, v33
    v_lshlrev_b32 v41, 10, v41
    v_and_b32 v42, 1, v33
    v_lshl_add_u32 v41, v42, 9, v41
    v_and_b32 v42, 15, v1
    v_lshl_add_u32 v41, v42, 4, v41
    s_lshl_b32 s36, s21, 12
    s_add_u32 s36, s36, 65536
    v_add_u32 v43, s36, v41
    s_mov_b32 s40, 0xbdd2d3e8
    v_mov_b32 v44, 0xc0135761
    s_mov_b32 s41, 0xbdd2d3e8
    v_mov_b32 v45, 0xc0135761
    s_waitcnt vmcnt(4)
    ds_read_b64_tr_b16 v[48:49], v36 offset:0
    ds_read_b64_tr_b16 v[50:51], v36 offset:256
    ds_read_b64_tr_b16 v[52:53], v36 offset:2048
    ds_read_b64_tr_b16 v[54:55], v36 offset:2304
    ds_read_b64_tr_b16 v[56:57], v37 offset:0
    ds_read_b64_tr_b16 v[58:59], v37 offset:256
    ds_read_b64_tr_b16 v[60:61], v37 offset:2048
    ds_read_b64_tr_b16 v[62:63], v37 offset:2304
    s_waitcnt lgkmcnt(0)
    v_mfma_f32_16x16x32_bf16 v[64:67], v[48:51], v[8:11], 0
    v_mfma_f32_16x16x32_bf16 v[68:71], v[56:59], v[8:11], 0
    v_mfma_f32_16x16x32_bf16 v[64:67], v[52:55], v[12:15], v[64:67]
    v_mfma_f32_16x16x32_bf16 v[68:71], v[60:63], v[12:15], v[68:71]
    ds_read_b64_tr_b16 v[84:85], v38 offset:0
    ds_read_b64_tr_b16 v[86:87], v38 offset:256
    ds_read_b64_tr_b16 v[88:89], v38 offset:2048
    ds_read_b64_tr_b16 v[90:91], v38 offset:2304
    ds_read_b64_tr_b16 v[92:93], v39 offset:0
    ds_read_b64_tr_b16 v[94:95], v39 offset:256
    ds_read_b64_tr_b16 v[96:97], v39 offset:2048
    ds_read_b64_tr_b16 v[98:99], v39 offset:2304
    v_mul_f32 v72, v64, v64
    v_mul_f32 v73, v65, v65
    v_mul_f32 v74, v66, v66
    v_mul_f32 v75, v67, v67
    v_mul_f32 v76, v68, v68
    v_mul_f32 v77, v69, v69
    v_mul_f32 v78, v70, v70
    v_mul_f32 v79, v71, v71
    v_fma_f32 v72, v72, s40, v44
    v_fma_f32 v73, v73, s40, v44
    v_fma_f32 v74, v74, s40, v44
    v_fma_f32 v75, v75, s40, v44
    v_fma_f32 v76, v76, s40, v44
    v_fma_f32 v77, v77, s40, v44
    v_fma_f32 v78, v78, s40, v44
    v_fma_f32 v79, v79, s40, v44
    v_mul_f32 v72, v72, v64
    v_mul_f32 v73, v73, v65
    v_mul_f32 v74, v74, v66
    v_mul_f32 v75, v75, v67
    v_mul_f32 v76, v76, v68
    v_mul_f32 v77, v77, v69
    v_mul_f32 v78, v78, v70
    v_mul_f32 v79, v79, v71
    v_exp_f32 v72, v72
    v_exp_f32 v73, v73
    v_exp_f32 v74, v74
    v_exp_f32 v75, v75
    v_exp_f32 v76, v76
    v_exp_f32 v77, v77
    v_exp_f32 v78, v78
    v_exp_f32 v79, v79
    v_add_f32 v72, 1.0, v72
    v_add_f32 v73, 1.0, v73
    v_add_f32 v74, 1.0, v74
    v_add_f32 v75, 1.0, v75
    v_add_f32 v76, 1.0, v76
    v_add_f32 v77, 1.0, v77
    v_add_f32 v78, 1.0, v78
    v_add_f32 v79, 1.0, v79
    v_rcp_f32 v72, v72
    v_rcp_f32 v73, v73
    v_rcp_f32 v74, v74
    v_rcp_f32 v75, v75
    v_rcp_f32 v76, v76
    v_rcp_f32 v77, v77
    v_rcp_f32 v78, v78
    v_rcp_f32 v79, v79
    v_mul_f32 v64, v64, v72
    v_mul_f32 v65, v65, v73
    v_mul_f32 v66, v66, v74
    v_mul_f32 v67, v67, v75
    v_mul_f32 v68, v68, v76
    v_mul_f32 v69, v69, v77
    v_mul_f32 v70, v70, v78
    v_mul_f32 v71, v71, v79
    v_cvt_pk_bf16_f32 v80, v64, v65
    v_cvt_pk_bf16_f32 v81, v66, v67
    v_cvt_pk_bf16_f32 v82, v68, v69
    v_cvt_pk_bf16_f32 v83, v70, v71
    ds_write_b128 v43, v[80:83] offset:0
    s_waitcnt vmcnt(0)
    s_waitcnt lgkmcnt(1)
    v_mfma_f32_16x16x32_bf16 v[100:103], v[84:87], v[16:19], 0
    v_mfma_f32_16x16x32_bf16 v[104:107], v[92:95], v[16:19], 0
    v_mfma_f32_16x16x32_bf16 v[100:103], v[88:91], v[20:23], v[100:103]
    v_mfma_f32_16x16x32_bf16 v[104:107], v[96:99], v[20:23], v[104:107]
    ds_read_b64_tr_b16 v[48:49], v36 offset:4096
    ds_read_b64_tr_b16 v[50:51], v36 offset:4352
    ds_read_b64_tr_b16 v[52:53], v36 offset:6144
    ds_read_b64_tr_b16 v[54:55], v36 offset:6400
    ds_read_b64_tr_b16 v[56:57], v37 offset:4096
    ds_read_b64_tr_b16 v[58:59], v37 offset:4352
    ds_read_b64_tr_b16 v[60:61], v37 offset:6144
    ds_read_b64_tr_b16 v[62:63], v37 offset:6400
    v_mul_f32 v72, v100, v100
    v_mul_f32 v73, v101, v101
    v_mul_f32 v74, v102, v102
    v_mul_f32 v75, v103, v103
    v_mul_f32 v76, v104, v104
    v_mul_f32 v77, v105, v105
    v_mul_f32 v78, v106, v106
    v_mul_f32 v79, v107, v107
    v_fma_f32 v72, v72, s40, v44
    v_fma_f32 v73, v73, s40, v44
    v_fma_f32 v74, v74, s40, v44
    v_fma_f32 v75, v75, s40, v44
    v_fma_f32 v76, v76, s40, v44
    v_fma_f32 v77, v77, s40, v44
    v_fma_f32 v78, v78, s40, v44
    v_fma_f32 v79, v79, s40, v44
    v_mul_f32 v72, v72, v100
    v_mul_f32 v73, v73, v101
    v_mul_f32 v74, v74, v102
    v_mul_f32 v75, v75, v103
    v_mul_f32 v76, v76, v104
    v_mul_f32 v77, v77, v105
    v_mul_f32 v78, v78, v106
    v_mul_f32 v79, v79, v107
    v_exp_f32 v72, v72
    v_exp_f32 v73, v73
    v_exp_f32 v74, v74
    v_exp_f32 v75, v75
    v_exp_f32 v76, v76
    v_exp_f32 v77, v77
    v_exp_f32 v78, v78
    v_exp_f32 v79, v79
    v_add_f32 v72, 1.0, v72
    v_add_f32 v73, 1.0, v73
    v_add_f32 v74, 1.0, v74
    v_add_f32 v75, 1.0, v75
    v_add_f32 v76, 1.0, v76
    v_add_f32 v77, 1.0, v77
    v_add_f32 v78, 1.0, v78
    v_add_f32 v79, 1.0, v79
    v_rcp_f32 v72, v72
    v_rcp_f32 v73, v73
    v_rcp_f32 v74, v74
    v_rcp_f32 v75, v75
    v_rcp_f32 v76, v76
    v_rcp_f32 v77, v77
    v_rcp_f32 v78, v78
    v_rcp_f32 v79, v79
    v_mul_f32 v100, v100, v72
    v_mul_f32 v101, v101, v73
    v_mul_f32 v102, v102, v74
    v_mul_f32 v103, v103, v75
    v_mul_f32 v104, v104, v76
    v_mul_f32 v105, v105, v77
    v_mul_f32 v106, v106, v78
    v_mul_f32 v107, v107, v79
    v_cvt_pk_bf16_f32 v108, v100, v101
    v_cvt_pk_bf16_f32 v109, v102, v103
    v_cvt_pk_bf16_f32 v110, v104, v105
    v_cvt_pk_bf16_f32 v111, v106, v107
    ds_write_b128 v43, v[108:111] offset:256
    s_waitcnt lgkmcnt(1)
    v_mfma_f32_16x16x32_bf16 v[64:67], v[48:51], v[8:11], 0
    v_mfma_f32_16x16x32_bf16 v[68:71], v[56:59], v[8:11], 0
    v_mfma_f32_16x16x32_bf16 v[64:67], v[52:55], v[12:15], v[64:67]
    v_mfma_f32_16x16x32_bf16 v[68:71], v[60:63], v[12:15], v[68:71]
    ds_read_b64_tr_b16 v[84:85], v38 offset:4096
    ds_read_b64_tr_b16 v[86:87], v38 offset:4352
    ds_read_b64_tr_b16 v[88:89], v38 offset:6144
    ds_read_b64_tr_b16 v[90:91], v38 offset:6400
    ds_read_b64_tr_b16 v[92:93], v39 offset:4096
    ds_read_b64_tr_b16 v[94:95], v39 offset:4352
    ds_read_b64_tr_b16 v[96:97], v39 offset:6144
    ds_read_b64_tr_b16 v[98:99], v39 offset:6400
    v_mul_f32 v72, v64, v64
    v_mul_f32 v73, v65, v65
    v_mul_f32 v74, v66, v66
    v_mul_f32 v75, v67, v67
    v_mul_f32 v76, v68, v68
    v_mul_f32 v77, v69, v69
    v_mul_f32 v78, v70, v70
    v_mul_f32 v79, v71, v71
    v_fma_f32 v72, v72, s40, v44
    v_fma_f32 v73, v73, s40, v44
    v_fma_f32 v74, v74, s40, v44
    v_fma_f32 v75, v75, s40, v44
    v_fma_f32 v76, v76, s40, v44
    v_fma_f32 v77, v77, s40, v44
    v_fma_f32 v78, v78, s40, v44
    v_fma_f32 v79, v79, s40, v44
    v_mul_f32 v72, v72, v64
    v_mul_f32 v73, v73, v65
    v_mul_f32 v74, v74, v66
    v_mul_f32 v75, v75, v67
    v_mul_f32 v76, v76, v68
    v_mul_f32 v77, v77, v69
    v_mul_f32 v78, v78, v70
    v_mul_f32 v79, v79, v71
    v_exp_f32 v72, v72
    v_exp_f32 v73, v73
    v_exp_f32 v74, v74
    v_exp_f32 v75, v75
    v_exp_f32 v76, v76
    v_exp_f32 v77, v77
    v_exp_f32 v78, v78
    v_exp_f32 v79, v79
    v_add_f32 v72, 1.0, v72
    v_add_f32 v73, 1.0, v73
    v_add_f32 v74, 1.0, v74
    v_add_f32 v75, 1.0, v75
    v_add_f32 v76, 1.0, v76
    v_add_f32 v77, 1.0, v77
    v_add_f32 v78, 1.0, v78
    v_add_f32 v79, 1.0, v79
    v_rcp_f32 v72, v72
    v_rcp_f32 v73, v73
    v_rcp_f32 v74, v74
    v_rcp_f32 v75, v75
    v_rcp_f32 v76, v76
    v_rcp_f32 v77, v77
    v_rcp_f32 v78, v78
    v_rcp_f32 v79, v79
    v_mul_f32 v64, v64, v72
    v_mul_f32 v65, v65, v73
    v_mul_f32 v66, v66, v74
    v_mul_f32 v67, v67, v75
    v_mul_f32 v68, v68, v76
    v_mul_f32 v69, v69, v77
    v_mul_f32 v70, v70, v78
    v_mul_f32 v71, v71, v79
    v_cvt_pk_bf16_f32 v80, v64, v65
    v_cvt_pk_bf16_f32 v81, v66, v67
    v_cvt_pk_bf16_f32 v82, v68, v69
    v_cvt_pk_bf16_f32 v83, v70, v71
    ds_write_b128 v43, v[80:83] offset:2048
    s_waitcnt lgkmcnt(1)
    v_mfma_f32_16x16x32_bf16 v[100:103], v[84:87], v[16:19], 0
    v_mfma_f32_16x16x32_bf16 v[104:107], v[92:95], v[16:19], 0
    v_mfma_f32_16x16x32_bf16 v[100:103], v[88:91], v[20:23], v[100:103]
    v_mfma_f32_16x16x32_bf16 v[104:107], v[96:99], v[20:23], v[104:107]
    s_nop 7
    v_mul_f32 v72, v100, v100
    v_mul_f32 v73, v101, v101
    v_mul_f32 v74, v102, v102
    v_mul_f32 v75, v103, v103
    v_mul_f32 v76, v104, v104
    v_mul_f32 v77, v105, v105
    v_mul_f32 v78, v106, v106
    v_mul_f32 v79, v107, v107
    v_fma_f32 v72, v72, s40, v44
    v_fma_f32 v73, v73, s40, v44
    v_fma_f32 v74, v74, s40, v44
    v_fma_f32 v75, v75, s40, v44
    v_fma_f32 v76, v76, s40, v44
    v_fma_f32 v77, v77, s40, v44
    v_fma_f32 v78, v78, s40, v44
    v_fma_f32 v79, v79, s40, v44
    v_mul_f32 v72, v72, v100
    v_mul_f32 v73, v73, v101
    v_mul_f32 v74, v74, v102
    v_mul_f32 v75, v75, v103
    v_mul_f32 v76, v76, v104
    v_mul_f32 v77, v77, v105
    v_mul_f32 v78, v78, v106
    v_mul_f32 v79, v79, v107
    v_exp_f32 v72, v72
    v_exp_f32 v73, v73
    v_exp_f32 v74, v74
    v_exp_f32 v75, v75
    v_exp_f32 v76, v76
    v_exp_f32 v77, v77
    v_exp_f32 v78, v78
    v_exp_f32 v79, v79
    v_add_f32 v72, 1.0, v72
    v_add_f32 v73, 1.0, v73
    v_add_f32 v74, 1.0, v74
    v_add_f32 v75, 1.0, v75
    v_add_f32 v76, 1.0, v76
    v_add_f32 v77, 1.0, v77
    v_add_f32 v78, 1.0, v78
    v_add_f32 v79, 1.0, v79
    v_rcp_f32 v72, v72
    v_rcp_f32 v73, v73
    v_rcp_f32 v74, v74
    v_rcp_f32 v75, v75
    v_rcp_f32 v76, v76
    v_rcp_f32 v77, v77
    v_rcp_f32 v78, v78
    v_rcp_f32 v79, v79
    v_mul_f32 v100, v100, v72
    v_mul_f32 v101, v101, v73
    v_mul_f32 v102, v102, v74
    v_mul_f32 v103, v103, v75
    v_mul_f32 v104, v104, v76
    v_mul_f32 v105, v105, v77
    v_mul_f32 v106, v106, v78
    v_mul_f32 v107, v107, v79
    v_cvt_pk_bf16_f32 v108, v100, v101
    v_cvt_pk_bf16_f32 v109, v102, v103
    v_cvt_pk_bf16_f32 v110, v104, v105
    v_cvt_pk_bf16_f32 v111, v106, v107
    ds_write_b128 v43, v[108:111] offset:2304
    s_waitcnt lgkmcnt(0)
    s_barrier
    v_and_b32 v46, 31, v1
    v_mul_u32_u24 v47, 528, v46
    v_lshrrev_b32 v45, 5, v1
    v_lshl_add_u32 v47, v45, 4, v47
    s_lshl_b32 s36, s21, 7
    s_add_u32 s36, s36, 115712
    v_add_u32 v6, s36, v47
    v_lshlrev_b32 v7, 6, v45
    s_lshl_b32 s36, s21, 8
    s_add_u32 s36, s36, 14336
    buffer_load_dwordx4 v[72:75], v7, s[12:15], s36 offen offset:0
    buffer_load_dwordx4 v[76:79], v7, s[12:15], s36 offen offset:16
    buffer_load_dwordx4 v[80:83], v7, s[12:15], s36 offen offset:32
    buffer_load_dwordx4 v[84:87], v7, s[12:15], s36 offen offset:48
    buffer_load_dwordx4 v[88:91], v7, s[12:15], s36 offen offset:128
    buffer_load_dwordx4 v[92:95], v7, s[12:15], s36 offen offset:144
    buffer_load_dwordx4 v[96:99], v7, s[12:15], s36 offen offset:160
    buffer_load_dwordx4 v[100:103], v7, s[12:15], s36 offen offset:176
    s_add_u32 s36, s38, 163840
    buffer_load_dwordx4 a[0:3], v5, s[12:15], s36 offen
    s_add_u32 s36, s38, 180224
    buffer_load_dwordx4 a[64:67], v5, s[12:15], s36 offen
    s_add_u32 s36, s38, 164864
    buffer_load_dwordx4 a[4:7], v5, s[12:15], s36 offen
    s_add_u32 s36, s38, 181248
    buffer_load_dwordx4 a[68:71], v5, s[12:15], s36 offen
    s_add_u32 s36, s38, 165888
    buffer_load_dwordx4 a[8:11], v5, s[12:15], s36 offen
    s_add_u32 s36, s38, 182272
    buffer_load_dwordx4 a[72:75], v5, s[12:15], s36 offen
    s_add_u32 s36, s38, 166912
    buffer_load_dwordx4 a[12:15], v5, s[12:15], s36 offen
    s_add_u32 s36, s38, 183296
    buffer_load_dwordx4 a[76:79], v5, s[12:15], s36 offen
    s_add_u32 s36, s38, 167936
    buffer_load_dwordx4 a[16:19], v5, s[12:15], s36 offen
    s_add_u32 s36, s38, 184320
    buffer_load_dwordx4 a[80:83], v5, s[12:15], s36 offen
    s_add_u32 s36, s38, 168960
    buffer_load_dwordx4 a[20:23], v5, s[12:15], s36 offen
    s_add_u32 s36, s38, 185344
    buffer_load_dwordx4 a[84:87], v5, s[12:15], s36 offen
    s_add_u32 s36, s38, 169984
    buffer_load_dwordx4 a[24:27], v5, s[12:15], s36 offen
    s_add_u32 s36, s38, 186368
    buffer_load_dwordx4 a[88:91], v5, s[12:15], s36 offen
    s_add_u32 s36, s38, 171008
    buffer_load_dwordx4 a[28:31], v5, s[12:15], s36 offen
    s_add_u32 s36, s38, 187392
    buffer_load_dwordx4 a[92:95], v5, s[12:15], s36 offen
    s_add_u32 s36, s38, 172032
    buffer_load_dwordx4 a[32:35], v5, s[12:15], s36 offen
    s_add_u32 s36, s38, 188416
    buffer_load_dwordx4 a[96:99], v5, s[12:15], s36 offen
    s_add_u32 s36, s38, 173056
    buffer_load_dwordx4 a[36:39], v5, s[12:15], s36 offen
    s_add_u32 s36, s38, 189440
    buffer_load_dwordx4 a[100:103], v5, s[12:15], s36 offen
    s_add_u32 s36, s38, 174080
    buffer_load_dwordx4 a[40:43], v5, s[12:15], s36 offen
    s_add_u32 s36, s38, 190464
    buffer_load_dwordx4 a[104:107], v5, s[12:15], s36 offen
    s_add_u32 s36, s38, 175104
    buffer_load_dwordx4 a[44:47], v5, s[12:15], s36 offen
    s_add_u32 s36, s38, 191488
    buffer_load_dwordx4 a[108:111], v5, s[12:15], s36 offen
    s_add_u32 s36, s38, 176128
    buffer_load_dwordx4 a[48:51], v5, s[12:15], s36 offen
    s_add_u32 s36, s38, 192512
    buffer_load_dwordx4 a[112:115], v5, s[12:15], s36 offen
    s_add_u32 s36, s38, 177152
    buffer_load_dwordx4 a[52:55], v5, s[12:15], s36 offen
    s_add_u32 s36, s38, 193536
    buffer_load_dwordx4 a[116:119], v5, s[12:15], s36 offen
    s_add_u32 s36, s38, 178176
    buffer_load_dwordx4 a[56:59], v5, s[12:15], s36 offen
    s_add_u32 s36, s38, 194560
    buffer_load_dwordx4 a[120:123], v5, s[12:15], s36 offen
    s_add_u32 s36, s38, 179200
    buffer_load_dwordx4 a[60:63], v5, s[12:15], s36 offen
    s_add_u32 s36, s38, 195584
    buffer_load_dwordx4 a[124:127], v5, s[12:15], s36 offen
    s_setprio 1
    s_barrier
    ds_read_b128 v[104:107], v5 offset:0
    ds_read_b128 v[108:111], v5 offset:1024
    ds_read_b128 v[112:115], v5 offset:2048
    s_waitcnt lgkmcnt(2)
    s_waitcnt vmcnt(30)
    v_mfma_f32_32x32x16_bf16 v[8:23], a[0:3], v[104:107], v[72:87]
    ds_read_b128 v[116:119], v5 offset:3072
    v_mfma_f32_32x32x16_bf16 v[24:39], a[64:67], v[104:107], v[88:103]
    s_waitcnt lgkmcnt(2)
    s_waitcnt vmcnt(28)
    v_mfma_f32_32x32x16_bf16 v[8:23], a[4:7], v[108:111], v[8:23]
    ds_read_b128 v[104:107], v5 offset:4096
    v_mfma_f32_32x32x16_bf16 v[24:39], a[68:71], v[108:111], v[24:39]
    s_waitcnt lgkmcnt(2)
    s_waitcnt vmcnt(26)
    v_mfma_f32_32x32x16_bf16 v[8:23], a[8:11], v[112:115], v[8:23]
    ds_read_b128 v[108:111], v5 offset:5120
    v_mfma_f32_32x32x16_bf16 v[24:39], a[72:75], v[112:115], v[24:39]
    s_waitcnt lgkmcnt(2)
    s_waitcnt vmcnt(24)
    v_mfma_f32_32x32x16_bf16 v[8:23], a[12:15], v[116:119], v[8:23]
    ds_read_b128 v[112:115], v5 offset:6144
    v_mfma_f32_32x32x16_bf16 v[24:39], a[76:79], v[116:119], v[24:39]
    s_waitcnt lgkmcnt(2)
    s_waitcnt vmcnt(22)
    v_mfma_f32_32x32x16_bf16 v[8:23], a[16:19], v[104:107], v[8:23]
    ds_read_b128 v[116:119], v5 offset:7168
    v_mfma_f32_32x32x16_bf16 v[24:39], a[80:83], v[104:107], v[24:39]
    s_waitcnt lgkmcnt(2)
    s_waitcnt vmcnt(20)
    v_mfma_f32_32x32x16_bf16 v[8:23], a[20:23], v[108:111], v[8:23]
    ds_read_b128 v[104:107], v5 offset:8192
    v_mfma_f32_32x32x16_bf16 v[24:39], a[84:87], v[108:111], v[24:39]
    s_waitcnt lgkmcnt(2)
    s_waitcnt vmcnt(18)
    v_mfma_f32_32x32x16_bf16 v[8:23], a[24:27], v[112:115], v[8:23]
    ds_read_b128 v[108:111], v5 offset:9216
    v_mfma_f32_32x32x16_bf16 v[24:39], a[88:91], v[112:115], v[24:39]
    s_waitcnt lgkmcnt(2)
    s_waitcnt vmcnt(16)
    v_mfma_f32_32x32x16_bf16 v[8:23], a[28:31], v[116:119], v[8:23]
    ds_read_b128 v[112:115], v5 offset:10240
    v_mfma_f32_32x32x16_bf16 v[24:39], a[92:95], v[116:119], v[24:39]
    s_waitcnt lgkmcnt(2)
    s_waitcnt vmcnt(14)
    v_mfma_f32_32x32x16_bf16 v[8:23], a[32:35], v[104:107], v[8:23]
    ds_read_b128 v[116:119], v5 offset:11264
    v_mfma_f32_32x32x16_bf16 v[24:39], a[96:99], v[104:107], v[24:39]
    s_waitcnt lgkmcnt(2)
    s_waitcnt vmcnt(12)
    v_mfma_f32_32x32x16_bf16 v[8:23], a[36:39], v[108:111], v[8:23]
    ds_read_b128 v[104:107], v5 offset:12288
    v_mfma_f32_32x32x16_bf16 v[24:39], a[100:103], v[108:111], v[24:39]
    s_waitcnt lgkmcnt(2)
    s_waitcnt vmcnt(10)
    v_mfma_f32_32x32x16_bf16 v[8:23], a[40:43], v[112:115], v[8:23]
    ds_read_b128 v[108:111], v5 offset:13312
    v_mfma_f32_32x32x16_bf16 v[24:39], a[104:107], v[112:115], v[24:39]
    s_waitcnt lgkmcnt(2)
    s_waitcnt vmcnt(8)
    v_mfma_f32_32x32x16_bf16 v[8:23], a[44:47], v[116:119], v[8:23]
    ds_read_b128 v[112:115], v5 offset:14336
    v_mfma_f32_32x32x16_bf16 v[24:39], a[108:111], v[116:119], v[24:39]
    s_waitcnt lgkmcnt(2)
    s_waitcnt vmcnt(6)
    v_mfma_f32_32x32x16_bf16 v[8:23], a[48:51], v[104:107], v[8:23]
    ds_read_b128 v[116:119], v5 offset:15360
    v_mfma_f32_32x32x16_bf16 v[24:39], a[112:115], v[104:107], v[24:39]
    s_waitcnt lgkmcnt(2)
    s_waitcnt vmcnt(4)
    v_mfma_f32_32x32x16_bf16 v[8:23], a[52:55], v[108:111], v[8:23]
    ds_read_b128 v[104:107], v5 offset:16384
    v_mfma_f32_32x32x16_bf16 v[24:39], a[116:119], v[108:111], v[24:39]
    s_waitcnt lgkmcnt(2)
    s_waitcnt vmcnt(2)
    v_mfma_f32_32x32x16_bf16 v[8:23], a[56:59], v[112:115], v[8:23]
    ds_read_b128 v[108:111], v5 offset:17408
    v_mfma_f32_32x32x16_bf16 v[24:39], a[120:123], v[112:115], v[24:39]
    s_waitcnt lgkmcnt(2)
    s_waitcnt vmcnt(0)
    v_mfma_f32_32x32x16_bf16 v[8:23], a[60:63], v[116:119], v[8:23]
    ds_read_b128 v[112:115], v5 offset:18432
    v_mfma_f32_32x32x16_bf16 v[24:39], a[124:127], v[116:119], v[24:39]
    s_barrier
    s_waitcnt lgkmcnt(2)
    v_mfma_f32_32x32x16_bf16 v[40:55], a[0:3], v[104:107], v[72:87]
    ds_read_b128 v[116:119], v5 offset:19456
    v_mfma_f32_32x32x16_bf16 v[56:71], a[64:67], v[104:107], v[88:103]
    s_waitcnt lgkmcnt(2)
    v_mfma_f32_32x32x16_bf16 v[40:55], a[4:7], v[108:111], v[40:55]
    ds_read_b128 v[104:107], v5 offset:20480
    v_mfma_f32_32x32x16_bf16 v[56:71], a[68:71], v[108:111], v[56:71]
    s_waitcnt lgkmcnt(2)
    v_mfma_f32_32x32x16_bf16 v[40:55], a[8:11], v[112:115], v[40:55]
    ds_read_b128 v[108:111], v5 offset:21504
    v_cvt_pk_bf16_f32 v120, v8, v9
    v_mfma_f32_32x32x16_bf16 v[56:71], a[72:75], v[112:115], v[56:71]
    v_cvt_pk_bf16_f32 v121, v10, v11
    s_waitcnt lgkmcnt(2)
    v_mfma_f32_32x32x16_bf16 v[40:55], a[12:15], v[116:119], v[40:55]
    ds_read_b128 v[112:115], v5 offset:22528
    v_cvt_pk_bf16_f32 v122, v12, v13
    v_mfma_f32_32x32x16_bf16 v[56:71], a[76:79], v[116:119], v[56:71]
    v_cvt_pk_bf16_f32 v123, v14, v15
    s_waitcnt lgkmcnt(2)
    v_mfma_f32_32x32x16_bf16 v[40:55], a[16:19], v[104:107], v[40:55]
    ds_read_b128 v[116:119], v5 offset:23552
    ds_write_b128 v6, v[120:123] offset:0
    v_mfma_f32_32x32x16_bf16 v[56:71], a[80:83], v[104:107], v[56:71]
    v_cvt_pk_bf16_f32 v124, v16, v17
    s_waitcnt lgkmcnt(3)
    v_mfma_f32_32x32x16_bf16 v[40:55], a[20:23], v[108:111], v[40:55]
    ds_read_b128 v[104:107], v5 offset:24576
    v_cvt_pk_bf16_f32 v125, v18, v19
    v_mfma_f32_32x32x16_bf16 v[56:71], a[84:87], v[108:111], v[56:71]
    v_cvt_pk_bf16_f32 v126, v20, v21
    s_waitcnt lgkmcnt(3)
    v_mfma_f32_32x32x16_bf16 v[40:55], a[24:27], v[112:115], v[40:55]
    ds_read_b128 v[108:111], v5 offset:25600
    v_cvt_pk_bf16_f32 v127, v22, v23
    v_mfma_f32_32x32x16_bf16 v[56:71], a[88:91], v[112:115], v[56:71]
    ds_write_b128 v6, v[124:127] offset:32
    s_waitcnt lgkmcnt(4)
    v_mfma_f32_32x32x16_bf16 v[40:55], a[28:31], v[116:119], v[40:55]
    ds_read_b128 v[112:115], v5 offset:26624
    v_cvt_pk_bf16_f32 v120, v24, v25
    v_mfma_f32_32x32x16_bf16 v[56:71], a[92:95], v[116:119], v[56:71]
    v_cvt_pk_bf16_f32 v121, v26, v27
    s_waitcnt lgkmcnt(3)
    v_mfma_f32_32x32x16_bf16 v[40:55], a[32:35], v[104:107], v[40:55]
    ds_read_b128 v[116:119], v5 offset:27648
    v_cvt_pk_bf16_f32 v122, v28, v29
    v_mfma_f32_32x32x16_bf16 v[56:71], a[96:99], v[104:107], v[56:71]
    v_cvt_pk_bf16_f32 v123, v30, v31
    s_waitcnt lgkmcnt(3)
    v_mfma_f32_32x32x16_bf16 v[40:55], a[36:39], v[108:111], v[40:55]
    ds_read_b128 v[104:107], v5 offset:28672
    ds_write_b128 v6, v[120:123] offset:64
    v_mfma_f32_32x32x16_bf16 v[56:71], a[100:103], v[108:111], v[56:71]
    v_cvt_pk_bf16_f32 v124, v32, v33
    s_waitcnt lgkmcnt(3)
    v_mfma_f32_32x32x16_bf16 v[40:55], a[40:43], v[112:115], v[40:55]
    ds_read_b128 v[108:111], v5 offset:29696
    v_cvt_pk_bf16_f32 v125, v34, v35
    v_mfma_f32_32x32x16_bf16 v[56:71], a[104:107], v[112:115], v[56:71]
    v_cvt_pk_bf16_f32 v126, v36, v37
    s_waitcnt lgkmcnt(3)
    v_mfma_f32_32x32x16_bf16 v[40:55], a[44:47], v[116:119], v[40:55]
    ds_read_b128 v[112:115], v5 offset:30720
    v_cvt_pk_bf16_f32 v127, v38, v39
    v_mfma_f32_32x32x16_bf16 v[56:71], a[108:111], v[116:119], v[56:71]
    ds_write_b128 v6, v[124:127] offset:96
    s_waitcnt lgkmcnt(4)
    v_mfma_f32_32x32x16_bf16 v[40:55], a[48:51], v[104:107], v[40:55]
    ds_read_b128 v[116:119], v5 offset:31744
    v_mfma_f32_32x32x16_bf16 v[56:71], a[112:115], v[104:107], v[56:71]
    s_waitcnt lgkmcnt(3)
    v_mfma_f32_32x32x16_bf16 v[40:55], a[52:55], v[108:111], v[40:55]
    ds_read_b128 v[104:107], v5 offset:32768
    v_mfma_f32_32x32x16_bf16 v[56:71], a[116:119], v[108:111], v[56:71]
    s_waitcnt lgkmcnt(3)
    v_mfma_f32_32x32x16_bf16 v[40:55], a[56:59], v[112:115], v[40:55]
    ds_read_b128 v[108:111], v5 offset:33792
    v_mfma_f32_32x32x16_bf16 v[56:71], a[120:123], v[112:115], v[56:71]
    s_waitcnt lgkmcnt(2)
    v_mfma_f32_32x32x16_bf16 v[40:55], a[60:63], v[116:119], v[40:55]
    ds_read_b128 v[112:115], v5 offset:34816
    v_mfma_f32_32x32x16_bf16 v[56:71], a[124:127], v[116:119], v[56:71]
    s_barrier
    s_waitcnt lgkmcnt(2)
    v_mfma_f32_32x32x16_bf16 v[8:23], a[0:3], v[104:107], v[72:87]
    ds_read_b128 v[116:119], v5 offset:35840
    v_mfma_f32_32x32x16_bf16 v[24:39], a[64:67], v[104:107], v[88:103]
    s_waitcnt lgkmcnt(2)
    v_mfma_f32_32x32x16_bf16 v[8:23], a[4:7], v[108:111], v[8:23]
    ds_read_b128 v[104:107], v5 offset:36864
    v_mfma_f32_32x32x16_bf16 v[24:39], a[68:71], v[108:111], v[24:39]
    s_waitcnt lgkmcnt(2)
    v_mfma_f32_32x32x16_bf16 v[8:23], a[8:11], v[112:115], v[8:23]
    ds_read_b128 v[108:111], v5 offset:37888
    v_cvt_pk_bf16_f32 v120, v40, v41
    v_mfma_f32_32x32x16_bf16 v[24:39], a[72:75], v[112:115], v[24:39]
    v_cvt_pk_bf16_f32 v121, v42, v43
    s_waitcnt lgkmcnt(2)
    v_mfma_f32_32x32x16_bf16 v[8:23], a[12:15], v[116:119], v[8:23]
    ds_read_b128 v[112:115], v5 offset:38912
    v_cvt_pk_bf16_f32 v122, v44, v45
    v_mfma_f32_32x32x16_bf16 v[24:39], a[76:79], v[116:119], v[24:39]
    v_cvt_pk_bf16_f32 v123, v46, v47
    s_waitcnt lgkmcnt(2)
    v_mfma_f32_32x32x16_bf16 v[8:23], a[16:19], v[104:107], v[8:23]
    ds_read_b128 v[116:119], v5 offset:39936
    ds_write_b128 v6, v[120:123] offset:16896
    v_mfma_f32_32x32x16_bf16 v[24:39], a[80:83], v[104:107], v[24:39]
    v_cvt_pk_bf16_f32 v124, v48, v49
    s_waitcnt lgkmcnt(3)
    v_mfma_f32_32x32x16_bf16 v[8:23], a[20:23], v[108:111], v[8:23]
    ds_read_b128 v[104:107], v5 offset:40960
    v_cvt_pk_bf16_f32 v125, v50, v51
    v_mfma_f32_32x32x16_bf16 v[24:39], a[84:87], v[108:111], v[24:39]
    v_cvt_pk_bf16_f32 v126, v52, v53
    s_waitcnt lgkmcnt(3)
    v_mfma_f32_32x32x16_bf16 v[8:23], a[24:27], v[112:115], v[8:23]
    ds_read_b128 v[108:111], v5 offset:41984
    v_cvt_pk_bf16_f32 v127, v54, v55
    v_mfma_f32_32x32x16_bf16 v[24:39], a[88:91], v[112:115], v[24:39]
    ds_write_b128 v6, v[124:127] offset:16928
    s_waitcnt lgkmcnt(4)
    v_mfma_f32_32x32x16_bf16 v[8:23], a[28:31], v[116:119], v[8:23]
    ds_read_b128 v[112:115], v5 offset:43008
    v_cvt_pk_bf16_f32 v120, v56, v57
    v_mfma_f32_32x32x16_bf16 v[24:39], a[92:95], v[116:119], v[24:39]
    v_cvt_pk_bf16_f32 v121, v58, v59
    s_waitcnt lgkmcnt(3)
    v_mfma_f32_32x32x16_bf16 v[8:23], a[32:35], v[104:107], v[8:23]
    ds_read_b128 v[116:119], v5 offset:44032
    v_cvt_pk_bf16_f32 v122, v60, v61
    v_mfma_f32_32x32x16_bf16 v[24:39], a[96:99], v[104:107], v[24:39]
    v_cvt_pk_bf16_f32 v123, v62, v63
    s_waitcnt lgkmcnt(3)
    v_mfma_f32_32x32x16_bf16 v[8:23], a[36:39], v[108:111], v[8:23]
    ds_read_b128 v[104:107], v5 offset:45056
    ds_write_b128 v6, v[120:123] offset:16960
    v_mfma_f32_32x32x16_bf16 v[24:39], a[100:103], v[108:111], v[24:39]
    v_cvt_pk_bf16_f32 v124, v64, v65
    s_waitcnt lgkmcnt(3)
    v_mfma_f32_32x32x16_bf16 v[8:23], a[40:43], v[112:115], v[8:23]
    ds_read_b128 v[108:111], v5 offset:46080
    v_cvt_pk_bf16_f32 v125, v66, v67
    v_mfma_f32_32x32x16_bf16 v[24:39], a[104:107], v[112:115], v[24:39]
    v_cvt_pk_bf16_f32 v126, v68, v69
    s_waitcnt lgkmcnt(3)
    v_mfma_f32_32x32x16_bf16 v[8:23], a[44:47], v[116:119], v[8:23]
    ds_read_b128 v[112:115], v5 offset:47104
    v_cvt_pk_bf16_f32 v127, v70, v71
    v_mfma_f32_32x32x16_bf16 v[24:39], a[108:111], v[116:119], v[24:39]
    ds_write_b128 v6, v[124:127] offset:16992
    s_waitcnt lgkmcnt(4)
    v_mfma_f32_32x32x16_bf16 v[8:23], a[48:51], v[104:107], v[8:23]
    ds_read_b128 v[116:119], v5 offset:48128
    v_mfma_f32_32x32x16_bf16 v[24:39], a[112:115], v[104:107], v[24:39]
    s_waitcnt lgkmcnt(3)
    v_mfma_f32_32x32x16_bf16 v[8:23], a[52:55], v[108:111], v[8:23]
    ds_read_b128 v[104:107], v5 offset:0
    v_mfma_f32_32x32x16_bf16 v[24:39], a[116:119], v[108:111], v[24:39]
    s_waitcnt lgkmcnt(3)
    v_mfma_f32_32x32x16_bf16 v[8:23], a[56:59], v[112:115], v[8:23]
    ds_read_b128 v[108:111], v5 offset:1024
    v_mfma_f32_32x32x16_bf16 v[24:39], a[120:123], v[112:115], v[24:39]
    s_waitcnt lgkmcnt(2)
    v_mfma_f32_32x32x16_bf16 v[8:23], a[60:63], v[116:119], v[8:23]
    ds_read_b128 v[112:115], v5 offset:2048
    v_mfma_f32_32x32x16_bf16 v[24:39], a[124:127], v[116:119], v[24:39]
    s_barrier
    s_waitcnt lgkmcnt(2)
    v_mfma_f32_32x32x16_bf16 v[40:55], a[0:3], v[104:107], v[72:87]
    ds_read_b128 v[116:119], v5 offset:3072
    v_mfma_f32_32x32x16_bf16 v[56:71], a[64:67], v[104:107], v[88:103]
    s_waitcnt lgkmcnt(2)
    v_mfma_f32_32x32x16_bf16 v[40:55], a[4:7], v[108:111], v[40:55]
    ds_read_b128 v[104:107], v5 offset:4096
    v_mfma_f32_32x32x16_bf16 v[56:71], a[68:71], v[108:111], v[56:71]
    s_waitcnt lgkmcnt(2)
    v_mfma_f32_32x32x16_bf16 v[40:55], a[8:11], v[112:115], v[40:55]
    ds_read_b128 v[108:111], v5 offset:5120
    v_cvt_pk_bf16_f32 v120, v8, v9
    v_mfma_f32_32x32x16_bf16 v[56:71], a[72:75], v[112:115], v[56:71]
    v_cvt_pk_bf16_f32 v121, v10, v11
    s_waitcnt lgkmcnt(2)
    v_mfma_f32_32x32x16_bf16 v[40:55], a[12:15], v[116:119], v[40:55]
    ds_read_b128 v[112:115], v5 offset:6144
    v_cvt_pk_bf16_f32 v122, v12, v13
    v_mfma_f32_32x32x16_bf16 v[56:71], a[76:79], v[116:119], v[56:71]
    v_cvt_pk_bf16_f32 v123, v14, v15
    s_waitcnt lgkmcnt(2)
    v_mfma_f32_32x32x16_bf16 v[40:55], a[16:19], v[104:107], v[40:55]
    ds_read_b128 v[116:119], v5 offset:7168
    ds_write_b128 v6, v[120:123] offset:0
    v_mfma_f32_32x32x16_bf16 v[56:71], a[80:83], v[104:107], v[56:71]
    v_cvt_pk_bf16_f32 v124, v16, v17
    s_waitcnt lgkmcnt(3)
    v_mfma_f32_32x32x16_bf16 v[40:55], a[20:23], v[108:111], v[40:55]
    ds_read_b128 v[104:107], v5 offset:8192
    v_cvt_pk_bf16_f32 v125, v18, v19
    v_mfma_f32_32x32x16_bf16 v[56:71], a[84:87], v[108:111], v[56:71]
    v_cvt_pk_bf16_f32 v126, v20, v21
    s_waitcnt lgkmcnt(3)
    v_mfma_f32_32x32x16_bf16 v[40:55], a[24:27], v[112:115], v[40:55]
    ds_read_b128 v[108:111], v5 offset:9216
    v_cvt_pk_bf16_f32 v127, v22, v23
    v_mfma_f32_32x32x16_bf16 v[56:71], a[88:91], v[112:115], v[56:71]
    ds_write_b128 v6, v[124:127] offset:32
    s_waitcnt lgkmcnt(4)
    v_mfma_f32_32x32x16_bf16 v[40:55], a[28:31], v[116:119], v[40:55]
    ds_read_b128 v[112:115], v5 offset:10240
    v_cvt_pk_bf16_f32 v120, v24, v25
    v_mfma_f32_32x32x16_bf16 v[56:71], a[92:95], v[116:119], v[56:71]
    v_cvt_pk_bf16_f32 v121, v26, v27
    s_waitcnt lgkmcnt(3)
    v_mfma_f32_32x32x16_bf16 v[40:55], a[32:35], v[104:107], v[40:55]
    ds_read_b128 v[116:119], v5 offset:11264
    v_cvt_pk_bf16_f32 v122, v28, v29
    v_mfma_f32_32x32x16_bf16 v[56:71], a[96:99], v[104:107], v[56:71]
    v_cvt_pk_bf16_f32 v123, v30, v31
    s_waitcnt lgkmcnt(3)
    v_mfma_f32_32x32x16_bf16 v[40:55], a[36:39], v[108:111], v[40:55]
    ds_read_b128 v[104:107], v5 offset:12288
    ds_write_b128 v6, v[120:123] offset:64
    v_mfma_f32_32x32x16_bf16 v[56:71], a[100:103], v[108:111], v[56:71]
    v_cvt_pk_bf16_f32 v124, v32, v33
    s_waitcnt lgkmcnt(3)
    v_mfma_f32_32x32x16_bf16 v[40:55], a[40:43], v[112:115], v[40:55]
    ds_read_b128 v[108:111], v5 offset:13312
    v_cvt_pk_bf16_f32 v125, v34, v35
    v_mfma_f32_32x32x16_bf16 v[56:71], a[104:107], v[112:115], v[56:71]
    v_cvt_pk_bf16_f32 v126, v36, v37
    s_waitcnt lgkmcnt(3)
    v_mfma_f32_32x32x16_bf16 v[40:55], a[44:47], v[116:119], v[40:55]
    ds_read_b128 v[112:115], v5 offset:14336
    v_cvt_pk_bf16_f32 v127, v38, v39
    v_mfma_f32_32x32x16_bf16 v[56:71], a[108:111], v[116:119], v[56:71]
    ds_write_b128 v6, v[124:127] offset:96
    s_waitcnt lgkmcnt(4)
    v_mfma_f32_32x32x16_bf16 v[40:55], a[48:51], v[104:107], v[40:55]
    ds_read_b128 v[116:119], v5 offset:15360
    v_mfma_f32_32x32x16_bf16 v[56:71], a[112:115], v[104:107], v[56:71]
    s_waitcnt lgkmcnt(3)
    v_mfma_f32_32x32x16_bf16 v[40:55], a[52:55], v[108:111], v[40:55]
    ds_read_b128 v[104:107], v5 offset:16384
    v_mfma_f32_32x32x16_bf16 v[56:71], a[116:119], v[108:111], v[56:71]
    s_waitcnt lgkmcnt(3)
    v_mfma_f32_32x32x16_bf16 v[40:55], a[56:59], v[112:115], v[40:55]
    ds_read_b128 v[108:111], v5 offset:17408
    v_mfma_f32_32x32x16_bf16 v[56:71], a[120:123], v[112:115], v[56:71]
    s_waitcnt lgkmcnt(2)
    v_mfma_f32_32x32x16_bf16 v[40:55], a[60:63], v[116:119], v[40:55]
    ds_read_b128 v[112:115], v5 offset:18432
    v_mfma_f32_32x32x16_bf16 v[56:71], a[124:127], v[116:119], v[56:71]
    s_barrier
    s_waitcnt lgkmcnt(2)
    v_mfma_f32_32x32x16_bf16 v[8:23], a[0:3], v[104:107], v[72:87]
    ds_read_b128 v[116:119], v5 offset:19456
    v_mfma_f32_32x32x16_bf16 v[24:39], a[64:67], v[104:107], v[88:103]
    s_waitcnt lgkmcnt(2)
    v_mfma_f32_32x32x16_bf16 v[8:23], a[4:7], v[108:111], v[8:23]
    ds_read_b128 v[104:107], v5 offset:20480
    v_mfma_f32_32x32x16_bf16 v[24:39], a[68:71], v[108:111], v[24:39]
    s_waitcnt lgkmcnt(2)
    v_mfma_f32_32x32x16_bf16 v[8:23], a[8:11], v[112:115], v[8:23]
    ds_read_b128 v[108:111], v5 offset:21504
    v_cvt_pk_bf16_f32 v120, v40, v41
    v_mfma_f32_32x32x16_bf16 v[24:39], a[72:75], v[112:115], v[24:39]
    v_cvt_pk_bf16_f32 v121, v42, v43
    s_waitcnt lgkmcnt(2)
    v_mfma_f32_32x32x16_bf16 v[8:23], a[12:15], v[116:119], v[8:23]
    ds_read_b128 v[112:115], v5 offset:22528
    v_cvt_pk_bf16_f32 v122, v44, v45
    v_mfma_f32_32x32x16_bf16 v[24:39], a[76:79], v[116:119], v[24:39]
    v_cvt_pk_bf16_f32 v123, v46, v47
    s_waitcnt lgkmcnt(2)
    v_mfma_f32_32x32x16_bf16 v[8:23], a[16:19], v[104:107], v[8:23]
    ds_read_b128 v[116:119], v5 offset:23552
    ds_write_b128 v6, v[120:123] offset:16896
    v_mfma_f32_32x32x16_bf16 v[24:39], a[80:83], v[104:107], v[24:39]
    v_cvt_pk_bf16_f32 v124, v48, v49
    s_waitcnt lgkmcnt(3)
    v_mfma_f32_32x32x16_bf16 v[8:23], a[20:23], v[108:111], v[8:23]
    ds_read_b128 v[104:107], v5 offset:24576
    v_cvt_pk_bf16_f32 v125, v50, v51
    v_mfma_f32_32x32x16_bf16 v[24:39], a[84:87], v[108:111], v[24:39]
    v_cvt_pk_bf16_f32 v126, v52, v53
    s_waitcnt lgkmcnt(3)
    v_mfma_f32_32x32x16_bf16 v[8:23], a[24:27], v[112:115], v[8:23]
    ds_read_b128 v[108:111], v5 offset:25600
    v_cvt_pk_bf16_f32 v127, v54, v55
    v_mfma_f32_32x32x16_bf16 v[24:39], a[88:91], v[112:115], v[24:39]
    ds_write_b128 v6, v[124:127] offset:16928
    s_waitcnt lgkmcnt(4)
    v_mfma_f32_32x32x16_bf16 v[8:23], a[28:31], v[116:119], v[8:23]
    ds_read_b128 v[112:115], v5 offset:26624
    v_cvt_pk_bf16_f32 v120, v56, v57
    v_mfma_f32_32x32x16_bf16 v[24:39], a[92:95], v[116:119], v[24:39]
    v_cvt_pk_bf16_f32 v121, v58, v59
    s_waitcnt lgkmcnt(3)
    v_mfma_f32_32x32x16_bf16 v[8:23], a[32:35], v[104:107], v[8:23]
    ds_read_b128 v[116:119], v5 offset:27648
    v_cvt_pk_bf16_f32 v122, v60, v61
    v_mfma_f32_32x32x16_bf16 v[24:39], a[96:99], v[104:107], v[24:39]
    v_cvt_pk_bf16_f32 v123, v62, v63
    s_waitcnt lgkmcnt(3)
    v_mfma_f32_32x32x16_bf16 v[8:23], a[36:39], v[108:111], v[8:23]
    ds_read_b128 v[104:107], v5 offset:28672
    ds_write_b128 v6, v[120:123] offset:16960
    v_mfma_f32_32x32x16_bf16 v[24:39], a[100:103], v[108:111], v[24:39]
    v_cvt_pk_bf16_f32 v124, v64, v65
    s_waitcnt lgkmcnt(3)
    v_mfma_f32_32x32x16_bf16 v[8:23], a[40:43], v[112:115], v[8:23]
    ds_read_b128 v[108:111], v5 offset:29696
    v_cvt_pk_bf16_f32 v125, v66, v67
    v_mfma_f32_32x32x16_bf16 v[24:39], a[104:107], v[112:115], v[24:39]
    v_cvt_pk_bf16_f32 v126, v68, v69
    s_waitcnt lgkmcnt(3)
    v_mfma_f32_32x32x16_bf16 v[8:23], a[44:47], v[116:119], v[8:23]
    ds_read_b128 v[112:115], v5 offset:30720
    v_cvt_pk_bf16_f32 v127, v70, v71
    v_mfma_f32_32x32x16_bf16 v[24:39], a[108:111], v[116:119], v[24:39]
    ds_write_b128 v6, v[124:127] offset:16992
    s_waitcnt lgkmcnt(4)
    v_mfma_f32_32x32x16_bf16 v[8:23], a[48:51], v[104:107], v[8:23]
    ds_read_b128 v[116:119], v5 offset:31744
    v_mfma_f32_32x32x16_bf16 v[24:39], a[112:115], v[104:107], v[24:39]
    s_waitcnt lgkmcnt(3)
    v_mfma_f32_32x32x16_bf16 v[8:23], a[52:55], v[108:111], v[8:23]
    ds_read_b128 v[104:107], v5 offset:32768
    v_mfma_f32_32x32x16_bf16 v[24:39], a[116:119], v[108:111], v[24:39]
    s_waitcnt lgkmcnt(3)
    v_mfma_f32_32x32x16_bf16 v[8:23], a[56:59], v[112:115], v[8:23]
    ds_read_b128 v[108:111], v5 offset:33792
    v_mfma_f32_32x32x16_bf16 v[24:39], a[120:123], v[112:115], v[24:39]
    s_waitcnt lgkmcnt(2)
    v_mfma_f32_32x32x16_bf16 v[8:23], a[60:63], v[116:119], v[8:23]
    ds_read_b128 v[112:115], v5 offset:34816
    v_mfma_f32_32x32x16_bf16 v[24:39], a[124:127], v[116:119], v[24:39]
    s_barrier
    s_waitcnt lgkmcnt(2)
    v_mfma_f32_32x32x16_bf16 v[40:55], a[0:3], v[104:107], v[72:87]
    ds_read_b128 v[116:119], v5 offset:35840
    v_mfma_f32_32x32x16_bf16 v[56:71], a[64:67], v[104:107], v[88:103]
    s_waitcnt lgkmcnt(2)
    v_mfma_f32_32x32x16_bf16 v[40:55], a[4:7], v[108:111], v[40:55]
    ds_read_b128 v[104:107], v5 offset:36864
    v_mfma_f32_32x32x16_bf16 v[56:71], a[68:71], v[108:111], v[56:71]
    s_waitcnt lgkmcnt(2)
    v_mfma_f32_32x32x16_bf16 v[40:55], a[8:11], v[112:115], v[40:55]
    ds_read_b128 v[108:111], v5 offset:37888
    v_cvt_pk_bf16_f32 v120, v8, v9
    v_mfma_f32_32x32x16_bf16 v[56:71], a[72:75], v[112:115], v[56:71]
    v_cvt_pk_bf16_f32 v121, v10, v11
    s_waitcnt lgkmcnt(2)
    v_mfma_f32_32x32x16_bf16 v[40:55], a[12:15], v[116:119], v[40:55]
    ds_read_b128 v[112:115], v5 offset:38912
    v_cvt_pk_bf16_f32 v122, v12, v13
    v_mfma_f32_32x32x16_bf16 v[56:71], a[76:79], v[116:119], v[56:71]
    v_cvt_pk_bf16_f32 v123, v14, v15
    s_waitcnt lgkmcnt(2)
    v_mfma_f32_32x32x16_bf16 v[40:55], a[16:19], v[104:107], v[40:55]
    ds_read_b128 v[116:119], v5 offset:39936
    ds_write_b128 v6, v[120:123] offset:0
    v_mfma_f32_32x32x16_bf16 v[56:71], a[80:83], v[104:107], v[56:71]
    v_cvt_pk_bf16_f32 v124, v16, v17
    s_waitcnt lgkmcnt(3)
    v_mfma_f32_32x32x16_bf16 v[40:55], a[20:23], v[108:111], v[40:55]
    ds_read_b128 v[104:107], v5 offset:40960
    v_cvt_pk_bf16_f32 v125, v18, v19
    v_mfma_f32_32x32x16_bf16 v[56:71], a[84:87], v[108:111], v[56:71]
    v_cvt_pk_bf16_f32 v126, v20, v21
    s_waitcnt lgkmcnt(3)
    v_mfma_f32_32x32x16_bf16 v[40:55], a[24:27], v[112:115], v[40:55]
    ds_read_b128 v[108:111], v5 offset:41984
    v_cvt_pk_bf16_f32 v127, v22, v23
    v_mfma_f32_32x32x16_bf16 v[56:71], a[88:91], v[112:115], v[56:71]
    ds_write_b128 v6, v[124:127] offset:32
    s_waitcnt lgkmcnt(4)
    v_mfma_f32_32x32x16_bf16 v[40:55], a[28:31], v[116:119], v[40:55]
    ds_read_b128 v[112:115], v5 offset:43008
    v_cvt_pk_bf16_f32 v120, v24, v25
    v_mfma_f32_32x32x16_bf16 v[56:71], a[92:95], v[116:119], v[56:71]
    v_cvt_pk_bf16_f32 v121, v26, v27
    s_waitcnt lgkmcnt(3)
    v_mfma_f32_32x32x16_bf16 v[40:55], a[32:35], v[104:107], v[40:55]
    ds_read_b128 v[116:119], v5 offset:44032
    v_cvt_pk_bf16_f32 v122, v28, v29
    v_mfma_f32_32x32x16_bf16 v[56:71], a[96:99], v[104:107], v[56:71]
    v_cvt_pk_bf16_f32 v123, v30, v31
    s_waitcnt lgkmcnt(3)
    v_mfma_f32_32x32x16_bf16 v[40:55], a[36:39], v[108:111], v[40:55]
    ds_read_b128 v[104:107], v5 offset:45056
    ds_write_b128 v6, v[120:123] offset:64
    v_mfma_f32_32x32x16_bf16 v[56:71], a[100:103], v[108:111], v[56:71]
    v_cvt_pk_bf16_f32 v124, v32, v33
    s_waitcnt lgkmcnt(3)
    v_mfma_f32_32x32x16_bf16 v[40:55], a[40:43], v[112:115], v[40:55]
    ds_read_b128 v[108:111], v5 offset:46080
    v_cvt_pk_bf16_f32 v125, v34, v35
    v_mfma_f32_32x32x16_bf16 v[56:71], a[104:107], v[112:115], v[56:71]
    v_cvt_pk_bf16_f32 v126, v36, v37
    s_waitcnt lgkmcnt(3)
    v_mfma_f32_32x32x16_bf16 v[40:55], a[44:47], v[116:119], v[40:55]
    ds_read_b128 v[112:115], v5 offset:47104
    v_cvt_pk_bf16_f32 v127, v38, v39
    v_mfma_f32_32x32x16_bf16 v[56:71], a[108:111], v[116:119], v[56:71]
    ds_write_b128 v6, v[124:127] offset:96
    s_waitcnt lgkmcnt(4)
    v_mfma_f32_32x32x16_bf16 v[40:55], a[48:51], v[104:107], v[40:55]
    ds_read_b128 v[116:119], v5 offset:48128
    v_mfma_f32_32x32x16_bf16 v[56:71], a[112:115], v[104:107], v[56:71]
    s_waitcnt lgkmcnt(3)
    v_mfma_f32_32x32x16_bf16 v[40:55], a[52:55], v[108:111], v[40:55]
    ds_read_b128 v[104:107], v5 offset:0
    v_mfma_f32_32x32x16_bf16 v[56:71], a[116:119], v[108:111], v[56:71]
    s_waitcnt lgkmcnt(3)
    v_mfma_f32_32x32x16_bf16 v[40:55], a[56:59], v[112:115], v[40:55]
    ds_read_b128 v[108:111], v5 offset:1024
    v_mfma_f32_32x32x16_bf16 v[56:71], a[120:123], v[112:115], v[56:71]
    s_waitcnt lgkmcnt(2)
    v_mfma_f32_32x32x16_bf16 v[40:55], a[60:63], v[116:119], v[40:55]
    ds_read_b128 v[112:115], v5 offset:2048
    v_mfma_f32_32x32x16_bf16 v[56:71], a[124:127], v[116:119], v[56:71]
    s_barrier
    s_waitcnt lgkmcnt(2)
    v_mfma_f32_32x32x16_bf16 v[8:23], a[0:3], v[104:107], v[72:87]
    ds_read_b128 v[116:119], v5 offset:3072
    v_mfma_f32_32x32x16_bf16 v[24:39], a[64:67], v[104:107], v[88:103]
    s_waitcnt lgkmcnt(2)
    v_mfma_f32_32x32x16_bf16 v[8:23], a[4:7], v[108:111], v[8:23]
    ds_read_b128 v[104:107], v5 offset:4096
    v_mfma_f32_32x32x16_bf16 v[24:39], a[68:71], v[108:111], v[24:39]
    s_waitcnt lgkmcnt(2)
    v_mfma_f32_32x32x16_bf16 v[8:23], a[8:11], v[112:115], v[8:23]
    ds_read_b128 v[108:111], v5 offset:5120
    v_cvt_pk_bf16_f32 v120, v40, v41
    v_mfma_f32_32x32x16_bf16 v[24:39], a[72:75], v[112:115], v[24:39]
    v_cvt_pk_bf16_f32 v121, v42, v43
    s_waitcnt lgkmcnt(2)
    v_mfma_f32_32x32x16_bf16 v[8:23], a[12:15], v[116:119], v[8:23]
    ds_read_b128 v[112:115], v5 offset:6144
    v_cvt_pk_bf16_f32 v122, v44, v45
    v_mfma_f32_32x32x16_bf16 v[24:39], a[76:79], v[116:119], v[24:39]
    v_cvt_pk_bf16_f32 v123, v46, v47
    s_waitcnt lgkmcnt(2)
    v_mfma_f32_32x32x16_bf16 v[8:23], a[16:19], v[104:107], v[8:23]
    ds_read_b128 v[116:119], v5 offset:7168
    ds_write_b128 v6, v[120:123] offset:16896
    v_mfma_f32_32x32x16_bf16 v[24:39], a[80:83], v[104:107], v[24:39]
    v_cvt_pk_bf16_f32 v124, v48, v49
    s_waitcnt lgkmcnt(3)
    v_mfma_f32_32x32x16_bf16 v[8:23], a[20:23], v[108:111], v[8:23]
    ds_read_b128 v[104:107], v5 offset:8192
    v_cvt_pk_bf16_f32 v125, v50, v51
    v_mfma_f32_32x32x16_bf16 v[24:39], a[84:87], v[108:111], v[24:39]
    v_cvt_pk_bf16_f32 v126, v52, v53
    s_waitcnt lgkmcnt(3)
    v_mfma_f32_32x32x16_bf16 v[8:23], a[24:27], v[112:115], v[8:23]
    ds_read_b128 v[108:111], v5 offset:9216
    v_cvt_pk_bf16_f32 v127, v54, v55
    v_mfma_f32_32x32x16_bf16 v[24:39], a[88:91], v[112:115], v[24:39]
    ds_write_b128 v6, v[124:127] offset:16928
    s_waitcnt lgkmcnt(4)
    v_mfma_f32_32x32x16_bf16 v[8:23], a[28:31], v[116:119], v[8:23]
    ds_read_b128 v[112:115], v5 offset:10240
    v_cvt_pk_bf16_f32 v120, v56, v57
    v_mfma_f32_32x32x16_bf16 v[24:39], a[92:95], v[116:119], v[24:39]
    v_cvt_pk_bf16_f32 v121, v58, v59
    s_waitcnt lgkmcnt(3)
    v_mfma_f32_32x32x16_bf16 v[8:23], a[32:35], v[104:107], v[8:23]
    ds_read_b128 v[116:119], v5 offset:11264
    v_cvt_pk_bf16_f32 v122, v60, v61
    v_mfma_f32_32x32x16_bf16 v[24:39], a[96:99], v[104:107], v[24:39]
    v_cvt_pk_bf16_f32 v123, v62, v63
    s_waitcnt lgkmcnt(3)
    v_mfma_f32_32x32x16_bf16 v[8:23], a[36:39], v[108:111], v[8:23]
    ds_read_b128 v[104:107], v5 offset:12288
    ds_write_b128 v6, v[120:123] offset:16960
    v_mfma_f32_32x32x16_bf16 v[24:39], a[100:103], v[108:111], v[24:39]
    v_cvt_pk_bf16_f32 v124, v64, v65
    s_waitcnt lgkmcnt(3)
    v_mfma_f32_32x32x16_bf16 v[8:23], a[40:43], v[112:115], v[8:23]
    ds_read_b128 v[108:111], v5 offset:13312
    v_cvt_pk_bf16_f32 v125, v66, v67
    v_mfma_f32_32x32x16_bf16 v[24:39], a[104:107], v[112:115], v[24:39]
    v_cvt_pk_bf16_f32 v126, v68, v69
    s_waitcnt lgkmcnt(3)
    v_mfma_f32_32x32x16_bf16 v[8:23], a[44:47], v[116:119], v[8:23]
    ds_read_b128 v[112:115], v5 offset:14336
    v_cvt_pk_bf16_f32 v127, v70, v71
    v_mfma_f32_32x32x16_bf16 v[24:39], a[108:111], v[116:119], v[24:39]
    ds_write_b128 v6, v[124:127] offset:16992
    s_waitcnt lgkmcnt(4)
    v_mfma_f32_32x32x16_bf16 v[8:23], a[48:51], v[104:107], v[8:23]
    ds_read_b128 v[116:119], v5 offset:15360
    v_mfma_f32_32x32x16_bf16 v[24:39], a[112:115], v[104:107], v[24:39]
    s_waitcnt lgkmcnt(3)
    v_mfma_f32_32x32x16_bf16 v[8:23], a[52:55], v[108:111], v[8:23]
    ds_read_b128 v[104:107], v5 offset:16384
    v_mfma_f32_32x32x16_bf16 v[24:39], a[116:119], v[108:111], v[24:39]
    s_waitcnt lgkmcnt(3)
    v_mfma_f32_32x32x16_bf16 v[8:23], a[56:59], v[112:115], v[8:23]
    ds_read_b128 v[108:111], v5 offset:17408
    v_mfma_f32_32x32x16_bf16 v[24:39], a[120:123], v[112:115], v[24:39]
    s_waitcnt lgkmcnt(2)
    v_mfma_f32_32x32x16_bf16 v[8:23], a[60:63], v[116:119], v[8:23]
    ds_read_b128 v[112:115], v5 offset:18432
    v_mfma_f32_32x32x16_bf16 v[24:39], a[124:127], v[116:119], v[24:39]
    s_barrier
    s_waitcnt lgkmcnt(2)
    v_mfma_f32_32x32x16_bf16 v[40:55], a[0:3], v[104:107], v[72:87]
    ds_read_b128 v[116:119], v5 offset:19456
    v_mfma_f32_32x32x16_bf16 v[56:71], a[64:67], v[104:107], v[88:103]
    s_waitcnt lgkmcnt(2)
    v_mfma_f32_32x32x16_bf16 v[40:55], a[4:7], v[108:111], v[40:55]
    ds_read_b128 v[104:107], v5 offset:20480
    v_mfma_f32_32x32x16_bf16 v[56:71], a[68:71], v[108:111], v[56:71]
    s_waitcnt lgkmcnt(2)
    v_mfma_f32_32x32x16_bf16 v[40:55], a[8:11], v[112:115], v[40:55]
    ds_read_b128 v[108:111], v5 offset:21504
    v_cvt_pk_bf16_f32 v120, v8, v9
    v_mfma_f32_32x32x16_bf16 v[56:71], a[72:75], v[112:115], v[56:71]
    v_cvt_pk_bf16_f32 v121, v10, v11
    s_waitcnt lgkmcnt(2)
    v_mfma_f32_32x32x16_bf16 v[40:55], a[12:15], v[116:119], v[40:55]
    ds_read_b128 v[112:115], v5 offset:22528
    v_cvt_pk_bf16_f32 v122, v12, v13
    v_mfma_f32_32x32x16_bf16 v[56:71], a[76:79], v[116:119], v[56:71]
    v_cvt_pk_bf16_f32 v123, v14, v15
    s_waitcnt lgkmcnt(2)
    v_mfma_f32_32x32x16_bf16 v[40:55], a[16:19], v[104:107], v[40:55]
    ds_read_b128 v[116:119], v5 offset:23552
    ds_write_b128 v6, v[120:123] offset:0
    v_mfma_f32_32x32x16_bf16 v[56:71], a[80:83], v[104:107], v[56:71]
    v_cvt_pk_bf16_f32 v124, v16, v17
    s_waitcnt lgkmcnt(3)
    v_mfma_f32_32x32x16_bf16 v[40:55], a[20:23], v[108:111], v[40:55]
    ds_read_b128 v[104:107], v5 offset:24576
    v_cvt_pk_bf16_f32 v125, v18, v19
    v_mfma_f32_32x32x16_bf16 v[56:71], a[84:87], v[108:111], v[56:71]
    v_cvt_pk_bf16_f32 v126, v20, v21
    s_waitcnt lgkmcnt(3)
    v_mfma_f32_32x32x16_bf16 v[40:55], a[24:27], v[112:115], v[40:55]
    ds_read_b128 v[108:111], v5 offset:25600
    v_cvt_pk_bf16_f32 v127, v22, v23
    v_mfma_f32_32x32x16_bf16 v[56:71], a[88:91], v[112:115], v[56:71]
    ds_write_b128 v6, v[124:127] offset:32
    s_waitcnt lgkmcnt(4)
    v_mfma_f32_32x32x16_bf16 v[40:55], a[28:31], v[116:119], v[40:55]
    ds_read_b128 v[112:115], v5 offset:26624
    v_cvt_pk_bf16_f32 v120, v24, v25
    v_mfma_f32_32x32x16_bf16 v[56:71], a[92:95], v[116:119], v[56:71]
    v_cvt_pk_bf16_f32 v121, v26, v27
    s_waitcnt lgkmcnt(3)
    v_mfma_f32_32x32x16_bf16 v[40:55], a[32:35], v[104:107], v[40:55]
    ds_read_b128 v[116:119], v5 offset:27648
    v_cvt_pk_bf16_f32 v122, v28, v29
    v_mfma_f32_32x32x16_bf16 v[56:71], a[96:99], v[104:107], v[56:71]
    v_cvt_pk_bf16_f32 v123, v30, v31
    s_waitcnt lgkmcnt(3)
    v_mfma_f32_32x32x16_bf16 v[40:55], a[36:39], v[108:111], v[40:55]
    ds_read_b128 v[104:107], v5 offset:28672
    ds_write_b128 v6, v[120:123] offset:64
    v_mfma_f32_32x32x16_bf16 v[56:71], a[100:103], v[108:111], v[56:71]
    v_cvt_pk_bf16_f32 v124, v32, v33
    s_waitcnt lgkmcnt(3)
    v_mfma_f32_32x32x16_bf16 v[40:55], a[40:43], v[112:115], v[40:55]
    ds_read_b128 v[108:111], v5 offset:29696
    v_cvt_pk_bf16_f32 v125, v34, v35
    v_mfma_f32_32x32x16_bf16 v[56:71], a[104:107], v[112:115], v[56:71]
    v_cvt_pk_bf16_f32 v126, v36, v37
    s_waitcnt lgkmcnt(3)
    v_mfma_f32_32x32x16_bf16 v[40:55], a[44:47], v[116:119], v[40:55]
    ds_read_b128 v[112:115], v5 offset:30720
    v_cvt_pk_bf16_f32 v127, v38, v39
    v_mfma_f32_32x32x16_bf16 v[56:71], a[108:111], v[116:119], v[56:71]
    ds_write_b128 v6, v[124:127] offset:96
    s_waitcnt lgkmcnt(4)
    v_mfma_f32_32x32x16_bf16 v[40:55], a[48:51], v[104:107], v[40:55]
    ds_read_b128 v[116:119], v5 offset:31744
    v_mfma_f32_32x32x16_bf16 v[56:71], a[112:115], v[104:107], v[56:71]
    s_waitcnt lgkmcnt(3)
    v_mfma_f32_32x32x16_bf16 v[40:55], a[52:55], v[108:111], v[40:55]
    v_mfma_f32_32x32x16_bf16 v[56:71], a[116:119], v[108:111], v[56:71]
    s_waitcnt lgkmcnt(2)
    v_mfma_f32_32x32x16_bf16 v[40:55], a[56:59], v[112:115], v[40:55]
    v_mfma_f32_32x32x16_bf16 v[56:71], a[120:123], v[112:115], v[56:71]
    s_waitcnt lgkmcnt(0)
    v_mfma_f32_32x32x16_bf16 v[40:55], a[60:63], v[116:119], v[40:55]
    v_mfma_f32_32x32x16_bf16 v[56:71], a[124:127], v[116:119], v[56:71]
    s_barrier
    s_nop 7
    s_nop 7
    v_cvt_pk_bf16_f32 v120, v40, v41
    v_cvt_pk_bf16_f32 v121, v42, v43
    v_cvt_pk_bf16_f32 v122, v44, v45
    v_cvt_pk_bf16_f32 v123, v46, v47
    ds_write_b128 v6, v[120:123] offset:16896
    v_cvt_pk_bf16_f32 v124, v48, v49
    v_cvt_pk_bf16_f32 v125, v50, v51
    v_cvt_pk_bf16_f32 v126, v52, v53
    v_cvt_pk_bf16_f32 v127, v54, v55
    ds_write_b128 v6, v[124:127] offset:16928
    v_cvt_pk_bf16_f32 v120, v56, v57
    v_cvt_pk_bf16_f32 v121, v58, v59
    v_cvt_pk_bf16_f32 v122, v60, v61
    v_cvt_pk_bf16_f32 v123, v62, v63
    ds_write_b128 v6, v[120:123] offset:16960
    v_cvt_pk_bf16_f32 v124, v64, v65
    v_cvt_pk_bf16_f32 v125, v66, v67
    v_cvt_pk_bf16_f32 v126, v68, v69
    v_cvt_pk_bf16_f32 v127, v70, v71
    ds_write_b128 v6, v[124:127] offset:16992
    s_waitcnt lgkmcnt(0)
    s_barrier
    s_endpgm
L_joint_kernel_helper:
    s_barrier
    v_add_u32 v7, 65536, v5
    ds_read_b128 v[64:67], v7 offset:0
    ds_read_b128 v[68:71], v7 offset:1024
    ds_read_b128 v[72:75], v7 offset:2048
    ds_read_b128 v[76:79], v7 offset:3072
    ds_read_b128 v[80:83], v7 offset:4096
    ds_read_b128 v[84:87], v7 offset:5120
    ds_read_b128 v[88:91], v7 offset:6144
    ds_read_b128 v[92:95], v7 offset:7168
    s_waitcnt vmcnt(38) lgkmcnt(7)
    v_mfma_f32_32x32x16_bf16 v[32:47], a[0:3], v[64:67], 0
    v_mfma_f32_32x32x16_bf16 v[48:63], a[64:67], v[64:67], 0
    s_waitcnt vmcnt(36) lgkmcnt(6)
    v_mfma_f32_32x32x16_bf16 v[32:47], a[4:7], v[68:71], v[32:47]
    v_mfma_f32_32x32x16_bf16 v[48:63], a[68:71], v[68:71], v[48:63]
    ds_read_b128 v[64:67], v7 offset:8192
    s_waitcnt vmcnt(34) lgkmcnt(6)
    v_mfma_f32_32x32x16_bf16 v[32:47], a[8:11], v[72:75], v[32:47]
    v_mfma_f32_32x32x16_bf16 v[48:63], a[72:75], v[72:75], v[48:63]
    ds_read_b128 v[68:71], v7 offset:9216
    s_waitcnt vmcnt(32) lgkmcnt(6)
    v_mfma_f32_32x32x16_bf16 v[32:47], a[12:15], v[76:79], v[32:47]
    v_mfma_f32_32x32x16_bf16 v[48:63], a[76:79], v[76:79], v[48:63]
    ds_read_b128 v[72:75], v7 offset:10240
    s_waitcnt vmcnt(30) lgkmcnt(6)
    v_mfma_f32_32x32x16_bf16 v[32:47], a[16:19], v[80:83], v[32:47]
    v_mfma_f32_32x32x16_bf16 v[48:63], a[80:83], v[80:83], v[48:63]
    ds_read_b128 v[76:79], v7 offset:11264
    s_waitcnt vmcnt(28) lgkmcnt(6)
    v_mfma_f32_32x32x16_bf16 v[32:47], a[20:23], v[84:87], v[32:47]
    v_mfma_f32_32x32x16_bf16 v[48:63], a[84:87], v[84:87], v[48:63]
    ds_read_b128 v[80:83], v7 offset:12288
    s_waitcnt vmcnt(26) lgkmcnt(6)
    v_mfma_f32_32x32x16_bf16 v[32:47], a[24:27], v[88:91], v[32:47]
    v_mfma_f32_32x32x16_bf16 v[48:63], a[88:91], v[88:91], v[48:63]
    ds_read_b128 v[84:87], v7 offset:13312
    s_waitcnt vmcnt(24) lgkmcnt(6)
    v_mfma_f32_32x32x16_bf16 v[32:47], a[28:31], v[92:95], v[32:47]
    v_mfma_f32_32x32x16_bf16 v[48:63], a[92:95], v[92:95], v[48:63]
    ds_read_b128 v[88:91], v7 offset:14336
    s_waitcnt vmcnt(22) lgkmcnt(6)
    v_mfma_f32_32x32x16_bf16 v[32:47], a[32:35], v[64:67], v[32:47]
    v_mfma_f32_32x32x16_bf16 v[48:63], a[96:99], v[64:67], v[48:63]
    ds_read_b128 v[92:95], v7 offset:15360
    s_waitcnt vmcnt(20) lgkmcnt(6)
    v_mfma_f32_32x32x16_bf16 v[32:47], a[36:39], v[68:71], v[32:47]
    v_mfma_f32_32x32x16_bf16 v[48:63], a[100:103], v[68:71], v[48:63]
    s_waitcnt vmcnt(0)
    v_max3_f32 v8, |v96|, |v97|, |v98|
    v_max3_f32 v8, v8, |v99|, |v100|
    v_max3_f32 v8, v8, |v101|, |v102|
    v_max3_f32 v8, v8, |v103|, |v104|
    v_max3_f32 v8, v8, |v105|, |v106|
    v_max3_f32 v8, v8, |v107|, |v108|
    v_max3_f32 v8, v8, |v109|, |v110|
    v_max3_f32 v8, v8, |v111|, |v112|
    s_waitcnt lgkmcnt(5)
    v_mfma_f32_32x32x16_bf16 v[32:47], a[40:43], v[72:75], v[32:47]
    v_mfma_f32_32x32x16_bf16 v[48:63], a[104:107], v[72:75], v[48:63]
    v_max3_f32 v8, v8, |v113|, |v114|
    v_max3_f32 v8, v8, |v115|, |v116|
    v_max3_f32 v8, v8, |v117|, |v118|
    v_max3_f32 v8, v8, |v119|, |v120|
    v_max3_f32 v8, v8, |v121|, |v122|
    v_max3_f32 v8, v8, |v123|, |v124|
    v_max3_f32 v8, v8, |v125|, |v126|
    v_max_f32 v8, v8, |v127|
    s_waitcnt lgkmcnt(4)
    v_mfma_f32_32x32x16_bf16 v[32:47], a[44:47], v[76:79], v[32:47]
    v_mfma_f32_32x32x16_bf16 v[48:63], a[108:111], v[76:79], v[48:63]
    s_mov_b32 s41, 0x42a80000
    v_cmp_lt_f32 s[42:43], s41, v8
    v_exp_f32 v96, v96
    v_exp_f32 v97, v97
    v_exp_f32 v98, v98
    v_exp_f32 v99, v99
    v_exp_f32 v100, v100
    v_exp_f32 v101, v101
    s_waitcnt lgkmcnt(3)
    v_mfma_f32_32x32x16_bf16 v[32:47], a[48:51], v[80:83], v[32:47]
    v_mfma_f32_32x32x16_bf16 v[48:63], a[112:115], v[80:83], v[48:63]
    v_exp_f32 v102, v102
    v_exp_f32 v103, v103
    v_exp_f32 v104, v104
    v_exp_f32 v105, v105
    v_exp_f32 v106, v106
    v_exp_f32 v107, v107
    v_exp_f32 v108, v108
    v_exp_f32 v109, v109
    s_waitcnt lgkmcnt(2)
    v_mfma_f32_32x32x16_bf16 v[32:47], a[52:55], v[84:87], v[32:47]
    v_mfma_f32_32x32x16_bf16 v[48:63], a[116:119], v[84:87], v[48:63]
    v_exp_f32 v110, v110
    v_exp_f32 v111, v111
    v_exp_f32 v112, v112
    v_exp_f32 v113, v113
    v_exp_f32 v114, v114
    v_exp_f32 v115, v115
    v_exp_f32 v116, v116
    v_exp_f32 v117, v117
    s_waitcnt lgkmcnt(1)
    v_mfma_f32_32x32x16_bf16 v[32:47], a[56:59], v[88:91], v[32:47]
    v_mfma_f32_32x32x16_bf16 v[48:63], a[120:123], v[88:91], v[48:63]
    v_exp_f32 v118, v118
    v_exp_f32 v119, v119
    v_exp_f32 v120, v120
    v_exp_f32 v121, v121
    v_exp_f32 v122, v122
    v_exp_f32 v123, v123
    v_exp_f32 v124, v124
    v_exp_f32 v125, v125
    s_waitcnt lgkmcnt(0)
    v_mfma_f32_32x32x16_bf16 v[32:47], a[60:63], v[92:95], v[32:47]
    v_mfma_f32_32x32x16_bf16 v[48:63], a[124:127], v[92:95], v[48:63]
    v_exp_f32 v126, v126
    v_exp_f32 v127, v127
    s_lshl_b32 s36, s21, 12
    v_add_u32 v2, s36, v5
    v_lshrrev_b32 v10, 5, v1
    v_lshlrev_b32 v11, 4, v10
    s_lshl_b32 s36, s21, 8
    s_add_u32 s36, s36, 81920
    v_add_u32 v11, s36, v11
    v_and_b32 v12, 31, v1
    v_mul_u32_u24 v13, 1056, v12
    v_add_u32 v9, v11, v13
    v_lshrrev_b32 v13, 3, v12
    v_mul_u32_u24 v13, 1056, v13
    v_add_u32 v4, v11, v13
    s_lshl_b32 s36, s21, 3
    v_add_u32 v10, s36, v10
    v_mul_u32_u24 v13, 528, v10
    v_lshl_add_u32 v13, v12, 4, v13
    v_add_u32 v6, 115712, v13
    v_lshlrev_b32 v13, 9, v10
    v_lshl_add_u32 v7, v12, 4, v13
    s_mov_b32 s41, 0x4038aa3b
    v_mul_f32 v64, s41, v32
    v_mul_f32 v65, s41, v33
    v_mul_f32 v66, s41, v34
    v_mul_f32 v67, s41, v35
    v_mul_f32 v68, s41, v36
    v_mul_f32 v69, s41, v37
    v_mul_f32 v70, s41, v38
    v_mul_f32 v71, s41, v39
    v_mul_f32 v72, s41, v40
    v_mul_f32 v73, s41, v41
    v_mul_f32 v74, s41, v42
    v_mul_f32 v75, s41, v43
    v_mul_f32 v76, s41, v44
    v_mul_f32 v77, s41, v45
    v_mul_f32 v78, s41, v46
    v_mul_f32 v79, s41, v47
    v_mul_f32 v80, s41, v48
    v_mul_f32 v81, s41, v49
    v_mul_f32 v82, s41, v50
    v_mul_f32 v83, s41, v51
    v_mul_f32 v84, s41, v52
    v_mul_f32 v85, s41, v53
    v_mul_f32 v86, s41, v54
    v_mul_f32 v87, s41, v55
    v_mul_f32 v88, s41, v56
    v_mul_f32 v89, s41, v57
    v_mul_f32 v90, s41, v58
    v_mul_f32 v91, s41, v59
    v_mul_f32 v92, s41, v60
    v_mul_f32 v93, s41, v61
    v_mul_f32 v94, s41, v62
    v_mul_f32 v95, s41, v63
    v_max3_f32 v8, |v64|, |v65|, |v66|
    v_max3_f32 v8, v8, |v67|, |v68|
    v_max3_f32 v8, v8, |v69|, |v70|
    v_max3_f32 v8, v8, |v71|, |v72|
    v_max3_f32 v8, v8, |v73|, |v74|
    v_max3_f32 v8, v8, |v75|, |v76|
    v_max3_f32 v8, v8, |v77|, |v78|
    v_max3_f32 v8, v8, |v79|, |v80|
    v_max3_f32 v8, v8, |v81|, |v82|
    v_max3_f32 v8, v8, |v83|, |v84|
    v_max3_f32 v8, v8, |v85|, |v86|
    v_max3_f32 v8, v8, |v87|, |v88|
    v_max3_f32 v8, v8, |v89|, |v90|
    v_max3_f32 v8, v8, |v91|, |v92|
    v_max3_f32 v8, v8, |v93|, |v94|
    v_max_f32 v8, v8, |v95|
    s_mov_b32 s41, 0x42200000
    v_cmp_lt_f32 vcc, s41, v8
    s_nop 3
    s_or_b64 s[42:43], s[42:43], vcc
    s_cmp_lg_u64 s[42:43], 0
    s_cselect_b32 s44, 1, 0
    s_cmp_lg_u32 s44, 0
    s_cbranch_scc1 L_joint_kernel_slow
    v_exp_f32 v32, v64
    v_exp_f32 v33, v65
    v_exp_f32 v34, v66
    v_exp_f32 v35, v67
    v_exp_f32 v36, v68
    v_exp_f32 v37, v69
    v_exp_f32 v38, v70
    v_exp_f32 v39, v71
    v_exp_f32 v40, v72
    v_exp_f32 v41, v73
    v_exp_f32 v42, v74
    v_exp_f32 v43, v75
    v_exp_f32 v44, v76
    v_exp_f32 v45, v77
    v_exp_f32 v46, v78
    v_exp_f32 v47, v79
    v_exp_f32 v48, v80
    v_exp_f32 v49, v81
    v_exp_f32 v50, v82
    v_exp_f32 v51, v83
    v_exp_f32 v52, v84
    v_exp_f32 v53, v85
    v_exp_f32 v54, v86
    v_exp_f32 v55, v87
    v_exp_f32 v56, v88
    v_exp_f32 v57, v89
    v_exp_f32 v58, v90
    v_exp_f32 v59, v91
    v_exp_f32 v60, v92
    v_exp_f32 v61, v93
    v_exp_f32 v62, v94
    v_exp_f32 v63, v95
    ds_write_b128 v9, v[32:35] offset:0
    ds_write_b128 v9, v[36:39] offset:32
    ds_write_b128 v9, v[40:43] offset:64
    ds_write_b128 v9, v[44:47] offset:96
    ds_write_b128 v9, v[48:51] offset:128
    ds_write_b128 v9, v[52:55] offset:160
    ds_write_b128 v9, v[56:59] offset:192
    ds_write_b128 v9, v[60:63] offset:224
    s_waitcnt lgkmcnt(0)
    ds_read_b128 v[32:35], v4 offset:0
    ds_read_b128 v[36:39], v4 offset:32
    ds_read_b128 v[40:43], v4 offset:64
    ds_read_b128 v[44:47], v4 offset:96
    ds_read_b128 v[48:51], v4 offset:128
    ds_read_b128 v[52:55], v4 offset:160
    ds_read_b128 v[56:59], v4 offset:192
    ds_read_b128 v[60:63], v4 offset:224
    s_waitcnt lgkmcnt(6)
    v_fma_f32 v64, v32, v96, 1.0
    v_fma_f32 v65, v33, v97, 1.0
    v_fma_f32 v66, v34, v98, 1.0
    v_fma_f32 v67, v35, v99, 1.0
    v_fma_f32 v68, v36, v100, 1.0
    v_fma_f32 v69, v37, v101, 1.0
    v_fma_f32 v70, v38, v102, 1.0
    v_fma_f32 v71, v39, v103, 1.0
    ds_read_b128 v[32:35], v4 offset:4224
    ds_read_b128 v[36:39], v4 offset:4256
    v_rcp_f32 v64, v64
    v_rcp_f32 v65, v65
    v_rcp_f32 v66, v66
    v_rcp_f32 v67, v67
    v_rcp_f32 v68, v68
    v_rcp_f32 v69, v69
    v_rcp_f32 v70, v70
    v_rcp_f32 v71, v71
    s_nop 0
    v_cvt_pk_bf16_f32 v80, v64, v65
    v_cvt_pk_bf16_f32 v81, v66, v67
    v_cvt_pk_bf16_f32 v82, v68, v69
    v_cvt_pk_bf16_f32 v83, v70, v71
    ds_write_b128 v2, v[80:83] offset:0
    s_waitcnt lgkmcnt(7)
    v_fma_f32 v72, v40, v104, 1.0
    v_fma_f32 v73, v41, v105, 1.0
    v_fma_f32 v74, v42, v106, 1.0
    v_fma_f32 v75, v43, v107, 1.0
    v_fma_f32 v76, v44, v108, 1.0
    v_fma_f32 v77, v45, v109, 1.0
    v_fma_f32 v78, v46, v110, 1.0
    v_fma_f32 v79, v47, v111, 1.0
    ds_read_b128 v[40:43], v4 offset:4288
    ds_read_b128 v[44:47], v4 offset:4320
    v_rcp_f32 v72, v72
    v_rcp_f32 v73, v73
    v_rcp_f32 v74, v74
    v_rcp_f32 v75, v75
    v_rcp_f32 v76, v76
    v_rcp_f32 v77, v77
    v_rcp_f32 v78, v78
    v_rcp_f32 v79, v79
    s_nop 0
    v_cvt_pk_bf16_f32 v84, v72, v73
    v_cvt_pk_bf16_f32 v85, v74, v75
    v_cvt_pk_bf16_f32 v86, v76, v77
    v_cvt_pk_bf16_f32 v87, v78, v79
    ds_write_b128 v2, v[84:87] offset:1024
    s_waitcnt lgkmcnt(8)
    v_fma_f32 v64, v48, v112, 1.0
    v_fma_f32 v65, v49, v113, 1.0
    v_fma_f32 v66, v50, v114, 1.0
    v_fma_f32 v67, v51, v115, 1.0
    v_fma_f32 v68, v52, v116, 1.0
    v_fma_f32 v69, v53, v117, 1.0
    v_fma_f32 v70, v54, v118, 1.0
    v_fma_f32 v71, v55, v119, 1.0
    ds_read_b128 v[48:51], v4 offset:4352
    ds_read_b128 v[52:55], v4 offset:4384
    v_rcp_f32 v64, v64
    v_rcp_f32 v65, v65
    v_rcp_f32 v66, v66
    v_rcp_f32 v67, v67
    v_rcp_f32 v68, v68
    v_rcp_f32 v69, v69
    v_rcp_f32 v70, v70
    v_rcp_f32 v71, v71
    s_nop 0
    v_cvt_pk_bf16_f32 v80, v64, v65
    v_cvt_pk_bf16_f32 v81, v66, v67
    v_cvt_pk_bf16_f32 v82, v68, v69
    v_cvt_pk_bf16_f32 v83, v70, v71
    ds_write_b128 v2, v[80:83] offset:2048
    s_waitcnt lgkmcnt(9)
    v_fma_f32 v72, v56, v120, 1.0
    v_fma_f32 v73, v57, v121, 1.0
    v_fma_f32 v74, v58, v122, 1.0
    v_fma_f32 v75, v59, v123, 1.0
    v_fma_f32 v76, v60, v124, 1.0
    v_fma_f32 v77, v61, v125, 1.0
    v_fma_f32 v78, v62, v126, 1.0
    v_fma_f32 v79, v63, v127, 1.0
    ds_read_b128 v[56:59], v4 offset:4416
    ds_read_b128 v[60:63], v4 offset:4448
    v_rcp_f32 v72, v72
    v_rcp_f32 v73, v73
    v_rcp_f32 v74, v74
    v_rcp_f32 v75, v75
    v_rcp_f32 v76, v76
    v_rcp_f32 v77, v77
    v_rcp_f32 v78, v78
    v_rcp_f32 v79, v79
    s_nop 0
    v_cvt_pk_bf16_f32 v84, v72, v73
    v_cvt_pk_bf16_f32 v85, v74, v75
    v_cvt_pk_bf16_f32 v86, v76, v77
    v_cvt_pk_bf16_f32 v87, v78, v79
    ds_write_b128 v2, v[84:87] offset:3072
    s_waitcnt lgkmcnt(10)
    v_fma_f32 v64, v32, v96, 1.0
    v_fma_f32 v65, v33, v97, 1.0
    v_fma_f32 v66, v34, v98, 1.0
    v_fma_f32 v67, v35, v99, 1.0
    v_fma_f32 v68, v36, v100, 1.0
    v_fma_f32 v69, v37, v101, 1.0
    v_fma_f32 v70, v38, v102, 1.0
    v_fma_f32 v71, v39, v103, 1.0
    ds_read_b128 v[32:35], v4 offset:8448
    ds_read_b128 v[36:39], v4 offset:8480
    v_rcp_f32 v64, v64
    v_rcp_f32 v65, v65
    v_rcp_f32 v66, v66
    v_rcp_f32 v67, v67
    v_rcp_f32 v68, v68
    v_rcp_f32 v69, v69
    v_rcp_f32 v70, v70
    v_rcp_f32 v71, v71
    s_nop 0
    v_cvt_pk_bf16_f32 v80, v64, v65
    v_cvt_pk_bf16_f32 v81, v66, v67
    v_cvt_pk_bf16_f32 v82, v68, v69
    v_cvt_pk_bf16_f32 v83, v70, v71
    ds_write_b128 v2, v[80:83] offset:16384
    s_waitcnt lgkmcnt(10)
    v_fma_f32 v72, v40, v104, 1.0
    v_fma_f32 v73, v41, v105, 1.0
    v_fma_f32 v74, v42, v106, 1.0
    v_fma_f32 v75, v43, v107, 1.0
    v_fma_f32 v76, v44, v108, 1.0
    v_fma_f32 v77, v45, v109, 1.0
    v_fma_f32 v78, v46, v110, 1.0
    v_fma_f32 v79, v47, v111, 1.0
    ds_read_b128 v[40:43], v4 offset:8512
    ds_read_b128 v[44:47], v4 offset:8544
    v_rcp_f32 v72, v72
    v_rcp_f32 v73, v73
    v_rcp_f32 v74, v74
    v_rcp_f32 v75, v75
    v_rcp_f32 v76, v76
    v_rcp_f32 v77, v77
    v_rcp_f32 v78, v78
    v_rcp_f32 v79, v79
    s_nop 0
    v_cvt_pk_bf16_f32 v84, v72, v73
    v_cvt_pk_bf16_f32 v85, v74, v75
    v_cvt_pk_bf16_f32 v86, v76, v77
    v_cvt_pk_bf16_f32 v87, v78, v79
    ds_write_b128 v2, v[84:87] offset:17408
    s_waitcnt lgkmcnt(10)
    v_fma_f32 v64, v48, v112, 1.0
    v_fma_f32 v65, v49, v113, 1.0
    v_fma_f32 v66, v50, v114, 1.0
    v_fma_f32 v67, v51, v115, 1.0
    v_fma_f32 v68, v52, v116, 1.0
    v_fma_f32 v69, v53, v117, 1.0
    v_fma_f32 v70, v54, v118, 1.0
    v_fma_f32 v71, v55, v119, 1.0
    ds_read_b128 v[48:51], v4 offset:8576
    ds_read_b128 v[52:55], v4 offset:8608
    v_rcp_f32 v64, v64
    v_rcp_f32 v65, v65
    v_rcp_f32 v66, v66
    v_rcp_f32 v67, v67
    v_rcp_f32 v68, v68
    v_rcp_f32 v69, v69
    v_rcp_f32 v70, v70
    v_rcp_f32 v71, v71
    s_nop 0
    v_cvt_pk_bf16_f32 v80, v64, v65
    v_cvt_pk_bf16_f32 v81, v66, v67
    v_cvt_pk_bf16_f32 v82, v68, v69
    v_cvt_pk_bf16_f32 v83, v70, v71
    ds_write_b128 v2, v[80:83] offset:18432
    s_waitcnt lgkmcnt(10)
    v_fma_f32 v72, v56, v120, 1.0
    v_fma_f32 v73, v57, v121, 1.0
    v_fma_f32 v74, v58, v122, 1.0
    v_fma_f32 v75, v59, v123, 1.0
    v_fma_f32 v76, v60, v124, 1.0
    v_fma_f32 v77, v61, v125, 1.0
    v_fma_f32 v78, v62, v126, 1.0
    v_fma_f32 v79, v63, v127, 1.0
    ds_read_b128 v[56:59], v4 offset:8640
    ds_read_b128 v[60:63], v4 offset:8672
    v_rcp_f32 v72, v72
    v_rcp_f32 v73, v73
    v_rcp_f32 v74, v74
    v_rcp_f32 v75, v75
    v_rcp_f32 v76, v76
    v_rcp_f32 v77, v77
    v_rcp_f32 v78, v78
    v_rcp_f32 v79, v79
    s_nop 0
    v_cvt_pk_bf16_f32 v84, v72, v73
    v_cvt_pk_bf16_f32 v85, v74, v75
    v_cvt_pk_bf16_f32 v86, v76, v77
    v_cvt_pk_bf16_f32 v87, v78, v79
    ds_write_b128 v2, v[84:87] offset:19456
    s_waitcnt lgkmcnt(0)
    s_barrier
    v_fma_f32 v64, v32, v96, 1.0
    v_fma_f32 v65, v33, v97, 1.0
    v_fma_f32 v66, v34, v98, 1.0
    v_fma_f32 v67, v35, v99, 1.0
    v_fma_f32 v68, v36, v100, 1.0
    v_fma_f32 v69, v37, v101, 1.0
    v_fma_f32 v70, v38, v102, 1.0
    v_fma_f32 v71, v39, v103, 1.0
    ds_read_b128 v[32:35], v4 offset:12672
    ds_read_b128 v[36:39], v4 offset:12704
    v_rcp_f32 v64, v64
    v_rcp_f32 v65, v65
    v_rcp_f32 v66, v66
    v_rcp_f32 v67, v67
    v_rcp_f32 v68, v68
    v_rcp_f32 v69, v69
    v_rcp_f32 v70, v70
    v_rcp_f32 v71, v71
    s_nop 0
    v_cvt_pk_bf16_f32 v80, v64, v65
    v_cvt_pk_bf16_f32 v81, v66, v67
    v_cvt_pk_bf16_f32 v82, v68, v69
    v_cvt_pk_bf16_f32 v83, v70, v71
    ds_write_b128 v2, v[80:83] offset:32768
    v_fma_f32 v72, v40, v104, 1.0
    v_fma_f32 v73, v41, v105, 1.0
    v_fma_f32 v74, v42, v106, 1.0
    v_fma_f32 v75, v43, v107, 1.0
    v_fma_f32 v76, v44, v108, 1.0
    v_fma_f32 v77, v45, v109, 1.0
    v_fma_f32 v78, v46, v110, 1.0
    v_fma_f32 v79, v47, v111, 1.0
    ds_read_b128 v[40:43], v4 offset:12736
    ds_read_b128 v[44:47], v4 offset:12768
    v_rcp_f32 v72, v72
    v_rcp_f32 v73, v73
    v_rcp_f32 v74, v74
    v_rcp_f32 v75, v75
    v_rcp_f32 v76, v76
    v_rcp_f32 v77, v77
    v_rcp_f32 v78, v78
    v_rcp_f32 v79, v79
    s_nop 0
    v_cvt_pk_bf16_f32 v84, v72, v73
    v_cvt_pk_bf16_f32 v85, v74, v75
    v_cvt_pk_bf16_f32 v86, v76, v77
    v_cvt_pk_bf16_f32 v87, v78, v79
    ds_write_b128 v2, v[84:87] offset:33792
    v_fma_f32 v64, v48, v112, 1.0
    v_fma_f32 v65, v49, v113, 1.0
    v_fma_f32 v66, v50, v114, 1.0
    v_fma_f32 v67, v51, v115, 1.0
    v_fma_f32 v68, v52, v116, 1.0
    v_fma_f32 v69, v53, v117, 1.0
    v_fma_f32 v70, v54, v118, 1.0
    v_fma_f32 v71, v55, v119, 1.0
    ds_read_b128 v[48:51], v4 offset:12800
    ds_read_b128 v[52:55], v4 offset:12832
    v_rcp_f32 v64, v64
    v_rcp_f32 v65, v65
    v_rcp_f32 v66, v66
    v_rcp_f32 v67, v67
    v_rcp_f32 v68, v68
    v_rcp_f32 v69, v69
    v_rcp_f32 v70, v70
    v_rcp_f32 v71, v71
    s_nop 0
    v_cvt_pk_bf16_f32 v80, v64, v65
    v_cvt_pk_bf16_f32 v81, v66, v67
    v_cvt_pk_bf16_f32 v82, v68, v69
    v_cvt_pk_bf16_f32 v83, v70, v71
    ds_write_b128 v2, v[80:83] offset:34816
    v_fma_f32 v72, v56, v120, 1.0
    v_fma_f32 v73, v57, v121, 1.0
    v_fma_f32 v74, v58, v122, 1.0
    v_fma_f32 v75, v59, v123, 1.0
    v_fma_f32 v76, v60, v124, 1.0
    v_fma_f32 v77, v61, v125, 1.0
    v_fma_f32 v78, v62, v126, 1.0
    v_fma_f32 v79, v63, v127, 1.0
    ds_read_b128 v[56:59], v4 offset:12864
    ds_read_b128 v[60:63], v4 offset:12896
    v_rcp_f32 v72, v72
    v_rcp_f32 v73, v73
    v_rcp_f32 v74, v74
    v_rcp_f32 v75, v75
    v_rcp_f32 v76, v76
    v_rcp_f32 v77, v77
    v_rcp_f32 v78, v78
    v_rcp_f32 v79, v79
    s_nop 0
    v_cvt_pk_bf16_f32 v84, v72, v73
    v_cvt_pk_bf16_f32 v85, v74, v75
    v_cvt_pk_bf16_f32 v86, v76, v77
    v_cvt_pk_bf16_f32 v87, v78, v79
    ds_write_b128 v2, v[84:87] offset:35840
    s_waitcnt lgkmcnt(0)
    s_barrier
    v_fma_f32 v64, v32, v96, 1.0
    v_fma_f32 v65, v33, v97, 1.0
    v_fma_f32 v66, v34, v98, 1.0
    v_fma_f32 v67, v35, v99, 1.0
    v_fma_f32 v68, v36, v100, 1.0
    v_fma_f32 v69, v37, v101, 1.0
    v_fma_f32 v70, v38, v102, 1.0
    v_fma_f32 v71, v39, v103, 1.0
    ds_read_b128 v[32:35], v4 offset:16896
    ds_read_b128 v[36:39], v4 offset:16928
    v_rcp_f32 v64, v64
    v_rcp_f32 v65, v65
    v_rcp_f32 v66, v66
    v_rcp_f32 v67, v67
    v_rcp_f32 v68, v68
    v_rcp_f32 v69, v69
    v_rcp_f32 v70, v70
    v_rcp_f32 v71, v71
    s_nop 0
    v_cvt_pk_bf16_f32 v80, v64, v65
    v_cvt_pk_bf16_f32 v81, v66, v67
    v_cvt_pk_bf16_f32 v82, v68, v69
    v_cvt_pk_bf16_f32 v83, v70, v71
    ds_write_b128 v2, v[80:83] offset:0
    v_fma_f32 v72, v40, v104, 1.0
    v_fma_f32 v73, v41, v105, 1.0
    v_fma_f32 v74, v42, v106, 1.0
    v_fma_f32 v75, v43, v107, 1.0
    v_fma_f32 v76, v44, v108, 1.0
    v_fma_f32 v77, v45, v109, 1.0
    v_fma_f32 v78, v46, v110, 1.0
    v_fma_f32 v79, v47, v111, 1.0
    ds_read_b128 v[40:43], v4 offset:16960
    ds_read_b128 v[44:47], v4 offset:16992
    v_rcp_f32 v72, v72
    v_rcp_f32 v73, v73
    v_rcp_f32 v74, v74
    v_rcp_f32 v75, v75
    v_rcp_f32 v76, v76
    v_rcp_f32 v77, v77
    v_rcp_f32 v78, v78
    v_rcp_f32 v79, v79
    s_nop 0
    v_cvt_pk_bf16_f32 v84, v72, v73
    v_cvt_pk_bf16_f32 v85, v74, v75
    v_cvt_pk_bf16_f32 v86, v76, v77
    v_cvt_pk_bf16_f32 v87, v78, v79
    ds_write_b128 v2, v[84:87] offset:1024
    v_fma_f32 v64, v48, v112, 1.0
    v_fma_f32 v65, v49, v113, 1.0
    v_fma_f32 v66, v50, v114, 1.0
    v_fma_f32 v67, v51, v115, 1.0
    v_fma_f32 v68, v52, v116, 1.0
    v_fma_f32 v69, v53, v117, 1.0
    v_fma_f32 v70, v54, v118, 1.0
    v_fma_f32 v71, v55, v119, 1.0
    ds_read_b128 v[48:51], v4 offset:17024
    ds_read_b128 v[52:55], v4 offset:17056
    v_rcp_f32 v64, v64
    v_rcp_f32 v65, v65
    v_rcp_f32 v66, v66
    v_rcp_f32 v67, v67
    v_rcp_f32 v68, v68
    v_rcp_f32 v69, v69
    v_rcp_f32 v70, v70
    v_rcp_f32 v71, v71
    s_nop 0
    v_cvt_pk_bf16_f32 v80, v64, v65
    v_cvt_pk_bf16_f32 v81, v66, v67
    v_cvt_pk_bf16_f32 v82, v68, v69
    v_cvt_pk_bf16_f32 v83, v70, v71
    ds_write_b128 v2, v[80:83] offset:2048
    v_fma_f32 v72, v56, v120, 1.0
    v_fma_f32 v73, v57, v121, 1.0
    v_fma_f32 v74, v58, v122, 1.0
    v_fma_f32 v75, v59, v123, 1.0
    v_fma_f32 v76, v60, v124, 1.0
    v_fma_f32 v77, v61, v125, 1.0
    v_fma_f32 v78, v62, v126, 1.0
    v_fma_f32 v79, v63, v127, 1.0
    ds_read_b128 v[56:59], v4 offset:17088
    ds_read_b128 v[60:63], v4 offset:17120
    v_rcp_f32 v72, v72
    v_rcp_f32 v73, v73
    v_rcp_f32 v74, v74
    v_rcp_f32 v75, v75
    v_rcp_f32 v76, v76
    v_rcp_f32 v77, v77
    v_rcp_f32 v78, v78
    v_rcp_f32 v79, v79
    s_nop 0
    v_cvt_pk_bf16_f32 v84, v72, v73
    v_cvt_pk_bf16_f32 v85, v74, v75
    v_cvt_pk_bf16_f32 v86, v76, v77
    v_cvt_pk_bf16_f32 v87, v78, v79
    ds_write_b128 v2, v[84:87] offset:3072
    s_waitcnt lgkmcnt(0)
    s_barrier
    ds_read_b128 a[0:3], v6 offset:0
    ds_read_b128 a[4:7], v6 offset:1056
    ds_read_b128 a[8:11], v6 offset:2112
    ds_read_b128 a[12:15], v6 offset:3168
    v_fma_f32 v64, v32, v96, 1.0
    v_fma_f32 v65, v33, v97, 1.0
    v_fma_f32 v66, v34, v98, 1.0
    v_fma_f32 v67, v35, v99, 1.0
    v_fma_f32 v68, v36, v100, 1.0
    v_fma_f32 v69, v37, v101, 1.0
    v_fma_f32 v70, v38, v102, 1.0
    v_fma_f32 v71, v39, v103, 1.0
    ds_read_b128 v[32:35], v4 offset:21120
    ds_read_b128 v[36:39], v4 offset:21152
    v_rcp_f32 v64, v64
    v_rcp_f32 v65, v65
    v_rcp_f32 v66, v66
    v_rcp_f32 v67, v67
    v_rcp_f32 v68, v68
    v_rcp_f32 v69, v69
    v_rcp_f32 v70, v70
    v_rcp_f32 v71, v71
    s_waitcnt lgkmcnt(5)
    s_mov_b32 s36, 0
    buffer_store_dwordx4 a[0:3], v7, s[16:19], s36 offen sc1
    s_waitcnt lgkmcnt(4)
    s_mov_b32 s36, 1024
    buffer_store_dwordx4 a[4:7], v7, s[16:19], s36 offen sc1
    v_cvt_pk_bf16_f32 v80, v64, v65
    v_cvt_pk_bf16_f32 v81, v66, v67
    v_cvt_pk_bf16_f32 v82, v68, v69
    v_cvt_pk_bf16_f32 v83, v70, v71
    ds_write_b128 v2, v[80:83] offset:16384
    v_fma_f32 v72, v40, v104, 1.0
    v_fma_f32 v73, v41, v105, 1.0
    v_fma_f32 v74, v42, v106, 1.0
    v_fma_f32 v75, v43, v107, 1.0
    v_fma_f32 v76, v44, v108, 1.0
    v_fma_f32 v77, v45, v109, 1.0
    v_fma_f32 v78, v46, v110, 1.0
    v_fma_f32 v79, v47, v111, 1.0
    ds_read_b128 v[40:43], v4 offset:21184
    ds_read_b128 v[44:47], v4 offset:21216
    v_rcp_f32 v72, v72
    v_rcp_f32 v73, v73
    v_rcp_f32 v74, v74
    v_rcp_f32 v75, v75
    v_rcp_f32 v76, v76
    v_rcp_f32 v77, v77
    v_rcp_f32 v78, v78
    v_rcp_f32 v79, v79
    s_waitcnt lgkmcnt(6)
    s_mov_b32 s36, 2048
    buffer_store_dwordx4 a[8:11], v7, s[16:19], s36 offen sc1
    s_waitcnt lgkmcnt(5)
    s_mov_b32 s36, 3072
    buffer_store_dwordx4 a[12:15], v7, s[16:19], s36 offen sc1
    v_cvt_pk_bf16_f32 v84, v72, v73
    v_cvt_pk_bf16_f32 v85, v74, v75
    v_cvt_pk_bf16_f32 v86, v76, v77
    v_cvt_pk_bf16_f32 v87, v78, v79
    ds_write_b128 v2, v[84:87] offset:17408
    v_fma_f32 v64, v48, v112, 1.0
    v_fma_f32 v65, v49, v113, 1.0
    v_fma_f32 v66, v50, v114, 1.0
    v_fma_f32 v67, v51, v115, 1.0
    v_fma_f32 v68, v52, v116, 1.0
    v_fma_f32 v69, v53, v117, 1.0
    v_fma_f32 v70, v54, v118, 1.0
    v_fma_f32 v71, v55, v119, 1.0
    ds_read_b128 v[48:51], v4 offset:21248
    ds_read_b128 v[52:55], v4 offset:21280
    v_rcp_f32 v64, v64
    v_rcp_f32 v65, v65
    v_rcp_f32 v66, v66
    v_rcp_f32 v67, v67
    v_rcp_f32 v68, v68
    v_rcp_f32 v69, v69
    v_rcp_f32 v70, v70
    v_rcp_f32 v71, v71
    s_nop 0
    v_cvt_pk_bf16_f32 v80, v64, v65
    v_cvt_pk_bf16_f32 v81, v66, v67
    v_cvt_pk_bf16_f32 v82, v68, v69
    v_cvt_pk_bf16_f32 v83, v70, v71
    ds_write_b128 v2, v[80:83] offset:18432
    v_fma_f32 v72, v56, v120, 1.0
    v_fma_f32 v73, v57, v121, 1.0
    v_fma_f32 v74, v58, v122, 1.0
    v_fma_f32 v75, v59, v123, 1.0
    v_fma_f32 v76, v60, v124, 1.0
    v_fma_f32 v77, v61, v125, 1.0
    v_fma_f32 v78, v62, v126, 1.0
    v_fma_f32 v79, v63, v127, 1.0
    ds_read_b128 v[56:59], v4 offset:21312
    ds_read_b128 v[60:63], v4 offset:21344
    v_rcp_f32 v72, v72
    v_rcp_f32 v73, v73
    v_rcp_f32 v74, v74
    v_rcp_f32 v75, v75
    v_rcp_f32 v76, v76
    v_rcp_f32 v77, v77
    v_rcp_f32 v78, v78
    v_rcp_f32 v79, v79
    s_nop 0
    v_cvt_pk_bf16_f32 v84, v72, v73
    v_cvt_pk_bf16_f32 v85, v74, v75
    v_cvt_pk_bf16_f32 v86, v76, v77
    v_cvt_pk_bf16_f32 v87, v78, v79
    ds_write_b128 v2, v[84:87] offset:19456
    s_waitcnt lgkmcnt(0)
    s_barrier
    ds_read_b128 a[0:3], v6 offset:16896
    ds_read_b128 a[4:7], v6 offset:17952
    ds_read_b128 a[8:11], v6 offset:19008
    ds_read_b128 a[12:15], v6 offset:20064
    v_fma_f32 v64, v32, v96, 1.0
    v_fma_f32 v65, v33, v97, 1.0
    v_fma_f32 v66, v34, v98, 1.0
    v_fma_f32 v67, v35, v99, 1.0
    v_fma_f32 v68, v36, v100, 1.0
    v_fma_f32 v69, v37, v101, 1.0
    v_fma_f32 v70, v38, v102, 1.0
    v_fma_f32 v71, v39, v103, 1.0
    ds_read_b128 v[32:35], v4 offset:25344
    ds_read_b128 v[36:39], v4 offset:25376
    v_rcp_f32 v64, v64
    v_rcp_f32 v65, v65
    v_rcp_f32 v66, v66
    v_rcp_f32 v67, v67
    v_rcp_f32 v68, v68
    v_rcp_f32 v69, v69
    v_rcp_f32 v70, v70
    v_rcp_f32 v71, v71
    s_waitcnt lgkmcnt(5)
    s_mov_b32 s36, 16384
    buffer_store_dwordx4 a[0:3], v7, s[16:19], s36 offen sc1
    s_waitcnt lgkmcnt(4)
    s_mov_b32 s36, 17408
    buffer_store_dwordx4 a[4:7], v7, s[16:19], s36 offen sc1
    v_cvt_pk_bf16_f32 v80, v64, v65
    v_cvt_pk_bf16_f32 v81, v66, v67
    v_cvt_pk_bf16_f32 v82, v68, v69
    v_cvt_pk_bf16_f32 v83, v70, v71
    ds_write_b128 v2, v[80:83] offset:32768
    v_fma_f32 v72, v40, v104, 1.0
    v_fma_f32 v73, v41, v105, 1.0
    v_fma_f32 v74, v42, v106, 1.0
    v_fma_f32 v75, v43, v107, 1.0
    v_fma_f32 v76, v44, v108, 1.0
    v_fma_f32 v77, v45, v109, 1.0
    v_fma_f32 v78, v46, v110, 1.0
    v_fma_f32 v79, v47, v111, 1.0
    ds_read_b128 v[40:43], v4 offset:25408
    ds_read_b128 v[44:47], v4 offset:25440
    v_rcp_f32 v72, v72
    v_rcp_f32 v73, v73
    v_rcp_f32 v74, v74
    v_rcp_f32 v75, v75
    v_rcp_f32 v76, v76
    v_rcp_f32 v77, v77
    v_rcp_f32 v78, v78
    v_rcp_f32 v79, v79
    s_waitcnt lgkmcnt(6)
    s_mov_b32 s36, 18432
    buffer_store_dwordx4 a[8:11], v7, s[16:19], s36 offen sc1
    s_waitcnt lgkmcnt(5)
    s_mov_b32 s36, 19456
    buffer_store_dwordx4 a[12:15], v7, s[16:19], s36 offen sc1
    v_cvt_pk_bf16_f32 v84, v72, v73
    v_cvt_pk_bf16_f32 v85, v74, v75
    v_cvt_pk_bf16_f32 v86, v76, v77
    v_cvt_pk_bf16_f32 v87, v78, v79
    ds_write_b128 v2, v[84:87] offset:33792
    v_fma_f32 v64, v48, v112, 1.0
    v_fma_f32 v65, v49, v113, 1.0
    v_fma_f32 v66, v50, v114, 1.0
    v_fma_f32 v67, v51, v115, 1.0
    v_fma_f32 v68, v52, v116, 1.0
    v_fma_f32 v69, v53, v117, 1.0
    v_fma_f32 v70, v54, v118, 1.0
    v_fma_f32 v71, v55, v119, 1.0
    ds_read_b128 v[48:51], v4 offset:25472
    ds_read_b128 v[52:55], v4 offset:25504
    v_rcp_f32 v64, v64
    v_rcp_f32 v65, v65
    v_rcp_f32 v66, v66
    v_rcp_f32 v67, v67
    v_rcp_f32 v68, v68
    v_rcp_f32 v69, v69
    v_rcp_f32 v70, v70
    v_rcp_f32 v71, v71
    s_nop 0
    v_cvt_pk_bf16_f32 v80, v64, v65
    v_cvt_pk_bf16_f32 v81, v66, v67
    v_cvt_pk_bf16_f32 v82, v68, v69
    v_cvt_pk_bf16_f32 v83, v70, v71
    ds_write_b128 v2, v[80:83] offset:34816
    v_fma_f32 v72, v56, v120, 1.0
    v_fma_f32 v73, v57, v121, 1.0
    v_fma_f32 v74, v58, v122, 1.0
    v_fma_f32 v75, v59, v123, 1.0
    v_fma_f32 v76, v60, v124, 1.0
    v_fma_f32 v77, v61, v125, 1.0
    v_fma_f32 v78, v62, v126, 1.0
    v_fma_f32 v79, v63, v127, 1.0
    ds_read_b128 v[56:59], v4 offset:25536
    ds_read_b128 v[60:63], v4 offset:25568
    v_rcp_f32 v72, v72
    v_rcp_f32 v73, v73
    v_rcp_f32 v74, v74
    v_rcp_f32 v75, v75
    v_rcp_f32 v76, v76
    v_rcp_f32 v77, v77
    v_rcp_f32 v78, v78
    v_rcp_f32 v79, v79
    s_nop 0
    v_cvt_pk_bf16_f32 v84, v72, v73
    v_cvt_pk_bf16_f32 v85, v74, v75
    v_cvt_pk_bf16_f32 v86, v76, v77
    v_cvt_pk_bf16_f32 v87, v78, v79
    ds_write_b128 v2, v[84:87] offset:35840
    s_waitcnt lgkmcnt(0)
    s_barrier
    ds_read_b128 a[0:3], v6 offset:0
    ds_read_b128 a[4:7], v6 offset:1056
    ds_read_b128 a[8:11], v6 offset:2112
    ds_read_b128 a[12:15], v6 offset:3168
    v_fma_f32 v64, v32, v96, 1.0
    v_fma_f32 v65, v33, v97, 1.0
    v_fma_f32 v66, v34, v98, 1.0
    v_fma_f32 v67, v35, v99, 1.0
    v_fma_f32 v68, v36, v100, 1.0
    v_fma_f32 v69, v37, v101, 1.0
    v_fma_f32 v70, v38, v102, 1.0
    v_fma_f32 v71, v39, v103, 1.0
    ds_read_b128 v[32:35], v4 offset:29568
    ds_read_b128 v[36:39], v4 offset:29600
    v_rcp_f32 v64, v64
    v_rcp_f32 v65, v65
    v_rcp_f32 v66, v66
    v_rcp_f32 v67, v67
    v_rcp_f32 v68, v68
    v_rcp_f32 v69, v69
    v_rcp_f32 v70, v70
    v_rcp_f32 v71, v71
    s_waitcnt lgkmcnt(5)
    s_mov_b32 s36, 32768
    buffer_store_dwordx4 a[0:3], v7, s[16:19], s36 offen sc1
    s_waitcnt lgkmcnt(4)
    s_mov_b32 s36, 33792
    buffer_store_dwordx4 a[4:7], v7, s[16:19], s36 offen sc1
    v_cvt_pk_bf16_f32 v80, v64, v65
    v_cvt_pk_bf16_f32 v81, v66, v67
    v_cvt_pk_bf16_f32 v82, v68, v69
    v_cvt_pk_bf16_f32 v83, v70, v71
    ds_write_b128 v2, v[80:83] offset:0
    v_fma_f32 v72, v40, v104, 1.0
    v_fma_f32 v73, v41, v105, 1.0
    v_fma_f32 v74, v42, v106, 1.0
    v_fma_f32 v75, v43, v107, 1.0
    v_fma_f32 v76, v44, v108, 1.0
    v_fma_f32 v77, v45, v109, 1.0
    v_fma_f32 v78, v46, v110, 1.0
    v_fma_f32 v79, v47, v111, 1.0
    ds_read_b128 v[40:43], v4 offset:29632
    ds_read_b128 v[44:47], v4 offset:29664
    v_rcp_f32 v72, v72
    v_rcp_f32 v73, v73
    v_rcp_f32 v74, v74
    v_rcp_f32 v75, v75
    v_rcp_f32 v76, v76
    v_rcp_f32 v77, v77
    v_rcp_f32 v78, v78
    v_rcp_f32 v79, v79
    s_waitcnt lgkmcnt(6)
    s_mov_b32 s36, 34816
    buffer_store_dwordx4 a[8:11], v7, s[16:19], s36 offen sc1
    s_waitcnt lgkmcnt(5)
    s_mov_b32 s36, 35840
    buffer_store_dwordx4 a[12:15], v7, s[16:19], s36 offen sc1
    v_cvt_pk_bf16_f32 v84, v72, v73
    v_cvt_pk_bf16_f32 v85, v74, v75
    v_cvt_pk_bf16_f32 v86, v76, v77
    v_cvt_pk_bf16_f32 v87, v78, v79
    ds_write_b128 v2, v[84:87] offset:1024
    v_fma_f32 v64, v48, v112, 1.0
    v_fma_f32 v65, v49, v113, 1.0
    v_fma_f32 v66, v50, v114, 1.0
    v_fma_f32 v67, v51, v115, 1.0
    v_fma_f32 v68, v52, v116, 1.0
    v_fma_f32 v69, v53, v117, 1.0
    v_fma_f32 v70, v54, v118, 1.0
    v_fma_f32 v71, v55, v119, 1.0
    ds_read_b128 v[48:51], v4 offset:29696
    ds_read_b128 v[52:55], v4 offset:29728
    v_rcp_f32 v64, v64
    v_rcp_f32 v65, v65
    v_rcp_f32 v66, v66
    v_rcp_f32 v67, v67
    v_rcp_f32 v68, v68
    v_rcp_f32 v69, v69
    v_rcp_f32 v70, v70
    v_rcp_f32 v71, v71
    s_nop 0
    v_cvt_pk_bf16_f32 v80, v64, v65
    v_cvt_pk_bf16_f32 v81, v66, v67
    v_cvt_pk_bf16_f32 v82, v68, v69
    v_cvt_pk_bf16_f32 v83, v70, v71
    ds_write_b128 v2, v[80:83] offset:2048
    v_fma_f32 v72, v56, v120, 1.0
    v_fma_f32 v73, v57, v121, 1.0
    v_fma_f32 v74, v58, v122, 1.0
    v_fma_f32 v75, v59, v123, 1.0
    v_fma_f32 v76, v60, v124, 1.0
    v_fma_f32 v77, v61, v125, 1.0
    v_fma_f32 v78, v62, v126, 1.0
    v_fma_f32 v79, v63, v127, 1.0
    ds_read_b128 v[56:59], v4 offset:29760
    ds_read_b128 v[60:63], v4 offset:29792
    v_rcp_f32 v72, v72
    v_rcp_f32 v73, v73
    v_rcp_f32 v74, v74
    v_rcp_f32 v75, v75
    v_rcp_f32 v76, v76
    v_rcp_f32 v77, v77
    v_rcp_f32 v78, v78
    v_rcp_f32 v79, v79
    s_nop 0
    v_cvt_pk_bf16_f32 v84, v72, v73
    v_cvt_pk_bf16_f32 v85, v74, v75
    v_cvt_pk_bf16_f32 v86, v76, v77
    v_cvt_pk_bf16_f32 v87, v78, v79
    ds_write_b128 v2, v[84:87] offset:3072
    s_waitcnt lgkmcnt(0)
    s_barrier
    ds_read_b128 a[0:3], v6 offset:16896
    ds_read_b128 a[4:7], v6 offset:17952
    ds_read_b128 a[8:11], v6 offset:19008
    ds_read_b128 a[12:15], v6 offset:20064
    v_fma_f32 v64, v32, v96, 1.0
    v_fma_f32 v65, v33, v97, 1.0
    v_fma_f32 v66, v34, v98, 1.0
    v_fma_f32 v67, v35, v99, 1.0
    v_fma_f32 v68, v36, v100, 1.0
    v_fma_f32 v69, v37, v101, 1.0
    v_fma_f32 v70, v38, v102, 1.0
    v_fma_f32 v71, v39, v103, 1.0
    v_rcp_f32 v64, v64
    v_rcp_f32 v65, v65
    v_rcp_f32 v66, v66
    v_rcp_f32 v67, v67
    v_rcp_f32 v68, v68
    v_rcp_f32 v69, v69
    v_rcp_f32 v70, v70
    v_rcp_f32 v71, v71
    s_waitcnt lgkmcnt(3)
    s_mov_b32 s36, 49152
    buffer_store_dwordx4 a[0:3], v7, s[16:19], s36 offen sc1
    s_waitcnt lgkmcnt(2)
    s_mov_b32 s36, 50176
    buffer_store_dwordx4 a[4:7], v7, s[16:19], s36 offen sc1
    v_cvt_pk_bf16_f32 v80, v64, v65
    v_cvt_pk_bf16_f32 v81, v66, v67
    v_cvt_pk_bf16_f32 v82, v68, v69
    v_cvt_pk_bf16_f32 v83, v70, v71
    ds_write_b128 v2, v[80:83] offset:16384
    v_fma_f32 v72, v40, v104, 1.0
    v_fma_f32 v73, v41, v105, 1.0
    v_fma_f32 v74, v42, v106, 1.0
    v_fma_f32 v75, v43, v107, 1.0
    v_fma_f32 v76, v44, v108, 1.0
    v_fma_f32 v77, v45, v109, 1.0
    v_fma_f32 v78, v46, v110, 1.0
    v_fma_f32 v79, v47, v111, 1.0
    v_rcp_f32 v72, v72
    v_rcp_f32 v73, v73
    v_rcp_f32 v74, v74
    v_rcp_f32 v75, v75
    v_rcp_f32 v76, v76
    v_rcp_f32 v77, v77
    v_rcp_f32 v78, v78
    v_rcp_f32 v79, v79
    s_waitcnt lgkmcnt(2)
    s_mov_b32 s36, 51200
    buffer_store_dwordx4 a[8:11], v7, s[16:19], s36 offen sc1
    s_waitcnt lgkmcnt(1)
    s_mov_b32 s36, 52224
    buffer_store_dwordx4 a[12:15], v7, s[16:19], s36 offen sc1
    v_cvt_pk_bf16_f32 v84, v72, v73
    v_cvt_pk_bf16_f32 v85, v74, v75
    v_cvt_pk_bf16_f32 v86, v76, v77
    v_cvt_pk_bf16_f32 v87, v78, v79
    ds_write_b128 v2, v[84:87] offset:17408
    v_fma_f32 v64, v48, v112, 1.0
    v_fma_f32 v65, v49, v113, 1.0
    v_fma_f32 v66, v50, v114, 1.0
    v_fma_f32 v67, v51, v115, 1.0
    v_fma_f32 v68, v52, v116, 1.0
    v_fma_f32 v69, v53, v117, 1.0
    v_fma_f32 v70, v54, v118, 1.0
    v_fma_f32 v71, v55, v119, 1.0
    v_rcp_f32 v64, v64
    v_rcp_f32 v65, v65
    v_rcp_f32 v66, v66
    v_rcp_f32 v67, v67
    v_rcp_f32 v68, v68
    v_rcp_f32 v69, v69
    v_rcp_f32 v70, v70
    v_rcp_f32 v71, v71
    s_nop 0
    v_cvt_pk_bf16_f32 v80, v64, v65
    v_cvt_pk_bf16_f32 v81, v66, v67
    v_cvt_pk_bf16_f32 v82, v68, v69
    v_cvt_pk_bf16_f32 v83, v70, v71
    ds_write_b128 v2, v[80:83] offset:18432
    v_fma_f32 v72, v56, v120, 1.0
    v_fma_f32 v73, v57, v121, 1.0
    v_fma_f32 v74, v58, v122, 1.0
    v_fma_f32 v75, v59, v123, 1.0
    v_fma_f32 v76, v60, v124, 1.0
    v_fma_f32 v77, v61, v125, 1.0
    v_fma_f32 v78, v62, v126, 1.0
    v_fma_f32 v79, v63, v127, 1.0
    v_rcp_f32 v72, v72
    v_rcp_f32 v73, v73
    v_rcp_f32 v74, v74
    v_rcp_f32 v75, v75
    v_rcp_f32 v76, v76
    v_rcp_f32 v77, v77
    v_rcp_f32 v78, v78
    v_rcp_f32 v79, v79
    s_nop 0
    v_cvt_pk_bf16_f32 v84, v72, v73
    v_cvt_pk_bf16_f32 v85, v74, v75
    v_cvt_pk_bf16_f32 v86, v76, v77
    v_cvt_pk_bf16_f32 v87, v78, v79
    ds_write_b128 v2, v[84:87] offset:19456
    s_waitcnt lgkmcnt(0)
    s_barrier
    ds_read_b128 a[0:3], v6 offset:0
    ds_read_b128 a[4:7], v6 offset:1056
    ds_read_b128 a[8:11], v6 offset:2112
    ds_read_b128 a[12:15], v6 offset:3168
    s_waitcnt lgkmcnt(3)
    s_mov_b32 s36, 65536
    buffer_store_dwordx4 a[0:3], v7, s[16:19], s36 offen sc1
    s_waitcnt lgkmcnt(2)
    s_mov_b32 s36, 66560
    buffer_store_dwordx4 a[4:7], v7, s[16:19], s36 offen sc1
    s_waitcnt lgkmcnt(1)
    s_mov_b32 s36, 67584
    buffer_store_dwordx4 a[8:11], v7, s[16:19], s36 offen sc1
    s_waitcnt lgkmcnt(0)
    s_mov_b32 s36, 68608
    buffer_store_dwordx4 a[12:15], v7, s[16:19], s36 offen sc1
    s_barrier
    ds_read_b128 a[0:3], v6 offset:16896
    ds_read_b128 a[4:7], v6 offset:17952
    ds_read_b128 a[8:11], v6 offset:19008
    ds_read_b128 a[12:15], v6 offset:20064
    s_waitcnt lgkmcnt(3)
    s_mov_b32 s36, 81920
    buffer_store_dwordx4 a[0:3], v7, s[16:19], s36 offen sc1
    s_waitcnt lgkmcnt(2)
    s_mov_b32 s36, 82944
    buffer_store_dwordx4 a[4:7], v7, s[16:19], s36 offen sc1
    s_waitcnt lgkmcnt(1)
    s_mov_b32 s36, 83968
    buffer_store_dwordx4 a[8:11], v7, s[16:19], s36 offen sc1
    s_waitcnt lgkmcnt(0)
    s_mov_b32 s36, 84992
    buffer_store_dwordx4 a[12:15], v7, s[16:19], s36 offen sc1
    s_barrier
    ds_read_b128 a[0:3], v6 offset:0
    ds_read_b128 a[4:7], v6 offset:1056
    ds_read_b128 a[8:11], v6 offset:2112
    ds_read_b128 a[12:15], v6 offset:3168
    s_waitcnt lgkmcnt(3)
    s_mov_b32 s36, 98304
    buffer_store_dwordx4 a[0:3], v7, s[16:19], s36 offen sc1
    s_waitcnt lgkmcnt(2)
    s_mov_b32 s36, 99328
    buffer_store_dwordx4 a[4:7], v7, s[16:19], s36 offen sc1
    s_waitcnt lgkmcnt(1)
    s_mov_b32 s36, 100352
    buffer_store_dwordx4 a[8:11], v7, s[16:19], s36 offen sc1
    s_waitcnt lgkmcnt(0)
    s_mov_b32 s36, 101376
    buffer_store_dwordx4 a[12:15], v7, s[16:19], s36 offen sc1
    s_barrier
    ds_read_b128 a[0:3], v6 offset:16896
    ds_read_b128 a[4:7], v6 offset:17952
    ds_read_b128 a[8:11], v6 offset:19008
    ds_read_b128 a[12:15], v6 offset:20064
    s_waitcnt lgkmcnt(3)
    s_mov_b32 s36, 114688
    buffer_store_dwordx4 a[0:3], v7, s[16:19], s36 offen sc1
    s_waitcnt lgkmcnt(2)
    s_mov_b32 s36, 115712
    buffer_store_dwordx4 a[4:7], v7, s[16:19], s36 offen sc1
    s_waitcnt lgkmcnt(1)
    s_mov_b32 s36, 116736
    buffer_store_dwordx4 a[8:11], v7, s[16:19], s36 offen sc1
    s_waitcnt lgkmcnt(0)
    s_mov_b32 s36, 117760
    buffer_store_dwordx4 a[12:15], v7, s[16:19], s36 offen sc1
    s_endpgm
L_joint_kernel_slow:
    buffer_load_dwordx4 v[96:99], v14, s[12:15], s37 offen offset:0
    buffer_load_dwordx4 v[100:103], v14, s[12:15], s37 offen offset:32
    buffer_load_dwordx4 v[104:107], v14, s[12:15], s37 offen offset:64
    buffer_load_dwordx4 v[108:111], v14, s[12:15], s37 offen offset:96
    buffer_load_dwordx4 v[112:115], v14, s[12:15], s37 offen offset:128
    buffer_load_dwordx4 v[116:119], v14, s[12:15], s37 offen offset:160
    buffer_load_dwordx4 v[120:123], v14, s[12:15], s37 offen offset:192
    buffer_load_dwordx4 v[124:127], v14, s[12:15], s37 offen offset:224
    s_waitcnt vmcnt(0)
    ds_write_b128 v9, v[64:67] offset:0
    ds_write_b128 v9, v[68:71] offset:32
    ds_write_b128 v9, v[72:75] offset:64
    ds_write_b128 v9, v[76:79] offset:96
    ds_write_b128 v9, v[80:83] offset:128
    ds_write_b128 v9, v[84:87] offset:160
    ds_write_b128 v9, v[88:91] offset:192
    ds_write_b128 v9, v[92:95] offset:224
    s_waitcnt lgkmcnt(0)
    ds_read_b128 v[32:35], v4 offset:0
    ds_read_b128 v[36:39], v4 offset:32
    ds_read_b128 v[40:43], v4 offset:64
    ds_read_b128 v[44:47], v4 offset:96
    ds_read_b128 v[48:51], v4 offset:128
    ds_read_b128 v[52:55], v4 offset:160
    ds_read_b128 v[56:59], v4 offset:192
    ds_read_b128 v[60:63], v4 offset:224
    s_waitcnt lgkmcnt(6)
    v_add_f32 v64, v32, v96
    v_add_f32 v65, v33, v97
    v_add_f32 v66, v34, v98
    v_add_f32 v67, v35, v99
    v_add_f32 v68, v36, v100
    v_add_f32 v69, v37, v101
    v_add_f32 v70, v38, v102
    v_add_f32 v71, v39, v103
    ds_read_b128 v[32:35], v4 offset:4224
    ds_read_b128 v[36:39], v4 offset:4256
    v_exp_f32 v64, v64
    v_exp_f32 v65, v65
    v_exp_f32 v66, v66
    v_exp_f32 v67, v67
    v_exp_f32 v68, v68
    v_exp_f32 v69, v69
    v_exp_f32 v70, v70
    v_exp_f32 v71, v71
    v_add_f32 v64, 1.0, v64
    v_add_f32 v65, 1.0, v65
    v_add_f32 v66, 1.0, v66
    v_add_f32 v67, 1.0, v67
    v_add_f32 v68, 1.0, v68
    v_add_f32 v69, 1.0, v69
    v_add_f32 v70, 1.0, v70
    v_add_f32 v71, 1.0, v71
    v_rcp_f32 v64, v64
    v_rcp_f32 v65, v65
    v_rcp_f32 v66, v66
    v_rcp_f32 v67, v67
    v_rcp_f32 v68, v68
    v_rcp_f32 v69, v69
    v_rcp_f32 v70, v70
    v_rcp_f32 v71, v71
    s_nop 0
    v_cvt_pk_bf16_f32 v80, v64, v65
    v_cvt_pk_bf16_f32 v81, v66, v67
    v_cvt_pk_bf16_f32 v82, v68, v69
    v_cvt_pk_bf16_f32 v83, v70, v71
    ds_write_b128 v2, v[80:83] offset:0
    s_waitcnt lgkmcnt(7)
    v_add_f32 v72, v40, v104
    v_add_f32 v73, v41, v105
    v_add_f32 v74, v42, v106
    v_add_f32 v75, v43, v107
    v_add_f32 v76, v44, v108
    v_add_f32 v77, v45, v109
    v_add_f32 v78, v46, v110
    v_add_f32 v79, v47, v111
    ds_read_b128 v[40:43], v4 offset:4288
    ds_read_b128 v[44:47], v4 offset:4320
    v_exp_f32 v72, v72
    v_exp_f32 v73, v73
    v_exp_f32 v74, v74
    v_exp_f32 v75, v75
    v_exp_f32 v76, v76
    v_exp_f32 v77, v77
    v_exp_f32 v78, v78
    v_exp_f32 v79, v79
    v_add_f32 v72, 1.0, v72
    v_add_f32 v73, 1.0, v73
    v_add_f32 v74, 1.0, v74
    v_add_f32 v75, 1.0, v75
    v_add_f32 v76, 1.0, v76
    v_add_f32 v77, 1.0, v77
    v_add_f32 v78, 1.0, v78
    v_add_f32 v79, 1.0, v79
    v_rcp_f32 v72, v72
    v_rcp_f32 v73, v73
    v_rcp_f32 v74, v74
    v_rcp_f32 v75, v75
    v_rcp_f32 v76, v76
    v_rcp_f32 v77, v77
    v_rcp_f32 v78, v78
    v_rcp_f32 v79, v79
    s_nop 0
    v_cvt_pk_bf16_f32 v84, v72, v73
    v_cvt_pk_bf16_f32 v85, v74, v75
    v_cvt_pk_bf16_f32 v86, v76, v77
    v_cvt_pk_bf16_f32 v87, v78, v79
    ds_write_b128 v2, v[84:87] offset:1024
    s_waitcnt lgkmcnt(8)
    v_add_f32 v64, v48, v112
    v_add_f32 v65, v49, v113
    v_add_f32 v66, v50, v114
    v_add_f32 v67, v51, v115
    v_add_f32 v68, v52, v116
    v_add_f32 v69, v53, v117
    v_add_f32 v70, v54, v118
    v_add_f32 v71, v55, v119
    ds_read_b128 v[48:51], v4 offset:4352
    ds_read_b128 v[52:55], v4 offset:4384
    v_exp_f32 v64, v64
    v_exp_f32 v65, v65
    v_exp_f32 v66, v66
    v_exp_f32 v67, v67
    v_exp_f32 v68, v68
    v_exp_f32 v69, v69
    v_exp_f32 v70, v70
    v_exp_f32 v71, v71
    v_add_f32 v64, 1.0, v64
    v_add_f32 v65, 1.0, v65
    v_add_f32 v66, 1.0, v66
    v_add_f32 v67, 1.0, v67
    v_add_f32 v68, 1.0, v68
    v_add_f32 v69, 1.0, v69
    v_add_f32 v70, 1.0, v70
    v_add_f32 v71, 1.0, v71
    v_rcp_f32 v64, v64
    v_rcp_f32 v65, v65
    v_rcp_f32 v66, v66
    v_rcp_f32 v67, v67
    v_rcp_f32 v68, v68
    v_rcp_f32 v69, v69
    v_rcp_f32 v70, v70
    v_rcp_f32 v71, v71
    s_nop 0
    v_cvt_pk_bf16_f32 v80, v64, v65
    v_cvt_pk_bf16_f32 v81, v66, v67
    v_cvt_pk_bf16_f32 v82, v68, v69
    v_cvt_pk_bf16_f32 v83, v70, v71
    ds_write_b128 v2, v[80:83] offset:2048
    s_waitcnt lgkmcnt(9)
    v_add_f32 v72, v56, v120
    v_add_f32 v73, v57, v121
    v_add_f32 v74, v58, v122
    v_add_f32 v75, v59, v123
    v_add_f32 v76, v60, v124
    v_add_f32 v77, v61, v125
    v_add_f32 v78, v62, v126
    v_add_f32 v79, v63, v127
    ds_read_b128 v[56:59], v4 offset:4416
    ds_read_b128 v[60:63], v4 offset:4448
    v_exp_f32 v72, v72
    v_exp_f32 v73, v73
    v_exp_f32 v74, v74
    v_exp_f32 v75, v75
    v_exp_f32 v76, v76
    v_exp_f32 v77, v77
    v_exp_f32 v78, v78
    v_exp_f32 v79, v79
    v_add_f32 v72, 1.0, v72
    v_add_f32 v73, 1.0, v73
    v_add_f32 v74, 1.0, v74
    v_add_f32 v75, 1.0, v75
    v_add_f32 v76, 1.0, v76
    v_add_f32 v77, 1.0, v77
    v_add_f32 v78, 1.0, v78
    v_add_f32 v79, 1.0, v79
    v_rcp_f32 v72, v72
    v_rcp_f32 v73, v73
    v_rcp_f32 v74, v74
    v_rcp_f32 v75, v75
    v_rcp_f32 v76, v76
    v_rcp_f32 v77, v77
    v_rcp_f32 v78, v78
    v_rcp_f32 v79, v79
    s_nop 0
    v_cvt_pk_bf16_f32 v84, v72, v73
    v_cvt_pk_bf16_f32 v85, v74, v75
    v_cvt_pk_bf16_f32 v86, v76, v77
    v_cvt_pk_bf16_f32 v87, v78, v79
    ds_write_b128 v2, v[84:87] offset:3072
    s_waitcnt lgkmcnt(10)
    v_add_f32 v64, v32, v96
    v_add_f32 v65, v33, v97
    v_add_f32 v66, v34, v98
    v_add_f32 v67, v35, v99
    v_add_f32 v68, v36, v100
    v_add_f32 v69, v37, v101
    v_add_f32 v70, v38, v102
    v_add_f32 v71, v39, v103
    ds_read_b128 v[32:35], v4 offset:8448
    ds_read_b128 v[36:39], v4 offset:8480
    v_exp_f32 v64, v64
    v_exp_f32 v65, v65
    v_exp_f32 v66, v66
    v_exp_f32 v67, v67
    v_exp_f32 v68, v68
    v_exp_f32 v69, v69
    v_exp_f32 v70, v70
    v_exp_f32 v71, v71
    v_add_f32 v64, 1.0, v64
    v_add_f32 v65, 1.0, v65
    v_add_f32 v66, 1.0, v66
    v_add_f32 v67, 1.0, v67
    v_add_f32 v68, 1.0, v68
    v_add_f32 v69, 1.0, v69
    v_add_f32 v70, 1.0, v70
    v_add_f32 v71, 1.0, v71
    v_rcp_f32 v64, v64
    v_rcp_f32 v65, v65
    v_rcp_f32 v66, v66
    v_rcp_f32 v67, v67
    v_rcp_f32 v68, v68
    v_rcp_f32 v69, v69
    v_rcp_f32 v70, v70
    v_rcp_f32 v71, v71
    s_nop 0
    v_cvt_pk_bf16_f32 v80, v64, v65
    v_cvt_pk_bf16_f32 v81, v66, v67
    v_cvt_pk_bf16_f32 v82, v68, v69
    v_cvt_pk_bf16_f32 v83, v70, v71
    ds_write_b128 v2, v[80:83] offset:16384
    s_waitcnt lgkmcnt(10)
    v_add_f32 v72, v40, v104
    v_add_f32 v73, v41, v105
    v_add_f32 v74, v42, v106
    v_add_f32 v75, v43, v107
    v_add_f32 v76, v44, v108
    v_add_f32 v77, v45, v109
    v_add_f32 v78, v46, v110
    v_add_f32 v79, v47, v111
    ds_read_b128 v[40:43], v4 offset:8512
    ds_read_b128 v[44:47], v4 offset:8544
    v_exp_f32 v72, v72
    v_exp_f32 v73, v73
    v_exp_f32 v74, v74
    v_exp_f32 v75, v75
    v_exp_f32 v76, v76
    v_exp_f32 v77, v77
    v_exp_f32 v78, v78
    v_exp_f32 v79, v79
    v_add_f32 v72, 1.0, v72
    v_add_f32 v73, 1.0, v73
    v_add_f32 v74, 1.0, v74
    v_add_f32 v75, 1.0, v75
    v_add_f32 v76, 1.0, v76
    v_add_f32 v77, 1.0, v77
    v_add_f32 v78, 1.0, v78
    v_add_f32 v79, 1.0, v79
    v_rcp_f32 v72, v72
    v_rcp_f32 v73, v73
    v_rcp_f32 v74, v74
    v_rcp_f32 v75, v75
    v_rcp_f32 v76, v76
    v_rcp_f32 v77, v77
    v_rcp_f32 v78, v78
    v_rcp_f32 v79, v79
    s_nop 0
    v_cvt_pk_bf16_f32 v84, v72, v73
    v_cvt_pk_bf16_f32 v85, v74, v75
    v_cvt_pk_bf16_f32 v86, v76, v77
    v_cvt_pk_bf16_f32 v87, v78, v79
    ds_write_b128 v2, v[84:87] offset:17408
    s_waitcnt lgkmcnt(10)
    v_add_f32 v64, v48, v112
    v_add_f32 v65, v49, v113
    v_add_f32 v66, v50, v114
    v_add_f32 v67, v51, v115
    v_add_f32 v68, v52, v116
    v_add_f32 v69, v53, v117
    v_add_f32 v70, v54, v118
    v_add_f32 v71, v55, v119
    ds_read_b128 v[48:51], v4 offset:8576
    ds_read_b128 v[52:55], v4 offset:8608
    v_exp_f32 v64, v64
    v_exp_f32 v65, v65
    v_exp_f32 v66, v66
    v_exp_f32 v67, v67
    v_exp_f32 v68, v68
    v_exp_f32 v69, v69
    v_exp_f32 v70, v70
    v_exp_f32 v71, v71
    v_add_f32 v64, 1.0, v64
    v_add_f32 v65, 1.0, v65
    v_add_f32 v66, 1.0, v66
    v_add_f32 v67, 1.0, v67
    v_add_f32 v68, 1.0, v68
    v_add_f32 v69, 1.0, v69
    v_add_f32 v70, 1.0, v70
    v_add_f32 v71, 1.0, v71
    v_rcp_f32 v64, v64
    v_rcp_f32 v65, v65
    v_rcp_f32 v66, v66
    v_rcp_f32 v67, v67
    v_rcp_f32 v68, v68
    v_rcp_f32 v69, v69
    v_rcp_f32 v70, v70
    v_rcp_f32 v71, v71
    s_nop 0
    v_cvt_pk_bf16_f32 v80, v64, v65
    v_cvt_pk_bf16_f32 v81, v66, v67
    v_cvt_pk_bf16_f32 v82, v68, v69
    v_cvt_pk_bf16_f32 v83, v70, v71
    ds_write_b128 v2, v[80:83] offset:18432
    s_waitcnt lgkmcnt(10)
    v_add_f32 v72, v56, v120
    v_add_f32 v73, v57, v121
    v_add_f32 v74, v58, v122
    v_add_f32 v75, v59, v123
    v_add_f32 v76, v60, v124
    v_add_f32 v77, v61, v125
    v_add_f32 v78, v62, v126
    v_add_f32 v79, v63, v127
    ds_read_b128 v[56:59], v4 offset:8640
    ds_read_b128 v[60:63], v4 offset:8672
    v_exp_f32 v72, v72
    v_exp_f32 v73, v73
    v_exp_f32 v74, v74
    v_exp_f32 v75, v75
    v_exp_f32 v76, v76
    v_exp_f32 v77, v77
    v_exp_f32 v78, v78
    v_exp_f32 v79, v79
    v_add_f32 v72, 1.0, v72
    v_add_f32 v73, 1.0, v73
    v_add_f32 v74, 1.0, v74
    v_add_f32 v75, 1.0, v75
    v_add_f32 v76, 1.0, v76
    v_add_f32 v77, 1.0, v77
    v_add_f32 v78, 1.0, v78
    v_add_f32 v79, 1.0, v79
    v_rcp_f32 v72, v72
    v_rcp_f32 v73, v73
    v_rcp_f32 v74, v74
    v_rcp_f32 v75, v75
    v_rcp_f32 v76, v76
    v_rcp_f32 v77, v77
    v_rcp_f32 v78, v78
    v_rcp_f32 v79, v79
    s_nop 0
    v_cvt_pk_bf16_f32 v84, v72, v73
    v_cvt_pk_bf16_f32 v85, v74, v75
    v_cvt_pk_bf16_f32 v86, v76, v77
    v_cvt_pk_bf16_f32 v87, v78, v79
    ds_write_b128 v2, v[84:87] offset:19456
    s_waitcnt lgkmcnt(0)
    s_barrier
    v_add_f32 v64, v32, v96
    v_add_f32 v65, v33, v97
    v_add_f32 v66, v34, v98
    v_add_f32 v67, v35, v99
    v_add_f32 v68, v36, v100
    v_add_f32 v69, v37, v101
    v_add_f32 v70, v38, v102
    v_add_f32 v71, v39, v103
    ds_read_b128 v[32:35], v4 offset:12672
    ds_read_b128 v[36:39], v4 offset:12704
    v_exp_f32 v64, v64
    v_exp_f32 v65, v65
    v_exp_f32 v66, v66
    v_exp_f32 v67, v67
    v_exp_f32 v68, v68
    v_exp_f32 v69, v69
    v_exp_f32 v70, v70
    v_exp_f32 v71, v71
    v_add_f32 v64, 1.0, v64
    v_add_f32 v65, 1.0, v65
    v_add_f32 v66, 1.0, v66
    v_add_f32 v67, 1.0, v67
    v_add_f32 v68, 1.0, v68
    v_add_f32 v69, 1.0, v69
    v_add_f32 v70, 1.0, v70
    v_add_f32 v71, 1.0, v71
    v_rcp_f32 v64, v64
    v_rcp_f32 v65, v65
    v_rcp_f32 v66, v66
    v_rcp_f32 v67, v67
    v_rcp_f32 v68, v68
    v_rcp_f32 v69, v69
    v_rcp_f32 v70, v70
    v_rcp_f32 v71, v71
    s_nop 0
    v_cvt_pk_bf16_f32 v80, v64, v65
    v_cvt_pk_bf16_f32 v81, v66, v67
    v_cvt_pk_bf16_f32 v82, v68, v69
    v_cvt_pk_bf16_f32 v83, v70, v71
    ds_write_b128 v2, v[80:83] offset:32768
    v_add_f32 v72, v40, v104
    v_add_f32 v73, v41, v105
    v_add_f32 v74, v42, v106
    v_add_f32 v75, v43, v107
    v_add_f32 v76, v44, v108
    v_add_f32 v77, v45, v109
    v_add_f32 v78, v46, v110
    v_add_f32 v79, v47, v111
    ds_read_b128 v[40:43], v4 offset:12736
    ds_read_b128 v[44:47], v4 offset:12768
    v_exp_f32 v72, v72
    v_exp_f32 v73, v73
    v_exp_f32 v74, v74
    v_exp_f32 v75, v75
    v_exp_f32 v76, v76
    v_exp_f32 v77, v77
    v_exp_f32 v78, v78
    v_exp_f32 v79, v79
    v_add_f32 v72, 1.0, v72
    v_add_f32 v73, 1.0, v73
    v_add_f32 v74, 1.0, v74
    v_add_f32 v75, 1.0, v75
    v_add_f32 v76, 1.0, v76
    v_add_f32 v77, 1.0, v77
    v_add_f32 v78, 1.0, v78
    v_add_f32 v79, 1.0, v79
    v_rcp_f32 v72, v72
    v_rcp_f32 v73, v73
    v_rcp_f32 v74, v74
    v_rcp_f32 v75, v75
    v_rcp_f32 v76, v76
    v_rcp_f32 v77, v77
    v_rcp_f32 v78, v78
    v_rcp_f32 v79, v79
    s_nop 0
    v_cvt_pk_bf16_f32 v84, v72, v73
    v_cvt_pk_bf16_f32 v85, v74, v75
    v_cvt_pk_bf16_f32 v86, v76, v77
    v_cvt_pk_bf16_f32 v87, v78, v79
    ds_write_b128 v2, v[84:87] offset:33792
    v_add_f32 v64, v48, v112
    v_add_f32 v65, v49, v113
    v_add_f32 v66, v50, v114
    v_add_f32 v67, v51, v115
    v_add_f32 v68, v52, v116
    v_add_f32 v69, v53, v117
    v_add_f32 v70, v54, v118
    v_add_f32 v71, v55, v119
    ds_read_b128 v[48:51], v4 offset:12800
    ds_read_b128 v[52:55], v4 offset:12832
    v_exp_f32 v64, v64
    v_exp_f32 v65, v65
    v_exp_f32 v66, v66
    v_exp_f32 v67, v67
    v_exp_f32 v68, v68
    v_exp_f32 v69, v69
    v_exp_f32 v70, v70
    v_exp_f32 v71, v71
    v_add_f32 v64, 1.0, v64
    v_add_f32 v65, 1.0, v65
    v_add_f32 v66, 1.0, v66
    v_add_f32 v67, 1.0, v67
    v_add_f32 v68, 1.0, v68
    v_add_f32 v69, 1.0, v69
    v_add_f32 v70, 1.0, v70
    v_add_f32 v71, 1.0, v71
    v_rcp_f32 v64, v64
    v_rcp_f32 v65, v65
    v_rcp_f32 v66, v66
    v_rcp_f32 v67, v67
    v_rcp_f32 v68, v68
    v_rcp_f32 v69, v69
    v_rcp_f32 v70, v70
    v_rcp_f32 v71, v71
    s_nop 0
    v_cvt_pk_bf16_f32 v80, v64, v65
    v_cvt_pk_bf16_f32 v81, v66, v67
    v_cvt_pk_bf16_f32 v82, v68, v69
    v_cvt_pk_bf16_f32 v83, v70, v71
    ds_write_b128 v2, v[80:83] offset:34816
    v_add_f32 v72, v56, v120
    v_add_f32 v73, v57, v121
    v_add_f32 v74, v58, v122
    v_add_f32 v75, v59, v123
    v_add_f32 v76, v60, v124
    v_add_f32 v77, v61, v125
    v_add_f32 v78, v62, v126
    v_add_f32 v79, v63, v127
    ds_read_b128 v[56:59], v4 offset:12864
    ds_read_b128 v[60:63], v4 offset:12896
    v_exp_f32 v72, v72
    v_exp_f32 v73, v73
    v_exp_f32 v74, v74
    v_exp_f32 v75, v75
    v_exp_f32 v76, v76
    v_exp_f32 v77, v77
    v_exp_f32 v78, v78
    v_exp_f32 v79, v79
    v_add_f32 v72, 1.0, v72
    v_add_f32 v73, 1.0, v73
    v_add_f32 v74, 1.0, v74
    v_add_f32 v75, 1.0, v75
    v_add_f32 v76, 1.0, v76
    v_add_f32 v77, 1.0, v77
    v_add_f32 v78, 1.0, v78
    v_add_f32 v79, 1.0, v79
    v_rcp_f32 v72, v72
    v_rcp_f32 v73, v73
    v_rcp_f32 v74, v74
    v_rcp_f32 v75, v75
    v_rcp_f32 v76, v76
    v_rcp_f32 v77, v77
    v_rcp_f32 v78, v78
    v_rcp_f32 v79, v79
    s_nop 0
    v_cvt_pk_bf16_f32 v84, v72, v73
    v_cvt_pk_bf16_f32 v85, v74, v75
    v_cvt_pk_bf16_f32 v86, v76, v77
    v_cvt_pk_bf16_f32 v87, v78, v79
    ds_write_b128 v2, v[84:87] offset:35840
    s_waitcnt lgkmcnt(0)
    s_barrier
    v_add_f32 v64, v32, v96
    v_add_f32 v65, v33, v97
    v_add_f32 v66, v34, v98
    v_add_f32 v67, v35, v99
    v_add_f32 v68, v36, v100
    v_add_f32 v69, v37, v101
    v_add_f32 v70, v38, v102
    v_add_f32 v71, v39, v103
    ds_read_b128 v[32:35], v4 offset:16896
    ds_read_b128 v[36:39], v4 offset:16928
    v_exp_f32 v64, v64
    v_exp_f32 v65, v65
    v_exp_f32 v66, v66
    v_exp_f32 v67, v67
    v_exp_f32 v68, v68
    v_exp_f32 v69, v69
    v_exp_f32 v70, v70
    v_exp_f32 v71, v71
    v_add_f32 v64, 1.0, v64
    v_add_f32 v65, 1.0, v65
    v_add_f32 v66, 1.0, v66
    v_add_f32 v67, 1.0, v67
    v_add_f32 v68, 1.0, v68
    v_add_f32 v69, 1.0, v69
    v_add_f32 v70, 1.0, v70
    v_add_f32 v71, 1.0, v71
    v_rcp_f32 v64, v64
    v_rcp_f32 v65, v65
    v_rcp_f32 v66, v66
    v_rcp_f32 v67, v67
    v_rcp_f32 v68, v68
    v_rcp_f32 v69, v69
    v_rcp_f32 v70, v70
    v_rcp_f32 v71, v71
    s_nop 0
    v_cvt_pk_bf16_f32 v80, v64, v65
    v_cvt_pk_bf16_f32 v81, v66, v67
    v_cvt_pk_bf16_f32 v82, v68, v69
    v_cvt_pk_bf16_f32 v83, v70, v71
    ds_write_b128 v2, v[80:83] offset:0
    v_add_f32 v72, v40, v104
    v_add_f32 v73, v41, v105
    v_add_f32 v74, v42, v106
    v_add_f32 v75, v43, v107
    v_add_f32 v76, v44, v108
    v_add_f32 v77, v45, v109
    v_add_f32 v78, v46, v110
    v_add_f32 v79, v47, v111
    ds_read_b128 v[40:43], v4 offset:16960
    ds_read_b128 v[44:47], v4 offset:16992
    v_exp_f32 v72, v72
    v_exp_f32 v73, v73
    v_exp_f32 v74, v74
    v_exp_f32 v75, v75
    v_exp_f32 v76, v76
    v_exp_f32 v77, v77
    v_exp_f32 v78, v78
    v_exp_f32 v79, v79
    v_add_f32 v72, 1.0, v72
    v_add_f32 v73, 1.0, v73
    v_add_f32 v74, 1.0, v74
    v_add_f32 v75, 1.0, v75
    v_add_f32 v76, 1.0, v76
    v_add_f32 v77, 1.0, v77
    v_add_f32 v78, 1.0, v78
    v_add_f32 v79, 1.0, v79
    v_rcp_f32 v72, v72
    v_rcp_f32 v73, v73
    v_rcp_f32 v74, v74
    v_rcp_f32 v75, v75
    v_rcp_f32 v76, v76
    v_rcp_f32 v77, v77
    v_rcp_f32 v78, v78
    v_rcp_f32 v79, v79
    s_nop 0
    v_cvt_pk_bf16_f32 v84, v72, v73
    v_cvt_pk_bf16_f32 v85, v74, v75
    v_cvt_pk_bf16_f32 v86, v76, v77
    v_cvt_pk_bf16_f32 v87, v78, v79
    ds_write_b128 v2, v[84:87] offset:1024
    v_add_f32 v64, v48, v112
    v_add_f32 v65, v49, v113
    v_add_f32 v66, v50, v114
    v_add_f32 v67, v51, v115
    v_add_f32 v68, v52, v116
    v_add_f32 v69, v53, v117
    v_add_f32 v70, v54, v118
    v_add_f32 v71, v55, v119
    ds_read_b128 v[48:51], v4 offset:17024
    ds_read_b128 v[52:55], v4 offset:17056
    v_exp_f32 v64, v64
    v_exp_f32 v65, v65
    v_exp_f32 v66, v66
    v_exp_f32 v67, v67
    v_exp_f32 v68, v68
    v_exp_f32 v69, v69
    v_exp_f32 v70, v70
    v_exp_f32 v71, v71
    v_add_f32 v64, 1.0, v64
    v_add_f32 v65, 1.0, v65
    v_add_f32 v66, 1.0, v66
    v_add_f32 v67, 1.0, v67
    v_add_f32 v68, 1.0, v68
    v_add_f32 v69, 1.0, v69
    v_add_f32 v70, 1.0, v70
    v_add_f32 v71, 1.0, v71
    v_rcp_f32 v64, v64
    v_rcp_f32 v65, v65
    v_rcp_f32 v66, v66
    v_rcp_f32 v67, v67
    v_rcp_f32 v68, v68
    v_rcp_f32 v69, v69
    v_rcp_f32 v70, v70
    v_rcp_f32 v71, v71
    s_nop 0
    v_cvt_pk_bf16_f32 v80, v64, v65
    v_cvt_pk_bf16_f32 v81, v66, v67
    v_cvt_pk_bf16_f32 v82, v68, v69
    v_cvt_pk_bf16_f32 v83, v70, v71
    ds_write_b128 v2, v[80:83] offset:2048
    v_add_f32 v72, v56, v120
    v_add_f32 v73, v57, v121
    v_add_f32 v74, v58, v122
    v_add_f32 v75, v59, v123
    v_add_f32 v76, v60, v124
    v_add_f32 v77, v61, v125
    v_add_f32 v78, v62, v126
    v_add_f32 v79, v63, v127
    ds_read_b128 v[56:59], v4 offset:17088
    ds_read_b128 v[60:63], v4 offset:17120
    v_exp_f32 v72, v72
    v_exp_f32 v73, v73
    v_exp_f32 v74, v74
    v_exp_f32 v75, v75
    v_exp_f32 v76, v76
    v_exp_f32 v77, v77
    v_exp_f32 v78, v78
    v_exp_f32 v79, v79
    v_add_f32 v72, 1.0, v72
    v_add_f32 v73, 1.0, v73
    v_add_f32 v74, 1.0, v74
    v_add_f32 v75, 1.0, v75
    v_add_f32 v76, 1.0, v76
    v_add_f32 v77, 1.0, v77
    v_add_f32 v78, 1.0, v78
    v_add_f32 v79, 1.0, v79
    v_rcp_f32 v72, v72
    v_rcp_f32 v73, v73
    v_rcp_f32 v74, v74
    v_rcp_f32 v75, v75
    v_rcp_f32 v76, v76
    v_rcp_f32 v77, v77
    v_rcp_f32 v78, v78
    v_rcp_f32 v79, v79
    s_nop 0
    v_cvt_pk_bf16_f32 v84, v72, v73
    v_cvt_pk_bf16_f32 v85, v74, v75
    v_cvt_pk_bf16_f32 v86, v76, v77
    v_cvt_pk_bf16_f32 v87, v78, v79
    ds_write_b128 v2, v[84:87] offset:3072
    s_waitcnt lgkmcnt(0)
    s_barrier
    ds_read_b128 a[0:3], v6 offset:0
    ds_read_b128 a[4:7], v6 offset:1056
    ds_read_b128 a[8:11], v6 offset:2112
    ds_read_b128 a[12:15], v6 offset:3168
    v_add_f32 v64, v32, v96
    v_add_f32 v65, v33, v97
    v_add_f32 v66, v34, v98
    v_add_f32 v67, v35, v99
    v_add_f32 v68, v36, v100
    v_add_f32 v69, v37, v101
    v_add_f32 v70, v38, v102
    v_add_f32 v71, v39, v103
    ds_read_b128 v[32:35], v4 offset:21120
    ds_read_b128 v[36:39], v4 offset:21152
    v_exp_f32 v64, v64
    v_exp_f32 v65, v65
    v_exp_f32 v66, v66
    v_exp_f32 v67, v67
    v_exp_f32 v68, v68
    v_exp_f32 v69, v69
    v_exp_f32 v70, v70
    v_exp_f32 v71, v71
    v_add_f32 v64, 1.0, v64
    v_add_f32 v65, 1.0, v65
    v_add_f32 v66, 1.0, v66
    v_add_f32 v67, 1.0, v67
    v_add_f32 v68, 1.0, v68
    v_add_f32 v69, 1.0, v69
    v_add_f32 v70, 1.0, v70
    v_add_f32 v71, 1.0, v71
    v_rcp_f32 v64, v64
    v_rcp_f32 v65, v65
    v_rcp_f32 v66, v66
    v_rcp_f32 v67, v67
    v_rcp_f32 v68, v68
    v_rcp_f32 v69, v69
    v_rcp_f32 v70, v70
    v_rcp_f32 v71, v71
    s_waitcnt lgkmcnt(5)
    s_mov_b32 s36, 0
    buffer_store_dwordx4 a[0:3], v7, s[16:19], s36 offen sc1
    s_waitcnt lgkmcnt(4)
    s_mov_b32 s36, 1024
    buffer_store_dwordx4 a[4:7], v7, s[16:19], s36 offen sc1
    v_cvt_pk_bf16_f32 v80, v64, v65
    v_cvt_pk_bf16_f32 v81, v66, v67
    v_cvt_pk_bf16_f32 v82, v68, v69
    v_cvt_pk_bf16_f32 v83, v70, v71
    ds_write_b128 v2, v[80:83] offset:16384
    v_add_f32 v72, v40, v104
    v_add_f32 v73, v41, v105
    v_add_f32 v74, v42, v106
    v_add_f32 v75, v43, v107
    v_add_f32 v76, v44, v108
    v_add_f32 v77, v45, v109
    v_add_f32 v78, v46, v110
    v_add_f32 v79, v47, v111
    ds_read_b128 v[40:43], v4 offset:21184
    ds_read_b128 v[44:47], v4 offset:21216
    v_exp_f32 v72, v72
    v_exp_f32 v73, v73
    v_exp_f32 v74, v74
    v_exp_f32 v75, v75
    v_exp_f32 v76, v76
    v_exp_f32 v77, v77
    v_exp_f32 v78, v78
    v_exp_f32 v79, v79
    v_add_f32 v72, 1.0, v72
    v_add_f32 v73, 1.0, v73
    v_add_f32 v74, 1.0, v74
    v_add_f32 v75, 1.0, v75
    v_add_f32 v76, 1.0, v76
    v_add_f32 v77, 1.0, v77
    v_add_f32 v78, 1.0, v78
    v_add_f32 v79, 1.0, v79
    v_rcp_f32 v72, v72
    v_rcp_f32 v73, v73
    v_rcp_f32 v74, v74
    v_rcp_f32 v75, v75
    v_rcp_f32 v76, v76
    v_rcp_f32 v77, v77
    v_rcp_f32 v78, v78
    v_rcp_f32 v79, v79
    s_waitcnt lgkmcnt(6)
    s_mov_b32 s36, 2048
    buffer_store_dwordx4 a[8:11], v7, s[16:19], s36 offen sc1
    s_waitcnt lgkmcnt(5)
    s_mov_b32 s36, 3072
    buffer_store_dwordx4 a[12:15], v7, s[16:19], s36 offen sc1
    v_cvt_pk_bf16_f32 v84, v72, v73
    v_cvt_pk_bf16_f32 v85, v74, v75
    v_cvt_pk_bf16_f32 v86, v76, v77
    v_cvt_pk_bf16_f32 v87, v78, v79
    ds_write_b128 v2, v[84:87] offset:17408
    v_add_f32 v64, v48, v112
    v_add_f32 v65, v49, v113
    v_add_f32 v66, v50, v114
    v_add_f32 v67, v51, v115
    v_add_f32 v68, v52, v116
    v_add_f32 v69, v53, v117
    v_add_f32 v70, v54, v118
    v_add_f32 v71, v55, v119
    ds_read_b128 v[48:51], v4 offset:21248
    ds_read_b128 v[52:55], v4 offset:21280
    v_exp_f32 v64, v64
    v_exp_f32 v65, v65
    v_exp_f32 v66, v66
    v_exp_f32 v67, v67
    v_exp_f32 v68, v68
    v_exp_f32 v69, v69
    v_exp_f32 v70, v70
    v_exp_f32 v71, v71
    v_add_f32 v64, 1.0, v64
    v_add_f32 v65, 1.0, v65
    v_add_f32 v66, 1.0, v66
    v_add_f32 v67, 1.0, v67
    v_add_f32 v68, 1.0, v68
    v_add_f32 v69, 1.0, v69
    v_add_f32 v70, 1.0, v70
    v_add_f32 v71, 1.0, v71
    v_rcp_f32 v64, v64
    v_rcp_f32 v65, v65
    v_rcp_f32 v66, v66
    v_rcp_f32 v67, v67
    v_rcp_f32 v68, v68
    v_rcp_f32 v69, v69
    v_rcp_f32 v70, v70
    v_rcp_f32 v71, v71
    s_nop 0
    v_cvt_pk_bf16_f32 v80, v64, v65
    v_cvt_pk_bf16_f32 v81, v66, v67
    v_cvt_pk_bf16_f32 v82, v68, v69
    v_cvt_pk_bf16_f32 v83, v70, v71
    ds_write_b128 v2, v[80:83] offset:18432
    v_add_f32 v72, v56, v120
    v_add_f32 v73, v57, v121
    v_add_f32 v74, v58, v122
    v_add_f32 v75, v59, v123
    v_add_f32 v76, v60, v124
    v_add_f32 v77, v61, v125
    v_add_f32 v78, v62, v126
    v_add_f32 v79, v63, v127
    ds_read_b128 v[56:59], v4 offset:21312
    ds_read_b128 v[60:63], v4 offset:21344
    v_exp_f32 v72, v72
    v_exp_f32 v73, v73
    v_exp_f32 v74, v74
    v_exp_f32 v75, v75
    v_exp_f32 v76, v76
    v_exp_f32 v77, v77
    v_exp_f32 v78, v78
    v_exp_f32 v79, v79
    v_add_f32 v72, 1.0, v72
    v_add_f32 v73, 1.0, v73
    v_add_f32 v74, 1.0, v74
    v_add_f32 v75, 1.0, v75
    v_add_f32 v76, 1.0, v76
    v_add_f32 v77, 1.0, v77
    v_add_f32 v78, 1.0, v78
    v_add_f32 v79, 1.0, v79
    v_rcp_f32 v72, v72
    v_rcp_f32 v73, v73
    v_rcp_f32 v74, v74
    v_rcp_f32 v75, v75
    v_rcp_f32 v76, v76
    v_rcp_f32 v77, v77
    v_rcp_f32 v78, v78
    v_rcp_f32 v79, v79
    s_nop 0
    v_cvt_pk_bf16_f32 v84, v72, v73
    v_cvt_pk_bf16_f32 v85, v74, v75
    v_cvt_pk_bf16_f32 v86, v76, v77
    v_cvt_pk_bf16_f32 v87, v78, v79
    ds_write_b128 v2, v[84:87] offset:19456
    s_waitcnt lgkmcnt(0)
    s_barrier
    ds_read_b128 a[0:3], v6 offset:16896
    ds_read_b128 a[4:7], v6 offset:17952
    ds_read_b128 a[8:11], v6 offset:19008
    ds_read_b128 a[12:15], v6 offset:20064
    v_add_f32 v64, v32, v96
    v_add_f32 v65, v33, v97
    v_add_f32 v66, v34, v98
    v_add_f32 v67, v35, v99
    v_add_f32 v68, v36, v100
    v_add_f32 v69, v37, v101
    v_add_f32 v70, v38, v102
    v_add_f32 v71, v39, v103
    ds_read_b128 v[32:35], v4 offset:25344
    ds_read_b128 v[36:39], v4 offset:25376
    v_exp_f32 v64, v64
    v_exp_f32 v65, v65
    v_exp_f32 v66, v66
    v_exp_f32 v67, v67
    v_exp_f32 v68, v68
    v_exp_f32 v69, v69
    v_exp_f32 v70, v70
    v_exp_f32 v71, v71
    v_add_f32 v64, 1.0, v64
    v_add_f32 v65, 1.0, v65
    v_add_f32 v66, 1.0, v66
    v_add_f32 v67, 1.0, v67
    v_add_f32 v68, 1.0, v68
    v_add_f32 v69, 1.0, v69
    v_add_f32 v70, 1.0, v70
    v_add_f32 v71, 1.0, v71
    v_rcp_f32 v64, v64
    v_rcp_f32 v65, v65
    v_rcp_f32 v66, v66
    v_rcp_f32 v67, v67
    v_rcp_f32 v68, v68
    v_rcp_f32 v69, v69
    v_rcp_f32 v70, v70
    v_rcp_f32 v71, v71
    s_waitcnt lgkmcnt(5)
    s_mov_b32 s36, 16384
    buffer_store_dwordx4 a[0:3], v7, s[16:19], s36 offen sc1
    s_waitcnt lgkmcnt(4)
    s_mov_b32 s36, 17408
    buffer_store_dwordx4 a[4:7], v7, s[16:19], s36 offen sc1
    v_cvt_pk_bf16_f32 v80, v64, v65
    v_cvt_pk_bf16_f32 v81, v66, v67
    v_cvt_pk_bf16_f32 v82, v68, v69
    v_cvt_pk_bf16_f32 v83, v70, v71
    ds_write_b128 v2, v[80:83] offset:32768
    v_add_f32 v72, v40, v104
    v_add_f32 v73, v41, v105
    v_add_f32 v74, v42, v106
    v_add_f32 v75, v43, v107
    v_add_f32 v76, v44, v108
    v_add_f32 v77, v45, v109
    v_add_f32 v78, v46, v110
    v_add_f32 v79, v47, v111
    ds_read_b128 v[40:43], v4 offset:25408
    ds_read_b128 v[44:47], v4 offset:25440
    v_exp_f32 v72, v72
    v_exp_f32 v73, v73
    v_exp_f32 v74, v74
    v_exp_f32 v75, v75
    v_exp_f32 v76, v76
    v_exp_f32 v77, v77
    v_exp_f32 v78, v78
    v_exp_f32 v79, v79
    v_add_f32 v72, 1.0, v72
    v_add_f32 v73, 1.0, v73
    v_add_f32 v74, 1.0, v74
    v_add_f32 v75, 1.0, v75
    v_add_f32 v76, 1.0, v76
    v_add_f32 v77, 1.0, v77
    v_add_f32 v78, 1.0, v78
    v_add_f32 v79, 1.0, v79
    v_rcp_f32 v72, v72
    v_rcp_f32 v73, v73
    v_rcp_f32 v74, v74
    v_rcp_f32 v75, v75
    v_rcp_f32 v76, v76
    v_rcp_f32 v77, v77
    v_rcp_f32 v78, v78
    v_rcp_f32 v79, v79
    s_waitcnt lgkmcnt(6)
    s_mov_b32 s36, 18432
    buffer_store_dwordx4 a[8:11], v7, s[16:19], s36 offen sc1
    s_waitcnt lgkmcnt(5)
    s_mov_b32 s36, 19456
    buffer_store_dwordx4 a[12:15], v7, s[16:19], s36 offen sc1
    v_cvt_pk_bf16_f32 v84, v72, v73
    v_cvt_pk_bf16_f32 v85, v74, v75
    v_cvt_pk_bf16_f32 v86, v76, v77
    v_cvt_pk_bf16_f32 v87, v78, v79
    ds_write_b128 v2, v[84:87] offset:33792
    v_add_f32 v64, v48, v112
    v_add_f32 v65, v49, v113
    v_add_f32 v66, v50, v114
    v_add_f32 v67, v51, v115
    v_add_f32 v68, v52, v116
    v_add_f32 v69, v53, v117
    v_add_f32 v70, v54, v118
    v_add_f32 v71, v55, v119
    ds_read_b128 v[48:51], v4 offset:25472
    ds_read_b128 v[52:55], v4 offset:25504
    v_exp_f32 v64, v64
    v_exp_f32 v65, v65
    v_exp_f32 v66, v66
    v_exp_f32 v67, v67
    v_exp_f32 v68, v68
    v_exp_f32 v69, v69
    v_exp_f32 v70, v70
    v_exp_f32 v71, v71
    v_add_f32 v64, 1.0, v64
    v_add_f32 v65, 1.0, v65
    v_add_f32 v66, 1.0, v66
    v_add_f32 v67, 1.0, v67
    v_add_f32 v68, 1.0, v68
    v_add_f32 v69, 1.0, v69
    v_add_f32 v70, 1.0, v70
    v_add_f32 v71, 1.0, v71
    v_rcp_f32 v64, v64
    v_rcp_f32 v65, v65
    v_rcp_f32 v66, v66
    v_rcp_f32 v67, v67
    v_rcp_f32 v68, v68
    v_rcp_f32 v69, v69
    v_rcp_f32 v70, v70
    v_rcp_f32 v71, v71
    s_nop 0
    v_cvt_pk_bf16_f32 v80, v64, v65
    v_cvt_pk_bf16_f32 v81, v66, v67
    v_cvt_pk_bf16_f32 v82, v68, v69
    v_cvt_pk_bf16_f32 v83, v70, v71
    ds_write_b128 v2, v[80:83] offset:34816
    v_add_f32 v72, v56, v120
    v_add_f32 v73, v57, v121
    v_add_f32 v74, v58, v122
    v_add_f32 v75, v59, v123
    v_add_f32 v76, v60, v124
    v_add_f32 v77, v61, v125
    v_add_f32 v78, v62, v126
    v_add_f32 v79, v63, v127
    ds_read_b128 v[56:59], v4 offset:25536
    ds_read_b128 v[60:63], v4 offset:25568
    v_exp_f32 v72, v72
    v_exp_f32 v73, v73
    v_exp_f32 v74, v74
    v_exp_f32 v75, v75
    v_exp_f32 v76, v76
    v_exp_f32 v77, v77
    v_exp_f32 v78, v78
    v_exp_f32 v79, v79
    v_add_f32 v72, 1.0, v72
    v_add_f32 v73, 1.0, v73
    v_add_f32 v74, 1.0, v74
    v_add_f32 v75, 1.0, v75
    v_add_f32 v76, 1.0, v76
    v_add_f32 v77, 1.0, v77
    v_add_f32 v78, 1.0, v78
    v_add_f32 v79, 1.0, v79
    v_rcp_f32 v72, v72
    v_rcp_f32 v73, v73
    v_rcp_f32 v74, v74
    v_rcp_f32 v75, v75
    v_rcp_f32 v76, v76
    v_rcp_f32 v77, v77
    v_rcp_f32 v78, v78
    v_rcp_f32 v79, v79
    s_nop 0
    v_cvt_pk_bf16_f32 v84, v72, v73
    v_cvt_pk_bf16_f32 v85, v74, v75
    v_cvt_pk_bf16_f32 v86, v76, v77
    v_cvt_pk_bf16_f32 v87, v78, v79
    ds_write_b128 v2, v[84:87] offset:35840
    s_waitcnt lgkmcnt(0)
    s_barrier
    ds_read_b128 a[0:3], v6 offset:0
    ds_read_b128 a[4:7], v6 offset:1056
    ds_read_b128 a[8:11], v6 offset:2112
    ds_read_b128 a[12:15], v6 offset:3168
    v_add_f32 v64, v32, v96
    v_add_f32 v65, v33, v97
    v_add_f32 v66, v34, v98
    v_add_f32 v67, v35, v99
    v_add_f32 v68, v36, v100
    v_add_f32 v69, v37, v101
    v_add_f32 v70, v38, v102
    v_add_f32 v71, v39, v103
    ds_read_b128 v[32:35], v4 offset:29568
    ds_read_b128 v[36:39], v4 offset:29600
    v_exp_f32 v64, v64
    v_exp_f32 v65, v65
    v_exp_f32 v66, v66
    v_exp_f32 v67, v67
    v_exp_f32 v68, v68
    v_exp_f32 v69, v69
    v_exp_f32 v70, v70
    v_exp_f32 v71, v71
    v_add_f32 v64, 1.0, v64
    v_add_f32 v65, 1.0, v65
    v_add_f32 v66, 1.0, v66
    v_add_f32 v67, 1.0, v67
    v_add_f32 v68, 1.0, v68
    v_add_f32 v69, 1.0, v69
    v_add_f32 v70, 1.0, v70
    v_add_f32 v71, 1.0, v71
    v_rcp_f32 v64, v64
    v_rcp_f32 v65, v65
    v_rcp_f32 v66, v66
    v_rcp_f32 v67, v67
    v_rcp_f32 v68, v68
    v_rcp_f32 v69, v69
    v_rcp_f32 v70, v70
    v_rcp_f32 v71, v71
    s_waitcnt lgkmcnt(5)
    s_mov_b32 s36, 32768
    buffer_store_dwordx4 a[0:3], v7, s[16:19], s36 offen sc1
    s_waitcnt lgkmcnt(4)
    s_mov_b32 s36, 33792
    buffer_store_dwordx4 a[4:7], v7, s[16:19], s36 offen sc1
    v_cvt_pk_bf16_f32 v80, v64, v65
    v_cvt_pk_bf16_f32 v81, v66, v67
    v_cvt_pk_bf16_f32 v82, v68, v69
    v_cvt_pk_bf16_f32 v83, v70, v71
    ds_write_b128 v2, v[80:83] offset:0
    v_add_f32 v72, v40, v104
    v_add_f32 v73, v41, v105
    v_add_f32 v74, v42, v106
    v_add_f32 v75, v43, v107
    v_add_f32 v76, v44, v108
    v_add_f32 v77, v45, v109
    v_add_f32 v78, v46, v110
    v_add_f32 v79, v47, v111
    ds_read_b128 v[40:43], v4 offset:29632
    ds_read_b128 v[44:47], v4 offset:29664
    v_exp_f32 v72, v72
    v_exp_f32 v73, v73
    v_exp_f32 v74, v74
    v_exp_f32 v75, v75
    v_exp_f32 v76, v76
    v_exp_f32 v77, v77
    v_exp_f32 v78, v78
    v_exp_f32 v79, v79
    v_add_f32 v72, 1.0, v72
    v_add_f32 v73, 1.0, v73
    v_add_f32 v74, 1.0, v74
    v_add_f32 v75, 1.0, v75
    v_add_f32 v76, 1.0, v76
    v_add_f32 v77, 1.0, v77
    v_add_f32 v78, 1.0, v78
    v_add_f32 v79, 1.0, v79
    v_rcp_f32 v72, v72
    v_rcp_f32 v73, v73
    v_rcp_f32 v74, v74
    v_rcp_f32 v75, v75
    v_rcp_f32 v76, v76
    v_rcp_f32 v77, v77
    v_rcp_f32 v78, v78
    v_rcp_f32 v79, v79
    s_waitcnt lgkmcnt(6)
    s_mov_b32 s36, 34816
    buffer_store_dwordx4 a[8:11], v7, s[16:19], s36 offen sc1
    s_waitcnt lgkmcnt(5)
    s_mov_b32 s36, 35840
    buffer_store_dwordx4 a[12:15], v7, s[16:19], s36 offen sc1
    v_cvt_pk_bf16_f32 v84, v72, v73
    v_cvt_pk_bf16_f32 v85, v74, v75
    v_cvt_pk_bf16_f32 v86, v76, v77
    v_cvt_pk_bf16_f32 v87, v78, v79
    ds_write_b128 v2, v[84:87] offset:1024
    v_add_f32 v64, v48, v112
    v_add_f32 v65, v49, v113
    v_add_f32 v66, v50, v114
    v_add_f32 v67, v51, v115
    v_add_f32 v68, v52, v116
    v_add_f32 v69, v53, v117
    v_add_f32 v70, v54, v118
    v_add_f32 v71, v55, v119
    ds_read_b128 v[48:51], v4 offset:29696
    ds_read_b128 v[52:55], v4 offset:29728
    v_exp_f32 v64, v64
    v_exp_f32 v65, v65
    v_exp_f32 v66, v66
    v_exp_f32 v67, v67
    v_exp_f32 v68, v68
    v_exp_f32 v69, v69
    v_exp_f32 v70, v70
    v_exp_f32 v71, v71
    v_add_f32 v64, 1.0, v64
    v_add_f32 v65, 1.0, v65
    v_add_f32 v66, 1.0, v66
    v_add_f32 v67, 1.0, v67
    v_add_f32 v68, 1.0, v68
    v_add_f32 v69, 1.0, v69
    v_add_f32 v70, 1.0, v70
    v_add_f32 v71, 1.0, v71
    v_rcp_f32 v64, v64
    v_rcp_f32 v65, v65
    v_rcp_f32 v66, v66
    v_rcp_f32 v67, v67
    v_rcp_f32 v68, v68
    v_rcp_f32 v69, v69
    v_rcp_f32 v70, v70
    v_rcp_f32 v71, v71
    s_nop 0
    v_cvt_pk_bf16_f32 v80, v64, v65
    v_cvt_pk_bf16_f32 v81, v66, v67
    v_cvt_pk_bf16_f32 v82, v68, v69
    v_cvt_pk_bf16_f32 v83, v70, v71
    ds_write_b128 v2, v[80:83] offset:2048
    v_add_f32 v72, v56, v120
    v_add_f32 v73, v57, v121
    v_add_f32 v74, v58, v122
    v_add_f32 v75, v59, v123
    v_add_f32 v76, v60, v124
    v_add_f32 v77, v61, v125
    v_add_f32 v78, v62, v126
    v_add_f32 v79, v63, v127
    ds_read_b128 v[56:59], v4 offset:29760
    ds_read_b128 v[60:63], v4 offset:29792
    v_exp_f32 v72, v72
    v_exp_f32 v73, v73
    v_exp_f32 v74, v74
    v_exp_f32 v75, v75
    v_exp_f32 v76, v76
    v_exp_f32 v77, v77
    v_exp_f32 v78, v78
    v_exp_f32 v79, v79
    v_add_f32 v72, 1.0, v72
    v_add_f32 v73, 1.0, v73
    v_add_f32 v74, 1.0, v74
    v_add_f32 v75, 1.0, v75
    v_add_f32 v76, 1.0, v76
    v_add_f32 v77, 1.0, v77
    v_add_f32 v78, 1.0, v78
    v_add_f32 v79, 1.0, v79
    v_rcp_f32 v72, v72
    v_rcp_f32 v73, v73
    v_rcp_f32 v74, v74
    v_rcp_f32 v75, v75
    v_rcp_f32 v76, v76
    v_rcp_f32 v77, v77
    v_rcp_f32 v78, v78
    v_rcp_f32 v79, v79
    s_nop 0
    v_cvt_pk_bf16_f32 v84, v72, v73
    v_cvt_pk_bf16_f32 v85, v74, v75
    v_cvt_pk_bf16_f32 v86, v76, v77
    v_cvt_pk_bf16_f32 v87, v78, v79
    ds_write_b128 v2, v[84:87] offset:3072
    s_waitcnt lgkmcnt(0)
    s_barrier
    ds_read_b128 a[0:3], v6 offset:16896
    ds_read_b128 a[4:7], v6 offset:17952
    ds_read_b128 a[8:11], v6 offset:19008
    ds_read_b128 a[12:15], v6 offset:20064
    v_add_f32 v64, v32, v96
    v_add_f32 v65, v33, v97
    v_add_f32 v66, v34, v98
    v_add_f32 v67, v35, v99
    v_add_f32 v68, v36, v100
    v_add_f32 v69, v37, v101
    v_add_f32 v70, v38, v102
    v_add_f32 v71, v39, v103
    v_exp_f32 v64, v64
    v_exp_f32 v65, v65
    v_exp_f32 v66, v66
    v_exp_f32 v67, v67
    v_exp_f32 v68, v68
    v_exp_f32 v69, v69
    v_exp_f32 v70, v70
    v_exp_f32 v71, v71
    v_add_f32 v64, 1.0, v64
    v_add_f32 v65, 1.0, v65
    v_add_f32 v66, 1.0, v66
    v_add_f32 v67, 1.0, v67
    v_add_f32 v68, 1.0, v68
    v_add_f32 v69, 1.0, v69
    v_add_f32 v70, 1.0, v70
    v_add_f32 v71, 1.0, v71
    v_rcp_f32 v64, v64
    v_rcp_f32 v65, v65
    v_rcp_f32 v66, v66
    v_rcp_f32 v67, v67
    v_rcp_f32 v68, v68
    v_rcp_f32 v69, v69
    v_rcp_f32 v70, v70
    v_rcp_f32 v71, v71
    s_waitcnt lgkmcnt(3)
    s_mov_b32 s36, 49152
    buffer_store_dwordx4 a[0:3], v7, s[16:19], s36 offen sc1
    s_waitcnt lgkmcnt(2)
    s_mov_b32 s36, 50176
    buffer_store_dwordx4 a[4:7], v7, s[16:19], s36 offen sc1
    v_cvt_pk_bf16_f32 v80, v64, v65
    v_cvt_pk_bf16_f32 v81, v66, v67
    v_cvt_pk_bf16_f32 v82, v68, v69
    v_cvt_pk_bf16_f32 v83, v70, v71
    ds_write_b128 v2, v[80:83] offset:16384
    v_add_f32 v72, v40, v104
    v_add_f32 v73, v41, v105
    v_add_f32 v74, v42, v106
    v_add_f32 v75, v43, v107
    v_add_f32 v76, v44, v108
    v_add_f32 v77, v45, v109
    v_add_f32 v78, v46, v110
    v_add_f32 v79, v47, v111
    v_exp_f32 v72, v72
    v_exp_f32 v73, v73
    v_exp_f32 v74, v74
    v_exp_f32 v75, v75
    v_exp_f32 v76, v76
    v_exp_f32 v77, v77
    v_exp_f32 v78, v78
    v_exp_f32 v79, v79
    v_add_f32 v72, 1.0, v72
    v_add_f32 v73, 1.0, v73
    v_add_f32 v74, 1.0, v74
    v_add_f32 v75, 1.0, v75
    v_add_f32 v76, 1.0, v76
    v_add_f32 v77, 1.0, v77
    v_add_f32 v78, 1.0, v78
    v_add_f32 v79, 1.0, v79
    v_rcp_f32 v72, v72
    v_rcp_f32 v73, v73
    v_rcp_f32 v74, v74
    v_rcp_f32 v75, v75
    v_rcp_f32 v76, v76
    v_rcp_f32 v77, v77
    v_rcp_f32 v78, v78
    v_rcp_f32 v79, v79
    s_waitcnt lgkmcnt(2)
    s_mov_b32 s36, 51200
    buffer_store_dwordx4 a[8:11], v7, s[16:19], s36 offen sc1
    s_waitcnt lgkmcnt(1)
    s_mov_b32 s36, 52224
    buffer_store_dwordx4 a[12:15], v7, s[16:19], s36 offen sc1
    v_cvt_pk_bf16_f32 v84, v72, v73
    v_cvt_pk_bf16_f32 v85, v74, v75
    v_cvt_pk_bf16_f32 v86, v76, v77
    v_cvt_pk_bf16_f32 v87, v78, v79
    ds_write_b128 v2, v[84:87] offset:17408
    v_add_f32 v64, v48, v112
    v_add_f32 v65, v49, v113
    v_add_f32 v66, v50, v114
    v_add_f32 v67, v51, v115
    v_add_f32 v68, v52, v116
    v_add_f32 v69, v53, v117
    v_add_f32 v70, v54, v118
    v_add_f32 v71, v55, v119
    v_exp_f32 v64, v64
    v_exp_f32 v65, v65
    v_exp_f32 v66, v66
    v_exp_f32 v67, v67
    v_exp_f32 v68, v68
    v_exp_f32 v69, v69
    v_exp_f32 v70, v70
    v_exp_f32 v71, v71
    v_add_f32 v64, 1.0, v64
    v_add_f32 v65, 1.0, v65
    v_add_f32 v66, 1.0, v66
    v_add_f32 v67, 1.0, v67
    v_add_f32 v68, 1.0, v68
    v_add_f32 v69, 1.0, v69
    v_add_f32 v70, 1.0, v70
    v_add_f32 v71, 1.0, v71
    v_rcp_f32 v64, v64
    v_rcp_f32 v65, v65
    v_rcp_f32 v66, v66
    v_rcp_f32 v67, v67
    v_rcp_f32 v68, v68
    v_rcp_f32 v69, v69
    v_rcp_f32 v70, v70
    v_rcp_f32 v71, v71
    s_nop 0
    v_cvt_pk_bf16_f32 v80, v64, v65
    v_cvt_pk_bf16_f32 v81, v66, v67
    v_cvt_pk_bf16_f32 v82, v68, v69
    v_cvt_pk_bf16_f32 v83, v70, v71
    ds_write_b128 v2, v[80:83] offset:18432
    v_add_f32 v72, v56, v120
    v_add_f32 v73, v57, v121
    v_add_f32 v74, v58, v122
    v_add_f32 v75, v59, v123
    v_add_f32 v76, v60, v124
    v_add_f32 v77, v61, v125
    v_add_f32 v78, v62, v126
    v_add_f32 v79, v63, v127
    v_exp_f32 v72, v72
    v_exp_f32 v73, v73
    v_exp_f32 v74, v74
    v_exp_f32 v75, v75
    v_exp_f32 v76, v76
    v_exp_f32 v77, v77
    v_exp_f32 v78, v78
    v_exp_f32 v79, v79
    v_add_f32 v72, 1.0, v72
    v_add_f32 v73, 1.0, v73
    v_add_f32 v74, 1.0, v74
    v_add_f32 v75, 1.0, v75
    v_add_f32 v76, 1.0, v76
    v_add_f32 v77, 1.0, v77
    v_add_f32 v78, 1.0, v78
    v_add_f32 v79, 1.0, v79
    v_rcp_f32 v72, v72
    v_rcp_f32 v73, v73
    v_rcp_f32 v74, v74
    v_rcp_f32 v75, v75
    v_rcp_f32 v76, v76
    v_rcp_f32 v77, v77
    v_rcp_f32 v78, v78
    v_rcp_f32 v79, v79
    s_nop 0
    v_cvt_pk_bf16_f32 v84, v72, v73
    v_cvt_pk_bf16_f32 v85, v74, v75
    v_cvt_pk_bf16_f32 v86, v76, v77
    v_cvt_pk_bf16_f32 v87, v78, v79
    ds_write_b128 v2, v[84:87] offset:19456
    s_waitcnt lgkmcnt(0)
    s_barrier
    ds_read_b128 a[0:3], v6 offset:0
    ds_read_b128 a[4:7], v6 offset:1056
    ds_read_b128 a[8:11], v6 offset:2112
    ds_read_b128 a[12:15], v6 offset:3168
    s_waitcnt lgkmcnt(3)
    s_mov_b32 s36, 65536
    buffer_store_dwordx4 a[0:3], v7, s[16:19], s36 offen sc1
    s_waitcnt lgkmcnt(2)
    s_mov_b32 s36, 66560
    buffer_store_dwordx4 a[4:7], v7, s[16:19], s36 offen sc1
    s_waitcnt lgkmcnt(1)
    s_mov_b32 s36, 67584
    buffer_store_dwordx4 a[8:11], v7, s[16:19], s36 offen sc1
    s_waitcnt lgkmcnt(0)
    s_mov_b32 s36, 68608
    buffer_store_dwordx4 a[12:15], v7, s[16:19], s36 offen sc1
    s_barrier
    ds_read_b128 a[0:3], v6 offset:16896
    ds_read_b128 a[4:7], v6 offset:17952
    ds_read_b128 a[8:11], v6 offset:19008
    ds_read_b128 a[12:15], v6 offset:20064
    s_waitcnt lgkmcnt(3)
    s_mov_b32 s36, 81920
    buffer_store_dwordx4 a[0:3], v7, s[16:19], s36 offen sc1
    s_waitcnt lgkmcnt(2)
    s_mov_b32 s36, 82944
    buffer_store_dwordx4 a[4:7], v7, s[16:19], s36 offen sc1
    s_waitcnt lgkmcnt(1)
    s_mov_b32 s36, 83968
    buffer_store_dwordx4 a[8:11], v7, s[16:19], s36 offen sc1
    s_waitcnt lgkmcnt(0)
    s_mov_b32 s36, 84992
    buffer_store_dwordx4 a[12:15], v7, s[16:19], s36 offen sc1
    s_barrier
    ds_read_b128 a[0:3], v6 offset:0
    ds_read_b128 a[4:7], v6 offset:1056
    ds_read_b128 a[8:11], v6 offset:2112
    ds_read_b128 a[12:15], v6 offset:3168
    s_waitcnt lgkmcnt(3)
    s_mov_b32 s36, 98304
    buffer_store_dwordx4 a[0:3], v7, s[16:19], s36 offen sc1
    s_waitcnt lgkmcnt(2)
    s_mov_b32 s36, 99328
    buffer_store_dwordx4 a[4:7], v7, s[16:19], s36 offen sc1
    s_waitcnt lgkmcnt(1)
    s_mov_b32 s36, 100352
    buffer_store_dwordx4 a[8:11], v7, s[16:19], s36 offen sc1
    s_waitcnt lgkmcnt(0)
    s_mov_b32 s36, 101376
    buffer_store_dwordx4 a[12:15], v7, s[16:19], s36 offen sc1
    s_barrier
    ds_read_b128 a[0:3], v6 offset:16896
    ds_read_b128 a[4:7], v6 offset:17952
    ds_read_b128 a[8:11], v6 offset:19008
    ds_read_b128 a[12:15], v6 offset:20064
    s_waitcnt lgkmcnt(3)
    s_mov_b32 s36, 114688
    buffer_store_dwordx4 a[0:3], v7, s[16:19], s36 offen sc1
    s_waitcnt lgkmcnt(2)
    s_mov_b32 s36, 115712
    buffer_store_dwordx4 a[4:7], v7, s[16:19], s36 offen sc1
    s_waitcnt lgkmcnt(1)
    s_mov_b32 s36, 116736
    buffer_store_dwordx4 a[8:11], v7, s[16:19], s36 offen sc1
    s_waitcnt lgkmcnt(0)
    s_mov_b32 s36, 117760
    buffer_store_dwordx4 a[12:15], v7, s[16:19], s36 offen sc1
    s_endpgm
L_joint_kernel_done:
    s_endpgm
.section .rodata,"a"
.p2align 6
.amdhsa_kernel prep_kernel
  .amdhsa_next_free_vgpr 128
  .amdhsa_next_free_sgpr 102
  .amdhsa_accum_offset 128
  .amdhsa_group_segment_fixed_size 0
  .amdhsa_kernarg_size 80
  .amdhsa_user_sgpr_count 2
  .amdhsa_user_sgpr_kernarg_segment_ptr 1
  .amdhsa_system_sgpr_workgroup_id_x 1
.end_amdhsa_kernel
.p2align 6
.amdhsa_kernel gemm1_kernel
  .amdhsa_next_free_vgpr 232
  .amdhsa_next_free_sgpr 102
  .amdhsa_accum_offset 232
  .amdhsa_group_segment_fixed_size 0
  .amdhsa_kernarg_size 80
  .amdhsa_user_sgpr_count 2
  .amdhsa_user_sgpr_kernarg_segment_ptr 1
  .amdhsa_system_sgpr_workgroup_id_x 1
.end_amdhsa_kernel
.p2align 6
.amdhsa_kernel mid_kernel
  .amdhsa_next_free_vgpr 128
  .amdhsa_next_free_sgpr 102
  .amdhsa_accum_offset 128
  .amdhsa_group_segment_fixed_size 0
  .amdhsa_kernarg_size 80
  .amdhsa_user_sgpr_count 2
  .amdhsa_user_sgpr_kernarg_segment_ptr 1
  .amdhsa_system_sgpr_workgroup_id_x 1
.end_amdhsa_kernel
.p2align 6
.amdhsa_kernel gemm2_kernel
  .amdhsa_next_free_vgpr 152
  .amdhsa_next_free_sgpr 102
  .amdhsa_accum_offset 152
  .amdhsa_group_segment_fixed_size 0
  .amdhsa_kernarg_size 80
  .amdhsa_user_sgpr_count 2
  .amdhsa_user_sgpr_kernarg_segment_ptr 1
  .amdhsa_system_sgpr_workgroup_id_x 1
.end_amdhsa_kernel
.p2align 6
.amdhsa_kernel joint_kernel
  .amdhsa_next_free_vgpr 256
  .amdhsa_next_free_sgpr 102
  .amdhsa_accum_offset 128
  .amdhsa_group_segment_fixed_size 0
  .amdhsa_kernarg_size 80
  .amdhsa_user_sgpr_count 2
  .amdhsa_user_sgpr_kernarg_segment_ptr 1
  .amdhsa_system_sgpr_workgroup_id_x 1
.end_amdhsa_kernel
```

```asm
; @launch kernel=prep_kernel grid=(941,1,1) block=(256,1,1) lds=40960
; @launch kernel=gemm1_kernel grid=(256,1,1) block=(512,1,1) lds=143360
; @launch kernel=mid_kernel grid=(704,1,1) block=(256,1,1) lds=53248
; @launch kernel=gemm2_kernel grid=(256,1,1) block=(512,1,1) lds=143360
; @launch kernel=joint_kernel grid=(256,1,1) block=(512,1,1) lds=149504
.amdgcn_target "amdgcn-amd-amdhsa--gfx950"
.text
.globl prep_kernel
.p2align 8
.type prep_kernel,@function
prep_kernel:
    s_cmp_ge_u32 s2, 941
    s_cbranch_scc1 L_prep_kernel_done
    v_readfirstlane_b32 s20, v0
    s_lshr_b32 s20, s20, 6
    s_cmp_lt_u32 s2, 13
    s_cbranch_scc1 L_prep_kernel_slab
    s_cmp_lt_u32 s2, 269
    s_cbranch_scc1 L_prep_kernel_g
    s_load_dwordx2 s[4:5], s[0:1], 0
    s_load_dwordx2 s[6:7], s[0:1], 72
    s_sub_u32 s24, s2, 269
    s_and_b32 s25, s24, 7
    s_mul_i32 s25, s25, 84
    s_lshr_b32 s24, s24, 3
    s_add_u32 s24, s24, s25
    s_cmp_ge_u32 s24, 668
    s_cbranch_scc1 L_prep_kernel_done
    s_mul_hi_u32 s25, s24, 25718368
    s_mul_i32 s26, s25, 167
    s_sub_u32 s26, s24, s26
    s_and_b32 s27, s25, 1
    s_lshr_b32 s25, s25, 1
    v_and_b32 v1, 63, v0
    v_lshrrev_b32 v2, 3, v1
    s_mul_i32 s28, s26, 96
    s_add_u32 s28, s28, s27
    s_sub_u32 s28, s28, 15
    v_lshlrev_b32 v3, 1, v2
    v_add_u32 v3, s28, v3
    v_lshlrev_b32 v3, 9, v3
    s_lshl_b32 s29, s20, 7
    v_add_u32 v3, s29, v3
    v_bfe_u32 v4, v2, 1, 1
    v_lshlrev_b32 v4, 1, v4
    v_and_b32 v5, 7, v1
    v_xor_b32 v4, v4, v5
    v_lshl_add_u32 v3, v4, 4, v3
    v_xor_b32 v4, 64, v3
    s_waitcnt lgkmcnt(0)
    s_mul_i32 s30, s25, 8192000
    s_add_u32 s8, s4, s30
    s_addc_u32 s9, s5, 0
    s_mov_b32 s10, 8192000
    s_mov_b32 s11, 0x00020000
    s_lshl_b32 s31, s20, 13
    s_add_u32 m0, s31, 0
    v_add_u32 v5, 0, v3
    buffer_load_dwordx4 v5, s[8:11], 0 offen nt lds
    s_add_u32 m0, s31, 1024
    v_add_u32 v5, 8192, v4
    buffer_load_dwordx4 v5, s[8:11], 0 offen nt lds
    s_add_u32 m0, s31, 2048
    v_add_u32 v5, 16384, v3
    buffer_load_dwordx4 v5, s[8:11], 0 offen nt lds
    s_add_u32 m0, s31, 3072
    v_add_u32 v5, 24576, v4
    buffer_load_dwordx4 v5, s[8:11], 0 offen nt lds
    s_add_u32 m0, s31, 4096
    v_add_u32 v5, 32768, v3
    buffer_load_dwordx4 v5, s[8:11], 0 offen nt lds
    s_add_u32 m0, s31, 5120
    v_add_u32 v5, 40960, v4
    buffer_load_dwordx4 v5, s[8:11], 0 offen nt lds
    s_add_u32 m0, s31, 6144
    v_add_u32 v5, 49152, v3
    buffer_load_dwordx4 v5, s[8:11], 0 offen nt lds
    s_add_u32 m0, s31, 7168
    v_add_u32 v5, 57344, v4
    buffer_load_dwordx4 v5, s[8:11], 0 offen nt lds
    s_add_u32 s12, s6, 0
    s_addc_u32 s13, s7, 0
    s_mov_b32 s14, 21889024
    s_mov_b32 s15, 0x00020000
    v_mov_b32 v8, v1
    s_lshl_b32 s32, s20, 4
    v_lshlrev_b32 v6, 4, v1
    s_lshl_b32 s33, s20, 11
    v_add_u32 v7, s33, v6
    v_and_b32 v9, 15, v8
    v_lshrrev_b32 v10, 4, v8
    v_or_b32 v11, 1, v9
    v_add_u32 v11, s32, v11
    v_cvt_f32_u32 v11, v11
    v_mul_f32 v11, 0x3c000000, v11
    v_lshlrev_b32 v10, 3, v10
    v_add_u32 v10, 0, v10
    v_cvt_f32_u32 v10, v10
    v_and_b32 v9, 1, v9
    v_cvt_f32_u32 v9, v9
    v_mul_f32 v9, 0x3e800000, v9
    v_fma_f32 v12, v11, v10, v9
    v_fract_f32 v13, v12
    v_add_f32 v12, v12, v11
    v_fract_f32 v14, v12
    v_add_f32 v12, v12, v11
    v_fract_f32 v15, v12
    v_add_f32 v12, v12, v11
    v_fract_f32 v16, v12
    v_add_f32 v12, v12, v11
    v_fract_f32 v17, v12
    v_add_f32 v12, v12, v11
    v_fract_f32 v18, v12
    v_add_f32 v12, v12, v11
    v_fract_f32 v19, v12
    v_add_f32 v12, v12, v11
    v_fract_f32 v20, v12
    v_cos_f32 v13, v13
    v_cos_f32 v14, v14
    v_cos_f32 v15, v15
    v_cos_f32 v16, v16
    v_cos_f32 v17, v17
    v_cos_f32 v18, v18
    v_cos_f32 v19, v19
    v_cos_f32 v20, v20
    s_nop 0
    v_cvt_pk_bf16_f32 v24, v13, v14
    v_cvt_pk_bf16_f32 v25, v15, v16
    v_cvt_pk_bf16_f32 v26, v17, v18
    v_cvt_pk_bf16_f32 v27, v19, v20
    ds_write_b128 v7, v[24:27] offset:32768
    v_and_b32 v9, 15, v8
    v_lshrrev_b32 v10, 4, v8
    v_or_b32 v11, 1, v9
    v_add_u32 v11, s32, v11
    v_cvt_f32_u32 v11, v11
    v_mul_f32 v11, 0x3c000000, v11
    v_lshlrev_b32 v10, 3, v10
    v_add_u32 v10, 32, v10
    v_cvt_f32_u32 v10, v10
    v_and_b32 v9, 1, v9
    v_cvt_f32_u32 v9, v9
    v_mul_f32 v9, 0x3e800000, v9
    v_fma_f32 v12, v11, v10, v9
    v_fract_f32 v13, v12
    v_add_f32 v12, v12, v11
    v_fract_f32 v14, v12
    v_add_f32 v12, v12, v11
    v_fract_f32 v15, v12
    v_add_f32 v12, v12, v11
    v_fract_f32 v16, v12
    v_add_f32 v12, v12, v11
    v_fract_f32 v17, v12
    v_add_f32 v12, v12, v11
    v_fract_f32 v18, v12
    v_add_f32 v12, v12, v11
    v_fract_f32 v19, v12
    v_add_f32 v12, v12, v11
    v_fract_f32 v20, v12
    v_cos_f32 v13, v13
    v_cos_f32 v14, v14
    v_cos_f32 v15, v15
    v_cos_f32 v16, v16
    v_cos_f32 v17, v17
    v_cos_f32 v18, v18
    v_cos_f32 v19, v19
    v_cos_f32 v20, v20
    s_nop 0
    v_cvt_pk_bf16_f32 v28, v13, v14
    v_cvt_pk_bf16_f32 v29, v15, v16
    v_cvt_pk_bf16_f32 v30, v17, v18
    v_cvt_pk_bf16_f32 v31, v19, v20
    ds_write_b128 v7, v[28:31] offset:33792
    v_bfe_u32 v8, v1, 2, 2
    v_lshrrev_b32 v9, 4, v1
    v_lshl_add_u32 v10, v9, 3, v8
    v_lshlrev_b32 v10, 7, v10
    v_lshrrev_b32 v8, 1, v8
    v_and_b32 v11, 1, v9
    v_lshl_add_u32 v8, v11, 1, v8
    v_lshlrev_b32 v8, 1, v8
    v_bfe_u32 v11, v1, 1, 1
    v_xor_b32 v8, v8, v11
    v_lshl_add_u32 v10, v8, 4, v10
    v_and_b32 v11, 1, v1
    v_lshl_add_u32 v10, v11, 3, v10
    v_add_u32 v10, s31, v10
    v_xor_b32 v12, 0, v10
    v_xor_b32 v13, 32, v10
    v_xor_b32 v14, 64, v10
    v_xor_b32 v15, 96, v10
    v_bfe_u32 v8, v1, 1, 3
    s_mov_b32 s33, 684032
    v_mul_lo_u32 v8, v8, s33
    v_and_b32 v11, 1, v1
    v_lshl_add_u32 v8, v11, 6, v8
    v_lshl_add_u32 v16, v9, 4, v8
    s_mul_i32 s34, s25, 167
    s_add_u32 s34, s34, s26
    s_lshl_b32 s34, s34, 11
    s_lshl_b32 s35, s27, 3
    s_lshl_b32 s36, s20, 1
    s_add_u32 s35, s35, s36
    s_lshl_b32 s35, s35, 7
    s_add_u32 s34, s34, s35
    s_waitcnt lgkmcnt(0)
    s_barrier
    ds_read_b128 v[24:27], v6 offset:32768
    ds_read_b128 v[28:31], v6 offset:33792
    ds_read_b128 v[32:35], v6 offset:34816
    ds_read_b128 v[36:39], v6 offset:35840
    ds_read_b128 v[40:43], v6 offset:36864
    ds_read_b128 v[44:47], v6 offset:37888
    ds_read_b128 v[48:51], v6 offset:38912
    ds_read_b128 v[52:55], v6 offset:39936
    s_waitcnt vmcnt(0)
    s_mov_b32 s36, 2
L_prep_kernel_xh:
    ds_read_b64_tr_b16 v[56:57], v12 offset:0
    ds_read_b64_tr_b16 v[58:59], v12 offset:512
    ds_read_b64_tr_b16 v[60:61], v12 offset:4096
    ds_read_b64_tr_b16 v[62:63], v12 offset:4608
    ds_read_b64_tr_b16 v[64:65], v13 offset:0
    ds_read_b64_tr_b16 v[66:67], v13 offset:512
    ds_read_b64_tr_b16 v[68:69], v13 offset:4096
    ds_read_b64_tr_b16 v[70:71], v13 offset:4608
    s_waitcnt lgkmcnt(0)
    v_mfma_f32_16x16x32_bf16 v[72:75], v[56:59], v[24:27], 0
    v_mfma_f32_16x16x32_bf16 v[76:79], v[56:59], v[32:35], 0
    v_mfma_f32_16x16x32_bf16 v[80:83], v[56:59], v[40:43], 0
    v_mfma_f32_16x16x32_bf16 v[84:87], v[56:59], v[48:51], 0
    v_mfma_f32_16x16x32_bf16 v[88:91], v[64:67], v[24:27], 0
    v_mfma_f32_16x16x32_bf16 v[92:95], v[64:67], v[32:35], 0
    v_mfma_f32_16x16x32_bf16 v[96:99], v[64:67], v[40:43], 0
    v_mfma_f32_16x16x32_bf16 v[100:103], v[64:67], v[48:51], 0
    v_mfma_f32_16x16x32_bf16 v[72:75], v[60:63], v[28:31], v[72:75]
    v_mfma_f32_16x16x32_bf16 v[76:79], v[60:63], v[36:39], v[76:79]
    v_mfma_f32_16x16x32_bf16 v[80:83], v[60:63], v[44:47], v[80:83]
    v_mfma_f32_16x16x32_bf16 v[84:87], v[60:63], v[52:55], v[84:87]
    v_mfma_f32_16x16x32_bf16 v[88:91], v[68:71], v[28:31], v[88:91]
    v_mfma_f32_16x16x32_bf16 v[92:95], v[68:71], v[36:39], v[92:95]
    v_mfma_f32_16x16x32_bf16 v[96:99], v[68:71], v[44:47], v[96:99]
    v_mfma_f32_16x16x32_bf16 v[100:103], v[68:71], v[52:55], v[100:103]
    v_xor_b32 v12, 64, v12
    v_xor_b32 v13, 64, v13
    s_nop 5
    v_cvt_pk_bf16_f32 v104, v72, v73
    v_cvt_pk_bf16_f32 v105, v74, v75
    v_cvt_pk_bf16_f32 v106, v88, v89
    v_cvt_pk_bf16_f32 v107, v90, v91
    s_add_u32 s35, s34, 0
    buffer_store_dwordx4 v[104:107], v16, s[12:15], s35 offen sc1
    s_nop 1
    v_cvt_pk_bf16_f32 v108, v76, v77
    v_cvt_pk_bf16_f32 v109, v78, v79
    v_cvt_pk_bf16_f32 v110, v92, v93
    v_cvt_pk_bf16_f32 v111, v94, v95
    s_add_u32 s35, s34, 5472256
    buffer_store_dwordx4 v[108:111], v16, s[12:15], s35 offen sc1
    s_nop 1
    v_cvt_pk_bf16_f32 v104, v80, v81
    v_cvt_pk_bf16_f32 v105, v82, v83
    v_cvt_pk_bf16_f32 v106, v96, v97
    v_cvt_pk_bf16_f32 v107, v98, v99
    s_add_u32 s35, s34, 10944512
    buffer_store_dwordx4 v[104:107], v16, s[12:15], s35 offen sc1
    s_nop 1
    v_cvt_pk_bf16_f32 v108, v84, v85
    v_cvt_pk_bf16_f32 v109, v86, v87
    v_cvt_pk_bf16_f32 v110, v100, v101
    v_cvt_pk_bf16_f32 v111, v102, v103
    s_add_u32 s35, s34, 16416768
    buffer_store_dwordx4 v[108:111], v16, s[12:15], s35 offen sc1
    s_nop 1
    s_add_u32 s34, s34, 128
    s_sub_u32 s36, s36, 1
    s_cmp_lg_u32 s36, 0
    s_cbranch_scc1 L_prep_kernel_xh
    s_endpgm
L_prep_kernel_g:
    s_sub_u32 s3, s2, 13
    s_load_dwordx2 s[4:5], s[0:1], 8
    s_load_dwordx2 s[6:7], s[0:1], 72
    s_lshr_b32 s24, s3, 4
    s_bfe_u32 s25, s3, 0x20002
    s_and_b32 s26, s3, 3
    s_lshr_b32 s27, s24, 3
    s_and_b32 s28, s24, 7
    v_and_b32 v1, 63, v0
    v_lshrrev_b32 v2, 3, v1
    v_lshrrev_b32 v3, 2, v2
    v_lshlrev_b32 v3, 4, v3
    v_and_b32 v4, 3, v2
    v_add_u32 v3, v3, v4
    s_lshl_b32 s29, s25, 2
    s_lshl_b32 s30, s28, 5
    s_add_u32 s29, s29, s30
    v_add_u32 v3, s29, v3
    v_lshlrev_b32 v3, 9, v3
    v_and_b32 v4, 7, v1
    s_lshr_b32 s30, s20, 1
    s_lshl_b32 s30, s30, 2
    v_xor_b32 v4, s30, v4
    v_lshl_add_u32 v3, v4, 4, v3
    s_lshl_b32 s30, s26, 7
    v_add_u32 v3, s30, v3
    v_xor_b32 v4, 32, v3
    s_waitcnt lgkmcnt(0)
    s_mov_b32 s8, s4
    s_mov_b32 s9, s5
    s_mov_b32 s10, 4063232
    s_mov_b32 s11, 0x00020000
    s_add_u32 s12, s6, 21954560
    s_addc_u32 s13, s7, 0
    s_mov_b32 s14, 16916480
    s_mov_b32 s15, 0x00020000
    s_lshl_b32 s30, s20, 3
    s_add_u32 s30, s30, s27
    s_lshl_b32 s30, s30, 17
    s_mul_i32 s31, s20, 4608
    s_add_u32 m0, s31, 0
    s_add_u32 s32, s30, 0
    buffer_load_dwordx4 v3, s[8:11], s32 offen nt lds
    s_add_u32 m0, s31, 1152
    s_add_u32 s32, s30, 262144
    buffer_load_dwordx4 v3, s[8:11], s32 offen nt lds
    s_add_u32 m0, s31, 2304
    s_add_u32 s32, s30, 524288
    buffer_load_dwordx4 v4, s[8:11], s32 offen nt lds
    s_add_u32 m0, s31, 3456
    s_add_u32 s32, s30, 786432
    buffer_load_dwordx4 v4, s[8:11], s32 offen nt lds
    v_and_b32 v8, 15, v1
    v_or_b32 v9, 1, v8
    s_lshl_b32 s33, s20, 4
    v_add_u32 v9, s33, v9
    v_cvt_f32_u32 v9, v9
    v_mul_f32 v9, 0x3c000000, v9
    v_bfe_u32 v10, v1, 4, 1
    v_lshlrev_b32 v10, 3, v10
    v_cvt_f32_u32 v10, v10
    v_and_b32 v8, 1, v8
    v_cvt_f32_u32 v8, v8
    v_mul_f32 v8, 0x3f400000, v8
    v_fma_f32 v11, v9, v10, v8
    v_fract_f32 v12, v11
    v_add_f32 v11, v11, v9
    v_fract_f32 v13, v11
    v_add_f32 v11, v11, v9
    v_fract_f32 v14, v11
    v_add_f32 v11, v11, v9
    v_fract_f32 v15, v11
    v_add_f32 v11, v11, v9
    v_fract_f32 v16, v11
    v_add_f32 v11, v11, v9
    v_fract_f32 v17, v11
    v_add_f32 v11, v11, v9
    v_fract_f32 v18, v11
    v_add_f32 v11, v11, v9
    v_fract_f32 v19, v11
    v_cos_f32 v12, v12
    v_cos_f32 v13, v13
    v_cos_f32 v14, v14
    v_cos_f32 v15, v15
    v_cos_f32 v16, v16
    v_cos_f32 v17, v17
    v_cos_f32 v18, v18
    v_cos_f32 v19, v19
    s_nop 0
    v_mul_f32 v12, 0x3d000000, v12
    v_mul_f32 v13, 0x3d000000, v13
    v_mul_f32 v14, 0x3d000000, v14
    v_mul_f32 v15, 0x3d000000, v15
    v_mul_f32 v16, 0x3d000000, v16
    v_mul_f32 v17, 0x3d000000, v17
    v_mul_f32 v18, 0x3d000000, v18
    v_mul_f32 v19, 0x3d000000, v19
    v_cvt_pk_bf16_f32 v20, v12, v13
    v_cvt_pk_bf16_f32 v21, v14, v15
    v_cvt_pk_bf16_f32 v22, v16, v17
    v_cvt_pk_bf16_f32 v23, v18, v19
    v_lshlrev_b32 v28, 16, v20
    v_and_b32 v29, 0xffff0000, v20
    v_sub_f32 v28, v12, v28
    v_sub_f32 v29, v13, v29
    v_cvt_pk_bf16_f32 v24, v28, v29
    v_lshlrev_b32 v28, 16, v21
    v_and_b32 v29, 0xffff0000, v21
    v_sub_f32 v28, v14, v28
    v_sub_f32 v29, v15, v29
    v_cvt_pk_bf16_f32 v25, v28, v29
    v_lshlrev_b32 v28, 16, v22
    v_and_b32 v29, 0xffff0000, v22
    v_sub_f32 v28, v16, v28
    v_sub_f32 v29, v17, v29
    v_cvt_pk_bf16_f32 v26, v28, v29
    v_lshlrev_b32 v28, 16, v23
    v_and_b32 v29, 0xffff0000, v23
    v_sub_f32 v28, v18, v28
    v_sub_f32 v29, v19, v29
    v_cvt_pk_bf16_f32 v27, v28, v29
    v_cmp_gt_u32 vcc, 32, v1
    s_nop 1
    v_cndmask_b32 v20, v24, v20, vcc
    v_cndmask_b32 v21, v25, v21, vcc
    v_cndmask_b32 v22, v26, v22, vcc
    v_cndmask_b32 v23, v27, v23, vcc
    v_lshlrev_b32 v28, 4, v1
    s_lshl_b32 s33, s20, 10
    v_add_u32 v29, s33, v28
    ds_write_b128 v29, v[20:23] offset:18432
    v_bfe_u32 v30, v1, 2, 2
    v_bfe_u32 v31, v1, 4, 1
    v_lshl_add_u32 v32, v31, 3, v30
    v_mul_u32_u24 v32, 1152, v32
    v_lshrrev_b32 v30, 1, v30
    v_lshl_add_u32 v30, v31, 1, v30
    v_lshlrev_b32 v30, 1, v30
    v_bfe_u32 v31, v1, 1, 1
    s_lshl_b32 s33, s20, 1
    v_add_u32 v31, s33, v31
    v_xor_b32 v30, v30, v31
    v_lshl_add_u32 v32, v30, 4, v32
    v_and_b32 v30, 1, v1
    v_lshl_add_u32 v32, v30, 3, v32
    v_lshrrev_b32 v30, 4, v1
    s_mov_b32 s33, 1057280
    v_mul_lo_u32 v30, v30, s33
    v_and_b32 v31, 15, v1
    v_lshl_add_u32 v33, v31, 4, v30
    s_lshl_b32 s34, s24, 15
    s_lshl_b32 s35, s26, 2
    s_add_u32 s35, s35, s20
    s_lshl_b32 s35, s35, 11
    s_add_u32 s34, s34, s35
    s_lshl_b32 s35, s25, 8
    s_add_u32 s34, s34, s35
    s_waitcnt vmcnt(0) lgkmcnt(0)
    s_barrier
    ds_read_b128 v[36:39], v28 offset:18432
    ds_read_b64_tr_b16 v[52:53], v32 offset:0
    ds_read_b64_tr_b16 v[54:55], v32 offset:4608
    ds_read_b64_tr_b16 v[56:57], v32 offset:128
    ds_read_b64_tr_b16 v[58:59], v32 offset:4736
    ds_read_b64_tr_b16 v[60:61], v32 offset:256
    ds_read_b64_tr_b16 v[62:63], v32 offset:4864
    ds_read_b64_tr_b16 v[64:65], v32 offset:384
    ds_read_b64_tr_b16 v[66:67], v32 offset:4992
    ds_read_b64_tr_b16 v[68:69], v32 offset:512
    ds_read_b64_tr_b16 v[70:71], v32 offset:5120
    ds_read_b64_tr_b16 v[72:73], v32 offset:640
    ds_read_b64_tr_b16 v[74:75], v32 offset:5248
    s_waitcnt lgkmcnt(8)
    ds_read_b64_tr_b16 v[76:77], v32 offset:768
    ds_read_b64_tr_b16 v[78:79], v32 offset:5376
    ds_read_b64_tr_b16 v[80:81], v32 offset:896
    ds_read_b64_tr_b16 v[82:83], v32 offset:5504
    s_mov_b32 s36, 4
L_prep_kernel_git1:
    s_waitcnt lgkmcnt(0)
    v_mfma_f32_16x16x32_bf16 v[84:87], v[36:39], v[52:55], 0
    v_mfma_f32_16x16x32_bf16 v[88:91], v[36:39], v[56:59], 0
    v_mfma_f32_16x16x32_bf16 v[92:95], v[36:39], v[60:63], 0
    v_mfma_f32_16x16x32_bf16 v[96:99], v[36:39], v[64:67], 0
    v_mfma_f32_16x16x32_bf16 v[100:103], v[36:39], v[68:71], 0
    v_mfma_f32_16x16x32_bf16 v[104:107], v[36:39], v[72:75], 0
    v_mfma_f32_16x16x32_bf16 v[108:111], v[36:39], v[76:79], 0
    v_mfma_f32_16x16x32_bf16 v[112:115], v[36:39], v[80:83], 0
    v_add_u32 v28, 1024, v28
    ds_read_b128 v[36:39], v28 offset:18432
    s_nop 7
    v_cvt_pk_bf16_f32 v116, v84, v88
    v_cvt_pk_bf16_f32 v117, v92, v96
    v_cvt_pk_bf16_f32 v118, v100, v104
    v_cvt_pk_bf16_f32 v119, v108, v112
    s_add_u32 s35, s34, 0
    buffer_store_dwordx4 v[116:119], v33, s[12:15], s35 offen sc1
    s_nop 1
    v_cvt_pk_bf16_f32 v120, v85, v89
    v_cvt_pk_bf16_f32 v121, v93, v97
    v_cvt_pk_bf16_f32 v122, v101, v105
    v_cvt_pk_bf16_f32 v123, v109, v113
    s_add_u32 s35, s34, 1024
    buffer_store_dwordx4 v[120:123], v33, s[12:15], s35 offen sc1
    s_nop 1
    v_cvt_pk_bf16_f32 v116, v86, v90
    v_cvt_pk_bf16_f32 v117, v94, v98
    v_cvt_pk_bf16_f32 v118, v102, v106
    v_cvt_pk_bf16_f32 v119, v110, v114
    s_add_u32 s35, s34, 528640
    buffer_store_dwordx4 v[116:119], v33, s[12:15], s35 offen sc1
    s_nop 1
    v_cvt_pk_bf16_f32 v120, v87, v91
    v_cvt_pk_bf16_f32 v121, v95, v99
    v_cvt_pk_bf16_f32 v122, v103, v107
    v_cvt_pk_bf16_f32 v123, v111, v115
    s_add_u32 s35, s34, 529664
    buffer_store_dwordx4 v[120:123], v33, s[12:15], s35 offen sc1
    s_nop 1
    s_add_u32 s34, s34, 4229120
    s_sub_u32 s36, s36, 1
    s_cmp_lg_u32 s36, 0
    s_cbranch_scc1 L_prep_kernel_git1
    s_endpgm
L_prep_kernel_slab:
    s_load_dwordx2 s[6:7], s[0:1], 72
    s_cmp_eq_u32 s2, 12
    s_cbranch_scc1 L_prep_kernel_tab
    s_lshr_b32 s24, s2, 2
    s_and_b32 s26, s2, 3
    s_mov_b32 s25, 40
    s_cmp_eq_u32 s24, 1
    s_cselect_b32 s25, 32, s25
    s_cmp_eq_u32 s24, 2
    s_cselect_b32 s25, 48, s25
    s_load_dwordx2 s[4:5], s[0:1], s25
    s_load_dwordx2 s[28:29], s[0:1], 24
    v_and_b32 v1, 63, v0
    v_lshrrev_b32 v2, 3, v1
    s_lshl_b32 s27, s20, 6
    v_add_u32 v2, s27, v2
    v_lshlrev_b32 v2, 9, v2
    v_and_b32 v3, 7, v1
    v_lshl_add_u32 v2, v3, 4, v2
    s_lshl_b32 s27, s26, 7
    v_add_u32 v2, s27, v2
    s_waitcnt lgkmcnt(0)
    s_mov_b32 s8, s4
    s_mov_b32 s9, s5
    s_mov_b32 s10, 131072
    s_mov_b32 s11, 0x00020000
    s_add_u32 s12, s6, 85499904
    s_addc_u32 s13, s7, 0
    s_mov_b32 s14, 294912
    s_mov_b32 s15, 0x00020000
    s_lshl_b32 s31, s20, 13
    s_add_u32 m0, s31, 0
    s_mov_b32 s32, 0
    buffer_load_dwordx4 v2, s[8:11], s32 offen nt lds
    s_add_u32 m0, s31, 1024
    s_mov_b32 s32, 4096
    buffer_load_dwordx4 v2, s[8:11], s32 offen nt lds
    s_add_u32 m0, s31, 2048
    s_mov_b32 s32, 8192
    buffer_load_dwordx4 v2, s[8:11], s32 offen nt lds
    s_add_u32 m0, s31, 3072
    s_mov_b32 s32, 12288
    buffer_load_dwordx4 v2, s[8:11], s32 offen nt lds
    s_add_u32 m0, s31, 4096
    s_mov_b32 s32, 16384
    buffer_load_dwordx4 v2, s[8:11], s32 offen nt lds
    s_add_u32 m0, s31, 5120
    s_mov_b32 s32, 20480
    buffer_load_dwordx4 v2, s[8:11], s32 offen nt lds
    s_add_u32 m0, s31, 6144
    s_mov_b32 s32, 24576
    buffer_load_dwordx4 v2, s[8:11], s32 offen nt lds
    s_add_u32 m0, s31, 7168
    s_mov_b32 s32, 28672
    buffer_load_dwordx4 v2, s[8:11], s32 offen nt lds
    s_cmp_eq_u32 s24, 0
    s_cbranch_scc1 L_prep_kernel_ge
    v_bfe_u32 v4, v1, 2, 2
    v_lshrrev_b32 v5, 5, v1
    v_bfe_u32 v6, v1, 4, 1
    v_and_b32 v7, 3, v1
    s_cmp_eq_u32 s24, 1
    s_cbranch_scc0 L_prep_kernel_wo
    v_lshl_add_u32 v8, v5, 4, v4
    v_lshlrev_b32 v8, 7, v8
    v_lshl_add_u32 v8, v6, 5, v8
    v_lshl_add_u32 v8, v7, 3, v8
    s_lshl_b32 s33, s20, 13
    v_add_u32 v8, s33, v8
    s_mov_b32 s34, 32768
    s_lshl_b32 s35, s26, 15
    s_add_u32 s34, s34, s35
    s_lshl_b32 s35, s20, 12
    s_add_u32 s34, s34, s35
    v_lshlrev_b32 v9, 4, v1
    s_waitcnt vmcnt(0)
    s_barrier
    ds_read_b64_tr_b16 v[16:17], v8 offset:0
    ds_read_b64_tr_b16 v[18:19], v8 offset:1024
    ds_read_b64_tr_b16 v[20:21], v8 offset:512
    ds_read_b64_tr_b16 v[22:23], v8 offset:1536
    ds_read_b64_tr_b16 v[24:25], v8 offset:4096
    ds_read_b64_tr_b16 v[26:27], v8 offset:5120
    ds_read_b64_tr_b16 v[28:29], v8 offset:4608
    ds_read_b64_tr_b16 v[30:31], v8 offset:5632
    s_waitcnt lgkmcnt(0)
    s_add_u32 s35, s34, 0
    buffer_store_dwordx4 v[16:19], v9, s[12:15], s35 offen sc1
    s_add_u32 s35, s34, 1024
    buffer_store_dwordx4 v[20:23], v9, s[12:15], s35 offen sc1
    s_add_u32 s35, s34, 2048
    buffer_store_dwordx4 v[24:27], v9, s[12:15], s35 offen sc1
    s_add_u32 s35, s34, 3072
    buffer_store_dwordx4 v[28:31], v9, s[12:15], s35 offen sc1
    ds_read_b64_tr_b16 v[32:33], v8 offset:64
    ds_read_b64_tr_b16 v[34:35], v8 offset:1088
    ds_read_b64_tr_b16 v[36:37], v8 offset:576
    ds_read_b64_tr_b16 v[38:39], v8 offset:1600
    ds_read_b64_tr_b16 v[40:41], v8 offset:4160
    ds_read_b64_tr_b16 v[42:43], v8 offset:5184
    ds_read_b64_tr_b16 v[44:45], v8 offset:4672
    ds_read_b64_tr_b16 v[46:47], v8 offset:5696
    s_waitcnt lgkmcnt(0)
    s_add_u32 s35, s34, 16384
    buffer_store_dwordx4 v[32:35], v9, s[12:15], s35 offen sc1
    s_add_u32 s35, s34, 17408
    buffer_store_dwordx4 v[36:39], v9, s[12:15], s35 offen sc1
    s_add_u32 s35, s34, 18432
    buffer_store_dwordx4 v[40:43], v9, s[12:15], s35 offen sc1
    s_add_u32 s35, s34, 19456
    buffer_store_dwordx4 v[44:47], v9, s[12:15], s35 offen sc1
    s_endpgm
L_prep_kernel_wo:
    v_lshl_add_u32 v8, v5, 2, v4
    v_lshlrev_b32 v8, 7, v8
    v_lshl_add_u32 v8, v6, 5, v8
    v_and_b32 v10, 1, v7
    v_lshl_add_u32 v8, v10, 4, v8
    v_lshrrev_b32 v10, 1, v7
    v_lshl_add_u32 v8, v10, 3, v8
    s_lshl_b32 s33, s20, 13
    v_add_u32 v8, s33, v8
    s_mov_b32 s34, 163840
    s_lshl_b32 s35, s26, 15
    s_add_u32 s34, s34, s35
    s_lshl_b32 s35, s20, 12
    s_add_u32 s34, s34, s35
    v_lshlrev_b32 v9, 4, v1
    s_waitcnt vmcnt(0)
    s_barrier
    ds_read_b64_tr_b16 v[16:17], v8 offset:0
    ds_read_b64_tr_b16 v[18:19], v8 offset:1024
    ds_read_b64_tr_b16 v[20:21], v8 offset:2048
    ds_read_b64_tr_b16 v[22:23], v8 offset:3072
    ds_read_b64_tr_b16 v[24:25], v8 offset:4096
    ds_read_b64_tr_b16 v[26:27], v8 offset:5120
    ds_read_b64_tr_b16 v[28:29], v8 offset:6144
    ds_read_b64_tr_b16 v[30:31], v8 offset:7168
    s_waitcnt lgkmcnt(0)
    v_mov_b32 v48, 0x3f803f80
    v_mov_b32 v49, 0x3f803f80
    v_mov_b32 v50, 0x3f803f80
    v_mov_b32 v51, 0x3f803f80
    s_nop 1
    v_mfma_f32_32x32x16_bf16 v[64:79], v[16:19], v[48:51], 0
    v_mfma_f32_32x32x16_bf16 v[64:79], v[20:23], v[48:51], v[64:79]
    v_mfma_f32_32x32x16_bf16 v[64:79], v[24:27], v[48:51], v[64:79]
    v_mfma_f32_32x32x16_bf16 v[64:79], v[28:31], v[48:51], v[64:79]
    v_lshlrev_b32 v52, 16, v16
    v_and_b32 v53, 0xffff0000, v16
    v_mul_f32 v52, -2.0, v52
    v_mul_f32 v53, -2.0, v53
    v_cvt_pk_bf16_f32 v16, v52, v53
    v_lshlrev_b32 v52, 16, v17
    v_and_b32 v53, 0xffff0000, v17
    v_mul_f32 v52, -2.0, v52
    v_mul_f32 v53, -2.0, v53
    v_cvt_pk_bf16_f32 v17, v52, v53
    v_lshlrev_b32 v52, 16, v18
    v_and_b32 v53, 0xffff0000, v18
    v_mul_f32 v52, -2.0, v52
    v_mul_f32 v53, -2.0, v53
    v_cvt_pk_bf16_f32 v18, v52, v53
    v_lshlrev_b32 v52, 16, v19
    v_and_b32 v53, 0xffff0000, v19
    v_mul_f32 v52, -2.0, v52
    v_mul_f32 v53, -2.0, v53
    v_cvt_pk_bf16_f32 v19, v52, v53
    v_lshlrev_b32 v52, 16, v20
    v_and_b32 v53, 0xffff0000, v20
    v_mul_f32 v52, -2.0, v52
    v_mul_f32 v53, -2.0, v53
    v_cvt_pk_bf16_f32 v20, v52, v53
    v_lshlrev_b32 v52, 16, v21
    v_and_b32 v53, 0xffff0000, v21
    v_mul_f32 v52, -2.0, v52
    v_mul_f32 v53, -2.0, v53
    v_cvt_pk_bf16_f32 v21, v52, v53
    v_lshlrev_b32 v52, 16, v22
    v_and_b32 v53, 0xffff0000, v22
    v_mul_f32 v52, -2.0, v52
    v_mul_f32 v53, -2.0, v53
    v_cvt_pk_bf16_f32 v22, v52, v53
    v_lshlrev_b32 v52, 16, v23
    v_and_b32 v53, 0xffff0000, v23
    v_mul_f32 v52, -2.0, v52
    v_mul_f32 v53, -2.0, v53
    v_cvt_pk_bf16_f32 v23, v52, v53
    v_lshlrev_b32 v52, 16, v24
    v_and_b32 v53, 0xffff0000, v24
    v_mul_f32 v52, -2.0, v52
    v_mul_f32 v53, -2.0, v53
    v_cvt_pk_bf16_f32 v24, v52, v53
    v_lshlrev_b32 v52, 16, v25
    v_and_b32 v53, 0xffff0000, v25
    v_mul_f32 v52, -2.0, v52
    v_mul_f32 v53, -2.0, v53
    v_cvt_pk_bf16_f32 v25, v52, v53
    v_lshlrev_b32 v52, 16, v26
    v_and_b32 v53, 0xffff0000, v26
    v_mul_f32 v52, -2.0, v52
    v_mul_f32 v53, -2.0, v53
    v_cvt_pk_bf16_f32 v26, v52, v53
    v_lshlrev_b32 v52, 16, v27
    v_and_b32 v53, 0xffff0000, v27
    v_mul_f32 v52, -2.0, v52
    v_mul_f32 v53, -2.0, v53
    v_cvt_pk_bf16_f32 v27, v52, v53
    v_lshlrev_b32 v52, 16, v28
    v_and_b32 v53, 0xffff0000, v28
    v_mul_f32 v52, -2.0, v52
    v_mul_f32 v53, -2.0, v53
    v_cvt_pk_bf16_f32 v28, v52, v53
    v_lshlrev_b32 v52, 16, v29
    v_and_b32 v53, 0xffff0000, v29
    v_mul_f32 v52, -2.0, v52
    v_mul_f32 v53, -2.0, v53
    v_cvt_pk_bf16_f32 v29, v52, v53
    v_lshlrev_b32 v52, 16, v30
    v_and_b32 v53, 0xffff0000, v30
    v_mul_f32 v52, -2.0, v52
    v_mul_f32 v53, -2.0, v53
    v_cvt_pk_bf16_f32 v30, v52, v53
    v_lshlrev_b32 v52, 16, v31
    v_and_b32 v53, 0xffff0000, v31
    v_mul_f32 v52, -2.0, v52
    v_mul_f32 v53, -2.0, v53
    v_cvt_pk_bf16_f32 v31, v52, v53
    s_add_u32 s35, s34, 0
    buffer_store_dwordx4 v[16:19], v9, s[12:15], s35 offen sc1
    s_add_u32 s35, s34, 1024
    buffer_store_dwordx4 v[20:23], v9, s[12:15], s35 offen sc1
    s_add_u32 s35, s34, 2048
    buffer_store_dwordx4 v[24:27], v9, s[12:15], s35 offen sc1
    s_add_u32 s35, s34, 3072
    buffer_store_dwordx4 v[28:31], v9, s[12:15], s35 offen sc1
    ds_read_b64_tr_b16 v[32:33], v8 offset:64
    ds_read_b64_tr_b16 v[34:35], v8 offset:1088
    ds_read_b64_tr_b16 v[36:37], v8 offset:2112
    ds_read_b64_tr_b16 v[38:39], v8 offset:3136
    ds_read_b64_tr_b16 v[40:41], v8 offset:4160
    ds_read_b64_tr_b16 v[42:43], v8 offset:5184
    ds_read_b64_tr_b16 v[44:45], v8 offset:6208
    ds_read_b64_tr_b16 v[46:47], v8 offset:7232
    s_waitcnt lgkmcnt(0)
    v_mfma_f32_32x32x16_bf16 v[80:95], v[32:35], v[48:51], 0
    v_mfma_f32_32x32x16_bf16 v[80:95], v[36:39], v[48:51], v[80:95]
    v_mfma_f32_32x32x16_bf16 v[80:95], v[40:43], v[48:51], v[80:95]
    v_mfma_f32_32x32x16_bf16 v[80:95], v[44:47], v[48:51], v[80:95]
    v_lshlrev_b32 v52, 16, v32
    v_and_b32 v53, 0xffff0000, v32
    v_mul_f32 v52, -2.0, v52
    v_mul_f32 v53, -2.0, v53
    v_cvt_pk_bf16_f32 v32, v52, v53
    v_lshlrev_b32 v52, 16, v33
    v_and_b32 v53, 0xffff0000, v33
    v_mul_f32 v52, -2.0, v52
    v_mul_f32 v53, -2.0, v53
    v_cvt_pk_bf16_f32 v33, v52, v53
    v_lshlrev_b32 v52, 16, v34
    v_and_b32 v53, 0xffff0000, v34
    v_mul_f32 v52, -2.0, v52
    v_mul_f32 v53, -2.0, v53
    v_cvt_pk_bf16_f32 v34, v52, v53
    v_lshlrev_b32 v52, 16, v35
    v_and_b32 v53, 0xffff0000, v35
    v_mul_f32 v52, -2.0, v52
    v_mul_f32 v53, -2.0, v53
    v_cvt_pk_bf16_f32 v35, v52, v53
    v_lshlrev_b32 v52, 16, v36
    v_and_b32 v53, 0xffff0000, v36
    v_mul_f32 v52, -2.0, v52
    v_mul_f32 v53, -2.0, v53
    v_cvt_pk_bf16_f32 v36, v52, v53
    v_lshlrev_b32 v52, 16, v37
    v_and_b32 v53, 0xffff0000, v37
    v_mul_f32 v52, -2.0, v52
    v_mul_f32 v53, -2.0, v53
    v_cvt_pk_bf16_f32 v37, v52, v53
    v_lshlrev_b32 v52, 16, v38
    v_and_b32 v53, 0xffff0000, v38
    v_mul_f32 v52, -2.0, v52
    v_mul_f32 v53, -2.0, v53
    v_cvt_pk_bf16_f32 v38, v52, v53
    v_lshlrev_b32 v52, 16, v39
    v_and_b32 v53, 0xffff0000, v39
    v_mul_f32 v52, -2.0, v52
    v_mul_f32 v53, -2.0, v53
    v_cvt_pk_bf16_f32 v39, v52, v53
    v_lshlrev_b32 v52, 16, v40
    v_and_b32 v53, 0xffff0000, v40
    v_mul_f32 v52, -2.0, v52
    v_mul_f32 v53, -2.0, v53
    v_cvt_pk_bf16_f32 v40, v52, v53
    v_lshlrev_b32 v52, 16, v41
    v_and_b32 v53, 0xffff0000, v41
    v_mul_f32 v52, -2.0, v52
    v_mul_f32 v53, -2.0, v53
    v_cvt_pk_bf16_f32 v41, v52, v53
    v_lshlrev_b32 v52, 16, v42
    v_and_b32 v53, 0xffff0000, v42
    v_mul_f32 v52, -2.0, v52
    v_mul_f32 v53, -2.0, v53
    v_cvt_pk_bf16_f32 v42, v52, v53
    v_lshlrev_b32 v52, 16, v43
    v_and_b32 v53, 0xffff0000, v43
    v_mul_f32 v52, -2.0, v52
    v_mul_f32 v53, -2.0, v53
    v_cvt_pk_bf16_f32 v43, v52, v53
    v_lshlrev_b32 v52, 16, v44
    v_and_b32 v53, 0xffff0000, v44
    v_mul_f32 v52, -2.0, v52
    v_mul_f32 v53, -2.0, v53
    v_cvt_pk_bf16_f32 v44, v52, v53
    v_lshlrev_b32 v52, 16, v45
    v_and_b32 v53, 0xffff0000, v45
    v_mul_f32 v52, -2.0, v52
    v_mul_f32 v53, -2.0, v53
    v_cvt_pk_bf16_f32 v45, v52, v53
    v_lshlrev_b32 v52, 16, v46
    v_and_b32 v53, 0xffff0000, v46
    v_mul_f32 v52, -2.0, v52
    v_mul_f32 v53, -2.0, v53
    v_cvt_pk_bf16_f32 v46, v52, v53
    v_lshlrev_b32 v52, 16, v47
    v_and_b32 v53, 0xffff0000, v47
    v_mul_f32 v52, -2.0, v52
    v_mul_f32 v53, -2.0, v53
    v_cvt_pk_bf16_f32 v47, v52, v53
    s_add_u32 s35, s34, 16384
    buffer_store_dwordx4 v[32:35], v9, s[12:15], s35 offen sc1
    s_add_u32 s35, s34, 17408
    buffer_store_dwordx4 v[36:39], v9, s[12:15], s35 offen sc1
    s_add_u32 s35, s34, 18432
    buffer_store_dwordx4 v[40:43], v9, s[12:15], s35 offen sc1
    s_add_u32 s35, s34, 19456
    buffer_store_dwordx4 v[44:47], v9, s[12:15], s35 offen sc1
    s_nop 7
    s_barrier
    v_lshlrev_b32 v10, 6, v1
    s_lshl_b32 s35, s20, 13
    v_add_u32 v11, s35, v10
    ds_write_b128 v11, v[64:67] offset:0
    ds_write_b128 v11, v[68:71] offset:16
    ds_write_b128 v11, v[72:75] offset:32
    ds_write_b128 v11, v[76:79] offset:48
    ds_write_b128 v11, v[80:83] offset:4096
    ds_write_b128 v11, v[84:87] offset:4112
    ds_write_b128 v11, v[88:91] offset:4128
    ds_write_b128 v11, v[92:95] offset:4144
    s_waitcnt lgkmcnt(0)
    s_barrier
    s_cmp_ge_u32 s20, 2
    s_cbranch_scc1 L_prep_kernel_done
    s_lshl_b32 s35, s20, 12
    v_add_u32 v11, s35, v10
    ds_read_b128 v[16:19], v11 offset:0
    ds_read_b128 v[20:23], v11 offset:16
    ds_read_b128 v[24:27], v11 offset:32
    ds_read_b128 v[28:31], v11 offset:48
    ds_read_b128 v[32:35], v11 offset:8192
    ds_read_b128 v[36:39], v11 offset:8208
    ds_read_b128 v[40:43], v11 offset:8224
    ds_read_b128 v[44:47], v11 offset:8240
    s_waitcnt lgkmcnt(0)
    ds_read_b128 v[48:51], v11 offset:16384
    ds_read_b128 v[52:55], v11 offset:16400
    ds_read_b128 v[56:59], v11 offset:16416
    ds_read_b128 v[60:63], v11 offset:16432
    ds_read_b128 v[64:67], v11 offset:24576
    ds_read_b128 v[68:71], v11 offset:24592
    ds_read_b128 v[72:75], v11 offset:24608
    ds_read_b128 v[76:79], v11 offset:24624
    s_waitcnt lgkmcnt(0)
    v_add_f32 v16, v16, v32
    v_add_f32 v48, v48, v64
    v_add_f32 v17, v17, v33
    v_add_f32 v49, v49, v65
    v_add_f32 v18, v18, v34
    v_add_f32 v50, v50, v66
    v_add_f32 v19, v19, v35
    v_add_f32 v51, v51, v67
    v_add_f32 v20, v20, v36
    v_add_f32 v52, v52, v68
    v_add_f32 v21, v21, v37
    v_add_f32 v53, v53, v69
    v_add_f32 v22, v22, v38
    v_add_f32 v54, v54, v70
    v_add_f32 v23, v23, v39
    v_add_f32 v55, v55, v71
    v_add_f32 v24, v24, v40
    v_add_f32 v56, v56, v72
    v_add_f32 v25, v25, v41
    v_add_f32 v57, v57, v73
    v_add_f32 v26, v26, v42
    v_add_f32 v58, v58, v74
    v_add_f32 v27, v27, v43
    v_add_f32 v59, v59, v75
    v_add_f32 v28, v28, v44
    v_add_f32 v60, v60, v76
    v_add_f32 v29, v29, v45
    v_add_f32 v61, v61, v77
    v_add_f32 v30, v30, v46
    v_add_f32 v62, v62, v78
    v_add_f32 v31, v31, v47
    v_add_f32 v63, v63, v79
    v_add_f32 v16, v16, v48
    v_add_f32 v17, v17, v49
    v_add_f32 v18, v18, v50
    v_add_f32 v19, v19, v51
    v_add_f32 v20, v20, v52
    v_add_f32 v21, v21, v53
    v_add_f32 v22, v22, v54
    v_add_f32 v23, v23, v55
    v_add_f32 v24, v24, v56
    v_add_f32 v25, v25, v57
    v_add_f32 v26, v26, v58
    v_add_f32 v27, v27, v59
    v_add_f32 v28, v28, v60
    v_add_f32 v29, v29, v61
    v_add_f32 v30, v30, v62
    v_add_f32 v31, v31, v63
    v_and_b32 v10, 31, v1
    v_cmp_eq_u32 vcc, 0, v10
    v_lshrrev_b32 v10, 5, v1
    v_lshlrev_b32 v10, 6, v10
    s_lshl_b32 s35, s26, 8
    s_lshl_b32 s36, s20, 7
    s_add_u32 s35, s35, s36
    s_add_u32 s35, s35, 14336
    s_and_saveexec_b64 s[38:39], vcc
    buffer_store_dwordx4 v[16:19], v10, s[12:15], s35 offen offset:0 sc1
    buffer_store_dwordx4 v[20:23], v10, s[12:15], s35 offen offset:16 sc1
    buffer_store_dwordx4 v[24:27], v10, s[12:15], s35 offen offset:32 sc1
    buffer_store_dwordx4 v[28:31], v10, s[12:15], s35 offen offset:48 sc1
    s_endpgm
L_prep_kernel_ge:
    s_mov_b32 s36, s28
    s_mov_b32 s37, s29
    s_mov_b32 s38, 8192
    s_mov_b32 s39, 0x00020000
    v_and_b32 v4, 15, v1
    v_lshrrev_b32 v5, 4, v1
    v_lshlrev_b32 v6, 9, v4
    v_lshl_add_u32 v6, v5, 4, v6
    buffer_load_dwordx4 v[16:19], v6, s[36:39], 0 offen offset:0
    buffer_load_dwordx4 v[20:23], v6, s[36:39], 0 offen offset:64
    buffer_load_dwordx4 v[24:27], v6, s[36:39], 0 offen offset:128
    buffer_load_dwordx4 v[28:31], v6, s[36:39], 0 offen offset:192
    buffer_load_dwordx4 v[32:35], v6, s[36:39], 0 offen offset:256
    buffer_load_dwordx4 v[36:39], v6, s[36:39], 0 offen offset:320
    buffer_load_dwordx4 v[40:43], v6, s[36:39], 0 offen offset:384
    buffer_load_dwordx4 v[44:47], v6, s[36:39], 0 offen offset:448
    v_bfe_u32 v7, v1, 2, 2
    v_lshl_add_u32 v7, v5, 3, v7
    v_lshlrev_b32 v7, 7, v7
    v_and_b32 v8, 3, v1
    v_lshl_add_u32 v7, v8, 3, v7
    s_lshl_b32 s33, s20, 5
    v_add_u32 v7, s33, v7
    s_waitcnt vmcnt(0)
    s_barrier
    ds_read_b64_tr_b16 v[48:49], v7 offset:0
    ds_read_b64_tr_b16 v[50:51], v7 offset:512
    ds_read_b64_tr_b16 v[52:53], v7 offset:4096
    ds_read_b64_tr_b16 v[54:55], v7 offset:4608
    ds_read_b64_tr_b16 v[56:57], v7 offset:8192
    ds_read_b64_tr_b16 v[58:59], v7 offset:8704
    ds_read_b64_tr_b16 v[60:61], v7 offset:12288
    ds_read_b64_tr_b16 v[62:63], v7 offset:12800
    s_waitcnt lgkmcnt(0)
    ds_read_b64_tr_b16 v[64:65], v7 offset:16384
    ds_read_b64_tr_b16 v[66:67], v7 offset:16896
    ds_read_b64_tr_b16 v[68:69], v7 offset:20480
    ds_read_b64_tr_b16 v[70:71], v7 offset:20992
    ds_read_b64_tr_b16 v[72:73], v7 offset:24576
    ds_read_b64_tr_b16 v[74:75], v7 offset:25088
    ds_read_b64_tr_b16 v[76:77], v7 offset:28672
    ds_read_b64_tr_b16 v[78:79], v7 offset:29184
    s_waitcnt lgkmcnt(0)
    v_mfma_f32_16x16x32_bf16 v[80:83], v[48:51], v[16:19], 0
    v_mfma_f32_16x16x32_bf16 v[80:83], v[52:55], v[20:23], v[80:83]
    v_mfma_f32_16x16x32_bf16 v[80:83], v[56:59], v[24:27], v[80:83]
    v_mfma_f32_16x16x32_bf16 v[80:83], v[60:63], v[28:31], v[80:83]
    v_mfma_f32_16x16x32_bf16 v[80:83], v[64:67], v[32:35], v[80:83]
    v_mfma_f32_16x16x32_bf16 v[80:83], v[68:71], v[36:39], v[80:83]
    v_mfma_f32_16x16x32_bf16 v[80:83], v[72:75], v[40:43], v[80:83]
    v_mfma_f32_16x16x32_bf16 v[80:83], v[76:79], v[44:47], v[80:83]
    s_nop 7
    v_cvt_pk_bf16_f32 v84, v80, v81
    v_cvt_pk_bf16_f32 v85, v82, v83
    s_mov_b32 s33, 0x4038aa3b
    v_lshlrev_b32 v80, 16, v84
    v_and_b32 v81, 0xffff0000, v84
    v_lshlrev_b32 v82, 16, v85
    v_and_b32 v83, 0xffff0000, v85
    v_mul_f32 v80, s33, v80
    v_mul_f32 v81, s33, v81
    v_mul_f32 v82, s33, v82
    v_mul_f32 v83, s33, v83
    v_lshlrev_b32 v6, 10, v4
    v_lshl_add_u32 v6, v5, 4, v6
    s_lshl_b32 s33, s26, 8
    s_lshl_b32 s34, s20, 6
    s_add_u32 s33, s33, s34
    s_add_u32 s33, s33, 16384
    buffer_store_dwordx4 v[80:83], v6, s[12:15], s33 offen sc1
    s_endpgm
L_prep_kernel_tab:
    v_and_b32 v8, 63, v0
    v_lshlrev_b32 v6, 4, v8
    s_waitcnt lgkmcnt(0)
    s_add_u32 s12, s6, 85499904
    s_addc_u32 s13, s7, 0
    s_mov_b32 s14, 294912
    s_mov_b32 s15, 0x00020000
    s_lshl_b32 s32, s20, 4
    s_lshl_b32 s33, s20, 11
    v_and_b32 v9, 15, v8
    v_lshrrev_b32 v10, 4, v8
    v_or_b32 v11, 1, v9
    v_add_u32 v11, s32, v11
    v_cvt_f32_u32 v11, v11
    v_mul_f32 v11, 0x3c000000, v11
    v_lshlrev_b32 v10, 3, v10
    v_add_u32 v10, 0, v10
    v_cvt_f32_u32 v10, v10
    v_and_b32 v9, 1, v9
    v_cvt_f32_u32 v9, v9
    v_mul_f32 v9, 0x3e800000, v9
    v_fma_f32 v12, v11, v10, v9
    v_fract_f32 v13, v12
    v_add_f32 v12, v12, v11
    v_fract_f32 v14, v12
    v_add_f32 v12, v12, v11
    v_fract_f32 v15, v12
    v_add_f32 v12, v12, v11
    v_fract_f32 v16, v12
    v_add_f32 v12, v12, v11
    v_fract_f32 v17, v12
    v_add_f32 v12, v12, v11
    v_fract_f32 v18, v12
    v_add_f32 v12, v12, v11
    v_fract_f32 v19, v12
    v_add_f32 v12, v12, v11
    v_fract_f32 v20, v12
    v_cos_f32 v13, v13
    v_cos_f32 v14, v14
    v_cos_f32 v15, v15
    v_cos_f32 v16, v16
    v_cos_f32 v17, v17
    v_cos_f32 v18, v18
    v_cos_f32 v19, v19
    v_cos_f32 v20, v20
    s_nop 0
    v_cvt_pk_bf16_f32 v24, v13, v14
    v_cvt_pk_bf16_f32 v25, v15, v16
    v_cvt_pk_bf16_f32 v26, v17, v18
    v_cvt_pk_bf16_f32 v27, v19, v20
    s_add_u32 s34, s33, 0
    buffer_store_dwordx4 v[24:27], v6, s[12:15], s34 offen sc1
    v_and_b32 v9, 15, v8
    v_lshrrev_b32 v10, 4, v8
    v_or_b32 v11, 1, v9
    v_add_u32 v11, s32, v11
    v_cvt_f32_u32 v11, v11
    v_mul_f32 v11, 0x3c000000, v11
    v_lshlrev_b32 v10, 3, v10
    v_add_u32 v10, 32, v10
    v_cvt_f32_u32 v10, v10
    v_and_b32 v9, 1, v9
    v_cvt_f32_u32 v9, v9
    v_mul_f32 v9, 0x3e800000, v9
    v_fma_f32 v12, v11, v10, v9
    v_fract_f32 v13, v12
    v_add_f32 v12, v12, v11
    v_fract_f32 v14, v12
    v_add_f32 v12, v12, v11
    v_fract_f32 v15, v12
    v_add_f32 v12, v12, v11
    v_fract_f32 v16, v12
    v_add_f32 v12, v12, v11
    v_fract_f32 v17, v12
    v_add_f32 v12, v12, v11
    v_fract_f32 v18, v12
    v_add_f32 v12, v12, v11
    v_fract_f32 v19, v12
    v_add_f32 v12, v12, v11
    v_fract_f32 v20, v12
    v_cos_f32 v13, v13
    v_cos_f32 v14, v14
    v_cos_f32 v15, v15
    v_cos_f32 v16, v16
    v_cos_f32 v17, v17
    v_cos_f32 v18, v18
    v_cos_f32 v19, v19
    v_cos_f32 v20, v20
    s_nop 0
    v_cvt_pk_bf16_f32 v28, v13, v14
    v_cvt_pk_bf16_f32 v29, v15, v16
    v_cvt_pk_bf16_f32 v30, v17, v18
    v_cvt_pk_bf16_f32 v31, v19, v20
    s_add_u32 s34, s33, 1024
    buffer_store_dwordx4 v[28:31], v6, s[12:15], s34 offen sc1
    s_cmp_ge_u32 s20, 3
    s_cbranch_scc1 L_prep_kernel_done
    v_and_b32 v9, 15, v8
    v_add_u32 v9, s32, v9
    v_cvt_f32_u32 v9, v9
    v_mul_f32 v9, 0x3c000000, v9
    v_lshrrev_b32 v10, 4, v8
    v_lshlrev_b32 v10, 3, v10
    v_add_u32 v11, 1, v10
    v_cvt_f32_u32 v11, v11
    v_mul_f32 v11, v11, v9
    v_fract_f32 v12, v11
    v_add_u32 v11, 1, v10
    v_cvt_f32_u32 v11, v11
    v_mul_f32 v11, v11, v9
    v_add_f32 v11, 0x3e800000, v11
    v_fract_f32 v13, v11
    v_add_u32 v11, 3, v10
    v_cvt_f32_u32 v11, v11
    v_mul_f32 v11, v11, v9
    v_fract_f32 v14, v11
    v_add_u32 v11, 3, v10
    v_cvt_f32_u32 v11, v11
    v_mul_f32 v11, v11, v9
    v_add_f32 v11, 0x3e800000, v11
    v_fract_f32 v15, v11
    v_add_u32 v11, 5, v10
    v_cvt_f32_u32 v11, v11
    v_mul_f32 v11, v11, v9
    v_fract_f32 v16, v11
    v_add_u32 v11, 5, v10
    v_cvt_f32_u32 v11, v11
    v_mul_f32 v11, v11, v9
    v_add_f32 v11, 0x3e800000, v11
    v_fract_f32 v17, v11
    v_add_u32 v11, 7, v10
    v_cvt_f32_u32 v11, v11
    v_mul_f32 v11, v11, v9
    v_fract_f32 v18, v11
    v_add_u32 v11, 7, v10
    v_cvt_f32_u32 v11, v11
    v_mul_f32 v11, v11, v9
    v_add_f32 v11, 0x3e800000, v11
    v_fract_f32 v19, v11
    v_cos_f32 v12, v12
    v_cos_f32 v13, v13
    v_cos_f32 v14, v14
    v_cos_f32 v15, v15
    v_cos_f32 v16, v16
    v_cos_f32 v17, v17
    v_cos_f32 v18, v18
    v_cos_f32 v19, v19
    s_nop 0
    v_cvt_pk_bf16_f32 v24, v12, v13
    v_cvt_pk_bf16_f32 v25, v14, v15
    v_cvt_pk_bf16_f32 v26, v16, v17
    v_cvt_pk_bf16_f32 v27, v18, v19
    s_add_u32 s34, s33, 8192
    buffer_store_dwordx4 v[24:27], v6, s[12:15], s34 offen sc1
    s_nop 1
    v_add_u32 v11, 33, v10
    v_cvt_f32_u32 v11, v11
    v_mul_f32 v11, v11, v9
    v_fract_f32 v12, v11
    v_add_u32 v11, 33, v10
    v_cvt_f32_u32 v11, v11
    v_mul_f32 v11, v11, v9
    v_add_f32 v11, 0x3e800000, v11
    v_fract_f32 v13, v11
    v_add_u32 v11, 35, v10
    v_cvt_f32_u32 v11, v11
    v_mul_f32 v11, v11, v9
    v_fract_f32 v14, v11
    v_add_u32 v11, 35, v10
    v_cvt_f32_u32 v11, v11
    v_mul_f32 v11, v11, v9
    v_add_f32 v11, 0x3e800000, v11
    v_fract_f32 v15, v11
    v_add_u32 v11, 37, v10
    v_cvt_f32_u32 v11, v11
    v_mul_f32 v11, v11, v9
    v_fract_f32 v16, v11
    v_add_u32 v11, 37, v10
    v_cvt_f32_u32 v11, v11
    v_mul_f32 v11, v11, v9
    v_add_f32 v11, 0x3e800000, v11
    v_fract_f32 v17, v11
    v_add_u32 v11, 39, v10
    v_cvt_f32_u32 v11, v11
    v_mul_f32 v11, v11, v9
    v_fract_f32 v18, v11
    v_add_u32 v11, 39, v10
    v_cvt_f32_u32 v11, v11
    v_mul_f32 v11, v11, v9
    v_add_f32 v11, 0x3e800000, v11
    v_fract_f32 v19, v11
    v_cos_f32 v12, v12
    v_cos_f32 v13, v13
    v_cos_f32 v14, v14
    v_cos_f32 v15, v15
    v_cos_f32 v16, v16
    v_cos_f32 v17, v17
    v_cos_f32 v18, v18
    v_cos_f32 v19, v19
    s_nop 0
    v_cvt_pk_bf16_f32 v24, v12, v13
    v_cvt_pk_bf16_f32 v25, v14, v15
    v_cvt_pk_bf16_f32 v26, v16, v17
    v_cvt_pk_bf16_f32 v27, v18, v19
    s_add_u32 s34, s33, 9216
    buffer_store_dwordx4 v[24:27], v6, s[12:15], s34 offen sc1
    s_nop 1
L_prep_kernel_done:
    s_endpgm
.globl gemm1_kernel
.p2align 8
.type gemm1_kernel,@function
gemm1_kernel:
    s_cmp_ge_u32 s2, 256
    s_cbranch_scc1 L_gemm1_kernel_done
    s_load_dwordx2 s[4:5], s[0:1], 72
    s_load_dwordx2 s[6:7], s[0:1], 72
    v_readfirstlane_b32 s20, v0
    s_lshr_b32 s20, s20, 6
    s_and_b32 s24, s2, 7
    s_lshr_b32 s25, s2, 3
    s_lshr_b32 s26, s25, 3
    s_lshl_b32 s24, s24, 2
    s_add_u32 s21, s24, s26
    s_and_b32 s25, s25, 7
    s_lshr_b32 s26, s25, 1
    s_and_b32 s27, s25, 1
    s_mul_i32 s22, s26, 84
    s_sub_u32 s28, 334, s22
    s_min_u32 s28, s28, 84
    s_waitcnt lgkmcnt(0)
    s_mul_i32 s29, s21, 684032
    s_lshl_b32 s30, s22, 11
    s_add_u32 s29, s29, s30
    s_add_u32 s29, s29, 0
    s_add_u32 s8, s6, s29
    s_addc_u32 s9, s7, 0
    s_lshl_b32 s10, s28, 11
    s_mov_b32 s11, 0x00020000
    s_mul_i32 s29, s21, 528640
    s_mul_i32 s30, s27, 16384
    s_add_u32 s29, s29, s30
    s_add_u32 s29, s29, 21954560
    s_add_u32 s12, s4, s29
    s_addc_u32 s13, s5, 0
    s_mov_b32 s14, 507904
    s_mov_b32 s15, 0x00020000
    s_cmp_lt_u32 s20, 4
    s_cbranch_scc1 L_gemm1_kernel_consumer
    s_sub_u32 s20, s20, 4
    v_and_b32 v1, 63, v0
    v_lshrrev_b32 v4, 3, v1
    v_and_b32 v5, 7, v1
    v_xor_b32 v5, v5, v4
    v_lshlrev_b32 v5, 4, v5
    v_lshl_add_u32 v2, v4, 11, v5
    v_lshlrev_b32 v3, 4, v1
    s_add_u32 s24, s20, 0
    s_lshl_b32 s40, s24, 10
    s_lshl_b32 s43, s24, 14
    s_add_u32 s24, s20, 4
    s_lshl_b32 s41, s24, 10
    s_lshl_b32 s44, s24, 14
    s_add_u32 s24, s20, 8
    s_lshl_b32 s42, s24, 10
    s_lshl_b32 s45, s24, 14
    s_mul_i32 s46, s20, 4096
    s_add_u32 s47, s46, 12288
    s_add_u32 m0, s40, 0
    s_add_u32 s24, s43, 0
    buffer_load_dwordx4 v2, s[8:11], s24 offen lds
    s_add_u32 m0, s41, 0
    s_add_u32 s24, s44, 0
    buffer_load_dwordx4 v2, s[8:11], s24 offen lds
    s_add_u32 m0, s42, 0
    s_add_u32 s24, s45, 0
    buffer_load_dwordx4 v2, s[8:11], s24 offen lds
    s_add_u32 m0, s47, 0
    s_add_u32 s24, s46, 0
    buffer_load_dwordx4 v3, s[12:15], s24 offen offset:0 lds
    buffer_load_dwordx4 v3, s[12:15], s24 offen offset:1024 lds
    buffer_load_dwordx4 v3, s[12:15], s24 offen offset:2048 lds
    buffer_load_dwordx4 v3, s[12:15], s24 offen offset:3072 lds
    s_add_u32 m0, s40, 28672
    s_add_u32 s24, s43, 128
    buffer_load_dwordx4 v2, s[8:11], s24 offen lds
    s_add_u32 m0, s41, 28672
    s_add_u32 s24, s44, 128
    buffer_load_dwordx4 v2, s[8:11], s24 offen lds
    s_add_u32 m0, s42, 28672
    s_add_u32 s24, s45, 128
    buffer_load_dwordx4 v2, s[8:11], s24 offen lds
    s_add_u32 m0, s47, 28672
    s_add_u32 s24, s46, 32768
    buffer_load_dwordx4 v3, s[12:15], s24 offen offset:0 lds
    buffer_load_dwordx4 v3, s[12:15], s24 offen offset:1024 lds
    buffer_load_dwordx4 v3, s[12:15], s24 offen offset:2048 lds
    buffer_load_dwordx4 v3, s[12:15], s24 offen offset:3072 lds
    s_waitcnt vmcnt(7)
    s_barrier
    s_add_u32 m0, s40, 57344
    s_add_u32 s24, s43, 256
    buffer_load_dwordx4 v2, s[8:11], s24 offen lds
    s_add_u32 m0, s41, 57344
    s_add_u32 s24, s44, 256
    buffer_load_dwordx4 v2, s[8:11], s24 offen lds
    s_add_u32 m0, s42, 57344
    s_add_u32 s24, s45, 256
    buffer_load_dwordx4 v2, s[8:11], s24 offen lds
    s_add_u32 m0, s47, 57344
    s_add_u32 s24, s46, 65536
    buffer_load_dwordx4 v3, s[12:15], s24 offen offset:0 lds
    buffer_load_dwordx4 v3, s[12:15], s24 offen offset:1024 lds
    buffer_load_dwordx4 v3, s[12:15], s24 offen offset:2048 lds
    buffer_load_dwordx4 v3, s[12:15], s24 offen offset:3072 lds
    s_waitcnt vmcnt(7)
    s_barrier
    s_add_u32 m0, s40, 86016
    s_add_u32 s24, s43, 384
    buffer_load_dwordx4 v2, s[8:11], s24 offen lds
    s_add_u32 m0, s41, 86016
    s_add_u32 s24, s44, 384
    buffer_load_dwordx4 v2, s[8:11], s24 offen lds
    s_add_u32 m0, s42, 86016
    s_add_u32 s24, s45, 384
    buffer_load_dwordx4 v2, s[8:11], s24 offen lds
    s_add_u32 m0, s47, 86016
    s_add_u32 s24, s46, 98304
    buffer_load_dwordx4 v3, s[12:15], s24 offen offset:0 lds
    buffer_load_dwordx4 v3, s[12:15], s24 offen offset:1024 lds
    buffer_load_dwordx4 v3, s[12:15], s24 offen offset:2048 lds
    buffer_load_dwordx4 v3, s[12:15], s24 offen offset:3072 lds
    s_add_u32 m0, s40, 114688
    s_add_u32 s24, s43, 512
    buffer_load_dwordx4 v2, s[8:11], s24 offen lds
    s_add_u32 m0, s41, 114688
    s_add_u32 s24, s44, 512
    buffer_load_dwordx4 v2, s[8:11], s24 offen lds
    s_add_u32 m0, s42, 114688
    s_add_u32 s24, s45, 512
    buffer_load_dwordx4 v2, s[8:11], s24 offen lds
    s_add_u32 m0, s47, 114688
    s_add_u32 s24, s46, 131072
    buffer_load_dwordx4 v3, s[12:15], s24 offen offset:0 lds
    buffer_load_dwordx4 v3, s[12:15], s24 offen offset:1024 lds
    buffer_load_dwordx4 v3, s[12:15], s24 offen offset:2048 lds
    buffer_load_dwordx4 v3, s[12:15], s24 offen offset:3072 lds
    s_waitcnt vmcnt(14)
    s_barrier
    s_add_u32 m0, s40, 0
    s_add_u32 s24, s43, 640
    buffer_load_dwordx4 v2, s[8:11], s24 offen lds
    s_add_u32 m0, s41, 0
    s_add_u32 s24, s44, 640
    buffer_load_dwordx4 v2, s[8:11], s24 offen lds
    s_add_u32 m0, s42, 0
    s_add_u32 s24, s45, 640
    buffer_load_dwordx4 v2, s[8:11], s24 offen lds
    s_add_u32 m0, s47, 0
    s_add_u32 s24, s46, 163840
    buffer_load_dwordx4 v3, s[12:15], s24 offen offset:0 lds
    buffer_load_dwordx4 v3, s[12:15], s24 offen offset:1024 lds
    buffer_load_dwordx4 v3, s[12:15], s24 offen offset:2048 lds
    buffer_load_dwordx4 v3, s[12:15], s24 offen offset:3072 lds
    s_add_u32 m0, s40, 28672
    s_add_u32 s24, s43, 768
    buffer_load_dwordx4 v2, s[8:11], s24 offen lds
    s_add_u32 m0, s41, 28672
    s_add_u32 s24, s44, 768
    buffer_load_dwordx4 v2, s[8:11], s24 offen lds
    s_add_u32 m0, s42, 28672
    s_add_u32 s24, s45, 768
    buffer_load_dwordx4 v2, s[8:11], s24 offen lds
    s_add_u32 m0, s47, 28672
    s_add_u32 s24, s46, 196608
    buffer_load_dwordx4 v3, s[12:15], s24 offen offset:0 lds
    buffer_load_dwordx4 v3, s[12:15], s24 offen offset:1024 lds
    buffer_load_dwordx4 v3, s[12:15], s24 offen offset:2048 lds
    buffer_load_dwordx4 v3, s[12:15], s24 offen offset:3072 lds
    s_waitcnt vmcnt(21)
    s_barrier
    s_add_u32 m0, s40, 57344
    s_add_u32 s24, s43, 896
    buffer_load_dwordx4 v2, s[8:11], s24 offen lds
    s_add_u32 m0, s41, 57344
    s_add_u32 s24, s44, 896
    buffer_load_dwordx4 v2, s[8:11], s24 offen lds
    s_add_u32 m0, s42, 57344
    s_add_u32 s24, s45, 896
    buffer_load_dwordx4 v2, s[8:11], s24 offen lds
    s_add_u32 m0, s47, 57344
    s_add_u32 s24, s46, 229376
    buffer_load_dwordx4 v3, s[12:15], s24 offen offset:0 lds
    buffer_load_dwordx4 v3, s[12:15], s24 offen offset:1024 lds
    buffer_load_dwordx4 v3, s[12:15], s24 offen offset:2048 lds
    buffer_load_dwordx4 v3, s[12:15], s24 offen offset:3072 lds
    s_waitcnt vmcnt(21)
    s_barrier
    s_add_u32 m0, s40, 86016
    s_add_u32 s24, s43, 1024
    buffer_load_dwordx4 v2, s[8:11], s24 offen lds
    s_add_u32 m0, s41, 86016
    s_add_u32 s24, s44, 1024
    buffer_load_dwordx4 v2, s[8:11], s24 offen lds
    s_add_u32 m0, s42, 86016
    s_add_u32 s24, s45, 1024
    buffer_load_dwordx4 v2, s[8:11], s24 offen lds
    s_add_u32 m0, s47, 86016
    s_add_u32 s24, s46, 262144
    buffer_load_dwordx4 v3, s[12:15], s24 offen offset:0 lds
    buffer_load_dwordx4 v3, s[12:15], s24 offen offset:1024 lds
    buffer_load_dwordx4 v3, s[12:15], s24 offen offset:2048 lds
    buffer_load_dwordx4 v3, s[12:15], s24 offen offset:3072 lds
    s_waitcnt vmcnt(21)
    s_barrier
    s_add_u32 m0, s40, 114688
    s_add_u32 s24, s43, 1152
    buffer_load_dwordx4 v2, s[8:11], s24 offen lds
    s_add_u32 m0, s41, 114688
    s_add_u32 s24, s44, 1152
    buffer_load_dwordx4 v2, s[8:11], s24 offen lds
    s_add_u32 m0, s42, 114688
    s_add_u32 s24, s45, 1152
    buffer_load_dwordx4 v2, s[8:11], s24 offen lds
    s_add_u32 m0, s47, 114688
    s_add_u32 s24, s46, 294912
    buffer_load_dwordx4 v3, s[12:15], s24 offen offset:0 lds
    buffer_load_dwordx4 v3, s[12:15], s24 offen offset:1024 lds
    buffer_load_dwordx4 v3, s[12:15], s24 offen offset:2048 lds
    buffer_load_dwordx4 v3, s[12:15], s24 offen offset:3072 lds
    s_waitcnt vmcnt(21)
    s_barrier
    s_add_u32 m0, s40, 0
    s_add_u32 s24, s43, 1280
    buffer_load_dwordx4 v2, s[8:11], s24 offen lds
    s_add_u32 m0, s41, 0
    s_add_u32 s24, s44, 1280
    buffer_load_dwordx4 v2, s[8:11], s24 offen lds
    s_add_u32 m0, s42, 0
    s_add_u32 s24, s45, 1280
    buffer_load_dwordx4 v2, s[8:11], s24 offen lds
    s_add_u32 m0, s47, 0
    s_add_u32 s24, s46, 327680
    buffer_load_dwordx4 v3, s[12:15], s24 offen offset:0 lds
    buffer_load_dwordx4 v3, s[12:15], s24 offen offset:1024 lds
    buffer_load_dwordx4 v3, s[12:15], s24 offen offset:2048 lds
    buffer_load_dwordx4 v3, s[12:15], s24 offen offset:3072 lds
    s_waitcnt vmcnt(21)
    s_barrier
    s_add_u32 m0, s40, 28672
    s_add_u32 s24, s43, 1408
    buffer_load_dwordx4 v2, s[8:11], s24 offen lds
    s_add_u32 m0, s41, 28672
    s_add_u32 s24, s44, 1408
    buffer_load_dwordx4 v2, s[8:11], s24 offen lds
    s_add_u32 m0, s42, 28672
    s_add_u32 s24, s45, 1408
    buffer_load_dwordx4 v2, s[8:11], s24 offen lds
    s_add_u32 m0, s47, 28672
    s_add_u32 s24, s46, 360448
    buffer_load_dwordx4 v3, s[12:15], s24 offen offset:0 lds
    buffer_load_dwordx4 v3, s[12:15], s24 offen offset:1024 lds
    buffer_load_dwordx4 v3, s[12:15], s24 offen offset:2048 lds
    buffer_load_dwordx4 v3, s[12:15], s24 offen offset:3072 lds
    s_waitcnt vmcnt(21)
    s_barrier
    s_add_u32 m0, s40, 57344
    s_add_u32 s24, s43, 1536
    buffer_load_dwordx4 v2, s[8:11], s24 offen lds
    s_add_u32 m0, s41, 57344
    s_add_u32 s24, s44, 1536
    buffer_load_dwordx4 v2, s[8:11], s24 offen lds
    s_add_u32 m0, s42, 57344
    s_add_u32 s24, s45, 1536
    buffer_load_dwordx4 v2, s[8:11], s24 offen lds
    s_add_u32 m0, s47, 57344
    s_add_u32 s24, s46, 393216
    buffer_load_dwordx4 v3, s[12:15], s24 offen offset:0 lds
    buffer_load_dwordx4 v3, s[12:15], s24 offen offset:1024 lds
    buffer_load_dwordx4 v3, s[12:15], s24 offen offset:2048 lds
    buffer_load_dwordx4 v3, s[12:15], s24 offen offset:3072 lds
    s_waitcnt vmcnt(21)
    s_barrier
    s_add_u32 m0, s40, 86016
    s_add_u32 s24, s43, 1664
    buffer_load_dwordx4 v2, s[8:11], s24 offen lds
    s_add_u32 m0, s41, 86016
    s_add_u32 s24, s44, 1664
    buffer_load_dwordx4 v2, s[8:11], s24 offen lds
    s_add_u32 m0, s42, 86016
    s_add_u32 s24, s45, 1664
    buffer_load_dwordx4 v2, s[8:11], s24 offen lds
    s_add_u32 m0, s47, 86016
    s_add_u32 s24, s46, 425984
    buffer_load_dwordx4 v3, s[12:15], s24 offen offset:0 lds
    buffer_load_dwordx4 v3, s[12:15], s24 offen offset:1024 lds
    buffer_load_dwordx4 v3, s[12:15], s24 offen offset:2048 lds
    buffer_load_dwordx4 v3, s[12:15], s24 offen offset:3072 lds
    s_waitcnt vmcnt(21)
    s_barrier
    s_add_u32 m0, s40, 114688
    s_add_u32 s24, s43, 1792
    buffer_load_dwordx4 v2, s[8:11], s24 offen lds
    s_add_u32 m0, s41, 114688
    s_add_u32 s24, s44, 1792
    buffer_load_dwordx4 v2, s[8:11], s24 offen lds
    s_add_u32 m0, s42, 114688
    s_add_u32 s24, s45, 1792
    buffer_load_dwordx4 v2, s[8:11], s24 offen lds
    s_add_u32 m0, s47, 114688
    s_add_u32 s24, s46, 458752
    buffer_load_dwordx4 v3, s[12:15], s24 offen offset:0 lds
    buffer_load_dwordx4 v3, s[12:15], s24 offen offset:1024 lds
    buffer_load_dwordx4 v3, s[12:15], s24 offen offset:2048 lds
    buffer_load_dwordx4 v3, s[12:15], s24 offen offset:3072 lds
    s_waitcnt vmcnt(21)
    s_barrier
    s_add_u32 m0, s40, 0
    s_add_u32 s24, s43, 1920
    buffer_load_dwordx4 v2, s[8:11], s24 offen lds
    s_add_u32 m0, s41, 0
    s_add_u32 s24, s44, 1920
    buffer_load_dwordx4 v2, s[8:11], s24 offen lds
    s_add_u32 m0, s42, 0
    s_add_u32 s24, s45, 1920
    buffer_load_dwordx4 v2, s[8:11], s24 offen lds
    s_add_u32 m0, s47, 0
    s_add_u32 s24, s46, 491520
    buffer_load_dwordx4 v3, s[12:15], s24 offen offset:0 lds
    buffer_load_dwordx4 v3, s[12:15], s24 offen offset:1024 lds
    buffer_load_dwordx4 v3, s[12:15], s24 offen offset:2048 lds
    buffer_load_dwordx4 v3, s[12:15], s24 offen offset:3072 lds
    s_waitcnt vmcnt(21)
    s_barrier
    s_waitcnt vmcnt(14)
    s_barrier
    s_waitcnt vmcnt(7)
    s_barrier
    s_waitcnt vmcnt(0)
    s_barrier
    s_barrier
    s_barrier
L_gemm1_kernel_done:
    s_endpgm
L_gemm1_kernel_consumer:
    s_mul_i32 s29, s22, 37120
    s_add_u32 s29, s29, 38871040
    s_add_u32 s16, s4, s29
    s_addc_u32 s17, s5, 0
    s_mul_i32 s18, s28, 37120
    s_mov_b32 s19, 0x00020000
    s_lshr_b32 s29, s20, 1
    s_and_b32 s30, s20, 1
    v_and_b32 v217, 15, v0
    v_bfe_u32 v218, v0, 4, 2
    v_and_b32 v219, 63, v0
    s_mul_i32 s31, s29, 6144
    v_and_b32 v220, 7, v217
    v_xor_b32 v220, v218, v220
    v_lshlrev_b32 v220, 4, v220
    v_lshl_add_u32 v220, v217, 7, v220
    v_add_u32 v220, s31, v220
    v_add_u32 v208, 0, v220
    v_xor_b32 v211, 64, v208
    v_add_u32 v209, 57344, v220
    v_xor_b32 v212, 64, v209
    v_add_u32 v210, 114688, v220
    v_xor_b32 v213, 64, v210
    s_mul_i32 s31, s30, 8192
    s_add_u32 s31, s31, 12288
    v_lshlrev_b32 v220, 4, v219
    v_add_u32 v220, s31, v220
    v_add_u32 v214, 0, v220
    v_add_u32 v215, 57344, v220
    v_add_u32 v216, 114688, v220
    v_and_b32 v224, 7, v217
    v_lshrrev_b32 v225, 3, v217
    v_mul_u32_u24 v222, 37120, v224
    v_lshl_add_u32 v222, v218, 4, v222
    s_mul_i32 s31, s29, 1781760
    v_add_u32 v222, s31, v222
    v_lshl_add_u32 v222, v225, 6, v222
    v_xor_b32 v225, 64, v222
    v_add_u32 v223, 296960, v225
    s_mul_i32 s31, s27, 4
    s_mul_i32 s29, s30, 2
    s_add_u32 s31, s31, s29
    s_mul_i32 s31, s31, 128
    s_mul_i32 s29, s21, 1024
    s_add_u32 s33, s31, s29
    s_mov_b32 s34, 0x80008000
    v_mov_b32 v0, 0
    v_mov_b32 v48, 0
    v_mov_b32 v1, 0
    v_mov_b32 v49, 0
    v_mov_b32 v2, 0
    v_mov_b32 v50, 0
    v_mov_b32 v3, 0
    v_mov_b32 v51, 0
    v_mov_b32 v4, 0
    v_mov_b32 v52, 0
    v_mov_b32 v5, 0
    v_mov_b32 v53, 0
    v_mov_b32 v6, 0
    v_mov_b32 v54, 0
    v_mov_b32 v7, 0
    v_mov_b32 v55, 0
    v_mov_b32 v8, 0
    v_mov_b32 v56, 0
    v_mov_b32 v9, 0
    v_mov_b32 v57, 0
    v_mov_b32 v10, 0
    v_mov_b32 v58, 0
    v_mov_b32 v11, 0
    v_mov_b32 v59, 0
    v_mov_b32 v12, 0
    v_mov_b32 v60, 0
    v_mov_b32 v13, 0
    v_mov_b32 v61, 0
    v_mov_b32 v14, 0
    v_mov_b32 v62, 0
    v_mov_b32 v15, 0
    v_mov_b32 v63, 0
    v_mov_b32 v16, 0
    v_mov_b32 v64, 0
    v_mov_b32 v17, 0
    v_mov_b32 v65, 0
    v_mov_b32 v18, 0
    v_mov_b32 v66, 0
    v_mov_b32 v19, 0
    v_mov_b32 v67, 0
    v_mov_b32 v20, 0
    v_mov_b32 v68, 0
    v_mov_b32 v21, 0
    v_mov_b32 v69, 0
    v_mov_b32 v22, 0
    v_mov_b32 v70, 0
    v_mov_b32 v23, 0
    v_mov_b32 v71, 0
    v_mov_b32 v24, 0
    v_mov_b32 v72, 0
    v_mov_b32 v25, 0
    v_mov_b32 v73, 0
    v_mov_b32 v26, 0
    v_mov_b32 v74, 0
    v_mov_b32 v27, 0
    v_mov_b32 v75, 0
    v_mov_b32 v28, 0
    v_mov_b32 v76, 0
    v_mov_b32 v29, 0
    v_mov_b32 v77, 0
    v_mov_b32 v30, 0
    v_mov_b32 v78, 0
    v_mov_b32 v31, 0
    v_mov_b32 v79, 0
    v_mov_b32 v32, 0
    v_mov_b32 v80, 0
    v_mov_b32 v33, 0
    v_mov_b32 v81, 0
    v_mov_b32 v34, 0
    v_mov_b32 v82, 0
    v_mov_b32 v35, 0
    v_mov_b32 v83, 0
    v_mov_b32 v36, 0
    v_mov_b32 v84, 0
    v_mov_b32 v37, 0
    v_mov_b32 v85, 0
    v_mov_b32 v38, 0
    v_mov_b32 v86, 0
    v_mov_b32 v39, 0
    v_mov_b32 v87, 0
    v_mov_b32 v40, 0
    v_mov_b32 v88, 0
    v_mov_b32 v41, 0
    v_mov_b32 v89, 0
    v_mov_b32 v42, 0
    v_mov_b32 v90, 0
    v_mov_b32 v43, 0
    v_mov_b32 v91, 0
    v_mov_b32 v44, 0
    v_mov_b32 v92, 0
    v_mov_b32 v45, 0
    v_mov_b32 v93, 0
    v_mov_b32 v46, 0
    v_mov_b32 v94, 0
    v_mov_b32 v47, 0
    v_mov_b32 v95, 0
    s_mov_b32 s38, 0
    v_add_u32 v209, s38, v208
    v_add_u32 v215, s38, v214
    v_xor_b32 v211, 64, v209
    s_add_u32 s38, s38, 28672
    s_cmp_eq_u32 s38, 143360
    s_cselect_b32 s38, 0, s38
    s_barrier
    ds_read_b128 v[96:99], v215 offset:0
    ds_read_b128 v[128:131], v209 offset:0
    ds_read_b128 v[136:139], v209 offset:2048
    ds_read_b128 v[144:147], v209 offset:4096
    ds_read_b128 v[104:107], v215 offset:2048
    ds_read_b128 v[112:115], v215 offset:4096
    ds_read_b128 v[120:123], v215 offset:6144
    ds_read_b128 v[132:135], v211 offset:0
    ds_read_b128 v[140:143], v211 offset:2048
    ds_read_b128 v[148:151], v211 offset:4096
    ds_read_b128 v[100:103], v215 offset:1024
    ds_read_b128 v[108:111], v215 offset:3072
    ds_read_b128 v[116:119], v215 offset:5120
    ds_read_b128 v[124:127], v215 offset:7168
    v_add_u32 v209, s38, v208
    v_add_u32 v215, s38, v214
    v_xor_b32 v211, 64, v209
    s_add_u32 s38, s38, 28672
    s_cmp_eq_u32 s38, 143360
    s_cselect_b32 s38, 0, s38
    s_mov_b32 s39, 8
    s_waitcnt lgkmcnt(0)
    s_barrier
L_gemm1_kernel_loop:
    v_mfma_f32_16x16x32_bf16 v[0:3], v[96:99], v[128:131], v[0:3]
    ds_read_b128 v[152:155], v215 offset:0
    v_mfma_f32_16x16x32_bf16 v[4:7], v[96:99], v[136:139], v[4:7]
    v_mfma_f32_16x16x32_bf16 v[8:11], v[96:99], v[144:147], v[8:11]
    ds_read_b128 v[184:187], v209 offset:0
    v_mfma_f32_16x16x32_bf16 v[12:15], v[104:107], v[128:131], v[12:15]
    v_mfma_f32_16x16x32_bf16 v[16:19], v[104:107], v[136:139], v[16:19]
    ds_read_b128 v[192:195], v209 offset:2048
    v_mfma_f32_16x16x32_bf16 v[20:23], v[104:107], v[144:147], v[20:23]
    v_mfma_f32_16x16x32_bf16 v[24:27], v[112:115], v[128:131], v[24:27]
    ds_read_b128 v[200:203], v209 offset:4096
    v_mfma_f32_16x16x32_bf16 v[28:31], v[112:115], v[136:139], v[28:31]
    v_mfma_f32_16x16x32_bf16 v[32:35], v[112:115], v[144:147], v[32:35]
    ds_read_b128 v[160:163], v215 offset:2048
    v_mfma_f32_16x16x32_bf16 v[36:39], v[120:123], v[128:131], v[36:39]
    v_mfma_f32_16x16x32_bf16 v[40:43], v[120:123], v[136:139], v[40:43]
    ds_read_b128 v[168:171], v215 offset:4096
    v_mfma_f32_16x16x32_bf16 v[44:47], v[120:123], v[144:147], v[44:47]
    v_mfma_f32_16x16x32_bf16 v[48:51], v[96:99], v[132:135], v[48:51]
    ds_read_b128 v[176:179], v215 offset:6144
    v_mfma_f32_16x16x32_bf16 v[52:55], v[96:99], v[140:143], v[52:55]
    v_mfma_f32_16x16x32_bf16 v[56:59], v[96:99], v[148:151], v[56:59]
    ds_read_b128 v[188:191], v211 offset:0
    v_mfma_f32_16x16x32_bf16 v[60:63], v[104:107], v[132:135], v[60:63]
    v_mfma_f32_16x16x32_bf16 v[64:67], v[104:107], v[140:143], v[64:67]
    ds_read_b128 v[196:199], v211 offset:2048
    v_mfma_f32_16x16x32_bf16 v[68:71], v[104:107], v[148:151], v[68:71]
    v_mfma_f32_16x16x32_bf16 v[72:75], v[112:115], v[132:135], v[72:75]
    ds_read_b128 v[204:207], v211 offset:4096
    v_mfma_f32_16x16x32_bf16 v[76:79], v[112:115], v[140:143], v[76:79]
    v_mfma_f32_16x16x32_bf16 v[80:83], v[112:115], v[148:151], v[80:83]
    ds_read_b128 v[156:159], v215 offset:1024
    v_mfma_f32_16x16x32_bf16 v[84:87], v[120:123], v[132:135], v[84:87]
    v_mfma_f32_16x16x32_bf16 v[88:91], v[120:123], v[140:143], v[88:91]
    ds_read_b128 v[164:167], v215 offset:3072
    v_mfma_f32_16x16x32_bf16 v[92:95], v[120:123], v[148:151], v[92:95]
    v_mfma_f32_16x16x32_bf16 v[48:51], v[100:103], v[128:131], v[48:51]
    ds_read_b128 v[172:175], v215 offset:5120
    v_xor_b32 v132, s34, v132
    v_xor_b32 v133, s34, v133
    v_mfma_f32_16x16x32_bf16 v[52:55], v[100:103], v[136:139], v[52:55]
    v_xor_b32 v134, s34, v134
    v_xor_b32 v135, s34, v135
    v_mfma_f32_16x16x32_bf16 v[56:59], v[100:103], v[144:147], v[56:59]
    ds_read_b128 v[180:183], v215 offset:7168
    v_xor_b32 v140, s34, v140
    v_xor_b32 v141, s34, v141
    v_mfma_f32_16x16x32_bf16 v[60:63], v[108:111], v[128:131], v[60:63]
    v_xor_b32 v142, s34, v142
    v_xor_b32 v143, s34, v143
    v_mfma_f32_16x16x32_bf16 v[64:67], v[108:111], v[136:139], v[64:67]
    v_xor_b32 v148, s34, v148
    v_xor_b32 v149, s34, v149
    v_mfma_f32_16x16x32_bf16 v[68:71], v[108:111], v[144:147], v[68:71]
    v_xor_b32 v150, s34, v150
    v_xor_b32 v151, s34, v151
    v_mfma_f32_16x16x32_bf16 v[72:75], v[116:119], v[128:131], v[72:75]
    v_mfma_f32_16x16x32_bf16 v[76:79], v[116:119], v[136:139], v[76:79]
    v_mfma_f32_16x16x32_bf16 v[80:83], v[116:119], v[144:147], v[80:83]
    v_mfma_f32_16x16x32_bf16 v[84:87], v[124:127], v[128:131], v[84:87]
    v_mfma_f32_16x16x32_bf16 v[88:91], v[124:127], v[136:139], v[88:91]
    v_mfma_f32_16x16x32_bf16 v[92:95], v[124:127], v[144:147], v[92:95]
    v_mfma_f32_16x16x32_bf16 v[0:3], v[100:103], v[132:135], v[0:3]
    v_mfma_f32_16x16x32_bf16 v[4:7], v[100:103], v[140:143], v[4:7]
    v_mfma_f32_16x16x32_bf16 v[8:11], v[100:103], v[148:151], v[8:11]
    v_mfma_f32_16x16x32_bf16 v[12:15], v[108:111], v[132:135], v[12:15]
    v_mfma_f32_16x16x32_bf16 v[16:19], v[108:111], v[140:143], v[16:19]
    s_waitcnt lgkmcnt(0)
    s_barrier
    v_mfma_f32_16x16x32_bf16 v[20:23], v[108:111], v[148:151], v[20:23]
    v_add_u32 v209, s38, v208
    v_add_u32 v215, s38, v214
    v_mfma_f32_16x16x32_bf16 v[24:27], v[116:119], v[132:135], v[24:27]
    v_xor_b32 v211, 64, v209
    s_add_u32 s38, s38, 28672
    v_mfma_f32_16x16x32_bf16 v[28:31], v[116:119], v[140:143], v[28:31]
    s_cmp_eq_u32 s38, 143360
    s_cselect_b32 s38, 0, s38
    v_mfma_f32_16x16x32_bf16 v[32:35], v[116:119], v[148:151], v[32:35]
    v_mfma_f32_16x16x32_bf16 v[36:39], v[124:127], v[132:135], v[36:39]
    v_mfma_f32_16x16x32_bf16 v[40:43], v[124:127], v[140:143], v[40:43]
    v_mfma_f32_16x16x32_bf16 v[44:47], v[124:127], v[148:151], v[44:47]
    v_mfma_f32_16x16x32_bf16 v[0:3], v[152:155], v[184:187], v[0:3]
    ds_read_b128 v[96:99], v215 offset:0
    v_mfma_f32_16x16x32_bf16 v[4:7], v[152:155], v[192:195], v[4:7]
    v_mfma_f32_16x16x32_bf16 v[8:11], v[152:155], v[200:203], v[8:11]
    ds_read_b128 v[128:131], v209 offset:0
    v_mfma_f32_16x16x32_bf16 v[12:15], v[160:163], v[184:187], v[12:15]
    v_mfma_f32_16x16x32_bf16 v[16:19], v[160:163], v[192:195], v[16:19]
    ds_read_b128 v[136:139], v209 offset:2048
    v_mfma_f32_16x16x32_bf16 v[20:23], v[160:163], v[200:203], v[20:23]
    v_mfma_f32_16x16x32_bf16 v[24:27], v[168:171], v[184:187], v[24:27]
    ds_read_b128 v[144:147], v209 offset:4096
    v_mfma_f32_16x16x32_bf16 v[28:31], v[168:171], v[192:195], v[28:31]
    v_mfma_f32_16x16x32_bf16 v[32:35], v[168:171], v[200:203], v[32:35]
    ds_read_b128 v[104:107], v215 offset:2048
    v_mfma_f32_16x16x32_bf16 v[36:39], v[176:179], v[184:187], v[36:39]
    v_mfma_f32_16x16x32_bf16 v[40:43], v[176:179], v[192:195], v[40:43]
    ds_read_b128 v[112:115], v215 offset:4096
    v_mfma_f32_16x16x32_bf16 v[44:47], v[176:179], v[200:203], v[44:47]
    v_mfma_f32_16x16x32_bf16 v[48:51], v[152:155], v[188:191], v[48:51]
    ds_read_b128 v[120:123], v215 offset:6144
    v_mfma_f32_16x16x32_bf16 v[52:55], v[152:155], v[196:199], v[52:55]
    v_mfma_f32_16x16x32_bf16 v[56:59], v[152:155], v[204:207], v[56:59]
    ds_read_b128 v[132:135], v211 offset:0
    v_mfma_f32_16x16x32_bf16 v[60:63], v[160:163], v[188:191], v[60:63]
    v_mfma_f32_16x16x32_bf16 v[64:67], v[160:163], v[196:199], v[64:67]
    ds_read_b128 v[140:143], v211 offset:2048
    v_mfma_f32_16x16x32_bf16 v[68:71], v[160:163], v[204:207], v[68:71]
    v_mfma_f32_16x16x32_bf16 v[72:75], v[168:171], v[188:191], v[72:75]
    ds_read_b128 v[148:151], v211 offset:4096
    v_mfma_f32_16x16x32_bf16 v[76:79], v[168:171], v[196:199], v[76:79]
    v_mfma_f32_16x16x32_bf16 v[80:83], v[168:171], v[204:207], v[80:83]
    ds_read_b128 v[100:103], v215 offset:1024
    v_mfma_f32_16x16x32_bf16 v[84:87], v[176:179], v[188:191], v[84:87]
    v_mfma_f32_16x16x32_bf16 v[88:91], v[176:179], v[196:199], v[88:91]
    ds_read_b128 v[108:111], v215 offset:3072
    v_mfma_f32_16x16x32_bf16 v[92:95], v[176:179], v[204:207], v[92:95]
    v_mfma_f32_16x16x32_bf16 v[48:51], v[156:159], v[184:187], v[48:51]
    ds_read_b128 v[116:119], v215 offset:5120
    v_xor_b32 v188, s34, v188
    v_xor_b32 v189, s34, v189
    v_mfma_f32_16x16x32_bf16 v[52:55], v[156:159], v[192:195], v[52:55]
    v_xor_b32 v190, s34, v190
    v_xor_b32 v191, s34, v191
    v_mfma_f32_16x16x32_bf16 v[56:59], v[156:159], v[200:203], v[56:59]
    ds_read_b128 v[124:127], v215 offset:7168
    v_xor_b32 v196, s34, v196
    v_xor_b32 v197, s34, v197
    v_mfma_f32_16x16x32_bf16 v[60:63], v[164:167], v[184:187], v[60:63]
    v_xor_b32 v198, s34, v198
    v_xor_b32 v199, s34, v199
    v_mfma_f32_16x16x32_bf16 v[64:67], v[164:167], v[192:195], v[64:67]
    v_xor_b32 v204, s34, v204
    v_xor_b32 v205, s34, v205
    v_mfma_f32_16x16x32_bf16 v[68:71], v[164:167], v[200:203], v[68:71]
    v_xor_b32 v206, s34, v206
    v_xor_b32 v207, s34, v207
    v_mfma_f32_16x16x32_bf16 v[72:75], v[172:175], v[184:187], v[72:75]
    v_mfma_f32_16x16x32_bf16 v[76:79], v[172:175], v[192:195], v[76:79]
    v_mfma_f32_16x16x32_bf16 v[80:83], v[172:175], v[200:203], v[80:83]
    v_mfma_f32_16x16x32_bf16 v[84:87], v[180:183], v[184:187], v[84:87]
    v_mfma_f32_16x16x32_bf16 v[88:91], v[180:183], v[192:195], v[88:91]
    v_mfma_f32_16x16x32_bf16 v[92:95], v[180:183], v[200:203], v[92:95]
    v_mfma_f32_16x16x32_bf16 v[0:3], v[156:159], v[188:191], v[0:3]
    v_mfma_f32_16x16x32_bf16 v[4:7], v[156:159], v[196:199], v[4:7]
    v_mfma_f32_16x16x32_bf16 v[8:11], v[156:159], v[204:207], v[8:11]
    v_mfma_f32_16x16x32_bf16 v[12:15], v[164:167], v[188:191], v[12:15]
    v_mfma_f32_16x16x32_bf16 v[16:19], v[164:167], v[196:199], v[16:19]
    s_waitcnt lgkmcnt(0)
    s_barrier
    v_mfma_f32_16x16x32_bf16 v[20:23], v[164:167], v[204:207], v[20:23]
    v_add_u32 v209, s38, v208
    v_add_u32 v215, s38, v214
    v_mfma_f32_16x16x32_bf16 v[24:27], v[172:175], v[188:191], v[24:27]
    v_xor_b32 v211, 64, v209
    s_add_u32 s38, s38, 28672
    v_mfma_f32_16x16x32_bf16 v[28:31], v[172:175], v[196:199], v[28:31]
    s_cmp_eq_u32 s38, 143360
    s_cselect_b32 s38, 0, s38
    v_mfma_f32_16x16x32_bf16 v[32:35], v[172:175], v[204:207], v[32:35]
    v_mfma_f32_16x16x32_bf16 v[36:39], v[180:183], v[188:191], v[36:39]
    v_mfma_f32_16x16x32_bf16 v[40:43], v[180:183], v[196:199], v[40:43]
    s_sub_u32 s39, s39, 1
    v_mfma_f32_16x16x32_bf16 v[44:47], v[180:183], v[204:207], v[44:47]
    s_cmp_lg_u32 s39, 0
    s_cbranch_scc1 L_gemm1_kernel_loop
    s_nop 7
    s_nop 7
    v_cvt_pk_bf16_f32 v96, v0, v1
    v_cvt_pk_bf16_f32 v97, v2, v3
    v_cvt_pk_bf16_f32 v98, v12, v13
    v_cvt_pk_bf16_f32 v99, v14, v15
    v_cvt_pk_bf16_f32 v100, v48, v49
    v_cvt_pk_bf16_f32 v101, v50, v51
    v_cvt_pk_bf16_f32 v102, v60, v61
    v_cvt_pk_bf16_f32 v103, v62, v63
    v_mov_b32 v104, v96
    v_mov_b32 v105, v97
    v_mov_b32 v106, v98
    v_mov_b32 v107, v99
    s_add_u32 s35, s33, 0
    v_mov_b32_dpp v104, v100 row_ror:8 row_mask:0xf bank_mask:0x3
    v_mov_b32_dpp v105, v101 row_ror:8 row_mask:0xf bank_mask:0x3
    v_mov_b32_dpp v106, v102 row_ror:8 row_mask:0xf bank_mask:0x3
    v_mov_b32_dpp v107, v103 row_ror:8 row_mask:0xf bank_mask:0x3
    v_mov_b32_dpp v96, v100 row_ror:8 row_mask:0xf bank_mask:0xc
    v_mov_b32_dpp v97, v101 row_ror:8 row_mask:0xf bank_mask:0xc
    v_mov_b32_dpp v98, v102 row_ror:8 row_mask:0xf bank_mask:0xc
    v_mov_b32_dpp v99, v103 row_ror:8 row_mask:0xf bank_mask:0xc
    buffer_store_dwordx4 v[96:99], v222, s[16:19], s35 offen sc1
    buffer_store_dwordx4 v[104:107], v223, s[16:19], s35 offen sc1
    v_cvt_pk_bf16_f32 v108, v4, v5
    v_cvt_pk_bf16_f32 v109, v6, v7
    v_cvt_pk_bf16_f32 v110, v16, v17
    v_cvt_pk_bf16_f32 v111, v18, v19
    v_cvt_pk_bf16_f32 v112, v52, v53
    v_cvt_pk_bf16_f32 v113, v54, v55
    v_cvt_pk_bf16_f32 v114, v64, v65
    v_cvt_pk_bf16_f32 v115, v66, v67
    v_mov_b32 v116, v108
    v_mov_b32 v117, v109
    v_mov_b32 v118, v110
    v_mov_b32 v119, v111
    s_add_u32 s35, s33, 593920
    v_mov_b32_dpp v116, v112 row_ror:8 row_mask:0xf bank_mask:0x3
    v_mov_b32_dpp v117, v113 row_ror:8 row_mask:0xf bank_mask:0x3
    v_mov_b32_dpp v118, v114 row_ror:8 row_mask:0xf bank_mask:0x3
    v_mov_b32_dpp v119, v115 row_ror:8 row_mask:0xf bank_mask:0x3
    v_mov_b32_dpp v108, v112 row_ror:8 row_mask:0xf bank_mask:0xc
    v_mov_b32_dpp v109, v113 row_ror:8 row_mask:0xf bank_mask:0xc
    v_mov_b32_dpp v110, v114 row_ror:8 row_mask:0xf bank_mask:0xc
    v_mov_b32_dpp v111, v115 row_ror:8 row_mask:0xf bank_mask:0xc
    buffer_store_dwordx4 v[108:111], v222, s[16:19], s35 offen sc1
    buffer_store_dwordx4 v[116:119], v223, s[16:19], s35 offen sc1
    v_cvt_pk_bf16_f32 v120, v8, v9
    v_cvt_pk_bf16_f32 v121, v10, v11
    v_cvt_pk_bf16_f32 v122, v20, v21
    v_cvt_pk_bf16_f32 v123, v22, v23
    v_cvt_pk_bf16_f32 v124, v56, v57
    v_cvt_pk_bf16_f32 v125, v58, v59
    v_cvt_pk_bf16_f32 v126, v68, v69
    v_cvt_pk_bf16_f32 v127, v70, v71
    v_mov_b32 v128, v120
    v_mov_b32 v129, v121
    v_mov_b32 v130, v122
    v_mov_b32 v131, v123
    s_add_u32 s35, s33, 1187840
    v_mov_b32_dpp v128, v124 row_ror:8 row_mask:0xf bank_mask:0x3
    v_mov_b32_dpp v129, v125 row_ror:8 row_mask:0xf bank_mask:0x3
    v_mov_b32_dpp v130, v126 row_ror:8 row_mask:0xf bank_mask:0x3
    v_mov_b32_dpp v131, v127 row_ror:8 row_mask:0xf bank_mask:0x3
    v_mov_b32_dpp v120, v124 row_ror:8 row_mask:0xf bank_mask:0xc
    v_mov_b32_dpp v121, v125 row_ror:8 row_mask:0xf bank_mask:0xc
    v_mov_b32_dpp v122, v126 row_ror:8 row_mask:0xf bank_mask:0xc
    v_mov_b32_dpp v123, v127 row_ror:8 row_mask:0xf bank_mask:0xc
    buffer_store_dwordx4 v[120:123], v222, s[16:19], s35 offen sc1
    buffer_store_dwordx4 v[128:131], v223, s[16:19], s35 offen sc1
    v_cvt_pk_bf16_f32 v96, v24, v25
    v_cvt_pk_bf16_f32 v97, v26, v27
    v_cvt_pk_bf16_f32 v98, v36, v37
    v_cvt_pk_bf16_f32 v99, v38, v39
    v_cvt_pk_bf16_f32 v100, v72, v73
    v_cvt_pk_bf16_f32 v101, v74, v75
    v_cvt_pk_bf16_f32 v102, v84, v85
    v_cvt_pk_bf16_f32 v103, v86, v87
    v_mov_b32 v104, v96
    v_mov_b32 v105, v97
    v_mov_b32 v106, v98
    v_mov_b32 v107, v99
    s_add_u32 s35, s33, 128
    v_mov_b32_dpp v104, v100 row_ror:8 row_mask:0xf bank_mask:0x3
    v_mov_b32_dpp v105, v101 row_ror:8 row_mask:0xf bank_mask:0x3
    v_mov_b32_dpp v106, v102 row_ror:8 row_mask:0xf bank_mask:0x3
    v_mov_b32_dpp v107, v103 row_ror:8 row_mask:0xf bank_mask:0x3
    v_mov_b32_dpp v96, v100 row_ror:8 row_mask:0xf bank_mask:0xc
    v_mov_b32_dpp v97, v101 row_ror:8 row_mask:0xf bank_mask:0xc
    v_mov_b32_dpp v98, v102 row_ror:8 row_mask:0xf bank_mask:0xc
    v_mov_b32_dpp v99, v103 row_ror:8 row_mask:0xf bank_mask:0xc
    buffer_store_dwordx4 v[96:99], v222, s[16:19], s35 offen sc1
    buffer_store_dwordx4 v[104:107], v223, s[16:19], s35 offen sc1
    v_cvt_pk_bf16_f32 v108, v28, v29
    v_cvt_pk_bf16_f32 v109, v30, v31
    v_cvt_pk_bf16_f32 v110, v40, v41
    v_cvt_pk_bf16_f32 v111, v42, v43
    v_cvt_pk_bf16_f32 v112, v76, v77
    v_cvt_pk_bf16_f32 v113, v78, v79
    v_cvt_pk_bf16_f32 v114, v88, v89
    v_cvt_pk_bf16_f32 v115, v90, v91
    v_mov_b32 v116, v108
    v_mov_b32 v117, v109
    v_mov_b32 v118, v110
    v_mov_b32 v119, v111
    s_add_u32 s35, s33, 594048
    v_mov_b32_dpp v116, v112 row_ror:8 row_mask:0xf bank_mask:0x3
    v_mov_b32_dpp v117, v113 row_ror:8 row_mask:0xf bank_mask:0x3
    v_mov_b32_dpp v118, v114 row_ror:8 row_mask:0xf bank_mask:0x3
    v_mov_b32_dpp v119, v115 row_ror:8 row_mask:0xf bank_mask:0x3
    v_mov_b32_dpp v108, v112 row_ror:8 row_mask:0xf bank_mask:0xc
    v_mov_b32_dpp v109, v113 row_ror:8 row_mask:0xf bank_mask:0xc
    v_mov_b32_dpp v110, v114 row_ror:8 row_mask:0xf bank_mask:0xc
    v_mov_b32_dpp v111, v115 row_ror:8 row_mask:0xf bank_mask:0xc
    buffer_store_dwordx4 v[108:111], v222, s[16:19], s35 offen sc1
    buffer_store_dwordx4 v[116:119], v223, s[16:19], s35 offen sc1
    v_cvt_pk_bf16_f32 v120, v32, v33
    v_cvt_pk_bf16_f32 v121, v34, v35
    v_cvt_pk_bf16_f32 v122, v44, v45
    v_cvt_pk_bf16_f32 v123, v46, v47
    v_cvt_pk_bf16_f32 v124, v80, v81
    v_cvt_pk_bf16_f32 v125, v82, v83
    v_cvt_pk_bf16_f32 v126, v92, v93
    v_cvt_pk_bf16_f32 v127, v94, v95
    v_mov_b32 v128, v120
    v_mov_b32 v129, v121
    v_mov_b32 v130, v122
    v_mov_b32 v131, v123
    s_add_u32 s35, s33, 1187968
    v_mov_b32_dpp v128, v124 row_ror:8 row_mask:0xf bank_mask:0x3
    v_mov_b32_dpp v129, v125 row_ror:8 row_mask:0xf bank_mask:0x3
    v_mov_b32_dpp v130, v126 row_ror:8 row_mask:0xf bank_mask:0x3
    v_mov_b32_dpp v131, v127 row_ror:8 row_mask:0xf bank_mask:0x3
    v_mov_b32_dpp v120, v124 row_ror:8 row_mask:0xf bank_mask:0xc
    v_mov_b32_dpp v121, v125 row_ror:8 row_mask:0xf bank_mask:0xc
    v_mov_b32_dpp v122, v126 row_ror:8 row_mask:0xf bank_mask:0xc
    v_mov_b32_dpp v123, v127 row_ror:8 row_mask:0xf bank_mask:0xc
    buffer_store_dwordx4 v[120:123], v222, s[16:19], s35 offen sc1
    buffer_store_dwordx4 v[128:131], v223, s[16:19], s35 offen sc1
    s_endpgm
.globl mid_kernel
.p2align 8
.type mid_kernel,@function
mid_kernel:
    s_cmp_ge_u32 s2, 704
    s_cbranch_scc1 L_mid_kernel_done
    v_readfirstlane_b32 s20, v0
    s_lshr_b32 s20, s20, 6
    s_cmp_ge_u32 s2, 448
    s_cbranch_scc1 L_mid_kernel_g
    s_mov_b32 s3, s2
    s_load_dwordx2 s[6:7], s[0:1], 72
    s_load_dwordx2 s[4:5], s[0:1], 72
    s_cmp_ge_u32 s3, 224
    s_cselect_b32 s24, 1, 0
    s_mul_i32 s25, s24, 224
    s_sub_u32 s25, s3, s25
    s_lshr_b32 s26, s25, 3
    s_and_b32 s27, s25, 7
    v_and_b32 v1, 63, v0
    v_lshrrev_b32 v2, 3, v1
    v_mul_u32_u24 v2, 1024, v2
    v_bfe_u32 v3, v1, 2, 1
    v_lshl_add_u32 v2, v3, 6, v2
    v_lshrrev_b32 v3, 5, v1
    v_lshlrev_b32 v3, 1, v3
    v_and_b32 v4, 3, v1
    v_xor_b32 v3, v3, v4
    v_lshl_add_u32 v2, v3, 4, v2
    s_mul_i32 s28, s26, 6
    s_lshl_b32 s29, s20, 1
    s_add_u32 s28, s28, s29
    s_sub_u32 s28, s28, 1
    s_mul_i32 s30, s27, 128
    s_add_u32 s31, s28, 0
    s_mul_i32 s32, s31, 37120
    s_add_u32 s32, s32, s30
    s_cmp_lt_i32 s31, 0
    s_cselect_b32 s32, 0x7f000000, s32
    v_add_u32 v3, s32, v2
    s_add_u32 s31, s28, 1
    s_mul_i32 s32, s31, 37120
    s_add_u32 s32, s32, s30
    s_cmp_lt_i32 s31, 0
    s_cselect_b32 s32, 0x7f000000, s32
    v_add_u32 v4, s32, v2
    s_waitcnt lgkmcnt(0)
    s_mul_i32 s33, s24, 6199040
    s_add_u32 s33, s33, 38871040
    s_add_u32 s8, s6, s33
    s_addc_u32 s9, s7, 0
    s_mov_b32 s10, 6199040
    s_mov_b32 s11, 0x00020000
    s_add_u32 s12, s6, 85499904
    s_addc_u32 s13, s7, 0
    s_mov_b32 s14, 16384
    s_mov_b32 s15, 0x00020000
    s_lshl_b32 s34, s20, 13
    s_add_u32 m0, s34, 0
    s_mov_b32 s35, 0
    buffer_load_dwordx4 v3, s[8:11], s35 offen lds
    s_add_u32 m0, s34, 1024
    s_mov_b32 s35, 8192
    buffer_load_dwordx4 v3, s[8:11], s35 offen lds
    s_add_u32 m0, s34, 2048
    s_mov_b32 s35, 16384
    buffer_load_dwordx4 v3, s[8:11], s35 offen lds
    s_add_u32 m0, s34, 3072
    s_mov_b32 s35, 24576
    buffer_load_dwordx4 v3, s[8:11], s35 offen lds
    s_add_u32 m0, s34, 4096
    s_mov_b32 s35, 0
    buffer_load_dwordx4 v4, s[8:11], s35 offen lds
    s_add_u32 m0, s34, 5120
    s_mov_b32 s35, 8192
    buffer_load_dwordx4 v4, s[8:11], s35 offen lds
    s_add_u32 m0, s34, 6144
    s_mov_b32 s35, 16384
    buffer_load_dwordx4 v4, s[8:11], s35 offen lds
    s_add_u32 m0, s34, 7168
    s_mov_b32 s35, 24576
    buffer_load_dwordx4 v4, s[8:11], s35 offen lds
    v_lshlrev_b32 v5, 4, v1
    s_mov_b32 s35, 8192
    buffer_load_dwordx4 v[8:11], v5, s[12:15], s35 offen
    s_mov_b32 s35, 9216
    buffer_load_dwordx4 v[12:15], v5, s[12:15], s35 offen
    s_mov_b32 s35, 10240
    buffer_load_dwordx4 v[16:19], v5, s[12:15], s35 offen
    s_mov_b32 s35, 11264
    buffer_load_dwordx4 v[20:23], v5, s[12:15], s35 offen
    s_mov_b32 s35, 12288
    buffer_load_dwordx4 v[24:27], v5, s[12:15], s35 offen
    s_mov_b32 s35, 13312
    buffer_load_dwordx4 v[28:31], v5, s[12:15], s35 offen
    s_lshl_b32 s35, s20, 11
    buffer_load_dwordx4 v[32:35], v5, s[12:15], s35 offen offset:0
    buffer_load_dwordx4 v[36:39], v5, s[12:15], s35 offen offset:1024
    v_bfe_u32 v40, v1, 2, 2
    v_lshrrev_b32 v41, 4, v1
    v_and_b32 v42, 3, v1
    v_lshl_add_u32 v43, v41, 3, v40
    v_lshlrev_b32 v46, 6, v43
    v_and_b32 v47, 1, v41
    v_lshlrev_b32 v47, 1, v47
    v_lshrrev_b32 v48, 1, v42
    v_xor_b32 v47, v47, v48
    v_lshl_add_u32 v46, v47, 4, v46
    v_and_b32 v48, 1, v42
    v_lshl_add_u32 v46, v48, 3, v46
    v_add_u32 v44, s34, v46
    v_xor_b32 v45, 32, v44
    v_add_u32 v49, 43008, v46
    v_xor_b32 v50, 32, v49
    v_add_u32 v47, 1, v43
    v_bfe_u32 v48, v47, 3, 1
    v_lshlrev_b32 v48, 1, v48
    v_lshrrev_b32 v55, 1, v42
    v_xor_b32 v48, v48, v55
    v_lshlrev_b32 v47, 6, v47
    v_lshl_add_u32 v47, v48, 4, v47
    v_and_b32 v48, 1, v42
    v_lshl_add_u32 v47, v48, 3, v47
    v_add_u32 v51, 32704, v47
    v_xor_b32 v52, 32, v51
    v_add_u32 v47, 5, v43
    v_bfe_u32 v48, v47, 3, 1
    v_lshlrev_b32 v48, 1, v48
    v_lshrrev_b32 v55, 1, v42
    v_xor_b32 v48, v48, v55
    v_lshlrev_b32 v47, 6, v47
    v_lshl_add_u32 v47, v48, 4, v47
    v_and_b32 v48, 1, v42
    v_lshl_add_u32 v47, v48, 3, v47
    v_add_u32 v53, 32704, v47
    v_xor_b32 v54, 32, v53
    v_and_b32 v47, 1, v1
    v_mul_u32_u24 v55, 10304, v47
    v_bfe_u32 v48, v1, 1, 3
    v_lshl_add_u32 v55, v48, 6, v55
    v_lshl_add_u32 v55, v41, 4, v55
    s_mul_i32 s35, s20, 3072
    s_add_u32 s35, s35, 31680
    v_add_u32 v56, s35, v55
    v_xor_b32 v57, 32, v56
    s_mul_i32 s35, s20, 48
    s_sub_u32 s35, s35, 17
    v_add_u32 v122, v48, v47
    v_add_u32 v122, s35, v122
    s_mov_b32 s35, 344064
    v_mul_lo_u32 v58, v48, s35
    v_and_b32 v47, 1, v1
    v_lshl_add_u32 v58, v47, 6, v58
    v_lshl_add_u32 v58, v41, 4, v58
    s_mov_b32 s36, 0xbdd2d3e8
    v_mov_b32 v59, 0xc0135761
    s_mov_b32 s42, 0xbdd2d3e8
    s_mov_b32 s43, 0xbdd2d3e8
    v_mov_b32 v120, 0xc0135761
    v_mov_b32 v121, 0xc0135761
    s_add_u32 s16, s4, 51269632
    s_addc_u32 s17, s5, 0
    s_mov_b32 s18, 11010048
    s_mov_b32 s19, 0x00020000
    s_mul_i32 s37, s20, 2752512
    s_mul_i32 s38, s24, 84
    s_mul_i32 s39, s26, 3
    s_add_u32 s38, s38, s39
    s_lshl_b32 s38, s38, 11
    s_add_u32 s37, s37, s38
    s_lshl_b32 s38, s27, 7
    s_add_u32 s37, s37, s38
    s_waitcnt vmcnt(2)
    s_mov_b32 s44, 2
L_mid_kernel_bb:
    ds_read_b64_tr_b16 v[60:61], v44 offset:0
    ds_read_b64_tr_b16 v[62:63], v44 offset:256
    ds_read_b64_tr_b16 v[64:65], v44 offset:2048
    ds_read_b64_tr_b16 v[66:67], v44 offset:2304
    ds_read_b64_tr_b16 v[68:69], v45 offset:0
    ds_read_b64_tr_b16 v[70:71], v45 offset:256
    ds_read_b64_tr_b16 v[72:73], v45 offset:2048
    ds_read_b64_tr_b16 v[74:75], v45 offset:2304
    s_cmp_eq_u32 s28, 166
    s_cselect_b32 s39, 0, -1
    s_waitcnt lgkmcnt(0)
    v_mfma_f32_16x16x32_bf16 v[76:79], v[60:63], v[8:11], 0
    v_mfma_f32_16x16x32_bf16 v[80:83], v[68:71], v[8:11], 0
    v_mfma_f32_16x16x32_bf16 v[84:87], v[60:63], v[16:19], 0
    v_mfma_f32_16x16x32_bf16 v[88:91], v[68:71], v[16:19], 0
    v_mfma_f32_16x16x32_bf16 v[92:95], v[60:63], v[24:27], 0
    v_mfma_f32_16x16x32_bf16 v[96:99], v[68:71], v[24:27], 0
    v_mfma_f32_16x16x32_bf16 v[76:79], v[64:67], v[12:15], v[76:79]
    v_mfma_f32_16x16x32_bf16 v[80:83], v[72:75], v[12:15], v[80:83]
    v_mfma_f32_16x16x32_bf16 v[84:87], v[64:67], v[20:23], v[84:87]
    v_mfma_f32_16x16x32_bf16 v[88:91], v[72:75], v[20:23], v[88:91]
    v_mfma_f32_16x16x32_bf16 v[92:95], v[64:67], v[28:31], v[92:95]
    v_mfma_f32_16x16x32_bf16 v[96:99], v[72:75], v[28:31], v[96:99]
    v_add_u32 v44, 4096, v44
    v_add_u32 v45, 4096, v45
    s_add_u32 s28, s28, 1
    s_nop 4
    v_mul_f32 v100, v76, v76
    v_mul_f32 v101, v77, v77
    v_mul_f32 v102, v78, v78
    v_mul_f32 v103, v79, v79
    v_mul_f32 v104, v80, v80
    v_mul_f32 v105, v81, v81
    v_mul_f32 v106, v82, v82
    v_mul_f32 v107, v83, v83
    v_fma_f32 v100, v100, s36, v59
    v_fma_f32 v101, v101, s36, v59
    v_fma_f32 v102, v102, s36, v59
    v_fma_f32 v103, v103, s36, v59
    v_fma_f32 v104, v104, s36, v59
    v_fma_f32 v105, v105, s36, v59
    v_fma_f32 v106, v106, s36, v59
    v_fma_f32 v107, v107, s36, v59
    v_mul_f32 v100, v100, v76
    v_mul_f32 v101, v101, v77
    v_mul_f32 v102, v102, v78
    v_mul_f32 v103, v103, v79
    v_mul_f32 v104, v104, v80
    v_mul_f32 v105, v105, v81
    v_mul_f32 v106, v106, v82
    v_mul_f32 v107, v107, v83
    v_exp_f32 v100, v100
    v_exp_f32 v101, v101
    v_exp_f32 v102, v102
    v_exp_f32 v103, v103
    v_exp_f32 v104, v104
    v_exp_f32 v105, v105
    v_exp_f32 v106, v106
    v_exp_f32 v107, v107
    v_add_f32 v100, 1.0, v100
    v_add_f32 v101, 1.0, v101
    v_add_f32 v102, 1.0, v102
    v_add_f32 v103, 1.0, v103
    v_add_f32 v104, 1.0, v104
    v_add_f32 v105, 1.0, v105
    v_add_f32 v106, 1.0, v106
    v_add_f32 v107, 1.0, v107
    v_rcp_f32 v100, v100
    v_rcp_f32 v101, v101
    v_rcp_f32 v102, v102
    v_rcp_f32 v103, v103
    v_rcp_f32 v104, v104
    v_rcp_f32 v105, v105
    v_rcp_f32 v106, v106
    v_rcp_f32 v107, v107
    v_mul_f32 v76, v76, v100
    v_mul_f32 v77, v77, v101
    v_mul_f32 v78, v78, v102
    v_mul_f32 v79, v79, v103
    v_mul_f32 v80, v80, v104
    v_mul_f32 v81, v81, v105
    v_mul_f32 v82, v82, v106
    v_mul_f32 v83, v83, v107
    v_cvt_pk_bf16_f32 v108, v76, v77
    v_cvt_pk_bf16_f32 v109, v78, v79
    v_cvt_pk_bf16_f32 v110, v80, v81
    v_cvt_pk_bf16_f32 v111, v82, v83
    v_add_u32 v123, 0, v122
    v_cmp_gt_u32 vcc, 160, v123
    s_nop 0
    s_and_saveexec_b64 s[40:41], vcc
    ds_write_b128 v56, v[108:111] offset:0
    s_mov_b64 exec, s[40:41]
    v_mul_f32 v100, v84, v84
    v_mul_f32 v101, v85, v85
    v_mul_f32 v102, v86, v86
    v_mul_f32 v103, v87, v87
    v_mul_f32 v104, v88, v88
    v_mul_f32 v105, v89, v89
    v_mul_f32 v106, v90, v90
    v_mul_f32 v107, v91, v91
    v_fma_f32 v100, v100, s36, v59
    v_fma_f32 v101, v101, s36, v59
    v_fma_f32 v102, v102, s36, v59
    v_fma_f32 v103, v103, s36, v59
    v_fma_f32 v104, v104, s36, v59
    v_fma_f32 v105, v105, s36, v59
    v_fma_f32 v106, v106, s36, v59
    v_fma_f32 v107, v107, s36, v59
    v_mul_f32 v100, v100, v84
    v_mul_f32 v101, v101, v85
    v_mul_f32 v102, v102, v86
    v_mul_f32 v103, v103, v87
    v_mul_f32 v104, v104, v88
    v_mul_f32 v105, v105, v89
    v_mul_f32 v106, v106, v90
    v_mul_f32 v107, v107, v91
    v_exp_f32 v100, v100
    v_exp_f32 v101, v101
    v_exp_f32 v102, v102
    v_exp_f32 v103, v103
    v_exp_f32 v104, v104
    v_exp_f32 v105, v105
    v_exp_f32 v106, v106
    v_exp_f32 v107, v107
    v_add_f32 v100, 1.0, v100
    v_add_f32 v101, 1.0, v101
    v_add_f32 v102, 1.0, v102
    v_add_f32 v103, 1.0, v103
    v_add_f32 v104, 1.0, v104
    v_add_f32 v105, 1.0, v105
    v_add_f32 v106, 1.0, v106
    v_add_f32 v107, 1.0, v107
    v_rcp_f32 v100, v100
    v_rcp_f32 v101, v101
    v_rcp_f32 v102, v102
    v_rcp_f32 v103, v103
    v_rcp_f32 v104, v104
    v_rcp_f32 v105, v105
    v_rcp_f32 v106, v106
    v_rcp_f32 v107, v107
    v_mul_f32 v84, v84, v100
    v_mul_f32 v85, v85, v101
    v_mul_f32 v86, v86, v102
    v_mul_f32 v87, v87, v103
    v_mul_f32 v88, v88, v104
    v_mul_f32 v89, v89, v105
    v_mul_f32 v90, v90, v106
    v_mul_f32 v91, v91, v107
    v_cvt_pk_bf16_f32 v112, v84, v85
    v_cvt_pk_bf16_f32 v113, v86, v87
    v_cvt_pk_bf16_f32 v114, v88, v89
    v_cvt_pk_bf16_f32 v115, v90, v91
    v_add_u32 v123, 8, v122
    v_cmp_gt_u32 vcc, 160, v123
    s_nop 0
    s_and_saveexec_b64 s[40:41], vcc
    ds_write_b128 v57, v[112:115] offset:512
    s_mov_b64 exec, s[40:41]
    v_mul_f32 v100, v92, v92
    v_mul_f32 v101, v93, v93
    v_mul_f32 v102, v94, v94
    v_mul_f32 v103, v95, v95
    v_mul_f32 v104, v96, v96
    v_mul_f32 v105, v97, v97
    v_mul_f32 v106, v98, v98
    v_mul_f32 v107, v99, v99
    v_fma_f32 v100, v100, s36, v59
    v_fma_f32 v101, v101, s36, v59
    v_fma_f32 v102, v102, s36, v59
    v_fma_f32 v103, v103, s36, v59
    v_fma_f32 v104, v104, s36, v59
    v_fma_f32 v105, v105, s36, v59
    v_fma_f32 v106, v106, s36, v59
    v_fma_f32 v107, v107, s36, v59
    v_mul_f32 v100, v100, v92
    v_mul_f32 v101, v101, v93
    v_mul_f32 v102, v102, v94
    v_mul_f32 v103, v103, v95
    v_mul_f32 v104, v104, v96
    v_mul_f32 v105, v105, v97
    v_mul_f32 v106, v106, v98
    v_mul_f32 v107, v107, v99
    v_exp_f32 v100, v100
    v_exp_f32 v101, v101
    v_exp_f32 v102, v102
    v_exp_f32 v103, v103
    v_exp_f32 v104, v104
    v_exp_f32 v105, v105
    v_exp_f32 v106, v106
    v_exp_f32 v107, v107
    v_add_f32 v100, 1.0, v100
    v_add_f32 v101, 1.0, v101
    v_add_f32 v102, 1.0, v102
    v_add_f32 v103, 1.0, v103
    v_add_f32 v104, 1.0, v104
    v_add_f32 v105, 1.0, v105
    v_add_f32 v106, 1.0, v106
    v_add_f32 v107, 1.0, v107
    v_rcp_f32 v100, v100
    v_rcp_f32 v101, v101
    v_rcp_f32 v102, v102
    v_rcp_f32 v103, v103
    v_rcp_f32 v104, v104
    v_rcp_f32 v105, v105
    v_rcp_f32 v106, v106
    v_rcp_f32 v107, v107
    v_mul_f32 v92, v92, v100
    v_mul_f32 v93, v93, v101
    v_mul_f32 v94, v94, v102
    v_mul_f32 v95, v95, v103
    v_mul_f32 v96, v96, v104
    v_mul_f32 v97, v97, v105
    v_mul_f32 v98, v98, v106
    v_mul_f32 v99, v99, v107
    v_cvt_pk_bf16_f32 v116, v92, v93
    v_cvt_pk_bf16_f32 v117, v94, v95
    v_cvt_pk_bf16_f32 v118, v96, v97
    v_cvt_pk_bf16_f32 v119, v98, v99
    v_and_b32 v116, s39, v116
    v_and_b32 v117, s39, v117
    v_and_b32 v118, s39, v118
    v_and_b32 v119, s39, v119
    v_add_u32 v123, 16, v122
    v_cmp_gt_u32 vcc, 160, v123
    s_nop 0
    s_and_saveexec_b64 s[40:41], vcc
    ds_write_b128 v56, v[116:119] offset:1024
    s_mov_b64 exec, s[40:41]
    v_xor_b32 v56, 32, v56
    v_add_u32 v56, 1536, v56
    v_xor_b32 v57, 32, v57
    v_add_u32 v57, 1536, v57
    v_add_u32 v122, 24, v122
    s_sub_u32 s44, s44, 1
    s_cmp_lg_u32 s44, 0
    s_cbranch_scc1 L_mid_kernel_bb
    s_waitcnt vmcnt(0)
    s_waitcnt lgkmcnt(0)
    s_barrier
    ds_read_b64_tr_b16 v[60:61], v49 offset:0
    ds_read_b64_tr_b16 v[62:63], v49 offset:256
    ds_read_b64_tr_b16 v[64:65], v49 offset:2048
    ds_read_b64_tr_b16 v[66:67], v49 offset:2304
    ds_read_b64_tr_b16 v[68:69], v50 offset:0
    ds_read_b64_tr_b16 v[70:71], v50 offset:256
    ds_read_b64_tr_b16 v[72:73], v50 offset:2048
    ds_read_b64_tr_b16 v[74:75], v50 offset:2304
    s_waitcnt lgkmcnt(0)
    v_mfma_f32_16x16x32_bf16 v[92:95], v[60:63], v[32:35], 0
    v_mfma_f32_16x16x32_bf16 v[96:99], v[68:71], v[32:35], 0
    v_mfma_f32_16x16x32_bf16 v[92:95], v[64:67], v[36:39], v[92:95]
    v_mfma_f32_16x16x32_bf16 v[96:99], v[72:75], v[36:39], v[96:99]
    ds_read_b64_tr_b16 v[76:77], v51 offset:0
    ds_read_b64_tr_b16 v[78:79], v53 offset:0
    ds_read_b64_tr_b16 v[80:81], v51 offset:2048
    ds_read_b64_tr_b16 v[82:83], v53 offset:2048
    ds_read_b64_tr_b16 v[84:85], v52 offset:0
    ds_read_b64_tr_b16 v[86:87], v54 offset:0
    ds_read_b64_tr_b16 v[88:89], v52 offset:2048
    ds_read_b64_tr_b16 v[90:91], v54 offset:2048
    v_cvt_pk_bf16_f32 v108, v92, v93
    v_cvt_pk_bf16_f32 v109, v94, v95
    v_cvt_pk_bf16_f32 v110, v96, v97
    v_cvt_pk_bf16_f32 v111, v98, v99
    s_add_u32 s38, s37, 0
    buffer_store_dwordx4 v[108:111], v58, s[16:19], s38 offen sc1
    s_waitcnt lgkmcnt(0)
    v_mfma_f32_16x16x32_bf16 v[100:103], v[76:79], v[32:35], 0
    v_mfma_f32_16x16x32_bf16 v[104:107], v[84:87], v[32:35], 0
    v_mfma_f32_16x16x32_bf16 v[100:103], v[80:83], v[36:39], v[100:103]
    v_mfma_f32_16x16x32_bf16 v[104:107], v[88:91], v[36:39], v[104:107]
    ds_read_b64_tr_b16 v[60:61], v49 offset:3072
    ds_read_b64_tr_b16 v[62:63], v49 offset:3328
    ds_read_b64_tr_b16 v[64:65], v49 offset:5120
    ds_read_b64_tr_b16 v[66:67], v49 offset:5376
    ds_read_b64_tr_b16 v[68:69], v50 offset:3072
    ds_read_b64_tr_b16 v[70:71], v50 offset:3328
    ds_read_b64_tr_b16 v[72:73], v50 offset:5120
    ds_read_b64_tr_b16 v[74:75], v50 offset:5376
    v_cvt_pk_bf16_f32 v112, v100, v101
    v_cvt_pk_bf16_f32 v113, v102, v103
    v_cvt_pk_bf16_f32 v114, v104, v105
    v_cvt_pk_bf16_f32 v115, v106, v107
    s_add_u32 s38, s37, 1024
    buffer_store_dwordx4 v[112:115], v58, s[16:19], s38 offen sc1
    s_waitcnt lgkmcnt(0)
    v_mfma_f32_16x16x32_bf16 v[92:95], v[60:63], v[32:35], 0
    v_mfma_f32_16x16x32_bf16 v[96:99], v[68:71], v[32:35], 0
    v_mfma_f32_16x16x32_bf16 v[92:95], v[64:67], v[36:39], v[92:95]
    v_mfma_f32_16x16x32_bf16 v[96:99], v[72:75], v[36:39], v[96:99]
    ds_read_b64_tr_b16 v[76:77], v51 offset:3072
    ds_read_b64_tr_b16 v[78:79], v53 offset:3072
    ds_read_b64_tr_b16 v[80:81], v51 offset:5120
    ds_read_b64_tr_b16 v[82:83], v53 offset:5120
    ds_read_b64_tr_b16 v[84:85], v52 offset:3072
    ds_read_b64_tr_b16 v[86:87], v54 offset:3072
    ds_read_b64_tr_b16 v[88:89], v52 offset:5120
    ds_read_b64_tr_b16 v[90:91], v54 offset:5120
    v_cvt_pk_bf16_f32 v108, v92, v93
    v_cvt_pk_bf16_f32 v109, v94, v95
    v_cvt_pk_bf16_f32 v110, v96, v97
    v_cvt_pk_bf16_f32 v111, v98, v99
    s_add_u32 s38, s37, 2048
    buffer_store_dwordx4 v[108:111], v58, s[16:19], s38 offen sc1
    s_waitcnt lgkmcnt(0)
    v_mfma_f32_16x16x32_bf16 v[100:103], v[76:79], v[32:35], 0
    v_mfma_f32_16x16x32_bf16 v[104:107], v[84:87], v[32:35], 0
    v_mfma_f32_16x16x32_bf16 v[100:103], v[80:83], v[36:39], v[100:103]
    v_mfma_f32_16x16x32_bf16 v[104:107], v[88:91], v[36:39], v[104:107]
    ds_read_b64_tr_b16 v[60:61], v49 offset:6144
    ds_read_b64_tr_b16 v[62:63], v49 offset:6400
    ds_read_b64_tr_b16 v[64:65], v49 offset:8192
    ds_read_b64_tr_b16 v[66:67], v49 offset:8448
    ds_read_b64_tr_b16 v[68:69], v50 offset:6144
    ds_read_b64_tr_b16 v[70:71], v50 offset:6400
    ds_read_b64_tr_b16 v[72:73], v50 offset:8192
    ds_read_b64_tr_b16 v[74:75], v50 offset:8448
    v_cvt_pk_bf16_f32 v112, v100, v101
    v_cvt_pk_bf16_f32 v113, v102, v103
    v_cvt_pk_bf16_f32 v114, v104, v105
    v_cvt_pk_bf16_f32 v115, v106, v107
    s_add_u32 s38, s37, 3072
    buffer_store_dwordx4 v[112:115], v58, s[16:19], s38 offen sc1
    s_waitcnt lgkmcnt(0)
    v_mfma_f32_16x16x32_bf16 v[92:95], v[60:63], v[32:35], 0
    v_mfma_f32_16x16x32_bf16 v[96:99], v[68:71], v[32:35], 0
    v_mfma_f32_16x16x32_bf16 v[92:95], v[64:67], v[36:39], v[92:95]
    v_mfma_f32_16x16x32_bf16 v[96:99], v[72:75], v[36:39], v[96:99]
    ds_read_b64_tr_b16 v[76:77], v51 offset:6144
    ds_read_b64_tr_b16 v[78:79], v53 offset:6144
    ds_read_b64_tr_b16 v[80:81], v51 offset:8192
    ds_read_b64_tr_b16 v[82:83], v53 offset:8192
    ds_read_b64_tr_b16 v[84:85], v52 offset:6144
    ds_read_b64_tr_b16 v[86:87], v54 offset:6144
    ds_read_b64_tr_b16 v[88:89], v52 offset:8192
    ds_read_b64_tr_b16 v[90:91], v54 offset:8192
    v_cvt_pk_bf16_f32 v108, v92, v93
    v_cvt_pk_bf16_f32 v109, v94, v95
    v_cvt_pk_bf16_f32 v110, v96, v97
    v_cvt_pk_bf16_f32 v111, v98, v99
    s_add_u32 s38, s37, 4096
    buffer_store_dwordx4 v[108:111], v58, s[16:19], s38 offen sc1
    s_waitcnt lgkmcnt(0)
    v_mfma_f32_16x16x32_bf16 v[100:103], v[76:79], v[32:35], 0
    v_mfma_f32_16x16x32_bf16 v[104:107], v[84:87], v[32:35], 0
    v_mfma_f32_16x16x32_bf16 v[100:103], v[80:83], v[36:39], v[100:103]
    v_mfma_f32_16x16x32_bf16 v[104:107], v[88:91], v[36:39], v[104:107]
    s_nop 7
    v_cvt_pk_bf16_f32 v112, v100, v101
    v_cvt_pk_bf16_f32 v113, v102, v103
    v_cvt_pk_bf16_f32 v114, v104, v105
    v_cvt_pk_bf16_f32 v115, v106, v107
    s_add_u32 s38, s37, 5120
    buffer_store_dwordx4 v[112:115], v58, s[16:19], s38 offen sc1
    s_endpgm
L_mid_kernel_g:
    s_sub_u32 s3, s2, 448
    s_load_dwordx2 s[4:5], s[0:1], 16
    s_load_dwordx2 s[6:7], s[0:1], 72
    s_lshr_b32 s24, s3, 4
    s_bfe_u32 s25, s3, 0x20002
    s_and_b32 s26, s3, 3
    s_lshr_b32 s27, s24, 3
    s_and_b32 s28, s24, 7
    v_and_b32 v1, 63, v0
    v_lshrrev_b32 v2, 3, v1
    v_mov_b32 v3, v2
    s_lshl_b32 s29, s25, 3
    s_lshl_b32 s30, s28, 5
    s_add_u32 s29, s29, s30
    v_add_u32 v3, s29, v3
    v_lshlrev_b32 v3, 9, v3
    v_and_b32 v4, 7, v1
    s_lshr_b32 s30, s20, 1
    s_lshl_b32 s30, s30, 2
    v_xor_b32 v4, s30, v4
    v_lshl_add_u32 v3, v4, 4, v3
    s_lshl_b32 s30, s26, 7
    v_add_u32 v3, s30, v3
    v_xor_b32 v4, 32, v3
    s_waitcnt lgkmcnt(0)
    s_mov_b32 s8, s4
    s_mov_b32 s9, s5
    s_mov_b32 s10, 4063232
    s_mov_b32 s11, 0x00020000
    s_add_u32 s12, s6, 62345216
    s_addc_u32 s13, s7, 0
    s_mov_b32 s14, 16916480
    s_mov_b32 s15, 0x00020000
    s_lshl_b32 s30, s20, 3
    s_add_u32 s30, s30, s27
    s_lshl_b32 s30, s30, 17
    s_mul_i32 s31, s20, 4608
    s_add_u32 m0, s31, 0
    s_add_u32 s32, s30, 0
    buffer_load_dwordx4 v3, s[8:11], s32 offen nt lds
    s_add_u32 m0, s31, 1152
    s_add_u32 s32, s30, 262144
    buffer_load_dwordx4 v3, s[8:11], s32 offen nt lds
    s_add_u32 m0, s31, 2304
    s_add_u32 s32, s30, 524288
    buffer_load_dwordx4 v4, s[8:11], s32 offen nt lds
    s_add_u32 m0, s31, 3456
    s_add_u32 s32, s30, 786432
    buffer_load_dwordx4 v4, s[8:11], s32 offen nt lds
    v_and_b32 v8, 15, v1
    v_or_b32 v9, 1, v8
    s_lshl_b32 s33, s20, 4
    v_add_u32 v9, s33, v9
    v_cvt_f32_u32 v9, v9
    v_mul_f32 v9, 0x3c000000, v9
    v_bfe_u32 v10, v1, 4, 1
    v_lshlrev_b32 v10, 3, v10
    v_cvt_f32_u32 v10, v10
    v_and_b32 v8, 1, v8
    v_cvt_f32_u32 v8, v8
    v_mul_f32 v8, 0x3f400000, v8
    v_fma_f32 v11, v9, v10, v8
    v_fract_f32 v12, v11
    v_add_f32 v11, v11, v9
    v_fract_f32 v13, v11
    v_add_f32 v11, v11, v9
    v_fract_f32 v14, v11
    v_add_f32 v11, v11, v9
    v_fract_f32 v15, v11
    v_add_f32 v11, v11, v9
    v_fract_f32 v16, v11
    v_add_f32 v11, v11, v9
    v_fract_f32 v17, v11
    v_add_f32 v11, v11, v9
    v_fract_f32 v18, v11
    v_add_f32 v11, v11, v9
    v_fract_f32 v19, v11
    v_cos_f32 v12, v12
    v_cos_f32 v13, v13
    v_cos_f32 v14, v14
    v_cos_f32 v15, v15
    v_cos_f32 v16, v16
    v_cos_f32 v17, v17
    v_cos_f32 v18, v18
    v_cos_f32 v19, v19
    s_nop 0
    v_mul_f32 v12, 0x3d000000, v12
    v_mul_f32 v13, 0x3d000000, v13
    v_mul_f32 v14, 0x3d000000, v14
    v_mul_f32 v15, 0x3d000000, v15
    v_mul_f32 v16, 0x3d000000, v16
    v_mul_f32 v17, 0x3d000000, v17
    v_mul_f32 v18, 0x3d000000, v18
    v_mul_f32 v19, 0x3d000000, v19
    v_cvt_pk_bf16_f32 v20, v12, v13
    v_cvt_pk_bf16_f32 v21, v14, v15
    v_cvt_pk_bf16_f32 v22, v16, v17
    v_cvt_pk_bf16_f32 v23, v18, v19
    v_lshlrev_b32 v28, 16, v20
    v_and_b32 v29, 0xffff0000, v20
    v_sub_f32 v28, v12, v28
    v_sub_f32 v29, v13, v29
    v_cvt_pk_bf16_f32 v24, v28, v29
    v_lshlrev_b32 v28, 16, v21
    v_and_b32 v29, 0xffff0000, v21
    v_sub_f32 v28, v14, v28
    v_sub_f32 v29, v15, v29
    v_cvt_pk_bf16_f32 v25, v28, v29
    v_lshlrev_b32 v28, 16, v22
    v_and_b32 v29, 0xffff0000, v22
    v_sub_f32 v28, v16, v28
    v_sub_f32 v29, v17, v29
    v_cvt_pk_bf16_f32 v26, v28, v29
    v_lshlrev_b32 v28, 16, v23
    v_and_b32 v29, 0xffff0000, v23
    v_sub_f32 v28, v18, v28
    v_sub_f32 v29, v19, v29
    v_cvt_pk_bf16_f32 v27, v28, v29
    v_cmp_gt_u32 vcc, 32, v1
    s_nop 1
    v_cndmask_b32 v20, v24, v20, vcc
    v_cndmask_b32 v21, v25, v21, vcc
    v_cndmask_b32 v22, v26, v22, vcc
    v_cndmask_b32 v23, v27, v23, vcc
    v_lshlrev_b32 v28, 4, v1
    s_lshl_b32 s33, s20, 10
    v_add_u32 v29, s33, v28
    ds_write_b128 v29, v[20:23] offset:18432
    v_bfe_u32 v30, v1, 2, 2
    v_bfe_u32 v31, v1, 4, 1
    v_lshl_add_u32 v32, v31, 3, v30
    v_mul_u32_u24 v32, 1152, v32
    v_lshrrev_b32 v30, 1, v30
    v_lshl_add_u32 v30, v31, 1, v30
    v_lshlrev_b32 v30, 1, v30
    v_bfe_u32 v31, v1, 1, 1
    s_lshl_b32 s33, s20, 1
    v_add_u32 v31, s33, v31
    v_xor_b32 v30, v30, v31
    v_lshl_add_u32 v32, v30, 4, v32
    v_and_b32 v30, 1, v1
    v_lshl_add_u32 v32, v30, 3, v32
    v_lshrrev_b32 v30, 4, v1
    s_mov_b32 s33, 1057280
    v_mul_lo_u32 v30, v30, s33
    v_and_b32 v31, 15, v1
    v_lshl_add_u32 v33, v31, 4, v30
    s_lshl_b32 s34, s24, 15
    s_lshl_b32 s35, s26, 2
    s_add_u32 s35, s35, s20
    s_lshl_b32 s35, s35, 11
    s_add_u32 s34, s34, s35
    s_lshl_b32 s35, s25, 8
    s_add_u32 s34, s34, s35
    s_waitcnt vmcnt(0) lgkmcnt(0)
    s_barrier
    ds_read_b128 v[36:39], v28 offset:18432
    ds_read_b64_tr_b16 v[52:53], v32 offset:0
    ds_read_b64_tr_b16 v[54:55], v32 offset:4608
    ds_read_b64_tr_b16 v[56:57], v32 offset:128
    ds_read_b64_tr_b16 v[58:59], v32 offset:4736
    ds_read_b64_tr_b16 v[60:61], v32 offset:256
    ds_read_b64_tr_b16 v[62:63], v32 offset:4864
    ds_read_b64_tr_b16 v[64:65], v32 offset:384
    ds_read_b64_tr_b16 v[66:67], v32 offset:4992
    ds_read_b64_tr_b16 v[68:69], v32 offset:512
    ds_read_b64_tr_b16 v[70:71], v32 offset:5120
    ds_read_b64_tr_b16 v[72:73], v32 offset:640
    ds_read_b64_tr_b16 v[74:75], v32 offset:5248
    s_waitcnt lgkmcnt(8)
    ds_read_b64_tr_b16 v[76:77], v32 offset:768
    ds_read_b64_tr_b16 v[78:79], v32 offset:5376
    ds_read_b64_tr_b16 v[80:81], v32 offset:896
    ds_read_b64_tr_b16 v[82:83], v32 offset:5504
    s_mov_b32 s36, 4
L_mid_kernel_git2:
    s_waitcnt lgkmcnt(0)
    v_mfma_f32_16x16x32_bf16 v[84:87], v[36:39], v[52:55], 0
    v_mfma_f32_16x16x32_bf16 v[88:91], v[36:39], v[56:59], 0
    v_mfma_f32_16x16x32_bf16 v[92:95], v[36:39], v[60:63], 0
    v_mfma_f32_16x16x32_bf16 v[96:99], v[36:39], v[64:67], 0
    v_mfma_f32_16x16x32_bf16 v[100:103], v[36:39], v[68:71], 0
    v_mfma_f32_16x16x32_bf16 v[104:107], v[36:39], v[72:75], 0
    v_mfma_f32_16x16x32_bf16 v[108:111], v[36:39], v[76:79], 0
    v_mfma_f32_16x16x32_bf16 v[112:115], v[36:39], v[80:83], 0
    v_add_u32 v28, 1024, v28
    ds_read_b128 v[36:39], v28 offset:18432
    s_nop 7
    v_cvt_pk_bf16_f32 v116, v84, v88
    v_cvt_pk_bf16_f32 v117, v92, v96
    v_cvt_pk_bf16_f32 v118, v100, v104
    v_cvt_pk_bf16_f32 v119, v108, v112
    s_add_u32 s35, s34, 0
    buffer_store_dwordx4 v[116:119], v33, s[12:15], s35 offen sc1
    s_nop 1
    v_cvt_pk_bf16_f32 v120, v85, v89
    v_cvt_pk_bf16_f32 v121, v93, v97
    v_cvt_pk_bf16_f32 v122, v101, v105
    v_cvt_pk_bf16_f32 v123, v109, v113
    s_add_u32 s35, s34, 1024
    buffer_store_dwordx4 v[120:123], v33, s[12:15], s35 offen sc1
    s_nop 1
    v_cvt_pk_bf16_f32 v116, v86, v90
    v_cvt_pk_bf16_f32 v117, v94, v98
    v_cvt_pk_bf16_f32 v118, v102, v106
    v_cvt_pk_bf16_f32 v119, v110, v114
    s_add_u32 s35, s34, 528640
    buffer_store_dwordx4 v[116:119], v33, s[12:15], s35 offen sc1
    s_nop 1
    v_cvt_pk_bf16_f32 v120, v87, v91
    v_cvt_pk_bf16_f32 v121, v95, v99
    v_cvt_pk_bf16_f32 v122, v103, v107
    v_cvt_pk_bf16_f32 v123, v111, v115
    s_add_u32 s35, s34, 529664
    buffer_store_dwordx4 v[120:123], v33, s[12:15], s35 offen sc1
    s_nop 1
    s_add_u32 s34, s34, 4229120
    s_sub_u32 s36, s36, 1
    s_cmp_lg_u32 s36, 0
    s_cbranch_scc1 L_mid_kernel_git2
    s_endpgm
L_mid_kernel_done:
    s_endpgm
.globl gemm2_kernel
.p2align 8
.type gemm2_kernel,@function
gemm2_kernel:
    s_cmp_ge_u32 s2, 256
    s_cbranch_scc1 L_gemm2_kernel_done
    s_load_dwordx2 s[4:5], s[0:1], 72
    s_load_dwordx2 s[6:7], s[0:1], 72
    v_readfirstlane_b32 s20, v0
    s_lshr_b32 s20, s20, 6
    s_and_b32 s24, s2, 7
    s_lshr_b32 s25, s2, 3
    s_lshr_b32 s26, s25, 3
    s_lshl_b32 s24, s24, 2
    s_add_u32 s21, s24, s26
    s_and_b32 s25, s25, 7
    s_lshr_b32 s26, s25, 2
    s_and_b32 s27, s25, 3
    s_mul_i32 s22, s26, 84
    s_sub_u32 s28, 168, s22
    s_min_u32 s28, s28, 84
    s_waitcnt lgkmcnt(0)
    s_mul_i32 s29, s21, 344064
    s_lshl_b32 s30, s22, 11
    s_add_u32 s29, s29, s30
    s_add_u32 s29, s29, 51269632
    s_add_u32 s8, s6, s29
    s_addc_u32 s9, s7, 0
    s_lshl_b32 s10, s28, 11
    s_mov_b32 s11, 0x00020000
    s_mul_i32 s29, s21, 528640
    s_mul_i32 s30, s27, 8192
    s_add_u32 s29, s29, s30
    s_add_u32 s29, s29, 62345216
    s_add_u32 s12, s4, s29
    s_addc_u32 s13, s5, 0
    s_mov_b32 s14, 499712
    s_mov_b32 s15, 0x00020000
    s_cmp_lt_u32 s20, 4
    s_cbranch_scc1 L_gemm2_kernel_consumer
    s_sub_u32 s20, s20, 4
    v_and_b32 v1, 63, v0
    v_lshrrev_b32 v4, 3, v1
    v_and_b32 v5, 7, v1
    v_xor_b32 v5, v5, v4
    v_lshlrev_b32 v5, 4, v5
    v_lshl_add_u32 v2, v4, 11, v5
    v_lshlrev_b32 v3, 4, v1
    s_add_u32 s24, s20, 0
    s_lshl_b32 s40, s24, 10
    s_lshl_b32 s43, s24, 14
    s_add_u32 s24, s20, 4
    s_lshl_b32 s41, s24, 10
    s_lshl_b32 s44, s24, 14
    s_add_u32 s24, s20, 8
    s_lshl_b32 s42, s24, 10
    s_lshl_b32 s45, s24, 14
    s_mul_i32 s46, s20, 2048
    s_add_u32 s47, s46, 12288
    s_add_u32 m0, s40, 0
    s_add_u32 s24, s43, 0
    buffer_load_dwordx4 v2, s[8:11], s24 offen lds
    s_add_u32 m0, s41, 0
    s_add_u32 s24, s44, 0
    buffer_load_dwordx4 v2, s[8:11], s24 offen lds
    s_add_u32 m0, s42, 0
    s_add_u32 s24, s45, 0
    buffer_load_dwordx4 v2, s[8:11], s24 offen lds
    s_add_u32 m0, s47, 0
    s_add_u32 s24, s46, 0
    buffer_load_dwordx4 v3, s[12:15], s24 offen offset:0 lds
    buffer_load_dwordx4 v3, s[12:15], s24 offen offset:1024 lds
    s_add_u32 m0, s40, 20480
    s_add_u32 s24, s43, 128
    buffer_load_dwordx4 v2, s[8:11], s24 offen lds
    s_add_u32 m0, s41, 20480
    s_add_u32 s24, s44, 128
    buffer_load_dwordx4 v2, s[8:11], s24 offen lds
    s_add_u32 m0, s42, 20480
    s_add_u32 s24, s45, 128
    buffer_load_dwordx4 v2, s[8:11], s24 offen lds
    s_add_u32 m0, s47, 20480
    s_add_u32 s24, s46, 32768
    buffer_load_dwordx4 v3, s[12:15], s24 offen offset:0 lds
    buffer_load_dwordx4 v3, s[12:15], s24 offen offset:1024 lds
    s_waitcnt vmcnt(5)
    s_barrier
    s_add_u32 m0, s40, 40960
    s_add_u32 s24, s43, 256
    buffer_load_dwordx4 v2, s[8:11], s24 offen lds
    s_add_u32 m0, s41, 40960
    s_add_u32 s24, s44, 256
    buffer_load_dwordx4 v2, s[8:11], s24 offen lds
    s_add_u32 m0, s42, 40960
    s_add_u32 s24, s45, 256
    buffer_load_dwordx4 v2, s[8:11], s24 offen lds
    s_add_u32 m0, s47, 40960
    s_add_u32 s24, s46, 65536
    buffer_load_dwordx4 v3, s[12:15], s24 offen offset:0 lds
    buffer_load_dwordx4 v3, s[12:15], s24 offen offset:1024 lds
    s_waitcnt vmcnt(5)
    s_barrier
    s_add_u32 m0, s40, 61440
    s_add_u32 s24, s43, 384
    buffer_load_dwordx4 v2, s[8:11], s24 offen lds
    s_add_u32 m0, s41, 61440
    s_add_u32 s24, s44, 384
    buffer_load_dwordx4 v2, s[8:11], s24 offen lds
    s_add_u32 m0, s42, 61440
    s_add_u32 s24, s45, 384
    buffer_load_dwordx4 v2, s[8:11], s24 offen lds
    s_add_u32 m0, s47, 61440
    s_add_u32 s24, s46, 98304
    buffer_load_dwordx4 v3, s[12:15], s24 offen offset:0 lds
    buffer_load_dwordx4 v3, s[12:15], s24 offen offset:1024 lds
    s_add_u32 m0, s40, 81920
    s_add_u32 s24, s43, 512
    buffer_load_dwordx4 v2, s[8:11], s24 offen lds
    s_add_u32 m0, s41, 81920
    s_add_u32 s24, s44, 512
    buffer_load_dwordx4 v2, s[8:11], s24 offen lds
    s_add_u32 m0, s42, 81920
    s_add_u32 s24, s45, 512
    buffer_load_dwordx4 v2, s[8:11], s24 offen lds
    s_add_u32 m0, s47, 81920
    s_add_u32 s24, s46, 131072
    buffer_load_dwordx4 v3, s[12:15], s24 offen offset:0 lds
    buffer_load_dwordx4 v3, s[12:15], s24 offen offset:1024 lds
    s_waitcnt vmcnt(10)
    s_barrier
    s_add_u32 m0, s40, 102400
    s_add_u32 s24, s43, 640
    buffer_load_dwordx4 v2, s[8:11], s24 offen lds
    s_add_u32 m0, s41, 102400
    s_add_u32 s24, s44, 640
    buffer_load_dwordx4 v2, s[8:11], s24 offen lds
    s_add_u32 m0, s42, 102400
    s_add_u32 s24, s45, 640
    buffer_load_dwordx4 v2, s[8:11], s24 offen lds
    s_add_u32 m0, s47, 102400
    s_add_u32 s24, s46, 163840
    buffer_load_dwordx4 v3, s[12:15], s24 offen offset:0 lds
    buffer_load_dwordx4 v3, s[12:15], s24 offen offset:1024 lds
    s_add_u32 m0, s40, 122880
    s_add_u32 s24, s43, 768
    buffer_load_dwordx4 v2, s[8:11], s24 offen lds
    s_add_u32 m0, s41, 122880
    s_add_u32 s24, s44, 768
    buffer_load_dwordx4 v2, s[8:11], s24 offen lds
    s_add_u32 m0, s42, 122880
    s_add_u32 s24, s45, 768
    buffer_load_dwordx4 v2, s[8:11], s24 offen lds
    s_add_u32 m0, s47, 122880
    s_add_u32 s24, s46, 196608
    buffer_load_dwordx4 v3, s[12:15], s24 offen offset:0 lds
    buffer_load_dwordx4 v3, s[12:15], s24 offen offset:1024 lds
    s_waitcnt vmcnt(15)
    s_barrier
    s_add_u32 m0, s40, 0
    s_add_u32 s24, s43, 896
    buffer_load_dwordx4 v2, s[8:11], s24 offen lds
    s_add_u32 m0, s41, 0
    s_add_u32 s24, s44, 896
    buffer_load_dwordx4 v2, s[8:11], s24 offen lds
    s_add_u32 m0, s42, 0
    s_add_u32 s24, s45, 896
    buffer_load_dwordx4 v2, s[8:11], s24 offen lds
    s_add_u32 m0, s47, 0
    s_add_u32 s24, s46, 229376
    buffer_load_dwordx4 v3, s[12:15], s24 offen offset:0 lds
    buffer_load_dwordx4 v3, s[12:15], s24 offen offset:1024 lds
    s_add_u32 m0, s40, 20480
    s_add_u32 s24, s43, 1024
    buffer_load_dwordx4 v2, s[8:11], s24 offen lds
    s_add_u32 m0, s41, 20480
    s_add_u32 s24, s44, 1024
    buffer_load_dwordx4 v2, s[8:11], s24 offen lds
    s_add_u32 m0, s42, 20480
    s_add_u32 s24, s45, 1024
    buffer_load_dwordx4 v2, s[8:11], s24 offen lds
    s_add_u32 m0, s47, 20480
    s_add_u32 s24, s46, 262144
    buffer_load_dwordx4 v3, s[12:15], s24 offen offset:0 lds
    buffer_load_dwordx4 v3, s[12:15], s24 offen offset:1024 lds
    s_waitcnt vmcnt(20)
    s_barrier
    s_add_u32 m0, s40, 40960
    s_add_u32 s24, s43, 1152
    buffer_load_dwordx4 v2, s[8:11], s24 offen lds
    s_add_u32 m0, s41, 40960
    s_add_u32 s24, s44, 1152
    buffer_load_dwordx4 v2, s[8:11], s24 offen lds
    s_add_u32 m0, s42, 40960
    s_add_u32 s24, s45, 1152
    buffer_load_dwordx4 v2, s[8:11], s24 offen lds
    s_add_u32 m0, s47, 40960
    s_add_u32 s24, s46, 294912
    buffer_load_dwordx4 v3, s[12:15], s24 offen offset:0 lds
    buffer_load_dwordx4 v3, s[12:15], s24 offen offset:1024 lds
    s_add_u32 m0, s40, 61440
    s_add_u32 s24, s43, 1280
    buffer_load_dwordx4 v2, s[8:11], s24 offen lds
    s_add_u32 m0, s41, 61440
    s_add_u32 s24, s44, 1280
    buffer_load_dwordx4 v2, s[8:11], s24 offen lds
    s_add_u32 m0, s42, 61440
    s_add_u32 s24, s45, 1280
    buffer_load_dwordx4 v2, s[8:11], s24 offen lds
    s_add_u32 m0, s47, 61440
    s_add_u32 s24, s46, 327680
    buffer_load_dwordx4 v3, s[12:15], s24 offen offset:0 lds
    buffer_load_dwordx4 v3, s[12:15], s24 offen offset:1024 lds
    s_waitcnt vmcnt(25)
    s_barrier
    s_add_u32 m0, s40, 81920
    s_add_u32 s24, s43, 1408
    buffer_load_dwordx4 v2, s[8:11], s24 offen lds
    s_add_u32 m0, s41, 81920
    s_add_u32 s24, s44, 1408
    buffer_load_dwordx4 v2, s[8:11], s24 offen lds
    s_add_u32 m0, s42, 81920
    s_add_u32 s24, s45, 1408
    buffer_load_dwordx4 v2, s[8:11], s24 offen lds
    s_add_u32 m0, s47, 81920
    s_add_u32 s24, s46, 360448
    buffer_load_dwordx4 v3, s[12:15], s24 offen offset:0 lds
    buffer_load_dwordx4 v3, s[12:15], s24 offen offset:1024 lds
    s_waitcnt vmcnt(25)
    s_barrier
    s_add_u32 m0, s40, 102400
    s_add_u32 s24, s43, 1536
    buffer_load_dwordx4 v2, s[8:11], s24 offen lds
    s_add_u32 m0, s41, 102400
    s_add_u32 s24, s44, 1536
    buffer_load_dwordx4 v2, s[8:11], s24 offen lds
    s_add_u32 m0, s42, 102400
    s_add_u32 s24, s45, 1536
    buffer_load_dwordx4 v2, s[8:11], s24 offen lds
    s_add_u32 m0, s47, 102400
    s_add_u32 s24, s46, 393216
    buffer_load_dwordx4 v3, s[12:15], s24 offen offset:0 lds
    buffer_load_dwordx4 v3, s[12:15], s24 offen offset:1024 lds
    s_waitcnt vmcnt(25)
    s_barrier
    s_add_u32 m0, s40, 122880
    s_add_u32 s24, s43, 1664
    buffer_load_dwordx4 v2, s[8:11], s24 offen lds
    s_add_u32 m0, s41, 122880
    s_add_u32 s24, s44, 1664
    buffer_load_dwordx4 v2, s[8:11], s24 offen lds
    s_add_u32 m0, s42, 122880
    s_add_u32 s24, s45, 1664
    buffer_load_dwordx4 v2, s[8:11], s24 offen lds
    s_add_u32 m0, s47, 122880
    s_add_u32 s24, s46, 425984
    buffer_load_dwordx4 v3, s[12:15], s24 offen offset:0 lds
    buffer_load_dwordx4 v3, s[12:15], s24 offen offset:1024 lds
    s_waitcnt vmcnt(25)
    s_barrier
    s_add_u32 m0, s40, 0
    s_add_u32 s24, s43, 1792
    buffer_load_dwordx4 v2, s[8:11], s24 offen lds
    s_add_u32 m0, s41, 0
    s_add_u32 s24, s44, 1792
    buffer_load_dwordx4 v2, s[8:11], s24 offen lds
    s_add_u32 m0, s42, 0
    s_add_u32 s24, s45, 1792
    buffer_load_dwordx4 v2, s[8:11], s24 offen lds
    s_add_u32 m0, s47, 0
    s_add_u32 s24, s46, 458752
    buffer_load_dwordx4 v3, s[12:15], s24 offen offset:0 lds
    buffer_load_dwordx4 v3, s[12:15], s24 offen offset:1024 lds
    s_waitcnt vmcnt(25)
    s_barrier
    s_add_u32 m0, s40, 20480
    s_add_u32 s24, s43, 1920
    buffer_load_dwordx4 v2, s[8:11], s24 offen lds
    s_add_u32 m0, s41, 20480
    s_add_u32 s24, s44, 1920
    buffer_load_dwordx4 v2, s[8:11], s24 offen lds
    s_add_u32 m0, s42, 20480
    s_add_u32 s24, s45, 1920
    buffer_load_dwordx4 v2, s[8:11], s24 offen lds
    s_add_u32 m0, s47, 20480
    s_add_u32 s24, s46, 491520
    buffer_load_dwordx4 v3, s[12:15], s24 offen offset:0 lds
    buffer_load_dwordx4 v3, s[12:15], s24 offen offset:1024 lds
    s_waitcnt vmcnt(25)
    s_barrier
    s_waitcnt vmcnt(20)
    s_barrier
    s_waitcnt vmcnt(15)
    s_barrier
    s_waitcnt vmcnt(10)
    s_barrier
    s_waitcnt vmcnt(5)
    s_barrier
    s_waitcnt vmcnt(0)
    s_barrier
    s_barrier
    s_barrier
L_gemm2_kernel_done:
    s_endpgm
L_gemm2_kernel_consumer:
    s_mul_i32 s29, s22, 37120
    s_add_u32 s29, s29, 79261696
    s_add_u32 s16, s4, s29
    s_addc_u32 s17, s5, 0
    s_mul_i32 s18, s28, 37120
    s_mov_b32 s19, 0x00020000
    s_lshr_b32 s29, s20, 1
    s_and_b32 s30, s20, 1
    v_and_b32 v137, 15, v0
    v_bfe_u32 v138, v0, 4, 2
    v_and_b32 v139, 63, v0
    s_mul_i32 s31, s29, 6144
    v_and_b32 v140, 7, v137
    v_xor_b32 v140, v138, v140
    v_lshlrev_b32 v140, 4, v140
    v_lshl_add_u32 v140, v137, 7, v140
    v_add_u32 v140, s31, v140
    v_add_u32 v128, 0, v140
    v_xor_b32 v131, 64, v128
    v_add_u32 v129, 61440, v140
    v_xor_b32 v132, 64, v129
    v_add_u32 v130, 122880, v140
    v_xor_b32 v133, 64, v130
    s_mul_i32 s31, s30, 4096
    s_add_u32 s31, s31, 12288
    v_lshlrev_b32 v140, 4, v139
    v_add_u32 v140, s31, v140
    v_add_u32 v134, 0, v140
    v_add_u32 v135, 61440, v140
    v_add_u32 v136, 122880, v140
    v_and_b32 v144, 7, v137
    v_lshrrev_b32 v145, 3, v137
    v_mul_u32_u24 v142, 37120, v144
    v_lshl_add_u32 v142, v138, 4, v142
    s_mul_i32 s31, s29, 1781760
    v_add_u32 v142, s31, v142
    v_lshl_add_u32 v142, v145, 6, v142
    v_xor_b32 v145, 64, v142
    v_add_u32 v143, 296960, v145
    s_mul_i32 s31, s27, 2
    s_mul_i32 s29, s30, 1
    s_add_u32 s31, s31, s29
    s_mul_i32 s31, s31, 128
    s_mul_i32 s29, s21, 1024
    s_add_u32 s33, s31, s29
    s_mov_b32 s34, 0x80008000
    v_mov_b32 v0, 0
    v_mov_b32 v24, 0
    v_mov_b32 v1, 0
    v_mov_b32 v25, 0
    v_mov_b32 v2, 0
    v_mov_b32 v26, 0
    v_mov_b32 v3, 0
    v_mov_b32 v27, 0
    v_mov_b32 v4, 0
    v_mov_b32 v28, 0
    v_mov_b32 v5, 0
    v_mov_b32 v29, 0
    v_mov_b32 v6, 0
    v_mov_b32 v30, 0
    v_mov_b32 v7, 0
    v_mov_b32 v31, 0
    v_mov_b32 v8, 0
    v_mov_b32 v32, 0
    v_mov_b32 v9, 0
    v_mov_b32 v33, 0
    v_mov_b32 v10, 0
    v_mov_b32 v34, 0
    v_mov_b32 v11, 0
    v_mov_b32 v35, 0
    v_mov_b32 v12, 0
    v_mov_b32 v36, 0
    v_mov_b32 v13, 0
    v_mov_b32 v37, 0
    v_mov_b32 v14, 0
    v_mov_b32 v38, 0
    v_mov_b32 v15, 0
    v_mov_b32 v39, 0
    v_mov_b32 v16, 0
    v_mov_b32 v40, 0
    v_mov_b32 v17, 0
    v_mov_b32 v41, 0
    v_mov_b32 v18, 0
    v_mov_b32 v42, 0
    v_mov_b32 v19, 0
    v_mov_b32 v43, 0
    v_mov_b32 v20, 0
    v_mov_b32 v44, 0
    v_mov_b32 v21, 0
    v_mov_b32 v45, 0
    v_mov_b32 v22, 0
    v_mov_b32 v46, 0
    v_mov_b32 v23, 0
    v_mov_b32 v47, 0
    s_mov_b32 s38, 0
    v_add_u32 v129, s38, v128
    v_add_u32 v135, s38, v134
    v_xor_b32 v131, 64, v129
    s_add_u32 s38, s38, 20480
    s_cmp_eq_u32 s38, 143360
    s_cselect_b32 s38, 0, s38
    s_barrier
    ds_read_b128 v[48:51], v135 offset:0
    ds_read_b128 v[64:67], v129 offset:0
    ds_read_b128 v[72:75], v129 offset:2048
    ds_read_b128 v[80:83], v129 offset:4096
    ds_read_b128 v[56:59], v135 offset:2048
    ds_read_b128 v[68:71], v131 offset:0
    ds_read_b128 v[76:79], v131 offset:2048
    ds_read_b128 v[84:87], v131 offset:4096
    ds_read_b128 v[52:55], v135 offset:1024
    ds_read_b128 v[60:63], v135 offset:3072
    v_add_u32 v129, s38, v128
    v_add_u32 v135, s38, v134
    v_xor_b32 v131, 64, v129
    s_add_u32 s38, s38, 20480
    s_cmp_eq_u32 s38, 143360
    s_cselect_b32 s38, 0, s38
    s_mov_b32 s39, 8
    s_waitcnt lgkmcnt(0)
    s_barrier
L_gemm2_kernel_loop:
    v_mfma_f32_16x16x32_bf16 v[0:3], v[48:51], v[64:67], v[0:3]
    ds_read_b128 v[88:91], v135 offset:0
    v_mfma_f32_16x16x32_bf16 v[4:7], v[48:51], v[72:75], v[4:7]
    ds_read_b128 v[104:107], v129 offset:0
    v_mfma_f32_16x16x32_bf16 v[8:11], v[48:51], v[80:83], v[8:11]
    ds_read_b128 v[112:115], v129 offset:2048
    v_mfma_f32_16x16x32_bf16 v[12:15], v[56:59], v[64:67], v[12:15]
    ds_read_b128 v[120:123], v129 offset:4096
    v_mfma_f32_16x16x32_bf16 v[16:19], v[56:59], v[72:75], v[16:19]
    ds_read_b128 v[96:99], v135 offset:2048
    v_mfma_f32_16x16x32_bf16 v[20:23], v[56:59], v[80:83], v[20:23]
    ds_read_b128 v[108:111], v131 offset:0
    v_mfma_f32_16x16x32_bf16 v[24:27], v[48:51], v[68:71], v[24:27]
    ds_read_b128 v[116:119], v131 offset:2048
    v_mfma_f32_16x16x32_bf16 v[28:31], v[48:51], v[76:79], v[28:31]
    ds_read_b128 v[124:127], v131 offset:4096
    v_mfma_f32_16x16x32_bf16 v[32:35], v[48:51], v[84:87], v[32:35]
    ds_read_b128 v[92:95], v135 offset:1024
    v_mfma_f32_16x16x32_bf16 v[36:39], v[56:59], v[68:71], v[36:39]
    ds_read_b128 v[100:103], v135 offset:3072
    v_mfma_f32_16x16x32_bf16 v[40:43], v[56:59], v[76:79], v[40:43]
    v_mfma_f32_16x16x32_bf16 v[44:47], v[56:59], v[84:87], v[44:47]
    v_mfma_f32_16x16x32_bf16 v[24:27], v[52:55], v[64:67], v[24:27]
    v_xor_b32 v68, s34, v68
    v_xor_b32 v69, s34, v69
    v_mfma_f32_16x16x32_bf16 v[28:31], v[52:55], v[72:75], v[28:31]
    v_xor_b32 v70, s34, v70
    v_xor_b32 v71, s34, v71
    v_mfma_f32_16x16x32_bf16 v[32:35], v[52:55], v[80:83], v[32:35]
    v_xor_b32 v76, s34, v76
    v_xor_b32 v77, s34, v77
    v_mfma_f32_16x16x32_bf16 v[36:39], v[60:63], v[64:67], v[36:39]
    v_xor_b32 v78, s34, v78
    v_xor_b32 v79, s34, v79
    v_mfma_f32_16x16x32_bf16 v[40:43], v[60:63], v[72:75], v[40:43]
    v_xor_b32 v84, s34, v84
    v_xor_b32 v85, s34, v85
    v_mfma_f32_16x16x32_bf16 v[44:47], v[60:63], v[80:83], v[44:47]
    v_xor_b32 v86, s34, v86
    v_xor_b32 v87, s34, v87
    v_mfma_f32_16x16x32_bf16 v[0:3], v[52:55], v[68:71], v[0:3]
    v_mfma_f32_16x16x32_bf16 v[4:7], v[52:55], v[76:79], v[4:7]
    v_mfma_f32_16x16x32_bf16 v[8:11], v[52:55], v[84:87], v[8:11]
    s_waitcnt lgkmcnt(0)
    s_barrier
    v_mfma_f32_16x16x32_bf16 v[12:15], v[60:63], v[68:71], v[12:15]
    v_add_u32 v129, s38, v128
    v_add_u32 v135, s38, v134
    v_mfma_f32_16x16x32_bf16 v[16:19], v[60:63], v[76:79], v[16:19]
    v_xor_b32 v131, 64, v129
    s_add_u32 s38, s38, 20480
    v_mfma_f32_16x16x32_bf16 v[20:23], v[60:63], v[84:87], v[20:23]
    s_cmp_eq_u32 s38, 143360
    s_cselect_b32 s38, 0, s38
    v_mfma_f32_16x16x32_bf16 v[0:3], v[88:91], v[104:107], v[0:3]
    ds_read_b128 v[48:51], v135 offset:0
    v_mfma_f32_16x16x32_bf16 v[4:7], v[88:91], v[112:115], v[4:7]
    ds_read_b128 v[64:67], v129 offset:0
    v_mfma_f32_16x16x32_bf16 v[8:11], v[88:91], v[120:123], v[8:11]
    ds_read_b128 v[72:75], v129 offset:2048
    v_mfma_f32_16x16x32_bf16 v[12:15], v[96:99], v[104:107], v[12:15]
    ds_read_b128 v[80:83], v129 offset:4096
    v_mfma_f32_16x16x32_bf16 v[16:19], v[96:99], v[112:115], v[16:19]
    ds_read_b128 v[56:59], v135 offset:2048
    v_mfma_f32_16x16x32_bf16 v[20:23], v[96:99], v[120:123], v[20:23]
    ds_read_b128 v[68:71], v131 offset:0
    v_mfma_f32_16x16x32_bf16 v[24:27], v[88:91], v[108:111], v[24:27]
    ds_read_b128 v[76:79], v131 offset:2048
    v_mfma_f32_16x16x32_bf16 v[28:31], v[88:91], v[116:119], v[28:31]
    ds_read_b128 v[84:87], v131 offset:4096
    v_mfma_f32_16x16x32_bf16 v[32:35], v[88:91], v[124:127], v[32:35]
    ds_read_b128 v[52:55], v135 offset:1024
    v_mfma_f32_16x16x32_bf16 v[36:39], v[96:99], v[108:111], v[36:39]
    ds_read_b128 v[60:63], v135 offset:3072
    v_mfma_f32_16x16x32_bf16 v[40:43], v[96:99], v[116:119], v[40:43]
    v_mfma_f32_16x16x32_bf16 v[44:47], v[96:99], v[124:127], v[44:47]
    v_mfma_f32_16x16x32_bf16 v[24:27], v[92:95], v[104:107], v[24:27]
    v_xor_b32 v108, s34, v108
    v_xor_b32 v109, s34, v109
    v_mfma_f32_16x16x32_bf16 v[28:31], v[92:95], v[112:115], v[28:31]
    v_xor_b32 v110, s34, v110
    v_xor_b32 v111, s34, v111
    v_mfma_f32_16x16x32_bf16 v[32:35], v[92:95], v[120:123], v[32:35]
    v_xor_b32 v116, s34, v116
    v_xor_b32 v117, s34, v117
    v_mfma_f32_16x16x32_bf16 v[36:39], v[100:103], v[104:107], v[36:39]
    v_xor_b32 v118, s34, v118
    v_xor_b32 v119, s34, v119
    v_mfma_f32_16x16x32_bf16 v[40:43], v[100:103], v[112:115], v[40:43]
    v_xor_b32 v124, s34, v124
    v_xor_b32 v125, s34, v125
    v_mfma_f32_16x16x32_bf16 v[44:47], v[100:103], v[120:123], v[44:47]
    v_xor_b32 v126, s34, v126
    v_xor_b32 v127, s34, v127
    v_mfma_f32_16x16x32_bf16 v[0:3], v[92:95], v[108:111], v[0:3]
    v_mfma_f32_16x16x32_bf16 v[4:7], v[92:95], v[116:119], v[4:7]
    v_mfma_f32_16x16x32_bf16 v[8:11], v[92:95], v[124:127], v[8:11]
    s_waitcnt lgkmcnt(0)
    s_barrier
    v_mfma_f32_16x16x32_bf16 v[12:15], v[100:103], v[108:111], v[12:15]
    v_add_u32 v129, s38, v128
    v_add_u32 v135, s38, v134
    v_mfma_f32_16x16x32_bf16 v[16:19], v[100:103], v[116:119], v[16:19]
    v_xor_b32 v131, 64, v129
    s_add_u32 s38, s38, 20480
    s_sub_u32 s39, s39, 1
    v_mfma_f32_16x16x32_bf16 v[20:23], v[100:103], v[124:127], v[20:23]
    s_cmp_eq_u32 s38, 143360
    s_cselect_b32 s38, 0, s38
    s_cmp_lg_u32 s39, 0
    s_cbranch_scc1 L_gemm2_kernel_loop
    s_nop 7
    s_nop 7
    v_cvt_pk_bf16_f32 v48, v0, v1
    v_cvt_pk_bf16_f32 v49, v2, v3
    v_cvt_pk_bf16_f32 v50, v12, v13
    v_cvt_pk_bf16_f32 v51, v14, v15
    v_cvt_pk_bf16_f32 v52, v24, v25
    v_cvt_pk_bf16_f32 v53, v26, v27
    v_cvt_pk_bf16_f32 v54, v36, v37
    v_cvt_pk_bf16_f32 v55, v38, v39
    v_mov_b32 v56, v48
    v_mov_b32 v57, v49
    v_mov_b32 v58, v50
    v_mov_b32 v59, v51
    s_add_u32 s35, s33, 0
    v_mov_b32_dpp v56, v52 row_ror:8 row_mask:0xf bank_mask:0x3
    v_mov_b32_dpp v57, v53 row_ror:8 row_mask:0xf bank_mask:0x3
    v_mov_b32_dpp v58, v54 row_ror:8 row_mask:0xf bank_mask:0x3
    v_mov_b32_dpp v59, v55 row_ror:8 row_mask:0xf bank_mask:0x3
    v_mov_b32_dpp v48, v52 row_ror:8 row_mask:0xf bank_mask:0xc
    v_mov_b32_dpp v49, v53 row_ror:8 row_mask:0xf bank_mask:0xc
    v_mov_b32_dpp v50, v54 row_ror:8 row_mask:0xf bank_mask:0xc
    v_mov_b32_dpp v51, v55 row_ror:8 row_mask:0xf bank_mask:0xc
    buffer_store_dwordx4 v[48:51], v142, s[16:19], s35 offen sc1
    buffer_store_dwordx4 v[56:59], v143, s[16:19], s35 offen sc1
    v_cvt_pk_bf16_f32 v60, v4, v5
    v_cvt_pk_bf16_f32 v61, v6, v7
    v_cvt_pk_bf16_f32 v62, v16, v17
    v_cvt_pk_bf16_f32 v63, v18, v19
    v_cvt_pk_bf16_f32 v64, v28, v29
    v_cvt_pk_bf16_f32 v65, v30, v31
    v_cvt_pk_bf16_f32 v66, v40, v41
    v_cvt_pk_bf16_f32 v67, v42, v43
    v_mov_b32 v68, v60
    v_mov_b32 v69, v61
    v_mov_b32 v70, v62
    v_mov_b32 v71, v63
    s_add_u32 s35, s33, 593920
    v_mov_b32_dpp v68, v64 row_ror:8 row_mask:0xf bank_mask:0x3
    v_mov_b32_dpp v69, v65 row_ror:8 row_mask:0xf bank_mask:0x3
    v_mov_b32_dpp v70, v66 row_ror:8 row_mask:0xf bank_mask:0x3
    v_mov_b32_dpp v71, v67 row_ror:8 row_mask:0xf bank_mask:0x3
    v_mov_b32_dpp v60, v64 row_ror:8 row_mask:0xf bank_mask:0xc
    v_mov_b32_dpp v61, v65 row_ror:8 row_mask:0xf bank_mask:0xc
    v_mov_b32_dpp v62, v66 row_ror:8 row_mask:0xf bank_mask:0xc
    v_mov_b32_dpp v63, v67 row_ror:8 row_mask:0xf bank_mask:0xc
    buffer_store_dwordx4 v[60:63], v142, s[16:19], s35 offen sc1
    buffer_store_dwordx4 v[68:71], v143, s[16:19], s35 offen sc1
    v_cvt_pk_bf16_f32 v72, v8, v9
    v_cvt_pk_bf16_f32 v73, v10, v11
    v_cvt_pk_bf16_f32 v74, v20, v21
    v_cvt_pk_bf16_f32 v75, v22, v23
    v_cvt_pk_bf16_f32 v76, v32, v33
    v_cvt_pk_bf16_f32 v77, v34, v35
    v_cvt_pk_bf16_f32 v78, v44, v45
    v_cvt_pk_bf16_f32 v79, v46, v47
    v_mov_b32 v80, v72
    v_mov_b32 v81, v73
    v_mov_b32 v82, v74
    v_mov_b32 v83, v75
    s_add_u32 s35, s33, 1187840
    v_mov_b32_dpp v80, v76 row_ror:8 row_mask:0xf bank_mask:0x3
    v_mov_b32_dpp v81, v77 row_ror:8 row_mask:0xf bank_mask:0x3
    v_mov_b32_dpp v82, v78 row_ror:8 row_mask:0xf bank_mask:0x3
    v_mov_b32_dpp v83, v79 row_ror:8 row_mask:0xf bank_mask:0x3
    v_mov_b32_dpp v72, v76 row_ror:8 row_mask:0xf bank_mask:0xc
    v_mov_b32_dpp v73, v77 row_ror:8 row_mask:0xf bank_mask:0xc
    v_mov_b32_dpp v74, v78 row_ror:8 row_mask:0xf bank_mask:0xc
    v_mov_b32_dpp v75, v79 row_ror:8 row_mask:0xf bank_mask:0xc
    buffer_store_dwordx4 v[72:75], v142, s[16:19], s35 offen sc1
    buffer_store_dwordx4 v[80:83], v143, s[16:19], s35 offen sc1
    s_endpgm
.globl joint_kernel
.p2align 8
.type joint_kernel,@function
joint_kernel:
    s_cmp_ge_u32 s2, 256
    s_cbranch_scc1 L_joint_kernel_done
    s_load_dwordx2 s[6:7], s[0:1], 72
    s_load_dwordx2 s[4:5], s[0:1], 56
    v_readfirstlane_b32 s20, v0
    s_lshr_b32 s20, s20, 6
    s_and_b32 s21, s20, 3
    s_and_b32 s23, s2, 7
    s_lshl_b32 s23, s23, 5
    s_lshr_b32 s22, s2, 3
    s_add_u32 s23, s23, s22
    s_cmp_ge_u32 s23, 250
    s_cbranch_scc1 L_joint_kernel_done
    s_cmp_ge_u32 s23, 125
    s_cselect_b32 s24, 1, 0
    s_mul_i32 s25, s24, 125
    s_sub_u32 s25, s23, s25
    s_lshl_b32 s26, s25, 1
    s_add_u32 s26, s26, 0
    s_mul_i32 s27, s26, 171
    s_lshr_b32 s28, s27, 9
    s_mul_i32 s27, s28, 3
    s_sub_u32 s30, s26, s27
    s_lshl_b32 s26, s25, 1
    s_add_u32 s26, s26, 1
    s_mul_i32 s27, s26, 171
    s_lshr_b32 s29, s27, 9
    s_mul_i32 s27, s29, 3
    s_sub_u32 s31, s26, s27
    v_and_b32 v1, 63, v0
    v_lshlrev_b32 v5, 4, v1
    s_waitcnt lgkmcnt(0)
    s_add_u32 s12, s6, 85499904
    s_addc_u32 s13, s7, 0
    s_mov_b32 s14, 295936
    s_mov_b32 s15, 0x00020000
    s_mul_i32 s36, s24, 4000
    s_lshl_b32 s37, s25, 5
    s_add_u32 s36, s36, s37
    s_lshl_b32 s36, s36, 12
    s_add_u32 s16, s4, s36
    s_addc_u32 s17, s5, 0
    s_mov_b32 s18, 131072
    s_mov_b32 s19, 0x00020000
    s_lshl_b32 s38, s21, 15
    s_cmp_lt_u32 s20, 4
    s_cbranch_scc1 L_joint_kernel_mpath
    v_and_b32 v14, 7, v1
    v_lshlrev_b32 v14, 10, v14
    v_lshrrev_b32 v15, 5, v1
    v_lshl_add_u32 v14, v15, 4, v14
    s_lshl_b32 s36, s24, 13
    s_lshl_b32 s37, s21, 8
    s_add_u32 s36, s36, s37
    s_add_u32 s37, s36, 16384
    s_add_u32 s36, s38, 32768
    buffer_load_dwordx4 a[0:3], v5, s[12:15], s36 offen
    s_add_u32 s36, s38, 49152
    buffer_load_dwordx4 a[64:67], v5, s[12:15], s36 offen
    s_add_u32 s36, s38, 33792
    buffer_load_dwordx4 a[4:7], v5, s[12:15], s36 offen
    s_add_u32 s36, s38, 50176
    buffer_load_dwordx4 a[68:71], v5, s[12:15], s36 offen
    s_add_u32 s36, s38, 34816
    buffer_load_dwordx4 a[8:11], v5, s[12:15], s36 offen
    s_add_u32 s36, s38, 51200
    buffer_load_dwordx4 a[72:75], v5, s[12:15], s36 offen
    s_add_u32 s36, s38, 35840
    buffer_load_dwordx4 a[12:15], v5, s[12:15], s36 offen
    s_add_u32 s36, s38, 52224
    buffer_load_dwordx4 a[76:79], v5, s[12:15], s36 offen
    s_add_u32 s36, s38, 36864
    buffer_load_dwordx4 a[16:19], v5, s[12:15], s36 offen
    s_add_u32 s36, s38, 53248
    buffer_load_dwordx4 a[80:83], v5, s[12:15], s36 offen
    s_add_u32 s36, s38, 37888
    buffer_load_dwordx4 a[20:23], v5, s[12:15], s36 offen
    s_add_u32 s36, s38, 54272
    buffer_load_dwordx4 a[84:87], v5, s[12:15], s36 offen
    s_add_u32 s36, s38, 38912
    buffer_load_dwordx4 a[24:27], v5, s[12:15], s36 offen
    s_add_u32 s36, s38, 55296
    buffer_load_dwordx4 a[88:91], v5, s[12:15], s36 offen
    s_add_u32 s36, s38, 39936
    buffer_load_dwordx4 a[28:31], v5, s[12:15], s36 offen
    s_add_u32 s36, s38, 56320
    buffer_load_dwordx4 a[92:95], v5, s[12:15], s36 offen
    s_add_u32 s36, s38, 40960
    buffer_load_dwordx4 a[32:35], v5, s[12:15], s36 offen
    s_add_u32 s36, s38, 57344
    buffer_load_dwordx4 a[96:99], v5, s[12:15], s36 offen
    s_add_u32 s36, s38, 41984
    buffer_load_dwordx4 a[36:39], v5, s[12:15], s36 offen
    s_add_u32 s36, s38, 58368
    buffer_load_dwordx4 a[100:103], v5, s[12:15], s36 offen
    s_add_u32 s36, s38, 43008
    buffer_load_dwordx4 a[40:43], v5, s[12:15], s36 offen
    s_add_u32 s36, s38, 59392
    buffer_load_dwordx4 a[104:107], v5, s[12:15], s36 offen
    s_add_u32 s36, s38, 44032
    buffer_load_dwordx4 a[44:47], v5, s[12:15], s36 offen
    s_add_u32 s36, s38, 60416
    buffer_load_dwordx4 a[108:111], v5, s[12:15], s36 offen
    s_add_u32 s36, s38, 45056
    buffer_load_dwordx4 a[48:51], v5, s[12:15], s36 offen
    s_add_u32 s36, s38, 61440
    buffer_load_dwordx4 a[112:115], v5, s[12:15], s36 offen
    s_add_u32 s36, s38, 46080
    buffer_load_dwordx4 a[52:55], v5, s[12:15], s36 offen
    s_add_u32 s36, s38, 62464
    buffer_load_dwordx4 a[116:119], v5, s[12:15], s36 offen
    s_add_u32 s36, s38, 47104
    buffer_load_dwordx4 a[56:59], v5, s[12:15], s36 offen
    s_add_u32 s36, s38, 63488
    buffer_load_dwordx4 a[120:123], v5, s[12:15], s36 offen
    s_add_u32 s36, s38, 48128
    buffer_load_dwordx4 a[60:63], v5, s[12:15], s36 offen
    s_add_u32 s36, s38, 64512
    buffer_load_dwordx4 a[124:127], v5, s[12:15], s36 offen
    buffer_load_dwordx4 v[96:99], v14, s[12:15], s37 offen offset:0
    buffer_load_dwordx4 v[100:103], v14, s[12:15], s37 offen offset:32
    buffer_load_dwordx4 v[104:107], v14, s[12:15], s37 offen offset:64
    buffer_load_dwordx4 v[108:111], v14, s[12:15], s37 offen offset:96
    buffer_load_dwordx4 v[112:115], v14, s[12:15], s37 offen offset:128
    buffer_load_dwordx4 v[116:119], v14, s[12:15], s37 offen offset:160
    buffer_load_dwordx4 v[120:123], v14, s[12:15], s37 offen offset:192
    buffer_load_dwordx4 v[124:127], v14, s[12:15], s37 offen offset:224
    s_branch L_joint_kernel_helper
L_joint_kernel_mpath:
    s_lshr_b32 s36, s2, 3
    s_and_b32 s36, s36, 31
    s_lshl_b32 s36, s36, 13
    s_add_u32 s36, s36, 32768
    v_lshlrev_b32 v6, 7, v1
    s_cmp_lg_u32 s20, 0
    s_cbranch_scc1 L_joint_kernel_nopf
    buffer_load_dword v7, v6, s[12:15], s36 offen
L_joint_kernel_nopf:
    v_lshrrev_b32 v2, 3, v1
    v_mul_u32_u24 v2, 1024, v2
    v_bfe_u32 v3, v1, 2, 1
    v_lshl_add_u32 v2, v3, 6, v2
    v_lshrrev_b32 v3, 5, v1
    v_lshlrev_b32 v3, 1, v3
    v_and_b32 v4, 3, v1
    v_xor_b32 v3, v3, v4
    v_lshl_add_u32 v2, v3, 4, v2
    s_lshl_b32 s34, s21, 14
    s_mul_i32 s35, s21, 256
    s_mul_i32 s33, s24, 3118080
    s_add_u32 s33, s33, 79261696
    s_add_u32 s8, s6, s33
    s_addc_u32 s9, s7, 0
    s_mov_b32 s10, 3118080
    s_mov_b32 s11, 0x00020000
    s_mov_b32 s46, 0
    s_cmp_eq_u32 s28, s29
    s_cbranch_scc1 L_joint_kernel_same
    s_mul_i32 s36, s29, 37120
    s_add_u32 s36, s36, s35
    s_add_u32 m0, s34, 8192
    s_add_u32 s37, s36, 0
    buffer_load_dwordx4 v2, s[8:11], s37 offen lds
    s_add_u32 m0, s34, 9216
    s_add_u32 s37, s36, 8192
    buffer_load_dwordx4 v2, s[8:11], s37 offen lds
    s_add_u32 m0, s34, 10240
    s_add_u32 s37, s36, 16384
    buffer_load_dwordx4 v2, s[8:11], s37 offen lds
    s_add_u32 m0, s34, 11264
    s_add_u32 s37, s36, 24576
    buffer_load_dwordx4 v2, s[8:11], s37 offen lds
    s_add_u32 m0, s34, 12288
    s_add_u32 s37, s36, 128
    buffer_load_dwordx4 v2, s[8:11], s37 offen lds
    s_add_u32 m0, s34, 13312
    s_add_u32 s37, s36, 8320
    buffer_load_dwordx4 v2, s[8:11], s37 offen lds
    s_add_u32 m0, s34, 14336
    s_add_u32 s37, s36, 16512
    buffer_load_dwordx4 v2, s[8:11], s37 offen lds
    s_add_u32 m0, s34, 15360
    s_add_u32 s37, s36, 24704
    buffer_load_dwordx4 v2, s[8:11], s37 offen lds
    s_mov_b32 s46, 8192
L_joint_kernel_same:
    s_lshl_b32 s36, s30, 11
    s_add_u32 s36, s36, 8192
    buffer_load_dwordx4 v[8:11], v5, s[12:15], s36 offen offset:0
    buffer_load_dwordx4 v[12:15], v5, s[12:15], s36 offen offset:1024
    s_lshl_b32 s36, s31, 11
    s_add_u32 s36, s36, 8192
    buffer_load_dwordx4 v[16:19], v5, s[12:15], s36 offen offset:0
    buffer_load_dwordx4 v[20:23], v5, s[12:15], s36 offen offset:1024
    s_mul_i32 s36, s28, 37120
    s_add_u32 s36, s36, s35
    s_add_u32 m0, s34, 0
    s_add_u32 s37, s36, 0
    buffer_load_dwordx4 v2, s[8:11], s37 offen lds
    s_add_u32 m0, s34, 1024
    s_add_u32 s37, s36, 8192
    buffer_load_dwordx4 v2, s[8:11], s37 offen lds
    s_add_u32 m0, s34, 2048
    s_add_u32 s37, s36, 16384
    buffer_load_dwordx4 v2, s[8:11], s37 offen lds
    s_add_u32 m0, s34, 3072
    s_add_u32 s37, s36, 24576
    buffer_load_dwordx4 v2, s[8:11], s37 offen lds
    s_add_u32 m0, s34, 4096
    s_add_u32 s37, s36, 128
    buffer_load_dwordx4 v2, s[8:11], s37 offen lds
    s_add_u32 m0, s34, 5120
    s_add_u32 s37, s36, 8320
    buffer_load_dwordx4 v2, s[8:11], s37 offen lds
    s_add_u32 m0, s34, 6144
    s_add_u32 s37, s36, 16512
    buffer_load_dwordx4 v2, s[8:11], s37 offen lds
    s_add_u32 m0, s34, 7168
    s_add_u32 s37, s36, 24704
    buffer_load_dwordx4 v2, s[8:11], s37 offen lds
    v_bfe_u32 v32, v1, 2, 2
    v_lshrrev_b32 v33, 4, v1
    v_and_b32 v34, 3, v1
    v_lshl_add_u32 v35, v33, 3, v32
    v_lshlrev_b32 v40, 6, v35
    v_and_b32 v41, 1, v33
    v_lshlrev_b32 v41, 1, v41
    v_lshrrev_b32 v42, 1, v34
    v_xor_b32 v41, v41, v42
    v_lshl_add_u32 v40, v41, 4, v40
    v_and_b32 v42, 1, v34
    v_lshl_add_u32 v40, v42, 3, v40
    v_add_u32 v36, s34, v40
    v_xor_b32 v37, 32, v36
    v_add_u32 v38, s46, v36
    v_add_u32 v39, s46, v37
    v_lshrrev_b32 v41, 1, v33
    v_lshlrev_b32 v41, 10, v41
    v_and_b32 v42, 1, v33
    v_lshl_add_u32 v41, v42, 9, v41
    v_and_b32 v42, 15, v1
    v_lshl_add_u32 v41, v42, 4, v41
    s_lshl_b32 s36, s21, 12
    s_add_u32 s36, s36, 65536
    v_add_u32 v43, s36, v41
    s_mov_b32 s40, 0xbdd2d3e8
    v_mov_b32 v44, 0xc0135761
    s_mov_b32 s41, 0xbdd2d3e8
    v_mov_b32 v45, 0xc0135761
    s_waitcnt vmcnt(4)
    ds_read_b64_tr_b16 v[48:49], v36 offset:0
    ds_read_b64_tr_b16 v[50:51], v36 offset:256
    ds_read_b64_tr_b16 v[52:53], v36 offset:2048
    ds_read_b64_tr_b16 v[54:55], v36 offset:2304
    ds_read_b64_tr_b16 v[56:57], v37 offset:0
    ds_read_b64_tr_b16 v[58:59], v37 offset:256
    ds_read_b64_tr_b16 v[60:61], v37 offset:2048
    ds_read_b64_tr_b16 v[62:63], v37 offset:2304
    s_waitcnt lgkmcnt(0)
    v_mfma_f32_16x16x32_bf16 v[64:67], v[48:51], v[8:11], 0
    v_mfma_f32_16x16x32_bf16 v[68:71], v[56:59], v[8:11], 0
    v_mfma_f32_16x16x32_bf16 v[64:67], v[52:55], v[12:15], v[64:67]
    v_mfma_f32_16x16x32_bf16 v[68:71], v[60:63], v[12:15], v[68:71]
    ds_read_b64_tr_b16 v[84:85], v38 offset:0
    ds_read_b64_tr_b16 v[86:87], v38 offset:256
    ds_read_b64_tr_b16 v[88:89], v38 offset:2048
    ds_read_b64_tr_b16 v[90:91], v38 offset:2304
    ds_read_b64_tr_b16 v[92:93], v39 offset:0
    ds_read_b64_tr_b16 v[94:95], v39 offset:256
    ds_read_b64_tr_b16 v[96:97], v39 offset:2048
    ds_read_b64_tr_b16 v[98:99], v39 offset:2304
    v_mul_f32 v72, v64, v64
    v_mul_f32 v73, v65, v65
    v_mul_f32 v74, v66, v66
    v_mul_f32 v75, v67, v67
    v_mul_f32 v76, v68, v68
    v_mul_f32 v77, v69, v69
    v_mul_f32 v78, v70, v70
    v_mul_f32 v79, v71, v71
    v_fma_f32 v72, v72, s40, v44
    v_fma_f32 v73, v73, s40, v44
    v_fma_f32 v74, v74, s40, v44
    v_fma_f32 v75, v75, s40, v44
    v_fma_f32 v76, v76, s40, v44
    v_fma_f32 v77, v77, s40, v44
    v_fma_f32 v78, v78, s40, v44
    v_fma_f32 v79, v79, s40, v44
    v_mul_f32 v72, v72, v64
    v_mul_f32 v73, v73, v65
    v_mul_f32 v74, v74, v66
    v_mul_f32 v75, v75, v67
    v_mul_f32 v76, v76, v68
    v_mul_f32 v77, v77, v69
    v_mul_f32 v78, v78, v70
    v_mul_f32 v79, v79, v71
    v_exp_f32 v72, v72
    v_exp_f32 v73, v73
    v_exp_f32 v74, v74
    v_exp_f32 v75, v75
    v_exp_f32 v76, v76
    v_exp_f32 v77, v77
    v_exp_f32 v78, v78
    v_exp_f32 v79, v79
    v_add_f32 v72, 1.0, v72
    v_add_f32 v73, 1.0, v73
    v_add_f32 v74, 1.0, v74
    v_add_f32 v75, 1.0, v75
    v_add_f32 v76, 1.0, v76
    v_add_f32 v77, 1.0, v77
    v_add_f32 v78, 1.0, v78
    v_add_f32 v79, 1.0, v79
    v_rcp_f32 v72, v72
    v_rcp_f32 v73, v73
    v_rcp_f32 v74, v74
    v_rcp_f32 v75, v75
    v_rcp_f32 v76, v76
    v_rcp_f32 v77, v77
    v_rcp_f32 v78, v78
    v_rcp_f32 v79, v79
    v_mul_f32 v64, v64, v72
    v_mul_f32 v65, v65, v73
    v_mul_f32 v66, v66, v74
    v_mul_f32 v67, v67, v75
    v_mul_f32 v68, v68, v76
    v_mul_f32 v69, v69, v77
    v_mul_f32 v70, v70, v78
    v_mul_f32 v71, v71, v79
    v_cvt_pk_bf16_f32 v80, v64, v65
    v_cvt_pk_bf16_f32 v81, v66, v67
    v_cvt_pk_bf16_f32 v82, v68, v69
    v_cvt_pk_bf16_f32 v83, v70, v71
    ds_write_b128 v43, v[80:83] offset:0
    s_waitcnt vmcnt(0)
    s_waitcnt lgkmcnt(1)
    v_mfma_f32_16x16x32_bf16 v[100:103], v[84:87], v[16:19], 0
    v_mfma_f32_16x16x32_bf16 v[104:107], v[92:95], v[16:19], 0
    v_mfma_f32_16x16x32_bf16 v[100:103], v[88:91], v[20:23], v[100:103]
    v_mfma_f32_16x16x32_bf16 v[104:107], v[96:99], v[20:23], v[104:107]
    ds_read_b64_tr_b16 v[48:49], v36 offset:4096
    ds_read_b64_tr_b16 v[50:51], v36 offset:4352
    ds_read_b64_tr_b16 v[52:53], v36 offset:6144
    ds_read_b64_tr_b16 v[54:55], v36 offset:6400
    ds_read_b64_tr_b16 v[56:57], v37 offset:4096
    ds_read_b64_tr_b16 v[58:59], v37 offset:4352
    ds_read_b64_tr_b16 v[60:61], v37 offset:6144
    ds_read_b64_tr_b16 v[62:63], v37 offset:6400
    v_mul_f32 v72, v100, v100
    v_mul_f32 v73, v101, v101
    v_mul_f32 v74, v102, v102
    v_mul_f32 v75, v103, v103
    v_mul_f32 v76, v104, v104
    v_mul_f32 v77, v105, v105
    v_mul_f32 v78, v106, v106
    v_mul_f32 v79, v107, v107
    v_fma_f32 v72, v72, s40, v44
    v_fma_f32 v73, v73, s40, v44
    v_fma_f32 v74, v74, s40, v44
    v_fma_f32 v75, v75, s40, v44
    v_fma_f32 v76, v76, s40, v44
    v_fma_f32 v77, v77, s40, v44
    v_fma_f32 v78, v78, s40, v44
    v_fma_f32 v79, v79, s40, v44
    v_mul_f32 v72, v72, v100
    v_mul_f32 v73, v73, v101
    v_mul_f32 v74, v74, v102
    v_mul_f32 v75, v75, v103
    v_mul_f32 v76, v76, v104
    v_mul_f32 v77, v77, v105
    v_mul_f32 v78, v78, v106
    v_mul_f32 v79, v79, v107
    v_exp_f32 v72, v72
    v_exp_f32 v73, v73
    v_exp_f32 v74, v74
    v_exp_f32 v75, v75
    v_exp_f32 v76, v76
    v_exp_f32 v77, v77
    v_exp_f32 v78, v78
    v_exp_f32 v79, v79
    v_add_f32 v72, 1.0, v72
    v_add_f32 v73, 1.0, v73
    v_add_f32 v74, 1.0, v74
    v_add_f32 v75, 1.0, v75
    v_add_f32 v76, 1.0, v76
    v_add_f32 v77, 1.0, v77
    v_add_f32 v78, 1.0, v78
    v_add_f32 v79, 1.0, v79
    v_rcp_f32 v72, v72
    v_rcp_f32 v73, v73
    v_rcp_f32 v74, v74
    v_rcp_f32 v75, v75
    v_rcp_f32 v76, v76
    v_rcp_f32 v77, v77
    v_rcp_f32 v78, v78
    v_rcp_f32 v79, v79
    v_mul_f32 v100, v100, v72
    v_mul_f32 v101, v101, v73
    v_mul_f32 v102, v102, v74
    v_mul_f32 v103, v103, v75
    v_mul_f32 v104, v104, v76
    v_mul_f32 v105, v105, v77
    v_mul_f32 v106, v106, v78
    v_mul_f32 v107, v107, v79
    v_cvt_pk_bf16_f32 v108, v100, v101
    v_cvt_pk_bf16_f32 v109, v102, v103
    v_cvt_pk_bf16_f32 v110, v104, v105
    v_cvt_pk_bf16_f32 v111, v106, v107
    ds_write_b128 v43, v[108:111] offset:256
    s_waitcnt lgkmcnt(1)
    v_mfma_f32_16x16x32_bf16 v[64:67], v[48:51], v[8:11], 0
    v_mfma_f32_16x16x32_bf16 v[68:71], v[56:59], v[8:11], 0
    v_mfma_f32_16x16x32_bf16 v[64:67], v[52:55], v[12:15], v[64:67]
    v_mfma_f32_16x16x32_bf16 v[68:71], v[60:63], v[12:15], v[68:71]
    ds_read_b64_tr_b16 v[84:85], v38 offset:4096
    ds_read_b64_tr_b16 v[86:87], v38 offset:4352
    ds_read_b64_tr_b16 v[88:89], v38 offset:6144
    ds_read_b64_tr_b16 v[90:91], v38 offset:6400
    ds_read_b64_tr_b16 v[92:93], v39 offset:4096
    ds_read_b64_tr_b16 v[94:95], v39 offset:4352
    ds_read_b64_tr_b16 v[96:97], v39 offset:6144
    ds_read_b64_tr_b16 v[98:99], v39 offset:6400
    v_mul_f32 v72, v64, v64
    v_mul_f32 v73, v65, v65
    v_mul_f32 v74, v66, v66
    v_mul_f32 v75, v67, v67
    v_mul_f32 v76, v68, v68
    v_mul_f32 v77, v69, v69
    v_mul_f32 v78, v70, v70
    v_mul_f32 v79, v71, v71
    v_fma_f32 v72, v72, s40, v44
    v_fma_f32 v73, v73, s40, v44
    v_fma_f32 v74, v74, s40, v44
    v_fma_f32 v75, v75, s40, v44
    v_fma_f32 v76, v76, s40, v44
    v_fma_f32 v77, v77, s40, v44
    v_fma_f32 v78, v78, s40, v44
    v_fma_f32 v79, v79, s40, v44
    v_mul_f32 v72, v72, v64
    v_mul_f32 v73, v73, v65
    v_mul_f32 v74, v74, v66
    v_mul_f32 v75, v75, v67
    v_mul_f32 v76, v76, v68
    v_mul_f32 v77, v77, v69
    v_mul_f32 v78, v78, v70
    v_mul_f32 v79, v79, v71
    v_exp_f32 v72, v72
    v_exp_f32 v73, v73
    v_exp_f32 v74, v74
    v_exp_f32 v75, v75
    v_exp_f32 v76, v76
    v_exp_f32 v77, v77
    v_exp_f32 v78, v78
    v_exp_f32 v79, v79
    v_add_f32 v72, 1.0, v72
    v_add_f32 v73, 1.0, v73
    v_add_f32 v74, 1.0, v74
    v_add_f32 v75, 1.0, v75
    v_add_f32 v76, 1.0, v76
    v_add_f32 v77, 1.0, v77
    v_add_f32 v78, 1.0, v78
    v_add_f32 v79, 1.0, v79
    v_rcp_f32 v72, v72
    v_rcp_f32 v73, v73
    v_rcp_f32 v74, v74
    v_rcp_f32 v75, v75
    v_rcp_f32 v76, v76
    v_rcp_f32 v77, v77
    v_rcp_f32 v78, v78
    v_rcp_f32 v79, v79
    v_mul_f32 v64, v64, v72
    v_mul_f32 v65, v65, v73
    v_mul_f32 v66, v66, v74
    v_mul_f32 v67, v67, v75
    v_mul_f32 v68, v68, v76
    v_mul_f32 v69, v69, v77
    v_mul_f32 v70, v70, v78
    v_mul_f32 v71, v71, v79
    v_cvt_pk_bf16_f32 v80, v64, v65
    v_cvt_pk_bf16_f32 v81, v66, v67
    v_cvt_pk_bf16_f32 v82, v68, v69
    v_cvt_pk_bf16_f32 v83, v70, v71
    ds_write_b128 v43, v[80:83] offset:2048
    s_waitcnt lgkmcnt(1)
    v_mfma_f32_16x16x32_bf16 v[100:103], v[84:87], v[16:19], 0
    v_mfma_f32_16x16x32_bf16 v[104:107], v[92:95], v[16:19], 0
    v_mfma_f32_16x16x32_bf16 v[100:103], v[88:91], v[20:23], v[100:103]
    v_mfma_f32_16x16x32_bf16 v[104:107], v[96:99], v[20:23], v[104:107]
    s_nop 7
    v_mul_f32 v72, v100, v100
    v_mul_f32 v73, v101, v101
    v_mul_f32 v74, v102, v102
    v_mul_f32 v75, v103, v103
    v_mul_f32 v76, v104, v104
    v_mul_f32 v77, v105, v105
    v_mul_f32 v78, v106, v106
    v_mul_f32 v79, v107, v107
    v_fma_f32 v72, v72, s40, v44
    v_fma_f32 v73, v73, s40, v44
    v_fma_f32 v74, v74, s40, v44
    v_fma_f32 v75, v75, s40, v44
    v_fma_f32 v76, v76, s40, v44
    v_fma_f32 v77, v77, s40, v44
    v_fma_f32 v78, v78, s40, v44
    v_fma_f32 v79, v79, s40, v44
    v_mul_f32 v72, v72, v100
    v_mul_f32 v73, v73, v101
    v_mul_f32 v74, v74, v102
    v_mul_f32 v75, v75, v103
    v_mul_f32 v76, v76, v104
    v_mul_f32 v77, v77, v105
    v_mul_f32 v78, v78, v106
    v_mul_f32 v79, v79, v107
    v_exp_f32 v72, v72
    v_exp_f32 v73, v73
    v_exp_f32 v74, v74
    v_exp_f32 v75, v75
    v_exp_f32 v76, v76
    v_exp_f32 v77, v77
    v_exp_f32 v78, v78
    v_exp_f32 v79, v79
    v_add_f32 v72, 1.0, v72
    v_add_f32 v73, 1.0, v73
    v_add_f32 v74, 1.0, v74
    v_add_f32 v75, 1.0, v75
    v_add_f32 v76, 1.0, v76
    v_add_f32 v77, 1.0, v77
    v_add_f32 v78, 1.0, v78
    v_add_f32 v79, 1.0, v79
    v_rcp_f32 v72, v72
    v_rcp_f32 v73, v73
    v_rcp_f32 v74, v74
    v_rcp_f32 v75, v75
    v_rcp_f32 v76, v76
    v_rcp_f32 v77, v77
    v_rcp_f32 v78, v78
    v_rcp_f32 v79, v79
    v_mul_f32 v100, v100, v72
    v_mul_f32 v101, v101, v73
    v_mul_f32 v102, v102, v74
    v_mul_f32 v103, v103, v75
    v_mul_f32 v104, v104, v76
    v_mul_f32 v105, v105, v77
    v_mul_f32 v106, v106, v78
    v_mul_f32 v107, v107, v79
    v_cvt_pk_bf16_f32 v108, v100, v101
    v_cvt_pk_bf16_f32 v109, v102, v103
    v_cvt_pk_bf16_f32 v110, v104, v105
    v_cvt_pk_bf16_f32 v111, v106, v107
    ds_write_b128 v43, v[108:111] offset:2304
    s_waitcnt lgkmcnt(0)
    s_barrier
    v_and_b32 v46, 31, v1
    v_mul_u32_u24 v47, 528, v46
    v_lshrrev_b32 v45, 5, v1
    v_lshl_add_u32 v47, v45, 4, v47
    s_lshl_b32 s36, s21, 7
    s_add_u32 s36, s36, 115712
    v_add_u32 v6, s36, v47
    v_lshlrev_b32 v7, 6, v45
    s_lshl_b32 s36, s21, 8
    s_add_u32 s36, s36, 14336
    buffer_load_dwordx4 v[72:75], v7, s[12:15], s36 offen offset:0
    buffer_load_dwordx4 v[76:79], v7, s[12:15], s36 offen offset:16
    buffer_load_dwordx4 v[80:83], v7, s[12:15], s36 offen offset:32
    buffer_load_dwordx4 v[84:87], v7, s[12:15], s36 offen offset:48
    buffer_load_dwordx4 v[88:91], v7, s[12:15], s36 offen offset:128
    buffer_load_dwordx4 v[92:95], v7, s[12:15], s36 offen offset:144
    buffer_load_dwordx4 v[96:99], v7, s[12:15], s36 offen offset:160
    buffer_load_dwordx4 v[100:103], v7, s[12:15], s36 offen offset:176
    s_add_u32 s36, s38, 163840
    buffer_load_dwordx4 a[0:3], v5, s[12:15], s36 offen
    s_add_u32 s36, s38, 180224
    buffer_load_dwordx4 a[64:67], v5, s[12:15], s36 offen
    s_add_u32 s36, s38, 164864
    buffer_load_dwordx4 a[4:7], v5, s[12:15], s36 offen
    s_add_u32 s36, s38, 181248
    buffer_load_dwordx4 a[68:71], v5, s[12:15], s36 offen
    s_add_u32 s36, s38, 165888
    buffer_load_dwordx4 a[8:11], v5, s[12:15], s36 offen
    s_add_u32 s36, s38, 182272
    buffer_load_dwordx4 a[72:75], v5, s[12:15], s36 offen
    s_add_u32 s36, s38, 166912
    buffer_load_dwordx4 a[12:15], v5, s[12:15], s36 offen
    s_add_u32 s36, s38, 183296
    buffer_load_dwordx4 a[76:79], v5, s[12:15], s36 offen
    s_add_u32 s36, s38, 167936
    buffer_load_dwordx4 a[16:19], v5, s[12:15], s36 offen
    s_add_u32 s36, s38, 184320
    buffer_load_dwordx4 a[80:83], v5, s[12:15], s36 offen
    s_add_u32 s36, s38, 168960
    buffer_load_dwordx4 a[20:23], v5, s[12:15], s36 offen
    s_add_u32 s36, s38, 185344
    buffer_load_dwordx4 a[84:87], v5, s[12:15], s36 offen
    s_add_u32 s36, s38, 169984
    buffer_load_dwordx4 a[24:27], v5, s[12:15], s36 offen
    s_add_u32 s36, s38, 186368
    buffer_load_dwordx4 a[88:91], v5, s[12:15], s36 offen
    s_add_u32 s36, s38, 171008
    buffer_load_dwordx4 a[28:31], v5, s[12:15], s36 offen
    s_add_u32 s36, s38, 187392
    buffer_load_dwordx4 a[92:95], v5, s[12:15], s36 offen
    s_add_u32 s36, s38, 172032
    buffer_load_dwordx4 a[32:35], v5, s[12:15], s36 offen
    s_add_u32 s36, s38, 188416
    buffer_load_dwordx4 a[96:99], v5, s[12:15], s36 offen
    s_add_u32 s36, s38, 173056
    buffer_load_dwordx4 a[36:39], v5, s[12:15], s36 offen
    s_add_u32 s36, s38, 189440
    buffer_load_dwordx4 a[100:103], v5, s[12:15], s36 offen
    s_add_u32 s36, s38, 174080
    buffer_load_dwordx4 a[40:43], v5, s[12:15], s36 offen
    s_add_u32 s36, s38, 190464
    buffer_load_dwordx4 a[104:107], v5, s[12:15], s36 offen
    s_add_u32 s36, s38, 175104
    buffer_load_dwordx4 a[44:47], v5, s[12:15], s36 offen
    s_add_u32 s36, s38, 191488
    buffer_load_dwordx4 a[108:111], v5, s[12:15], s36 offen
    s_add_u32 s36, s38, 176128
    buffer_load_dwordx4 a[48:51], v5, s[12:15], s36 offen
    s_add_u32 s36, s38, 192512
    buffer_load_dwordx4 a[112:115], v5, s[12:15], s36 offen
    s_add_u32 s36, s38, 177152
    buffer_load_dwordx4 a[52:55], v5, s[12:15], s36 offen
    s_add_u32 s36, s38, 193536
    buffer_load_dwordx4 a[116:119], v5, s[12:15], s36 offen
    s_add_u32 s36, s38, 178176
    buffer_load_dwordx4 a[56:59], v5, s[12:15], s36 offen
    s_add_u32 s36, s38, 194560
    buffer_load_dwordx4 a[120:123], v5, s[12:15], s36 offen
    s_add_u32 s36, s38, 179200
    buffer_load_dwordx4 a[60:63], v5, s[12:15], s36 offen
    s_add_u32 s36, s38, 195584
    buffer_load_dwordx4 a[124:127], v5, s[12:15], s36 offen
    s_setprio 1
    s_barrier
    ds_read_b128 v[104:107], v5 offset:0
    ds_read_b128 v[108:111], v5 offset:1024
    ds_read_b128 v[112:115], v5 offset:2048
    s_waitcnt lgkmcnt(2)
    s_waitcnt vmcnt(30)
    v_mfma_f32_32x32x16_bf16 v[8:23], a[0:3], v[104:107], v[72:87]
    ds_read_b128 v[116:119], v5 offset:3072
    v_mfma_f32_32x32x16_bf16 v[24:39], a[64:67], v[104:107], v[88:103]
    s_waitcnt lgkmcnt(2)
    s_waitcnt vmcnt(28)
    v_mfma_f32_32x32x16_bf16 v[8:23], a[4:7], v[108:111], v[8:23]
    ds_read_b128 v[104:107], v5 offset:4096
    v_mfma_f32_32x32x16_bf16 v[24:39], a[68:71], v[108:111], v[24:39]
    s_waitcnt lgkmcnt(2)
    s_waitcnt vmcnt(26)
    v_mfma_f32_32x32x16_bf16 v[8:23], a[8:11], v[112:115], v[8:23]
    ds_read_b128 v[108:111], v5 offset:5120
    v_mfma_f32_32x32x16_bf16 v[24:39], a[72:75], v[112:115], v[24:39]
    s_waitcnt lgkmcnt(2)
    s_waitcnt vmcnt(24)
    v_mfma_f32_32x32x16_bf16 v[8:23], a[12:15], v[116:119], v[8:23]
    ds_read_b128 v[112:115], v5 offset:6144
    v_mfma_f32_32x32x16_bf16 v[24:39], a[76:79], v[116:119], v[24:39]
    s_waitcnt lgkmcnt(2)
    s_waitcnt vmcnt(22)
    v_mfma_f32_32x32x16_bf16 v[8:23], a[16:19], v[104:107], v[8:23]
    ds_read_b128 v[116:119], v5 offset:7168
    v_mfma_f32_32x32x16_bf16 v[24:39], a[80:83], v[104:107], v[24:39]
    s_waitcnt lgkmcnt(2)
    s_waitcnt vmcnt(20)
    v_mfma_f32_32x32x16_bf16 v[8:23], a[20:23], v[108:111], v[8:23]
    ds_read_b128 v[104:107], v5 offset:8192
    v_mfma_f32_32x32x16_bf16 v[24:39], a[84:87], v[108:111], v[24:39]
    s_waitcnt lgkmcnt(2)
    s_waitcnt vmcnt(18)
    v_mfma_f32_32x32x16_bf16 v[8:23], a[24:27], v[112:115], v[8:23]
    ds_read_b128 v[108:111], v5 offset:9216
    v_mfma_f32_32x32x16_bf16 v[24:39], a[88:91], v[112:115], v[24:39]
    s_waitcnt lgkmcnt(2)
    s_waitcnt vmcnt(16)
    v_mfma_f32_32x32x16_bf16 v[8:23], a[28:31], v[116:119], v[8:23]
    ds_read_b128 v[112:115], v5 offset:10240
    v_mfma_f32_32x32x16_bf16 v[24:39], a[92:95], v[116:119], v[24:39]
    s_waitcnt lgkmcnt(2)
    s_waitcnt vmcnt(14)
    v_mfma_f32_32x32x16_bf16 v[8:23], a[32:35], v[104:107], v[8:23]
    ds_read_b128 v[116:119], v5 offset:11264
    v_mfma_f32_32x32x16_bf16 v[24:39], a[96:99], v[104:107], v[24:39]
    s_waitcnt lgkmcnt(2)
    s_waitcnt vmcnt(12)
    v_mfma_f32_32x32x16_bf16 v[8:23], a[36:39], v[108:111], v[8:23]
    ds_read_b128 v[104:107], v5 offset:12288
    v_mfma_f32_32x32x16_bf16 v[24:39], a[100:103], v[108:111], v[24:39]
    s_waitcnt lgkmcnt(2)
    s_waitcnt vmcnt(10)
    v_mfma_f32_32x32x16_bf16 v[8:23], a[40:43], v[112:115], v[8:23]
    ds_read_b128 v[108:111], v5 offset:13312
    v_mfma_f32_32x32x16_bf16 v[24:39], a[104:107], v[112:115], v[24:39]
    s_waitcnt lgkmcnt(2)
    s_waitcnt vmcnt(8)
    v_mfma_f32_32x32x16_bf16 v[8:23], a[44:47], v[116:119], v[8:23]
    ds_read_b128 v[112:115], v5 offset:14336
    v_mfma_f32_32x32x16_bf16 v[24:39], a[108:111], v[116:119], v[24:39]
    s_waitcnt lgkmcnt(2)
    s_waitcnt vmcnt(6)
    v_mfma_f32_32x32x16_bf16 v[8:23], a[48:51], v[104:107], v[8:23]
    ds_read_b128 v[116:119], v5 offset:15360
    v_mfma_f32_32x32x16_bf16 v[24:39], a[112:115], v[104:107], v[24:39]
    s_waitcnt lgkmcnt(2)
    s_waitcnt vmcnt(4)
    v_mfma_f32_32x32x16_bf16 v[8:23], a[52:55], v[108:111], v[8:23]
    ds_read_b128 v[104:107], v5 offset:16384
    v_mfma_f32_32x32x16_bf16 v[24:39], a[116:119], v[108:111], v[24:39]
    s_waitcnt lgkmcnt(2)
    s_waitcnt vmcnt(2)
    v_mfma_f32_32x32x16_bf16 v[8:23], a[56:59], v[112:115], v[8:23]
    ds_read_b128 v[108:111], v5 offset:17408
    v_mfma_f32_32x32x16_bf16 v[24:39], a[120:123], v[112:115], v[24:39]
    s_waitcnt lgkmcnt(2)
    s_waitcnt vmcnt(0)
    v_mfma_f32_32x32x16_bf16 v[8:23], a[60:63], v[116:119], v[8:23]
    ds_read_b128 v[112:115], v5 offset:18432
    v_mfma_f32_32x32x16_bf16 v[24:39], a[124:127], v[116:119], v[24:39]
    s_barrier
    s_waitcnt lgkmcnt(2)
    v_mfma_f32_32x32x16_bf16 v[40:55], a[0:3], v[104:107], v[72:87]
    ds_read_b128 v[116:119], v5 offset:19456
    v_mfma_f32_32x32x16_bf16 v[56:71], a[64:67], v[104:107], v[88:103]
    s_waitcnt lgkmcnt(2)
    v_mfma_f32_32x32x16_bf16 v[40:55], a[4:7], v[108:111], v[40:55]
    ds_read_b128 v[104:107], v5 offset:20480
    v_mfma_f32_32x32x16_bf16 v[56:71], a[68:71], v[108:111], v[56:71]
    s_waitcnt lgkmcnt(2)
    v_mfma_f32_32x32x16_bf16 v[40:55], a[8:11], v[112:115], v[40:55]
    ds_read_b128 v[108:111], v5 offset:21504
    v_cvt_pk_bf16_f32 v120, v8, v9
    v_mfma_f32_32x32x16_bf16 v[56:71], a[72:75], v[112:115], v[56:71]
    v_cvt_pk_bf16_f32 v121, v10, v11
    s_waitcnt lgkmcnt(2)
    v_mfma_f32_32x32x16_bf16 v[40:55], a[12:15], v[116:119], v[40:55]
    ds_read_b128 v[112:115], v5 offset:22528
    v_cvt_pk_bf16_f32 v122, v12, v13
    v_mfma_f32_32x32x16_bf16 v[56:71], a[76:79], v[116:119], v[56:71]
    v_cvt_pk_bf16_f32 v123, v14, v15
    s_waitcnt lgkmcnt(2)
    v_mfma_f32_32x32x16_bf16 v[40:55], a[16:19], v[104:107], v[40:55]
    ds_read_b128 v[116:119], v5 offset:23552
    ds_write_b128 v6, v[120:123] offset:0
    v_mfma_f32_32x32x16_bf16 v[56:71], a[80:83], v[104:107], v[56:71]
    v_cvt_pk_bf16_f32 v124, v16, v17
    s_waitcnt lgkmcnt(3)
    v_mfma_f32_32x32x16_bf16 v[40:55], a[20:23], v[108:111], v[40:55]
    ds_read_b128 v[104:107], v5 offset:24576
    v_cvt_pk_bf16_f32 v125, v18, v19
    v_mfma_f32_32x32x16_bf16 v[56:71], a[84:87], v[108:111], v[56:71]
    v_cvt_pk_bf16_f32 v126, v20, v21
    s_waitcnt lgkmcnt(3)
    v_mfma_f32_32x32x16_bf16 v[40:55], a[24:27], v[112:115], v[40:55]
    ds_read_b128 v[108:111], v5 offset:25600
    v_cvt_pk_bf16_f32 v127, v22, v23
    v_mfma_f32_32x32x16_bf16 v[56:71], a[88:91], v[112:115], v[56:71]
    ds_write_b128 v6, v[124:127] offset:32
    s_waitcnt lgkmcnt(4)
    v_mfma_f32_32x32x16_bf16 v[40:55], a[28:31], v[116:119], v[40:55]
    ds_read_b128 v[112:115], v5 offset:26624
    v_cvt_pk_bf16_f32 v120, v24, v25
    v_mfma_f32_32x32x16_bf16 v[56:71], a[92:95], v[116:119], v[56:71]
    v_cvt_pk_bf16_f32 v121, v26, v27
    s_waitcnt lgkmcnt(3)
    v_mfma_f32_32x32x16_bf16 v[40:55], a[32:35], v[104:107], v[40:55]
    ds_read_b128 v[116:119], v5 offset:27648
    v_cvt_pk_bf16_f32 v122, v28, v29
    v_mfma_f32_32x32x16_bf16 v[56:71], a[96:99], v[104:107], v[56:71]
    v_cvt_pk_bf16_f32 v123, v30, v31
    s_waitcnt lgkmcnt(3)
    v_mfma_f32_32x32x16_bf16 v[40:55], a[36:39], v[108:111], v[40:55]
    ds_read_b128 v[104:107], v5 offset:28672
    ds_write_b128 v6, v[120:123] offset:64
    v_mfma_f32_32x32x16_bf16 v[56:71], a[100:103], v[108:111], v[56:71]
    v_cvt_pk_bf16_f32 v124, v32, v33
    s_waitcnt lgkmcnt(3)
    v_mfma_f32_32x32x16_bf16 v[40:55], a[40:43], v[112:115], v[40:55]
    ds_read_b128 v[108:111], v5 offset:29696
    v_cvt_pk_bf16_f32 v125, v34, v35
    v_mfma_f32_32x32x16_bf16 v[56:71], a[104:107], v[112:115], v[56:71]
    v_cvt_pk_bf16_f32 v126, v36, v37
    s_waitcnt lgkmcnt(3)
    v_mfma_f32_32x32x16_bf16 v[40:55], a[44:47], v[116:119], v[40:55]
    ds_read_b128 v[112:115], v5 offset:30720
    v_cvt_pk_bf16_f32 v127, v38, v39
    v_mfma_f32_32x32x16_bf16 v[56:71], a[108:111], v[116:119], v[56:71]
    ds_write_b128 v6, v[124:127] offset:96
    s_waitcnt lgkmcnt(4)
    v_mfma_f32_32x32x16_bf16 v[40:55], a[48:51], v[104:107], v[40:55]
    ds_read_b128 v[116:119], v5 offset:31744
    v_mfma_f32_32x32x16_bf16 v[56:71], a[112:115], v[104:107], v[56:71]
    s_waitcnt lgkmcnt(3)
    v_mfma_f32_32x32x16_bf16 v[40:55], a[52:55], v[108:111], v[40:55]
    ds_read_b128 v[104:107], v5 offset:32768
    v_mfma_f32_32x32x16_bf16 v[56:71], a[116:119], v[108:111], v[56:71]
    s_waitcnt lgkmcnt(3)
    v_mfma_f32_32x32x16_bf16 v[40:55], a[56:59], v[112:115], v[40:55]
    ds_read_b128 v[108:111], v5 offset:33792
    v_mfma_f32_32x32x16_bf16 v[56:71], a[120:123], v[112:115], v[56:71]
    s_waitcnt lgkmcnt(2)
    v_mfma_f32_32x32x16_bf16 v[40:55], a[60:63], v[116:119], v[40:55]
    ds_read_b128 v[112:115], v5 offset:34816
    v_mfma_f32_32x32x16_bf16 v[56:71], a[124:127], v[116:119], v[56:71]
    s_barrier
    s_waitcnt lgkmcnt(2)
    v_mfma_f32_32x32x16_bf16 v[8:23], a[0:3], v[104:107], v[72:87]
    ds_read_b128 v[116:119], v5 offset:35840
    v_mfma_f32_32x32x16_bf16 v[24:39], a[64:67], v[104:107], v[88:103]
    s_waitcnt lgkmcnt(2)
    v_mfma_f32_32x32x16_bf16 v[8:23], a[4:7], v[108:111], v[8:23]
    ds_read_b128 v[104:107], v5 offset:36864
    v_mfma_f32_32x32x16_bf16 v[24:39], a[68:71], v[108:111], v[24:39]
    s_waitcnt lgkmcnt(2)
    v_mfma_f32_32x32x16_bf16 v[8:23], a[8:11], v[112:115], v[8:23]
    ds_read_b128 v[108:111], v5 offset:37888
    v_cvt_pk_bf16_f32 v120, v40, v41
    v_mfma_f32_32x32x16_bf16 v[24:39], a[72:75], v[112:115], v[24:39]
    v_cvt_pk_bf16_f32 v121, v42, v43
    s_waitcnt lgkmcnt(2)
    v_mfma_f32_32x32x16_bf16 v[8:23], a[12:15], v[116:119], v[8:23]
    ds_read_b128 v[112:115], v5 offset:38912
    v_cvt_pk_bf16_f32 v122, v44, v45
    v_mfma_f32_32x32x16_bf16 v[24:39], a[76:79], v[116:119], v[24:39]
    v_cvt_pk_bf16_f32 v123, v46, v47
    s_waitcnt lgkmcnt(2)
    v_mfma_f32_32x32x16_bf16 v[8:23], a[16:19], v[104:107], v[8:23]
    ds_read_b128 v[116:119], v5 offset:39936
    ds_write_b128 v6, v[120:123] offset:16896
    v_mfma_f32_32x32x16_bf16 v[24:39], a[80:83], v[104:107], v[24:39]
    v_cvt_pk_bf16_f32 v124, v48, v49
    s_waitcnt lgkmcnt(3)
    v_mfma_f32_32x32x16_bf16 v[8:23], a[20:23], v[108:111], v[8:23]
    ds_read_b128 v[104:107], v5 offset:40960
    v_cvt_pk_bf16_f32 v125, v50, v51
    v_mfma_f32_32x32x16_bf16 v[24:39], a[84:87], v[108:111], v[24:39]
    v_cvt_pk_bf16_f32 v126, v52, v53
    s_waitcnt lgkmcnt(3)
    v_mfma_f32_32x32x16_bf16 v[8:23], a[24:27], v[112:115], v[8:23]
    ds_read_b128 v[108:111], v5 offset:41984
    v_cvt_pk_bf16_f32 v127, v54, v55
    v_mfma_f32_32x32x16_bf16 v[24:39], a[88:91], v[112:115], v[24:39]
    ds_write_b128 v6, v[124:127] offset:16928
    s_waitcnt lgkmcnt(4)
    v_mfma_f32_32x32x16_bf16 v[8:23], a[28:31], v[116:119], v[8:23]
    ds_read_b128 v[112:115], v5 offset:43008
    v_cvt_pk_bf16_f32 v120, v56, v57
    v_mfma_f32_32x32x16_bf16 v[24:39], a[92:95], v[116:119], v[24:39]
    v_cvt_pk_bf16_f32 v121, v58, v59
    s_waitcnt lgkmcnt(3)
    v_mfma_f32_32x32x16_bf16 v[8:23], a[32:35], v[104:107], v[8:23]
    ds_read_b128 v[116:119], v5 offset:44032
    v_cvt_pk_bf16_f32 v122, v60, v61
    v_mfma_f32_32x32x16_bf16 v[24:39], a[96:99], v[104:107], v[24:39]
    v_cvt_pk_bf16_f32 v123, v62, v63
    s_waitcnt lgkmcnt(3)
    v_mfma_f32_32x32x16_bf16 v[8:23], a[36:39], v[108:111], v[8:23]
    ds_read_b128 v[104:107], v5 offset:45056
    ds_write_b128 v6, v[120:123] offset:16960
    v_mfma_f32_32x32x16_bf16 v[24:39], a[100:103], v[108:111], v[24:39]
    v_cvt_pk_bf16_f32 v124, v64, v65
    s_waitcnt lgkmcnt(3)
    v_mfma_f32_32x32x16_bf16 v[8:23], a[40:43], v[112:115], v[8:23]
    ds_read_b128 v[108:111], v5 offset:46080
    v_cvt_pk_bf16_f32 v125, v66, v67
    v_mfma_f32_32x32x16_bf16 v[24:39], a[104:107], v[112:115], v[24:39]
    v_cvt_pk_bf16_f32 v126, v68, v69
    s_waitcnt lgkmcnt(3)
    v_mfma_f32_32x32x16_bf16 v[8:23], a[44:47], v[116:119], v[8:23]
    ds_read_b128 v[112:115], v5 offset:47104
    v_cvt_pk_bf16_f32 v127, v70, v71
    v_mfma_f32_32x32x16_bf16 v[24:39], a[108:111], v[116:119], v[24:39]
    ds_write_b128 v6, v[124:127] offset:16992
    s_waitcnt lgkmcnt(4)
    v_mfma_f32_32x32x16_bf16 v[8:23], a[48:51], v[104:107], v[8:23]
    ds_read_b128 v[116:119], v5 offset:48128
    v_mfma_f32_32x32x16_bf16 v[24:39], a[112:115], v[104:107], v[24:39]
    s_waitcnt lgkmcnt(3)
    v_mfma_f32_32x32x16_bf16 v[8:23], a[52:55], v[108:111], v[8:23]
    ds_read_b128 v[104:107], v5 offset:0
    v_mfma_f32_32x32x16_bf16 v[24:39], a[116:119], v[108:111], v[24:39]
    s_waitcnt lgkmcnt(3)
    v_mfma_f32_32x32x16_bf16 v[8:23], a[56:59], v[112:115], v[8:23]
    ds_read_b128 v[108:111], v5 offset:1024
    v_mfma_f32_32x32x16_bf16 v[24:39], a[120:123], v[112:115], v[24:39]
    s_waitcnt lgkmcnt(2)
    v_mfma_f32_32x32x16_bf16 v[8:23], a[60:63], v[116:119], v[8:23]
    ds_read_b128 v[112:115], v5 offset:2048
    v_mfma_f32_32x32x16_bf16 v[24:39], a[124:127], v[116:119], v[24:39]
    s_barrier
    s_waitcnt lgkmcnt(2)
    v_mfma_f32_32x32x16_bf16 v[40:55], a[0:3], v[104:107], v[72:87]
    ds_read_b128 v[116:119], v5 offset:3072
    v_mfma_f32_32x32x16_bf16 v[56:71], a[64:67], v[104:107], v[88:103]
    s_waitcnt lgkmcnt(2)
    v_mfma_f32_32x32x16_bf16 v[40:55], a[4:7], v[108:111], v[40:55]
    ds_read_b128 v[104:107], v5 offset:4096
    v_mfma_f32_32x32x16_bf16 v[56:71], a[68:71], v[108:111], v[56:71]
    s_waitcnt lgkmcnt(2)
    v_mfma_f32_32x32x16_bf16 v[40:55], a[8:11], v[112:115], v[40:55]
    ds_read_b128 v[108:111], v5 offset:5120
    v_cvt_pk_bf16_f32 v120, v8, v9
    v_mfma_f32_32x32x16_bf16 v[56:71], a[72:75], v[112:115], v[56:71]
    v_cvt_pk_bf16_f32 v121, v10, v11
    s_waitcnt lgkmcnt(2)
    v_mfma_f32_32x32x16_bf16 v[40:55], a[12:15], v[116:119], v[40:55]
    ds_read_b128 v[112:115], v5 offset:6144
    v_cvt_pk_bf16_f32 v122, v12, v13
    v_mfma_f32_32x32x16_bf16 v[56:71], a[76:79], v[116:119], v[56:71]
    v_cvt_pk_bf16_f32 v123, v14, v15
    s_waitcnt lgkmcnt(2)
    v_mfma_f32_32x32x16_bf16 v[40:55], a[16:19], v[104:107], v[40:55]
    ds_read_b128 v[116:119], v5 offset:7168
    ds_write_b128 v6, v[120:123] offset:0
    v_mfma_f32_32x32x16_bf16 v[56:71], a[80:83], v[104:107], v[56:71]
    v_cvt_pk_bf16_f32 v124, v16, v17
    s_waitcnt lgkmcnt(3)
    v_mfma_f32_32x32x16_bf16 v[40:55], a[20:23], v[108:111], v[40:55]
    ds_read_b128 v[104:107], v5 offset:8192
    v_cvt_pk_bf16_f32 v125, v18, v19
    v_mfma_f32_32x32x16_bf16 v[56:71], a[84:87], v[108:111], v[56:71]
    v_cvt_pk_bf16_f32 v126, v20, v21
    s_waitcnt lgkmcnt(3)
    v_mfma_f32_32x32x16_bf16 v[40:55], a[24:27], v[112:115], v[40:55]
    ds_read_b128 v[108:111], v5 offset:9216
    v_cvt_pk_bf16_f32 v127, v22, v23
    v_mfma_f32_32x32x16_bf16 v[56:71], a[88:91], v[112:115], v[56:71]
    ds_write_b128 v6, v[124:127] offset:32
    s_waitcnt lgkmcnt(4)
    v_mfma_f32_32x32x16_bf16 v[40:55], a[28:31], v[116:119], v[40:55]
    ds_read_b128 v[112:115], v5 offset:10240
    v_cvt_pk_bf16_f32 v120, v24, v25
    v_mfma_f32_32x32x16_bf16 v[56:71], a[92:95], v[116:119], v[56:71]
    v_cvt_pk_bf16_f32 v121, v26, v27
    s_waitcnt lgkmcnt(3)
    v_mfma_f32_32x32x16_bf16 v[40:55], a[32:35], v[104:107], v[40:55]
    ds_read_b128 v[116:119], v5 offset:11264
    v_cvt_pk_bf16_f32 v122, v28, v29
    v_mfma_f32_32x32x16_bf16 v[56:71], a[96:99], v[104:107], v[56:71]
    v_cvt_pk_bf16_f32 v123, v30, v31
    s_waitcnt lgkmcnt(3)
    v_mfma_f32_32x32x16_bf16 v[40:55], a[36:39], v[108:111], v[40:55]
    ds_read_b128 v[104:107], v5 offset:12288
    ds_write_b128 v6, v[120:123] offset:64
    v_mfma_f32_32x32x16_bf16 v[56:71], a[100:103], v[108:111], v[56:71]
    v_cvt_pk_bf16_f32 v124, v32, v33
    s_waitcnt lgkmcnt(3)
    v_mfma_f32_32x32x16_bf16 v[40:55], a[40:43], v[112:115], v[40:55]
    ds_read_b128 v[108:111], v5 offset:13312
    v_cvt_pk_bf16_f32 v125, v34, v35
    v_mfma_f32_32x32x16_bf16 v[56:71], a[104:107], v[112:115], v[56:71]
    v_cvt_pk_bf16_f32 v126, v36, v37
    s_waitcnt lgkmcnt(3)
    v_mfma_f32_32x32x16_bf16 v[40:55], a[44:47], v[116:119], v[40:55]
    ds_read_b128 v[112:115], v5 offset:14336
    v_cvt_pk_bf16_f32 v127, v38, v39
    v_mfma_f32_32x32x16_bf16 v[56:71], a[108:111], v[116:119], v[56:71]
    ds_write_b128 v6, v[124:127] offset:96
    s_waitcnt lgkmcnt(4)
    v_mfma_f32_32x32x16_bf16 v[40:55], a[48:51], v[104:107], v[40:55]
    ds_read_b128 v[116:119], v5 offset:15360
    v_mfma_f32_32x32x16_bf16 v[56:71], a[112:115], v[104:107], v[56:71]
    s_waitcnt lgkmcnt(3)
    v_mfma_f32_32x32x16_bf16 v[40:55], a[52:55], v[108:111], v[40:55]
    ds_read_b128 v[104:107], v5 offset:16384
    v_mfma_f32_32x32x16_bf16 v[56:71], a[116:119], v[108:111], v[56:71]
    s_waitcnt lgkmcnt(3)
    v_mfma_f32_32x32x16_bf16 v[40:55], a[56:59], v[112:115], v[40:55]
    ds_read_b128 v[108:111], v5 offset:17408
    v_mfma_f32_32x32x16_bf16 v[56:71], a[120:123], v[112:115], v[56:71]
    s_waitcnt lgkmcnt(2)
    v_mfma_f32_32x32x16_bf16 v[40:55], a[60:63], v[116:119], v[40:55]
    ds_read_b128 v[112:115], v5 offset:18432
    v_mfma_f32_32x32x16_bf16 v[56:71], a[124:127], v[116:119], v[56:71]
    s_barrier
    s_waitcnt lgkmcnt(2)
    v_mfma_f32_32x32x16_bf16 v[8:23], a[0:3], v[104:107], v[72:87]
    ds_read_b128 v[116:119], v5 offset:19456
    v_mfma_f32_32x32x16_bf16 v[24:39], a[64:67], v[104:107], v[88:103]
    s_waitcnt lgkmcnt(2)
    v_mfma_f32_32x32x16_bf16 v[8:23], a[4:7], v[108:111], v[8:23]
    ds_read_b128 v[104:107], v5 offset:20480
    v_mfma_f32_32x32x16_bf16 v[24:39], a[68:71], v[108:111], v[24:39]
    s_waitcnt lgkmcnt(2)
    v_mfma_f32_32x32x16_bf16 v[8:23], a[8:11], v[112:115], v[8:23]
    ds_read_b128 v[108:111], v5 offset:21504
    v_cvt_pk_bf16_f32 v120, v40, v41
    v_mfma_f32_32x32x16_bf16 v[24:39], a[72:75], v[112:115], v[24:39]
    v_cvt_pk_bf16_f32 v121, v42, v43
    s_waitcnt lgkmcnt(2)
    v_mfma_f32_32x32x16_bf16 v[8:23], a[12:15], v[116:119], v[8:23]
    ds_read_b128 v[112:115], v5 offset:22528
    v_cvt_pk_bf16_f32 v122, v44, v45
    v_mfma_f32_32x32x16_bf16 v[24:39], a[76:79], v[116:119], v[24:39]
    v_cvt_pk_bf16_f32 v123, v46, v47
    s_waitcnt lgkmcnt(2)
    v_mfma_f32_32x32x16_bf16 v[8:23], a[16:19], v[104:107], v[8:23]
    ds_read_b128 v[116:119], v5 offset:23552
    ds_write_b128 v6, v[120:123] offset:16896
    v_mfma_f32_32x32x16_bf16 v[24:39], a[80:83], v[104:107], v[24:39]
    v_cvt_pk_bf16_f32 v124, v48, v49
    s_waitcnt lgkmcnt(3)
    v_mfma_f32_32x32x16_bf16 v[8:23], a[20:23], v[108:111], v[8:23]
    ds_read_b128 v[104:107], v5 offset:24576
    v_cvt_pk_bf16_f32 v125, v50, v51
    v_mfma_f32_32x32x16_bf16 v[24:39], a[84:87], v[108:111], v[24:39]
    v_cvt_pk_bf16_f32 v126, v52, v53
    s_waitcnt lgkmcnt(3)
    v_mfma_f32_32x32x16_bf16 v[8:23], a[24:27], v[112:115], v[8:23]
    ds_read_b128 v[108:111], v5 offset:25600
    v_cvt_pk_bf16_f32 v127, v54, v55
    v_mfma_f32_32x32x16_bf16 v[24:39], a[88:91], v[112:115], v[24:39]
    ds_write_b128 v6, v[124:127] offset:16928
    s_waitcnt lgkmcnt(4)
    v_mfma_f32_32x32x16_bf16 v[8:23], a[28:31], v[116:119], v[8:23]
    ds_read_b128 v[112:115], v5 offset:26624
    v_cvt_pk_bf16_f32 v120, v56, v57
    v_mfma_f32_32x32x16_bf16 v[24:39], a[92:95], v[116:119], v[24:39]
    v_cvt_pk_bf16_f32 v121, v58, v59
    s_waitcnt lgkmcnt(3)
    v_mfma_f32_32x32x16_bf16 v[8:23], a[32:35], v[104:107], v[8:23]
    ds_read_b128 v[116:119], v5 offset:27648
    v_cvt_pk_bf16_f32 v122, v60, v61
    v_mfma_f32_32x32x16_bf16 v[24:39], a[96:99], v[104:107], v[24:39]
    v_cvt_pk_bf16_f32 v123, v62, v63
    s_waitcnt lgkmcnt(3)
    v_mfma_f32_32x32x16_bf16 v[8:23], a[36:39], v[108:111], v[8:23]
    ds_read_b128 v[104:107], v5 offset:28672
    ds_write_b128 v6, v[120:123] offset:16960
    v_mfma_f32_32x32x16_bf16 v[24:39], a[100:103], v[108:111], v[24:39]
    v_cvt_pk_bf16_f32 v124, v64, v65
    s_waitcnt lgkmcnt(3)
    v_mfma_f32_32x32x16_bf16 v[8:23], a[40:43], v[112:115], v[8:23]
    ds_read_b128 v[108:111], v5 offset:29696
    v_cvt_pk_bf16_f32 v125, v66, v67
    v_mfma_f32_32x32x16_bf16 v[24:39], a[104:107], v[112:115], v[24:39]
    v_cvt_pk_bf16_f32 v126, v68, v69
    s_waitcnt lgkmcnt(3)
    v_mfma_f32_32x32x16_bf16 v[8:23], a[44:47], v[116:119], v[8:23]
    ds_read_b128 v[112:115], v5 offset:30720
    v_cvt_pk_bf16_f32 v127, v70, v71
    v_mfma_f32_32x32x16_bf16 v[24:39], a[108:111], v[116:119], v[24:39]
    ds_write_b128 v6, v[124:127] offset:16992
    s_waitcnt lgkmcnt(4)
    v_mfma_f32_32x32x16_bf16 v[8:23], a[48:51], v[104:107], v[8:23]
    ds_read_b128 v[116:119], v5 offset:31744
    v_mfma_f32_32x32x16_bf16 v[24:39], a[112:115], v[104:107], v[24:39]
    s_waitcnt lgkmcnt(3)
    v_mfma_f32_32x32x16_bf16 v[8:23], a[52:55], v[108:111], v[8:23]
    ds_read_b128 v[104:107], v5 offset:32768
    v_mfma_f32_32x32x16_bf16 v[24:39], a[116:119], v[108:111], v[24:39]
    s_waitcnt lgkmcnt(3)
    v_mfma_f32_32x32x16_bf16 v[8:23], a[56:59], v[112:115], v[8:23]
    ds_read_b128 v[108:111], v5 offset:33792
    v_mfma_f32_32x32x16_bf16 v[24:39], a[120:123], v[112:115], v[24:39]
    s_waitcnt lgkmcnt(2)
    v_mfma_f32_32x32x16_bf16 v[8:23], a[60:63], v[116:119], v[8:23]
    ds_read_b128 v[112:115], v5 offset:34816
    v_mfma_f32_32x32x16_bf16 v[24:39], a[124:127], v[116:119], v[24:39]
    s_barrier
    s_waitcnt lgkmcnt(2)
    v_mfma_f32_32x32x16_bf16 v[40:55], a[0:3], v[104:107], v[72:87]
    ds_read_b128 v[116:119], v5 offset:35840
    v_mfma_f32_32x32x16_bf16 v[56:71], a[64:67], v[104:107], v[88:103]
    s_waitcnt lgkmcnt(2)
    v_mfma_f32_32x32x16_bf16 v[40:55], a[4:7], v[108:111], v[40:55]
    ds_read_b128 v[104:107], v5 offset:36864
    v_mfma_f32_32x32x16_bf16 v[56:71], a[68:71], v[108:111], v[56:71]
    s_waitcnt lgkmcnt(2)
    v_mfma_f32_32x32x16_bf16 v[40:55], a[8:11], v[112:115], v[40:55]
    ds_read_b128 v[108:111], v5 offset:37888
    v_cvt_pk_bf16_f32 v120, v8, v9
    v_mfma_f32_32x32x16_bf16 v[56:71], a[72:75], v[112:115], v[56:71]
    v_cvt_pk_bf16_f32 v121, v10, v11
    s_waitcnt lgkmcnt(2)
    v_mfma_f32_32x32x16_bf16 v[40:55], a[12:15], v[116:119], v[40:55]
    ds_read_b128 v[112:115], v5 offset:38912
    v_cvt_pk_bf16_f32 v122, v12, v13
    v_mfma_f32_32x32x16_bf16 v[56:71], a[76:79], v[116:119], v[56:71]
    v_cvt_pk_bf16_f32 v123, v14, v15
    s_waitcnt lgkmcnt(2)
    v_mfma_f32_32x32x16_bf16 v[40:55], a[16:19], v[104:107], v[40:55]
    ds_read_b128 v[116:119], v5 offset:39936
    ds_write_b128 v6, v[120:123] offset:0
    v_mfma_f32_32x32x16_bf16 v[56:71], a[80:83], v[104:107], v[56:71]
    v_cvt_pk_bf16_f32 v124, v16, v17
    s_waitcnt lgkmcnt(3)
    v_mfma_f32_32x32x16_bf16 v[40:55], a[20:23], v[108:111], v[40:55]
    ds_read_b128 v[104:107], v5 offset:40960
    v_cvt_pk_bf16_f32 v125, v18, v19
    v_mfma_f32_32x32x16_bf16 v[56:71], a[84:87], v[108:111], v[56:71]
    v_cvt_pk_bf16_f32 v126, v20, v21
    s_waitcnt lgkmcnt(3)
    v_mfma_f32_32x32x16_bf16 v[40:55], a[24:27], v[112:115], v[40:55]
    ds_read_b128 v[108:111], v5 offset:41984
    v_cvt_pk_bf16_f32 v127, v22, v23
    v_mfma_f32_32x32x16_bf16 v[56:71], a[88:91], v[112:115], v[56:71]
    ds_write_b128 v6, v[124:127] offset:32
    s_waitcnt lgkmcnt(4)
    v_mfma_f32_32x32x16_bf16 v[40:55], a[28:31], v[116:119], v[40:55]
    ds_read_b128 v[112:115], v5 offset:43008
    v_cvt_pk_bf16_f32 v120, v24, v25
    v_mfma_f32_32x32x16_bf16 v[56:71], a[92:95], v[116:119], v[56:71]
    v_cvt_pk_bf16_f32 v121, v26, v27
    s_waitcnt lgkmcnt(3)
    v_mfma_f32_32x32x16_bf16 v[40:55], a[32:35], v[104:107], v[40:55]
    ds_read_b128 v[116:119], v5 offset:44032
    v_cvt_pk_bf16_f32 v122, v28, v29
    v_mfma_f32_32x32x16_bf16 v[56:71], a[96:99], v[104:107], v[56:71]
    v_cvt_pk_bf16_f32 v123, v30, v31
    s_waitcnt lgkmcnt(3)
    v_mfma_f32_32x32x16_bf16 v[40:55], a[36:39], v[108:111], v[40:55]
    ds_read_b128 v[104:107], v5 offset:45056
    ds_write_b128 v6, v[120:123] offset:64
    v_mfma_f32_32x32x16_bf16 v[56:71], a[100:103], v[108:111], v[56:71]
    v_cvt_pk_bf16_f32 v124, v32, v33
    s_waitcnt lgkmcnt(3)
    v_mfma_f32_32x32x16_bf16 v[40:55], a[40:43], v[112:115], v[40:55]
    ds_read_b128 v[108:111], v5 offset:46080
    v_cvt_pk_bf16_f32 v125, v34, v35
    v_mfma_f32_32x32x16_bf16 v[56:71], a[104:107], v[112:115], v[56:71]
    v_cvt_pk_bf16_f32 v126, v36, v37
    s_waitcnt lgkmcnt(3)
    v_mfma_f32_32x32x16_bf16 v[40:55], a[44:47], v[116:119], v[40:55]
    ds_read_b128 v[112:115], v5 offset:47104
    v_cvt_pk_bf16_f32 v127, v38, v39
    v_mfma_f32_32x32x16_bf16 v[56:71], a[108:111], v[116:119], v[56:71]
    ds_write_b128 v6, v[124:127] offset:96
    s_waitcnt lgkmcnt(4)
    v_mfma_f32_32x32x16_bf16 v[40:55], a[48:51], v[104:107], v[40:55]
    ds_read_b128 v[116:119], v5 offset:48128
    v_mfma_f32_32x32x16_bf16 v[56:71], a[112:115], v[104:107], v[56:71]
    s_waitcnt lgkmcnt(3)
    v_mfma_f32_32x32x16_bf16 v[40:55], a[52:55], v[108:111], v[40:55]
    ds_read_b128 v[104:107], v5 offset:0
    v_mfma_f32_32x32x16_bf16 v[56:71], a[116:119], v[108:111], v[56:71]
    s_waitcnt lgkmcnt(3)
    v_mfma_f32_32x32x16_bf16 v[40:55], a[56:59], v[112:115], v[40:55]
    ds_read_b128 v[108:111], v5 offset:1024
    v_mfma_f32_32x32x16_bf16 v[56:71], a[120:123], v[112:115], v[56:71]
    s_waitcnt lgkmcnt(2)
    v_mfma_f32_32x32x16_bf16 v[40:55], a[60:63], v[116:119], v[40:55]
    ds_read_b128 v[112:115], v5 offset:2048
    v_mfma_f32_32x32x16_bf16 v[56:71], a[124:127], v[116:119], v[56:71]
    s_barrier
    s_waitcnt lgkmcnt(2)
    v_mfma_f32_32x32x16_bf16 v[8:23], a[0:3], v[104:107], v[72:87]
    ds_read_b128 v[116:119], v5 offset:3072
    v_mfma_f32_32x32x16_bf16 v[24:39], a[64:67], v[104:107], v[88:103]
    s_waitcnt lgkmcnt(2)
    v_mfma_f32_32x32x16_bf16 v[8:23], a[4:7], v[108:111], v[8:23]
    ds_read_b128 v[104:107], v5 offset:4096
    v_mfma_f32_32x32x16_bf16 v[24:39], a[68:71], v[108:111], v[24:39]
    s_waitcnt lgkmcnt(2)
    v_mfma_f32_32x32x16_bf16 v[8:23], a[8:11], v[112:115], v[8:23]
    ds_read_b128 v[108:111], v5 offset:5120
    v_cvt_pk_bf16_f32 v120, v40, v41
    v_mfma_f32_32x32x16_bf16 v[24:39], a[72:75], v[112:115], v[24:39]
    v_cvt_pk_bf16_f32 v121, v42, v43
    s_waitcnt lgkmcnt(2)
    v_mfma_f32_32x32x16_bf16 v[8:23], a[12:15], v[116:119], v[8:23]
    ds_read_b128 v[112:115], v5 offset:6144
    v_cvt_pk_bf16_f32 v122, v44, v45
    v_mfma_f32_32x32x16_bf16 v[24:39], a[76:79], v[116:119], v[24:39]
    v_cvt_pk_bf16_f32 v123, v46, v47
    s_waitcnt lgkmcnt(2)
    v_mfma_f32_32x32x16_bf16 v[8:23], a[16:19], v[104:107], v[8:23]
    ds_read_b128 v[116:119], v5 offset:7168
    ds_write_b128 v6, v[120:123] offset:16896
    v_mfma_f32_32x32x16_bf16 v[24:39], a[80:83], v[104:107], v[24:39]
    v_cvt_pk_bf16_f32 v124, v48, v49
    s_waitcnt lgkmcnt(3)
    v_mfma_f32_32x32x16_bf16 v[8:23], a[20:23], v[108:111], v[8:23]
    ds_read_b128 v[104:107], v5 offset:8192
    v_cvt_pk_bf16_f32 v125, v50, v51
    v_mfma_f32_32x32x16_bf16 v[24:39], a[84:87], v[108:111], v[24:39]
    v_cvt_pk_bf16_f32 v126, v52, v53
    s_waitcnt lgkmcnt(3)
    v_mfma_f32_32x32x16_bf16 v[8:23], a[24:27], v[112:115], v[8:23]
    ds_read_b128 v[108:111], v5 offset:9216
    v_cvt_pk_bf16_f32 v127, v54, v55
    v_mfma_f32_32x32x16_bf16 v[24:39], a[88:91], v[112:115], v[24:39]
    ds_write_b128 v6, v[124:127] offset:16928
    s_waitcnt lgkmcnt(4)
    v_mfma_f32_32x32x16_bf16 v[8:23], a[28:31], v[116:119], v[8:23]
    ds_read_b128 v[112:115], v5 offset:10240
    v_cvt_pk_bf16_f32 v120, v56, v57
    v_mfma_f32_32x32x16_bf16 v[24:39], a[92:95], v[116:119], v[24:39]
    v_cvt_pk_bf16_f32 v121, v58, v59
    s_waitcnt lgkmcnt(3)
    v_mfma_f32_32x32x16_bf16 v[8:23], a[32:35], v[104:107], v[8:23]
    ds_read_b128 v[116:119], v5 offset:11264
    v_cvt_pk_bf16_f32 v122, v60, v61
    v_mfma_f32_32x32x16_bf16 v[24:39], a[96:99], v[104:107], v[24:39]
    v_cvt_pk_bf16_f32 v123, v62, v63
    s_waitcnt lgkmcnt(3)
    v_mfma_f32_32x32x16_bf16 v[8:23], a[36:39], v[108:111], v[8:23]
    ds_read_b128 v[104:107], v5 offset:12288
    ds_write_b128 v6, v[120:123] offset:16960
    v_mfma_f32_32x32x16_bf16 v[24:39], a[100:103], v[108:111], v[24:39]
    v_cvt_pk_bf16_f32 v124, v64, v65
    s_waitcnt lgkmcnt(3)
    v_mfma_f32_32x32x16_bf16 v[8:23], a[40:43], v[112:115], v[8:23]
    ds_read_b128 v[108:111], v5 offset:13312
    v_cvt_pk_bf16_f32 v125, v66, v67
    v_mfma_f32_32x32x16_bf16 v[24:39], a[104:107], v[112:115], v[24:39]
    v_cvt_pk_bf16_f32 v126, v68, v69
    s_waitcnt lgkmcnt(3)
    v_mfma_f32_32x32x16_bf16 v[8:23], a[44:47], v[116:119], v[8:23]
    ds_read_b128 v[112:115], v5 offset:14336
    v_cvt_pk_bf16_f32 v127, v70, v71
    v_mfma_f32_32x32x16_bf16 v[24:39], a[108:111], v[116:119], v[24:39]
    ds_write_b128 v6, v[124:127] offset:16992
    s_waitcnt lgkmcnt(4)
    v_mfma_f32_32x32x16_bf16 v[8:23], a[48:51], v[104:107], v[8:23]
    ds_read_b128 v[116:119], v5 offset:15360
    v_mfma_f32_32x32x16_bf16 v[24:39], a[112:115], v[104:107], v[24:39]
    s_waitcnt lgkmcnt(3)
    v_mfma_f32_32x32x16_bf16 v[8:23], a[52:55], v[108:111], v[8:23]
    ds_read_b128 v[104:107], v5 offset:16384
    v_mfma_f32_32x32x16_bf16 v[24:39], a[116:119], v[108:111], v[24:39]
    s_waitcnt lgkmcnt(3)
    v_mfma_f32_32x32x16_bf16 v[8:23], a[56:59], v[112:115], v[8:23]
    ds_read_b128 v[108:111], v5 offset:17408
    v_mfma_f32_32x32x16_bf16 v[24:39], a[120:123], v[112:115], v[24:39]
    s_waitcnt lgkmcnt(2)
    v_mfma_f32_32x32x16_bf16 v[8:23], a[60:63], v[116:119], v[8:23]
    ds_read_b128 v[112:115], v5 offset:18432
    v_mfma_f32_32x32x16_bf16 v[24:39], a[124:127], v[116:119], v[24:39]
    s_barrier
    s_waitcnt lgkmcnt(2)
    v_mfma_f32_32x32x16_bf16 v[40:55], a[0:3], v[104:107], v[72:87]
    ds_read_b128 v[116:119], v5 offset:19456
    v_mfma_f32_32x32x16_bf16 v[56:71], a[64:67], v[104:107], v[88:103]
    s_waitcnt lgkmcnt(2)
    v_mfma_f32_32x32x16_bf16 v[40:55], a[4:7], v[108:111], v[40:55]
    ds_read_b128 v[104:107], v5 offset:20480
    v_mfma_f32_32x32x16_bf16 v[56:71], a[68:71], v[108:111], v[56:71]
    s_waitcnt lgkmcnt(2)
    v_mfma_f32_32x32x16_bf16 v[40:55], a[8:11], v[112:115], v[40:55]
    ds_read_b128 v[108:111], v5 offset:21504
    v_cvt_pk_bf16_f32 v120, v8, v9
    v_mfma_f32_32x32x16_bf16 v[56:71], a[72:75], v[112:115], v[56:71]
    v_cvt_pk_bf16_f32 v121, v10, v11
    s_waitcnt lgkmcnt(2)
    v_mfma_f32_32x32x16_bf16 v[40:55], a[12:15], v[116:119], v[40:55]
    ds_read_b128 v[112:115], v5 offset:22528
    v_cvt_pk_bf16_f32 v122, v12, v13
    v_mfma_f32_32x32x16_bf16 v[56:71], a[76:79], v[116:119], v[56:71]
    v_cvt_pk_bf16_f32 v123, v14, v15
    s_waitcnt lgkmcnt(2)
    v_mfma_f32_32x32x16_bf16 v[40:55], a[16:19], v[104:107], v[40:55]
    ds_read_b128 v[116:119], v5 offset:23552
    ds_write_b128 v6, v[120:123] offset:0
    v_mfma_f32_32x32x16_bf16 v[56:71], a[80:83], v[104:107], v[56:71]
    v_cvt_pk_bf16_f32 v124, v16, v17
    s_waitcnt lgkmcnt(3)
    v_mfma_f32_32x32x16_bf16 v[40:55], a[20:23], v[108:111], v[40:55]
    ds_read_b128 v[104:107], v5 offset:24576
    v_cvt_pk_bf16_f32 v125, v18, v19
    v_mfma_f32_32x32x16_bf16 v[56:71], a[84:87], v[108:111], v[56:71]
    v_cvt_pk_bf16_f32 v126, v20, v21
    s_waitcnt lgkmcnt(3)
    v_mfma_f32_32x32x16_bf16 v[40:55], a[24:27], v[112:115], v[40:55]
    ds_read_b128 v[108:111], v5 offset:25600
    v_cvt_pk_bf16_f32 v127, v22, v23
    v_mfma_f32_32x32x16_bf16 v[56:71], a[88:91], v[112:115], v[56:71]
    ds_write_b128 v6, v[124:127] offset:32
    s_waitcnt lgkmcnt(4)
    v_mfma_f32_32x32x16_bf16 v[40:55], a[28:31], v[116:119], v[40:55]
    ds_read_b128 v[112:115], v5 offset:26624
    v_cvt_pk_bf16_f32 v120, v24, v25
    v_mfma_f32_32x32x16_bf16 v[56:71], a[92:95], v[116:119], v[56:71]
    v_cvt_pk_bf16_f32 v121, v26, v27
    s_waitcnt lgkmcnt(3)
    v_mfma_f32_32x32x16_bf16 v[40:55], a[32:35], v[104:107], v[40:55]
    ds_read_b128 v[116:119], v5 offset:27648
    v_cvt_pk_bf16_f32 v122, v28, v29
    v_mfma_f32_32x32x16_bf16 v[56:71], a[96:99], v[104:107], v[56:71]
    v_cvt_pk_bf16_f32 v123, v30, v31
    s_waitcnt lgkmcnt(3)
    v_mfma_f32_32x32x16_bf16 v[40:55], a[36:39], v[108:111], v[40:55]
    ds_read_b128 v[104:107], v5 offset:28672
    ds_write_b128 v6, v[120:123] offset:64
    v_mfma_f32_32x32x16_bf16 v[56:71], a[100:103], v[108:111], v[56:71]
    v_cvt_pk_bf16_f32 v124, v32, v33
    s_waitcnt lgkmcnt(3)
    v_mfma_f32_32x32x16_bf16 v[40:55], a[40:43], v[112:115], v[40:55]
    ds_read_b128 v[108:111], v5 offset:29696
    v_cvt_pk_bf16_f32 v125, v34, v35
    v_mfma_f32_32x32x16_bf16 v[56:71], a[104:107], v[112:115], v[56:71]
    v_cvt_pk_bf16_f32 v126, v36, v37
    s_waitcnt lgkmcnt(3)
    v_mfma_f32_32x32x16_bf16 v[40:55], a[44:47], v[116:119], v[40:55]
    ds_read_b128 v[112:115], v5 offset:30720
    v_cvt_pk_bf16_f32 v127, v38, v39
    v_mfma_f32_32x32x16_bf16 v[56:71], a[108:111], v[116:119], v[56:71]
    ds_write_b128 v6, v[124:127] offset:96
    s_waitcnt lgkmcnt(4)
    v_mfma_f32_32x32x16_bf16 v[40:55], a[48:51], v[104:107], v[40:55]
    ds_read_b128 v[116:119], v5 offset:31744
    v_mfma_f32_32x32x16_bf16 v[56:71], a[112:115], v[104:107], v[56:71]
    s_waitcnt lgkmcnt(3)
    v_mfma_f32_32x32x16_bf16 v[40:55], a[52:55], v[108:111], v[40:55]
    v_mfma_f32_32x32x16_bf16 v[56:71], a[116:119], v[108:111], v[56:71]
    s_waitcnt lgkmcnt(2)
    v_mfma_f32_32x32x16_bf16 v[40:55], a[56:59], v[112:115], v[40:55]
    v_mfma_f32_32x32x16_bf16 v[56:71], a[120:123], v[112:115], v[56:71]
    s_waitcnt lgkmcnt(0)
    v_mfma_f32_32x32x16_bf16 v[40:55], a[60:63], v[116:119], v[40:55]
    v_mfma_f32_32x32x16_bf16 v[56:71], a[124:127], v[116:119], v[56:71]
    s_barrier
    s_nop 7
    s_nop 7
    v_cvt_pk_bf16_f32 v120, v40, v41
    v_cvt_pk_bf16_f32 v121, v42, v43
    v_cvt_pk_bf16_f32 v122, v44, v45
    v_cvt_pk_bf16_f32 v123, v46, v47
    ds_write_b128 v6, v[120:123] offset:16896
    v_cvt_pk_bf16_f32 v124, v48, v49
    v_cvt_pk_bf16_f32 v125, v50, v51
    v_cvt_pk_bf16_f32 v126, v52, v53
    v_cvt_pk_bf16_f32 v127, v54, v55
    ds_write_b128 v6, v[124:127] offset:16928
    v_cvt_pk_bf16_f32 v120, v56, v57
    v_cvt_pk_bf16_f32 v121, v58, v59
    v_cvt_pk_bf16_f32 v122, v60, v61
    v_cvt_pk_bf16_f32 v123, v62, v63
    ds_write_b128 v6, v[120:123] offset:16960
    v_cvt_pk_bf16_f32 v124, v64, v65
    v_cvt_pk_bf16_f32 v125, v66, v67
    v_cvt_pk_bf16_f32 v126, v68, v69
    v_cvt_pk_bf16_f32 v127, v70, v71
    ds_write_b128 v6, v[124:127] offset:16992
    s_waitcnt lgkmcnt(0)
    s_barrier
    s_endpgm
L_joint_kernel_helper:
    s_barrier
    v_add_u32 v7, 65536, v5
    ds_read_b128 v[64:67], v7 offset:0
    ds_read_b128 v[68:71], v7 offset:1024
    ds_read_b128 v[72:75], v7 offset:2048
    ds_read_b128 v[76:79], v7 offset:3072
    ds_read_b128 v[80:83], v7 offset:4096
    ds_read_b128 v[84:87], v7 offset:5120
    ds_read_b128 v[88:91], v7 offset:6144
    ds_read_b128 v[92:95], v7 offset:7168
    s_waitcnt vmcnt(38) lgkmcnt(7)
    v_mfma_f32_32x32x16_bf16 v[32:47], a[0:3], v[64:67], 0
    v_mfma_f32_32x32x16_bf16 v[48:63], a[64:67], v[64:67], 0
    s_waitcnt vmcnt(36) lgkmcnt(6)
    v_mfma_f32_32x32x16_bf16 v[32:47], a[4:7], v[68:71], v[32:47]
    v_mfma_f32_32x32x16_bf16 v[48:63], a[68:71], v[68:71], v[48:63]
    ds_read_b128 v[64:67], v7 offset:8192
    s_waitcnt vmcnt(34) lgkmcnt(6)
    v_mfma_f32_32x32x16_bf16 v[32:47], a[8:11], v[72:75], v[32:47]
    v_mfma_f32_32x32x16_bf16 v[48:63], a[72:75], v[72:75], v[48:63]
    ds_read_b128 v[68:71], v7 offset:9216
    s_waitcnt vmcnt(32) lgkmcnt(6)
    v_mfma_f32_32x32x16_bf16 v[32:47], a[12:15], v[76:79], v[32:47]
    v_mfma_f32_32x32x16_bf16 v[48:63], a[76:79], v[76:79], v[48:63]
    ds_read_b128 v[72:75], v7 offset:10240
    s_waitcnt vmcnt(30) lgkmcnt(6)
    v_mfma_f32_32x32x16_bf16 v[32:47], a[16:19], v[80:83], v[32:47]
    v_mfma_f32_32x32x16_bf16 v[48:63], a[80:83], v[80:83], v[48:63]
    ds_read_b128 v[76:79], v7 offset:11264
    s_waitcnt vmcnt(28) lgkmcnt(6)
    v_mfma_f32_32x32x16_bf16 v[32:47], a[20:23], v[84:87], v[32:47]
    v_mfma_f32_32x32x16_bf16 v[48:63], a[84:87], v[84:87], v[48:63]
    ds_read_b128 v[80:83], v7 offset:12288
    s_waitcnt vmcnt(26) lgkmcnt(6)
    v_mfma_f32_32x32x16_bf16 v[32:47], a[24:27], v[88:91], v[32:47]
    v_mfma_f32_32x32x16_bf16 v[48:63], a[88:91], v[88:91], v[48:63]
    ds_read_b128 v[84:87], v7 offset:13312
    s_waitcnt vmcnt(24) lgkmcnt(6)
    v_mfma_f32_32x32x16_bf16 v[32:47], a[28:31], v[92:95], v[32:47]
    v_mfma_f32_32x32x16_bf16 v[48:63], a[92:95], v[92:95], v[48:63]
    ds_read_b128 v[88:91], v7 offset:14336
    s_waitcnt vmcnt(22) lgkmcnt(6)
    v_mfma_f32_32x32x16_bf16 v[32:47], a[32:35], v[64:67], v[32:47]
    v_mfma_f32_32x32x16_bf16 v[48:63], a[96:99], v[64:67], v[48:63]
    ds_read_b128 v[92:95], v7 offset:15360
    s_waitcnt vmcnt(20) lgkmcnt(6)
    v_mfma_f32_32x32x16_bf16 v[32:47], a[36:39], v[68:71], v[32:47]
    v_mfma_f32_32x32x16_bf16 v[48:63], a[100:103], v[68:71], v[48:63]
    s_waitcnt vmcnt(0)
    v_max3_f32 v8, |v96|, |v97|, |v98|
    v_max3_f32 v8, v8, |v99|, |v100|
    v_max3_f32 v8, v8, |v101|, |v102|
    v_max3_f32 v8, v8, |v103|, |v104|
    v_max3_f32 v8, v8, |v105|, |v106|
    v_max3_f32 v8, v8, |v107|, |v108|
    v_max3_f32 v8, v8, |v109|, |v110|
    v_max3_f32 v8, v8, |v111|, |v112|
    s_waitcnt lgkmcnt(5)
    v_mfma_f32_32x32x16_bf16 v[32:47], a[40:43], v[72:75], v[32:47]
    v_mfma_f32_32x32x16_bf16 v[48:63], a[104:107], v[72:75], v[48:63]
    v_max3_f32 v8, v8, |v113|, |v114|
    v_max3_f32 v8, v8, |v115|, |v116|
    v_max3_f32 v8, v8, |v117|, |v118|
    v_max3_f32 v8, v8, |v119|, |v120|
    v_max3_f32 v8, v8, |v121|, |v122|
    v_max3_f32 v8, v8, |v123|, |v124|
    v_max3_f32 v8, v8, |v125|, |v126|
    v_max_f32 v8, v8, |v127|
    s_waitcnt lgkmcnt(4)
    v_mfma_f32_32x32x16_bf16 v[32:47], a[44:47], v[76:79], v[32:47]
    v_mfma_f32_32x32x16_bf16 v[48:63], a[108:111], v[76:79], v[48:63]
    s_mov_b32 s41, 0x42a80000
    v_cmp_lt_f32 s[42:43], s41, v8
    v_exp_f32 v96, v96
    v_exp_f32 v97, v97
    v_exp_f32 v98, v98
    v_exp_f32 v99, v99
    v_exp_f32 v100, v100
    v_exp_f32 v101, v101
    s_waitcnt lgkmcnt(3)
    v_mfma_f32_32x32x16_bf16 v[32:47], a[48:51], v[80:83], v[32:47]
    v_mfma_f32_32x32x16_bf16 v[48:63], a[112:115], v[80:83], v[48:63]
    v_exp_f32 v102, v102
    v_exp_f32 v103, v103
    v_exp_f32 v104, v104
    v_exp_f32 v105, v105
    v_exp_f32 v106, v106
    v_exp_f32 v107, v107
    v_exp_f32 v108, v108
    v_exp_f32 v109, v109
    s_waitcnt lgkmcnt(2)
    v_mfma_f32_32x32x16_bf16 v[32:47], a[52:55], v[84:87], v[32:47]
    v_mfma_f32_32x32x16_bf16 v[48:63], a[116:119], v[84:87], v[48:63]
    v_exp_f32 v110, v110
    v_exp_f32 v111, v111
    v_exp_f32 v112, v112
    v_exp_f32 v113, v113
    v_exp_f32 v114, v114
    v_exp_f32 v115, v115
    v_exp_f32 v116, v116
    v_exp_f32 v117, v117
    s_waitcnt lgkmcnt(1)
    v_mfma_f32_32x32x16_bf16 v[32:47], a[56:59], v[88:91], v[32:47]
    v_mfma_f32_32x32x16_bf16 v[48:63], a[120:123], v[88:91], v[48:63]
    v_exp_f32 v118, v118
    v_exp_f32 v119, v119
    v_exp_f32 v120, v120
    v_exp_f32 v121, v121
    v_exp_f32 v122, v122
    v_exp_f32 v123, v123
    v_exp_f32 v124, v124
    v_exp_f32 v125, v125
    s_waitcnt lgkmcnt(0)
    v_mfma_f32_32x32x16_bf16 v[32:47], a[60:63], v[92:95], v[32:47]
    v_mfma_f32_32x32x16_bf16 v[48:63], a[124:127], v[92:95], v[48:63]
    v_exp_f32 v126, v126
    v_exp_f32 v127, v127
    s_lshl_b32 s36, s21, 12
    v_add_u32 v2, s36, v5
    v_lshrrev_b32 v10, 5, v1
    v_lshlrev_b32 v11, 4, v10
    s_lshl_b32 s36, s21, 8
    s_add_u32 s36, s36, 81920
    v_add_u32 v11, s36, v11
    v_and_b32 v12, 31, v1
    v_mul_u32_u24 v13, 1056, v12
    v_add_u32 v9, v11, v13
    v_lshrrev_b32 v13, 3, v12
    v_mul_u32_u24 v13, 1056, v13
    v_add_u32 v4, v11, v13
    s_lshl_b32 s36, s21, 3
    v_add_u32 v10, s36, v10
    v_mul_u32_u24 v13, 528, v10
    v_lshl_add_u32 v13, v12, 4, v13
    v_add_u32 v6, 115712, v13
    v_lshlrev_b32 v13, 9, v10
    v_lshl_add_u32 v7, v12, 4, v13
    s_mov_b32 s41, 0x4038aa3b
    v_mul_f32 v64, s41, v32
    v_mul_f32 v65, s41, v33
    v_mul_f32 v66, s41, v34
    v_mul_f32 v67, s41, v35
    v_mul_f32 v68, s41, v36
    v_mul_f32 v69, s41, v37
    v_mul_f32 v70, s41, v38
    v_mul_f32 v71, s41, v39
    v_mul_f32 v72, s41, v40
    v_mul_f32 v73, s41, v41
    v_mul_f32 v74, s41, v42
    v_mul_f32 v75, s41, v43
    v_mul_f32 v76, s41, v44
    v_mul_f32 v77, s41, v45
    v_mul_f32 v78, s41, v46
    v_mul_f32 v79, s41, v47
    v_mul_f32 v80, s41, v48
    v_mul_f32 v81, s41, v49
    v_mul_f32 v82, s41, v50
    v_mul_f32 v83, s41, v51
    v_mul_f32 v84, s41, v52
    v_mul_f32 v85, s41, v53
    v_mul_f32 v86, s41, v54
    v_mul_f32 v87, s41, v55
    v_mul_f32 v88, s41, v56
    v_mul_f32 v89, s41, v57
    v_mul_f32 v90, s41, v58
    v_mul_f32 v91, s41, v59
    v_mul_f32 v92, s41, v60
    v_mul_f32 v93, s41, v61
    v_mul_f32 v94, s41, v62
    v_mul_f32 v95, s41, v63
    v_max3_f32 v8, |v64|, |v65|, |v66|
    v_max3_f32 v8, v8, |v67|, |v68|
    v_max3_f32 v8, v8, |v69|, |v70|
    v_max3_f32 v8, v8, |v71|, |v72|
    v_max3_f32 v8, v8, |v73|, |v74|
    v_max3_f32 v8, v8, |v75|, |v76|
    v_max3_f32 v8, v8, |v77|, |v78|
    v_max3_f32 v8, v8, |v79|, |v80|
    v_max3_f32 v8, v8, |v81|, |v82|
    v_max3_f32 v8, v8, |v83|, |v84|
    v_max3_f32 v8, v8, |v85|, |v86|
    v_max3_f32 v8, v8, |v87|, |v88|
    v_max3_f32 v8, v8, |v89|, |v90|
    v_max3_f32 v8, v8, |v91|, |v92|
    v_max3_f32 v8, v8, |v93|, |v94|
    v_max_f32 v8, v8, |v95|
    s_mov_b32 s41, 0x42200000
    v_cmp_lt_f32 vcc, s41, v8
    s_nop 3
    s_or_b64 s[42:43], s[42:43], vcc
    s_cmp_lg_u64 s[42:43], 0
    s_cselect_b32 s44, 1, 0
    s_cmp_lg_u32 s44, 0
    s_cbranch_scc1 L_joint_kernel_slow
    v_exp_f32 v32, v64
    v_exp_f32 v33, v65
    v_exp_f32 v34, v66
    v_exp_f32 v35, v67
    v_exp_f32 v36, v68
    v_exp_f32 v37, v69
    v_exp_f32 v38, v70
    v_exp_f32 v39, v71
    v_exp_f32 v40, v72
    v_exp_f32 v41, v73
    v_exp_f32 v42, v74
    v_exp_f32 v43, v75
    v_exp_f32 v44, v76
    v_exp_f32 v45, v77
    v_exp_f32 v46, v78
    v_exp_f32 v47, v79
    v_exp_f32 v48, v80
    v_exp_f32 v49, v81
    v_exp_f32 v50, v82
    v_exp_f32 v51, v83
    v_exp_f32 v52, v84
    v_exp_f32 v53, v85
    v_exp_f32 v54, v86
    v_exp_f32 v55, v87
    v_exp_f32 v56, v88
    v_exp_f32 v57, v89
    v_exp_f32 v58, v90
    v_exp_f32 v59, v91
    v_exp_f32 v60, v92
    v_exp_f32 v61, v93
    v_exp_f32 v62, v94
    v_exp_f32 v63, v95
    ds_write_b128 v9, v[32:35] offset:0
    ds_write_b128 v9, v[36:39] offset:32
    ds_write_b128 v9, v[40:43] offset:64
    ds_write_b128 v9, v[44:47] offset:96
    ds_write_b128 v9, v[48:51] offset:128
    ds_write_b128 v9, v[52:55] offset:160
    ds_write_b128 v9, v[56:59] offset:192
    ds_write_b128 v9, v[60:63] offset:224
    s_waitcnt lgkmcnt(0)
    ds_read_b128 v[32:35], v4 offset:0
    ds_read_b128 v[36:39], v4 offset:32
    ds_read_b128 v[40:43], v4 offset:64
    ds_read_b128 v[44:47], v4 offset:96
    ds_read_b128 v[48:51], v4 offset:128
    ds_read_b128 v[52:55], v4 offset:160
    ds_read_b128 v[56:59], v4 offset:192
    ds_read_b128 v[60:63], v4 offset:224
    s_waitcnt lgkmcnt(6)
    v_fma_f32 v64, v32, v96, 1.0
    v_fma_f32 v65, v33, v97, 1.0
    v_fma_f32 v66, v34, v98, 1.0
    v_fma_f32 v67, v35, v99, 1.0
    v_fma_f32 v68, v36, v100, 1.0
    v_fma_f32 v69, v37, v101, 1.0
    v_fma_f32 v70, v38, v102, 1.0
    v_fma_f32 v71, v39, v103, 1.0
    ds_read_b128 v[32:35], v4 offset:4224
    ds_read_b128 v[36:39], v4 offset:4256
    v_rcp_f32 v64, v64
    v_rcp_f32 v65, v65
    v_rcp_f32 v66, v66
    v_rcp_f32 v67, v67
    v_rcp_f32 v68, v68
    v_rcp_f32 v69, v69
    v_rcp_f32 v70, v70
    v_rcp_f32 v71, v71
    s_nop 0
    v_cvt_pk_bf16_f32 v80, v64, v65
    v_cvt_pk_bf16_f32 v81, v66, v67
    v_cvt_pk_bf16_f32 v82, v68, v69
    v_cvt_pk_bf16_f32 v83, v70, v71
    ds_write_b128 v2, v[80:83] offset:0
    s_waitcnt lgkmcnt(7)
    v_fma_f32 v72, v40, v104, 1.0
    v_fma_f32 v73, v41, v105, 1.0
    v_fma_f32 v74, v42, v106, 1.0
    v_fma_f32 v75, v43, v107, 1.0
    v_fma_f32 v76, v44, v108, 1.0
    v_fma_f32 v77, v45, v109, 1.0
    v_fma_f32 v78, v46, v110, 1.0
    v_fma_f32 v79, v47, v111, 1.0
    ds_read_b128 v[40:43], v4 offset:4288
    ds_read_b128 v[44:47], v4 offset:4320
    v_rcp_f32 v72, v72
    v_rcp_f32 v73, v73
    v_rcp_f32 v74, v74
    v_rcp_f32 v75, v75
    v_rcp_f32 v76, v76
    v_rcp_f32 v77, v77
    v_rcp_f32 v78, v78
    v_rcp_f32 v79, v79
    s_nop 0
    v_cvt_pk_bf16_f32 v84, v72, v73
    v_cvt_pk_bf16_f32 v85, v74, v75
    v_cvt_pk_bf16_f32 v86, v76, v77
    v_cvt_pk_bf16_f32 v87, v78, v79
    ds_write_b128 v2, v[84:87] offset:1024
    s_waitcnt lgkmcnt(8)
    v_fma_f32 v64, v48, v112, 1.0
    v_fma_f32 v65, v49, v113, 1.0
    v_fma_f32 v66, v50, v114, 1.0
    v_fma_f32 v67, v51, v115, 1.0
    v_fma_f32 v68, v52, v116, 1.0
    v_fma_f32 v69, v53, v117, 1.0
    v_fma_f32 v70, v54, v118, 1.0
    v_fma_f32 v71, v55, v119, 1.0
    ds_read_b128 v[48:51], v4 offset:4352
    ds_read_b128 v[52:55], v4 offset:4384
    v_rcp_f32 v64, v64
    v_rcp_f32 v65, v65
    v_rcp_f32 v66, v66
    v_rcp_f32 v67, v67
    v_rcp_f32 v68, v68
    v_rcp_f32 v69, v69
    v_rcp_f32 v70, v70
    v_rcp_f32 v71, v71
    s_nop 0
    v_cvt_pk_bf16_f32 v80, v64, v65
    v_cvt_pk_bf16_f32 v81, v66, v67
    v_cvt_pk_bf16_f32 v82, v68, v69
    v_cvt_pk_bf16_f32 v83, v70, v71
    ds_write_b128 v2, v[80:83] offset:2048
    s_waitcnt lgkmcnt(9)
    v_fma_f32 v72, v56, v120, 1.0
    v_fma_f32 v73, v57, v121, 1.0
    v_fma_f32 v74, v58, v122, 1.0
    v_fma_f32 v75, v59, v123, 1.0
    v_fma_f32 v76, v60, v124, 1.0
    v_fma_f32 v77, v61, v125, 1.0
    v_fma_f32 v78, v62, v126, 1.0
    v_fma_f32 v79, v63, v127, 1.0
    ds_read_b128 v[56:59], v4 offset:4416
    ds_read_b128 v[60:63], v4 offset:4448
    v_rcp_f32 v72, v72
    v_rcp_f32 v73, v73
    v_rcp_f32 v74, v74
    v_rcp_f32 v75, v75
    v_rcp_f32 v76, v76
    v_rcp_f32 v77, v77
    v_rcp_f32 v78, v78
    v_rcp_f32 v79, v79
    s_nop 0
    v_cvt_pk_bf16_f32 v84, v72, v73
    v_cvt_pk_bf16_f32 v85, v74, v75
    v_cvt_pk_bf16_f32 v86, v76, v77
    v_cvt_pk_bf16_f32 v87, v78, v79
    ds_write_b128 v2, v[84:87] offset:3072
    s_waitcnt lgkmcnt(10)
    v_fma_f32 v64, v32, v96, 1.0
    v_fma_f32 v65, v33, v97, 1.0
    v_fma_f32 v66, v34, v98, 1.0
    v_fma_f32 v67, v35, v99, 1.0
    v_fma_f32 v68, v36, v100, 1.0
    v_fma_f32 v69, v37, v101, 1.0
    v_fma_f32 v70, v38, v102, 1.0
    v_fma_f32 v71, v39, v103, 1.0
    ds_read_b128 v[32:35], v4 offset:8448
    ds_read_b128 v[36:39], v4 offset:8480
    v_rcp_f32 v64, v64
    v_rcp_f32 v65, v65
    v_rcp_f32 v66, v66
    v_rcp_f32 v67, v67
    v_rcp_f32 v68, v68
    v_rcp_f32 v69, v69
    v_rcp_f32 v70, v70
    v_rcp_f32 v71, v71
    s_nop 0
    v_cvt_pk_bf16_f32 v80, v64, v65
    v_cvt_pk_bf16_f32 v81, v66, v67
    v_cvt_pk_bf16_f32 v82, v68, v69
    v_cvt_pk_bf16_f32 v83, v70, v71
    ds_write_b128 v2, v[80:83] offset:16384
    s_waitcnt lgkmcnt(10)
    v_fma_f32 v72, v40, v104, 1.0
    v_fma_f32 v73, v41, v105, 1.0
    v_fma_f32 v74, v42, v106, 1.0
    v_fma_f32 v75, v43, v107, 1.0
    v_fma_f32 v76, v44, v108, 1.0
    v_fma_f32 v77, v45, v109, 1.0
    v_fma_f32 v78, v46, v110, 1.0
    v_fma_f32 v79, v47, v111, 1.0
    ds_read_b128 v[40:43], v4 offset:8512
    ds_read_b128 v[44:47], v4 offset:8544
    v_rcp_f32 v72, v72
    v_rcp_f32 v73, v73
    v_rcp_f32 v74, v74
    v_rcp_f32 v75, v75
    v_rcp_f32 v76, v76
    v_rcp_f32 v77, v77
    v_rcp_f32 v78, v78
    v_rcp_f32 v79, v79
    s_nop 0
    v_cvt_pk_bf16_f32 v84, v72, v73
    v_cvt_pk_bf16_f32 v85, v74, v75
    v_cvt_pk_bf16_f32 v86, v76, v77
    v_cvt_pk_bf16_f32 v87, v78, v79
    ds_write_b128 v2, v[84:87] offset:17408
    s_waitcnt lgkmcnt(10)
    v_fma_f32 v64, v48, v112, 1.0
    v_fma_f32 v65, v49, v113, 1.0
    v_fma_f32 v66, v50, v114, 1.0
    v_fma_f32 v67, v51, v115, 1.0
    v_fma_f32 v68, v52, v116, 1.0
    v_fma_f32 v69, v53, v117, 1.0
    v_fma_f32 v70, v54, v118, 1.0
    v_fma_f32 v71, v55, v119, 1.0
    ds_read_b128 v[48:51], v4 offset:8576
    ds_read_b128 v[52:55], v4 offset:8608
    v_rcp_f32 v64, v64
    v_rcp_f32 v65, v65
    v_rcp_f32 v66, v66
    v_rcp_f32 v67, v67
    v_rcp_f32 v68, v68
    v_rcp_f32 v69, v69
    v_rcp_f32 v70, v70
    v_rcp_f32 v71, v71
    s_nop 0
    v_cvt_pk_bf16_f32 v80, v64, v65
    v_cvt_pk_bf16_f32 v81, v66, v67
    v_cvt_pk_bf16_f32 v82, v68, v69
    v_cvt_pk_bf16_f32 v83, v70, v71
    ds_write_b128 v2, v[80:83] offset:18432
    s_waitcnt lgkmcnt(10)
    v_fma_f32 v72, v56, v120, 1.0
    v_fma_f32 v73, v57, v121, 1.0
    v_fma_f32 v74, v58, v122, 1.0
    v_fma_f32 v75, v59, v123, 1.0
    v_fma_f32 v76, v60, v124, 1.0
    v_fma_f32 v77, v61, v125, 1.0
    v_fma_f32 v78, v62, v126, 1.0
    v_fma_f32 v79, v63, v127, 1.0
    ds_read_b128 v[56:59], v4 offset:8640
    ds_read_b128 v[60:63], v4 offset:8672
    v_rcp_f32 v72, v72
    v_rcp_f32 v73, v73
    v_rcp_f32 v74, v74
    v_rcp_f32 v75, v75
    v_rcp_f32 v76, v76
    v_rcp_f32 v77, v77
    v_rcp_f32 v78, v78
    v_rcp_f32 v79, v79
    s_nop 0
    v_cvt_pk_bf16_f32 v84, v72, v73
    v_cvt_pk_bf16_f32 v85, v74, v75
    v_cvt_pk_bf16_f32 v86, v76, v77
    v_cvt_pk_bf16_f32 v87, v78, v79
    ds_write_b128 v2, v[84:87] offset:19456
    s_waitcnt lgkmcnt(0)
    s_barrier
    v_fma_f32 v64, v32, v96, 1.0
    v_fma_f32 v65, v33, v97, 1.0
    v_fma_f32 v66, v34, v98, 1.0
    v_fma_f32 v67, v35, v99, 1.0
    v_fma_f32 v68, v36, v100, 1.0
    v_fma_f32 v69, v37, v101, 1.0
    v_fma_f32 v70, v38, v102, 1.0
    v_fma_f32 v71, v39, v103, 1.0
    ds_read_b128 v[32:35], v4 offset:12672
    ds_read_b128 v[36:39], v4 offset:12704
    v_rcp_f32 v64, v64
    v_rcp_f32 v65, v65
    v_rcp_f32 v66, v66
    v_rcp_f32 v67, v67
    v_rcp_f32 v68, v68
    v_rcp_f32 v69, v69
    v_rcp_f32 v70, v70
    v_rcp_f32 v71, v71
    s_nop 0
    v_cvt_pk_bf16_f32 v80, v64, v65
    v_cvt_pk_bf16_f32 v81, v66, v67
    v_cvt_pk_bf16_f32 v82, v68, v69
    v_cvt_pk_bf16_f32 v83, v70, v71
    ds_write_b128 v2, v[80:83] offset:32768
    v_fma_f32 v72, v40, v104, 1.0
    v_fma_f32 v73, v41, v105, 1.0
    v_fma_f32 v74, v42, v106, 1.0
    v_fma_f32 v75, v43, v107, 1.0
    v_fma_f32 v76, v44, v108, 1.0
    v_fma_f32 v77, v45, v109, 1.0
    v_fma_f32 v78, v46, v110, 1.0
    v_fma_f32 v79, v47, v111, 1.0
    ds_read_b128 v[40:43], v4 offset:12736
    ds_read_b128 v[44:47], v4 offset:12768
    v_rcp_f32 v72, v72
    v_rcp_f32 v73, v73
    v_rcp_f32 v74, v74
    v_rcp_f32 v75, v75
    v_rcp_f32 v76, v76
    v_rcp_f32 v77, v77
    v_rcp_f32 v78, v78
    v_rcp_f32 v79, v79
    s_nop 0
    v_cvt_pk_bf16_f32 v84, v72, v73
    v_cvt_pk_bf16_f32 v85, v74, v75
    v_cvt_pk_bf16_f32 v86, v76, v77
    v_cvt_pk_bf16_f32 v87, v78, v79
    ds_write_b128 v2, v[84:87] offset:33792
    v_fma_f32 v64, v48, v112, 1.0
    v_fma_f32 v65, v49, v113, 1.0
    v_fma_f32 v66, v50, v114, 1.0
    v_fma_f32 v67, v51, v115, 1.0
    v_fma_f32 v68, v52, v116, 1.0
    v_fma_f32 v69, v53, v117, 1.0
    v_fma_f32 v70, v54, v118, 1.0
    v_fma_f32 v71, v55, v119, 1.0
    ds_read_b128 v[48:51], v4 offset:12800
    ds_read_b128 v[52:55], v4 offset:12832
    v_rcp_f32 v64, v64
    v_rcp_f32 v65, v65
    v_rcp_f32 v66, v66
    v_rcp_f32 v67, v67
    v_rcp_f32 v68, v68
    v_rcp_f32 v69, v69
    v_rcp_f32 v70, v70
    v_rcp_f32 v71, v71
    s_nop 0
    v_cvt_pk_bf16_f32 v80, v64, v65
    v_cvt_pk_bf16_f32 v81, v66, v67
    v_cvt_pk_bf16_f32 v82, v68, v69
    v_cvt_pk_bf16_f32 v83, v70, v71
    ds_write_b128 v2, v[80:83] offset:34816
    v_fma_f32 v72, v56, v120, 1.0
    v_fma_f32 v73, v57, v121, 1.0
    v_fma_f32 v74, v58, v122, 1.0
    v_fma_f32 v75, v59, v123, 1.0
    v_fma_f32 v76, v60, v124, 1.0
    v_fma_f32 v77, v61, v125, 1.0
    v_fma_f32 v78, v62, v126, 1.0
    v_fma_f32 v79, v63, v127, 1.0
    ds_read_b128 v[56:59], v4 offset:12864
    ds_read_b128 v[60:63], v4 offset:12896
    v_rcp_f32 v72, v72
    v_rcp_f32 v73, v73
    v_rcp_f32 v74, v74
    v_rcp_f32 v75, v75
    v_rcp_f32 v76, v76
    v_rcp_f32 v77, v77
    v_rcp_f32 v78, v78
    v_rcp_f32 v79, v79
    s_nop 0
    v_cvt_pk_bf16_f32 v84, v72, v73
    v_cvt_pk_bf16_f32 v85, v74, v75
    v_cvt_pk_bf16_f32 v86, v76, v77
    v_cvt_pk_bf16_f32 v87, v78, v79
    ds_write_b128 v2, v[84:87] offset:35840
    s_waitcnt lgkmcnt(0)
    s_barrier
    v_fma_f32 v64, v32, v96, 1.0
    v_fma_f32 v65, v33, v97, 1.0
    v_fma_f32 v66, v34, v98, 1.0
    v_fma_f32 v67, v35, v99, 1.0
    v_fma_f32 v68, v36, v100, 1.0
    v_fma_f32 v69, v37, v101, 1.0
    v_fma_f32 v70, v38, v102, 1.0
    v_fma_f32 v71, v39, v103, 1.0
    ds_read_b128 v[32:35], v4 offset:16896
    ds_read_b128 v[36:39], v4 offset:16928
    v_rcp_f32 v64, v64
    v_rcp_f32 v65, v65
    v_rcp_f32 v66, v66
    v_rcp_f32 v67, v67
    v_rcp_f32 v68, v68
    v_rcp_f32 v69, v69
    v_rcp_f32 v70, v70
    v_rcp_f32 v71, v71
    s_nop 0
    v_cvt_pk_bf16_f32 v80, v64, v65
    v_cvt_pk_bf16_f32 v81, v66, v67
    v_cvt_pk_bf16_f32 v82, v68, v69
    v_cvt_pk_bf16_f32 v83, v70, v71
    ds_write_b128 v2, v[80:83] offset:0
    v_fma_f32 v72, v40, v104, 1.0
    v_fma_f32 v73, v41, v105, 1.0
    v_fma_f32 v74, v42, v106, 1.0
    v_fma_f32 v75, v43, v107, 1.0
    v_fma_f32 v76, v44, v108, 1.0
    v_fma_f32 v77, v45, v109, 1.0
    v_fma_f32 v78, v46, v110, 1.0
    v_fma_f32 v79, v47, v111, 1.0
    ds_read_b128 v[40:43], v4 offset:16960
    ds_read_b128 v[44:47], v4 offset:16992
    v_rcp_f32 v72, v72
    v_rcp_f32 v73, v73
    v_rcp_f32 v74, v74
    v_rcp_f32 v75, v75
    v_rcp_f32 v76, v76
    v_rcp_f32 v77, v77
    v_rcp_f32 v78, v78
    v_rcp_f32 v79, v79
    s_nop 0
    v_cvt_pk_bf16_f32 v84, v72, v73
    v_cvt_pk_bf16_f32 v85, v74, v75
    v_cvt_pk_bf16_f32 v86, v76, v77
    v_cvt_pk_bf16_f32 v87, v78, v79
    ds_write_b128 v2, v[84:87] offset:1024
    v_fma_f32 v64, v48, v112, 1.0
    v_fma_f32 v65, v49, v113, 1.0
    v_fma_f32 v66, v50, v114, 1.0
    v_fma_f32 v67, v51, v115, 1.0
    v_fma_f32 v68, v52, v116, 1.0
    v_fma_f32 v69, v53, v117, 1.0
    v_fma_f32 v70, v54, v118, 1.0
    v_fma_f32 v71, v55, v119, 1.0
    ds_read_b128 v[48:51], v4 offset:17024
    ds_read_b128 v[52:55], v4 offset:17056
    v_rcp_f32 v64, v64
    v_rcp_f32 v65, v65
    v_rcp_f32 v66, v66
    v_rcp_f32 v67, v67
    v_rcp_f32 v68, v68
    v_rcp_f32 v69, v69
    v_rcp_f32 v70, v70
    v_rcp_f32 v71, v71
    s_nop 0
    v_cvt_pk_bf16_f32 v80, v64, v65
    v_cvt_pk_bf16_f32 v81, v66, v67
    v_cvt_pk_bf16_f32 v82, v68, v69
    v_cvt_pk_bf16_f32 v83, v70, v71
    ds_write_b128 v2, v[80:83] offset:2048
    v_fma_f32 v72, v56, v120, 1.0
    v_fma_f32 v73, v57, v121, 1.0
    v_fma_f32 v74, v58, v122, 1.0
    v_fma_f32 v75, v59, v123, 1.0
    v_fma_f32 v76, v60, v124, 1.0
    v_fma_f32 v77, v61, v125, 1.0
    v_fma_f32 v78, v62, v126, 1.0
    v_fma_f32 v79, v63, v127, 1.0
    ds_read_b128 v[56:59], v4 offset:17088
    ds_read_b128 v[60:63], v4 offset:17120
    v_rcp_f32 v72, v72
    v_rcp_f32 v73, v73
    v_rcp_f32 v74, v74
    v_rcp_f32 v75, v75
    v_rcp_f32 v76, v76
    v_rcp_f32 v77, v77
    v_rcp_f32 v78, v78
    v_rcp_f32 v79, v79
    s_nop 0
    v_cvt_pk_bf16_f32 v84, v72, v73
    v_cvt_pk_bf16_f32 v85, v74, v75
    v_cvt_pk_bf16_f32 v86, v76, v77
    v_cvt_pk_bf16_f32 v87, v78, v79
    ds_write_b128 v2, v[84:87] offset:3072
    s_waitcnt lgkmcnt(0)
    s_barrier
    ds_read_b128 a[0:3], v6 offset:0
    ds_read_b128 a[4:7], v6 offset:1056
    ds_read_b128 a[8:11], v6 offset:2112
    ds_read_b128 a[12:15], v6 offset:3168
    v_fma_f32 v64, v32, v96, 1.0
    v_fma_f32 v65, v33, v97, 1.0
    v_fma_f32 v66, v34, v98, 1.0
    v_fma_f32 v67, v35, v99, 1.0
    v_fma_f32 v68, v36, v100, 1.0
    v_fma_f32 v69, v37, v101, 1.0
    v_fma_f32 v70, v38, v102, 1.0
    v_fma_f32 v71, v39, v103, 1.0
    ds_read_b128 v[32:35], v4 offset:21120
    ds_read_b128 v[36:39], v4 offset:21152
    v_rcp_f32 v64, v64
    v_rcp_f32 v65, v65
    v_rcp_f32 v66, v66
    v_rcp_f32 v67, v67
    v_rcp_f32 v68, v68
    v_rcp_f32 v69, v69
    v_rcp_f32 v70, v70
    v_rcp_f32 v71, v71
    s_waitcnt lgkmcnt(5)
    s_mov_b32 s36, 0
    buffer_store_dwordx4 a[0:3], v7, s[16:19], s36 offen sc1
    s_waitcnt lgkmcnt(4)
    s_mov_b32 s36, 1024
    buffer_store_dwordx4 a[4:7], v7, s[16:19], s36 offen sc1
    v_cvt_pk_bf16_f32 v80, v64, v65
    v_cvt_pk_bf16_f32 v81, v66, v67
    v_cvt_pk_bf16_f32 v82, v68, v69
    v_cvt_pk_bf16_f32 v83, v70, v71
    ds_write_b128 v2, v[80:83] offset:16384
    v_fma_f32 v72, v40, v104, 1.0
    v_fma_f32 v73, v41, v105, 1.0
    v_fma_f32 v74, v42, v106, 1.0
    v_fma_f32 v75, v43, v107, 1.0
    v_fma_f32 v76, v44, v108, 1.0
    v_fma_f32 v77, v45, v109, 1.0
    v_fma_f32 v78, v46, v110, 1.0
    v_fma_f32 v79, v47, v111, 1.0
    ds_read_b128 v[40:43], v4 offset:21184
    ds_read_b128 v[44:47], v4 offset:21216
    v_rcp_f32 v72, v72
    v_rcp_f32 v73, v73
    v_rcp_f32 v74, v74
    v_rcp_f32 v75, v75
    v_rcp_f32 v76, v76
    v_rcp_f32 v77, v77
    v_rcp_f32 v78, v78
    v_rcp_f32 v79, v79
    s_waitcnt lgkmcnt(6)
    s_mov_b32 s36, 2048
    buffer_store_dwordx4 a[8:11], v7, s[16:19], s36 offen sc1
    s_waitcnt lgkmcnt(5)
    s_mov_b32 s36, 3072
    buffer_store_dwordx4 a[12:15], v7, s[16:19], s36 offen sc1
    v_cvt_pk_bf16_f32 v84, v72, v73
    v_cvt_pk_bf16_f32 v85, v74, v75
    v_cvt_pk_bf16_f32 v86, v76, v77
    v_cvt_pk_bf16_f32 v87, v78, v79
    ds_write_b128 v2, v[84:87] offset:17408
    v_fma_f32 v64, v48, v112, 1.0
    v_fma_f32 v65, v49, v113, 1.0
    v_fma_f32 v66, v50, v114, 1.0
    v_fma_f32 v67, v51, v115, 1.0
    v_fma_f32 v68, v52, v116, 1.0
    v_fma_f32 v69, v53, v117, 1.0
    v_fma_f32 v70, v54, v118, 1.0
    v_fma_f32 v71, v55, v119, 1.0
    ds_read_b128 v[48:51], v4 offset:21248
    ds_read_b128 v[52:55], v4 offset:21280
    v_rcp_f32 v64, v64
    v_rcp_f32 v65, v65
    v_rcp_f32 v66, v66
    v_rcp_f32 v67, v67
    v_rcp_f32 v68, v68
    v_rcp_f32 v69, v69
    v_rcp_f32 v70, v70
    v_rcp_f32 v71, v71
    s_nop 0
    v_cvt_pk_bf16_f32 v80, v64, v65
    v_cvt_pk_bf16_f32 v81, v66, v67
    v_cvt_pk_bf16_f32 v82, v68, v69
    v_cvt_pk_bf16_f32 v83, v70, v71
    ds_write_b128 v2, v[80:83] offset:18432
    v_fma_f32 v72, v56, v120, 1.0
    v_fma_f32 v73, v57, v121, 1.0
    v_fma_f32 v74, v58, v122, 1.0
    v_fma_f32 v75, v59, v123, 1.0
    v_fma_f32 v76, v60, v124, 1.0
    v_fma_f32 v77, v61, v125, 1.0
    v_fma_f32 v78, v62, v126, 1.0
    v_fma_f32 v79, v63, v127, 1.0
    ds_read_b128 v[56:59], v4 offset:21312
    ds_read_b128 v[60:63], v4 offset:21344
    v_rcp_f32 v72, v72
    v_rcp_f32 v73, v73
    v_rcp_f32 v74, v74
    v_rcp_f32 v75, v75
    v_rcp_f32 v76, v76
    v_rcp_f32 v77, v77
    v_rcp_f32 v78, v78
    v_rcp_f32 v79, v79
    s_nop 0
    v_cvt_pk_bf16_f32 v84, v72, v73
    v_cvt_pk_bf16_f32 v85, v74, v75
    v_cvt_pk_bf16_f32 v86, v76, v77
    v_cvt_pk_bf16_f32 v87, v78, v79
    ds_write_b128 v2, v[84:87] offset:19456
    s_waitcnt lgkmcnt(0)
    s_barrier
    ds_read_b128 a[0:3], v6 offset:16896
    ds_read_b128 a[4:7], v6 offset:17952
    ds_read_b128 a[8:11], v6 offset:19008
    ds_read_b128 a[12:15], v6 offset:20064
    v_fma_f32 v64, v32, v96, 1.0
    v_fma_f32 v65, v33, v97, 1.0
    v_fma_f32 v66, v34, v98, 1.0
    v_fma_f32 v67, v35, v99, 1.0
    v_fma_f32 v68, v36, v100, 1.0
    v_fma_f32 v69, v37, v101, 1.0
    v_fma_f32 v70, v38, v102, 1.0
    v_fma_f32 v71, v39, v103, 1.0
    ds_read_b128 v[32:35], v4 offset:25344
    ds_read_b128 v[36:39], v4 offset:25376
    v_rcp_f32 v64, v64
    v_rcp_f32 v65, v65
    v_rcp_f32 v66, v66
    v_rcp_f32 v67, v67
    v_rcp_f32 v68, v68
    v_rcp_f32 v69, v69
    v_rcp_f32 v70, v70
    v_rcp_f32 v71, v71
    s_waitcnt lgkmcnt(5)
    s_mov_b32 s36, 16384
    buffer_store_dwordx4 a[0:3], v7, s[16:19], s36 offen sc1
    s_waitcnt lgkmcnt(4)
    s_mov_b32 s36, 17408
    buffer_store_dwordx4 a[4:7], v7, s[16:19], s36 offen sc1
    v_cvt_pk_bf16_f32 v80, v64, v65
    v_cvt_pk_bf16_f32 v81, v66, v67
    v_cvt_pk_bf16_f32 v82, v68, v69
    v_cvt_pk_bf16_f32 v83, v70, v71
    ds_write_b128 v2, v[80:83] offset:32768
    v_fma_f32 v72, v40, v104, 1.0
    v_fma_f32 v73, v41, v105, 1.0
    v_fma_f32 v74, v42, v106, 1.0
    v_fma_f32 v75, v43, v107, 1.0
    v_fma_f32 v76, v44, v108, 1.0
    v_fma_f32 v77, v45, v109, 1.0
    v_fma_f32 v78, v46, v110, 1.0
    v_fma_f32 v79, v47, v111, 1.0
    ds_read_b128 v[40:43], v4 offset:25408
    ds_read_b128 v[44:47], v4 offset:25440
    v_rcp_f32 v72, v72
    v_rcp_f32 v73, v73
    v_rcp_f32 v74, v74
    v_rcp_f32 v75, v75
    v_rcp_f32 v76, v76
    v_rcp_f32 v77, v77
    v_rcp_f32 v78, v78
    v_rcp_f32 v79, v79
    s_waitcnt lgkmcnt(6)
    s_mov_b32 s36, 18432
    buffer_store_dwordx4 a[8:11], v7, s[16:19], s36 offen sc1
    s_waitcnt lgkmcnt(5)
    s_mov_b32 s36, 19456
    buffer_store_dwordx4 a[12:15], v7, s[16:19], s36 offen sc1
    v_cvt_pk_bf16_f32 v84, v72, v73
    v_cvt_pk_bf16_f32 v85, v74, v75
    v_cvt_pk_bf16_f32 v86, v76, v77
    v_cvt_pk_bf16_f32 v87, v78, v79
    ds_write_b128 v2, v[84:87] offset:33792
    v_fma_f32 v64, v48, v112, 1.0
    v_fma_f32 v65, v49, v113, 1.0
    v_fma_f32 v66, v50, v114, 1.0
    v_fma_f32 v67, v51, v115, 1.0
    v_fma_f32 v68, v52, v116, 1.0
    v_fma_f32 v69, v53, v117, 1.0
    v_fma_f32 v70, v54, v118, 1.0
    v_fma_f32 v71, v55, v119, 1.0
    ds_read_b128 v[48:51], v4 offset:25472
    ds_read_b128 v[52:55], v4 offset:25504
    v_rcp_f32 v64, v64
    v_rcp_f32 v65, v65
    v_rcp_f32 v66, v66
    v_rcp_f32 v67, v67
    v_rcp_f32 v68, v68
    v_rcp_f32 v69, v69
    v_rcp_f32 v70, v70
    v_rcp_f32 v71, v71
    s_nop 0
    v_cvt_pk_bf16_f32 v80, v64, v65
    v_cvt_pk_bf16_f32 v81, v66, v67
    v_cvt_pk_bf16_f32 v82, v68, v69
    v_cvt_pk_bf16_f32 v83, v70, v71
    ds_write_b128 v2, v[80:83] offset:34816
    v_fma_f32 v72, v56, v120, 1.0
    v_fma_f32 v73, v57, v121, 1.0
    v_fma_f32 v74, v58, v122, 1.0
    v_fma_f32 v75, v59, v123, 1.0
    v_fma_f32 v76, v60, v124, 1.0
    v_fma_f32 v77, v61, v125, 1.0
    v_fma_f32 v78, v62, v126, 1.0
    v_fma_f32 v79, v63, v127, 1.0
    ds_read_b128 v[56:59], v4 offset:25536
    ds_read_b128 v[60:63], v4 offset:25568
    v_rcp_f32 v72, v72
    v_rcp_f32 v73, v73
    v_rcp_f32 v74, v74
    v_rcp_f32 v75, v75
    v_rcp_f32 v76, v76
    v_rcp_f32 v77, v77
    v_rcp_f32 v78, v78
    v_rcp_f32 v79, v79
    s_nop 0
    v_cvt_pk_bf16_f32 v84, v72, v73
    v_cvt_pk_bf16_f32 v85, v74, v75
    v_cvt_pk_bf16_f32 v86, v76, v77
    v_cvt_pk_bf16_f32 v87, v78, v79
    ds_write_b128 v2, v[84:87] offset:35840
    s_waitcnt lgkmcnt(0)
    s_barrier
    ds_read_b128 a[0:3], v6 offset:0
    ds_read_b128 a[4:7], v6 offset:1056
    ds_read_b128 a[8:11], v6 offset:2112
    ds_read_b128 a[12:15], v6 offset:3168
    v_fma_f32 v64, v32, v96, 1.0
    v_fma_f32 v65, v33, v97, 1.0
    v_fma_f32 v66, v34, v98, 1.0
    v_fma_f32 v67, v35, v99, 1.0
    v_fma_f32 v68, v36, v100, 1.0
    v_fma_f32 v69, v37, v101, 1.0
    v_fma_f32 v70, v38, v102, 1.0
    v_fma_f32 v71, v39, v103, 1.0
    ds_read_b128 v[32:35], v4 offset:29568
    ds_read_b128 v[36:39], v4 offset:29600
    v_rcp_f32 v64, v64
    v_rcp_f32 v65, v65
    v_rcp_f32 v66, v66
    v_rcp_f32 v67, v67
    v_rcp_f32 v68, v68
    v_rcp_f32 v69, v69
    v_rcp_f32 v70, v70
    v_rcp_f32 v71, v71
    s_waitcnt lgkmcnt(5)
    s_mov_b32 s36, 32768
    buffer_store_dwordx4 a[0:3], v7, s[16:19], s36 offen sc1
    s_waitcnt lgkmcnt(4)
    s_mov_b32 s36, 33792
    buffer_store_dwordx4 a[4:7], v7, s[16:19], s36 offen sc1
    v_cvt_pk_bf16_f32 v80, v64, v65
    v_cvt_pk_bf16_f32 v81, v66, v67
    v_cvt_pk_bf16_f32 v82, v68, v69
    v_cvt_pk_bf16_f32 v83, v70, v71
    ds_write_b128 v2, v[80:83] offset:0
    v_fma_f32 v72, v40, v104, 1.0
    v_fma_f32 v73, v41, v105, 1.0
    v_fma_f32 v74, v42, v106, 1.0
    v_fma_f32 v75, v43, v107, 1.0
    v_fma_f32 v76, v44, v108, 1.0
    v_fma_f32 v77, v45, v109, 1.0
    v_fma_f32 v78, v46, v110, 1.0
    v_fma_f32 v79, v47, v111, 1.0
    ds_read_b128 v[40:43], v4 offset:29632
    ds_read_b128 v[44:47], v4 offset:29664
    v_rcp_f32 v72, v72
    v_rcp_f32 v73, v73
    v_rcp_f32 v74, v74
    v_rcp_f32 v75, v75
    v_rcp_f32 v76, v76
    v_rcp_f32 v77, v77
    v_rcp_f32 v78, v78
    v_rcp_f32 v79, v79
    s_waitcnt lgkmcnt(6)
    s_mov_b32 s36, 34816
    buffer_store_dwordx4 a[8:11], v7, s[16:19], s36 offen sc1
    s_waitcnt lgkmcnt(5)
    s_mov_b32 s36, 35840
    buffer_store_dwordx4 a[12:15], v7, s[16:19], s36 offen sc1
    v_cvt_pk_bf16_f32 v84, v72, v73
    v_cvt_pk_bf16_f32 v85, v74, v75
    v_cvt_pk_bf16_f32 v86, v76, v77
    v_cvt_pk_bf16_f32 v87, v78, v79
    ds_write_b128 v2, v[84:87] offset:1024
    v_fma_f32 v64, v48, v112, 1.0
    v_fma_f32 v65, v49, v113, 1.0
    v_fma_f32 v66, v50, v114, 1.0
    v_fma_f32 v67, v51, v115, 1.0
    v_fma_f32 v68, v52, v116, 1.0
    v_fma_f32 v69, v53, v117, 1.0
    v_fma_f32 v70, v54, v118, 1.0
    v_fma_f32 v71, v55, v119, 1.0
    ds_read_b128 v[48:51], v4 offset:29696
    ds_read_b128 v[52:55], v4 offset:29728
    v_rcp_f32 v64, v64
    v_rcp_f32 v65, v65
    v_rcp_f32 v66, v66
    v_rcp_f32 v67, v67
    v_rcp_f32 v68, v68
    v_rcp_f32 v69, v69
    v_rcp_f32 v70, v70
    v_rcp_f32 v71, v71
    s_nop 0
    v_cvt_pk_bf16_f32 v80, v64, v65
    v_cvt_pk_bf16_f32 v81, v66, v67
    v_cvt_pk_bf16_f32 v82, v68, v69
    v_cvt_pk_bf16_f32 v83, v70, v71
    ds_write_b128 v2, v[80:83] offset:2048
    v_fma_f32 v72, v56, v120, 1.0
    v_fma_f32 v73, v57, v121, 1.0
    v_fma_f32 v74, v58, v122, 1.0
    v_fma_f32 v75, v59, v123, 1.0
    v_fma_f32 v76, v60, v124, 1.0
    v_fma_f32 v77, v61, v125, 1.0
    v_fma_f32 v78, v62, v126, 1.0
    v_fma_f32 v79, v63, v127, 1.0
    ds_read_b128 v[56:59], v4 offset:29760
    ds_read_b128 v[60:63], v4 offset:29792
    v_rcp_f32 v72, v72
    v_rcp_f32 v73, v73
    v_rcp_f32 v74, v74
    v_rcp_f32 v75, v75
    v_rcp_f32 v76, v76
    v_rcp_f32 v77, v77
    v_rcp_f32 v78, v78
    v_rcp_f32 v79, v79
    s_nop 0
    v_cvt_pk_bf16_f32 v84, v72, v73
    v_cvt_pk_bf16_f32 v85, v74, v75
    v_cvt_pk_bf16_f32 v86, v76, v77
    v_cvt_pk_bf16_f32 v87, v78, v79
    ds_write_b128 v2, v[84:87] offset:3072
    s_waitcnt lgkmcnt(0)
    s_barrier
    ds_read_b128 a[0:3], v6 offset:16896
    ds_read_b128 a[4:7], v6 offset:17952
    ds_read_b128 a[8:11], v6 offset:19008
    ds_read_b128 a[12:15], v6 offset:20064
    v_fma_f32 v64, v32, v96, 1.0
    v_fma_f32 v65, v33, v97, 1.0
    v_fma_f32 v66, v34, v98, 1.0
    v_fma_f32 v67, v35, v99, 1.0
    v_fma_f32 v68, v36, v100, 1.0
    v_fma_f32 v69, v37, v101, 1.0
    v_fma_f32 v70, v38, v102, 1.0
    v_fma_f32 v71, v39, v103, 1.0
    v_rcp_f32 v64, v64
    v_rcp_f32 v65, v65
    v_rcp_f32 v66, v66
    v_rcp_f32 v67, v67
    v_rcp_f32 v68, v68
    v_rcp_f32 v69, v69
    v_rcp_f32 v70, v70
    v_rcp_f32 v71, v71
    s_waitcnt lgkmcnt(3)
    s_mov_b32 s36, 49152
    buffer_store_dwordx4 a[0:3], v7, s[16:19], s36 offen sc1
    s_waitcnt lgkmcnt(2)
    s_mov_b32 s36, 50176
    buffer_store_dwordx4 a[4:7], v7, s[16:19], s36 offen sc1
    v_cvt_pk_bf16_f32 v80, v64, v65
    v_cvt_pk_bf16_f32 v81, v66, v67
    v_cvt_pk_bf16_f32 v82, v68, v69
    v_cvt_pk_bf16_f32 v83, v70, v71
    ds_write_b128 v2, v[80:83] offset:16384
    v_fma_f32 v72, v40, v104, 1.0
    v_fma_f32 v73, v41, v105, 1.0
    v_fma_f32 v74, v42, v106, 1.0
    v_fma_f32 v75, v43, v107, 1.0
    v_fma_f32 v76, v44, v108, 1.0
    v_fma_f32 v77, v45, v109, 1.0
    v_fma_f32 v78, v46, v110, 1.0
    v_fma_f32 v79, v47, v111, 1.0
    v_rcp_f32 v72, v72
    v_rcp_f32 v73, v73
    v_rcp_f32 v74, v74
    v_rcp_f32 v75, v75
    v_rcp_f32 v76, v76
    v_rcp_f32 v77, v77
    v_rcp_f32 v78, v78
    v_rcp_f32 v79, v79
    s_waitcnt lgkmcnt(2)
    s_mov_b32 s36, 51200
    buffer_store_dwordx4 a[8:11], v7, s[16:19], s36 offen sc1
    s_waitcnt lgkmcnt(1)
    s_mov_b32 s36, 52224
    buffer_store_dwordx4 a[12:15], v7, s[16:19], s36 offen sc1
    v_cvt_pk_bf16_f32 v84, v72, v73
    v_cvt_pk_bf16_f32 v85, v74, v75
    v_cvt_pk_bf16_f32 v86, v76, v77
    v_cvt_pk_bf16_f32 v87, v78, v79
    ds_write_b128 v2, v[84:87] offset:17408
    v_fma_f32 v64, v48, v112, 1.0
    v_fma_f32 v65, v49, v113, 1.0
    v_fma_f32 v66, v50, v114, 1.0
    v_fma_f32 v67, v51, v115, 1.0
    v_fma_f32 v68, v52, v116, 1.0
    v_fma_f32 v69, v53, v117, 1.0
    v_fma_f32 v70, v54, v118, 1.0
    v_fma_f32 v71, v55, v119, 1.0
    v_rcp_f32 v64, v64
    v_rcp_f32 v65, v65
    v_rcp_f32 v66, v66
    v_rcp_f32 v67, v67
    v_rcp_f32 v68, v68
    v_rcp_f32 v69, v69
    v_rcp_f32 v70, v70
    v_rcp_f32 v71, v71
    s_nop 0
    v_cvt_pk_bf16_f32 v80, v64, v65
    v_cvt_pk_bf16_f32 v81, v66, v67
    v_cvt_pk_bf16_f32 v82, v68, v69
    v_cvt_pk_bf16_f32 v83, v70, v71
    ds_write_b128 v2, v[80:83] offset:18432
    v_fma_f32 v72, v56, v120, 1.0
    v_fma_f32 v73, v57, v121, 1.0
    v_fma_f32 v74, v58, v122, 1.0
    v_fma_f32 v75, v59, v123, 1.0
    v_fma_f32 v76, v60, v124, 1.0
    v_fma_f32 v77, v61, v125, 1.0
    v_fma_f32 v78, v62, v126, 1.0
    v_fma_f32 v79, v63, v127, 1.0
    v_rcp_f32 v72, v72
    v_rcp_f32 v73, v73
    v_rcp_f32 v74, v74
    v_rcp_f32 v75, v75
    v_rcp_f32 v76, v76
    v_rcp_f32 v77, v77
    v_rcp_f32 v78, v78
    v_rcp_f32 v79, v79
    s_nop 0
    v_cvt_pk_bf16_f32 v84, v72, v73
    v_cvt_pk_bf16_f32 v85, v74, v75
    v_cvt_pk_bf16_f32 v86, v76, v77
    v_cvt_pk_bf16_f32 v87, v78, v79
    ds_write_b128 v2, v[84:87] offset:19456
    s_waitcnt lgkmcnt(0)
    s_barrier
    ds_read_b128 a[0:3], v6 offset:0
    ds_read_b128 a[4:7], v6 offset:1056
    ds_read_b128 a[8:11], v6 offset:2112
    ds_read_b128 a[12:15], v6 offset:3168
    s_waitcnt lgkmcnt(3)
    s_mov_b32 s36, 65536
    buffer_store_dwordx4 a[0:3], v7, s[16:19], s36 offen sc1
    s_waitcnt lgkmcnt(2)
    s_mov_b32 s36, 66560
    buffer_store_dwordx4 a[4:7], v7, s[16:19], s36 offen sc1
    s_waitcnt lgkmcnt(1)
    s_mov_b32 s36, 67584
    buffer_store_dwordx4 a[8:11], v7, s[16:19], s36 offen sc1
    s_waitcnt lgkmcnt(0)
    s_mov_b32 s36, 68608
    buffer_store_dwordx4 a[12:15], v7, s[16:19], s36 offen sc1
    s_barrier
    ds_read_b128 a[0:3], v6 offset:16896
    ds_read_b128 a[4:7], v6 offset:17952
    ds_read_b128 a[8:11], v6 offset:19008
    ds_read_b128 a[12:15], v6 offset:20064
    s_waitcnt lgkmcnt(3)
    s_mov_b32 s36, 81920
    buffer_store_dwordx4 a[0:3], v7, s[16:19], s36 offen sc1
    s_waitcnt lgkmcnt(2)
    s_mov_b32 s36, 82944
    buffer_store_dwordx4 a[4:7], v7, s[16:19], s36 offen sc1
    s_waitcnt lgkmcnt(1)
    s_mov_b32 s36, 83968
    buffer_store_dwordx4 a[8:11], v7, s[16:19], s36 offen sc1
    s_waitcnt lgkmcnt(0)
    s_mov_b32 s36, 84992
    buffer_store_dwordx4 a[12:15], v7, s[16:19], s36 offen sc1
    s_barrier
    ds_read_b128 a[0:3], v6 offset:0
    ds_read_b128 a[4:7], v6 offset:1056
    ds_read_b128 a[8:11], v6 offset:2112
    ds_read_b128 a[12:15], v6 offset:3168
    s_waitcnt lgkmcnt(3)
    s_mov_b32 s36, 98304
    buffer_store_dwordx4 a[0:3], v7, s[16:19], s36 offen sc1
    s_waitcnt lgkmcnt(2)
    s_mov_b32 s36, 99328
    buffer_store_dwordx4 a[4:7], v7, s[16:19], s36 offen sc1
    s_waitcnt lgkmcnt(1)
    s_mov_b32 s36, 100352
    buffer_store_dwordx4 a[8:11], v7, s[16:19], s36 offen sc1
    s_waitcnt lgkmcnt(0)
    s_mov_b32 s36, 101376
    buffer_store_dwordx4 a[12:15], v7, s[16:19], s36 offen sc1
    s_barrier
    ds_read_b128 a[0:3], v6 offset:16896
    ds_read_b128 a[4:7], v6 offset:17952
    ds_read_b128 a[8:11], v6 offset:19008
    ds_read_b128 a[12:15], v6 offset:20064
    s_waitcnt lgkmcnt(3)
    s_mov_b32 s36, 114688
    buffer_store_dwordx4 a[0:3], v7, s[16:19], s36 offen sc1
    s_waitcnt lgkmcnt(2)
    s_mov_b32 s36, 115712
    buffer_store_dwordx4 a[4:7], v7, s[16:19], s36 offen sc1
    s_waitcnt lgkmcnt(1)
    s_mov_b32 s36, 116736
    buffer_store_dwordx4 a[8:11], v7, s[16:19], s36 offen sc1
    s_waitcnt lgkmcnt(0)
    s_mov_b32 s36, 117760
    buffer_store_dwordx4 a[12:15], v7, s[16:19], s36 offen sc1
    s_endpgm
L_joint_kernel_slow:
    buffer_load_dwordx4 v[96:99], v14, s[12:15], s37 offen offset:0
    buffer_load_dwordx4 v[100:103], v14, s[12:15], s37 offen offset:32
    buffer_load_dwordx4 v[104:107], v14, s[12:15], s37 offen offset:64
    buffer_load_dwordx4 v[108:111], v14, s[12:15], s37 offen offset:96
    buffer_load_dwordx4 v[112:115], v14, s[12:15], s37 offen offset:128
    buffer_load_dwordx4 v[116:119], v14, s[12:15], s37 offen offset:160
    buffer_load_dwordx4 v[120:123], v14, s[12:15], s37 offen offset:192
    buffer_load_dwordx4 v[124:127], v14, s[12:15], s37 offen offset:224
    s_waitcnt vmcnt(0)
    ds_write_b128 v9, v[64:67] offset:0
    ds_write_b128 v9, v[68:71] offset:32
    ds_write_b128 v9, v[72:75] offset:64
    ds_write_b128 v9, v[76:79] offset:96
    ds_write_b128 v9, v[80:83] offset:128
    ds_write_b128 v9, v[84:87] offset:160
    ds_write_b128 v9, v[88:91] offset:192
    ds_write_b128 v9, v[92:95] offset:224
    s_waitcnt lgkmcnt(0)
    ds_read_b128 v[32:35], v4 offset:0
    ds_read_b128 v[36:39], v4 offset:32
    ds_read_b128 v[40:43], v4 offset:64
    ds_read_b128 v[44:47], v4 offset:96
    ds_read_b128 v[48:51], v4 offset:128
    ds_read_b128 v[52:55], v4 offset:160
    ds_read_b128 v[56:59], v4 offset:192
    ds_read_b128 v[60:63], v4 offset:224
    s_waitcnt lgkmcnt(6)
    v_add_f32 v64, v32, v96
    v_add_f32 v65, v33, v97
    v_add_f32 v66, v34, v98
    v_add_f32 v67, v35, v99
    v_add_f32 v68, v36, v100
    v_add_f32 v69, v37, v101
    v_add_f32 v70, v38, v102
    v_add_f32 v71, v39, v103
    ds_read_b128 v[32:35], v4 offset:4224
    ds_read_b128 v[36:39], v4 offset:4256
    v_exp_f32 v64, v64
    v_exp_f32 v65, v65
    v_exp_f32 v66, v66
    v_exp_f32 v67, v67
    v_exp_f32 v68, v68
    v_exp_f32 v69, v69
    v_exp_f32 v70, v70
    v_exp_f32 v71, v71
    v_add_f32 v64, 1.0, v64
    v_add_f32 v65, 1.0, v65
    v_add_f32 v66, 1.0, v66
    v_add_f32 v67, 1.0, v67
    v_add_f32 v68, 1.0, v68
    v_add_f32 v69, 1.0, v69
    v_add_f32 v70, 1.0, v70
    v_add_f32 v71, 1.0, v71
    v_rcp_f32 v64, v64
    v_rcp_f32 v65, v65
    v_rcp_f32 v66, v66
    v_rcp_f32 v67, v67
    v_rcp_f32 v68, v68
    v_rcp_f32 v69, v69
    v_rcp_f32 v70, v70
    v_rcp_f32 v71, v71
    s_nop 0
    v_cvt_pk_bf16_f32 v80, v64, v65
    v_cvt_pk_bf16_f32 v81, v66, v67
    v_cvt_pk_bf16_f32 v82, v68, v69
    v_cvt_pk_bf16_f32 v83, v70, v71
    ds_write_b128 v2, v[80:83] offset:0
    s_waitcnt lgkmcnt(7)
    v_add_f32 v72, v40, v104
    v_add_f32 v73, v41, v105
    v_add_f32 v74, v42, v106
    v_add_f32 v75, v43, v107
    v_add_f32 v76, v44, v108
    v_add_f32 v77, v45, v109
    v_add_f32 v78, v46, v110
    v_add_f32 v79, v47, v111
    ds_read_b128 v[40:43], v4 offset:4288
    ds_read_b128 v[44:47], v4 offset:4320
    v_exp_f32 v72, v72
    v_exp_f32 v73, v73
    v_exp_f32 v74, v74
    v_exp_f32 v75, v75
    v_exp_f32 v76, v76
    v_exp_f32 v77, v77
    v_exp_f32 v78, v78
    v_exp_f32 v79, v79
    v_add_f32 v72, 1.0, v72
    v_add_f32 v73, 1.0, v73
    v_add_f32 v74, 1.0, v74
    v_add_f32 v75, 1.0, v75
    v_add_f32 v76, 1.0, v76
    v_add_f32 v77, 1.0, v77
    v_add_f32 v78, 1.0, v78
    v_add_f32 v79, 1.0, v79
    v_rcp_f32 v72, v72
    v_rcp_f32 v73, v73
    v_rcp_f32 v74, v74
    v_rcp_f32 v75, v75
    v_rcp_f32 v76, v76
    v_rcp_f32 v77, v77
    v_rcp_f32 v78, v78
    v_rcp_f32 v79, v79
    s_nop 0
    v_cvt_pk_bf16_f32 v84, v72, v73
    v_cvt_pk_bf16_f32 v85, v74, v75
    v_cvt_pk_bf16_f32 v86, v76, v77
    v_cvt_pk_bf16_f32 v87, v78, v79
    ds_write_b128 v2, v[84:87] offset:1024
    s_waitcnt lgkmcnt(8)
    v_add_f32 v64, v48, v112
    v_add_f32 v65, v49, v113
    v_add_f32 v66, v50, v114
    v_add_f32 v67, v51, v115
    v_add_f32 v68, v52, v116
    v_add_f32 v69, v53, v117
    v_add_f32 v70, v54, v118
    v_add_f32 v71, v55, v119
    ds_read_b128 v[48:51], v4 offset:4352
    ds_read_b128 v[52:55], v4 offset:4384
    v_exp_f32 v64, v64
    v_exp_f32 v65, v65
    v_exp_f32 v66, v66
    v_exp_f32 v67, v67
    v_exp_f32 v68, v68
    v_exp_f32 v69, v69
    v_exp_f32 v70, v70
    v_exp_f32 v71, v71
    v_add_f32 v64, 1.0, v64
    v_add_f32 v65, 1.0, v65
    v_add_f32 v66, 1.0, v66
    v_add_f32 v67, 1.0, v67
    v_add_f32 v68, 1.0, v68
    v_add_f32 v69, 1.0, v69
    v_add_f32 v70, 1.0, v70
    v_add_f32 v71, 1.0, v71
    v_rcp_f32 v64, v64
    v_rcp_f32 v65, v65
    v_rcp_f32 v66, v66
    v_rcp_f32 v67, v67
    v_rcp_f32 v68, v68
    v_rcp_f32 v69, v69
    v_rcp_f32 v70, v70
    v_rcp_f32 v71, v71
    s_nop 0
    v_cvt_pk_bf16_f32 v80, v64, v65
    v_cvt_pk_bf16_f32 v81, v66, v67
    v_cvt_pk_bf16_f32 v82, v68, v69
    v_cvt_pk_bf16_f32 v83, v70, v71
    ds_write_b128 v2, v[80:83] offset:2048
    s_waitcnt lgkmcnt(9)
    v_add_f32 v72, v56, v120
    v_add_f32 v73, v57, v121
    v_add_f32 v74, v58, v122
    v_add_f32 v75, v59, v123
    v_add_f32 v76, v60, v124
    v_add_f32 v77, v61, v125
    v_add_f32 v78, v62, v126
    v_add_f32 v79, v63, v127
    ds_read_b128 v[56:59], v4 offset:4416
    ds_read_b128 v[60:63], v4 offset:4448
    v_exp_f32 v72, v72
    v_exp_f32 v73, v73
    v_exp_f32 v74, v74
    v_exp_f32 v75, v75
    v_exp_f32 v76, v76
    v_exp_f32 v77, v77
    v_exp_f32 v78, v78
    v_exp_f32 v79, v79
    v_add_f32 v72, 1.0, v72
    v_add_f32 v73, 1.0, v73
    v_add_f32 v74, 1.0, v74
    v_add_f32 v75, 1.0, v75
    v_add_f32 v76, 1.0, v76
    v_add_f32 v77, 1.0, v77
    v_add_f32 v78, 1.0, v78
    v_add_f32 v79, 1.0, v79
    v_rcp_f32 v72, v72
    v_rcp_f32 v73, v73
    v_rcp_f32 v74, v74
    v_rcp_f32 v75, v75
    v_rcp_f32 v76, v76
    v_rcp_f32 v77, v77
    v_rcp_f32 v78, v78
    v_rcp_f32 v79, v79
    s_nop 0
    v_cvt_pk_bf16_f32 v84, v72, v73
    v_cvt_pk_bf16_f32 v85, v74, v75
    v_cvt_pk_bf16_f32 v86, v76, v77
    v_cvt_pk_bf16_f32 v87, v78, v79
    ds_write_b128 v2, v[84:87] offset:3072
    s_waitcnt lgkmcnt(10)
    v_add_f32 v64, v32, v96
    v_add_f32 v65, v33, v97
    v_add_f32 v66, v34, v98
    v_add_f32 v67, v35, v99
    v_add_f32 v68, v36, v100
    v_add_f32 v69, v37, v101
    v_add_f32 v70, v38, v102
    v_add_f32 v71, v39, v103
    ds_read_b128 v[32:35], v4 offset:8448
    ds_read_b128 v[36:39], v4 offset:8480
    v_exp_f32 v64, v64
    v_exp_f32 v65, v65
    v_exp_f32 v66, v66
    v_exp_f32 v67, v67
    v_exp_f32 v68, v68
    v_exp_f32 v69, v69
    v_exp_f32 v70, v70
    v_exp_f32 v71, v71
    v_add_f32 v64, 1.0, v64
    v_add_f32 v65, 1.0, v65
    v_add_f32 v66, 1.0, v66
    v_add_f32 v67, 1.0, v67
    v_add_f32 v68, 1.0, v68
    v_add_f32 v69, 1.0, v69
    v_add_f32 v70, 1.0, v70
    v_add_f32 v71, 1.0, v71
    v_rcp_f32 v64, v64
    v_rcp_f32 v65, v65
    v_rcp_f32 v66, v66
    v_rcp_f32 v67, v67
    v_rcp_f32 v68, v68
    v_rcp_f32 v69, v69
    v_rcp_f32 v70, v70
    v_rcp_f32 v71, v71
    s_nop 0
    v_cvt_pk_bf16_f32 v80, v64, v65
    v_cvt_pk_bf16_f32 v81, v66, v67
    v_cvt_pk_bf16_f32 v82, v68, v69
    v_cvt_pk_bf16_f32 v83, v70, v71
    ds_write_b128 v2, v[80:83] offset:16384
    s_waitcnt lgkmcnt(10)
    v_add_f32 v72, v40, v104
    v_add_f32 v73, v41, v105
    v_add_f32 v74, v42, v106
    v_add_f32 v75, v43, v107
    v_add_f32 v76, v44, v108
    v_add_f32 v77, v45, v109
    v_add_f32 v78, v46, v110
    v_add_f32 v79, v47, v111
    ds_read_b128 v[40:43], v4 offset:8512
    ds_read_b128 v[44:47], v4 offset:8544
    v_exp_f32 v72, v72
    v_exp_f32 v73, v73
    v_exp_f32 v74, v74
    v_exp_f32 v75, v75
    v_exp_f32 v76, v76
    v_exp_f32 v77, v77
    v_exp_f32 v78, v78
    v_exp_f32 v79, v79
    v_add_f32 v72, 1.0, v72
    v_add_f32 v73, 1.0, v73
    v_add_f32 v74, 1.0, v74
    v_add_f32 v75, 1.0, v75
    v_add_f32 v76, 1.0, v76
    v_add_f32 v77, 1.0, v77
    v_add_f32 v78, 1.0, v78
    v_add_f32 v79, 1.0, v79
    v_rcp_f32 v72, v72
    v_rcp_f32 v73, v73
    v_rcp_f32 v74, v74
    v_rcp_f32 v75, v75
    v_rcp_f32 v76, v76
    v_rcp_f32 v77, v77
    v_rcp_f32 v78, v78
    v_rcp_f32 v79, v79
    s_nop 0
    v_cvt_pk_bf16_f32 v84, v72, v73
    v_cvt_pk_bf16_f32 v85, v74, v75
    v_cvt_pk_bf16_f32 v86, v76, v77
    v_cvt_pk_bf16_f32 v87, v78, v79
    ds_write_b128 v2, v[84:87] offset:17408
    s_waitcnt lgkmcnt(10)
    v_add_f32 v64, v48, v112
    v_add_f32 v65, v49, v113
    v_add_f32 v66, v50, v114
    v_add_f32 v67, v51, v115
    v_add_f32 v68, v52, v116
    v_add_f32 v69, v53, v117
    v_add_f32 v70, v54, v118
    v_add_f32 v71, v55, v119
    ds_read_b128 v[48:51], v4 offset:8576
    ds_read_b128 v[52:55], v4 offset:8608
    v_exp_f32 v64, v64
    v_exp_f32 v65, v65
    v_exp_f32 v66, v66
    v_exp_f32 v67, v67
    v_exp_f32 v68, v68
    v_exp_f32 v69, v69
    v_exp_f32 v70, v70
    v_exp_f32 v71, v71
    v_add_f32 v64, 1.0, v64
    v_add_f32 v65, 1.0, v65
    v_add_f32 v66, 1.0, v66
    v_add_f32 v67, 1.0, v67
    v_add_f32 v68, 1.0, v68
    v_add_f32 v69, 1.0, v69
    v_add_f32 v70, 1.0, v70
    v_add_f32 v71, 1.0, v71
    v_rcp_f32 v64, v64
    v_rcp_f32 v65, v65
    v_rcp_f32 v66, v66
    v_rcp_f32 v67, v67
    v_rcp_f32 v68, v68
    v_rcp_f32 v69, v69
    v_rcp_f32 v70, v70
    v_rcp_f32 v71, v71
    s_nop 0
    v_cvt_pk_bf16_f32 v80, v64, v65
    v_cvt_pk_bf16_f32 v81, v66, v67
    v_cvt_pk_bf16_f32 v82, v68, v69
    v_cvt_pk_bf16_f32 v83, v70, v71
    ds_write_b128 v2, v[80:83] offset:18432
    s_waitcnt lgkmcnt(10)
    v_add_f32 v72, v56, v120
    v_add_f32 v73, v57, v121
    v_add_f32 v74, v58, v122
    v_add_f32 v75, v59, v123
    v_add_f32 v76, v60, v124
    v_add_f32 v77, v61, v125
    v_add_f32 v78, v62, v126
    v_add_f32 v79, v63, v127
    ds_read_b128 v[56:59], v4 offset:8640
    ds_read_b128 v[60:63], v4 offset:8672
    v_exp_f32 v72, v72
    v_exp_f32 v73, v73
    v_exp_f32 v74, v74
    v_exp_f32 v75, v75
    v_exp_f32 v76, v76
    v_exp_f32 v77, v77
    v_exp_f32 v78, v78
    v_exp_f32 v79, v79
    v_add_f32 v72, 1.0, v72
    v_add_f32 v73, 1.0, v73
    v_add_f32 v74, 1.0, v74
    v_add_f32 v75, 1.0, v75
    v_add_f32 v76, 1.0, v76
    v_add_f32 v77, 1.0, v77
    v_add_f32 v78, 1.0, v78
    v_add_f32 v79, 1.0, v79
    v_rcp_f32 v72, v72
    v_rcp_f32 v73, v73
    v_rcp_f32 v74, v74
    v_rcp_f32 v75, v75
    v_rcp_f32 v76, v76
    v_rcp_f32 v77, v77
    v_rcp_f32 v78, v78
    v_rcp_f32 v79, v79
    s_nop 0
    v_cvt_pk_bf16_f32 v84, v72, v73
    v_cvt_pk_bf16_f32 v85, v74, v75
    v_cvt_pk_bf16_f32 v86, v76, v77
    v_cvt_pk_bf16_f32 v87, v78, v79
    ds_write_b128 v2, v[84:87] offset:19456
    s_waitcnt lgkmcnt(0)
    s_barrier
    v_add_f32 v64, v32, v96
    v_add_f32 v65, v33, v97
    v_add_f32 v66, v34, v98
    v_add_f32 v67, v35, v99
    v_add_f32 v68, v36, v100
    v_add_f32 v69, v37, v101
    v_add_f32 v70, v38, v102
    v_add_f32 v71, v39, v103
    ds_read_b128 v[32:35], v4 offset:12672
    ds_read_b128 v[36:39], v4 offset:12704
    v_exp_f32 v64, v64
    v_exp_f32 v65, v65
    v_exp_f32 v66, v66
    v_exp_f32 v67, v67
    v_exp_f32 v68, v68
    v_exp_f32 v69, v69
    v_exp_f32 v70, v70
    v_exp_f32 v71, v71
    v_add_f32 v64, 1.0, v64
    v_add_f32 v65, 1.0, v65
    v_add_f32 v66, 1.0, v66
    v_add_f32 v67, 1.0, v67
    v_add_f32 v68, 1.0, v68
    v_add_f32 v69, 1.0, v69
    v_add_f32 v70, 1.0, v70
    v_add_f32 v71, 1.0, v71
    v_rcp_f32 v64, v64
    v_rcp_f32 v65, v65
    v_rcp_f32 v66, v66
    v_rcp_f32 v67, v67
    v_rcp_f32 v68, v68
    v_rcp_f32 v69, v69
    v_rcp_f32 v70, v70
    v_rcp_f32 v71, v71
    s_nop 0
    v_cvt_pk_bf16_f32 v80, v64, v65
    v_cvt_pk_bf16_f32 v81, v66, v67
    v_cvt_pk_bf16_f32 v82, v68, v69
    v_cvt_pk_bf16_f32 v83, v70, v71
    ds_write_b128 v2, v[80:83] offset:32768
    v_add_f32 v72, v40, v104
    v_add_f32 v73, v41, v105
    v_add_f32 v74, v42, v106
    v_add_f32 v75, v43, v107
    v_add_f32 v76, v44, v108
    v_add_f32 v77, v45, v109
    v_add_f32 v78, v46, v110
    v_add_f32 v79, v47, v111
    ds_read_b128 v[40:43], v4 offset:12736
    ds_read_b128 v[44:47], v4 offset:12768
    v_exp_f32 v72, v72
    v_exp_f32 v73, v73
    v_exp_f32 v74, v74
    v_exp_f32 v75, v75
    v_exp_f32 v76, v76
    v_exp_f32 v77, v77
    v_exp_f32 v78, v78
    v_exp_f32 v79, v79
    v_add_f32 v72, 1.0, v72
    v_add_f32 v73, 1.0, v73
    v_add_f32 v74, 1.0, v74
    v_add_f32 v75, 1.0, v75
    v_add_f32 v76, 1.0, v76
    v_add_f32 v77, 1.0, v77
    v_add_f32 v78, 1.0, v78
    v_add_f32 v79, 1.0, v79
    v_rcp_f32 v72, v72
    v_rcp_f32 v73, v73
    v_rcp_f32 v74, v74
    v_rcp_f32 v75, v75
    v_rcp_f32 v76, v76
    v_rcp_f32 v77, v77
    v_rcp_f32 v78, v78
    v_rcp_f32 v79, v79
    s_nop 0
    v_cvt_pk_bf16_f32 v84, v72, v73
    v_cvt_pk_bf16_f32 v85, v74, v75
    v_cvt_pk_bf16_f32 v86, v76, v77
    v_cvt_pk_bf16_f32 v87, v78, v79
    ds_write_b128 v2, v[84:87] offset:33792
    v_add_f32 v64, v48, v112
    v_add_f32 v65, v49, v113
    v_add_f32 v66, v50, v114
    v_add_f32 v67, v51, v115
    v_add_f32 v68, v52, v116
    v_add_f32 v69, v53, v117
    v_add_f32 v70, v54, v118
    v_add_f32 v71, v55, v119
    ds_read_b128 v[48:51], v4 offset:12800
    ds_read_b128 v[52:55], v4 offset:12832
    v_exp_f32 v64, v64
    v_exp_f32 v65, v65
    v_exp_f32 v66, v66
    v_exp_f32 v67, v67
    v_exp_f32 v68, v68
    v_exp_f32 v69, v69
    v_exp_f32 v70, v70
    v_exp_f32 v71, v71
    v_add_f32 v64, 1.0, v64
    v_add_f32 v65, 1.0, v65
    v_add_f32 v66, 1.0, v66
    v_add_f32 v67, 1.0, v67
    v_add_f32 v68, 1.0, v68
    v_add_f32 v69, 1.0, v69
    v_add_f32 v70, 1.0, v70
    v_add_f32 v71, 1.0, v71
    v_rcp_f32 v64, v64
    v_rcp_f32 v65, v65
    v_rcp_f32 v66, v66
    v_rcp_f32 v67, v67
    v_rcp_f32 v68, v68
    v_rcp_f32 v69, v69
    v_rcp_f32 v70, v70
    v_rcp_f32 v71, v71
    s_nop 0
    v_cvt_pk_bf16_f32 v80, v64, v65
    v_cvt_pk_bf16_f32 v81, v66, v67
    v_cvt_pk_bf16_f32 v82, v68, v69
    v_cvt_pk_bf16_f32 v83, v70, v71
    ds_write_b128 v2, v[80:83] offset:34816
    v_add_f32 v72, v56, v120
    v_add_f32 v73, v57, v121
    v_add_f32 v74, v58, v122
    v_add_f32 v75, v59, v123
    v_add_f32 v76, v60, v124
    v_add_f32 v77, v61, v125
    v_add_f32 v78, v62, v126
    v_add_f32 v79, v63, v127
    ds_read_b128 v[56:59], v4 offset:12864
    ds_read_b128 v[60:63], v4 offset:12896
    v_exp_f32 v72, v72
    v_exp_f32 v73, v73
    v_exp_f32 v74, v74
    v_exp_f32 v75, v75
    v_exp_f32 v76, v76
    v_exp_f32 v77, v77
    v_exp_f32 v78, v78
    v_exp_f32 v79, v79
    v_add_f32 v72, 1.0, v72
    v_add_f32 v73, 1.0, v73
    v_add_f32 v74, 1.0, v74
    v_add_f32 v75, 1.0, v75
    v_add_f32 v76, 1.0, v76
    v_add_f32 v77, 1.0, v77
    v_add_f32 v78, 1.0, v78
    v_add_f32 v79, 1.0, v79
    v_rcp_f32 v72, v72
    v_rcp_f32 v73, v73
    v_rcp_f32 v74, v74
    v_rcp_f32 v75, v75
    v_rcp_f32 v76, v76
    v_rcp_f32 v77, v77
    v_rcp_f32 v78, v78
    v_rcp_f32 v79, v79
    s_nop 0
    v_cvt_pk_bf16_f32 v84, v72, v73
    v_cvt_pk_bf16_f32 v85, v74, v75
    v_cvt_pk_bf16_f32 v86, v76, v77
    v_cvt_pk_bf16_f32 v87, v78, v79
    ds_write_b128 v2, v[84:87] offset:35840
    s_waitcnt lgkmcnt(0)
    s_barrier
    v_add_f32 v64, v32, v96
    v_add_f32 v65, v33, v97
    v_add_f32 v66, v34, v98
    v_add_f32 v67, v35, v99
    v_add_f32 v68, v36, v100
    v_add_f32 v69, v37, v101
    v_add_f32 v70, v38, v102
    v_add_f32 v71, v39, v103
    ds_read_b128 v[32:35], v4 offset:16896
    ds_read_b128 v[36:39], v4 offset:16928
    v_exp_f32 v64, v64
    v_exp_f32 v65, v65
    v_exp_f32 v66, v66
    v_exp_f32 v67, v67
    v_exp_f32 v68, v68
    v_exp_f32 v69, v69
    v_exp_f32 v70, v70
    v_exp_f32 v71, v71
    v_add_f32 v64, 1.0, v64
    v_add_f32 v65, 1.0, v65
    v_add_f32 v66, 1.0, v66
    v_add_f32 v67, 1.0, v67
    v_add_f32 v68, 1.0, v68
    v_add_f32 v69, 1.0, v69
    v_add_f32 v70, 1.0, v70
    v_add_f32 v71, 1.0, v71
    v_rcp_f32 v64, v64
    v_rcp_f32 v65, v65
    v_rcp_f32 v66, v66
    v_rcp_f32 v67, v67
    v_rcp_f32 v68, v68
    v_rcp_f32 v69, v69
    v_rcp_f32 v70, v70
    v_rcp_f32 v71, v71
    s_nop 0
    v_cvt_pk_bf16_f32 v80, v64, v65
    v_cvt_pk_bf16_f32 v81, v66, v67
    v_cvt_pk_bf16_f32 v82, v68, v69
    v_cvt_pk_bf16_f32 v83, v70, v71
    ds_write_b128 v2, v[80:83] offset:0
    v_add_f32 v72, v40, v104
    v_add_f32 v73, v41, v105
    v_add_f32 v74, v42, v106
    v_add_f32 v75, v43, v107
    v_add_f32 v76, v44, v108
    v_add_f32 v77, v45, v109
    v_add_f32 v78, v46, v110
    v_add_f32 v79, v47, v111
    ds_read_b128 v[40:43], v4 offset:16960
    ds_read_b128 v[44:47], v4 offset:16992
    v_exp_f32 v72, v72
    v_exp_f32 v73, v73
    v_exp_f32 v74, v74
    v_exp_f32 v75, v75
    v_exp_f32 v76, v76
    v_exp_f32 v77, v77
    v_exp_f32 v78, v78
    v_exp_f32 v79, v79
    v_add_f32 v72, 1.0, v72
    v_add_f32 v73, 1.0, v73
    v_add_f32 v74, 1.0, v74
    v_add_f32 v75, 1.0, v75
    v_add_f32 v76, 1.0, v76
    v_add_f32 v77, 1.0, v77
    v_add_f32 v78, 1.0, v78
    v_add_f32 v79, 1.0, v79
    v_rcp_f32 v72, v72
    v_rcp_f32 v73, v73
    v_rcp_f32 v74, v74
    v_rcp_f32 v75, v75
    v_rcp_f32 v76, v76
    v_rcp_f32 v77, v77
    v_rcp_f32 v78, v78
    v_rcp_f32 v79, v79
    s_nop 0
    v_cvt_pk_bf16_f32 v84, v72, v73
    v_cvt_pk_bf16_f32 v85, v74, v75
    v_cvt_pk_bf16_f32 v86, v76, v77
    v_cvt_pk_bf16_f32 v87, v78, v79
    ds_write_b128 v2, v[84:87] offset:1024
    v_add_f32 v64, v48, v112
    v_add_f32 v65, v49, v113
    v_add_f32 v66, v50, v114
    v_add_f32 v67, v51, v115
    v_add_f32 v68, v52, v116
    v_add_f32 v69, v53, v117
    v_add_f32 v70, v54, v118
    v_add_f32 v71, v55, v119
    ds_read_b128 v[48:51], v4 offset:17024
    ds_read_b128 v[52:55], v4 offset:17056
    v_exp_f32 v64, v64
    v_exp_f32 v65, v65
    v_exp_f32 v66, v66
    v_exp_f32 v67, v67
    v_exp_f32 v68, v68
    v_exp_f32 v69, v69
    v_exp_f32 v70, v70
    v_exp_f32 v71, v71
    v_add_f32 v64, 1.0, v64
    v_add_f32 v65, 1.0, v65
    v_add_f32 v66, 1.0, v66
    v_add_f32 v67, 1.0, v67
    v_add_f32 v68, 1.0, v68
    v_add_f32 v69, 1.0, v69
    v_add_f32 v70, 1.0, v70
    v_add_f32 v71, 1.0, v71
    v_rcp_f32 v64, v64
    v_rcp_f32 v65, v65
    v_rcp_f32 v66, v66
    v_rcp_f32 v67, v67
    v_rcp_f32 v68, v68
    v_rcp_f32 v69, v69
    v_rcp_f32 v70, v70
    v_rcp_f32 v71, v71
    s_nop 0
    v_cvt_pk_bf16_f32 v80, v64, v65
    v_cvt_pk_bf16_f32 v81, v66, v67
    v_cvt_pk_bf16_f32 v82, v68, v69
    v_cvt_pk_bf16_f32 v83, v70, v71
    ds_write_b128 v2, v[80:83] offset:2048
    v_add_f32 v72, v56, v120
    v_add_f32 v73, v57, v121
    v_add_f32 v74, v58, v122
    v_add_f32 v75, v59, v123
    v_add_f32 v76, v60, v124
    v_add_f32 v77, v61, v125
    v_add_f32 v78, v62, v126
    v_add_f32 v79, v63, v127
    ds_read_b128 v[56:59], v4 offset:17088
    ds_read_b128 v[60:63], v4 offset:17120
    v_exp_f32 v72, v72
    v_exp_f32 v73, v73
    v_exp_f32 v74, v74
    v_exp_f32 v75, v75
    v_exp_f32 v76, v76
    v_exp_f32 v77, v77
    v_exp_f32 v78, v78
    v_exp_f32 v79, v79
    v_add_f32 v72, 1.0, v72
    v_add_f32 v73, 1.0, v73
    v_add_f32 v74, 1.0, v74
    v_add_f32 v75, 1.0, v75
    v_add_f32 v76, 1.0, v76
    v_add_f32 v77, 1.0, v77
    v_add_f32 v78, 1.0, v78
    v_add_f32 v79, 1.0, v79
    v_rcp_f32 v72, v72
    v_rcp_f32 v73, v73
    v_rcp_f32 v74, v74
    v_rcp_f32 v75, v75
    v_rcp_f32 v76, v76
    v_rcp_f32 v77, v77
    v_rcp_f32 v78, v78
    v_rcp_f32 v79, v79
    s_nop 0
    v_cvt_pk_bf16_f32 v84, v72, v73
    v_cvt_pk_bf16_f32 v85, v74, v75
    v_cvt_pk_bf16_f32 v86, v76, v77
    v_cvt_pk_bf16_f32 v87, v78, v79
    ds_write_b128 v2, v[84:87] offset:3072
    s_waitcnt lgkmcnt(0)
    s_barrier
    ds_read_b128 a[0:3], v6 offset:0
    ds_read_b128 a[4:7], v6 offset:1056
    ds_read_b128 a[8:11], v6 offset:2112
    ds_read_b128 a[12:15], v6 offset:3168
    v_add_f32 v64, v32, v96
    v_add_f32 v65, v33, v97
    v_add_f32 v66, v34, v98
    v_add_f32 v67, v35, v99
    v_add_f32 v68, v36, v100
    v_add_f32 v69, v37, v101
    v_add_f32 v70, v38, v102
    v_add_f32 v71, v39, v103
    ds_read_b128 v[32:35], v4 offset:21120
    ds_read_b128 v[36:39], v4 offset:21152
    v_exp_f32 v64, v64
    v_exp_f32 v65, v65
    v_exp_f32 v66, v66
    v_exp_f32 v67, v67
    v_exp_f32 v68, v68
    v_exp_f32 v69, v69
    v_exp_f32 v70, v70
    v_exp_f32 v71, v71
    v_add_f32 v64, 1.0, v64
    v_add_f32 v65, 1.0, v65
    v_add_f32 v66, 1.0, v66
    v_add_f32 v67, 1.0, v67
    v_add_f32 v68, 1.0, v68
    v_add_f32 v69, 1.0, v69
    v_add_f32 v70, 1.0, v70
    v_add_f32 v71, 1.0, v71
    v_rcp_f32 v64, v64
    v_rcp_f32 v65, v65
    v_rcp_f32 v66, v66
    v_rcp_f32 v67, v67
    v_rcp_f32 v68, v68
    v_rcp_f32 v69, v69
    v_rcp_f32 v70, v70
    v_rcp_f32 v71, v71
    s_waitcnt lgkmcnt(5)
    s_mov_b32 s36, 0
    buffer_store_dwordx4 a[0:3], v7, s[16:19], s36 offen sc1
    s_waitcnt lgkmcnt(4)
    s_mov_b32 s36, 1024
    buffer_store_dwordx4 a[4:7], v7, s[16:19], s36 offen sc1
    v_cvt_pk_bf16_f32 v80, v64, v65
    v_cvt_pk_bf16_f32 v81, v66, v67
    v_cvt_pk_bf16_f32 v82, v68, v69
    v_cvt_pk_bf16_f32 v83, v70, v71
    ds_write_b128 v2, v[80:83] offset:16384
    v_add_f32 v72, v40, v104
    v_add_f32 v73, v41, v105
    v_add_f32 v74, v42, v106
    v_add_f32 v75, v43, v107
    v_add_f32 v76, v44, v108
    v_add_f32 v77, v45, v109
    v_add_f32 v78, v46, v110
    v_add_f32 v79, v47, v111
    ds_read_b128 v[40:43], v4 offset:21184
    ds_read_b128 v[44:47], v4 offset:21216
    v_exp_f32 v72, v72
    v_exp_f32 v73, v73
    v_exp_f32 v74, v74
    v_exp_f32 v75, v75
    v_exp_f32 v76, v76
    v_exp_f32 v77, v77
    v_exp_f32 v78, v78
    v_exp_f32 v79, v79
    v_add_f32 v72, 1.0, v72
    v_add_f32 v73, 1.0, v73
    v_add_f32 v74, 1.0, v74
    v_add_f32 v75, 1.0, v75
    v_add_f32 v76, 1.0, v76
    v_add_f32 v77, 1.0, v77
    v_add_f32 v78, 1.0, v78
    v_add_f32 v79, 1.0, v79
    v_rcp_f32 v72, v72
    v_rcp_f32 v73, v73
    v_rcp_f32 v74, v74
    v_rcp_f32 v75, v75
    v_rcp_f32 v76, v76
    v_rcp_f32 v77, v77
    v_rcp_f32 v78, v78
    v_rcp_f32 v79, v79
    s_waitcnt lgkmcnt(6)
    s_mov_b32 s36, 2048
    buffer_store_dwordx4 a[8:11], v7, s[16:19], s36 offen sc1
    s_waitcnt lgkmcnt(5)
    s_mov_b32 s36, 3072
    buffer_store_dwordx4 a[12:15], v7, s[16:19], s36 offen sc1
    v_cvt_pk_bf16_f32 v84, v72, v73
    v_cvt_pk_bf16_f32 v85, v74, v75
    v_cvt_pk_bf16_f32 v86, v76, v77
    v_cvt_pk_bf16_f32 v87, v78, v79
    ds_write_b128 v2, v[84:87] offset:17408
    v_add_f32 v64, v48, v112
    v_add_f32 v65, v49, v113
    v_add_f32 v66, v50, v114
    v_add_f32 v67, v51, v115
    v_add_f32 v68, v52, v116
    v_add_f32 v69, v53, v117
    v_add_f32 v70, v54, v118
    v_add_f32 v71, v55, v119
    ds_read_b128 v[48:51], v4 offset:21248
    ds_read_b128 v[52:55], v4 offset:21280
    v_exp_f32 v64, v64
    v_exp_f32 v65, v65
    v_exp_f32 v66, v66
    v_exp_f32 v67, v67
    v_exp_f32 v68, v68
    v_exp_f32 v69, v69
    v_exp_f32 v70, v70
    v_exp_f32 v71, v71
    v_add_f32 v64, 1.0, v64
    v_add_f32 v65, 1.0, v65
    v_add_f32 v66, 1.0, v66
    v_add_f32 v67, 1.0, v67
    v_add_f32 v68, 1.0, v68
    v_add_f32 v69, 1.0, v69
    v_add_f32 v70, 1.0, v70
    v_add_f32 v71, 1.0, v71
    v_rcp_f32 v64, v64
    v_rcp_f32 v65, v65
    v_rcp_f32 v66, v66
    v_rcp_f32 v67, v67
    v_rcp_f32 v68, v68
    v_rcp_f32 v69, v69
    v_rcp_f32 v70, v70
    v_rcp_f32 v71, v71
    s_nop 0
    v_cvt_pk_bf16_f32 v80, v64, v65
    v_cvt_pk_bf16_f32 v81, v66, v67
    v_cvt_pk_bf16_f32 v82, v68, v69
    v_cvt_pk_bf16_f32 v83, v70, v71
    ds_write_b128 v2, v[80:83] offset:18432
    v_add_f32 v72, v56, v120
    v_add_f32 v73, v57, v121
    v_add_f32 v74, v58, v122
    v_add_f32 v75, v59, v123
    v_add_f32 v76, v60, v124
    v_add_f32 v77, v61, v125
    v_add_f32 v78, v62, v126
    v_add_f32 v79, v63, v127
    ds_read_b128 v[56:59], v4 offset:21312
    ds_read_b128 v[60:63], v4 offset:21344
    v_exp_f32 v72, v72
    v_exp_f32 v73, v73
    v_exp_f32 v74, v74
    v_exp_f32 v75, v75
    v_exp_f32 v76, v76
    v_exp_f32 v77, v77
    v_exp_f32 v78, v78
    v_exp_f32 v79, v79
    v_add_f32 v72, 1.0, v72
    v_add_f32 v73, 1.0, v73
    v_add_f32 v74, 1.0, v74
    v_add_f32 v75, 1.0, v75
    v_add_f32 v76, 1.0, v76
    v_add_f32 v77, 1.0, v77
    v_add_f32 v78, 1.0, v78
    v_add_f32 v79, 1.0, v79
    v_rcp_f32 v72, v72
    v_rcp_f32 v73, v73
    v_rcp_f32 v74, v74
    v_rcp_f32 v75, v75
    v_rcp_f32 v76, v76
    v_rcp_f32 v77, v77
    v_rcp_f32 v78, v78
    v_rcp_f32 v79, v79
    s_nop 0
    v_cvt_pk_bf16_f32 v84, v72, v73
    v_cvt_pk_bf16_f32 v85, v74, v75
    v_cvt_pk_bf16_f32 v86, v76, v77
    v_cvt_pk_bf16_f32 v87, v78, v79
    ds_write_b128 v2, v[84:87] offset:19456
    s_waitcnt lgkmcnt(0)
    s_barrier
    ds_read_b128 a[0:3], v6 offset:16896
    ds_read_b128 a[4:7], v6 offset:17952
    ds_read_b128 a[8:11], v6 offset:19008
    ds_read_b128 a[12:15], v6 offset:20064
    v_add_f32 v64, v32, v96
    v_add_f32 v65, v33, v97
    v_add_f32 v66, v34, v98
    v_add_f32 v67, v35, v99
    v_add_f32 v68, v36, v100
    v_add_f32 v69, v37, v101
    v_add_f32 v70, v38, v102
    v_add_f32 v71, v39, v103
    ds_read_b128 v[32:35], v4 offset:25344
    ds_read_b128 v[36:39], v4 offset:25376
    v_exp_f32 v64, v64
    v_exp_f32 v65, v65
    v_exp_f32 v66, v66
    v_exp_f32 v67, v67
    v_exp_f32 v68, v68
    v_exp_f32 v69, v69
    v_exp_f32 v70, v70
    v_exp_f32 v71, v71
    v_add_f32 v64, 1.0, v64
    v_add_f32 v65, 1.0, v65
    v_add_f32 v66, 1.0, v66
    v_add_f32 v67, 1.0, v67
    v_add_f32 v68, 1.0, v68
    v_add_f32 v69, 1.0, v69
    v_add_f32 v70, 1.0, v70
    v_add_f32 v71, 1.0, v71
    v_rcp_f32 v64, v64
    v_rcp_f32 v65, v65
    v_rcp_f32 v66, v66
    v_rcp_f32 v67, v67
    v_rcp_f32 v68, v68
    v_rcp_f32 v69, v69
    v_rcp_f32 v70, v70
    v_rcp_f32 v71, v71
    s_waitcnt lgkmcnt(5)
    s_mov_b32 s36, 16384
    buffer_store_dwordx4 a[0:3], v7, s[16:19], s36 offen sc1
    s_waitcnt lgkmcnt(4)
    s_mov_b32 s36, 17408
    buffer_store_dwordx4 a[4:7], v7, s[16:19], s36 offen sc1
    v_cvt_pk_bf16_f32 v80, v64, v65
    v_cvt_pk_bf16_f32 v81, v66, v67
    v_cvt_pk_bf16_f32 v82, v68, v69
    v_cvt_pk_bf16_f32 v83, v70, v71
    ds_write_b128 v2, v[80:83] offset:32768
    v_add_f32 v72, v40, v104
    v_add_f32 v73, v41, v105
    v_add_f32 v74, v42, v106
    v_add_f32 v75, v43, v107
    v_add_f32 v76, v44, v108
    v_add_f32 v77, v45, v109
    v_add_f32 v78, v46, v110
    v_add_f32 v79, v47, v111
    ds_read_b128 v[40:43], v4 offset:25408
    ds_read_b128 v[44:47], v4 offset:25440
    v_exp_f32 v72, v72
    v_exp_f32 v73, v73
    v_exp_f32 v74, v74
    v_exp_f32 v75, v75
    v_exp_f32 v76, v76
    v_exp_f32 v77, v77
    v_exp_f32 v78, v78
    v_exp_f32 v79, v79
    v_add_f32 v72, 1.0, v72
    v_add_f32 v73, 1.0, v73
    v_add_f32 v74, 1.0, v74
    v_add_f32 v75, 1.0, v75
    v_add_f32 v76, 1.0, v76
    v_add_f32 v77, 1.0, v77
    v_add_f32 v78, 1.0, v78
    v_add_f32 v79, 1.0, v79
    v_rcp_f32 v72, v72
    v_rcp_f32 v73, v73
    v_rcp_f32 v74, v74
    v_rcp_f32 v75, v75
    v_rcp_f32 v76, v76
    v_rcp_f32 v77, v77
    v_rcp_f32 v78, v78
    v_rcp_f32 v79, v79
    s_waitcnt lgkmcnt(6)
    s_mov_b32 s36, 18432
    buffer_store_dwordx4 a[8:11], v7, s[16:19], s36 offen sc1
    s_waitcnt lgkmcnt(5)
    s_mov_b32 s36, 19456
    buffer_store_dwordx4 a[12:15], v7, s[16:19], s36 offen sc1
    v_cvt_pk_bf16_f32 v84, v72, v73
    v_cvt_pk_bf16_f32 v85, v74, v75
    v_cvt_pk_bf16_f32 v86, v76, v77
    v_cvt_pk_bf16_f32 v87, v78, v79
    ds_write_b128 v2, v[84:87] offset:33792
    v_add_f32 v64, v48, v112
    v_add_f32 v65, v49, v113
    v_add_f32 v66, v50, v114
    v_add_f32 v67, v51, v115
    v_add_f32 v68, v52, v116
    v_add_f32 v69, v53, v117
    v_add_f32 v70, v54, v118
    v_add_f32 v71, v55, v119
    ds_read_b128 v[48:51], v4 offset:25472
    ds_read_b128 v[52:55], v4 offset:25504
    v_exp_f32 v64, v64
    v_exp_f32 v65, v65
    v_exp_f32 v66, v66
    v_exp_f32 v67, v67
    v_exp_f32 v68, v68
    v_exp_f32 v69, v69
    v_exp_f32 v70, v70
    v_exp_f32 v71, v71
    v_add_f32 v64, 1.0, v64
    v_add_f32 v65, 1.0, v65
    v_add_f32 v66, 1.0, v66
    v_add_f32 v67, 1.0, v67
    v_add_f32 v68, 1.0, v68
    v_add_f32 v69, 1.0, v69
    v_add_f32 v70, 1.0, v70
    v_add_f32 v71, 1.0, v71
    v_rcp_f32 v64, v64
    v_rcp_f32 v65, v65
    v_rcp_f32 v66, v66
    v_rcp_f32 v67, v67
    v_rcp_f32 v68, v68
    v_rcp_f32 v69, v69
    v_rcp_f32 v70, v70
    v_rcp_f32 v71, v71
    s_nop 0
    v_cvt_pk_bf16_f32 v80, v64, v65
    v_cvt_pk_bf16_f32 v81, v66, v67
    v_cvt_pk_bf16_f32 v82, v68, v69
    v_cvt_pk_bf16_f32 v83, v70, v71
    ds_write_b128 v2, v[80:83] offset:34816
    v_add_f32 v72, v56, v120
    v_add_f32 v73, v57, v121
    v_add_f32 v74, v58, v122
    v_add_f32 v75, v59, v123
    v_add_f32 v76, v60, v124
    v_add_f32 v77, v61, v125
    v_add_f32 v78, v62, v126
    v_add_f32 v79, v63, v127
    ds_read_b128 v[56:59], v4 offset:25536
    ds_read_b128 v[60:63], v4 offset:25568
    v_exp_f32 v72, v72
    v_exp_f32 v73, v73
    v_exp_f32 v74, v74
    v_exp_f32 v75, v75
    v_exp_f32 v76, v76
    v_exp_f32 v77, v77
    v_exp_f32 v78, v78
    v_exp_f32 v79, v79
    v_add_f32 v72, 1.0, v72
    v_add_f32 v73, 1.0, v73
    v_add_f32 v74, 1.0, v74
    v_add_f32 v75, 1.0, v75
    v_add_f32 v76, 1.0, v76
    v_add_f32 v77, 1.0, v77
    v_add_f32 v78, 1.0, v78
    v_add_f32 v79, 1.0, v79
    v_rcp_f32 v72, v72
    v_rcp_f32 v73, v73
    v_rcp_f32 v74, v74
    v_rcp_f32 v75, v75
    v_rcp_f32 v76, v76
    v_rcp_f32 v77, v77
    v_rcp_f32 v78, v78
    v_rcp_f32 v79, v79
    s_nop 0
    v_cvt_pk_bf16_f32 v84, v72, v73
    v_cvt_pk_bf16_f32 v85, v74, v75
    v_cvt_pk_bf16_f32 v86, v76, v77
    v_cvt_pk_bf16_f32 v87, v78, v79
    ds_write_b128 v2, v[84:87] offset:35840
    s_waitcnt lgkmcnt(0)
    s_barrier
    ds_read_b128 a[0:3], v6 offset:0
    ds_read_b128 a[4:7], v6 offset:1056
    ds_read_b128 a[8:11], v6 offset:2112
    ds_read_b128 a[12:15], v6 offset:3168
    v_add_f32 v64, v32, v96
    v_add_f32 v65, v33, v97
    v_add_f32 v66, v34, v98
    v_add_f32 v67, v35, v99
    v_add_f32 v68, v36, v100
    v_add_f32 v69, v37, v101
    v_add_f32 v70, v38, v102
    v_add_f32 v71, v39, v103
    ds_read_b128 v[32:35], v4 offset:29568
    ds_read_b128 v[36:39], v4 offset:29600
    v_exp_f32 v64, v64
    v_exp_f32 v65, v65
    v_exp_f32 v66, v66
    v_exp_f32 v67, v67
    v_exp_f32 v68, v68
    v_exp_f32 v69, v69
    v_exp_f32 v70, v70
    v_exp_f32 v71, v71
    v_add_f32 v64, 1.0, v64
    v_add_f32 v65, 1.0, v65
    v_add_f32 v66, 1.0, v66
    v_add_f32 v67, 1.0, v67
    v_add_f32 v68, 1.0, v68
    v_add_f32 v69, 1.0, v69
    v_add_f32 v70, 1.0, v70
    v_add_f32 v71, 1.0, v71
    v_rcp_f32 v64, v64
    v_rcp_f32 v65, v65
    v_rcp_f32 v66, v66
    v_rcp_f32 v67, v67
    v_rcp_f32 v68, v68
    v_rcp_f32 v69, v69
    v_rcp_f32 v70, v70
    v_rcp_f32 v71, v71
    s_waitcnt lgkmcnt(5)
    s_mov_b32 s36, 32768
    buffer_store_dwordx4 a[0:3], v7, s[16:19], s36 offen sc1
    s_waitcnt lgkmcnt(4)
    s_mov_b32 s36, 33792
    buffer_store_dwordx4 a[4:7], v7, s[16:19], s36 offen sc1
    v_cvt_pk_bf16_f32 v80, v64, v65
    v_cvt_pk_bf16_f32 v81, v66, v67
    v_cvt_pk_bf16_f32 v82, v68, v69
    v_cvt_pk_bf16_f32 v83, v70, v71
    ds_write_b128 v2, v[80:83] offset:0
    v_add_f32 v72, v40, v104
    v_add_f32 v73, v41, v105
    v_add_f32 v74, v42, v106
    v_add_f32 v75, v43, v107
    v_add_f32 v76, v44, v108
    v_add_f32 v77, v45, v109
    v_add_f32 v78, v46, v110
    v_add_f32 v79, v47, v111
    ds_read_b128 v[40:43], v4 offset:29632
    ds_read_b128 v[44:47], v4 offset:29664
    v_exp_f32 v72, v72
    v_exp_f32 v73, v73
    v_exp_f32 v74, v74
    v_exp_f32 v75, v75
    v_exp_f32 v76, v76
    v_exp_f32 v77, v77
    v_exp_f32 v78, v78
    v_exp_f32 v79, v79
    v_add_f32 v72, 1.0, v72
    v_add_f32 v73, 1.0, v73
    v_add_f32 v74, 1.0, v74
    v_add_f32 v75, 1.0, v75
    v_add_f32 v76, 1.0, v76
    v_add_f32 v77, 1.0, v77
    v_add_f32 v78, 1.0, v78
    v_add_f32 v79, 1.0, v79
    v_rcp_f32 v72, v72
    v_rcp_f32 v73, v73
    v_rcp_f32 v74, v74
    v_rcp_f32 v75, v75
    v_rcp_f32 v76, v76
    v_rcp_f32 v77, v77
    v_rcp_f32 v78, v78
    v_rcp_f32 v79, v79
    s_waitcnt lgkmcnt(6)
    s_mov_b32 s36, 34816
    buffer_store_dwordx4 a[8:11], v7, s[16:19], s36 offen sc1
    s_waitcnt lgkmcnt(5)
    s_mov_b32 s36, 35840
    buffer_store_dwordx4 a[12:15], v7, s[16:19], s36 offen sc1
    v_cvt_pk_bf16_f32 v84, v72, v73
    v_cvt_pk_bf16_f32 v85, v74, v75
    v_cvt_pk_bf16_f32 v86, v76, v77
    v_cvt_pk_bf16_f32 v87, v78, v79
    ds_write_b128 v2, v[84:87] offset:1024
    v_add_f32 v64, v48, v112
    v_add_f32 v65, v49, v113
    v_add_f32 v66, v50, v114
    v_add_f32 v67, v51, v115
    v_add_f32 v68, v52, v116
    v_add_f32 v69, v53, v117
    v_add_f32 v70, v54, v118
    v_add_f32 v71, v55, v119
    ds_read_b128 v[48:51], v4 offset:29696
    ds_read_b128 v[52:55], v4 offset:29728
    v_exp_f32 v64, v64
    v_exp_f32 v65, v65
    v_exp_f32 v66, v66
    v_exp_f32 v67, v67
    v_exp_f32 v68, v68
    v_exp_f32 v69, v69
    v_exp_f32 v70, v70
    v_exp_f32 v71, v71
    v_add_f32 v64, 1.0, v64
    v_add_f32 v65, 1.0, v65
    v_add_f32 v66, 1.0, v66
    v_add_f32 v67, 1.0, v67
    v_add_f32 v68, 1.0, v68
    v_add_f32 v69, 1.0, v69
    v_add_f32 v70, 1.0, v70
    v_add_f32 v71, 1.0, v71
    v_rcp_f32 v64, v64
    v_rcp_f32 v65, v65
    v_rcp_f32 v66, v66
    v_rcp_f32 v67, v67
    v_rcp_f32 v68, v68
    v_rcp_f32 v69, v69
    v_rcp_f32 v70, v70
    v_rcp_f32 v71, v71
    s_nop 0
    v_cvt_pk_bf16_f32 v80, v64, v65
    v_cvt_pk_bf16_f32 v81, v66, v67
    v_cvt_pk_bf16_f32 v82, v68, v69
    v_cvt_pk_bf16_f32 v83, v70, v71
    ds_write_b128 v2, v[80:83] offset:2048
    v_add_f32 v72, v56, v120
    v_add_f32 v73, v57, v121
    v_add_f32 v74, v58, v122
    v_add_f32 v75, v59, v123
    v_add_f32 v76, v60, v124
    v_add_f32 v77, v61, v125
    v_add_f32 v78, v62, v126
    v_add_f32 v79, v63, v127
    ds_read_b128 v[56:59], v4 offset:29760
    ds_read_b128 v[60:63], v4 offset:29792
    v_exp_f32 v72, v72
    v_exp_f32 v73, v73
    v_exp_f32 v74, v74
    v_exp_f32 v75, v75
    v_exp_f32 v76, v76
    v_exp_f32 v77, v77
    v_exp_f32 v78, v78
    v_exp_f32 v79, v79
    v_add_f32 v72, 1.0, v72
    v_add_f32 v73, 1.0, v73
    v_add_f32 v74, 1.0, v74
    v_add_f32 v75, 1.0, v75
    v_add_f32 v76, 1.0, v76
    v_add_f32 v77, 1.0, v77
    v_add_f32 v78, 1.0, v78
    v_add_f32 v79, 1.0, v79
    v_rcp_f32 v72, v72
    v_rcp_f32 v73, v73
    v_rcp_f32 v74, v74
    v_rcp_f32 v75, v75
    v_rcp_f32 v76, v76
    v_rcp_f32 v77, v77
    v_rcp_f32 v78, v78
    v_rcp_f32 v79, v79
    s_nop 0
    v_cvt_pk_bf16_f32 v84, v72, v73
    v_cvt_pk_bf16_f32 v85, v74, v75
    v_cvt_pk_bf16_f32 v86, v76, v77
    v_cvt_pk_bf16_f32 v87, v78, v79
    ds_write_b128 v2, v[84:87] offset:3072
    s_waitcnt lgkmcnt(0)
    s_barrier
    ds_read_b128 a[0:3], v6 offset:16896
    ds_read_b128 a[4:7], v6 offset:17952
    ds_read_b128 a[8:11], v6 offset:19008
    ds_read_b128 a[12:15], v6 offset:20064
    v_add_f32 v64, v32, v96
    v_add_f32 v65, v33, v97
    v_add_f32 v66, v34, v98
    v_add_f32 v67, v35, v99
    v_add_f32 v68, v36, v100
    v_add_f32 v69, v37, v101
    v_add_f32 v70, v38, v102
    v_add_f32 v71, v39, v103
    v_exp_f32 v64, v64
    v_exp_f32 v65, v65
    v_exp_f32 v66, v66
    v_exp_f32 v67, v67
    v_exp_f32 v68, v68
    v_exp_f32 v69, v69
    v_exp_f32 v70, v70
    v_exp_f32 v71, v71
    v_add_f32 v64, 1.0, v64
    v_add_f32 v65, 1.0, v65
    v_add_f32 v66, 1.0, v66
    v_add_f32 v67, 1.0, v67
    v_add_f32 v68, 1.0, v68
    v_add_f32 v69, 1.0, v69
    v_add_f32 v70, 1.0, v70
    v_add_f32 v71, 1.0, v71
    v_rcp_f32 v64, v64
    v_rcp_f32 v65, v65
    v_rcp_f32 v66, v66
    v_rcp_f32 v67, v67
    v_rcp_f32 v68, v68
    v_rcp_f32 v69, v69
    v_rcp_f32 v70, v70
    v_rcp_f32 v71, v71
    s_waitcnt lgkmcnt(3)
    s_mov_b32 s36, 49152
    buffer_store_dwordx4 a[0:3], v7, s[16:19], s36 offen sc1
    s_waitcnt lgkmcnt(2)
    s_mov_b32 s36, 50176
    buffer_store_dwordx4 a[4:7], v7, s[16:19], s36 offen sc1
    v_cvt_pk_bf16_f32 v80, v64, v65
    v_cvt_pk_bf16_f32 v81, v66, v67
    v_cvt_pk_bf16_f32 v82, v68, v69
    v_cvt_pk_bf16_f32 v83, v70, v71
    ds_write_b128 v2, v[80:83] offset:16384
    v_add_f32 v72, v40, v104
    v_add_f32 v73, v41, v105
    v_add_f32 v74, v42, v106
    v_add_f32 v75, v43, v107
    v_add_f32 v76, v44, v108
    v_add_f32 v77, v45, v109
    v_add_f32 v78, v46, v110
    v_add_f32 v79, v47, v111
    v_exp_f32 v72, v72
    v_exp_f32 v73, v73
    v_exp_f32 v74, v74
    v_exp_f32 v75, v75
    v_exp_f32 v76, v76
    v_exp_f32 v77, v77
    v_exp_f32 v78, v78
    v_exp_f32 v79, v79
    v_add_f32 v72, 1.0, v72
    v_add_f32 v73, 1.0, v73
    v_add_f32 v74, 1.0, v74
    v_add_f32 v75, 1.0, v75
    v_add_f32 v76, 1.0, v76
    v_add_f32 v77, 1.0, v77
    v_add_f32 v78, 1.0, v78
    v_add_f32 v79, 1.0, v79
    v_rcp_f32 v72, v72
    v_rcp_f32 v73, v73
    v_rcp_f32 v74, v74
    v_rcp_f32 v75, v75
    v_rcp_f32 v76, v76
    v_rcp_f32 v77, v77
    v_rcp_f32 v78, v78
    v_rcp_f32 v79, v79
    s_waitcnt lgkmcnt(2)
    s_mov_b32 s36, 51200
    buffer_store_dwordx4 a[8:11], v7, s[16:19], s36 offen sc1
    s_waitcnt lgkmcnt(1)
    s_mov_b32 s36, 52224
    buffer_store_dwordx4 a[12:15], v7, s[16:19], s36 offen sc1
    v_cvt_pk_bf16_f32 v84, v72, v73
    v_cvt_pk_bf16_f32 v85, v74, v75
    v_cvt_pk_bf16_f32 v86, v76, v77
    v_cvt_pk_bf16_f32 v87, v78, v79
    ds_write_b128 v2, v[84:87] offset:17408
    v_add_f32 v64, v48, v112
    v_add_f32 v65, v49, v113
    v_add_f32 v66, v50, v114
    v_add_f32 v67, v51, v115
    v_add_f32 v68, v52, v116
    v_add_f32 v69, v53, v117
    v_add_f32 v70, v54, v118
    v_add_f32 v71, v55, v119
    v_exp_f32 v64, v64
    v_exp_f32 v65, v65
    v_exp_f32 v66, v66
    v_exp_f32 v67, v67
    v_exp_f32 v68, v68
    v_exp_f32 v69, v69
    v_exp_f32 v70, v70
    v_exp_f32 v71, v71
    v_add_f32 v64, 1.0, v64
    v_add_f32 v65, 1.0, v65
    v_add_f32 v66, 1.0, v66
    v_add_f32 v67, 1.0, v67
    v_add_f32 v68, 1.0, v68
    v_add_f32 v69, 1.0, v69
    v_add_f32 v70, 1.0, v70
    v_add_f32 v71, 1.0, v71
    v_rcp_f32 v64, v64
    v_rcp_f32 v65, v65
    v_rcp_f32 v66, v66
    v_rcp_f32 v67, v67
    v_rcp_f32 v68, v68
    v_rcp_f32 v69, v69
    v_rcp_f32 v70, v70
    v_rcp_f32 v71, v71
    s_nop 0
    v_cvt_pk_bf16_f32 v80, v64, v65
    v_cvt_pk_bf16_f32 v81, v66, v67
    v_cvt_pk_bf16_f32 v82, v68, v69
    v_cvt_pk_bf16_f32 v83, v70, v71
    ds_write_b128 v2, v[80:83] offset:18432
    v_add_f32 v72, v56, v120
    v_add_f32 v73, v57, v121
    v_add_f32 v74, v58, v122
    v_add_f32 v75, v59, v123
    v_add_f32 v76, v60, v124
    v_add_f32 v77, v61, v125
    v_add_f32 v78, v62, v126
    v_add_f32 v79, v63, v127
    v_exp_f32 v72, v72
    v_exp_f32 v73, v73
    v_exp_f32 v74, v74
    v_exp_f32 v75, v75
    v_exp_f32 v76, v76
    v_exp_f32 v77, v77
    v_exp_f32 v78, v78
    v_exp_f32 v79, v79
    v_add_f32 v72, 1.0, v72
    v_add_f32 v73, 1.0, v73
    v_add_f32 v74, 1.0, v74
    v_add_f32 v75, 1.0, v75
    v_add_f32 v76, 1.0, v76
    v_add_f32 v77, 1.0, v77
    v_add_f32 v78, 1.0, v78
    v_add_f32 v79, 1.0, v79
    v_rcp_f32 v72, v72
    v_rcp_f32 v73, v73
    v_rcp_f32 v74, v74
    v_rcp_f32 v75, v75
    v_rcp_f32 v76, v76
    v_rcp_f32 v77, v77
    v_rcp_f32 v78, v78
    v_rcp_f32 v79, v79
    s_nop 0
    v_cvt_pk_bf16_f32 v84, v72, v73
    v_cvt_pk_bf16_f32 v85, v74, v75
    v_cvt_pk_bf16_f32 v86, v76, v77
    v_cvt_pk_bf16_f32 v87, v78, v79
    ds_write_b128 v2, v[84:87] offset:19456
    s_waitcnt lgkmcnt(0)
    s_barrier
    ds_read_b128 a[0:3], v6 offset:0
    ds_read_b128 a[4:7], v6 offset:1056
    ds_read_b128 a[8:11], v6 offset:2112
    ds_read_b128 a[12:15], v6 offset:3168
    s_waitcnt lgkmcnt(3)
    s_mov_b32 s36, 65536
    buffer_store_dwordx4 a[0:3], v7, s[16:19], s36 offen sc1
    s_waitcnt lgkmcnt(2)
    s_mov_b32 s36, 66560
    buffer_store_dwordx4 a[4:7], v7, s[16:19], s36 offen sc1
    s_waitcnt lgkmcnt(1)
    s_mov_b32 s36, 67584
    buffer_store_dwordx4 a[8:11], v7, s[16:19], s36 offen sc1
    s_waitcnt lgkmcnt(0)
    s_mov_b32 s36, 68608
    buffer_store_dwordx4 a[12:15], v7, s[16:19], s36 offen sc1
    s_barrier
    ds_read_b128 a[0:3], v6 offset:16896
    ds_read_b128 a[4:7], v6 offset:17952
    ds_read_b128 a[8:11], v6 offset:19008
    ds_read_b128 a[12:15], v6 offset:20064
    s_waitcnt lgkmcnt(3)
    s_mov_b32 s36, 81920
    buffer_store_dwordx4 a[0:3], v7, s[16:19], s36 offen sc1
    s_waitcnt lgkmcnt(2)
    s_mov_b32 s36, 82944
    buffer_store_dwordx4 a[4:7], v7, s[16:19], s36 offen sc1
    s_waitcnt lgkmcnt(1)
    s_mov_b32 s36, 83968
    buffer_store_dwordx4 a[8:11], v7, s[16:19], s36 offen sc1
    s_waitcnt lgkmcnt(0)
    s_mov_b32 s36, 84992
    buffer_store_dwordx4 a[12:15], v7, s[16:19], s36 offen sc1
    s_barrier
    ds_read_b128 a[0:3], v6 offset:0
    ds_read_b128 a[4:7], v6 offset:1056
    ds_read_b128 a[8:11], v6 offset:2112
    ds_read_b128 a[12:15], v6 offset:3168
    s_waitcnt lgkmcnt(3)
    s_mov_b32 s36, 98304
    buffer_store_dwordx4 a[0:3], v7, s[16:19], s36 offen sc1
    s_waitcnt lgkmcnt(2)
    s_mov_b32 s36, 99328
    buffer_store_dwordx4 a[4:7], v7, s[16:19], s36 offen sc1
    s_waitcnt lgkmcnt(1)
    s_mov_b32 s36, 100352
    buffer_store_dwordx4 a[8:11], v7, s[16:19], s36 offen sc1
    s_waitcnt lgkmcnt(0)
    s_mov_b32 s36, 101376
    buffer_store_dwordx4 a[12:15], v7, s[16:19], s36 offen sc1
    s_barrier
    ds_read_b128 a[0:3], v6 offset:16896
    ds_read_b128 a[4:7], v6 offset:17952
    ds_read_b128 a[8:11], v6 offset:19008
    ds_read_b128 a[12:15], v6 offset:20064
    s_waitcnt lgkmcnt(3)
    s_mov_b32 s36, 114688
    buffer_store_dwordx4 a[0:3], v7, s[16:19], s36 offen sc1
    s_waitcnt lgkmcnt(2)
    s_mov_b32 s36, 115712
    buffer_store_dwordx4 a[4:7], v7, s[16:19], s36 offen sc1
    s_waitcnt lgkmcnt(1)
    s_mov_b32 s36, 116736
    buffer_store_dwordx4 a[8:11], v7, s[16:19], s36 offen sc1
    s_waitcnt lgkmcnt(0)
    s_mov_b32 s36, 117760
    buffer_store_dwordx4 a[12:15], v7, s[16:19], s36 offen sc1
    s_endpgm
L_joint_kernel_done:
    s_endpgm
.section .rodata,"a"
.p2align 6
.amdhsa_kernel prep_kernel
  .amdhsa_next_free_vgpr 128
  .amdhsa_next_free_sgpr 102
  .amdhsa_accum_offset 128
  .amdhsa_group_segment_fixed_size 0
  .amdhsa_kernarg_size 80
  .amdhsa_user_sgpr_count 2
  .amdhsa_user_sgpr_kernarg_segment_ptr 1
  .amdhsa_system_sgpr_workgroup_id_x 1
.end_amdhsa_kernel
.p2align 6
.amdhsa_kernel gemm1_kernel
  .amdhsa_next_free_vgpr 232
  .amdhsa_next_free_sgpr 102
  .amdhsa_accum_offset 232
  .amdhsa_group_segment_fixed_size 0
  .amdhsa_kernarg_size 80
  .amdhsa_user_sgpr_count 2
  .amdhsa_user_sgpr_kernarg_segment_ptr 1
  .amdhsa_system_sgpr_workgroup_id_x 1
.end_amdhsa_kernel
.p2align 6
.amdhsa_kernel mid_kernel
  .amdhsa_next_free_vgpr 128
  .amdhsa_next_free_sgpr 102
  .amdhsa_accum_offset 128
  .amdhsa_group_segment_fixed_size 0
  .amdhsa_kernarg_size 80
  .amdhsa_user_sgpr_count 2
  .amdhsa_user_sgpr_kernarg_segment_ptr 1
  .amdhsa_system_sgpr_workgroup_id_x 1
.end_amdhsa_kernel
.p2align 6
.amdhsa_kernel gemm2_kernel
  .amdhsa_next_free_vgpr 152
  .amdhsa_next_free_sgpr 102
  .amdhsa_accum_offset 152
  .amdhsa_group_segment_fixed_size 0
  .amdhsa_kernarg_size 80
  .amdhsa_user_sgpr_count 2
  .amdhsa_user_sgpr_kernarg_segment_ptr 1
  .amdhsa_system_sgpr_workgroup_id_x 1
.end_amdhsa_kernel
.p2align 6
.amdhsa_kernel joint_kernel
  .amdhsa_next_free_vgpr 256
  .amdhsa_next_free_sgpr 102
  .amdhsa_accum_offset 128
  .amdhsa_group_segment_fixed_size 0
  .amdhsa_kernarg_size 80
  .amdhsa_user_sgpr_count 2
  .amdhsa_user_sgpr_kernarg_segment_ptr 1
  .amdhsa_system_sgpr_workgroup_id_x 1
.end_amdhsa_kernel
```
